```python
import torch

def _softmax(x, axis=-1):
    return torch.softmax(x, dim=axis)

def _gelu(x):
    return torch.nn.functional.gelu(x, approximate='tanh')

def _silu(x):
    return torch.nn.functional.silu(x)

def _sigmoid(x):
    return torch.sigmoid(x)

def _layernorm(x, axis=-1, eps=1e-05):
    m = x.mean(dim=axis, keepdim=True)
    v = x.var(dim=axis, keepdim=True, unbiased=False)
    return (x - m) / torch.sqrt(v + eps)

def _scatter_add(tgt, idx, src, axis=0):
    return tgt.clone().index_add_(axis, idx, src)

def _segment_sum(src, seg, n):
    out = torch.zeros((n,) + src.shape[1:], dtype=src.dtype)
    return out.index_add_(0, seg, src)

def _pad(x, pw):
    flat = tuple((v for pair in reversed(pw) for v in pair))
    return torch.nn.functional.pad(x, flat)
kernel_name = 'sequential_preLN__memory_aug_recurrent_mem_tr__geglu_ffn__prompt'

def setup_inputs():

    _w = lambda a: (lambda t: t.to(torch.bfloat16) if t.is_floating_point() else t)(torch.as_tensor(a))

    def _A_setup():
        B, S, Dm = (1, 2048, 1024)
        H, Dh = (32, 128)
        M, seg = (8, 32)
        seg = min(seg, S)
        S = S // seg * seg
        return {'x': _w((lambda *s: torch.randn(*s, dtype=torch.bfloat16) * 0.05)(B, S, Dm)), 'mem0': _w((lambda *s: torch.randn(*s, dtype=torch.bfloat16) * 0.2)(B, M, Dm)), 'Wq': _w((lambda *s: torch.randn(*s, dtype=torch.bfloat16) * 1.6)(Dm, H, Dh) * Dm ** (-0.5)), 'Wk': _w((lambda *s: torch.randn(*s, dtype=torch.bfloat16) * 1.6)(Dm, H, Dh) * Dm ** (-0.5)), 'Wv': _w((lambda *s: torch.randn(*s, dtype=torch.bfloat16) * 0.2)(Dm, H, Dh) * Dm ** (-0.5)), 'Wo': _w((lambda *s: torch.randn(*s, dtype=torch.bfloat16) * 0.2)(H, Dh, Dm) * (H * Dh) ** (-0.5)), 'seg_len': seg}
    _A_in = _A_setup()

    def _B_setup():
        B, S, D, F = (1, 2048, 1024, 3584)
        return {'x': _w((lambda *s: torch.randn(*s, dtype=torch.bfloat16) * 0.05)(B, S, D)), 'w_gate': _w((lambda *s: torch.randn(*s, dtype=torch.bfloat16) * 0.05)(D, F)), 'w_up': _w((lambda *s: torch.randn(*s, dtype=torch.bfloat16) * 0.05)(D, F)), 'w_down': _w((lambda *s: torch.randn(*s, dtype=torch.bfloat16) * 0.05)(F, D))}
    _B_in = _B_setup()
    return {'A_x': _A_in['x'], 'A_mem0': _A_in['mem0'], 'A_Wq': _A_in['Wq'], 'A_Wk': _A_in['Wk'], 'A_Wv': _A_in['Wv'], 'A_Wo': _A_in['Wo'], 'A_seg_len': _A_in['seg_len'], 'B_x': _B_in['x'], 'B_w_gate': _B_in['w_gate'], 'B_w_up': _B_in['w_up'], 'B_w_down': _B_in['w_down']}

def reference(A_x, A_mem0, A_Wq, A_Wk, A_Wv, A_Wo, A_seg_len, B_x, B_w_gate, B_w_up, B_w_down):

    def _A_ref(x, mem0, Wq, Wk, Wv, Wo, seg_len):
        B, S, Dm = x.shape
        H, Dh = (Wq.shape[1], Wq.shape[2])
        M = mem0.shape[1]
        scale = Dh ** (-0.5)
        n_seg = S // seg_len
        L = M + seg_len
        idx = torch.arange(L)
        mask = (idx[:, None] < M) | (idx[:, None] >= idx[None, :])
        mem = mem0
        outs = []
        for s in range(n_seg):
            xs = x[:, s * seg_len:(s + 1) * seg_len, :].clone()
            h = torch.concatenate([mem, xs], axis=1)
            q = torch.einsum('btd,dhe->bhte', h, Wq)
            k = torch.einsum('btd,dhe->bhte', h, Wk)
            v = torch.einsum('btd,dhe->bhte', h, Wv)
            scores = torch.einsum('bhqe,bhke->bhqk', q, k) * scale
            scores = torch.where(mask[None, None], scores, -1000000000.0)
            p = _softmax(scores, axis=-1)
            o = torch.einsum('bhqk,bhke->bhqe', p, v)
            o = torch.einsum('bhte,hed->btd', o, Wo)
            mem = o[:, :M, :].clone()
            outs.append(o[:, M:, :])
        return torch.concatenate(outs, axis=1)

    def _B_ref(x, w_gate, w_up, w_down):
        return _gelu(x @ w_gate) * (x @ w_up) @ w_down
    x = A_x
    h = x + _A_ref(_layernorm(x, axis=-1), A_mem0, A_Wq, A_Wk, A_Wv, A_Wo, A_seg_len)
    h2 = h + _B_ref(_layernorm(h, axis=-1), B_w_gate, B_w_up, B_w_down)
    return h2
```

```asm
; @launch grid=(256,1,1) block=(256,1,1) lds=163840
.amdgcn_target "amdgcn-amd-amdhsa--gfx950"
.text
.globl sequential_preLN__memory_aug_recurrent_mem_tr__geglu_ffn__prompt_kernel
.p2align 8
.type sequential_preLN__memory_aug_recurrent_mem_tr__geglu_ffn__prompt_kernel,@function
sequential_preLN__memory_aug_recurrent_mem_tr__geglu_ffn__prompt_kernel:
s_cmp_lt_u32 s2, 256
s_cbranch_scc1 Lstart
s_endpgm
Lstart:
s_mov_b32 s44, s2
s_load_dwordx4 s[16:19], s[0:1], 0
s_load_dwordx4 s[20:23], s[0:1], 16
s_load_dwordx4 s[24:27], s[0:1], 32
s_load_dwordx4 s[28:31], s[0:1], 64
s_load_dwordx4 s[32:35], s[0:1], 80
s_load_dwordx4 s[36:39], s[0:1], 96
s_getreg_b32 s3, hwreg(HW_REG_XCC_ID, 0, 4)
s_lshl_b32 s50, s3, 2
s_lshr_b32 s50, 1985229328, s50
s_and_b32 s50, s50, 15
s_cmp_lt_u32 s3, 8
s_cselect_b32 s3, s50, s3
v_lshrrev_b32 v1, 6, v0
s_mov_b32 s41, 0
s_mov_b32 s99, 0
s_mov_b32 s43, 0x40000
v_readfirstlane_b32 s42, v1
s_waitcnt lgkmcnt(0)
s_mov_b32 s4, s38
s_mov_b32 s5, s39
s_mov_b32 s6, 268435456
s_mov_b32 s7, 0x20000
s_add_u32 s8, s38, 136314879
s_addc_u32 s9, s39, 0
s_and_b32 s8, s8, 0xffe00000
s_mov_b32 s10, 0x200000
s_mov_b32 s11, 0x20000
s_mov_b32 s2, 0
s_lshr_b32 s53, s44, 3
s_mov_b32 s12, s16
s_mov_b32 s13, s17
s_mov_b32 s14, 4194304
s_mov_b32 s15, 0x20000
v_and_b32 v242, 63, v0
v_and_b32 v243, 7, v242
v_lshrrev_b32 v244, 3, v242
v_lshlrev_b32 v16, 11, v243
v_lshl_add_u32 v16, v244, 4, v16
s_lshl_b32 s51, s44, 14
s_lshl_b32 s52, s42, 9
s_add_u32 s51, s51, s52
buffer_load_dwordx4 v[192:195], v16, s[12:15], s51 offen offset:0
buffer_load_dwordx4 v[196:199], v16, s[12:15], s51 offen offset:128
buffer_load_dwordx4 v[200:203], v16, s[12:15], s51 offen offset:256
buffer_load_dwordx4 v[204:207], v16, s[12:15], s51 offen offset:384
v_lshlrev_b32 v248, 9, v244
v_lshl_add_u32 v248, v243, 4, v248
v_mov_b32 v4, -1
v_mov_b32 v5, -1
v_mov_b32 v6, -1
v_mov_b32 v7, -1
v_lshlrev_b32 v18, 4, v0
s_and_b32 s51, s44, 63
s_mul_i32 s51, s51, 4608
s_lshr_b32 s52, s44, 6
s_lshl_b32 s52, s52, 19
s_add_u32 s51, s51, s52
buffer_store_dwordx4 v[4:7], v18, s[8:11], s51 offen sc1
v_lshlrev_b32 v19, 1, v0
s_add_u32 s52, s51, 4096
buffer_store_short v4, v19, s[8:11], s52 offen sc1
v_mov_b32 v20, 0
s_lshl_b32 s51, s44, 9
s_add_u32 s51, s51, 133169152
v_and_b32 v21, 3, v0
v_lshlrev_b32 v21, 7, v21
buffer_store_dword v20, v21, s[4:7], s51 offen sc1
s_lshl_b32 s51, s44, 9
s_add_u32 s51, s51, 311296
buffer_store_dword v20, v21, s[8:11], s51 offen sc1
v_and_b32 v247, 7, v242
v_lshlrev_b32 v247, 4, v247
s_lshl_b32 s50, s42, 2
v_add_u32 v246, s50, v247
s_lshl_b32 s40, s3, 5
s_add_u32 s40, s40, s53
s_cmp_ge_u32 s3, 8
s_cbranch_scc1 Loverflow
Ldispatch:
s_cmp_ge_u32 s40, 64
s_cbranch_scc1 Lbulk
s_branch Lrec
Loverflow:
s_cmp_lg_u32 s2, 0
s_cbranch_scc1 Lln_1
s_waitcnt vmcnt(4)
v_lshlrev_b32 v208, 16, v192
v_and_b32 v209, 0xffff0000, v192
v_lshlrev_b32 v210, 16, v193
v_and_b32 v211, 0xffff0000, v193
v_lshlrev_b32 v212, 16, v194
v_and_b32 v213, 0xffff0000, v194
v_lshlrev_b32 v214, 16, v195
v_and_b32 v215, 0xffff0000, v195
v_lshlrev_b32 v216, 16, v196
v_and_b32 v217, 0xffff0000, v196
v_lshlrev_b32 v218, 16, v197
v_and_b32 v219, 0xffff0000, v197
v_lshlrev_b32 v220, 16, v198
v_and_b32 v221, 0xffff0000, v198
v_lshlrev_b32 v222, 16, v199
v_and_b32 v223, 0xffff0000, v199
v_lshlrev_b32 v224, 16, v200
v_and_b32 v225, 0xffff0000, v200
v_lshlrev_b32 v226, 16, v201
v_and_b32 v227, 0xffff0000, v201
v_lshlrev_b32 v228, 16, v202
v_and_b32 v229, 0xffff0000, v202
v_lshlrev_b32 v230, 16, v203
v_and_b32 v231, 0xffff0000, v203
v_lshlrev_b32 v232, 16, v204
v_and_b32 v233, 0xffff0000, v204
v_lshlrev_b32 v234, 16, v205
v_and_b32 v235, 0xffff0000, v205
v_lshlrev_b32 v236, 16, v206
v_and_b32 v237, 0xffff0000, v206
v_lshlrev_b32 v238, 16, v207
v_and_b32 v239, 0xffff0000, v207
v_pk_add_f32 v[242:243], v[208:209], v[210:211]
v_pk_add_f32 v[242:243], v[242:243], v[212:213]
v_pk_add_f32 v[242:243], v[242:243], v[214:215]
v_pk_add_f32 v[242:243], v[242:243], v[216:217]
v_pk_add_f32 v[242:243], v[242:243], v[218:219]
v_pk_add_f32 v[242:243], v[242:243], v[220:221]
v_pk_add_f32 v[242:243], v[242:243], v[222:223]
v_pk_add_f32 v[242:243], v[242:243], v[224:225]
v_pk_add_f32 v[242:243], v[242:243], v[226:227]
v_pk_add_f32 v[242:243], v[242:243], v[228:229]
v_pk_add_f32 v[242:243], v[242:243], v[230:231]
v_pk_add_f32 v[242:243], v[242:243], v[232:233]
v_pk_add_f32 v[242:243], v[242:243], v[234:235]
v_pk_add_f32 v[242:243], v[242:243], v[236:237]
v_pk_add_f32 v[242:243], v[242:243], v[238:239]
v_add_f32 v240, v242, v243
s_nop 1
v_add_f32_dpp v240, v240, v240 row_ror:8 row_mask:0xf bank_mask:0xf
v_mov_b32 v241, v240
s_nop 1
v_permlane16_swap_b32 v240, v241
v_add_f32 v240, v240, v241
v_mov_b32 v241, v240
s_nop 1
v_permlane32_swap_b32 v240, v241
v_add_f32 v240, v240, v241
ds_write_b32 v246, v240 offset:0
s_waitcnt lgkmcnt(0)
s_barrier
ds_read_b128 v[242:245], v247 offset:0
s_waitcnt lgkmcnt(0)
v_pk_add_f32 v[242:243], v[242:243], v[244:245]
v_add_f32 v240, v242, v243
v_mul_f32 v240, 0xba800000, v240
v_mov_b32 v250, v240
v_cvt_pk_bf16_f32 v250, v250, v250
v_and_b32 v250, 0xffff0000, v250
v_sub_f32 v250, v250, v240
v_pk_add_f32 v[208:209], v[208:209], v[240:241] op_sel_hi:[1,0]
v_pk_add_f32 v[210:211], v[210:211], v[240:241] op_sel_hi:[1,0]
v_pk_add_f32 v[212:213], v[212:213], v[240:241] op_sel_hi:[1,0]
v_pk_add_f32 v[214:215], v[214:215], v[240:241] op_sel_hi:[1,0]
v_pk_add_f32 v[216:217], v[216:217], v[240:241] op_sel_hi:[1,0]
v_pk_add_f32 v[218:219], v[218:219], v[240:241] op_sel_hi:[1,0]
v_pk_add_f32 v[220:221], v[220:221], v[240:241] op_sel_hi:[1,0]
v_pk_add_f32 v[222:223], v[222:223], v[240:241] op_sel_hi:[1,0]
v_pk_add_f32 v[224:225], v[224:225], v[240:241] op_sel_hi:[1,0]
v_pk_add_f32 v[226:227], v[226:227], v[240:241] op_sel_hi:[1,0]
v_pk_add_f32 v[228:229], v[228:229], v[240:241] op_sel_hi:[1,0]
v_pk_add_f32 v[230:231], v[230:231], v[240:241] op_sel_hi:[1,0]
v_pk_add_f32 v[232:233], v[232:233], v[240:241] op_sel_hi:[1,0]
v_pk_add_f32 v[234:235], v[234:235], v[240:241] op_sel_hi:[1,0]
v_pk_add_f32 v[236:237], v[236:237], v[240:241] op_sel_hi:[1,0]
v_pk_add_f32 v[238:239], v[238:239], v[240:241] op_sel_hi:[1,0]
v_pk_mul_f32 v[242:243], v[208:209], v[208:209]
v_pk_fma_f32 v[242:243], v[210:211], v[210:211], v[242:243]
v_pk_fma_f32 v[242:243], v[212:213], v[212:213], v[242:243]
v_pk_fma_f32 v[242:243], v[214:215], v[214:215], v[242:243]
v_pk_fma_f32 v[242:243], v[216:217], v[216:217], v[242:243]
v_pk_fma_f32 v[242:243], v[218:219], v[218:219], v[242:243]
v_pk_fma_f32 v[242:243], v[220:221], v[220:221], v[242:243]
v_pk_fma_f32 v[242:243], v[222:223], v[222:223], v[242:243]
v_pk_fma_f32 v[242:243], v[224:225], v[224:225], v[242:243]
v_pk_fma_f32 v[242:243], v[226:227], v[226:227], v[242:243]
v_pk_fma_f32 v[242:243], v[228:229], v[228:229], v[242:243]
v_pk_fma_f32 v[242:243], v[230:231], v[230:231], v[242:243]
v_pk_fma_f32 v[242:243], v[232:233], v[232:233], v[242:243]
v_pk_fma_f32 v[242:243], v[234:235], v[234:235], v[242:243]
v_pk_fma_f32 v[242:243], v[236:237], v[236:237], v[242:243]
v_pk_fma_f32 v[242:243], v[238:239], v[238:239], v[242:243]
v_add_f32 v240, v242, v243
v_pk_add_f32 v[208:209], v[208:209], v[250:251] op_sel_hi:[1,0]
v_pk_add_f32 v[210:211], v[210:211], v[250:251] op_sel_hi:[1,0]
v_pk_add_f32 v[212:213], v[212:213], v[250:251] op_sel_hi:[1,0]
v_pk_add_f32 v[214:215], v[214:215], v[250:251] op_sel_hi:[1,0]
v_pk_add_f32 v[216:217], v[216:217], v[250:251] op_sel_hi:[1,0]
v_pk_add_f32 v[218:219], v[218:219], v[250:251] op_sel_hi:[1,0]
v_pk_add_f32 v[220:221], v[220:221], v[250:251] op_sel_hi:[1,0]
v_pk_add_f32 v[222:223], v[222:223], v[250:251] op_sel_hi:[1,0]
v_pk_add_f32 v[224:225], v[224:225], v[250:251] op_sel_hi:[1,0]
v_pk_add_f32 v[226:227], v[226:227], v[250:251] op_sel_hi:[1,0]
v_pk_add_f32 v[228:229], v[228:229], v[250:251] op_sel_hi:[1,0]
v_pk_add_f32 v[230:231], v[230:231], v[250:251] op_sel_hi:[1,0]
v_pk_add_f32 v[232:233], v[232:233], v[250:251] op_sel_hi:[1,0]
v_pk_add_f32 v[234:235], v[234:235], v[250:251] op_sel_hi:[1,0]
v_pk_add_f32 v[236:237], v[236:237], v[250:251] op_sel_hi:[1,0]
v_pk_add_f32 v[238:239], v[238:239], v[250:251] op_sel_hi:[1,0]
v_cvt_pk_bf16_f32 v192, v208, v209
v_cvt_pk_bf16_f32 v193, v210, v211
v_cvt_pk_bf16_f32 v194, v212, v213
v_cvt_pk_bf16_f32 v195, v214, v215
v_cvt_pk_bf16_f32 v196, v216, v217
v_cvt_pk_bf16_f32 v197, v218, v219
v_cvt_pk_bf16_f32 v198, v220, v221
v_cvt_pk_bf16_f32 v199, v222, v223
v_cvt_pk_bf16_f32 v200, v224, v225
v_cvt_pk_bf16_f32 v201, v226, v227
v_cvt_pk_bf16_f32 v202, v228, v229
v_cvt_pk_bf16_f32 v203, v230, v231
v_cvt_pk_bf16_f32 v204, v232, v233
v_cvt_pk_bf16_f32 v205, v234, v235
v_cvt_pk_bf16_f32 v206, v236, v237
v_cvt_pk_bf16_f32 v207, v238, v239
v_lshlrev_b32 v208, 16, v192
v_and_b32 v209, 0xffff0000, v192
v_lshlrev_b32 v210, 16, v193
v_and_b32 v211, 0xffff0000, v193
v_lshlrev_b32 v212, 16, v194
v_and_b32 v213, 0xffff0000, v194
v_lshlrev_b32 v214, 16, v195
v_and_b32 v215, 0xffff0000, v195
v_lshlrev_b32 v216, 16, v196
v_and_b32 v217, 0xffff0000, v196
v_lshlrev_b32 v218, 16, v197
v_and_b32 v219, 0xffff0000, v197
v_lshlrev_b32 v220, 16, v198
v_and_b32 v221, 0xffff0000, v198
v_lshlrev_b32 v222, 16, v199
v_and_b32 v223, 0xffff0000, v199
v_lshlrev_b32 v224, 16, v200
v_and_b32 v225, 0xffff0000, v200
v_lshlrev_b32 v226, 16, v201
v_and_b32 v227, 0xffff0000, v201
v_lshlrev_b32 v228, 16, v202
v_and_b32 v229, 0xffff0000, v202
v_lshlrev_b32 v230, 16, v203
v_and_b32 v231, 0xffff0000, v203
v_lshlrev_b32 v232, 16, v204
v_and_b32 v233, 0xffff0000, v204
v_lshlrev_b32 v234, 16, v205
v_and_b32 v235, 0xffff0000, v205
v_lshlrev_b32 v236, 16, v206
v_and_b32 v237, 0xffff0000, v206
v_lshlrev_b32 v238, 16, v207
v_and_b32 v239, 0xffff0000, v207
v_add_f32_dpp v240, v240, v240 row_ror:8 row_mask:0xf bank_mask:0xf
v_mov_b32 v241, v240
s_nop 1
v_permlane16_swap_b32 v240, v241
v_add_f32 v240, v240, v241
v_mov_b32 v241, v240
s_nop 1
v_permlane32_swap_b32 v240, v241
v_add_f32 v240, v240, v241
ds_write_b32 v246, v240 offset:128
s_waitcnt lgkmcnt(0)
s_barrier
ds_read_b128 v[242:245], v247 offset:128
s_waitcnt lgkmcnt(0)
v_pk_add_f32 v[242:243], v[242:243], v[244:245]
v_add_f32 v240, v242, v243
v_mul_f32 v240, 0x3a800000, v240
v_cvt_pk_bf16_f32 v240, v240, v240
v_and_b32 v240, 0xffff0000, v240
v_add_f32 v240, 0x3727c5ac, v240
v_cvt_pk_bf16_f32 v240, v240, v240
v_and_b32 v240, 0xffff0000, v240
v_sqrt_f32 v240, v240
s_nop 0
v_cvt_pk_bf16_f32 v240, v240, v240
v_and_b32 v240, 0xffff0000, v240
v_rcp_f32 v240, v240
s_nop 0
v_pk_mul_f32 v[208:209], v[208:209], v[240:241] op_sel_hi:[1,0]
v_pk_mul_f32 v[210:211], v[210:211], v[240:241] op_sel_hi:[1,0]
v_pk_mul_f32 v[212:213], v[212:213], v[240:241] op_sel_hi:[1,0]
v_pk_mul_f32 v[214:215], v[214:215], v[240:241] op_sel_hi:[1,0]
v_pk_mul_f32 v[216:217], v[216:217], v[240:241] op_sel_hi:[1,0]
v_pk_mul_f32 v[218:219], v[218:219], v[240:241] op_sel_hi:[1,0]
v_pk_mul_f32 v[220:221], v[220:221], v[240:241] op_sel_hi:[1,0]
v_pk_mul_f32 v[222:223], v[222:223], v[240:241] op_sel_hi:[1,0]
v_pk_mul_f32 v[224:225], v[224:225], v[240:241] op_sel_hi:[1,0]
v_pk_mul_f32 v[226:227], v[226:227], v[240:241] op_sel_hi:[1,0]
v_pk_mul_f32 v[228:229], v[228:229], v[240:241] op_sel_hi:[1,0]
v_pk_mul_f32 v[230:231], v[230:231], v[240:241] op_sel_hi:[1,0]
v_pk_mul_f32 v[232:233], v[232:233], v[240:241] op_sel_hi:[1,0]
v_pk_mul_f32 v[234:235], v[234:235], v[240:241] op_sel_hi:[1,0]
v_pk_mul_f32 v[236:237], v[236:237], v[240:241] op_sel_hi:[1,0]
v_pk_mul_f32 v[238:239], v[238:239], v[240:241] op_sel_hi:[1,0]
v_cvt_pk_bf16_f32 v192, v208, v209
v_cvt_pk_bf16_f32 v193, v210, v211
v_cvt_pk_bf16_f32 v194, v212, v213
v_cvt_pk_bf16_f32 v195, v214, v215
v_cvt_pk_bf16_f32 v196, v216, v217
v_cvt_pk_bf16_f32 v197, v218, v219
v_cvt_pk_bf16_f32 v198, v220, v221
v_cvt_pk_bf16_f32 v199, v222, v223
v_cvt_pk_bf16_f32 v200, v224, v225
v_cvt_pk_bf16_f32 v201, v226, v227
v_cvt_pk_bf16_f32 v202, v228, v229
v_cvt_pk_bf16_f32 v203, v230, v231
v_cvt_pk_bf16_f32 v204, v232, v233
v_cvt_pk_bf16_f32 v205, v234, v235
v_cvt_pk_bf16_f32 v206, v236, v237
v_cvt_pk_bf16_f32 v207, v238, v239
s_lshr_b32 s50, s44, 2
s_lshl_b32 s50, s50, 16
s_and_b32 s54, s44, 3
s_lshl_b32 s54, s54, 7
s_add_u32 s50, s50, s54
s_lshl_b32 s54, s42, 14
s_add_u32 s50, s50, s54
buffer_store_dwordx4 v[192:195], v248, s[4:7], s50 offen sc1
s_add_u32 s50, s50, 4096
buffer_store_dwordx4 v[196:199], v248, s[4:7], s50 offen sc1
s_add_u32 s50, s50, 4096
buffer_store_dwordx4 v[200:203], v248, s[4:7], s50 offen sc1
s_add_u32 s50, s50, 4096
buffer_store_dwordx4 v[204:207], v248, s[4:7], s50 offen sc1
s_branch Lln_2
Lln_1:
s_waitcnt vmcnt(0)
Lln_2:
s_waitcnt vmcnt(0)
s_barrier
s_or_b32 s50, s42, s2
s_cbranch_scc1 Larr_3
s_lshr_b32 s50, s44, 3
s_lshl_b32 s50, 1, s50
v_mov_b32 v110, s50
v_mov_b32 v111, 0x10000
s_lshl_b32 s50, s3, 3
v_mov_b32 v112, s50
s_mov_b64 exec, 1
global_atomic_add_x2 v[110:111], v112, v[110:111], s[36:37] offset:128 sc0
s_mov_b64 exec, -1
Larr_3:
s_waitcnt vmcnt(0)
s_or_b32 s50, s42, s2
s_cbranch_scc1 Ltk_4
v_readfirstlane_b32 s99, v111
s_nop 0
s_lshr_b32 s99, s99, 16
Ltk_4:
v_mbcnt_lo_u32_b32 v16, -1, 0
v_mbcnt_hi_u32_b32 v16, -1, v16
v_lshlrev_b32 v16, 2, v16
Lbw_5:
global_load_dword v17, v16, s[36:37] sc1
s_waitcnt vmcnt(0)
Lbw_5s:
s_cmp_lg_u32 s2, 0
s_cbranch_scc1 Lbw_7
v_cmp_ne_u32 vcc, -1, v17
s_nop 0
s_and_b32 s50, vcc_hi, 0x5555
v_cmp_ne_u32 vcc, 0x200000, v17
s_nop 0
s_and_b32 s54, vcc_hi, 0xaaaa
s_or_b32 s50, s50, s54
s_cbranch_scc0 Lbw_7
s_mov_b32 s50, 0
v_readlane_b32 s54, v17, 33
s_nop 0
s_lshr_b32 s54, s54, 16
s_add_u32 s50, s50, s54
v_readlane_b32 s54, v17, 35
s_nop 0
s_lshr_b32 s54, s54, 16
s_add_u32 s50, s50, s54
v_readlane_b32 s54, v17, 37
s_nop 0
s_lshr_b32 s54, s54, 16
s_add_u32 s50, s50, s54
v_readlane_b32 s54, v17, 39
s_nop 0
s_lshr_b32 s54, s54, 16
s_add_u32 s50, s50, s54
v_readlane_b32 s54, v17, 41
s_nop 0
s_lshr_b32 s54, s54, 16
s_add_u32 s50, s50, s54
v_readlane_b32 s54, v17, 43
s_nop 0
s_lshr_b32 s54, s54, 16
s_add_u32 s50, s50, s54
v_readlane_b32 s54, v17, 45
s_nop 0
s_lshr_b32 s54, s54, 16
s_add_u32 s50, s50, s54
v_readlane_b32 s54, v17, 47
s_nop 0
s_lshr_b32 s54, s54, 16
s_add_u32 s50, s50, s54
v_readlane_b32 s54, v17, 49
s_nop 0
s_lshr_b32 s54, s54, 16
s_add_u32 s50, s50, s54
v_readlane_b32 s54, v17, 51
s_nop 0
s_lshr_b32 s54, s54, 16
s_add_u32 s50, s50, s54
v_readlane_b32 s54, v17, 53
s_nop 0
s_lshr_b32 s54, s54, 16
s_add_u32 s50, s50, s54
v_readlane_b32 s54, v17, 55
s_nop 0
s_lshr_b32 s54, s54, 16
s_add_u32 s50, s50, s54
v_readlane_b32 s54, v17, 57
s_nop 0
s_lshr_b32 s54, s54, 16
s_add_u32 s50, s50, s54
v_readlane_b32 s54, v17, 59
s_nop 0
s_lshr_b32 s54, s54, 16
s_add_u32 s50, s50, s54
v_readlane_b32 s54, v17, 61
s_nop 0
s_lshr_b32 s54, s54, 16
s_add_u32 s50, s50, s54
v_readlane_b32 s54, v17, 63
s_nop 0
s_lshr_b32 s54, s54, 16
s_add_u32 s50, s50, s54
s_cmp_ge_u32 s50, 256
s_cbranch_scc1 Lbw_6
s_sleep 8
s_sub_u32 s43, s43, 1
s_cbranch_scc0 Lbw_5
s_mov_b32 s43, 0
Lbw_6:
v_lshrrev_b32 v17, 16, v17
v_cmp_ne_u32 vcc, 32, v17
s_nop 0
s_and_b32 s54, vcc_hi, 0xaaaa
s_or_b32 s54, s54, 0
s_branch Lrestart
Lbw_7:
Lrestart:
s_mov_b32 s2, 1
s_waitcnt vmcnt(0) lgkmcnt(0)
s_barrier
v_mov_b32 v1, 0
s_cmp_lg_u32 s42, 0
s_cbranch_scc1 Lrs1
v_mov_b32 v2, s99
ds_write_b32 v1, v2
s_waitcnt lgkmcnt(0)
Lrs1:
s_barrier
ds_read_b32 v2, v1
v_mbcnt_lo_u32_b32 v0, -1, 0
v_mbcnt_hi_u32_b32 v0, -1, v0
s_lshl_b32 s50, s42, 6
v_add_u32 v0, s50, v0
s_waitcnt lgkmcnt(0)
v_readfirstlane_b32 s50, v2
s_barrier
s_lshl_b32 s40, s3, 5
s_add_u32 s40, s40, s50
s_cmp_eq_u32 s54, 0
s_cbranch_scc1 Ldispatch
s_mov_b32 s41, 1
s_mov_b32 s40, s44
s_branch Ldispatch
Lrec:
s_lshr_b32 s45, s40, 5
s_and_b32 s46, s40, 31
s_lshr_b32 s47, s40, 1
s_and_b32 s48, s40, 1
v_and_b32 v80, 63, v0
v_lshrrev_b32 v81, 3, v80
v_lshlrev_b32 v81, 13, v81
s_lshl_b32 s50, s42, 1
v_and_b32 v83, 7, v80
v_xor_b32 v82, s50, v83
v_lshl_add_u32 v84, v82, 4, v81
s_lshl_b32 s51, s40, 7
s_lshl_b32 s52, s42, 17
s_add_u32 s51, s51, s52
s_lshl_b32 s55, s42, 11
s_add_u32 s55, s55, 32768
s_mov_b32 s12, s22
s_mov_b32 s13, s23
s_mov_b32 s14, 8388608
s_mov_b32 s15, 0x20000
s_add_u32 m0, s55, 0
s_add_u32 s54, s51, 0
buffer_load_dwordx4 v84, s[12:15], s54 offen  lds
s_add_u32 m0, s55, 1024
s_add_u32 s54, s51, 65536
buffer_load_dwordx4 v84, s[12:15], s54 offen  lds
s_add_u32 m0, s55, 8192
s_add_u32 s54, s51, 524288
buffer_load_dwordx4 v84, s[12:15], s54 offen  lds
s_add_u32 m0, s55, 9216
s_add_u32 s54, s51, 589824
buffer_load_dwordx4 v84, s[12:15], s54 offen  lds
s_add_u32 m0, s55, 16384
s_add_u32 s54, s51, 1048576
buffer_load_dwordx4 v84, s[12:15], s54 offen  lds
s_add_u32 m0, s55, 17408
s_add_u32 s54, s51, 1114112
buffer_load_dwordx4 v84, s[12:15], s54 offen  lds
s_add_u32 m0, s55, 24576
s_add_u32 s54, s51, 1572864
buffer_load_dwordx4 v84, s[12:15], s54 offen  lds
s_add_u32 m0, s55, 25600
s_add_u32 s54, s51, 1638400
buffer_load_dwordx4 v84, s[12:15], s54 offen  lds
s_add_u32 m0, s55, 32768
s_add_u32 s54, s51, 2097152
buffer_load_dwordx4 v84, s[12:15], s54 offen  lds
s_add_u32 m0, s55, 33792
s_add_u32 s54, s51, 2162688
buffer_load_dwordx4 v84, s[12:15], s54 offen  lds
s_add_u32 m0, s55, 40960
s_add_u32 s54, s51, 2621440
buffer_load_dwordx4 v84, s[12:15], s54 offen  lds
s_add_u32 m0, s55, 41984
s_add_u32 s54, s51, 2686976
buffer_load_dwordx4 v84, s[12:15], s54 offen  lds
s_add_u32 m0, s55, 49152
s_add_u32 s54, s51, 3145728
buffer_load_dwordx4 v84, s[12:15], s54 offen  lds
s_add_u32 m0, s55, 50176
s_add_u32 s54, s51, 3211264
buffer_load_dwordx4 v84, s[12:15], s54 offen  lds
s_add_u32 m0, s55, 57344
s_add_u32 s54, s51, 3670016
buffer_load_dwordx4 v84, s[12:15], s54 offen  lds
s_add_u32 m0, s55, 58368
s_add_u32 s54, s51, 3735552
buffer_load_dwordx4 v84, s[12:15], s54 offen  lds
s_mov_b32 s12, s22
s_mov_b32 s13, s23
s_mov_b32 s14, 8388608
s_mov_b32 s15, 0x20000
s_add_u32 m0, s55, 65536
s_add_u32 s54, s51, 4194304
buffer_load_dwordx4 v84, s[12:15], s54 offen  lds
s_add_u32 m0, s55, 66560
s_add_u32 s54, s51, 4259840
buffer_load_dwordx4 v84, s[12:15], s54 offen  lds
s_add_u32 m0, s55, 73728
s_add_u32 s54, s51, 4718592
buffer_load_dwordx4 v84, s[12:15], s54 offen  lds
s_add_u32 m0, s55, 74752
s_add_u32 s54, s51, 4784128
buffer_load_dwordx4 v84, s[12:15], s54 offen  lds
s_add_u32 m0, s55, 81920
s_add_u32 s54, s51, 5242880
buffer_load_dwordx4 v84, s[12:15], s54 offen  lds
s_add_u32 m0, s55, 82944
s_add_u32 s54, s51, 5308416
buffer_load_dwordx4 v84, s[12:15], s54 offen  lds
s_add_u32 m0, s55, 90112
s_add_u32 s54, s51, 5767168
buffer_load_dwordx4 v84, s[12:15], s54 offen  lds
s_add_u32 m0, s55, 91136
s_add_u32 s54, s51, 5832704
buffer_load_dwordx4 v84, s[12:15], s54 offen  lds
s_add_u32 m0, s55, 98304
s_add_u32 s54, s51, 6291456
buffer_load_dwordx4 v84, s[12:15], s54 offen  lds
s_add_u32 m0, s55, 99328
s_add_u32 s54, s51, 6356992
buffer_load_dwordx4 v84, s[12:15], s54 offen  lds
s_add_u32 m0, s55, 106496
s_add_u32 s54, s51, 6815744
buffer_load_dwordx4 v84, s[12:15], s54 offen  lds
s_add_u32 m0, s55, 107520
s_add_u32 s54, s51, 6881280
buffer_load_dwordx4 v84, s[12:15], s54 offen  lds
s_add_u32 m0, s55, 114688
s_add_u32 s54, s51, 7340032
buffer_load_dwordx4 v84, s[12:15], s54 offen  lds
s_add_u32 m0, s55, 115712
s_add_u32 s54, s51, 7405568
buffer_load_dwordx4 v84, s[12:15], s54 offen  lds
s_add_u32 m0, s55, 122880
s_add_u32 s54, s51, 7864320
buffer_load_dwordx4 v84, s[12:15], s54 offen  lds
s_add_u32 m0, s55, 123904
s_add_u32 s54, s51, 7929856
buffer_load_dwordx4 v84, s[12:15], s54 offen  lds
v_and_b32 v16, 63, v0
v_lshrrev_b32 v17, 4, v16
v_and_b32 v18, 15, v16
v_and_b32 v19, 7, v16
v_and_b32 v20, 1, v17
v_lshrrev_b32 v21, 1, v17
v_bfe_u32 v22, v16, 2, 2
v_bfe_u32 v23, v16, 3, 1
v_lshlrev_b32 v2, 3, v16
v_lshlrev_b32 v3, 2, v16
v_lshl_add_u32 v4, v21, 3, v19
v_lshlrev_b32 v4, 4, v4
v_lshl_add_u32 v4, v20, 3, v4
v_lshlrev_b32 v5, 4, v18
v_lshl_add_u32 v5, v17, 9, v5
v_lshlrev_b32 v1, 4, v19
v_lshl_add_u32 v1, v17, 7, v1
v_lshlrev_b32 v7, 2, v16
v_mul_u32_u24 v8, 576, v17
v_lshl_add_u32 v8, v18, 3, v8
s_lshl_b32 s50, s42, 7
s_add_u32 s50, s50, 16384
v_add_u32 v8, s50, v8
v_and_b32 v9, 1, v16
v_mul_u32_u24 v9, 576, v9
v_lshl_add_u32 v24, v20, 2, v22
v_lshl_add_u32 v24, v21, 4, v24
v_lshl_add_u32 v9, v24, 3, v9
v_add_u32 v9, 16384, v9
v_mul_u32_u24 v10, 512, v20
v_lshl_add_u32 v24, v21, 4, v18
v_lshl_add_u32 v10, v24, 2, v10
s_mul_i32 s50, s42, 1024
s_add_u32 s50, s50, 18688
v_add_u32 v10, s50, v10
v_lshlrev_b32 v11, 4, v16
v_add_u32 v11, 18688, v11
v_mov_b32 v13, 0x4444
v_mov_b32 v24, 0xeeee
v_cmp_lt_u32 vcc, 7, v18
s_nop 1
v_cndmask_b32 v13, v13, v24, vcc
v_lshlrev_b32 v14, 4, v23
v_mov_b32 v15, 0
s_mov_b32 s74, 0x00ff00ff
s_mov_b32 s75, 0x00ff00ff
s_mov_b32 s76, 0xff00ff00
s_mov_b32 s77, 0xff00ff00
s_mov_b32 s78, 0
s_mov_b32 s79, -1
v_lshlrev_b32 v0, 4, v16
s_lshl_b32 s50, s42, 14
s_add_u32 s50, s50, 32768
v_add_u32 v12, s50, v0
v_add_u32 v6, 0x10000, v12
s_mov_b32 s84, 0x3e0293ee
s_mov_b32 s85, s84
s_mov_b32 s69, 0x3f80
s_mov_b32 s70, 0x3f800000
s_lshl_b32 s50, s45, 15
s_lshl_b32 s53, s42, 13
s_add_u32 s60, s50, s53
s_add_u32 s60, s60, 98304
s_add_u32 s61, s60, 4096
s_lshl_b32 s53, s46, 10
s_add_u32 s62, s50, s53
s_lshl_b32 s53, s42, 8
s_add_u32 s62, s62, s53
s_add_u32 s62, s62, 98304
s_lshl_b32 s53, s40, 11
s_add_u32 s63, s53, 163840
s_xor_b32 s64, s63, 0x800
s_lshl_b32 s58, s40, 9
s_lshl_b32 s51, s45, 14
s_lshl_b32 s53, s42, 12
s_add_u32 s56, s51, s53
s_lshr_b32 s53, s40, 4
s_lshl_b32 s59, s53, 14
s_and_b32 s53, s46, 15
s_lshl_b32 s53, s53, 9
s_add_u32 s59, s59, s53
s_add_u32 s59, s59, 32768
s_xor_b32 s57, s50, 0x8000
s_lshr_b32 s53, s42, 1
s_lshl_b32 s53, s53, 14
s_add_u32 s57, s57, s53
s_and_b32 s53, s42, 1
s_lshl_b32 s53, s53, 12
s_add_u32 s57, s57, s53
s_add_u32 s57, s57, 32768
s_sub_u32 s54, s8, s38
s_lshl_b32 s50, s47, 20
s_add_u32 s50, s50, s54
s_lshl_b32 s51, s48, 12
s_add_u32 s65, s50, s51
s_lshl_b32 s52, s42, 10
s_add_u32 s65, s65, s52
s_add_u32 s65, s65, 33554432
s_lshl_b32 s53, s48, 8
s_add_u32 s66, s50, s53
s_lshl_b32 s52, s42, 11
s_add_u32 s66, s66, s52
s_add_u32 s66, s66, 67108864
s_lshl_b32 s80, s40, 7
s_sub_u32 s53, s8, s38
s_add_u32 s80, s80, s53
s_add_u32 s80, s80, 311296
s_lshl_b32 s81, s47, 8
s_add_u32 s81, s81, 133169152
s_add_u32 s71, s81, 24576
s_lshl_b32 s50, s47, 18
s_add_u32 s50, s50, s54
s_lshl_b32 s51, s48, 10
s_add_u32 s50, s50, s51
s_and_b32 s52, s42, 1
s_lshl_b32 s52, s52, 9
s_add_u32 s67, s50, s52
s_add_u32 s67, s67, 100653056
s_lshl_b32 s52, s42, 8
s_add_u32 s68, s50, s52
s_add_u32 s68, s68, 109041664
v_lshrrev_b32 v80, 4, v0
v_lshrrev_b32 v81, 3, v80
v_lshlrev_b32 v81, 13, v81
s_lshl_b32 s50, s42, 1
v_and_b32 v83, 7, v80
v_xor_b32 v82, s50, v83
v_lshl_add_u32 v84, v82, 4, v81
v_lshrrev_b32 v81, 4, v80
v_lshrrev_b32 v82, 1, v81
v_lshlrev_b32 v82, 2, v82
v_and_b32 v83, 1, v81
v_or_b32 v82, v82, v83
v_bfe_u32 v83, v80, 1, 3
v_xor_b32 v82, v82, v83
v_lshrrev_b32 v83, 1, v82
v_lshl_add_u32 v83, v81, 2, v83
v_lshlrev_b32 v83, 11, v83
v_and_b32 v82, 1, v82
v_lshl_add_u32 v83, v82, 5, v83
v_and_b32 v82, 1, v80
v_lshl_add_u32 v85, v82, 4, v83
v_bfe_u32 v86, v80, 2, 2
v_lshrrev_b32 v87, 1, v86
v_and_b32 v88, 1, v81
v_lshl_add_u32 v89, v87, 1, v88
v_lshrrev_b32 v90, 1, v81
v_lshl_add_u32 v98, v90, 2, v89
v_lshlrev_b32 v90, 8, v98
v_and_b32 v97, 1, v86
v_lshlrev_b32 v91, 1, v97
v_lshl_add_u32 v92, v87, 2, v88
v_xor_b32 v91, v91, v92
v_and_b32 v99, 3, v80
v_lshl_add_u32 v90, v99, 3, v90
s_lshl_b32 s50, s42, 14
s_add_u32 s50, s50, 32768
v_add_u32 v90, s50, v90
v_xor_b32 v100, s42, v89
v_lshlrev_b32 v100, 5, v100
v_lshl_add_u32 v100, v99, 3, v100
v_lshrrev_b32 v98, 1, v81
v_lshl_add_u32 v98, v98, 1, v97
v_lshl_add_u32 v98, v89, 4, v98
v_lshl_add_u32 v100, v98, 7, v100
v_add_u32 v100, 32768, v100
v_add_u32 v101, 0x10000, v100
v_xor_b32 v92, 0, v91
v_lshl_add_u32 v93, v92, 5, v90
v_xor_b32 v92, 1, v91
v_lshl_add_u32 v94, v92, 5, v90
v_xor_b32 v92, 4, v91
v_lshl_add_u32 v95, v92, 5, v90
v_xor_b32 v92, 5, v91
v_lshl_add_u32 v96, v92, 5, v90
s_lshl_b32 s51, s47, 8
s_lshl_b32 s52, s48, 7
s_add_u32 s51, s51, s52
s_lshl_b32 s52, s42, 17
s_add_u32 s51, s51, s52
s_lshl_b32 s52, s45, 22
s_lshl_b32 s53, s46, 6
s_add_u32 s52, s52, s53
s_lshl_b32 s53, s42, 20
s_add_u32 s52, s52, s53
s_lshl_b32 s53, s42, 14
s_add_u32 s53, s53, 32768
s_lshl_b32 s55, s42, 11
s_add_u32 s55, s55, 32768
s_cmp_lg_u32 s2, 0
s_cbranch_scc1 Lln_8
s_waitcnt vmcnt(36)
v_lshlrev_b32 v208, 16, v192
v_and_b32 v209, 0xffff0000, v192
v_lshlrev_b32 v210, 16, v193
v_and_b32 v211, 0xffff0000, v193
v_lshlrev_b32 v212, 16, v194
v_and_b32 v213, 0xffff0000, v194
v_lshlrev_b32 v214, 16, v195
v_and_b32 v215, 0xffff0000, v195
v_lshlrev_b32 v216, 16, v196
v_and_b32 v217, 0xffff0000, v196
v_lshlrev_b32 v218, 16, v197
v_and_b32 v219, 0xffff0000, v197
v_lshlrev_b32 v220, 16, v198
v_and_b32 v221, 0xffff0000, v198
v_lshlrev_b32 v222, 16, v199
v_and_b32 v223, 0xffff0000, v199
v_lshlrev_b32 v224, 16, v200
v_and_b32 v225, 0xffff0000, v200
v_lshlrev_b32 v226, 16, v201
v_and_b32 v227, 0xffff0000, v201
v_lshlrev_b32 v228, 16, v202
v_and_b32 v229, 0xffff0000, v202
v_lshlrev_b32 v230, 16, v203
v_and_b32 v231, 0xffff0000, v203
v_lshlrev_b32 v232, 16, v204
v_and_b32 v233, 0xffff0000, v204
v_lshlrev_b32 v234, 16, v205
v_and_b32 v235, 0xffff0000, v205
v_lshlrev_b32 v236, 16, v206
v_and_b32 v237, 0xffff0000, v206
v_lshlrev_b32 v238, 16, v207
v_and_b32 v239, 0xffff0000, v207
v_pk_add_f32 v[242:243], v[208:209], v[210:211]
v_pk_add_f32 v[242:243], v[242:243], v[212:213]
v_pk_add_f32 v[242:243], v[242:243], v[214:215]
v_pk_add_f32 v[242:243], v[242:243], v[216:217]
v_pk_add_f32 v[242:243], v[242:243], v[218:219]
v_pk_add_f32 v[242:243], v[242:243], v[220:221]
v_pk_add_f32 v[242:243], v[242:243], v[222:223]
v_pk_add_f32 v[242:243], v[242:243], v[224:225]
v_pk_add_f32 v[242:243], v[242:243], v[226:227]
v_pk_add_f32 v[242:243], v[242:243], v[228:229]
v_pk_add_f32 v[242:243], v[242:243], v[230:231]
v_pk_add_f32 v[242:243], v[242:243], v[232:233]
v_pk_add_f32 v[242:243], v[242:243], v[234:235]
v_pk_add_f32 v[242:243], v[242:243], v[236:237]
v_pk_add_f32 v[242:243], v[242:243], v[238:239]
v_add_f32 v240, v242, v243
s_nop 1
v_add_f32_dpp v240, v240, v240 row_ror:8 row_mask:0xf bank_mask:0xf
v_mov_b32 v241, v240
s_nop 1
v_permlane16_swap_b32 v240, v241
v_add_f32 v240, v240, v241
v_mov_b32 v241, v240
s_nop 1
v_permlane32_swap_b32 v240, v241
v_add_f32 v240, v240, v241
ds_write_b32 v246, v240 offset:0
s_waitcnt lgkmcnt(0)
s_barrier
ds_read_b128 v[242:245], v247 offset:0
s_waitcnt lgkmcnt(0)
v_pk_add_f32 v[242:243], v[242:243], v[244:245]
v_add_f32 v240, v242, v243
v_mul_f32 v240, 0xba800000, v240
v_mov_b32 v250, v240
v_cvt_pk_bf16_f32 v250, v250, v250
v_and_b32 v250, 0xffff0000, v250
v_sub_f32 v250, v250, v240
v_pk_add_f32 v[208:209], v[208:209], v[240:241] op_sel_hi:[1,0]
v_pk_add_f32 v[210:211], v[210:211], v[240:241] op_sel_hi:[1,0]
v_pk_add_f32 v[212:213], v[212:213], v[240:241] op_sel_hi:[1,0]
v_pk_add_f32 v[214:215], v[214:215], v[240:241] op_sel_hi:[1,0]
v_pk_add_f32 v[216:217], v[216:217], v[240:241] op_sel_hi:[1,0]
v_pk_add_f32 v[218:219], v[218:219], v[240:241] op_sel_hi:[1,0]
v_pk_add_f32 v[220:221], v[220:221], v[240:241] op_sel_hi:[1,0]
v_pk_add_f32 v[222:223], v[222:223], v[240:241] op_sel_hi:[1,0]
v_pk_add_f32 v[224:225], v[224:225], v[240:241] op_sel_hi:[1,0]
v_pk_add_f32 v[226:227], v[226:227], v[240:241] op_sel_hi:[1,0]
v_pk_add_f32 v[228:229], v[228:229], v[240:241] op_sel_hi:[1,0]
v_pk_add_f32 v[230:231], v[230:231], v[240:241] op_sel_hi:[1,0]
v_pk_add_f32 v[232:233], v[232:233], v[240:241] op_sel_hi:[1,0]
v_pk_add_f32 v[234:235], v[234:235], v[240:241] op_sel_hi:[1,0]
v_pk_add_f32 v[236:237], v[236:237], v[240:241] op_sel_hi:[1,0]
v_pk_add_f32 v[238:239], v[238:239], v[240:241] op_sel_hi:[1,0]
v_pk_mul_f32 v[242:243], v[208:209], v[208:209]
v_pk_fma_f32 v[242:243], v[210:211], v[210:211], v[242:243]
v_pk_fma_f32 v[242:243], v[212:213], v[212:213], v[242:243]
v_pk_fma_f32 v[242:243], v[214:215], v[214:215], v[242:243]
v_pk_fma_f32 v[242:243], v[216:217], v[216:217], v[242:243]
v_pk_fma_f32 v[242:243], v[218:219], v[218:219], v[242:243]
v_pk_fma_f32 v[242:243], v[220:221], v[220:221], v[242:243]
v_pk_fma_f32 v[242:243], v[222:223], v[222:223], v[242:243]
v_pk_fma_f32 v[242:243], v[224:225], v[224:225], v[242:243]
v_pk_fma_f32 v[242:243], v[226:227], v[226:227], v[242:243]
v_pk_fma_f32 v[242:243], v[228:229], v[228:229], v[242:243]
v_pk_fma_f32 v[242:243], v[230:231], v[230:231], v[242:243]
v_pk_fma_f32 v[242:243], v[232:233], v[232:233], v[242:243]
v_pk_fma_f32 v[242:243], v[234:235], v[234:235], v[242:243]
v_pk_fma_f32 v[242:243], v[236:237], v[236:237], v[242:243]
v_pk_fma_f32 v[242:243], v[238:239], v[238:239], v[242:243]
v_add_f32 v240, v242, v243
v_pk_add_f32 v[208:209], v[208:209], v[250:251] op_sel_hi:[1,0]
v_pk_add_f32 v[210:211], v[210:211], v[250:251] op_sel_hi:[1,0]
v_pk_add_f32 v[212:213], v[212:213], v[250:251] op_sel_hi:[1,0]
v_pk_add_f32 v[214:215], v[214:215], v[250:251] op_sel_hi:[1,0]
v_pk_add_f32 v[216:217], v[216:217], v[250:251] op_sel_hi:[1,0]
v_pk_add_f32 v[218:219], v[218:219], v[250:251] op_sel_hi:[1,0]
v_pk_add_f32 v[220:221], v[220:221], v[250:251] op_sel_hi:[1,0]
v_pk_add_f32 v[222:223], v[222:223], v[250:251] op_sel_hi:[1,0]
v_pk_add_f32 v[224:225], v[224:225], v[250:251] op_sel_hi:[1,0]
v_pk_add_f32 v[226:227], v[226:227], v[250:251] op_sel_hi:[1,0]
v_pk_add_f32 v[228:229], v[228:229], v[250:251] op_sel_hi:[1,0]
v_pk_add_f32 v[230:231], v[230:231], v[250:251] op_sel_hi:[1,0]
v_pk_add_f32 v[232:233], v[232:233], v[250:251] op_sel_hi:[1,0]
v_pk_add_f32 v[234:235], v[234:235], v[250:251] op_sel_hi:[1,0]
v_pk_add_f32 v[236:237], v[236:237], v[250:251] op_sel_hi:[1,0]
v_pk_add_f32 v[238:239], v[238:239], v[250:251] op_sel_hi:[1,0]
v_cvt_pk_bf16_f32 v192, v208, v209
v_cvt_pk_bf16_f32 v193, v210, v211
v_cvt_pk_bf16_f32 v194, v212, v213
v_cvt_pk_bf16_f32 v195, v214, v215
v_cvt_pk_bf16_f32 v196, v216, v217
v_cvt_pk_bf16_f32 v197, v218, v219
v_cvt_pk_bf16_f32 v198, v220, v221
v_cvt_pk_bf16_f32 v199, v222, v223
v_cvt_pk_bf16_f32 v200, v224, v225
v_cvt_pk_bf16_f32 v201, v226, v227
v_cvt_pk_bf16_f32 v202, v228, v229
v_cvt_pk_bf16_f32 v203, v230, v231
v_cvt_pk_bf16_f32 v204, v232, v233
v_cvt_pk_bf16_f32 v205, v234, v235
v_cvt_pk_bf16_f32 v206, v236, v237
v_cvt_pk_bf16_f32 v207, v238, v239
v_lshlrev_b32 v208, 16, v192
v_and_b32 v209, 0xffff0000, v192
v_lshlrev_b32 v210, 16, v193
v_and_b32 v211, 0xffff0000, v193
v_lshlrev_b32 v212, 16, v194
v_and_b32 v213, 0xffff0000, v194
v_lshlrev_b32 v214, 16, v195
v_and_b32 v215, 0xffff0000, v195
v_lshlrev_b32 v216, 16, v196
v_and_b32 v217, 0xffff0000, v196
v_lshlrev_b32 v218, 16, v197
v_and_b32 v219, 0xffff0000, v197
v_lshlrev_b32 v220, 16, v198
v_and_b32 v221, 0xffff0000, v198
v_lshlrev_b32 v222, 16, v199
v_and_b32 v223, 0xffff0000, v199
v_lshlrev_b32 v224, 16, v200
v_and_b32 v225, 0xffff0000, v200
v_lshlrev_b32 v226, 16, v201
v_and_b32 v227, 0xffff0000, v201
v_lshlrev_b32 v228, 16, v202
v_and_b32 v229, 0xffff0000, v202
v_lshlrev_b32 v230, 16, v203
v_and_b32 v231, 0xffff0000, v203
v_lshlrev_b32 v232, 16, v204
v_and_b32 v233, 0xffff0000, v204
v_lshlrev_b32 v234, 16, v205
v_and_b32 v235, 0xffff0000, v205
v_lshlrev_b32 v236, 16, v206
v_and_b32 v237, 0xffff0000, v206
v_lshlrev_b32 v238, 16, v207
v_and_b32 v239, 0xffff0000, v207
v_add_f32_dpp v240, v240, v240 row_ror:8 row_mask:0xf bank_mask:0xf
v_mov_b32 v241, v240
s_nop 1
v_permlane16_swap_b32 v240, v241
v_add_f32 v240, v240, v241
v_mov_b32 v241, v240
s_nop 1
v_permlane32_swap_b32 v240, v241
v_add_f32 v240, v240, v241
ds_write_b32 v246, v240 offset:128
s_waitcnt lgkmcnt(0)
s_barrier
ds_read_b128 v[242:245], v247 offset:128
s_waitcnt lgkmcnt(0)
v_pk_add_f32 v[242:243], v[242:243], v[244:245]
v_add_f32 v240, v242, v243
v_mul_f32 v240, 0x3a800000, v240
v_cvt_pk_bf16_f32 v240, v240, v240
v_and_b32 v240, 0xffff0000, v240
v_add_f32 v240, 0x3727c5ac, v240
v_cvt_pk_bf16_f32 v240, v240, v240
v_and_b32 v240, 0xffff0000, v240
v_sqrt_f32 v240, v240
s_nop 0
v_cvt_pk_bf16_f32 v240, v240, v240
v_and_b32 v240, 0xffff0000, v240
v_rcp_f32 v240, v240
s_nop 0
v_pk_mul_f32 v[208:209], v[208:209], v[240:241] op_sel_hi:[1,0]
v_pk_mul_f32 v[210:211], v[210:211], v[240:241] op_sel_hi:[1,0]
v_pk_mul_f32 v[212:213], v[212:213], v[240:241] op_sel_hi:[1,0]
v_pk_mul_f32 v[214:215], v[214:215], v[240:241] op_sel_hi:[1,0]
v_pk_mul_f32 v[216:217], v[216:217], v[240:241] op_sel_hi:[1,0]
v_pk_mul_f32 v[218:219], v[218:219], v[240:241] op_sel_hi:[1,0]
v_pk_mul_f32 v[220:221], v[220:221], v[240:241] op_sel_hi:[1,0]
v_pk_mul_f32 v[222:223], v[222:223], v[240:241] op_sel_hi:[1,0]
v_pk_mul_f32 v[224:225], v[224:225], v[240:241] op_sel_hi:[1,0]
v_pk_mul_f32 v[226:227], v[226:227], v[240:241] op_sel_hi:[1,0]
v_pk_mul_f32 v[228:229], v[228:229], v[240:241] op_sel_hi:[1,0]
v_pk_mul_f32 v[230:231], v[230:231], v[240:241] op_sel_hi:[1,0]
v_pk_mul_f32 v[232:233], v[232:233], v[240:241] op_sel_hi:[1,0]
v_pk_mul_f32 v[234:235], v[234:235], v[240:241] op_sel_hi:[1,0]
v_pk_mul_f32 v[236:237], v[236:237], v[240:241] op_sel_hi:[1,0]
v_pk_mul_f32 v[238:239], v[238:239], v[240:241] op_sel_hi:[1,0]
v_cvt_pk_bf16_f32 v192, v208, v209
v_cvt_pk_bf16_f32 v193, v210, v211
v_cvt_pk_bf16_f32 v194, v212, v213
v_cvt_pk_bf16_f32 v195, v214, v215
v_cvt_pk_bf16_f32 v196, v216, v217
v_cvt_pk_bf16_f32 v197, v218, v219
v_cvt_pk_bf16_f32 v198, v220, v221
v_cvt_pk_bf16_f32 v199, v222, v223
v_cvt_pk_bf16_f32 v200, v224, v225
v_cvt_pk_bf16_f32 v201, v226, v227
v_cvt_pk_bf16_f32 v202, v228, v229
v_cvt_pk_bf16_f32 v203, v230, v231
v_cvt_pk_bf16_f32 v204, v232, v233
v_cvt_pk_bf16_f32 v205, v234, v235
v_cvt_pk_bf16_f32 v206, v236, v237
v_cvt_pk_bf16_f32 v207, v238, v239
s_lshr_b32 s50, s44, 2
s_lshl_b32 s50, s50, 16
s_and_b32 s54, s44, 3
s_lshl_b32 s54, s54, 7
s_add_u32 s50, s50, s54
s_lshl_b32 s54, s42, 14
s_add_u32 s50, s50, s54
buffer_store_dwordx4 v[192:195], v248, s[4:7], s50 offen sc1
s_add_u32 s50, s50, 4096
buffer_store_dwordx4 v[196:199], v248, s[4:7], s50 offen sc1
s_add_u32 s50, s50, 4096
buffer_store_dwordx4 v[200:203], v248, s[4:7], s50 offen sc1
s_add_u32 s50, s50, 4096
buffer_store_dwordx4 v[204:207], v248, s[4:7], s50 offen sc1
s_branch Lln_9
Lln_8:
s_waitcnt vmcnt(16)
Lln_9:
s_waitcnt vmcnt(20)
s_barrier
ds_read_b64_tr_b16 a[128:129], v100 offset:0
ds_read_b64_tr_b16 a[130:131], v100 offset:1024
ds_read_b64_tr_b16 a[132:133], v100 offset:512
ds_read_b64_tr_b16 a[134:135], v100 offset:1536
ds_read_b64_tr_b16 a[136:137], v100 offset:8192
ds_read_b64_tr_b16 a[138:139], v100 offset:9216
ds_read_b64_tr_b16 a[140:141], v100 offset:8704
ds_read_b64_tr_b16 a[142:143], v100 offset:9728
ds_read_b64_tr_b16 a[144:145], v100 offset:16384
ds_read_b64_tr_b16 a[146:147], v100 offset:17408
ds_read_b64_tr_b16 a[148:149], v100 offset:16896
ds_read_b64_tr_b16 a[150:151], v100 offset:17920
ds_read_b64_tr_b16 a[152:153], v100 offset:24576
ds_read_b64_tr_b16 a[154:155], v100 offset:25600
ds_read_b64_tr_b16 a[156:157], v100 offset:25088
ds_read_b64_tr_b16 a[158:159], v100 offset:26112
ds_read_b64_tr_b16 a[160:161], v100 offset:32768
ds_read_b64_tr_b16 a[162:163], v100 offset:33792
ds_read_b64_tr_b16 a[164:165], v100 offset:33280
ds_read_b64_tr_b16 a[166:167], v100 offset:34304
ds_read_b64_tr_b16 a[168:169], v100 offset:40960
ds_read_b64_tr_b16 a[170:171], v100 offset:41984
ds_read_b64_tr_b16 a[172:173], v100 offset:41472
ds_read_b64_tr_b16 a[174:175], v100 offset:42496
ds_read_b64_tr_b16 a[176:177], v100 offset:49152
ds_read_b64_tr_b16 a[178:179], v100 offset:50176
ds_read_b64_tr_b16 a[180:181], v100 offset:49664
ds_read_b64_tr_b16 a[182:183], v100 offset:50688
ds_read_b64_tr_b16 a[184:185], v100 offset:57344
ds_read_b64_tr_b16 a[186:187], v100 offset:58368
ds_read_b64_tr_b16 a[188:189], v100 offset:57856
ds_read_b64_tr_b16 a[190:191], v100 offset:58880
s_waitcnt lgkmcnt(0)
s_barrier
s_mov_b32 s12, s24
s_mov_b32 s13, s25
s_mov_b32 s14, 8388608
s_mov_b32 s15, 0x20000
s_add_u32 m0, s55, 0
s_add_u32 s54, s51, 0
buffer_load_dwordx4 v84, s[12:15], s54 offen  lds
s_add_u32 m0, s55, 1024
s_add_u32 s54, s51, 65536
buffer_load_dwordx4 v84, s[12:15], s54 offen  lds
s_add_u32 m0, s55, 8192
s_add_u32 s54, s51, 524288
buffer_load_dwordx4 v84, s[12:15], s54 offen  lds
s_add_u32 m0, s55, 9216
s_add_u32 s54, s51, 589824
buffer_load_dwordx4 v84, s[12:15], s54 offen  lds
s_add_u32 m0, s55, 16384
s_add_u32 s54, s51, 1048576
buffer_load_dwordx4 v84, s[12:15], s54 offen  lds
s_add_u32 m0, s55, 17408
s_add_u32 s54, s51, 1114112
buffer_load_dwordx4 v84, s[12:15], s54 offen  lds
s_add_u32 m0, s55, 24576
s_add_u32 s54, s51, 1572864
buffer_load_dwordx4 v84, s[12:15], s54 offen  lds
s_add_u32 m0, s55, 25600
s_add_u32 s54, s51, 1638400
buffer_load_dwordx4 v84, s[12:15], s54 offen  lds
s_add_u32 m0, s55, 32768
s_add_u32 s54, s51, 2097152
buffer_load_dwordx4 v84, s[12:15], s54 offen  lds
s_add_u32 m0, s55, 33792
s_add_u32 s54, s51, 2162688
buffer_load_dwordx4 v84, s[12:15], s54 offen  lds
s_add_u32 m0, s55, 40960
s_add_u32 s54, s51, 2621440
buffer_load_dwordx4 v84, s[12:15], s54 offen  lds
s_add_u32 m0, s55, 41984
s_add_u32 s54, s51, 2686976
buffer_load_dwordx4 v84, s[12:15], s54 offen  lds
s_add_u32 m0, s55, 49152
s_add_u32 s54, s51, 3145728
buffer_load_dwordx4 v84, s[12:15], s54 offen  lds
s_add_u32 m0, s55, 50176
s_add_u32 s54, s51, 3211264
buffer_load_dwordx4 v84, s[12:15], s54 offen  lds
s_add_u32 m0, s55, 57344
s_add_u32 s54, s51, 3670016
buffer_load_dwordx4 v84, s[12:15], s54 offen  lds
s_add_u32 m0, s55, 58368
s_add_u32 s54, s51, 3735552
buffer_load_dwordx4 v84, s[12:15], s54 offen  lds
s_waitcnt vmcnt(16)
s_barrier
s_or_b32 s50, s42, s2
s_cbranch_scc1 Larr_10
s_lshr_b32 s50, s44, 3
s_lshl_b32 s50, 1, s50
v_mov_b32 v110, s50
v_mov_b32 v111, 0x10000
s_lshl_b32 s50, s3, 3
v_mov_b32 v112, s50
s_mov_b64 exec, 1
global_atomic_add_x2 v[110:111], v112, v[110:111], s[36:37] offset:128 sc0
s_mov_b64 exec, -1
Larr_10:
ds_read_b64_tr_b16 a[192:193], v101 offset:0
ds_read_b64_tr_b16 a[194:195], v101 offset:1024
ds_read_b64_tr_b16 a[196:197], v101 offset:512
ds_read_b64_tr_b16 a[198:199], v101 offset:1536
ds_read_b64_tr_b16 a[200:201], v101 offset:8192
ds_read_b64_tr_b16 a[202:203], v101 offset:9216
ds_read_b64_tr_b16 a[204:205], v101 offset:8704
ds_read_b64_tr_b16 a[206:207], v101 offset:9728
ds_read_b64_tr_b16 a[208:209], v101 offset:16384
ds_read_b64_tr_b16 a[210:211], v101 offset:17408
ds_read_b64_tr_b16 a[212:213], v101 offset:16896
ds_read_b64_tr_b16 a[214:215], v101 offset:17920
ds_read_b64_tr_b16 a[216:217], v101 offset:24576
ds_read_b64_tr_b16 a[218:219], v101 offset:25600
ds_read_b64_tr_b16 a[220:221], v101 offset:25088
ds_read_b64_tr_b16 a[222:223], v101 offset:26112
ds_read_b64_tr_b16 a[224:225], v101 offset:32768
ds_read_b64_tr_b16 a[226:227], v101 offset:33792
ds_read_b64_tr_b16 a[228:229], v101 offset:33280
ds_read_b64_tr_b16 a[230:231], v101 offset:34304
ds_read_b64_tr_b16 a[232:233], v101 offset:40960
ds_read_b64_tr_b16 a[234:235], v101 offset:41984
ds_read_b64_tr_b16 a[236:237], v101 offset:41472
ds_read_b64_tr_b16 a[238:239], v101 offset:42496
ds_read_b64_tr_b16 a[240:241], v101 offset:49152
ds_read_b64_tr_b16 a[242:243], v101 offset:50176
ds_read_b64_tr_b16 a[244:245], v101 offset:49664
ds_read_b64_tr_b16 a[246:247], v101 offset:50688
ds_read_b64_tr_b16 a[248:249], v101 offset:57344
ds_read_b64_tr_b16 a[250:251], v101 offset:58368
ds_read_b64_tr_b16 a[252:253], v101 offset:57856
ds_read_b64_tr_b16 a[254:255], v101 offset:58880
s_waitcnt lgkmcnt(0)
s_barrier
s_mov_b32 s12, s24
s_mov_b32 s13, s25
s_mov_b32 s14, 8388608
s_mov_b32 s15, 0x20000
s_add_u32 m0, s55, 65536
s_add_u32 s54, s51, 4194304
buffer_load_dwordx4 v84, s[12:15], s54 offen  lds
s_add_u32 m0, s55, 66560
s_add_u32 s54, s51, 4259840
buffer_load_dwordx4 v84, s[12:15], s54 offen  lds
s_add_u32 m0, s55, 73728
s_add_u32 s54, s51, 4718592
buffer_load_dwordx4 v84, s[12:15], s54 offen  lds
s_add_u32 m0, s55, 74752
s_add_u32 s54, s51, 4784128
buffer_load_dwordx4 v84, s[12:15], s54 offen  lds
s_add_u32 m0, s55, 81920
s_add_u32 s54, s51, 5242880
buffer_load_dwordx4 v84, s[12:15], s54 offen  lds
s_add_u32 m0, s55, 82944
s_add_u32 s54, s51, 5308416
buffer_load_dwordx4 v84, s[12:15], s54 offen  lds
s_add_u32 m0, s55, 90112
s_add_u32 s54, s51, 5767168
buffer_load_dwordx4 v84, s[12:15], s54 offen  lds
s_add_u32 m0, s55, 91136
s_add_u32 s54, s51, 5832704
buffer_load_dwordx4 v84, s[12:15], s54 offen  lds
s_add_u32 m0, s55, 98304
s_add_u32 s54, s51, 6291456
buffer_load_dwordx4 v84, s[12:15], s54 offen  lds
s_add_u32 m0, s55, 99328
s_add_u32 s54, s51, 6356992
buffer_load_dwordx4 v84, s[12:15], s54 offen  lds
s_add_u32 m0, s55, 106496
s_add_u32 s54, s51, 6815744
buffer_load_dwordx4 v84, s[12:15], s54 offen  lds
s_add_u32 m0, s55, 107520
s_add_u32 s54, s51, 6881280
buffer_load_dwordx4 v84, s[12:15], s54 offen  lds
s_add_u32 m0, s55, 114688
s_add_u32 s54, s51, 7340032
buffer_load_dwordx4 v84, s[12:15], s54 offen  lds
s_add_u32 m0, s55, 115712
s_add_u32 s54, s51, 7405568
buffer_load_dwordx4 v84, s[12:15], s54 offen  lds
s_add_u32 m0, s55, 122880
s_add_u32 s54, s51, 7864320
buffer_load_dwordx4 v84, s[12:15], s54 offen  lds
s_add_u32 m0, s55, 123904
s_add_u32 s54, s51, 7929856
buffer_load_dwordx4 v84, s[12:15], s54 offen  lds
s_waitcnt vmcnt(16)
s_barrier
s_or_b32 s50, s42, s2
s_cbranch_scc1 Ltk_11
v_readfirstlane_b32 s99, v111
s_nop 0
s_lshr_b32 s99, s99, 16
Ltk_11:
ds_read_b64_tr_b16 v[128:129], v100 offset:0
ds_read_b64_tr_b16 v[130:131], v100 offset:1024
ds_read_b64_tr_b16 v[132:133], v100 offset:512
ds_read_b64_tr_b16 v[134:135], v100 offset:1536
ds_read_b64_tr_b16 v[136:137], v100 offset:8192
ds_read_b64_tr_b16 v[138:139], v100 offset:9216
ds_read_b64_tr_b16 v[140:141], v100 offset:8704
ds_read_b64_tr_b16 v[142:143], v100 offset:9728
ds_read_b64_tr_b16 v[144:145], v100 offset:16384
ds_read_b64_tr_b16 v[146:147], v100 offset:17408
ds_read_b64_tr_b16 v[148:149], v100 offset:16896
ds_read_b64_tr_b16 v[150:151], v100 offset:17920
ds_read_b64_tr_b16 v[152:153], v100 offset:24576
ds_read_b64_tr_b16 v[154:155], v100 offset:25600
ds_read_b64_tr_b16 v[156:157], v100 offset:25088
ds_read_b64_tr_b16 v[158:159], v100 offset:26112
ds_read_b64_tr_b16 v[160:161], v100 offset:32768
ds_read_b64_tr_b16 v[162:163], v100 offset:33792
ds_read_b64_tr_b16 v[164:165], v100 offset:33280
ds_read_b64_tr_b16 v[166:167], v100 offset:34304
ds_read_b64_tr_b16 v[168:169], v100 offset:40960
ds_read_b64_tr_b16 v[170:171], v100 offset:41984
ds_read_b64_tr_b16 v[172:173], v100 offset:41472
ds_read_b64_tr_b16 v[174:175], v100 offset:42496
ds_read_b64_tr_b16 v[176:177], v100 offset:49152
ds_read_b64_tr_b16 v[178:179], v100 offset:50176
ds_read_b64_tr_b16 v[180:181], v100 offset:49664
ds_read_b64_tr_b16 v[182:183], v100 offset:50688
ds_read_b64_tr_b16 v[184:185], v100 offset:57344
ds_read_b64_tr_b16 v[186:187], v100 offset:58368
ds_read_b64_tr_b16 v[188:189], v100 offset:57856
ds_read_b64_tr_b16 v[190:191], v100 offset:58880
s_waitcnt lgkmcnt(0)
s_barrier
s_mov_b32 s12, s20
s_mov_b32 s13, s21
s_mov_b32 s14, 8388608
s_mov_b32 s15, 0x20000
s_add_u32 m0, s55, 0
s_add_u32 s54, s51, 0
buffer_load_dwordx4 v84, s[12:15], s54 offen  lds
s_add_u32 m0, s55, 1024
s_add_u32 s54, s51, 65536
buffer_load_dwordx4 v84, s[12:15], s54 offen  lds
s_add_u32 m0, s55, 8192
s_add_u32 s54, s51, 524288
buffer_load_dwordx4 v84, s[12:15], s54 offen  lds
s_add_u32 m0, s55, 9216
s_add_u32 s54, s51, 589824
buffer_load_dwordx4 v84, s[12:15], s54 offen  lds
s_add_u32 m0, s55, 16384
s_add_u32 s54, s51, 1048576
buffer_load_dwordx4 v84, s[12:15], s54 offen  lds
s_add_u32 m0, s55, 17408
s_add_u32 s54, s51, 1114112
buffer_load_dwordx4 v84, s[12:15], s54 offen  lds
s_add_u32 m0, s55, 24576
s_add_u32 s54, s51, 1572864
buffer_load_dwordx4 v84, s[12:15], s54 offen  lds
s_add_u32 m0, s55, 25600
s_add_u32 s54, s51, 1638400
buffer_load_dwordx4 v84, s[12:15], s54 offen  lds
s_add_u32 m0, s55, 32768
s_add_u32 s54, s51, 2097152
buffer_load_dwordx4 v84, s[12:15], s54 offen  lds
s_add_u32 m0, s55, 33792
s_add_u32 s54, s51, 2162688
buffer_load_dwordx4 v84, s[12:15], s54 offen  lds
s_add_u32 m0, s55, 40960
s_add_u32 s54, s51, 2621440
buffer_load_dwordx4 v84, s[12:15], s54 offen  lds
s_add_u32 m0, s55, 41984
s_add_u32 s54, s51, 2686976
buffer_load_dwordx4 v84, s[12:15], s54 offen  lds
s_add_u32 m0, s55, 49152
s_add_u32 s54, s51, 3145728
buffer_load_dwordx4 v84, s[12:15], s54 offen  lds
s_add_u32 m0, s55, 50176
s_add_u32 s54, s51, 3211264
buffer_load_dwordx4 v84, s[12:15], s54 offen  lds
s_add_u32 m0, s55, 57344
s_add_u32 s54, s51, 3670016
buffer_load_dwordx4 v84, s[12:15], s54 offen  lds
s_add_u32 m0, s55, 58368
s_add_u32 s54, s51, 3735552
buffer_load_dwordx4 v84, s[12:15], s54 offen  lds
s_waitcnt vmcnt(16)
s_barrier
ds_read_b64_tr_b16 v[192:193], v101 offset:0
ds_read_b64_tr_b16 v[194:195], v101 offset:1024
ds_read_b64_tr_b16 v[196:197], v101 offset:512
ds_read_b64_tr_b16 v[198:199], v101 offset:1536
ds_read_b64_tr_b16 v[200:201], v101 offset:8192
ds_read_b64_tr_b16 v[202:203], v101 offset:9216
ds_read_b64_tr_b16 v[204:205], v101 offset:8704
ds_read_b64_tr_b16 v[206:207], v101 offset:9728
ds_read_b64_tr_b16 v[208:209], v101 offset:16384
ds_read_b64_tr_b16 v[210:211], v101 offset:17408
ds_read_b64_tr_b16 v[212:213], v101 offset:16896
ds_read_b64_tr_b16 v[214:215], v101 offset:17920
ds_read_b64_tr_b16 v[216:217], v101 offset:24576
ds_read_b64_tr_b16 v[218:219], v101 offset:25600
ds_read_b64_tr_b16 v[220:221], v101 offset:25088
ds_read_b64_tr_b16 v[222:223], v101 offset:26112
ds_read_b64_tr_b16 v[224:225], v101 offset:32768
ds_read_b64_tr_b16 v[226:227], v101 offset:33792
ds_read_b64_tr_b16 v[228:229], v101 offset:33280
ds_read_b64_tr_b16 v[230:231], v101 offset:34304
ds_read_b64_tr_b16 v[232:233], v101 offset:40960
ds_read_b64_tr_b16 v[234:235], v101 offset:41984
ds_read_b64_tr_b16 v[236:237], v101 offset:41472
ds_read_b64_tr_b16 v[238:239], v101 offset:42496
ds_read_b64_tr_b16 v[240:241], v101 offset:49152
ds_read_b64_tr_b16 v[242:243], v101 offset:50176
ds_read_b64_tr_b16 v[244:245], v101 offset:49664
ds_read_b64_tr_b16 v[246:247], v101 offset:50688
ds_read_b64_tr_b16 v[248:249], v101 offset:57344
ds_read_b64_tr_b16 v[250:251], v101 offset:58368
ds_read_b64_tr_b16 v[252:253], v101 offset:57856
ds_read_b64_tr_b16 v[254:255], v101 offset:58880
s_waitcnt lgkmcnt(0)
s_barrier
s_mov_b32 s12, s20
s_mov_b32 s13, s21
s_mov_b32 s14, 8388608
s_mov_b32 s15, 0x20000
s_add_u32 m0, s55, 65536
s_add_u32 s54, s51, 4194304
buffer_load_dwordx4 v84, s[12:15], s54 offen  lds
s_add_u32 m0, s55, 66560
s_add_u32 s54, s51, 4259840
buffer_load_dwordx4 v84, s[12:15], s54 offen  lds
s_add_u32 m0, s55, 73728
s_add_u32 s54, s51, 4718592
buffer_load_dwordx4 v84, s[12:15], s54 offen  lds
s_add_u32 m0, s55, 74752
s_add_u32 s54, s51, 4784128
buffer_load_dwordx4 v84, s[12:15], s54 offen  lds
s_add_u32 m0, s55, 81920
s_add_u32 s54, s51, 5242880
buffer_load_dwordx4 v84, s[12:15], s54 offen  lds
s_add_u32 m0, s55, 82944
s_add_u32 s54, s51, 5308416
buffer_load_dwordx4 v84, s[12:15], s54 offen  lds
s_add_u32 m0, s55, 90112
s_add_u32 s54, s51, 5767168
buffer_load_dwordx4 v84, s[12:15], s54 offen  lds
s_add_u32 m0, s55, 91136
s_add_u32 s54, s51, 5832704
buffer_load_dwordx4 v84, s[12:15], s54 offen  lds
s_add_u32 m0, s55, 98304
s_add_u32 s54, s51, 6291456
buffer_load_dwordx4 v84, s[12:15], s54 offen  lds
s_add_u32 m0, s55, 99328
s_add_u32 s54, s51, 6356992
buffer_load_dwordx4 v84, s[12:15], s54 offen  lds
s_add_u32 m0, s55, 106496
s_add_u32 s54, s51, 6815744
buffer_load_dwordx4 v84, s[12:15], s54 offen  lds
s_add_u32 m0, s55, 107520
s_add_u32 s54, s51, 6881280
buffer_load_dwordx4 v84, s[12:15], s54 offen  lds
s_add_u32 m0, s55, 114688
s_add_u32 s54, s51, 7340032
buffer_load_dwordx4 v84, s[12:15], s54 offen  lds
s_add_u32 m0, s55, 115712
s_add_u32 s54, s51, 7405568
buffer_load_dwordx4 v84, s[12:15], s54 offen  lds
s_add_u32 m0, s55, 122880
s_add_u32 s54, s51, 7864320
buffer_load_dwordx4 v84, s[12:15], s54 offen  lds
s_add_u32 m0, s55, 123904
s_add_u32 s54, s51, 7929856
buffer_load_dwordx4 v84, s[12:15], s54 offen  lds
s_waitcnt vmcnt(16)
s_barrier
ds_read_b64_tr_b16 a[0:1], v100 offset:0
ds_read_b64_tr_b16 a[2:3], v100 offset:1024
ds_read_b64_tr_b16 a[4:5], v100 offset:512
ds_read_b64_tr_b16 a[6:7], v100 offset:1536
ds_read_b64_tr_b16 a[8:9], v100 offset:8192
ds_read_b64_tr_b16 a[10:11], v100 offset:9216
ds_read_b64_tr_b16 a[12:13], v100 offset:8704
ds_read_b64_tr_b16 a[14:15], v100 offset:9728
ds_read_b64_tr_b16 a[16:17], v100 offset:16384
ds_read_b64_tr_b16 a[18:19], v100 offset:17408
ds_read_b64_tr_b16 a[20:21], v100 offset:16896
ds_read_b64_tr_b16 a[22:23], v100 offset:17920
ds_read_b64_tr_b16 a[24:25], v100 offset:24576
ds_read_b64_tr_b16 a[26:27], v100 offset:25600
ds_read_b64_tr_b16 a[28:29], v100 offset:25088
ds_read_b64_tr_b16 a[30:31], v100 offset:26112
ds_read_b64_tr_b16 a[32:33], v100 offset:32768
ds_read_b64_tr_b16 a[34:35], v100 offset:33792
ds_read_b64_tr_b16 a[36:37], v100 offset:33280
ds_read_b64_tr_b16 a[38:39], v100 offset:34304
ds_read_b64_tr_b16 a[40:41], v100 offset:40960
ds_read_b64_tr_b16 a[42:43], v100 offset:41984
ds_read_b64_tr_b16 a[44:45], v100 offset:41472
ds_read_b64_tr_b16 a[46:47], v100 offset:42496
ds_read_b64_tr_b16 a[48:49], v100 offset:49152
ds_read_b64_tr_b16 a[50:51], v100 offset:50176
ds_read_b64_tr_b16 a[52:53], v100 offset:49664
ds_read_b64_tr_b16 a[54:55], v100 offset:50688
ds_read_b64_tr_b16 a[56:57], v100 offset:57344
ds_read_b64_tr_b16 a[58:59], v100 offset:58368
ds_read_b64_tr_b16 a[60:61], v100 offset:57856
ds_read_b64_tr_b16 a[62:63], v100 offset:58880
s_waitcnt lgkmcnt(0)
s_barrier
s_mov_b32 s12, s26
s_mov_b32 s13, s27
s_mov_b32 s14, 8388608
s_mov_b32 s15, 0x20000
s_add_u32 m0, s53, 0
s_add_u32 s54, s52, 0
buffer_load_dwordx4 v85, s[12:15], s54 offen  lds
s_add_u32 m0, s53, 1024
s_add_u32 s54, s52, 32768
buffer_load_dwordx4 v85, s[12:15], s54 offen  lds
s_add_u32 m0, s53, 2048
s_add_u32 s54, s52, 65536
buffer_load_dwordx4 v85, s[12:15], s54 offen  lds
s_add_u32 m0, s53, 3072
s_add_u32 s54, s52, 98304
buffer_load_dwordx4 v85, s[12:15], s54 offen  lds
s_add_u32 m0, s53, 4096
s_add_u32 s54, s52, 131072
buffer_load_dwordx4 v85, s[12:15], s54 offen  lds
s_add_u32 m0, s53, 5120
s_add_u32 s54, s52, 163840
buffer_load_dwordx4 v85, s[12:15], s54 offen  lds
s_add_u32 m0, s53, 6144
s_add_u32 s54, s52, 196608
buffer_load_dwordx4 v85, s[12:15], s54 offen  lds
s_add_u32 m0, s53, 7168
s_add_u32 s54, s52, 229376
buffer_load_dwordx4 v85, s[12:15], s54 offen  lds
s_add_u32 m0, s53, 8192
s_add_u32 s54, s52, 262144
buffer_load_dwordx4 v85, s[12:15], s54 offen  lds
s_add_u32 m0, s53, 9216
s_add_u32 s54, s52, 294912
buffer_load_dwordx4 v85, s[12:15], s54 offen  lds
s_add_u32 m0, s53, 10240
s_add_u32 s54, s52, 327680
buffer_load_dwordx4 v85, s[12:15], s54 offen  lds
s_add_u32 m0, s53, 11264
s_add_u32 s54, s52, 360448
buffer_load_dwordx4 v85, s[12:15], s54 offen  lds
s_add_u32 m0, s53, 12288
s_add_u32 s54, s52, 393216
buffer_load_dwordx4 v85, s[12:15], s54 offen  lds
s_add_u32 m0, s53, 13312
s_add_u32 s54, s52, 425984
buffer_load_dwordx4 v85, s[12:15], s54 offen  lds
s_add_u32 m0, s53, 14336
s_add_u32 s54, s52, 458752
buffer_load_dwordx4 v85, s[12:15], s54 offen  lds
s_add_u32 m0, s53, 15360
s_add_u32 s54, s52, 491520
buffer_load_dwordx4 v85, s[12:15], s54 offen  lds
s_waitcnt vmcnt(16)
s_barrier
ds_read_b64_tr_b16 a[64:65], v101 offset:0
ds_read_b64_tr_b16 a[66:67], v101 offset:1024
ds_read_b64_tr_b16 a[68:69], v101 offset:512
ds_read_b64_tr_b16 a[70:71], v101 offset:1536
ds_read_b64_tr_b16 a[72:73], v101 offset:8192
ds_read_b64_tr_b16 a[74:75], v101 offset:9216
ds_read_b64_tr_b16 a[76:77], v101 offset:8704
ds_read_b64_tr_b16 a[78:79], v101 offset:9728
ds_read_b64_tr_b16 a[80:81], v101 offset:16384
ds_read_b64_tr_b16 a[82:83], v101 offset:17408
ds_read_b64_tr_b16 a[84:85], v101 offset:16896
ds_read_b64_tr_b16 a[86:87], v101 offset:17920
ds_read_b64_tr_b16 a[88:89], v101 offset:24576
ds_read_b64_tr_b16 a[90:91], v101 offset:25600
ds_read_b64_tr_b16 a[92:93], v101 offset:25088
ds_read_b64_tr_b16 a[94:95], v101 offset:26112
ds_read_b64_tr_b16 a[96:97], v101 offset:32768
ds_read_b64_tr_b16 a[98:99], v101 offset:33792
ds_read_b64_tr_b16 a[100:101], v101 offset:33280
ds_read_b64_tr_b16 a[102:103], v101 offset:34304
ds_read_b64_tr_b16 a[104:105], v101 offset:40960
ds_read_b64_tr_b16 a[106:107], v101 offset:41984
ds_read_b64_tr_b16 a[108:109], v101 offset:41472
ds_read_b64_tr_b16 a[110:111], v101 offset:42496
ds_read_b64_tr_b16 a[112:113], v101 offset:49152
ds_read_b64_tr_b16 a[114:115], v101 offset:50176
ds_read_b64_tr_b16 a[116:117], v101 offset:49664
ds_read_b64_tr_b16 a[118:119], v101 offset:50688
ds_read_b64_tr_b16 a[120:121], v101 offset:57344
ds_read_b64_tr_b16 a[122:123], v101 offset:58368
ds_read_b64_tr_b16 a[124:125], v101 offset:57856
ds_read_b64_tr_b16 a[126:127], v101 offset:58880
s_waitcnt lgkmcnt(0)
s_barrier
s_mov_b32 s12, s26
s_mov_b32 s13, s27
s_mov_b32 s14, 8388608
s_mov_b32 s15, 0x20000
s_add_u32 m0, s53, 65536
s_add_u32 s54, s52, 524288
buffer_load_dwordx4 v85, s[12:15], s54 offen  lds
s_add_u32 m0, s53, 66560
s_add_u32 s54, s52, 557056
buffer_load_dwordx4 v85, s[12:15], s54 offen  lds
s_add_u32 m0, s53, 67584
s_add_u32 s54, s52, 589824
buffer_load_dwordx4 v85, s[12:15], s54 offen  lds
s_add_u32 m0, s53, 68608
s_add_u32 s54, s52, 622592
buffer_load_dwordx4 v85, s[12:15], s54 offen  lds
s_add_u32 m0, s53, 69632
s_add_u32 s54, s52, 655360
buffer_load_dwordx4 v85, s[12:15], s54 offen  lds
s_add_u32 m0, s53, 70656
s_add_u32 s54, s52, 688128
buffer_load_dwordx4 v85, s[12:15], s54 offen  lds
s_add_u32 m0, s53, 71680
s_add_u32 s54, s52, 720896
buffer_load_dwordx4 v85, s[12:15], s54 offen  lds
s_add_u32 m0, s53, 72704
s_add_u32 s54, s52, 753664
buffer_load_dwordx4 v85, s[12:15], s54 offen  lds
s_add_u32 m0, s53, 73728
s_add_u32 s54, s52, 786432
buffer_load_dwordx4 v85, s[12:15], s54 offen  lds
s_add_u32 m0, s53, 74752
s_add_u32 s54, s52, 819200
buffer_load_dwordx4 v85, s[12:15], s54 offen  lds
s_add_u32 m0, s53, 75776
s_add_u32 s54, s52, 851968
buffer_load_dwordx4 v85, s[12:15], s54 offen  lds
s_add_u32 m0, s53, 76800
s_add_u32 s54, s52, 884736
buffer_load_dwordx4 v85, s[12:15], s54 offen  lds
s_add_u32 m0, s53, 77824
s_add_u32 s54, s52, 917504
buffer_load_dwordx4 v85, s[12:15], s54 offen  lds
s_add_u32 m0, s53, 78848
s_add_u32 s54, s52, 950272
buffer_load_dwordx4 v85, s[12:15], s54 offen  lds
s_add_u32 m0, s53, 79872
s_add_u32 s54, s52, 983040
buffer_load_dwordx4 v85, s[12:15], s54 offen  lds
s_add_u32 m0, s53, 80896
s_add_u32 s54, s52, 1015808
buffer_load_dwordx4 v85, s[12:15], s54 offen  lds
s_mov_b32 s12, s18
s_mov_b32 s13, s19
s_mov_b32 s14, 16384
s_mov_b32 s15, 0x20000
v_lshrrev_b32 v120, 4, v0
v_bfe_u32 v121, v120, 2, 3
v_lshlrev_b32 v121, 11, v121
v_and_b32 v122, 3, v120
v_lshl_add_u32 v121, v122, 4, v121
v_lshrrev_b32 v120, 5, v120
v_lshl_add_u32 v121, v120, 6, v121
s_lshl_b32 s54, s42, 9
buffer_load_dwordx4 v[104:107], v121, s[12:15], s54 offen offset:0
buffer_load_dwordx4 v[108:111], v121, s[12:15], s54 offen offset:128
buffer_load_dwordx4 v[112:115], v121, s[12:15], s54 offen offset:256
buffer_load_dwordx4 v[116:119], v121, s[12:15], s54 offen offset:384
global_load_dword v123, v3, s[36:37] sc1
s_waitcnt vmcnt(21)
ds_read_b64_tr_b16 v[16:17], v93 offset:0
ds_read_b64_tr_b16 v[18:19], v95 offset:0
ds_read_b64_tr_b16 v[20:21], v93 offset:2048
ds_read_b64_tr_b16 v[22:23], v95 offset:2048
ds_read_b64_tr_b16 v[24:25], v94 offset:0
ds_read_b64_tr_b16 v[26:27], v96 offset:0
ds_read_b64_tr_b16 v[28:29], v94 offset:2048
ds_read_b64_tr_b16 v[30:31], v96 offset:2048
ds_read_b64_tr_b16 v[32:33], v93 offset:4096
ds_read_b64_tr_b16 v[34:35], v95 offset:4096
ds_read_b64_tr_b16 v[36:37], v93 offset:6144
ds_read_b64_tr_b16 v[38:39], v95 offset:6144
ds_read_b64_tr_b16 v[40:41], v94 offset:4096
ds_read_b64_tr_b16 v[42:43], v96 offset:4096
ds_read_b64_tr_b16 v[44:45], v94 offset:6144
ds_read_b64_tr_b16 v[46:47], v96 offset:6144
ds_read_b64_tr_b16 v[48:49], v93 offset:8192
ds_read_b64_tr_b16 v[50:51], v95 offset:8192
ds_read_b64_tr_b16 v[52:53], v93 offset:10240
ds_read_b64_tr_b16 v[54:55], v95 offset:10240
ds_read_b64_tr_b16 v[56:57], v94 offset:8192
ds_read_b64_tr_b16 v[58:59], v96 offset:8192
ds_read_b64_tr_b16 v[60:61], v94 offset:10240
ds_read_b64_tr_b16 v[62:63], v96 offset:10240
ds_read_b64_tr_b16 v[64:65], v93 offset:12288
ds_read_b64_tr_b16 v[66:67], v95 offset:12288
ds_read_b64_tr_b16 v[68:69], v93 offset:14336
ds_read_b64_tr_b16 v[70:71], v95 offset:14336
ds_read_b64_tr_b16 v[72:73], v94 offset:12288
ds_read_b64_tr_b16 v[74:75], v96 offset:12288
ds_read_b64_tr_b16 v[76:77], v94 offset:14336
ds_read_b64_tr_b16 v[78:79], v96 offset:14336
s_waitcnt lgkmcnt(0)
ds_write_b128 v12, v[16:19] offset:0
ds_write_b128 v12, v[20:23] offset:1024
ds_write_b128 v12, v[24:27] offset:2048
ds_write_b128 v12, v[28:31] offset:3072
ds_write_b128 v12, v[32:35] offset:4096
ds_write_b128 v12, v[36:39] offset:5120
ds_write_b128 v12, v[40:43] offset:6144
ds_write_b128 v12, v[44:47] offset:7168
ds_write_b128 v12, v[48:51] offset:8192
ds_write_b128 v12, v[52:55] offset:9216
ds_write_b128 v12, v[56:59] offset:10240
ds_write_b128 v12, v[60:63] offset:11264
ds_write_b128 v12, v[64:67] offset:12288
ds_write_b128 v12, v[68:71] offset:13312
ds_write_b128 v12, v[72:75] offset:14336
ds_write_b128 v12, v[76:79] offset:15360
v_add_u32 v93, 0x10000, v93
v_add_u32 v94, 0x10000, v94
v_add_u32 v95, 0x10000, v95
v_add_u32 v96, 0x10000, v96
s_waitcnt lgkmcnt(0)
s_waitcnt vmcnt(13)
ds_read_b64_tr_b16 v[16:17], v93 offset:0
ds_read_b64_tr_b16 v[18:19], v95 offset:0
ds_read_b64_tr_b16 v[20:21], v93 offset:2048
ds_read_b64_tr_b16 v[22:23], v95 offset:2048
ds_read_b64_tr_b16 v[24:25], v94 offset:0
ds_read_b64_tr_b16 v[26:27], v96 offset:0
ds_read_b64_tr_b16 v[28:29], v94 offset:2048
ds_read_b64_tr_b16 v[30:31], v96 offset:2048
ds_read_b64_tr_b16 v[32:33], v93 offset:4096
ds_read_b64_tr_b16 v[34:35], v95 offset:4096
ds_read_b64_tr_b16 v[36:37], v93 offset:6144
ds_read_b64_tr_b16 v[38:39], v95 offset:6144
ds_read_b64_tr_b16 v[40:41], v94 offset:4096
ds_read_b64_tr_b16 v[42:43], v96 offset:4096
ds_read_b64_tr_b16 v[44:45], v94 offset:6144
ds_read_b64_tr_b16 v[46:47], v96 offset:6144
s_waitcnt lgkmcnt(0)
ds_write_b128 v6, v[16:19] offset:0
ds_write_b128 v6, v[20:23] offset:1024
ds_write_b128 v6, v[24:27] offset:2048
ds_write_b128 v6, v[28:31] offset:3072
ds_write_b128 v6, v[32:35] offset:4096
ds_write_b128 v6, v[36:39] offset:5120
ds_write_b128 v6, v[40:43] offset:6144
ds_write_b128 v6, v[44:47] offset:7168
s_waitcnt vmcnt(0)
v_mbcnt_lo_u32_b32 v122, -1, 0
v_mbcnt_hi_u32_b32 v122, -1, v122
v_lshlrev_b32 v122, 2, v122
s_branch Lbw_12s
Lbw_12:
global_load_dword v123, v122, s[36:37] sc1
s_waitcnt vmcnt(0)
Lbw_12s:
s_cmp_lg_u32 s2, 0
s_cbranch_scc1 Lbw_14
v_cmp_ne_u32 vcc, -1, v123
s_nop 0
s_and_b32 s50, vcc_hi, 0x5555
v_cmp_ne_u32 vcc, 0x200000, v123
s_nop 0
s_and_b32 s54, vcc_hi, 0xaaaa
s_or_b32 s50, s50, s54
s_cbranch_scc0 Lbw_14
s_mov_b32 s50, 0
v_readlane_b32 s54, v123, 33
s_nop 0
s_lshr_b32 s54, s54, 16
s_add_u32 s50, s50, s54
v_readlane_b32 s54, v123, 35
s_nop 0
s_lshr_b32 s54, s54, 16
s_add_u32 s50, s50, s54
v_readlane_b32 s54, v123, 37
s_nop 0
s_lshr_b32 s54, s54, 16
s_add_u32 s50, s50, s54
v_readlane_b32 s54, v123, 39
s_nop 0
s_lshr_b32 s54, s54, 16
s_add_u32 s50, s50, s54
v_readlane_b32 s54, v123, 41
s_nop 0
s_lshr_b32 s54, s54, 16
s_add_u32 s50, s50, s54
v_readlane_b32 s54, v123, 43
s_nop 0
s_lshr_b32 s54, s54, 16
s_add_u32 s50, s50, s54
v_readlane_b32 s54, v123, 45
s_nop 0
s_lshr_b32 s54, s54, 16
s_add_u32 s50, s50, s54
v_readlane_b32 s54, v123, 47
s_nop 0
s_lshr_b32 s54, s54, 16
s_add_u32 s50, s50, s54
v_readlane_b32 s54, v123, 49
s_nop 0
s_lshr_b32 s54, s54, 16
s_add_u32 s50, s50, s54
v_readlane_b32 s54, v123, 51
s_nop 0
s_lshr_b32 s54, s54, 16
s_add_u32 s50, s50, s54
v_readlane_b32 s54, v123, 53
s_nop 0
s_lshr_b32 s54, s54, 16
s_add_u32 s50, s50, s54
v_readlane_b32 s54, v123, 55
s_nop 0
s_lshr_b32 s54, s54, 16
s_add_u32 s50, s50, s54
v_readlane_b32 s54, v123, 57
s_nop 0
s_lshr_b32 s54, s54, 16
s_add_u32 s50, s50, s54
v_readlane_b32 s54, v123, 59
s_nop 0
s_lshr_b32 s54, s54, 16
s_add_u32 s50, s50, s54
v_readlane_b32 s54, v123, 61
s_nop 0
s_lshr_b32 s54, s54, 16
s_add_u32 s50, s50, s54
v_readlane_b32 s54, v123, 63
s_nop 0
s_lshr_b32 s54, s54, 16
s_add_u32 s50, s50, s54
s_cmp_ge_u32 s50, 256
s_cbranch_scc1 Lbw_13
s_sleep 8
s_sub_u32 s43, s43, 1
s_cbranch_scc0 Lbw_12
s_mov_b32 s43, 0
Lbw_13:
v_lshrrev_b32 v123, 16, v123
v_cmp_ne_u32 vcc, 32, v123
s_nop 0
s_and_b32 s54, vcc_hi, 0xaaaa
s_or_b32 s54, s54, 0
s_branch Lrestart
Lbw_14:
s_branch Lngrs
Lngr:
global_load_dword v123, v122, s[36:37] sc1
s_waitcnt vmcnt(0)
Lngrs:
s_add_u32 s55, s2, 8
v_readlane_b32 s50, v123, s55
s_nop 0
s_lshr_b32 s55, s50, 1
s_or_b32 s55, s55, s50
s_and_b32 s55, s55, 0x155555
s_cmp_eq_u32 s55, 0x155555
s_cbranch_scc1 Lngrd
s_sleep 4
s_sub_u32 s43, s43, 1
s_cbranch_scc0 Lngr
s_mov_b32 s43, 0
Lngrd:
s_lshr_b32 s51, s50, 8
s_and_b32 s51, s51, 0x2000
s_add_u32 s59, s59, s51
s_add_u32 s57, s57, s51
s_add_u32 s80, s80, s51
s_lshr_b32 s51, s47, 3
s_lshl_b32 s51, s51, 1
s_add_u32 s51, s51, 0
s_lshr_b32 s51, s50, s51
s_xor_b32 s51, s51, s47
s_and_b32 s51, s51, 2
s_lshl_b32 s51, s51, 12
s_add_u32 s65, s65, s51
s_lshr_b32 s51, s47, 3
s_lshl_b32 s51, s51, 1
s_add_u32 s51, s51, 8
s_lshr_b32 s51, s50, s51
s_xor_b32 s51, s51, s47
s_and_b32 s51, s51, 2
s_lshl_b32 s51, s51, 12
s_add_u32 s66, s66, s51
s_lshr_b32 s51, s47, 2
s_lshl_b32 s51, s51, 16
s_xor_b32 s51, s51, s50
s_lshr_b32 s51, s51, 16
s_and_b32 s51, s51, 2
s_lshl_b32 s51, s51, 12
s_add_u32 s67, s67, s51
s_lshr_b32 s51, s47, 2
s_lshl_b32 s51, s51, 18
s_xor_b32 s51, s51, s50
s_lshr_b32 s51, s51, 18
s_and_b32 s51, s51, 2
s_lshl_b32 s51, s51, 12
s_add_u32 s68, s68, s51
Lrec_kv0:
s_buffer_load_dword s82, s[4:7], s81 glc
s_buffer_load_dword s83, s[4:7], s81 offset:128 glc
s_waitcnt lgkmcnt(0)
s_min_i32 s82, s82, s83
s_cmp_ge_i32 s82, 1
s_cbranch_scc1 Lrec_kv0d
s_sleep 1
s_sub_u32 s43, s43, 1
s_cbranch_scc0 Lrec_kv0
s_mov_b32 s43, 0
Lrec_kv0d:
s_lshl_b32 s52, s42, 10
s_add_u32 m0, s52, 24576
s_add_u32 s52, s52, 28672
buffer_load_dwordx4 v0, s[4:7], s65 offen sc1 lds
s_mov_b32 m0, s52
s_add_u32 s50, s81, 8192
buffer_load_dwordx4 v5, s[4:7], s66 offen sc1 lds
s_lshl_b32 m0, s42, 12
s_buffer_load_dword s82, s[4:7], s50 glc
s_buffer_load_dword s83, s[4:7], s50 offset:128 glc
s_lshl_b32 s50, s42, 19
s_add_u32 s52, s50, s63
buffer_load_dwordx4 v[124:127], v0, s[8:11], s52 offen sc1
buffer_load_dwordx2 v[124:125], v2, s[8:11], s52 offen offset:1024 sc1
s_add_u32 s52, s50, s58
buffer_load_dwordx2 v[124:125], v2, s[8:11], s52 offen sc1
s_lshl_b32 s52, s40, 10
s_add_u32 s52, s52, s50
s_add_u32 s52, s52, 98304
buffer_load_dwordx4 v[124:127], v0, s[8:11], s52 offen sc1
s_add_u32 s52, s67, 0x2800
buffer_load_dword v124, v15, s[4:7], s52 offen sc1
s_add_u32 s52, s68, 0x2800
buffer_load_dword v124, v15, s[4:7], s52 offen sc1
ds_write_addtid_b32 v104 offset:0
ds_write_addtid_b32 v105 offset:256
ds_write_addtid_b32 v106 offset:512
ds_write_addtid_b32 v107 offset:768
ds_write_addtid_b32 v108 offset:1024
ds_write_addtid_b32 v109 offset:1280
ds_write_addtid_b32 v110 offset:1536
ds_write_addtid_b32 v111 offset:1792
ds_write_addtid_b32 v112 offset:2048
ds_write_addtid_b32 v113 offset:2304
ds_write_addtid_b32 v114 offset:2560
ds_write_addtid_b32 v115 offset:2816
ds_write_addtid_b32 v116 offset:3072
ds_write_addtid_b32 v117 offset:3328
ds_write_addtid_b32 v118 offset:3584
ds_write_addtid_b32 v119 offset:3840
ds_read_b64_tr_b16 v[48:49], v93 offset:8192
ds_read_b64_tr_b16 v[50:51], v95 offset:8192
ds_read_b64_tr_b16 v[52:53], v93 offset:10240
ds_read_b64_tr_b16 v[54:55], v95 offset:10240
ds_read_b64_tr_b16 v[56:57], v94 offset:8192
ds_read_b64_tr_b16 v[58:59], v96 offset:8192
ds_read_b64_tr_b16 v[60:61], v94 offset:10240
ds_read_b64_tr_b16 v[62:63], v96 offset:10240
ds_read_b64_tr_b16 v[64:65], v93 offset:12288
ds_read_b64_tr_b16 v[66:67], v95 offset:12288
ds_read_b64_tr_b16 v[68:69], v93 offset:14336
ds_read_b64_tr_b16 v[70:71], v95 offset:14336
ds_read_b64_tr_b16 v[72:73], v94 offset:12288
ds_read_b64_tr_b16 v[74:75], v96 offset:12288
ds_read_b64_tr_b16 v[76:77], v94 offset:14336
ds_read_b64_tr_b16 v[78:79], v96 offset:14336
s_waitcnt lgkmcnt(0)
ds_write_b128 v6, v[48:51] offset:8192
ds_write_b128 v6, v[52:55] offset:9216
ds_write_b128 v6, v[56:59] offset:10240
ds_write_b128 v6, v[60:63] offset:11264
ds_write_b128 v6, v[64:67] offset:12288
ds_write_b128 v6, v[68:71] offset:13312
ds_write_b128 v6, v[72:75] offset:14336
ds_write_b128 v6, v[76:79] offset:15360
s_waitcnt lgkmcnt(0)
s_mov_b32 s49, 0
s_mov_b32 s73, s8
s_lshl_b32 s46, s40, 10
s_add_u32 s46, s46, 98304
s_mov_b32 s72, 1572864
s_mov_b32 s10, 294912
s_mov_b32 s12, s8
s_mov_b32 s13, s9
s_mov_b32 s14, 294912
s_mov_b32 s15, 0x20000
s_waitcnt vmcnt(0)
s_barrier
s_cmp_lg_u32 s41, 0
s_cbranch_scc1 Lrec_slow
s_cmp_eq_u32 s42, 0
s_cbranch_scc1 Lrec00_in
s_cmp_eq_u32 s42, 1
s_cbranch_scc1 Lrec01_in
s_cmp_eq_u32 s42, 2
s_cbranch_scc1 Lrec02_in
s_branch Lrec03_in
Lrec_slow:
s_cmp_eq_u32 s42, 0
s_cbranch_scc1 Lrec10_in
s_cmp_eq_u32 s42, 1
s_cbranch_scc1 Lrec11_in
s_cmp_eq_u32 s42, 2
s_cbranch_scc1 Lrec12_in
s_branch Lrec13_in
Lrec00_in:
ds_read_b128 v[80:83], v5 offset:24576
ds_read_b128 v[84:87], v5 offset:26624
ds_read_b128 v[88:91], v5 offset:24832
ds_read_b128 v[92:95], v5 offset:26880
ds_read_b128 v[124:127], v0 offset:28672
s_waitcnt lgkmcnt(0)
s_barrier
s_add_u32 s81, s81, 8192
s_cmp_eq_u32 s81, s71
s_cselect_b32 s51, 24576, 0
s_sub_u32 s81, s81, s51
s_cmp_eq_u32 s49, 63
s_cselect_b32 s51, -2, s49
s_add_u32 s51, s51, 2
s_min_i32 s82, s82, s83
s_cmp_lt_i32 s82, s51
s_cbranch_scc1 Lrec00_kva
Lrec00_kvda:
s_add_u32 s45, s81, 8192
s_cmp_eq_u32 s45, s71
s_cselect_b32 s51, 24576, 0
s_sub_u32 s45, s45, s51
s_mov_b32 m0, 24576
s_add_u32 s65, s65, 0x4000
buffer_load_dwordx4 v0, s[4:7], s65 offen sc1 lds
s_mov_b32 m0, 28672
s_add_u32 s66, s66, 0x4000
buffer_load_dwordx4 v5, s[4:7], s66 offen sc1 lds
v_pk_mul_f32 v[96:97], v[14:15], v[14:15] op_sel:[1,1] op_sel_hi:[1,1]
v_pk_mul_f32 v[98:99], v[14:15], v[14:15] op_sel:[1,1] op_sel_hi:[1,1]
v_pk_mul_f32 v[100:101], v[14:15], v[14:15] op_sel:[1,1] op_sel_hi:[1,1]
v_pk_mul_f32 v[102:103], v[14:15], v[14:15] op_sel:[1,1] op_sel_hi:[1,1]
ds_read_b128 v[16:19], v0 offset:0
ds_read_b128 v[20:23], v0 offset:1024
ds_read_b128 v[24:27], v0 offset:2048
s_waitcnt lgkmcnt(2)
v_smfmac_f32_16x16x64_bf16 v[96:99], v[16:19], a[0:7], v13
ds_read_b128 v[28:31], v0 offset:3072
v_smfmac_f32_16x16x64_bf16 v[100:103], v[16:19], a[128:135], v13
s_waitcnt lgkmcnt(1)
v_smfmac_f32_16x16x64_bf16 v[96:99], v[20:23], a[8:15], v13
ds_read_b128 v[32:35], v0 offset:4096
v_smfmac_f32_16x16x64_bf16 v[100:103], v[20:23], a[136:143], v13
v_smfmac_f32_16x16x64_bf16 v[96:99], v[24:27], a[16:23], v13
ds_read_b128 v[36:39], v0 offset:5120
v_smfmac_f32_16x16x64_bf16 v[100:103], v[24:27], a[144:151], v13
s_waitcnt lgkmcnt(1)
v_smfmac_f32_16x16x64_bf16 v[96:99], v[28:31], a[24:31], v13
ds_read_b128 v[40:43], v0 offset:6144
v_smfmac_f32_16x16x64_bf16 v[100:103], v[28:31], a[152:159], v13
v_smfmac_f32_16x16x64_bf16 v[96:99], v[32:35], a[32:39], v13
ds_read_b128 v[44:47], v0 offset:7168
v_smfmac_f32_16x16x64_bf16 v[100:103], v[32:35], a[160:167], v13
s_waitcnt lgkmcnt(1)
v_smfmac_f32_16x16x64_bf16 v[96:99], v[36:39], a[40:47], v13
ds_read_b128 v[48:51], v0 offset:8192
v_smfmac_f32_16x16x64_bf16 v[100:103], v[36:39], a[168:175], v13
v_smfmac_f32_16x16x64_bf16 v[96:99], v[40:43], a[48:55], v13
ds_read_b128 v[52:55], v0 offset:9216
v_smfmac_f32_16x16x64_bf16 v[100:103], v[40:43], a[176:183], v13
s_waitcnt lgkmcnt(1)
v_smfmac_f32_16x16x64_bf16 v[96:99], v[44:47], a[56:63], v13
ds_read_b128 v[56:59], v0 offset:10240
v_smfmac_f32_16x16x64_bf16 v[100:103], v[44:47], a[184:191], v13
s_branch Lrec00_p2
.p2align 10
Lrec00_p1:
ds_read_b128 v[80:83], v5 offset:24576
ds_read_b128 v[84:87], v5 offset:26624
ds_read_b128 v[88:91], v5 offset:24832
ds_read_b128 v[92:95], v5 offset:26880
ds_read_b128 v[124:127], v0 offset:28672
ds_read_b64_tr_b16 v[112:113], v9 offset:1152
ds_read_b64_tr_b16 v[114:115], v9 offset:1216
s_add_u32 s49, s49, 1
v_mov_b32 v116, -1
v_mov_b32 v117, -1
s_add_u32 s81, s81, 8192
s_cmp_eq_u32 s81, s71
s_cselect_b32 s51, 24576, 0
s_sub_u32 s81, s81, s51
s_cmp_eq_u32 s49, 63
s_cselect_b32 s51, -2, s49
s_add_u32 s51, s51, 2
s_min_i32 s82, s82, s83
s_cmp_lt_i32 s82, s51
s_cbranch_scc1 Lrec00_kvb
Lrec00_kvdb:
s_add_u32 s45, s81, 8192
s_cmp_eq_u32 s45, s71
s_cselect_b32 s51, 24576, 0
s_sub_u32 s45, s45, s51
s_mov_b32 m0, 0
s_waitcnt vmcnt(1)
s_barrier
buffer_load_dwordx4 v[48:51], v0, s[8:11], s56 offen offset:0 sc1
buffer_load_dwordx4 v[52:55], v0, s[8:11], s56 offen offset:1024 sc1
buffer_load_dwordx4 v[56:59], v0, s[8:11], s56 offen offset:2048 sc1
buffer_load_dwordx4 v[60:63], v0, s[8:11], s56 offen offset:3072 sc1
Lrec00_g_16w:
s_waitcnt vmcnt(3)
v_max3_u32 v122, v48, v49, v50
v_max_u32 v122, v51, v122
s_waitcnt vmcnt(2)
v_max3_u32 v122, v52, v53, v122
v_max3_u32 v122, v54, v55, v122
v_cmp_eq_u32 vcc, -1, v122
buffer_load_dwordx4 v[64:67], v0, s[8:11], s57 offen offset:0 sc1
buffer_load_dwordx4 v[68:71], v0, s[8:11], s57 offen offset:1024 sc1
s_cbranch_vccnz Lrec00_r_15
Lrec00_g_16:
v_lshlrev_b32 v16, 16, v48
v_and_b32 v17, 0xffff0000, v48
v_lshlrev_b32 v18, 16, v49
v_and_b32 v19, 0xffff0000, v49
v_lshlrev_b32 v20, 16, v50
v_and_b32 v21, 0xffff0000, v50
v_lshlrev_b32 v22, 16, v51
v_and_b32 v23, 0xffff0000, v51
v_lshlrev_b32 v24, 16, v52
v_and_b32 v25, 0xffff0000, v52
v_lshlrev_b32 v26, 16, v53
v_and_b32 v27, 0xffff0000, v53
v_lshlrev_b32 v28, 16, v54
v_and_b32 v29, 0xffff0000, v54
v_lshlrev_b32 v30, 16, v55
v_and_b32 v31, 0xffff0000, v55
Lrec00_g_18w:
s_waitcnt vmcnt(3)
v_max3_u32 v122, v56, v57, v58
v_max_u32 v122, v59, v122
s_waitcnt vmcnt(2)
v_max3_u32 v122, v60, v61, v122
v_max3_u32 v122, v62, v63, v122
v_cmp_eq_u32 vcc, -1, v122
buffer_load_dwordx4 v[72:75], v0, s[8:11], s57 offen offset:2048 sc1
buffer_load_dwordx4 v[76:79], v0, s[8:11], s57 offen offset:3072 sc1
s_cbranch_vccnz Lrec00_r_17
Lrec00_g_18:
v_lshlrev_b32 v32, 16, v56
v_and_b32 v33, 0xffff0000, v56
v_lshlrev_b32 v34, 16, v57
v_and_b32 v35, 0xffff0000, v57
v_lshlrev_b32 v36, 16, v58
v_and_b32 v37, 0xffff0000, v58
v_lshlrev_b32 v38, 16, v59
v_and_b32 v39, 0xffff0000, v59
v_lshlrev_b32 v40, 16, v60
v_and_b32 v41, 0xffff0000, v60
v_lshlrev_b32 v42, 16, v61
v_and_b32 v43, 0xffff0000, v61
v_lshlrev_b32 v44, 16, v62
v_and_b32 v45, 0xffff0000, v62
v_lshlrev_b32 v46, 16, v63
v_and_b32 v47, 0xffff0000, v63
Lrec00_g_20w:
s_waitcnt vmcnt(3)
v_max3_u32 v122, v64, v65, v66
v_max_u32 v122, v67, v122
s_waitcnt vmcnt(2)
v_max3_u32 v122, v68, v69, v122
v_max3_u32 v122, v70, v71, v122
v_cmp_eq_u32 vcc, -1, v122
s_cbranch_vccnz Lrec00_r_19
Lrec00_g_20:
v_dot2_f32_bf16 v16, v64, s69, v16
v_dot2_f32_bf16 v17, v64, s70, v17
v_dot2_f32_bf16 v18, v65, s69, v18
v_dot2_f32_bf16 v19, v65, s70, v19
v_dot2_f32_bf16 v20, v66, s69, v20
v_dot2_f32_bf16 v21, v66, s70, v21
v_dot2_f32_bf16 v22, v67, s69, v22
v_dot2_f32_bf16 v23, v67, s70, v23
v_cvt_pk_bf16_f32 v48, v16, v17
v_cvt_pk_bf16_f32 v49, v18, v19
v_cvt_pk_bf16_f32 v50, v20, v21
v_cvt_pk_bf16_f32 v51, v22, v23
ds_write_addtid_b32 v48 offset:0
ds_write_addtid_b32 v49 offset:256
ds_write_addtid_b32 v50 offset:512
ds_write_addtid_b32 v51 offset:768
v_dot2_f32_bf16 v24, v68, s69, v24
v_dot2_f32_bf16 v25, v68, s70, v25
v_dot2_f32_bf16 v26, v69, s69, v26
v_dot2_f32_bf16 v27, v69, s70, v27
v_dot2_f32_bf16 v28, v70, s69, v28
v_dot2_f32_bf16 v29, v70, s70, v29
v_dot2_f32_bf16 v30, v71, s69, v30
v_dot2_f32_bf16 v31, v71, s70, v31
v_cvt_pk_bf16_f32 v52, v24, v25
v_cvt_pk_bf16_f32 v53, v26, v27
v_cvt_pk_bf16_f32 v54, v28, v29
v_cvt_pk_bf16_f32 v55, v30, v31
ds_write_addtid_b32 v52 offset:1024
ds_write_addtid_b32 v53 offset:1280
ds_write_addtid_b32 v54 offset:1536
ds_write_addtid_b32 v55 offset:1792
Lrec00_g_22w:
s_waitcnt vmcnt(1)
v_max3_u32 v122, v72, v73, v74
v_max_u32 v122, v75, v122
s_waitcnt vmcnt(0)
v_max3_u32 v122, v76, v77, v122
v_max3_u32 v122, v78, v79, v122
v_cmp_eq_u32 vcc, -1, v122
s_cbranch_vccnz Lrec00_r_21
Lrec00_g_22:
v_dot2_f32_bf16 v32, v72, s69, v32
v_dot2_f32_bf16 v33, v72, s70, v33
v_dot2_f32_bf16 v34, v73, s69, v34
v_dot2_f32_bf16 v35, v73, s70, v35
v_dot2_f32_bf16 v36, v74, s69, v36
v_dot2_f32_bf16 v37, v74, s70, v37
v_dot2_f32_bf16 v38, v75, s69, v38
v_dot2_f32_bf16 v39, v75, s70, v39
v_cvt_pk_bf16_f32 v56, v32, v33
v_cvt_pk_bf16_f32 v57, v34, v35
v_cvt_pk_bf16_f32 v58, v36, v37
v_cvt_pk_bf16_f32 v59, v38, v39
ds_write_addtid_b32 v56 offset:2048
ds_write_addtid_b32 v57 offset:2304
ds_write_addtid_b32 v58 offset:2560
ds_write_addtid_b32 v59 offset:2816
v_dot2_f32_bf16 v40, v76, s69, v40
v_dot2_f32_bf16 v41, v76, s70, v41
v_dot2_f32_bf16 v42, v77, s69, v42
v_dot2_f32_bf16 v43, v77, s70, v43
v_dot2_f32_bf16 v44, v78, s69, v44
v_dot2_f32_bf16 v45, v78, s70, v45
v_dot2_f32_bf16 v46, v79, s69, v46
v_dot2_f32_bf16 v47, v79, s70, v47
v_cvt_pk_bf16_f32 v60, v40, v41
v_cvt_pk_bf16_f32 v61, v42, v43
v_cvt_pk_bf16_f32 v62, v44, v45
v_cvt_pk_bf16_f32 v63, v46, v47
ds_write_addtid_b32 v60 offset:3072
ds_write_addtid_b32 v61 offset:3328
ds_write_addtid_b32 v62 offset:3584
ds_write_addtid_b32 v63 offset:3840
v_pk_mul_f32 v[96:97], v[14:15], v[14:15] op_sel:[1,1] op_sel_hi:[1,1]
v_pk_mul_f32 v[98:99], v[14:15], v[14:15] op_sel:[1,1] op_sel_hi:[1,1]
v_pk_mul_f32 v[100:101], v[14:15], v[14:15] op_sel:[1,1] op_sel_hi:[1,1]
v_pk_mul_f32 v[102:103], v[14:15], v[14:15] op_sel:[1,1] op_sel_hi:[1,1]
s_waitcnt lgkmcnt(0)
s_barrier
ds_read_b128 v[16:19], v0 offset:0
ds_read_b128 v[20:23], v0 offset:1024
ds_read_b128 v[24:27], v0 offset:2048
s_mov_b32 m0, 24576
s_add_u32 s65, s65, 0x4000
buffer_load_dwordx4 v0, s[4:7], s65 offen sc1 lds
s_waitcnt lgkmcnt(2)
v_smfmac_f32_16x16x64_bf16 v[96:99], v[16:19], a[0:7], v13
ds_read_b128 v[28:31], v0 offset:3072
v_smfmac_f32_16x16x64_bf16 v[100:103], v[16:19], a[128:135], v13
s_mov_b32 m0, 28672
s_add_u32 s66, s66, 0x4000
buffer_load_dwordx4 v5, s[4:7], s66 offen sc1 lds
s_waitcnt lgkmcnt(1)
v_smfmac_f32_16x16x64_bf16 v[96:99], v[20:23], a[8:15], v13
ds_read_b128 v[32:35], v0 offset:4096
v_smfmac_f32_16x16x64_bf16 v[100:103], v[20:23], a[136:143], v13
buffer_store_dword v108, v7, s[4:7], s68 offen sc1
v_smfmac_f32_16x16x64_bf16 v[96:99], v[24:27], a[16:23], v13
ds_read_b128 v[36:39], v0 offset:5120
v_smfmac_f32_16x16x64_bf16 v[100:103], v[24:27], a[144:151], v13
s_mov_b64 exec, s[74:75]
buffer_store_dwordx4 v[112:115], v1, s[4:7], s67 offen sc1
s_mov_b64 exec, -1
s_waitcnt lgkmcnt(1)
v_smfmac_f32_16x16x64_bf16 v[96:99], v[28:31], a[24:31], v13
ds_read_b128 v[40:43], v0 offset:6144
v_smfmac_f32_16x16x64_bf16 v[100:103], v[28:31], a[152:159], v13
buffer_store_dwordx2 v[116:117], v2, s[12:15], s63 offen offset:0
v_smfmac_f32_16x16x64_bf16 v[96:99], v[32:35], a[32:39], v13
ds_read_b128 v[44:47], v0 offset:7168
v_smfmac_f32_16x16x64_bf16 v[100:103], v[32:35], a[160:167], v13
s_waitcnt lgkmcnt(1)
v_smfmac_f32_16x16x64_bf16 v[96:99], v[36:39], a[40:47], v13
ds_read_b128 v[48:51], v0 offset:8192
v_smfmac_f32_16x16x64_bf16 v[100:103], v[36:39], a[168:175], v13
v_smfmac_f32_16x16x64_bf16 v[96:99], v[40:43], a[48:55], v13
ds_read_b128 v[52:55], v0 offset:9216
v_smfmac_f32_16x16x64_bf16 v[100:103], v[40:43], a[176:183], v13
s_waitcnt lgkmcnt(1)
v_smfmac_f32_16x16x64_bf16 v[96:99], v[44:47], a[56:63], v13
ds_read_b128 v[56:59], v0 offset:10240
v_smfmac_f32_16x16x64_bf16 v[100:103], v[44:47], a[184:191], v13
Lrec00_p2:
v_smfmac_f32_16x16x64_bf16 v[96:99], v[48:51], a[64:71], v13
ds_read_b128 v[60:63], v0 offset:11264
v_smfmac_f32_16x16x64_bf16 v[100:103], v[48:51], a[192:199], v13
s_add_u32 s72, s72, 524288
s_waitcnt lgkmcnt(1)
v_smfmac_f32_16x16x64_bf16 v[96:99], v[52:55], a[72:79], v13
ds_read_b128 v[64:67], v0 offset:12288
v_smfmac_f32_16x16x64_bf16 v[100:103], v[52:55], a[200:207], v13
s_and_b32 s72, s72, 1572864
v_smfmac_f32_16x16x64_bf16 v[96:99], v[56:59], a[80:87], v13
ds_read_b128 v[68:71], v0 offset:13312
v_smfmac_f32_16x16x64_bf16 v[100:103], v[56:59], a[208:215], v13
s_or_b32 s8, s73, s72
s_waitcnt lgkmcnt(1)
v_smfmac_f32_16x16x64_bf16 v[96:99], v[60:63], a[88:95], v13
ds_read_b128 v[72:75], v0 offset:14336
v_smfmac_f32_16x16x64_bf16 v[100:103], v[60:63], a[216:223], v13
s_xor_b32 s12, s8, 1048576
v_smfmac_f32_16x16x64_bf16 v[96:99], v[64:67], a[96:103], v13
ds_read_b128 v[76:79], v0 offset:15360
v_smfmac_f32_16x16x64_bf16 v[100:103], v[64:67], a[224:231], v13
s_and_b32 s50, s49, 3
s_cselect_b32 s50, 0, 0x2000
s_waitcnt lgkmcnt(1)
v_smfmac_f32_16x16x64_bf16 v[96:99], v[68:71], a[104:111], v13
v_smfmac_f32_16x16x64_bf16 v[100:103], v[68:71], a[232:239], v13
s_add_u32 s50, s50, 0x800
v_smfmac_f32_16x16x64_bf16 v[96:99], v[72:75], a[112:119], v13
v_smfmac_f32_16x16x64_bf16 v[100:103], v[72:75], a[240:247], v13
s_add_u32 s68, s68, s50
s_waitcnt lgkmcnt(0)
v_smfmac_f32_16x16x64_bf16 v[96:99], v[76:79], a[120:127], v13
v_smfmac_f32_16x16x64_bf16 v[100:103], v[76:79], a[248:255], v13
s_add_u32 s67, s67, s50
s_nop 6
v_permlane32_swap_b32 v96, v100
v_permlane32_swap_b32 v97, v101
v_permlane32_swap_b32 v98, v102
v_permlane32_swap_b32 v99, v103
v_pk_add_f32 v[96:97], v[96:97], v[100:101]
v_pk_add_f32 v[98:99], v[98:99], v[102:103]
v_cvt_pk_bf16_f32 v96, v96, v97
v_cvt_pk_bf16_f32 v97, v98, v99
ds_write_b64 v8, v[96:97]
s_waitcnt lgkmcnt(0)
s_barrier
ds_read_b64_tr_b16 v[96:97], v9 offset:0
ds_read_b64_tr_b16 v[98:99], v9 offset:64
ds_read_b64_tr_b16 v[100:101], v9 offset:256
ds_read_b64_tr_b16 v[102:103], v9 offset:320
s_waitcnt lgkmcnt(2)
v_mfma_f32_16x16x32_bf16 v[112:115], v[80:83], v[96:99], 0
s_waitcnt lgkmcnt(0)
v_mfma_f32_16x16x32_bf16 v[112:115], v[84:87], v[100:103], v[112:115]
ds_read_b64_tr_b16 v[104:105], v9 offset:1152
ds_read_b64_tr_b16 v[106:107], v9 offset:1216
v_mfma_f32_16x16x32_bf16 v[116:119], v[88:91], v[96:99], 0
ds_read_b64_tr_b16 v[108:109], v9 offset:1408
ds_read_b64_tr_b16 v[110:111], v9 offset:1472
v_mfma_f32_16x16x32_bf16 v[116:119], v[92:95], v[100:103], v[116:119]
s_mov_b64 exec, s[74:75]
s_nop 0
buffer_store_dwordx4 v[112:115], v0, s[8:11], s63 offen
s_mov_b64 exec, -1
s_waitcnt lgkmcnt(0)
v_mfma_f32_16x16x32_bf16 v[120:123], v[104:107], v[96:99], 0
v_mfma_f32_16x16x32_bf16 v[120:123], v[108:111], v[100:103], v[120:123]
v_pk_mul_f32 v[104:105], v[14:15], v[14:15] op_sel:[1,1] op_sel_hi:[1,1]
v_pk_mul_f32 v[106:107], v[14:15], v[14:15] op_sel:[1,1] op_sel_hi:[1,1]
s_nop 1
v_smfmac_f32_16x16x64_bf16 v[104:107], v[16:19], v[128:135], v13
s_buffer_load_dword s82, s[4:7], s45 glc
v_smfmac_f32_16x16x64_bf16 v[104:107], v[20:23], v[136:143], v13
s_buffer_load_dword s83, s[4:7], s45 offset:128 glc
v_smfmac_f32_16x16x64_bf16 v[104:107], v[24:27], v[144:151], v13
v_cndmask_b32 v112, v112, v116, s[76:77]
v_smfmac_f32_16x16x64_bf16 v[104:107], v[28:31], v[152:159], v13
v_cndmask_b32 v113, v113, v117, s[76:77]
v_smfmac_f32_16x16x64_bf16 v[104:107], v[32:35], v[160:167], v13
v_cndmask_b32 v114, v114, v118, s[76:77]
v_smfmac_f32_16x16x64_bf16 v[104:107], v[36:39], v[168:175], v13
v_cndmask_b32 v115, v115, v119, s[76:77]
buffer_load_dwordx4 v[88:91], v0, s[8:11], s64 offen sc1
buffer_load_dword v92, v3, s[8:11], s64 offen offset:1024 sc1
v_smfmac_f32_16x16x64_bf16 v[104:107], v[40:43], v[176:183], v13
v_cndmask_b32 v120, v120, v122, s[78:79]
v_smfmac_f32_16x16x64_bf16 v[104:107], v[44:47], v[184:191], v13
v_cndmask_b32 v121, v121, v123, s[78:79]
v_smfmac_f32_16x16x64_bf16 v[104:107], v[48:51], v[192:199], v13
v_cndmask_b32 v116, v120, v121, s[76:77]
v_smfmac_f32_16x16x64_bf16 v[104:107], v[52:55], v[200:207], v13
s_cmp_eq_u32 s49, 63
v_smfmac_f32_16x16x64_bf16 v[104:107], v[56:59], v[208:215], v13
v_smfmac_f32_16x16x64_bf16 v[104:107], v[60:63], v[216:223], v13
v_smfmac_f32_16x16x64_bf16 v[104:107], v[64:67], v[224:231], v13
v_smfmac_f32_16x16x64_bf16 v[104:107], v[68:71], v[232:239], v13
v_smfmac_f32_16x16x64_bf16 v[104:107], v[72:75], v[240:247], v13
v_smfmac_f32_16x16x64_bf16 v[104:107], v[76:79], v[248:255], v13
buffer_load_dwordx4 v[54:57], v0, s[8:11], s64 offen sc1
buffer_load_dword v58, v3, s[8:11], s64 offen offset:1024 sc1
s_cbranch_scc1 Lrec00_last
s_waitcnt vmcnt(2)
v_max3_u32 v53, v88, v89, v90
v_max3_u32 v53, v91, v92, v53
v_cmp_eq_u32 vcc, -1, v53
s_cbranch_vccnz Lrec00_ps
Lrec00_ps1:
v_pk_add_f32 v[112:113], v[112:113], v[88:89]
v_pk_add_f32 v[114:115], v[114:115], v[90:91]
v_add_f32 v116, v116, v92
Lrec00_ps2:
v_max3_f32 v60, v112, v113, v114
v_max3_f32 v60, v115, v116, v60
v_mov_b32 v65, 0
v_mov_b32 v109, 0
v_max_f32_dpp v60, v60, v60 row_ror:8 row_mask:0xf bank_mask:0xf
v_mov_b32 v61, v60
v_permlane32_swap_b32 v104, v106
v_permlane32_swap_b32 v105, v107
v_permlane32_swap_b32 v60, v61
v_max_f32 v60, v60, v61
v_mov_b32 v61, v60
v_pk_add_f32 v[104:105], v[104:105], v[106:107]
v_cvt_pk_bf16_f32 v108, v104, v105
v_permlane16_swap_b32 v60, v61
v_max_f32 v60, v60, v61
v_mul_f32 v60, s84, v60
v_fma_f32 v116, v116, s84, -v60
v_pk_fma_f32 v[112:113], v[112:113], s[84:85], v[60:61] op_sel_hi:[1,1,0] neg_lo:[0,0,1] neg_hi:[0,0,1]
v_exp_f32 v116, v116
v_pk_fma_f32 v[114:115], v[114:115], s[84:85], v[60:61] op_sel_hi:[1,1,0] neg_lo:[0,0,1] neg_hi:[0,0,1]
v_exp_f32 v112, v112
v_cvt_pk_bf16_f32 v64, v116, v15
v_exp_f32 v113, v113
v_lshlrev_b32 v64, v14, v64
v_exp_f32 v114, v114
v_exp_f32 v115, v115
v_mfma_f32_16x16x16_bf16 v[68:71], v[108:109], v[64:65], 0
v_cvt_pk_bf16_f32 v62, v112, v113
v_cvt_pk_bf16_f32 v63, v114, v115
v_pk_add_f32 v[112:113], v[112:113], v[114:115]
v_add_f32 v60, v116, v112
v_mfma_f32_16x16x16_bf16 v[76:79], v[126:127], v[62:63], v[68:71]
v_mfma_f32_16x16x16_bf16 v[72:75], v[124:125], v[62:63], v[68:71]
v_add_f32 v60, v60, v113
s_nop 1
v_add_f32_dpp v60, v60, v60 row_ror:8 row_mask:0xf bank_mask:0xf
v_mov_b32 v61, v60
s_nop 1
v_permlane32_swap_b32 v60, v61
v_add_f32 v60, v60, v61
v_mov_b32 v61, v60
v_add_f32_dpp v72, v76, v72 row_ror:8 row_mask:0xf bank_mask:0xf
v_add_f32_dpp v73, v77, v73 row_ror:8 row_mask:0xf bank_mask:0xf
v_permlane16_swap_b32 v60, v61
v_add_f32 v60, v60, v61
v_rcp_f32 v60, v60
v_add_f32_dpp v74, v78, v74 row_ror:8 row_mask:0xf bank_mask:0xf
v_add_f32_dpp v75, v79, v75 row_ror:8 row_mask:0xf bank_mask:0xf
v_pk_mul_f32 v[72:73], v[72:73], v[60:61] op_sel_hi:[1,0]
v_pk_mul_f32 v[74:75], v[74:75], v[60:61] op_sel_hi:[1,0]
v_cvt_pk_bf16_f32 v120, v72, v73
v_cvt_pk_bf16_f32 v121, v74, v75
s_mov_b64 exec, s[74:75]
buffer_store_dwordx2 v[120:121], v4, s[8:11], s62 offen offset:0
s_mov_b64 exec, -1
s_cmp_ge_u32 s49, 61
s_cbranch_scc1 Lrec00_early
Lrec00_earlyd:
v_pk_mul_f32 v[112:113], v[14:15], v[14:15] op_sel:[1,1] op_sel_hi:[1,1]
v_pk_mul_f32 v[114:115], v[14:15], v[14:15] op_sel:[1,1] op_sel_hi:[1,1]
v_pk_mul_f32 v[116:117], v[14:15], v[14:15] op_sel:[1,1] op_sel_hi:[1,1]
v_pk_mul_f32 v[118:119], v[14:15], v[14:15] op_sel:[1,1] op_sel_hi:[1,1]
s_waitcnt vmcnt(1)
ds_read_b128 v[80:83], v12 offset:0
ds_read_b128 v[84:87], v12 offset:1024
ds_read_b128 v[88:91], v12 offset:2048
ds_read_b128 v[92:95], v12 offset:3072
ds_read_b128 v[96:99], v12 offset:4096
ds_read_b128 v[100:103], v12 offset:5120
ds_read_b128 v[16:19], v12 offset:6144
ds_read_b128 v[20:23], v12 offset:7168
ds_read_b128 v[24:27], v12 offset:8192
ds_read_b128 v[28:31], v12 offset:9216
ds_read_b128 v[32:35], v12 offset:10240
ds_read_b128 v[36:39], v12 offset:11264
ds_read_b128 v[40:43], v12 offset:12288
ds_read_b128 v[44:47], v12 offset:13312
s_waitcnt vmcnt(0)
buffer_load_dwordx4 v[48:51], v0, s[8:11], s60 offen offset:0 sc1
buffer_load_dwordx4 v[52:55], v0, s[8:11], s60 offen offset:1024 sc1
buffer_load_dwordx4 v[56:59], v0, s[8:11], s60 offen offset:2048 sc1
buffer_load_dwordx4 v[60:63], v0, s[8:11], s60 offen offset:3072 sc1
Lrec00_g_24w:
s_waitcnt vmcnt(3)
v_max3_u32 v104, v48, v49, v50
v_max_u32 v104, v51, v104
s_waitcnt vmcnt(2)
v_max3_u32 v104, v52, v53, v104
v_max3_u32 v104, v54, v55, v104
v_cmp_eq_u32 vcc, -1, v104
buffer_load_dwordx4 v[64:67], v0, s[8:11], s61 offen offset:0 sc1
buffer_load_dwordx4 v[68:71], v0, s[8:11], s61 offen offset:1024 sc1
s_cbranch_vccnz Lrec00_r_23
Lrec00_g_24:
s_waitcnt lgkmcnt(12)
v_smfmac_f32_16x16x64_bf16 v[112:115], v[48:51], v[80:87], v13
ds_read_b128 v[80:83], v12 offset:14336
ds_read_b128 v[84:87], v12 offset:15360
s_waitcnt lgkmcnt(12)
v_smfmac_f32_16x16x64_bf16 v[116:119], v[48:51], v[88:95], v13
ds_read_b128 v[88:91], v6 offset:0
ds_read_b128 v[92:95], v6 offset:1024
s_waitcnt lgkmcnt(12)
v_smfmac_f32_16x16x64_bf16 v[112:115], v[52:55], v[96:103], v13
ds_read_b128 v[96:99], v6 offset:2048
ds_read_b128 v[100:103], v6 offset:3072
s_waitcnt lgkmcnt(12)
v_smfmac_f32_16x16x64_bf16 v[116:119], v[52:55], v[16:23], v13
ds_read_b128 v[16:19], v6 offset:4096
ds_read_b128 v[20:23], v6 offset:5120
Lrec00_g_26w:
s_waitcnt vmcnt(3)
v_max3_u32 v104, v56, v57, v58
v_max_u32 v104, v59, v104
s_waitcnt vmcnt(2)
v_max3_u32 v104, v60, v61, v104
v_max3_u32 v104, v62, v63, v104
v_cmp_eq_u32 vcc, -1, v104
buffer_load_dwordx4 v[72:75], v0, s[8:11], s61 offen offset:2048 sc1
buffer_load_dwordx4 v[76:79], v0, s[8:11], s61 offen offset:3072 sc1
s_cbranch_vccnz Lrec00_r_25
Lrec00_g_26:
s_waitcnt lgkmcnt(12)
v_smfmac_f32_16x16x64_bf16 v[112:115], v[56:59], v[24:31], v13
ds_read_b128 v[24:27], v6 offset:6144
ds_read_b128 v[28:31], v6 offset:7168
s_waitcnt lgkmcnt(12)
v_smfmac_f32_16x16x64_bf16 v[116:119], v[56:59], v[32:39], v13
ds_read_b128 v[32:35], v6 offset:8192
ds_read_b128 v[36:39], v6 offset:9216
s_waitcnt lgkmcnt(12)
v_smfmac_f32_16x16x64_bf16 v[112:115], v[60:63], v[40:47], v13
ds_read_b128 v[40:43], v6 offset:10240
ds_read_b128 v[44:47], v6 offset:11264
s_waitcnt lgkmcnt(12)
v_smfmac_f32_16x16x64_bf16 v[116:119], v[60:63], v[80:87], v13
ds_read_b128 v[80:83], v6 offset:12288
ds_read_b128 v[84:87], v6 offset:13312
Lrec00_g_28w:
s_waitcnt vmcnt(3)
v_max3_u32 v104, v64, v65, v66
v_max_u32 v104, v67, v104
s_waitcnt vmcnt(2)
v_max3_u32 v104, v68, v69, v104
v_max3_u32 v104, v70, v71, v104
v_cmp_eq_u32 vcc, -1, v104
s_cbranch_vccnz Lrec00_r_27
Lrec00_g_28:
s_waitcnt lgkmcnt(12)
v_smfmac_f32_16x16x64_bf16 v[112:115], v[64:67], v[88:95], v13
ds_read_b128 v[88:91], v6 offset:14336
ds_read_b128 v[92:95], v6 offset:15360
s_waitcnt lgkmcnt(12)
v_smfmac_f32_16x16x64_bf16 v[116:119], v[64:67], v[96:103], v13
s_waitcnt lgkmcnt(10)
v_smfmac_f32_16x16x64_bf16 v[112:115], v[68:71], v[16:23], v13
s_waitcnt lgkmcnt(8)
v_smfmac_f32_16x16x64_bf16 v[116:119], v[68:71], v[24:31], v13
Lrec00_g_30w:
s_waitcnt vmcnt(1)
v_max3_u32 v104, v72, v73, v74
v_max_u32 v104, v75, v104
s_waitcnt vmcnt(0)
v_max3_u32 v104, v76, v77, v104
v_max3_u32 v104, v78, v79, v104
v_cmp_eq_u32 vcc, -1, v104
s_cbranch_vccnz Lrec00_r_29
Lrec00_g_30:
s_waitcnt lgkmcnt(6)
v_smfmac_f32_16x16x64_bf16 v[112:115], v[72:75], v[32:39], v13
s_waitcnt lgkmcnt(4)
v_smfmac_f32_16x16x64_bf16 v[116:119], v[72:75], v[40:47], v13
s_waitcnt lgkmcnt(2)
v_smfmac_f32_16x16x64_bf16 v[112:115], v[76:79], v[80:87], v13
s_waitcnt lgkmcnt(0)
v_smfmac_f32_16x16x64_bf16 v[116:119], v[76:79], v[88:95], v13
s_nop 7
v_permlane32_swap_b32 v112, v116
v_permlane32_swap_b32 v113, v117
v_permlane32_swap_b32 v114, v118
v_permlane32_swap_b32 v115, v119
v_pk_add_f32 v[112:113], v[112:113], v[116:117]
ds_write2_b32 v10, v112, v113 offset1:32
v_pk_add_f32 v[114:115], v[114:115], v[118:119]
ds_write2_b32 v10, v114, v115 offset0:64 offset1:96
s_waitcnt lgkmcnt(0)
s_barrier
ds_read_b128 v[16:19], v11 offset:0
ds_read_b128 v[20:23], v11 offset:1024
ds_read_b128 v[24:27], v11 offset:2048
ds_read_b128 v[28:31], v11 offset:3072
s_waitcnt lgkmcnt(2)
v_pk_add_f32 v[16:17], v[16:17], v[20:21]
v_pk_add_f32 v[18:19], v[18:19], v[22:23]
s_waitcnt lgkmcnt(1)
v_pk_add_f32 v[16:17], v[16:17], v[24:25]
v_pk_add_f32 v[18:19], v[18:19], v[26:27]
s_waitcnt lgkmcnt(0)
v_pk_add_f32 v[16:17], v[16:17], v[28:29]
v_pk_add_f32 v[18:19], v[18:19], v[30:31]
v_cvt_pk_bf16_f32 v16, v16, v17
v_cvt_pk_bf16_f32 v17, v18, v19
buffer_store_dwordx2 v[16:17], v2, s[8:11], s58 offen
buffer_store_dwordx2 v[16:17], v2, s[8:11], s59 offen sc1
s_branch Lrec00_p1
Lrec00_kva:
s_sub_u32 s43, s43, 1
s_cbranch_scc1 Lrec00_kvxa
s_buffer_load_dword s82, s[4:7], s81 glc
s_buffer_load_dword s83, s[4:7], s81 offset:128 glc
s_waitcnt lgkmcnt(0)
s_min_i32 s82, s82, s83
s_cmp_lt_i32 s82, s51
s_cbranch_scc1 Lrec00_kva
s_branch Lrec00_kvda
Lrec00_kvxa:
s_mov_b32 s43, 0
s_branch Lrec00_kvda
Lrec00_kvb:
s_sub_u32 s43, s43, 1
s_cbranch_scc1 Lrec00_kvxb
s_buffer_load_dword s82, s[4:7], s81 glc
s_buffer_load_dword s83, s[4:7], s81 offset:128 glc
s_waitcnt lgkmcnt(0)
s_min_i32 s82, s82, s83
s_cmp_lt_i32 s82, s51
s_cbranch_scc1 Lrec00_kvb
s_branch Lrec00_kvdb
Lrec00_kvxb:
s_mov_b32 s43, 0
s_branch Lrec00_kvdb
Lrec00_r_15:
s_sub_u32 s43, s43, 1
s_cbranch_scc1 Lrec00_r_15x
buffer_load_dwordx4 v[48:51], v0, s[8:11], s56 offen offset:0 sc1
buffer_load_dwordx4 v[52:55], v0, s[8:11], s56 offen offset:1024 sc1
buffer_load_dwordx4 v[56:59], v0, s[8:11], s56 offen offset:2048 sc1
buffer_load_dwordx4 v[60:63], v0, s[8:11], s56 offen offset:3072 sc1
s_branch Lrec00_g_16w
Lrec00_r_15x:
s_mov_b32 s43, 0
s_branch Lrec00_g_16
Lrec00_r_17:
s_sub_u32 s43, s43, 1
s_cbranch_scc1 Lrec00_r_17x
buffer_load_dwordx4 v[56:59], v0, s[8:11], s56 offen offset:2048 sc1
buffer_load_dwordx4 v[60:63], v0, s[8:11], s56 offen offset:3072 sc1
buffer_load_dwordx4 v[64:67], v0, s[8:11], s57 offen offset:0 sc1
buffer_load_dwordx4 v[68:71], v0, s[8:11], s57 offen offset:1024 sc1
s_branch Lrec00_g_18w
Lrec00_r_17x:
s_mov_b32 s43, 0
s_branch Lrec00_g_18
Lrec00_r_19:
s_sub_u32 s43, s43, 1
s_cbranch_scc1 Lrec00_r_19x
buffer_load_dwordx4 v[64:67], v0, s[8:11], s57 offen offset:0 sc1
buffer_load_dwordx4 v[68:71], v0, s[8:11], s57 offen offset:1024 sc1
buffer_load_dwordx4 v[72:75], v0, s[8:11], s57 offen offset:2048 sc1
buffer_load_dwordx4 v[76:79], v0, s[8:11], s57 offen offset:3072 sc1
s_branch Lrec00_g_20w
Lrec00_r_19x:
s_mov_b32 s43, 0
s_branch Lrec00_g_20
Lrec00_r_21:
s_sub_u32 s43, s43, 1
s_cbranch_scc1 Lrec00_r_21x
buffer_load_dwordx4 v[72:75], v0, s[8:11], s57 offen offset:2048 sc1
buffer_load_dwordx4 v[76:79], v0, s[8:11], s57 offen offset:3072 sc1
s_branch Lrec00_g_22w
Lrec00_r_21x:
s_mov_b32 s43, 0
s_branch Lrec00_g_22
Lrec00_ps:
buffer_load_dwordx4 v[88:91], v0, s[8:11], s64 offen sc1
buffer_load_dword v92, v3, s[8:11], s64 offen offset:1024 sc1
s_waitcnt vmcnt(2)
v_max3_u32 v53, v54, v55, v56
v_max3_u32 v53, v57, v58, v53
v_cmp_eq_u32 vcc, -1, v53
s_cbranch_vccz Lrec00_psq
buffer_load_dwordx4 v[54:57], v0, s[8:11], s64 offen sc1
buffer_load_dword v58, v3, s[8:11], s64 offen offset:1024 sc1
s_waitcnt vmcnt(2)
v_max3_u32 v53, v88, v89, v90
v_max3_u32 v53, v91, v92, v53
v_cmp_eq_u32 vcc, -1, v53
s_cbranch_vccz Lrec00_ps1
s_sub_u32 s43, s43, 1
s_cbranch_scc0 Lrec00_ps
s_mov_b32 s43, 0
s_branch Lrec00_ps1
Lrec00_psq:
v_pk_add_f32 v[112:113], v[112:113], v[54:55]
v_pk_add_f32 v[114:115], v[114:115], v[56:57]
v_add_f32 v116, v116, v58
s_branch Lrec00_ps2
Lrec00_early:
ds_read_b64_tr_b16 v[112:113], v9 offset:1152
ds_read_b64_tr_b16 v[114:115], v9 offset:1216
s_waitcnt lgkmcnt(0)
buffer_store_dword v108, v7, s[4:7], s68 offen sc1
s_mov_b64 exec, s[74:75]
buffer_store_dwordx4 v[112:115], v1, s[4:7], s67 offen sc1
s_mov_b64 exec, -1
s_nop 1
s_branch Lrec00_earlyd
Lrec00_r_23:
s_sub_u32 s43, s43, 1
s_cbranch_scc1 Lrec00_r_23x
buffer_load_dwordx4 v[48:51], v0, s[8:11], s60 offen offset:0 sc1
buffer_load_dwordx4 v[52:55], v0, s[8:11], s60 offen offset:1024 sc1
buffer_load_dwordx4 v[56:59], v0, s[8:11], s60 offen offset:2048 sc1
buffer_load_dwordx4 v[60:63], v0, s[8:11], s60 offen offset:3072 sc1
s_branch Lrec00_g_24w
Lrec00_r_23x:
s_mov_b32 s43, 0
s_branch Lrec00_g_24
Lrec00_r_25:
s_sub_u32 s43, s43, 1
s_cbranch_scc1 Lrec00_r_25x
buffer_load_dwordx4 v[56:59], v0, s[8:11], s60 offen offset:2048 sc1
buffer_load_dwordx4 v[60:63], v0, s[8:11], s60 offen offset:3072 sc1
buffer_load_dwordx4 v[64:67], v0, s[8:11], s61 offen offset:0 sc1
buffer_load_dwordx4 v[68:71], v0, s[8:11], s61 offen offset:1024 sc1
s_branch Lrec00_g_26w
Lrec00_r_25x:
s_mov_b32 s43, 0
s_branch Lrec00_g_26
Lrec00_r_27:
s_sub_u32 s43, s43, 1
s_cbranch_scc1 Lrec00_r_27x
buffer_load_dwordx4 v[64:67], v0, s[8:11], s61 offen offset:0 sc1
buffer_load_dwordx4 v[68:71], v0, s[8:11], s61 offen offset:1024 sc1
buffer_load_dwordx4 v[72:75], v0, s[8:11], s61 offen offset:2048 sc1
buffer_load_dwordx4 v[76:79], v0, s[8:11], s61 offen offset:3072 sc1
s_branch Lrec00_g_28w
Lrec00_r_27x:
s_mov_b32 s43, 0
s_branch Lrec00_g_28
Lrec00_r_29:
s_sub_u32 s43, s43, 1
s_cbranch_scc1 Lrec00_r_29x
buffer_load_dwordx4 v[72:75], v0, s[8:11], s61 offen offset:2048 sc1
buffer_load_dwordx4 v[76:79], v0, s[8:11], s61 offen offset:3072 sc1
s_branch Lrec00_g_30w
Lrec00_r_29x:
s_mov_b32 s43, 0
s_branch Lrec00_g_30
Lrec00_last:
s_nop 4
v_permlane32_swap_b32 v104, v106
v_permlane32_swap_b32 v105, v107
v_pk_add_f32 v[104:105], v[104:105], v[106:107]
v_cvt_pk_bf16_f32 v108, v104, v105
v_mov_b32 v109, 0
ds_read_b64_tr_b16 v[112:113], v9 offset:1152
ds_read_b64_tr_b16 v[114:115], v9 offset:1216
s_waitcnt lgkmcnt(0)
buffer_store_dword v108, v7, s[4:7], s68 offen sc1
s_mov_b64 exec, s[74:75]
buffer_store_dwordx4 v[112:115], v1, s[4:7], s67 offen sc1
s_mov_b64 exec, -1
s_branch Lrec_end
Lrec01_in:
ds_read_b128 v[80:83], v5 offset:24576
ds_read_b128 v[84:87], v5 offset:26624
ds_read_b128 v[88:91], v5 offset:24832
ds_read_b128 v[92:95], v5 offset:26880
ds_read_b128 v[124:127], v0 offset:29696
s_waitcnt lgkmcnt(0)
s_barrier
s_add_u32 s81, s81, 8192
s_cmp_eq_u32 s81, s71
s_cselect_b32 s51, 24576, 0
s_sub_u32 s81, s81, s51
s_cmp_eq_u32 s49, 63
s_cselect_b32 s51, -2, s49
s_add_u32 s51, s51, 2
s_min_i32 s82, s82, s83
s_cmp_lt_i32 s82, s51
s_cbranch_scc1 Lrec01_kva
Lrec01_kvda:
s_add_u32 s45, s81, 8192
s_cmp_eq_u32 s45, s71
s_cselect_b32 s51, 24576, 0
s_sub_u32 s45, s45, s51
s_mov_b32 m0, 25600
s_add_u32 s65, s65, 0x4000
buffer_load_dwordx4 v0, s[4:7], s65 offen sc1 lds
s_mov_b32 m0, 29696
s_add_u32 s66, s66, 0x4000
buffer_load_dwordx4 v5, s[4:7], s66 offen sc1 lds
v_pk_mul_f32 v[96:97], v[14:15], v[14:15] op_sel:[1,1] op_sel_hi:[1,1]
v_pk_mul_f32 v[98:99], v[14:15], v[14:15] op_sel:[1,1] op_sel_hi:[1,1]
v_pk_mul_f32 v[100:101], v[14:15], v[14:15] op_sel:[1,1] op_sel_hi:[1,1]
v_pk_mul_f32 v[102:103], v[14:15], v[14:15] op_sel:[1,1] op_sel_hi:[1,1]
ds_read_b128 v[16:19], v0 offset:0
ds_read_b128 v[20:23], v0 offset:1024
ds_read_b128 v[24:27], v0 offset:2048
s_waitcnt lgkmcnt(2)
v_smfmac_f32_16x16x64_bf16 v[96:99], v[16:19], a[0:7], v13
ds_read_b128 v[28:31], v0 offset:3072
v_smfmac_f32_16x16x64_bf16 v[100:103], v[16:19], a[128:135], v13
s_waitcnt lgkmcnt(1)
v_smfmac_f32_16x16x64_bf16 v[96:99], v[20:23], a[8:15], v13
ds_read_b128 v[32:35], v0 offset:4096
v_smfmac_f32_16x16x64_bf16 v[100:103], v[20:23], a[136:143], v13
v_smfmac_f32_16x16x64_bf16 v[96:99], v[24:27], a[16:23], v13
ds_read_b128 v[36:39], v0 offset:5120
v_smfmac_f32_16x16x64_bf16 v[100:103], v[24:27], a[144:151], v13
s_waitcnt lgkmcnt(1)
v_smfmac_f32_16x16x64_bf16 v[96:99], v[28:31], a[24:31], v13
ds_read_b128 v[40:43], v0 offset:6144
v_smfmac_f32_16x16x64_bf16 v[100:103], v[28:31], a[152:159], v13
v_smfmac_f32_16x16x64_bf16 v[96:99], v[32:35], a[32:39], v13
ds_read_b128 v[44:47], v0 offset:7168
v_smfmac_f32_16x16x64_bf16 v[100:103], v[32:35], a[160:167], v13
s_waitcnt lgkmcnt(1)
v_smfmac_f32_16x16x64_bf16 v[96:99], v[36:39], a[40:47], v13
ds_read_b128 v[48:51], v0 offset:8192
v_smfmac_f32_16x16x64_bf16 v[100:103], v[36:39], a[168:175], v13
v_smfmac_f32_16x16x64_bf16 v[96:99], v[40:43], a[48:55], v13
ds_read_b128 v[52:55], v0 offset:9216
v_smfmac_f32_16x16x64_bf16 v[100:103], v[40:43], a[176:183], v13
s_waitcnt lgkmcnt(1)
v_smfmac_f32_16x16x64_bf16 v[96:99], v[44:47], a[56:63], v13
ds_read_b128 v[56:59], v0 offset:10240
v_smfmac_f32_16x16x64_bf16 v[100:103], v[44:47], a[184:191], v13
s_branch Lrec01_p2
.p2align 10
Lrec01_p1:
s_add_u32 s49, s49, 1
v_mov_b32 v116, -1
v_mov_b32 v117, -1
s_add_u32 s81, s81, 8192
s_cmp_eq_u32 s81, s71
s_cselect_b32 s51, 24576, 0
s_sub_u32 s81, s81, s51
s_cmp_eq_u32 s49, 63
s_cselect_b32 s51, -2, s49
s_add_u32 s51, s51, 2
s_min_i32 s82, s82, s83
s_cmp_lt_i32 s82, s51
s_cbranch_scc1 Lrec01_kvb
Lrec01_kvdb:
s_add_u32 s45, s81, 8192
s_cmp_eq_u32 s45, s71
s_cselect_b32 s51, 24576, 0
s_sub_u32 s45, s45, s51
s_mov_b32 m0, 0
ds_read_b128 v[80:83], v5 offset:24576
ds_read_b128 v[84:87], v5 offset:26624
ds_read_b128 v[88:91], v5 offset:24832
ds_read_b128 v[92:95], v5 offset:26880
ds_read_b128 v[124:127], v0 offset:29696
ds_read_b64_tr_b16 v[112:113], v9 offset:1408
ds_read_b64_tr_b16 v[114:115], v9 offset:1472
s_barrier
buffer_load_dwordx4 v[48:51], v0, s[8:11], s56 offen offset:1024 sc1
buffer_load_dwordx4 v[52:55], v0, s[8:11], s56 offen offset:2048 sc1
buffer_load_dwordx4 v[56:59], v0, s[8:11], s56 offen offset:3072 sc1
buffer_load_dwordx4 v[60:63], v0, s[8:11], s56 offen offset:0 sc1
Lrec01_g_32w:
s_waitcnt vmcnt(3)
v_max3_u32 v122, v48, v49, v50
v_max_u32 v122, v51, v122
s_waitcnt vmcnt(2)
v_max3_u32 v122, v52, v53, v122
v_max3_u32 v122, v54, v55, v122
v_cmp_eq_u32 vcc, -1, v122
buffer_load_dwordx4 v[64:67], v0, s[8:11], s57 offen offset:1024 sc1
buffer_load_dwordx4 v[68:71], v0, s[8:11], s57 offen offset:2048 sc1
s_cbranch_vccnz Lrec01_r_31
Lrec01_g_32:
v_lshlrev_b32 v16, 16, v48
v_and_b32 v17, 0xffff0000, v48
v_lshlrev_b32 v18, 16, v49
v_and_b32 v19, 0xffff0000, v49
v_lshlrev_b32 v20, 16, v50
v_and_b32 v21, 0xffff0000, v50
v_lshlrev_b32 v22, 16, v51
v_and_b32 v23, 0xffff0000, v51
v_lshlrev_b32 v24, 16, v52
v_and_b32 v25, 0xffff0000, v52
v_lshlrev_b32 v26, 16, v53
v_and_b32 v27, 0xffff0000, v53
v_lshlrev_b32 v28, 16, v54
v_and_b32 v29, 0xffff0000, v54
v_lshlrev_b32 v30, 16, v55
v_and_b32 v31, 0xffff0000, v55
Lrec01_g_34w:
s_waitcnt vmcnt(3)
v_max3_u32 v122, v56, v57, v58
v_max_u32 v122, v59, v122
s_waitcnt vmcnt(2)
v_max3_u32 v122, v60, v61, v122
v_max3_u32 v122, v62, v63, v122
v_cmp_eq_u32 vcc, -1, v122
buffer_load_dwordx4 v[72:75], v0, s[8:11], s57 offen offset:3072 sc1
buffer_load_dwordx4 v[76:79], v0, s[8:11], s57 offen offset:0 sc1
s_cbranch_vccnz Lrec01_r_33
Lrec01_g_34:
v_lshlrev_b32 v32, 16, v56
v_and_b32 v33, 0xffff0000, v56
v_lshlrev_b32 v34, 16, v57
v_and_b32 v35, 0xffff0000, v57
v_lshlrev_b32 v36, 16, v58
v_and_b32 v37, 0xffff0000, v58
v_lshlrev_b32 v38, 16, v59
v_and_b32 v39, 0xffff0000, v59
v_lshlrev_b32 v40, 16, v60
v_and_b32 v41, 0xffff0000, v60
v_lshlrev_b32 v42, 16, v61
v_and_b32 v43, 0xffff0000, v61
v_lshlrev_b32 v44, 16, v62
v_and_b32 v45, 0xffff0000, v62
v_lshlrev_b32 v46, 16, v63
v_and_b32 v47, 0xffff0000, v63
Lrec01_g_36w:
s_waitcnt vmcnt(3)
v_max3_u32 v122, v64, v65, v66
v_max_u32 v122, v67, v122
s_waitcnt vmcnt(2)
v_max3_u32 v122, v68, v69, v122
v_max3_u32 v122, v70, v71, v122
v_cmp_eq_u32 vcc, -1, v122
s_cbranch_vccnz Lrec01_r_35
Lrec01_g_36:
v_dot2_f32_bf16 v16, v64, s69, v16
v_dot2_f32_bf16 v17, v64, s70, v17
v_dot2_f32_bf16 v18, v65, s69, v18
v_dot2_f32_bf16 v19, v65, s70, v19
v_dot2_f32_bf16 v20, v66, s69, v20
v_dot2_f32_bf16 v21, v66, s70, v21
v_dot2_f32_bf16 v22, v67, s69, v22
v_dot2_f32_bf16 v23, v67, s70, v23
v_cvt_pk_bf16_f32 v48, v16, v17
v_cvt_pk_bf16_f32 v49, v18, v19
v_cvt_pk_bf16_f32 v50, v20, v21
v_cvt_pk_bf16_f32 v51, v22, v23
ds_write_addtid_b32 v48 offset:5120
ds_write_addtid_b32 v49 offset:5376
ds_write_addtid_b32 v50 offset:5632
ds_write_addtid_b32 v51 offset:5888
v_dot2_f32_bf16 v24, v68, s69, v24
v_dot2_f32_bf16 v25, v68, s70, v25
v_dot2_f32_bf16 v26, v69, s69, v26
v_dot2_f32_bf16 v27, v69, s70, v27
v_dot2_f32_bf16 v28, v70, s69, v28
v_dot2_f32_bf16 v29, v70, s70, v29
v_dot2_f32_bf16 v30, v71, s69, v30
v_dot2_f32_bf16 v31, v71, s70, v31
v_cvt_pk_bf16_f32 v52, v24, v25
v_cvt_pk_bf16_f32 v53, v26, v27
v_cvt_pk_bf16_f32 v54, v28, v29
v_cvt_pk_bf16_f32 v55, v30, v31
ds_write_addtid_b32 v52 offset:6144
ds_write_addtid_b32 v53 offset:6400
ds_write_addtid_b32 v54 offset:6656
ds_write_addtid_b32 v55 offset:6912
Lrec01_g_38w:
s_waitcnt vmcnt(1)
v_max3_u32 v122, v72, v73, v74
v_max_u32 v122, v75, v122
s_waitcnt vmcnt(0)
v_max3_u32 v122, v76, v77, v122
v_max3_u32 v122, v78, v79, v122
v_cmp_eq_u32 vcc, -1, v122
s_cbranch_vccnz Lrec01_r_37
Lrec01_g_38:
v_dot2_f32_bf16 v32, v72, s69, v32
v_dot2_f32_bf16 v33, v72, s70, v33
v_dot2_f32_bf16 v34, v73, s69, v34
v_dot2_f32_bf16 v35, v73, s70, v35
v_dot2_f32_bf16 v36, v74, s69, v36
v_dot2_f32_bf16 v37, v74, s70, v37
v_dot2_f32_bf16 v38, v75, s69, v38
v_dot2_f32_bf16 v39, v75, s70, v39
v_cvt_pk_bf16_f32 v56, v32, v33
v_cvt_pk_bf16_f32 v57, v34, v35
v_cvt_pk_bf16_f32 v58, v36, v37
v_cvt_pk_bf16_f32 v59, v38, v39
ds_write_addtid_b32 v56 offset:7168
ds_write_addtid_b32 v57 offset:7424
ds_write_addtid_b32 v58 offset:7680
ds_write_addtid_b32 v59 offset:7936
v_dot2_f32_bf16 v40, v76, s69, v40
v_dot2_f32_bf16 v41, v76, s70, v41
v_dot2_f32_bf16 v42, v77, s69, v42
v_dot2_f32_bf16 v43, v77, s70, v43
v_dot2_f32_bf16 v44, v78, s69, v44
v_dot2_f32_bf16 v45, v78, s70, v45
v_dot2_f32_bf16 v46, v79, s69, v46
v_dot2_f32_bf16 v47, v79, s70, v47
v_cvt_pk_bf16_f32 v60, v40, v41
v_cvt_pk_bf16_f32 v61, v42, v43
v_cvt_pk_bf16_f32 v62, v44, v45
v_cvt_pk_bf16_f32 v63, v46, v47
ds_write_addtid_b32 v60 offset:4096
ds_write_addtid_b32 v61 offset:4352
ds_write_addtid_b32 v62 offset:4608
ds_write_addtid_b32 v63 offset:4864
v_pk_mul_f32 v[96:97], v[14:15], v[14:15] op_sel:[1,1] op_sel_hi:[1,1]
v_pk_mul_f32 v[98:99], v[14:15], v[14:15] op_sel:[1,1] op_sel_hi:[1,1]
v_pk_mul_f32 v[100:101], v[14:15], v[14:15] op_sel:[1,1] op_sel_hi:[1,1]
v_pk_mul_f32 v[102:103], v[14:15], v[14:15] op_sel:[1,1] op_sel_hi:[1,1]
s_waitcnt lgkmcnt(0)
s_barrier
ds_read_b128 v[16:19], v0 offset:0
ds_read_b128 v[20:23], v0 offset:1024
ds_read_b128 v[24:27], v0 offset:2048
s_mov_b32 m0, 25600
s_add_u32 s65, s65, 0x4000
buffer_load_dwordx4 v0, s[4:7], s65 offen sc1 lds
s_waitcnt lgkmcnt(2)
v_smfmac_f32_16x16x64_bf16 v[96:99], v[16:19], a[0:7], v13
ds_read_b128 v[28:31], v0 offset:3072
v_smfmac_f32_16x16x64_bf16 v[100:103], v[16:19], a[128:135], v13
s_mov_b32 m0, 29696
s_add_u32 s66, s66, 0x4000
buffer_load_dwordx4 v5, s[4:7], s66 offen sc1 lds
s_waitcnt lgkmcnt(1)
v_smfmac_f32_16x16x64_bf16 v[96:99], v[20:23], a[8:15], v13
ds_read_b128 v[32:35], v0 offset:4096
v_smfmac_f32_16x16x64_bf16 v[100:103], v[20:23], a[136:143], v13
buffer_store_dword v108, v7, s[4:7], s68 offen sc1
v_smfmac_f32_16x16x64_bf16 v[96:99], v[24:27], a[16:23], v13
ds_read_b128 v[36:39], v0 offset:5120
v_smfmac_f32_16x16x64_bf16 v[100:103], v[24:27], a[144:151], v13
s_mov_b64 exec, s[74:75]
buffer_store_dwordx4 v[112:115], v1, s[4:7], s67 offen sc1
s_mov_b64 exec, -1
s_waitcnt lgkmcnt(1)
v_smfmac_f32_16x16x64_bf16 v[96:99], v[28:31], a[24:31], v13
ds_read_b128 v[40:43], v0 offset:6144
v_smfmac_f32_16x16x64_bf16 v[100:103], v[28:31], a[152:159], v13
buffer_store_dwordx2 v[116:117], v2, s[12:15], s63 offen offset:512
v_smfmac_f32_16x16x64_bf16 v[96:99], v[32:35], a[32:39], v13
ds_read_b128 v[44:47], v0 offset:7168
v_smfmac_f32_16x16x64_bf16 v[100:103], v[32:35], a[160:167], v13
s_waitcnt lgkmcnt(1)
v_smfmac_f32_16x16x64_bf16 v[96:99], v[36:39], a[40:47], v13
ds_read_b128 v[48:51], v0 offset:8192
v_smfmac_f32_16x16x64_bf16 v[100:103], v[36:39], a[168:175], v13
v_smfmac_f32_16x16x64_bf16 v[96:99], v[40:43], a[48:55], v13
ds_read_b128 v[52:55], v0 offset:9216
v_smfmac_f32_16x16x64_bf16 v[100:103], v[40:43], a[176:183], v13
s_waitcnt lgkmcnt(1)
v_smfmac_f32_16x16x64_bf16 v[96:99], v[44:47], a[56:63], v13
ds_read_b128 v[56:59], v0 offset:10240
v_smfmac_f32_16x16x64_bf16 v[100:103], v[44:47], a[184:191], v13
Lrec01_p2:
v_smfmac_f32_16x16x64_bf16 v[96:99], v[48:51], a[64:71], v13
ds_read_b128 v[60:63], v0 offset:11264
v_smfmac_f32_16x16x64_bf16 v[100:103], v[48:51], a[192:199], v13
s_add_u32 s72, s72, 524288
s_waitcnt lgkmcnt(1)
v_smfmac_f32_16x16x64_bf16 v[96:99], v[52:55], a[72:79], v13
ds_read_b128 v[64:67], v0 offset:12288
v_smfmac_f32_16x16x64_bf16 v[100:103], v[52:55], a[200:207], v13
s_and_b32 s72, s72, 1572864
v_smfmac_f32_16x16x64_bf16 v[96:99], v[56:59], a[80:87], v13
ds_read_b128 v[68:71], v0 offset:13312
v_smfmac_f32_16x16x64_bf16 v[100:103], v[56:59], a[208:215], v13
s_or_b32 s8, s73, s72
s_waitcnt lgkmcnt(1)
v_smfmac_f32_16x16x64_bf16 v[96:99], v[60:63], a[88:95], v13
ds_read_b128 v[72:75], v0 offset:14336
v_smfmac_f32_16x16x64_bf16 v[100:103], v[60:63], a[216:223], v13
s_xor_b32 s12, s8, 1048576
v_smfmac_f32_16x16x64_bf16 v[96:99], v[64:67], a[96:103], v13
ds_read_b128 v[76:79], v0 offset:15360
v_smfmac_f32_16x16x64_bf16 v[100:103], v[64:67], a[224:231], v13
s_and_b32 s50, s49, 3
s_cselect_b32 s50, 0, 0x2000
s_waitcnt lgkmcnt(1)
v_smfmac_f32_16x16x64_bf16 v[96:99], v[68:71], a[104:111], v13
v_smfmac_f32_16x16x64_bf16 v[100:103], v[68:71], a[232:239], v13
s_add_u32 s50, s50, 0x800
v_smfmac_f32_16x16x64_bf16 v[96:99], v[72:75], a[112:119], v13
v_smfmac_f32_16x16x64_bf16 v[100:103], v[72:75], a[240:247], v13
s_add_u32 s68, s68, s50
s_waitcnt lgkmcnt(0)
v_smfmac_f32_16x16x64_bf16 v[96:99], v[76:79], a[120:127], v13
v_smfmac_f32_16x16x64_bf16 v[100:103], v[76:79], a[248:255], v13
s_add_u32 s67, s67, s50
s_nop 6
v_permlane32_swap_b32 v96, v100
v_permlane32_swap_b32 v97, v101
v_permlane32_swap_b32 v98, v102
v_permlane32_swap_b32 v99, v103
v_pk_add_f32 v[96:97], v[96:97], v[100:101]
v_pk_add_f32 v[98:99], v[98:99], v[102:103]
v_cvt_pk_bf16_f32 v96, v96, v97
v_cvt_pk_bf16_f32 v97, v98, v99
ds_write_b64 v8, v[96:97]
s_waitcnt lgkmcnt(0)
s_barrier
ds_read_b64_tr_b16 v[96:97], v9 offset:0
ds_read_b64_tr_b16 v[98:99], v9 offset:64
ds_read_b64_tr_b16 v[100:101], v9 offset:256
ds_read_b64_tr_b16 v[102:103], v9 offset:320
s_waitcnt lgkmcnt(2)
v_mfma_f32_16x16x32_bf16 v[116:119], v[88:91], v[96:99], 0
s_waitcnt lgkmcnt(0)
v_mfma_f32_16x16x32_bf16 v[116:119], v[92:95], v[100:103], v[116:119]
ds_read_b64_tr_b16 v[104:105], v9 offset:1152
ds_read_b64_tr_b16 v[106:107], v9 offset:1216
v_mfma_f32_16x16x32_bf16 v[112:115], v[80:83], v[96:99], 0
ds_read_b64_tr_b16 v[108:109], v9 offset:1408
ds_read_b64_tr_b16 v[110:111], v9 offset:1472
v_mfma_f32_16x16x32_bf16 v[112:115], v[84:87], v[100:103], v[112:115]
s_mov_b64 exec, s[76:77]
s_nop 0
buffer_store_dwordx4 v[116:119], v0, s[8:11], s63 offen
s_mov_b64 exec, -1
s_waitcnt lgkmcnt(0)
v_mfma_f32_16x16x32_bf16 v[120:123], v[104:107], v[96:99], 0
v_mfma_f32_16x16x32_bf16 v[120:123], v[108:111], v[100:103], v[120:123]
v_pk_mul_f32 v[104:105], v[14:15], v[14:15] op_sel:[1,1] op_sel_hi:[1,1]
v_pk_mul_f32 v[106:107], v[14:15], v[14:15] op_sel:[1,1] op_sel_hi:[1,1]
s_nop 1
v_smfmac_f32_16x16x64_bf16 v[104:107], v[16:19], v[128:135], v13
s_buffer_load_dword s82, s[4:7], s45 glc
v_smfmac_f32_16x16x64_bf16 v[104:107], v[20:23], v[136:143], v13
s_buffer_load_dword s83, s[4:7], s45 offset:128 glc
v_smfmac_f32_16x16x64_bf16 v[104:107], v[24:27], v[144:151], v13
v_cndmask_b32 v112, v112, v116, s[76:77]
v_smfmac_f32_16x16x64_bf16 v[104:107], v[28:31], v[152:159], v13
v_cndmask_b32 v113, v113, v117, s[76:77]
v_smfmac_f32_16x16x64_bf16 v[104:107], v[32:35], v[160:167], v13
v_cndmask_b32 v114, v114, v118, s[76:77]
v_smfmac_f32_16x16x64_bf16 v[104:107], v[36:39], v[168:175], v13
v_cndmask_b32 v115, v115, v119, s[76:77]
buffer_load_dwordx4 v[88:91], v0, s[8:11], s64 offen sc1
buffer_load_dword v92, v3, s[8:11], s64 offen offset:1024 sc1
v_smfmac_f32_16x16x64_bf16 v[104:107], v[40:43], v[176:183], v13
v_cndmask_b32 v120, v120, v122, s[78:79]
v_smfmac_f32_16x16x64_bf16 v[104:107], v[44:47], v[184:191], v13
v_cndmask_b32 v121, v121, v123, s[78:79]
v_smfmac_f32_16x16x64_bf16 v[104:107], v[48:51], v[192:199], v13
v_cndmask_b32 v116, v120, v121, s[76:77]
v_smfmac_f32_16x16x64_bf16 v[104:107], v[52:55], v[200:207], v13
s_cmp_eq_u32 s49, 63
v_smfmac_f32_16x16x64_bf16 v[104:107], v[56:59], v[208:215], v13
v_smfmac_f32_16x16x64_bf16 v[104:107], v[60:63], v[216:223], v13
v_smfmac_f32_16x16x64_bf16 v[104:107], v[64:67], v[224:231], v13
v_smfmac_f32_16x16x64_bf16 v[104:107], v[68:71], v[232:239], v13
v_smfmac_f32_16x16x64_bf16 v[104:107], v[72:75], v[240:247], v13
v_smfmac_f32_16x16x64_bf16 v[104:107], v[76:79], v[248:255], v13
buffer_load_dwordx4 v[54:57], v0, s[8:11], s64 offen sc1
buffer_load_dword v58, v3, s[8:11], s64 offen offset:1024 sc1
s_cbranch_scc1 Lrec01_last
s_waitcnt vmcnt(2)
v_max3_u32 v53, v88, v89, v90
v_max3_u32 v53, v91, v92, v53
v_cmp_eq_u32 vcc, -1, v53
s_cbranch_vccnz Lrec01_ps
Lrec01_ps1:
v_pk_add_f32 v[112:113], v[112:113], v[88:89]
v_pk_add_f32 v[114:115], v[114:115], v[90:91]
v_add_f32 v116, v116, v92
Lrec01_ps2:
v_max3_f32 v60, v112, v113, v114
v_max3_f32 v60, v115, v116, v60
v_mov_b32 v65, 0
v_mov_b32 v109, 0
v_max_f32_dpp v60, v60, v60 row_ror:8 row_mask:0xf bank_mask:0xf
v_mov_b32 v61, v60
v_permlane32_swap_b32 v104, v106
v_permlane32_swap_b32 v105, v107
v_permlane32_swap_b32 v60, v61
v_max_f32 v60, v60, v61
v_mov_b32 v61, v60
v_pk_add_f32 v[104:105], v[104:105], v[106:107]
v_cvt_pk_bf16_f32 v108, v104, v105
v_permlane16_swap_b32 v60, v61
v_max_f32 v60, v60, v61
v_mul_f32 v60, s84, v60
v_fma_f32 v116, v116, s84, -v60
v_pk_fma_f32 v[112:113], v[112:113], s[84:85], v[60:61] op_sel_hi:[1,1,0] neg_lo:[0,0,1] neg_hi:[0,0,1]
v_exp_f32 v116, v116
v_pk_fma_f32 v[114:115], v[114:115], s[84:85], v[60:61] op_sel_hi:[1,1,0] neg_lo:[0,0,1] neg_hi:[0,0,1]
v_exp_f32 v112, v112
v_cvt_pk_bf16_f32 v64, v116, v15
v_exp_f32 v113, v113
v_lshlrev_b32 v64, v14, v64
v_exp_f32 v114, v114
v_exp_f32 v115, v115
v_mfma_f32_16x16x16_bf16 v[68:71], v[108:109], v[64:65], 0
v_cvt_pk_bf16_f32 v62, v112, v113
v_cvt_pk_bf16_f32 v63, v114, v115
v_pk_add_f32 v[112:113], v[112:113], v[114:115]
v_add_f32 v60, v116, v112
v_mfma_f32_16x16x16_bf16 v[76:79], v[126:127], v[62:63], v[68:71]
v_mfma_f32_16x16x16_bf16 v[72:75], v[124:125], v[62:63], v[68:71]
v_add_f32 v60, v60, v113
s_nop 1
v_add_f32_dpp v60, v60, v60 row_ror:8 row_mask:0xf bank_mask:0xf
v_mov_b32 v61, v60
s_nop 1
v_permlane32_swap_b32 v60, v61
v_add_f32 v60, v60, v61
v_mov_b32 v61, v60
v_add_f32_dpp v72, v76, v72 row_ror:8 row_mask:0xf bank_mask:0xf
v_add_f32_dpp v73, v77, v73 row_ror:8 row_mask:0xf bank_mask:0xf
v_permlane16_swap_b32 v60, v61
v_add_f32 v60, v60, v61
v_rcp_f32 v60, v60
v_add_f32_dpp v74, v78, v74 row_ror:8 row_mask:0xf bank_mask:0xf
v_add_f32_dpp v75, v79, v75 row_ror:8 row_mask:0xf bank_mask:0xf
v_pk_mul_f32 v[72:73], v[72:73], v[60:61] op_sel_hi:[1,0]
v_pk_mul_f32 v[74:75], v[74:75], v[60:61] op_sel_hi:[1,0]
v_cvt_pk_bf16_f32 v120, v72, v73
v_cvt_pk_bf16_f32 v121, v74, v75
s_mov_b64 exec, s[74:75]
buffer_store_dwordx2 v[120:121], v4, s[8:11], s62 offen offset:0
s_mov_b64 exec, -1
s_cmp_ge_u32 s49, 61
s_cbranch_scc1 Lrec01_early
Lrec01_earlyd:
v_pk_mul_f32 v[112:113], v[14:15], v[14:15] op_sel:[1,1] op_sel_hi:[1,1]
v_pk_mul_f32 v[114:115], v[14:15], v[14:15] op_sel:[1,1] op_sel_hi:[1,1]
v_pk_mul_f32 v[116:117], v[14:15], v[14:15] op_sel:[1,1] op_sel_hi:[1,1]
v_pk_mul_f32 v[118:119], v[14:15], v[14:15] op_sel:[1,1] op_sel_hi:[1,1]
s_waitcnt vmcnt(1)
ds_read_b128 v[80:83], v12 offset:4096
ds_read_b128 v[84:87], v12 offset:5120
ds_read_b128 v[88:91], v12 offset:6144
ds_read_b128 v[92:95], v12 offset:7168
ds_read_b128 v[96:99], v12 offset:8192
ds_read_b128 v[100:103], v12 offset:9216
ds_read_b128 v[16:19], v12 offset:10240
ds_read_b128 v[20:23], v12 offset:11264
ds_read_b128 v[24:27], v12 offset:12288
ds_read_b128 v[28:31], v12 offset:13312
ds_read_b128 v[32:35], v12 offset:14336
ds_read_b128 v[36:39], v12 offset:15360
ds_read_b128 v[40:43], v6 offset:0
ds_read_b128 v[44:47], v6 offset:1024
s_waitcnt vmcnt(0)
buffer_load_dwordx4 v[48:51], v0, s[8:11], s60 offen offset:1024 sc1
buffer_load_dwordx4 v[52:55], v0, s[8:11], s60 offen offset:2048 sc1
buffer_load_dwordx4 v[56:59], v0, s[8:11], s60 offen offset:3072 sc1
buffer_load_dwordx4 v[60:63], v0, s[8:11], s61 offen offset:0 sc1
Lrec01_g_40w:
s_waitcnt vmcnt(3)
v_max3_u32 v104, v48, v49, v50
v_max_u32 v104, v51, v104
s_waitcnt vmcnt(2)
v_max3_u32 v104, v52, v53, v104
v_max3_u32 v104, v54, v55, v104
v_cmp_eq_u32 vcc, -1, v104
buffer_load_dwordx4 v[64:67], v0, s[8:11], s61 offen offset:1024 sc1
buffer_load_dwordx4 v[68:71], v0, s[8:11], s61 offen offset:2048 sc1
s_cbranch_vccnz Lrec01_r_39
Lrec01_g_40:
s_waitcnt lgkmcnt(12)
v_smfmac_f32_16x16x64_bf16 v[112:115], v[48:51], v[80:87], v13
ds_read_b128 v[80:83], v6 offset:2048
ds_read_b128 v[84:87], v6 offset:3072
s_waitcnt lgkmcnt(12)
v_smfmac_f32_16x16x64_bf16 v[116:119], v[48:51], v[88:95], v13
ds_read_b128 v[88:91], v6 offset:4096
ds_read_b128 v[92:95], v6 offset:5120
s_waitcnt lgkmcnt(12)
v_smfmac_f32_16x16x64_bf16 v[112:115], v[52:55], v[96:103], v13
ds_read_b128 v[96:99], v6 offset:6144
ds_read_b128 v[100:103], v6 offset:7168
s_waitcnt lgkmcnt(12)
v_smfmac_f32_16x16x64_bf16 v[116:119], v[52:55], v[16:23], v13
ds_read_b128 v[16:19], v6 offset:8192
ds_read_b128 v[20:23], v6 offset:9216
Lrec01_g_42w:
s_waitcnt vmcnt(3)
v_max3_u32 v104, v56, v57, v58
v_max_u32 v104, v59, v104
s_waitcnt vmcnt(2)
v_max3_u32 v104, v60, v61, v104
v_max3_u32 v104, v62, v63, v104
v_cmp_eq_u32 vcc, -1, v104
buffer_load_dwordx4 v[72:75], v0, s[8:11], s61 offen offset:3072 sc1
buffer_load_dwordx4 v[76:79], v0, s[8:11], s60 offen offset:0 sc1
s_cbranch_vccnz Lrec01_r_41
Lrec01_g_42:
s_waitcnt lgkmcnt(12)
v_smfmac_f32_16x16x64_bf16 v[112:115], v[56:59], v[24:31], v13
ds_read_b128 v[24:27], v6 offset:10240
ds_read_b128 v[28:31], v6 offset:11264
s_waitcnt lgkmcnt(12)
v_smfmac_f32_16x16x64_bf16 v[116:119], v[56:59], v[32:39], v13
ds_read_b128 v[32:35], v6 offset:12288
ds_read_b128 v[36:39], v6 offset:13312
s_waitcnt lgkmcnt(12)
v_smfmac_f32_16x16x64_bf16 v[112:115], v[60:63], v[40:47], v13
ds_read_b128 v[40:43], v6 offset:14336
ds_read_b128 v[44:47], v6 offset:15360
s_waitcnt lgkmcnt(12)
v_smfmac_f32_16x16x64_bf16 v[116:119], v[60:63], v[80:87], v13
ds_read_b128 v[80:83], v12 offset:0
ds_read_b128 v[84:87], v12 offset:1024
Lrec01_g_44w:
s_waitcnt vmcnt(3)
v_max3_u32 v104, v64, v65, v66
v_max_u32 v104, v67, v104
s_waitcnt vmcnt(2)
v_max3_u32 v104, v68, v69, v104
v_max3_u32 v104, v70, v71, v104
v_cmp_eq_u32 vcc, -1, v104
s_cbranch_vccnz Lrec01_r_43
Lrec01_g_44:
s_waitcnt lgkmcnt(12)
v_smfmac_f32_16x16x64_bf16 v[112:115], v[64:67], v[88:95], v13
ds_read_b128 v[88:91], v12 offset:2048
ds_read_b128 v[92:95], v12 offset:3072
s_waitcnt lgkmcnt(12)
v_smfmac_f32_16x16x64_bf16 v[116:119], v[64:67], v[96:103], v13
s_waitcnt lgkmcnt(10)
v_smfmac_f32_16x16x64_bf16 v[112:115], v[68:71], v[16:23], v13
s_waitcnt lgkmcnt(8)
v_smfmac_f32_16x16x64_bf16 v[116:119], v[68:71], v[24:31], v13
Lrec01_g_46w:
s_waitcnt vmcnt(1)
v_max3_u32 v104, v72, v73, v74
v_max_u32 v104, v75, v104
s_waitcnt vmcnt(0)
v_max3_u32 v104, v76, v77, v104
v_max3_u32 v104, v78, v79, v104
v_cmp_eq_u32 vcc, -1, v104
s_cbranch_vccnz Lrec01_r_45
Lrec01_g_46:
s_waitcnt lgkmcnt(6)
v_smfmac_f32_16x16x64_bf16 v[112:115], v[72:75], v[32:39], v13
s_waitcnt lgkmcnt(4)
v_smfmac_f32_16x16x64_bf16 v[116:119], v[72:75], v[40:47], v13
s_waitcnt lgkmcnt(2)
v_smfmac_f32_16x16x64_bf16 v[112:115], v[76:79], v[80:87], v13
s_waitcnt lgkmcnt(0)
v_smfmac_f32_16x16x64_bf16 v[116:119], v[76:79], v[88:95], v13
s_nop 7
v_permlane32_swap_b32 v112, v116
v_permlane32_swap_b32 v113, v117
v_permlane32_swap_b32 v114, v118
v_permlane32_swap_b32 v115, v119
v_pk_add_f32 v[112:113], v[112:113], v[116:117]
ds_write2_b32 v10, v112, v113 offset1:32
v_pk_add_f32 v[114:115], v[114:115], v[118:119]
ds_write2_b32 v10, v114, v115 offset0:64 offset1:96
s_waitcnt lgkmcnt(0)
s_barrier
s_cmp_ge_u32 s49, 61
s_cbranch_scc1 Lrec01_eflag
Lrec01_eflagd:
s_branch Lrec01_p1
Lrec01_kva:
s_sub_u32 s43, s43, 1
s_cbranch_scc1 Lrec01_kvxa
s_buffer_load_dword s82, s[4:7], s81 glc
s_buffer_load_dword s83, s[4:7], s81 offset:128 glc
s_waitcnt lgkmcnt(0)
s_min_i32 s82, s82, s83
s_cmp_lt_i32 s82, s51
s_cbranch_scc1 Lrec01_kva
s_branch Lrec01_kvda
Lrec01_kvxa:
s_mov_b32 s43, 0
s_branch Lrec01_kvda
Lrec01_kvb:
s_sub_u32 s43, s43, 1
s_cbranch_scc1 Lrec01_kvxb
s_buffer_load_dword s82, s[4:7], s81 glc
s_buffer_load_dword s83, s[4:7], s81 offset:128 glc
s_waitcnt lgkmcnt(0)
s_min_i32 s82, s82, s83
s_cmp_lt_i32 s82, s51
s_cbranch_scc1 Lrec01_kvb
s_branch Lrec01_kvdb
Lrec01_kvxb:
s_mov_b32 s43, 0
s_branch Lrec01_kvdb
Lrec01_r_31:
s_sub_u32 s43, s43, 1
s_cbranch_scc1 Lrec01_r_31x
buffer_load_dwordx4 v[48:51], v0, s[8:11], s56 offen offset:1024 sc1
buffer_load_dwordx4 v[52:55], v0, s[8:11], s56 offen offset:2048 sc1
buffer_load_dwordx4 v[56:59], v0, s[8:11], s56 offen offset:3072 sc1
buffer_load_dwordx4 v[60:63], v0, s[8:11], s56 offen offset:0 sc1
s_branch Lrec01_g_32w
Lrec01_r_31x:
s_mov_b32 s43, 0
s_branch Lrec01_g_32
Lrec01_r_33:
s_sub_u32 s43, s43, 1
s_cbranch_scc1 Lrec01_r_33x
buffer_load_dwordx4 v[56:59], v0, s[8:11], s56 offen offset:3072 sc1
buffer_load_dwordx4 v[60:63], v0, s[8:11], s56 offen offset:0 sc1
buffer_load_dwordx4 v[64:67], v0, s[8:11], s57 offen offset:1024 sc1
buffer_load_dwordx4 v[68:71], v0, s[8:11], s57 offen offset:2048 sc1
s_branch Lrec01_g_34w
Lrec01_r_33x:
s_mov_b32 s43, 0
s_branch Lrec01_g_34
Lrec01_r_35:
s_sub_u32 s43, s43, 1
s_cbranch_scc1 Lrec01_r_35x
buffer_load_dwordx4 v[64:67], v0, s[8:11], s57 offen offset:1024 sc1
buffer_load_dwordx4 v[68:71], v0, s[8:11], s57 offen offset:2048 sc1
buffer_load_dwordx4 v[72:75], v0, s[8:11], s57 offen offset:3072 sc1
buffer_load_dwordx4 v[76:79], v0, s[8:11], s57 offen offset:0 sc1
s_branch Lrec01_g_36w
Lrec01_r_35x:
s_mov_b32 s43, 0
s_branch Lrec01_g_36
Lrec01_r_37:
s_sub_u32 s43, s43, 1
s_cbranch_scc1 Lrec01_r_37x
buffer_load_dwordx4 v[72:75], v0, s[8:11], s57 offen offset:3072 sc1
buffer_load_dwordx4 v[76:79], v0, s[8:11], s57 offen offset:0 sc1
s_branch Lrec01_g_38w
Lrec01_r_37x:
s_mov_b32 s43, 0
s_branch Lrec01_g_38
Lrec01_ps:
buffer_load_dwordx4 v[88:91], v0, s[8:11], s64 offen sc1
buffer_load_dword v92, v3, s[8:11], s64 offen offset:1024 sc1
s_waitcnt vmcnt(2)
v_max3_u32 v53, v54, v55, v56
v_max3_u32 v53, v57, v58, v53
v_cmp_eq_u32 vcc, -1, v53
s_cbranch_vccz Lrec01_psq
buffer_load_dwordx4 v[54:57], v0, s[8:11], s64 offen sc1
buffer_load_dword v58, v3, s[8:11], s64 offen offset:1024 sc1
s_waitcnt vmcnt(2)
v_max3_u32 v53, v88, v89, v90
v_max3_u32 v53, v91, v92, v53
v_cmp_eq_u32 vcc, -1, v53
s_cbranch_vccz Lrec01_ps1
s_sub_u32 s43, s43, 1
s_cbranch_scc0 Lrec01_ps
s_mov_b32 s43, 0
s_branch Lrec01_ps1
Lrec01_psq:
v_pk_add_f32 v[112:113], v[112:113], v[54:55]
v_pk_add_f32 v[114:115], v[114:115], v[56:57]
v_add_f32 v116, v116, v58
s_branch Lrec01_ps2
Lrec01_early:
ds_read_b64_tr_b16 v[112:113], v9 offset:1408
ds_read_b64_tr_b16 v[114:115], v9 offset:1472
s_waitcnt lgkmcnt(0)
buffer_store_dword v108, v7, s[4:7], s68 offen sc1
s_mov_b64 exec, s[74:75]
buffer_store_dwordx4 v[112:115], v1, s[4:7], s67 offen sc1
s_mov_b64 exec, -1
s_nop 1
s_branch Lrec01_earlyd
Lrec01_r_39:
s_sub_u32 s43, s43, 1
s_cbranch_scc1 Lrec01_r_39x
buffer_load_dwordx4 v[48:51], v0, s[8:11], s60 offen offset:1024 sc1
buffer_load_dwordx4 v[52:55], v0, s[8:11], s60 offen offset:2048 sc1
buffer_load_dwordx4 v[56:59], v0, s[8:11], s60 offen offset:3072 sc1
buffer_load_dwordx4 v[60:63], v0, s[8:11], s61 offen offset:0 sc1
s_branch Lrec01_g_40w
Lrec01_r_39x:
s_mov_b32 s43, 0
s_branch Lrec01_g_40
Lrec01_r_41:
s_sub_u32 s43, s43, 1
s_cbranch_scc1 Lrec01_r_41x
buffer_load_dwordx4 v[56:59], v0, s[8:11], s60 offen offset:3072 sc1
buffer_load_dwordx4 v[60:63], v0, s[8:11], s61 offen offset:0 sc1
buffer_load_dwordx4 v[64:67], v0, s[8:11], s61 offen offset:1024 sc1
buffer_load_dwordx4 v[68:71], v0, s[8:11], s61 offen offset:2048 sc1
s_branch Lrec01_g_42w
Lrec01_r_41x:
s_mov_b32 s43, 0
s_branch Lrec01_g_42
Lrec01_r_43:
s_sub_u32 s43, s43, 1
s_cbranch_scc1 Lrec01_r_43x
buffer_load_dwordx4 v[64:67], v0, s[8:11], s61 offen offset:1024 sc1
buffer_load_dwordx4 v[68:71], v0, s[8:11], s61 offen offset:2048 sc1
buffer_load_dwordx4 v[72:75], v0, s[8:11], s61 offen offset:3072 sc1
buffer_load_dwordx4 v[76:79], v0, s[8:11], s60 offen offset:0 sc1
s_branch Lrec01_g_44w
Lrec01_r_43x:
s_mov_b32 s43, 0
s_branch Lrec01_g_44
Lrec01_r_45:
s_sub_u32 s43, s43, 1
s_cbranch_scc1 Lrec01_r_45x
buffer_load_dwordx4 v[72:75], v0, s[8:11], s61 offen offset:3072 sc1
buffer_load_dwordx4 v[76:79], v0, s[8:11], s60 offen offset:0 sc1
s_branch Lrec01_g_46w
Lrec01_r_45x:
s_mov_b32 s43, 0
s_branch Lrec01_g_46
Lrec01_eflag:
s_add_u32 s50, s49, 1
v_mov_b32 v16, s50
s_mov_b64 exec, 1
buffer_store_dword v16, v15, s[4:7], s80 offen sc1
s_mov_b64 exec, -1
s_branch Lrec01_eflagd
Lrec01_last:
s_nop 4
v_permlane32_swap_b32 v104, v106
v_permlane32_swap_b32 v105, v107
v_pk_add_f32 v[104:105], v[104:105], v[106:107]
v_cvt_pk_bf16_f32 v108, v104, v105
v_mov_b32 v109, 0
ds_read_b64_tr_b16 v[112:113], v9 offset:1408
ds_read_b64_tr_b16 v[114:115], v9 offset:1472
s_waitcnt lgkmcnt(0)
buffer_store_dword v108, v7, s[4:7], s68 offen sc1
s_mov_b64 exec, s[74:75]
buffer_store_dwordx4 v[112:115], v1, s[4:7], s67 offen sc1
s_mov_b64 exec, -1
s_branch Lrec_end
Lrec02_in:
ds_read_b128 v[80:83], v5 offset:24576
ds_read_b128 v[84:87], v5 offset:26624
ds_read_b128 v[88:91], v5 offset:24832
ds_read_b128 v[92:95], v5 offset:26880
ds_read_b128 v[124:127], v0 offset:30720
s_waitcnt lgkmcnt(0)
s_barrier
s_add_u32 s81, s81, 8192
s_cmp_eq_u32 s81, s71
s_cselect_b32 s51, 24576, 0
s_sub_u32 s81, s81, s51
s_cmp_eq_u32 s49, 63
s_cselect_b32 s51, -2, s49
s_add_u32 s51, s51, 2
s_min_i32 s82, s82, s83
s_cmp_lt_i32 s82, s51
s_cbranch_scc1 Lrec02_kva
Lrec02_kvda:
s_add_u32 s45, s81, 8192
s_cmp_eq_u32 s45, s71
s_cselect_b32 s51, 24576, 0
s_sub_u32 s45, s45, s51
s_mov_b32 m0, 26624
s_add_u32 s65, s65, 0x4000
buffer_load_dwordx4 v0, s[4:7], s65 offen sc1 lds
s_mov_b32 m0, 30720
s_add_u32 s66, s66, 0x4000
buffer_load_dwordx4 v5, s[4:7], s66 offen sc1 lds
v_pk_mul_f32 v[96:97], v[14:15], v[14:15] op_sel:[1,1] op_sel_hi:[1,1]
v_pk_mul_f32 v[98:99], v[14:15], v[14:15] op_sel:[1,1] op_sel_hi:[1,1]
v_pk_mul_f32 v[100:101], v[14:15], v[14:15] op_sel:[1,1] op_sel_hi:[1,1]
v_pk_mul_f32 v[102:103], v[14:15], v[14:15] op_sel:[1,1] op_sel_hi:[1,1]
ds_read_b128 v[16:19], v0 offset:0
ds_read_b128 v[20:23], v0 offset:1024
ds_read_b128 v[24:27], v0 offset:2048
s_waitcnt lgkmcnt(2)
v_smfmac_f32_16x16x64_bf16 v[96:99], v[16:19], a[0:7], v13
ds_read_b128 v[28:31], v0 offset:3072
v_smfmac_f32_16x16x64_bf16 v[100:103], v[16:19], a[128:135], v13
s_waitcnt lgkmcnt(1)
v_smfmac_f32_16x16x64_bf16 v[96:99], v[20:23], a[8:15], v13
ds_read_b128 v[32:35], v0 offset:4096
v_smfmac_f32_16x16x64_bf16 v[100:103], v[20:23], a[136:143], v13
v_smfmac_f32_16x16x64_bf16 v[96:99], v[24:27], a[16:23], v13
ds_read_b128 v[36:39], v0 offset:5120
v_smfmac_f32_16x16x64_bf16 v[100:103], v[24:27], a[144:151], v13
s_waitcnt lgkmcnt(1)
v_smfmac_f32_16x16x64_bf16 v[96:99], v[28:31], a[24:31], v13
ds_read_b128 v[40:43], v0 offset:6144
v_smfmac_f32_16x16x64_bf16 v[100:103], v[28:31], a[152:159], v13
v_smfmac_f32_16x16x64_bf16 v[96:99], v[32:35], a[32:39], v13
ds_read_b128 v[44:47], v0 offset:7168
v_smfmac_f32_16x16x64_bf16 v[100:103], v[32:35], a[160:167], v13
s_waitcnt lgkmcnt(1)
v_smfmac_f32_16x16x64_bf16 v[96:99], v[36:39], a[40:47], v13
ds_read_b128 v[48:51], v0 offset:8192
v_smfmac_f32_16x16x64_bf16 v[100:103], v[36:39], a[168:175], v13
v_smfmac_f32_16x16x64_bf16 v[96:99], v[40:43], a[48:55], v13
ds_read_b128 v[52:55], v0 offset:9216
v_smfmac_f32_16x16x64_bf16 v[100:103], v[40:43], a[176:183], v13
s_waitcnt lgkmcnt(1)
v_smfmac_f32_16x16x64_bf16 v[96:99], v[44:47], a[56:63], v13
ds_read_b128 v[56:59], v0 offset:10240
v_smfmac_f32_16x16x64_bf16 v[100:103], v[44:47], a[184:191], v13
s_branch Lrec02_p2
.p2align 10
Lrec02_p1:
s_add_u32 s49, s49, 1
v_mov_b32 v116, -1
v_mov_b32 v117, -1
s_add_u32 s81, s81, 8192
s_cmp_eq_u32 s81, s71
s_cselect_b32 s51, 24576, 0
s_sub_u32 s81, s81, s51
s_cmp_eq_u32 s49, 63
s_cselect_b32 s51, -2, s49
s_add_u32 s51, s51, 2
s_min_i32 s82, s82, s83
s_cmp_lt_i32 s82, s51
s_cbranch_scc1 Lrec02_kvb
Lrec02_kvdb:
s_add_u32 s45, s81, 8192
s_cmp_eq_u32 s45, s71
s_cselect_b32 s51, 24576, 0
s_sub_u32 s45, s45, s51
s_mov_b32 m0, 0
ds_read_b128 v[80:83], v5 offset:24576
ds_read_b128 v[84:87], v5 offset:26624
ds_read_b128 v[88:91], v5 offset:24832
ds_read_b128 v[92:95], v5 offset:26880
ds_read_b128 v[124:127], v0 offset:30720
s_barrier
buffer_load_dwordx4 v[48:51], v0, s[8:11], s56 offen offset:2048 sc1
buffer_load_dwordx4 v[52:55], v0, s[8:11], s56 offen offset:3072 sc1
buffer_load_dwordx4 v[56:59], v0, s[8:11], s56 offen offset:0 sc1
buffer_load_dwordx4 v[60:63], v0, s[8:11], s56 offen offset:1024 sc1
Lrec02_g_48w:
s_waitcnt vmcnt(3)
v_max3_u32 v122, v48, v49, v50
v_max_u32 v122, v51, v122
s_waitcnt vmcnt(2)
v_max3_u32 v122, v52, v53, v122
v_max3_u32 v122, v54, v55, v122
v_cmp_eq_u32 vcc, -1, v122
buffer_load_dwordx4 v[64:67], v0, s[8:11], s57 offen offset:2048 sc1
buffer_load_dwordx4 v[68:71], v0, s[8:11], s57 offen offset:3072 sc1
s_cbranch_vccnz Lrec02_r_47
Lrec02_g_48:
v_lshlrev_b32 v16, 16, v48
v_and_b32 v17, 0xffff0000, v48
v_lshlrev_b32 v18, 16, v49
v_and_b32 v19, 0xffff0000, v49
v_lshlrev_b32 v20, 16, v50
v_and_b32 v21, 0xffff0000, v50
v_lshlrev_b32 v22, 16, v51
v_and_b32 v23, 0xffff0000, v51
v_lshlrev_b32 v24, 16, v52
v_and_b32 v25, 0xffff0000, v52
v_lshlrev_b32 v26, 16, v53
v_and_b32 v27, 0xffff0000, v53
v_lshlrev_b32 v28, 16, v54
v_and_b32 v29, 0xffff0000, v54
v_lshlrev_b32 v30, 16, v55
v_and_b32 v31, 0xffff0000, v55
Lrec02_g_50w:
s_waitcnt vmcnt(3)
v_max3_u32 v122, v56, v57, v58
v_max_u32 v122, v59, v122
s_waitcnt vmcnt(2)
v_max3_u32 v122, v60, v61, v122
v_max3_u32 v122, v62, v63, v122
v_cmp_eq_u32 vcc, -1, v122
buffer_load_dwordx4 v[72:75], v0, s[8:11], s57 offen offset:0 sc1
buffer_load_dwordx4 v[76:79], v0, s[8:11], s57 offen offset:1024 sc1
s_cbranch_vccnz Lrec02_r_49
Lrec02_g_50:
v_lshlrev_b32 v32, 16, v56
v_and_b32 v33, 0xffff0000, v56
v_lshlrev_b32 v34, 16, v57
v_and_b32 v35, 0xffff0000, v57
v_lshlrev_b32 v36, 16, v58
v_and_b32 v37, 0xffff0000, v58
v_lshlrev_b32 v38, 16, v59
v_and_b32 v39, 0xffff0000, v59
v_lshlrev_b32 v40, 16, v60
v_and_b32 v41, 0xffff0000, v60
v_lshlrev_b32 v42, 16, v61
v_and_b32 v43, 0xffff0000, v61
v_lshlrev_b32 v44, 16, v62
v_and_b32 v45, 0xffff0000, v62
v_lshlrev_b32 v46, 16, v63
v_and_b32 v47, 0xffff0000, v63
Lrec02_g_52w:
s_waitcnt vmcnt(3)
v_max3_u32 v122, v64, v65, v66
v_max_u32 v122, v67, v122
s_waitcnt vmcnt(2)
v_max3_u32 v122, v68, v69, v122
v_max3_u32 v122, v70, v71, v122
v_cmp_eq_u32 vcc, -1, v122
s_cbranch_vccnz Lrec02_r_51
Lrec02_g_52:
v_dot2_f32_bf16 v16, v64, s69, v16
v_dot2_f32_bf16 v17, v64, s70, v17
v_dot2_f32_bf16 v18, v65, s69, v18
v_dot2_f32_bf16 v19, v65, s70, v19
v_dot2_f32_bf16 v20, v66, s69, v20
v_dot2_f32_bf16 v21, v66, s70, v21
v_dot2_f32_bf16 v22, v67, s69, v22
v_dot2_f32_bf16 v23, v67, s70, v23
v_cvt_pk_bf16_f32 v48, v16, v17
v_cvt_pk_bf16_f32 v49, v18, v19
v_cvt_pk_bf16_f32 v50, v20, v21
v_cvt_pk_bf16_f32 v51, v22, v23
ds_write_addtid_b32 v48 offset:10240
ds_write_addtid_b32 v49 offset:10496
ds_write_addtid_b32 v50 offset:10752
ds_write_addtid_b32 v51 offset:11008
v_dot2_f32_bf16 v24, v68, s69, v24
v_dot2_f32_bf16 v25, v68, s70, v25
v_dot2_f32_bf16 v26, v69, s69, v26
v_dot2_f32_bf16 v27, v69, s70, v27
v_dot2_f32_bf16 v28, v70, s69, v28
v_dot2_f32_bf16 v29, v70, s70, v29
v_dot2_f32_bf16 v30, v71, s69, v30
v_dot2_f32_bf16 v31, v71, s70, v31
v_cvt_pk_bf16_f32 v52, v24, v25
v_cvt_pk_bf16_f32 v53, v26, v27
v_cvt_pk_bf16_f32 v54, v28, v29
v_cvt_pk_bf16_f32 v55, v30, v31
ds_write_addtid_b32 v52 offset:11264
ds_write_addtid_b32 v53 offset:11520
ds_write_addtid_b32 v54 offset:11776
ds_write_addtid_b32 v55 offset:12032
Lrec02_g_54w:
s_waitcnt vmcnt(1)
v_max3_u32 v122, v72, v73, v74
v_max_u32 v122, v75, v122
s_waitcnt vmcnt(0)
v_max3_u32 v122, v76, v77, v122
v_max3_u32 v122, v78, v79, v122
v_cmp_eq_u32 vcc, -1, v122
s_cbranch_vccnz Lrec02_r_53
Lrec02_g_54:
v_dot2_f32_bf16 v32, v72, s69, v32
v_dot2_f32_bf16 v33, v72, s70, v33
v_dot2_f32_bf16 v34, v73, s69, v34
v_dot2_f32_bf16 v35, v73, s70, v35
v_dot2_f32_bf16 v36, v74, s69, v36
v_dot2_f32_bf16 v37, v74, s70, v37
v_dot2_f32_bf16 v38, v75, s69, v38
v_dot2_f32_bf16 v39, v75, s70, v39
v_cvt_pk_bf16_f32 v56, v32, v33
v_cvt_pk_bf16_f32 v57, v34, v35
v_cvt_pk_bf16_f32 v58, v36, v37
v_cvt_pk_bf16_f32 v59, v38, v39
ds_write_addtid_b32 v56 offset:8192
ds_write_addtid_b32 v57 offset:8448
ds_write_addtid_b32 v58 offset:8704
ds_write_addtid_b32 v59 offset:8960
v_dot2_f32_bf16 v40, v76, s69, v40
v_dot2_f32_bf16 v41, v76, s70, v41
v_dot2_f32_bf16 v42, v77, s69, v42
v_dot2_f32_bf16 v43, v77, s70, v43
v_dot2_f32_bf16 v44, v78, s69, v44
v_dot2_f32_bf16 v45, v78, s70, v45
v_dot2_f32_bf16 v46, v79, s69, v46
v_dot2_f32_bf16 v47, v79, s70, v47
v_cvt_pk_bf16_f32 v60, v40, v41
v_cvt_pk_bf16_f32 v61, v42, v43
v_cvt_pk_bf16_f32 v62, v44, v45
v_cvt_pk_bf16_f32 v63, v46, v47
ds_write_addtid_b32 v60 offset:9216
ds_write_addtid_b32 v61 offset:9472
ds_write_addtid_b32 v62 offset:9728
ds_write_addtid_b32 v63 offset:9984
v_pk_mul_f32 v[96:97], v[14:15], v[14:15] op_sel:[1,1] op_sel_hi:[1,1]
v_pk_mul_f32 v[98:99], v[14:15], v[14:15] op_sel:[1,1] op_sel_hi:[1,1]
v_pk_mul_f32 v[100:101], v[14:15], v[14:15] op_sel:[1,1] op_sel_hi:[1,1]
v_pk_mul_f32 v[102:103], v[14:15], v[14:15] op_sel:[1,1] op_sel_hi:[1,1]
s_waitcnt lgkmcnt(0)
s_barrier
ds_read_b128 v[16:19], v0 offset:0
ds_read_b128 v[20:23], v0 offset:1024
ds_read_b128 v[24:27], v0 offset:2048
s_mov_b32 m0, 26624
s_add_u32 s65, s65, 0x4000
buffer_load_dwordx4 v0, s[4:7], s65 offen sc1 lds
s_waitcnt lgkmcnt(2)
v_smfmac_f32_16x16x64_bf16 v[96:99], v[16:19], a[0:7], v13
ds_read_b128 v[28:31], v0 offset:3072
v_smfmac_f32_16x16x64_bf16 v[100:103], v[16:19], a[128:135], v13
s_mov_b32 m0, 30720
s_add_u32 s66, s66, 0x4000
buffer_load_dwordx4 v5, s[4:7], s66 offen sc1 lds
s_waitcnt lgkmcnt(1)
v_smfmac_f32_16x16x64_bf16 v[96:99], v[20:23], a[8:15], v13
ds_read_b128 v[32:35], v0 offset:4096
v_smfmac_f32_16x16x64_bf16 v[100:103], v[20:23], a[136:143], v13
buffer_store_dword v108, v7, s[4:7], s68 offen sc1
v_smfmac_f32_16x16x64_bf16 v[96:99], v[24:27], a[16:23], v13
ds_read_b128 v[36:39], v0 offset:5120
v_smfmac_f32_16x16x64_bf16 v[100:103], v[24:27], a[144:151], v13
buffer_store_dwordx2 v[116:117], v2, s[12:15], s63 offen offset:1024
s_waitcnt lgkmcnt(1)
v_smfmac_f32_16x16x64_bf16 v[96:99], v[28:31], a[24:31], v13
ds_read_b128 v[40:43], v0 offset:6144
v_smfmac_f32_16x16x64_bf16 v[100:103], v[28:31], a[152:159], v13
buffer_store_dwordx2 v[116:117], v2, s[12:15], s58 offen
v_smfmac_f32_16x16x64_bf16 v[96:99], v[32:35], a[32:39], v13
ds_read_b128 v[44:47], v0 offset:7168
v_smfmac_f32_16x16x64_bf16 v[100:103], v[32:35], a[160:167], v13
s_waitcnt lgkmcnt(1)
v_smfmac_f32_16x16x64_bf16 v[96:99], v[36:39], a[40:47], v13
ds_read_b128 v[48:51], v0 offset:8192
v_smfmac_f32_16x16x64_bf16 v[100:103], v[36:39], a[168:175], v13
v_smfmac_f32_16x16x64_bf16 v[96:99], v[40:43], a[48:55], v13
ds_read_b128 v[52:55], v0 offset:9216
v_smfmac_f32_16x16x64_bf16 v[100:103], v[40:43], a[176:183], v13
s_waitcnt lgkmcnt(1)
v_smfmac_f32_16x16x64_bf16 v[96:99], v[44:47], a[56:63], v13
ds_read_b128 v[56:59], v0 offset:10240
v_smfmac_f32_16x16x64_bf16 v[100:103], v[44:47], a[184:191], v13
Lrec02_p2:
v_smfmac_f32_16x16x64_bf16 v[96:99], v[48:51], a[64:71], v13
ds_read_b128 v[60:63], v0 offset:11264
v_smfmac_f32_16x16x64_bf16 v[100:103], v[48:51], a[192:199], v13
s_add_u32 s72, s72, 524288
s_waitcnt lgkmcnt(1)
v_smfmac_f32_16x16x64_bf16 v[96:99], v[52:55], a[72:79], v13
ds_read_b128 v[64:67], v0 offset:12288
v_smfmac_f32_16x16x64_bf16 v[100:103], v[52:55], a[200:207], v13
s_and_b32 s72, s72, 1572864
v_smfmac_f32_16x16x64_bf16 v[96:99], v[56:59], a[80:87], v13
ds_read_b128 v[68:71], v0 offset:13312
v_smfmac_f32_16x16x64_bf16 v[100:103], v[56:59], a[208:215], v13
s_or_b32 s8, s73, s72
s_waitcnt lgkmcnt(1)
v_smfmac_f32_16x16x64_bf16 v[96:99], v[60:63], a[88:95], v13
ds_read_b128 v[72:75], v0 offset:14336
v_smfmac_f32_16x16x64_bf16 v[100:103], v[60:63], a[216:223], v13
s_xor_b32 s12, s8, 1048576
v_smfmac_f32_16x16x64_bf16 v[96:99], v[64:67], a[96:103], v13
ds_read_b128 v[76:79], v0 offset:15360
v_smfmac_f32_16x16x64_bf16 v[100:103], v[64:67], a[224:231], v13
s_and_b32 s50, s49, 3
s_cselect_b32 s50, 0, 0x2000
s_waitcnt lgkmcnt(1)
v_smfmac_f32_16x16x64_bf16 v[96:99], v[68:71], a[104:111], v13
v_smfmac_f32_16x16x64_bf16 v[100:103], v[68:71], a[232:239], v13
s_add_u32 s50, s50, 0x800
v_smfmac_f32_16x16x64_bf16 v[96:99], v[72:75], a[112:119], v13
v_smfmac_f32_16x16x64_bf16 v[100:103], v[72:75], a[240:247], v13
s_add_u32 s68, s68, s50
s_waitcnt lgkmcnt(0)
v_smfmac_f32_16x16x64_bf16 v[96:99], v[76:79], a[120:127], v13
v_smfmac_f32_16x16x64_bf16 v[100:103], v[76:79], a[248:255], v13
s_add_u32 s67, s67, s50
s_nop 6
v_permlane32_swap_b32 v96, v100
v_permlane32_swap_b32 v97, v101
v_permlane32_swap_b32 v98, v102
v_permlane32_swap_b32 v99, v103
v_pk_add_f32 v[96:97], v[96:97], v[100:101]
v_pk_add_f32 v[98:99], v[98:99], v[102:103]
v_cvt_pk_bf16_f32 v96, v96, v97
v_cvt_pk_bf16_f32 v97, v98, v99
ds_write_b64 v8, v[96:97]
s_waitcnt lgkmcnt(0)
s_barrier
ds_read_b64_tr_b16 v[96:97], v9 offset:0
ds_read_b64_tr_b16 v[98:99], v9 offset:64
ds_read_b64_tr_b16 v[104:105], v9 offset:1152
ds_read_b64_tr_b16 v[106:107], v9 offset:1216
ds_read_b64_tr_b16 v[100:101], v9 offset:256
ds_read_b64_tr_b16 v[102:103], v9 offset:320
ds_read_b64_tr_b16 v[108:109], v9 offset:1408
ds_read_b64_tr_b16 v[110:111], v9 offset:1472
s_waitcnt lgkmcnt(4)
v_mfma_f32_16x16x32_bf16 v[120:123], v[104:107], v[96:99], 0
s_waitcnt lgkmcnt(0)
v_mfma_f32_16x16x32_bf16 v[120:123], v[108:111], v[100:103], v[120:123]
v_mfma_f32_16x16x32_bf16 v[112:115], v[80:83], v[96:99], 0
v_mfma_f32_16x16x32_bf16 v[112:115], v[84:87], v[100:103], v[112:115]
s_mov_b32 exec_lo, 0xff00ff
s_mov_b32 exec_hi, 0x0
s_nop 3
buffer_store_dword v120, v3, s[8:11], s63 offen offset:1024
s_lshl_b64 exec, exec, 8
buffer_store_dword v121, v3, s[8:11], s63 offen offset:1024
s_mov_b64 exec, -1
v_mfma_f32_16x16x32_bf16 v[116:119], v[88:91], v[96:99], 0
v_mfma_f32_16x16x32_bf16 v[116:119], v[92:95], v[100:103], v[116:119]
v_pk_mul_f32 v[104:105], v[14:15], v[14:15] op_sel:[1,1] op_sel_hi:[1,1]
v_pk_mul_f32 v[106:107], v[14:15], v[14:15] op_sel:[1,1] op_sel_hi:[1,1]
s_nop 1
v_smfmac_f32_16x16x64_bf16 v[104:107], v[16:19], v[128:135], v13
s_buffer_load_dword s82, s[4:7], s45 glc
v_smfmac_f32_16x16x64_bf16 v[104:107], v[20:23], v[136:143], v13
s_buffer_load_dword s83, s[4:7], s45 offset:128 glc
v_smfmac_f32_16x16x64_bf16 v[104:107], v[24:27], v[144:151], v13
v_cndmask_b32 v112, v112, v116, s[76:77]
v_smfmac_f32_16x16x64_bf16 v[104:107], v[28:31], v[152:159], v13
v_cndmask_b32 v113, v113, v117, s[76:77]
v_smfmac_f32_16x16x64_bf16 v[104:107], v[32:35], v[160:167], v13
v_cndmask_b32 v114, v114, v118, s[76:77]
v_smfmac_f32_16x16x64_bf16 v[104:107], v[36:39], v[168:175], v13
v_cndmask_b32 v115, v115, v119, s[76:77]
buffer_load_dwordx4 v[88:91], v0, s[8:11], s64 offen sc1
buffer_load_dword v92, v3, s[8:11], s64 offen offset:1024 sc1
v_smfmac_f32_16x16x64_bf16 v[104:107], v[40:43], v[176:183], v13
v_cndmask_b32 v120, v120, v122, s[78:79]
v_smfmac_f32_16x16x64_bf16 v[104:107], v[44:47], v[184:191], v13
v_cndmask_b32 v121, v121, v123, s[78:79]
v_smfmac_f32_16x16x64_bf16 v[104:107], v[48:51], v[192:199], v13
v_cndmask_b32 v116, v120, v121, s[76:77]
v_smfmac_f32_16x16x64_bf16 v[104:107], v[52:55], v[200:207], v13
s_cmp_eq_u32 s49, 63
v_smfmac_f32_16x16x64_bf16 v[104:107], v[56:59], v[208:215], v13
v_smfmac_f32_16x16x64_bf16 v[104:107], v[60:63], v[216:223], v13
v_smfmac_f32_16x16x64_bf16 v[104:107], v[64:67], v[224:231], v13
v_smfmac_f32_16x16x64_bf16 v[104:107], v[68:71], v[232:239], v13
v_smfmac_f32_16x16x64_bf16 v[104:107], v[72:75], v[240:247], v13
v_smfmac_f32_16x16x64_bf16 v[104:107], v[76:79], v[248:255], v13
buffer_load_dwordx4 v[54:57], v0, s[8:11], s64 offen sc1
buffer_load_dword v58, v3, s[8:11], s64 offen offset:1024 sc1
s_cbranch_scc1 Lrec02_last
s_waitcnt vmcnt(2)
v_max3_u32 v53, v88, v89, v90
v_max3_u32 v53, v91, v92, v53
v_cmp_eq_u32 vcc, -1, v53
s_cbranch_vccnz Lrec02_ps
Lrec02_ps1:
v_pk_add_f32 v[112:113], v[112:113], v[88:89]
v_pk_add_f32 v[114:115], v[114:115], v[90:91]
v_add_f32 v116, v116, v92
Lrec02_ps2:
v_max3_f32 v60, v112, v113, v114
v_max3_f32 v60, v115, v116, v60
v_mov_b32 v65, 0
v_mov_b32 v109, 0
v_max_f32_dpp v60, v60, v60 row_ror:8 row_mask:0xf bank_mask:0xf
v_mov_b32 v61, v60
v_permlane32_swap_b32 v104, v106
v_permlane32_swap_b32 v105, v107
v_permlane32_swap_b32 v60, v61
v_max_f32 v60, v60, v61
v_mov_b32 v61, v60
v_pk_add_f32 v[104:105], v[104:105], v[106:107]
v_cvt_pk_bf16_f32 v108, v104, v105
v_permlane16_swap_b32 v60, v61
v_max_f32 v60, v60, v61
v_mul_f32 v60, s84, v60
v_fma_f32 v116, v116, s84, -v60
v_pk_fma_f32 v[112:113], v[112:113], s[84:85], v[60:61] op_sel_hi:[1,1,0] neg_lo:[0,0,1] neg_hi:[0,0,1]
v_exp_f32 v116, v116
v_pk_fma_f32 v[114:115], v[114:115], s[84:85], v[60:61] op_sel_hi:[1,1,0] neg_lo:[0,0,1] neg_hi:[0,0,1]
v_exp_f32 v112, v112
v_cvt_pk_bf16_f32 v64, v116, v15
v_exp_f32 v113, v113
v_lshlrev_b32 v64, v14, v64
v_exp_f32 v114, v114
v_exp_f32 v115, v115
v_mfma_f32_16x16x16_bf16 v[68:71], v[108:109], v[64:65], 0
v_cvt_pk_bf16_f32 v62, v112, v113
v_cvt_pk_bf16_f32 v63, v114, v115
v_pk_add_f32 v[112:113], v[112:113], v[114:115]
v_add_f32 v60, v116, v112
v_mfma_f32_16x16x16_bf16 v[76:79], v[126:127], v[62:63], v[68:71]
v_mfma_f32_16x16x16_bf16 v[72:75], v[124:125], v[62:63], v[68:71]
v_add_f32 v60, v60, v113
s_nop 1
v_add_f32_dpp v60, v60, v60 row_ror:8 row_mask:0xf bank_mask:0xf
v_mov_b32 v61, v60
s_nop 1
v_permlane32_swap_b32 v60, v61
v_add_f32 v60, v60, v61
v_mov_b32 v61, v60
v_add_f32_dpp v72, v76, v72 row_ror:8 row_mask:0xf bank_mask:0xf
v_add_f32_dpp v73, v77, v73 row_ror:8 row_mask:0xf bank_mask:0xf
v_permlane16_swap_b32 v60, v61
v_add_f32 v60, v60, v61
v_rcp_f32 v60, v60
v_add_f32_dpp v74, v78, v74 row_ror:8 row_mask:0xf bank_mask:0xf
v_add_f32_dpp v75, v79, v75 row_ror:8 row_mask:0xf bank_mask:0xf
v_pk_mul_f32 v[72:73], v[72:73], v[60:61] op_sel_hi:[1,0]
v_pk_mul_f32 v[74:75], v[74:75], v[60:61] op_sel_hi:[1,0]
v_cvt_pk_bf16_f32 v120, v72, v73
v_cvt_pk_bf16_f32 v121, v74, v75
s_mov_b64 exec, s[74:75]
buffer_store_dwordx2 v[120:121], v4, s[8:11], s62 offen offset:0
s_mov_b64 exec, -1
s_cmp_ge_u32 s49, 61
s_cbranch_scc1 Lrec02_early
Lrec02_earlyd:
v_pk_mul_f32 v[112:113], v[14:15], v[14:15] op_sel:[1,1] op_sel_hi:[1,1]
v_pk_mul_f32 v[114:115], v[14:15], v[14:15] op_sel:[1,1] op_sel_hi:[1,1]
v_pk_mul_f32 v[116:117], v[14:15], v[14:15] op_sel:[1,1] op_sel_hi:[1,1]
v_pk_mul_f32 v[118:119], v[14:15], v[14:15] op_sel:[1,1] op_sel_hi:[1,1]
s_waitcnt vmcnt(1)
ds_read_b128 v[80:83], v12 offset:8192
ds_read_b128 v[84:87], v12 offset:9216
ds_read_b128 v[88:91], v12 offset:10240
ds_read_b128 v[92:95], v12 offset:11264
ds_read_b128 v[96:99], v12 offset:12288
ds_read_b128 v[100:103], v12 offset:13312
ds_read_b128 v[16:19], v12 offset:14336
ds_read_b128 v[20:23], v12 offset:15360
ds_read_b128 v[24:27], v6 offset:0
ds_read_b128 v[28:31], v6 offset:1024
ds_read_b128 v[32:35], v6 offset:2048
ds_read_b128 v[36:39], v6 offset:3072
ds_read_b128 v[40:43], v6 offset:4096
ds_read_b128 v[44:47], v6 offset:5120
s_waitcnt vmcnt(0)
buffer_load_dwordx4 v[48:51], v0, s[8:11], s60 offen offset:2048 sc1
buffer_load_dwordx4 v[52:55], v0, s[8:11], s60 offen offset:3072 sc1
buffer_load_dwordx4 v[56:59], v0, s[8:11], s61 offen offset:0 sc1
buffer_load_dwordx4 v[60:63], v0, s[8:11], s61 offen offset:1024 sc1
Lrec02_g_56w:
s_waitcnt vmcnt(3)
v_max3_u32 v104, v48, v49, v50
v_max_u32 v104, v51, v104
s_waitcnt vmcnt(2)
v_max3_u32 v104, v52, v53, v104
v_max3_u32 v104, v54, v55, v104
v_cmp_eq_u32 vcc, -1, v104
buffer_load_dwordx4 v[64:67], v0, s[8:11], s61 offen offset:2048 sc1
buffer_load_dwordx4 v[68:71], v0, s[8:11], s61 offen offset:3072 sc1
s_cbranch_vccnz Lrec02_r_55
Lrec02_g_56:
s_waitcnt lgkmcnt(12)
v_smfmac_f32_16x16x64_bf16 v[112:115], v[48:51], v[80:87], v13
ds_read_b128 v[80:83], v6 offset:6144
ds_read_b128 v[84:87], v6 offset:7168
s_waitcnt lgkmcnt(12)
v_smfmac_f32_16x16x64_bf16 v[116:119], v[48:51], v[88:95], v13
ds_read_b128 v[88:91], v6 offset:8192
ds_read_b128 v[92:95], v6 offset:9216
s_waitcnt lgkmcnt(12)
v_smfmac_f32_16x16x64_bf16 v[112:115], v[52:55], v[96:103], v13
ds_read_b128 v[96:99], v6 offset:10240
ds_read_b128 v[100:103], v6 offset:11264
s_waitcnt lgkmcnt(12)
v_smfmac_f32_16x16x64_bf16 v[116:119], v[52:55], v[16:23], v13
ds_read_b128 v[16:19], v6 offset:12288
ds_read_b128 v[20:23], v6 offset:13312
Lrec02_g_58w:
s_waitcnt vmcnt(3)
v_max3_u32 v104, v56, v57, v58
v_max_u32 v104, v59, v104
s_waitcnt vmcnt(2)
v_max3_u32 v104, v60, v61, v104
v_max3_u32 v104, v62, v63, v104
v_cmp_eq_u32 vcc, -1, v104
buffer_load_dwordx4 v[72:75], v0, s[8:11], s60 offen offset:0 sc1
buffer_load_dwordx4 v[76:79], v0, s[8:11], s60 offen offset:1024 sc1
s_cbranch_vccnz Lrec02_r_57
Lrec02_g_58:
s_waitcnt lgkmcnt(12)
v_smfmac_f32_16x16x64_bf16 v[112:115], v[56:59], v[24:31], v13
ds_read_b128 v[24:27], v6 offset:14336
ds_read_b128 v[28:31], v6 offset:15360
s_waitcnt lgkmcnt(12)
v_smfmac_f32_16x16x64_bf16 v[116:119], v[56:59], v[32:39], v13
ds_read_b128 v[32:35], v12 offset:0
ds_read_b128 v[36:39], v12 offset:1024
s_waitcnt lgkmcnt(12)
v_smfmac_f32_16x16x64_bf16 v[112:115], v[60:63], v[40:47], v13
ds_read_b128 v[40:43], v12 offset:2048
ds_read_b128 v[44:47], v12 offset:3072
s_waitcnt lgkmcnt(12)
v_smfmac_f32_16x16x64_bf16 v[116:119], v[60:63], v[80:87], v13
ds_read_b128 v[80:83], v12 offset:4096
ds_read_b128 v[84:87], v12 offset:5120
Lrec02_g_60w:
s_waitcnt vmcnt(3)
v_max3_u32 v104, v64, v65, v66
v_max_u32 v104, v67, v104
s_waitcnt vmcnt(2)
v_max3_u32 v104, v68, v69, v104
v_max3_u32 v104, v70, v71, v104
v_cmp_eq_u32 vcc, -1, v104
s_cbranch_vccnz Lrec02_r_59
Lrec02_g_60:
s_waitcnt lgkmcnt(12)
v_smfmac_f32_16x16x64_bf16 v[112:115], v[64:67], v[88:95], v13
ds_read_b128 v[88:91], v12 offset:6144
ds_read_b128 v[92:95], v12 offset:7168
s_waitcnt lgkmcnt(12)
v_smfmac_f32_16x16x64_bf16 v[116:119], v[64:67], v[96:103], v13
s_waitcnt lgkmcnt(10)
v_smfmac_f32_16x16x64_bf16 v[112:115], v[68:71], v[16:23], v13
s_waitcnt lgkmcnt(8)
v_smfmac_f32_16x16x64_bf16 v[116:119], v[68:71], v[24:31], v13
Lrec02_g_62w:
s_waitcnt vmcnt(1)
v_max3_u32 v104, v72, v73, v74
v_max_u32 v104, v75, v104
s_waitcnt vmcnt(0)
v_max3_u32 v104, v76, v77, v104
v_max3_u32 v104, v78, v79, v104
v_cmp_eq_u32 vcc, -1, v104
s_cbranch_vccnz Lrec02_r_61
Lrec02_g_62:
s_waitcnt lgkmcnt(6)
v_smfmac_f32_16x16x64_bf16 v[112:115], v[72:75], v[32:39], v13
s_waitcnt lgkmcnt(4)
v_smfmac_f32_16x16x64_bf16 v[116:119], v[72:75], v[40:47], v13
s_waitcnt lgkmcnt(2)
v_smfmac_f32_16x16x64_bf16 v[112:115], v[76:79], v[80:87], v13
s_waitcnt lgkmcnt(0)
v_smfmac_f32_16x16x64_bf16 v[116:119], v[76:79], v[88:95], v13
s_nop 7
v_permlane32_swap_b32 v112, v116
v_permlane32_swap_b32 v113, v117
v_permlane32_swap_b32 v114, v118
v_permlane32_swap_b32 v115, v119
v_pk_add_f32 v[112:113], v[112:113], v[116:117]
ds_write2_b32 v10, v112, v113 offset1:32
v_pk_add_f32 v[114:115], v[114:115], v[118:119]
ds_write2_b32 v10, v114, v115 offset0:64 offset1:96
s_waitcnt lgkmcnt(0)
s_barrier
v_mov_b32 v16, -1
v_mov_b32 v17, -1
buffer_store_dwordx2 v[16:17], v2, s[12:15], s46 offen offset:0
s_branch Lrec02_p1
Lrec02_kva:
s_sub_u32 s43, s43, 1
s_cbranch_scc1 Lrec02_kvxa
s_buffer_load_dword s82, s[4:7], s81 glc
s_buffer_load_dword s83, s[4:7], s81 offset:128 glc
s_waitcnt lgkmcnt(0)
s_min_i32 s82, s82, s83
s_cmp_lt_i32 s82, s51
s_cbranch_scc1 Lrec02_kva
s_branch Lrec02_kvda
Lrec02_kvxa:
s_mov_b32 s43, 0
s_branch Lrec02_kvda
Lrec02_kvb:
s_sub_u32 s43, s43, 1
s_cbranch_scc1 Lrec02_kvxb
s_buffer_load_dword s82, s[4:7], s81 glc
s_buffer_load_dword s83, s[4:7], s81 offset:128 glc
s_waitcnt lgkmcnt(0)
s_min_i32 s82, s82, s83
s_cmp_lt_i32 s82, s51
s_cbranch_scc1 Lrec02_kvb
s_branch Lrec02_kvdb
Lrec02_kvxb:
s_mov_b32 s43, 0
s_branch Lrec02_kvdb
Lrec02_r_47:
s_sub_u32 s43, s43, 1
s_cbranch_scc1 Lrec02_r_47x
buffer_load_dwordx4 v[48:51], v0, s[8:11], s56 offen offset:2048 sc1
buffer_load_dwordx4 v[52:55], v0, s[8:11], s56 offen offset:3072 sc1
buffer_load_dwordx4 v[56:59], v0, s[8:11], s56 offen offset:0 sc1
buffer_load_dwordx4 v[60:63], v0, s[8:11], s56 offen offset:1024 sc1
s_branch Lrec02_g_48w
Lrec02_r_47x:
s_mov_b32 s43, 0
s_branch Lrec02_g_48
Lrec02_r_49:
s_sub_u32 s43, s43, 1
s_cbranch_scc1 Lrec02_r_49x
buffer_load_dwordx4 v[56:59], v0, s[8:11], s56 offen offset:0 sc1
buffer_load_dwordx4 v[60:63], v0, s[8:11], s56 offen offset:1024 sc1
buffer_load_dwordx4 v[64:67], v0, s[8:11], s57 offen offset:2048 sc1
buffer_load_dwordx4 v[68:71], v0, s[8:11], s57 offen offset:3072 sc1
s_branch Lrec02_g_50w
Lrec02_r_49x:
s_mov_b32 s43, 0
s_branch Lrec02_g_50
Lrec02_r_51:
s_sub_u32 s43, s43, 1
s_cbranch_scc1 Lrec02_r_51x
buffer_load_dwordx4 v[64:67], v0, s[8:11], s57 offen offset:2048 sc1
buffer_load_dwordx4 v[68:71], v0, s[8:11], s57 offen offset:3072 sc1
buffer_load_dwordx4 v[72:75], v0, s[8:11], s57 offen offset:0 sc1
buffer_load_dwordx4 v[76:79], v0, s[8:11], s57 offen offset:1024 sc1
s_branch Lrec02_g_52w
Lrec02_r_51x:
s_mov_b32 s43, 0
s_branch Lrec02_g_52
Lrec02_r_53:
s_sub_u32 s43, s43, 1
s_cbranch_scc1 Lrec02_r_53x
buffer_load_dwordx4 v[72:75], v0, s[8:11], s57 offen offset:0 sc1
buffer_load_dwordx4 v[76:79], v0, s[8:11], s57 offen offset:1024 sc1
s_branch Lrec02_g_54w
Lrec02_r_53x:
s_mov_b32 s43, 0
s_branch Lrec02_g_54
Lrec02_ps:
buffer_load_dwordx4 v[88:91], v0, s[8:11], s64 offen sc1
buffer_load_dword v92, v3, s[8:11], s64 offen offset:1024 sc1
s_waitcnt vmcnt(2)
v_max3_u32 v53, v54, v55, v56
v_max3_u32 v53, v57, v58, v53
v_cmp_eq_u32 vcc, -1, v53
s_cbranch_vccz Lrec02_psq
buffer_load_dwordx4 v[54:57], v0, s[8:11], s64 offen sc1
buffer_load_dword v58, v3, s[8:11], s64 offen offset:1024 sc1
s_waitcnt vmcnt(2)
v_max3_u32 v53, v88, v89, v90
v_max3_u32 v53, v91, v92, v53
v_cmp_eq_u32 vcc, -1, v53
s_cbranch_vccz Lrec02_ps1
s_sub_u32 s43, s43, 1
s_cbranch_scc0 Lrec02_ps
s_mov_b32 s43, 0
s_branch Lrec02_ps1
Lrec02_psq:
v_pk_add_f32 v[112:113], v[112:113], v[54:55]
v_pk_add_f32 v[114:115], v[114:115], v[56:57]
v_add_f32 v116, v116, v58
s_branch Lrec02_ps2
Lrec02_early:
s_waitcnt lgkmcnt(0)
buffer_store_dword v108, v7, s[4:7], s68 offen sc1
s_branch Lrec02_earlyd
Lrec02_r_55:
s_sub_u32 s43, s43, 1
s_cbranch_scc1 Lrec02_r_55x
buffer_load_dwordx4 v[48:51], v0, s[8:11], s60 offen offset:2048 sc1
buffer_load_dwordx4 v[52:55], v0, s[8:11], s60 offen offset:3072 sc1
buffer_load_dwordx4 v[56:59], v0, s[8:11], s61 offen offset:0 sc1
buffer_load_dwordx4 v[60:63], v0, s[8:11], s61 offen offset:1024 sc1
s_branch Lrec02_g_56w
Lrec02_r_55x:
s_mov_b32 s43, 0
s_branch Lrec02_g_56
Lrec02_r_57:
s_sub_u32 s43, s43, 1
s_cbranch_scc1 Lrec02_r_57x
buffer_load_dwordx4 v[56:59], v0, s[8:11], s61 offen offset:0 sc1
buffer_load_dwordx4 v[60:63], v0, s[8:11], s61 offen offset:1024 sc1
buffer_load_dwordx4 v[64:67], v0, s[8:11], s61 offen offset:2048 sc1
buffer_load_dwordx4 v[68:71], v0, s[8:11], s61 offen offset:3072 sc1
s_branch Lrec02_g_58w
Lrec02_r_57x:
s_mov_b32 s43, 0
s_branch Lrec02_g_58
Lrec02_r_59:
s_sub_u32 s43, s43, 1
s_cbranch_scc1 Lrec02_r_59x
buffer_load_dwordx4 v[64:67], v0, s[8:11], s61 offen offset:2048 sc1
buffer_load_dwordx4 v[68:71], v0, s[8:11], s61 offen offset:3072 sc1
buffer_load_dwordx4 v[72:75], v0, s[8:11], s60 offen offset:0 sc1
buffer_load_dwordx4 v[76:79], v0, s[8:11], s60 offen offset:1024 sc1
s_branch Lrec02_g_60w
Lrec02_r_59x:
s_mov_b32 s43, 0
s_branch Lrec02_g_60
Lrec02_r_61:
s_sub_u32 s43, s43, 1
s_cbranch_scc1 Lrec02_r_61x
buffer_load_dwordx4 v[72:75], v0, s[8:11], s60 offen offset:0 sc1
buffer_load_dwordx4 v[76:79], v0, s[8:11], s60 offen offset:1024 sc1
s_branch Lrec02_g_62w
Lrec02_r_61x:
s_mov_b32 s43, 0
s_branch Lrec02_g_62
Lrec02_last:
s_nop 4
v_permlane32_swap_b32 v104, v106
v_permlane32_swap_b32 v105, v107
v_pk_add_f32 v[104:105], v[104:105], v[106:107]
v_cvt_pk_bf16_f32 v108, v104, v105
v_mov_b32 v109, 0
s_waitcnt lgkmcnt(0)
buffer_store_dword v108, v7, s[4:7], s68 offen sc1
s_branch Lrec_end
Lrec03_in:
ds_read_b128 v[80:83], v5 offset:24576
ds_read_b128 v[84:87], v5 offset:26624
ds_read_b128 v[88:91], v5 offset:24832
ds_read_b128 v[92:95], v5 offset:26880
ds_read_b128 v[124:127], v0 offset:31744
s_waitcnt lgkmcnt(0)
s_barrier
s_add_u32 s81, s81, 8192
s_cmp_eq_u32 s81, s71
s_cselect_b32 s51, 24576, 0
s_sub_u32 s81, s81, s51
s_cmp_eq_u32 s49, 63
s_cselect_b32 s51, -2, s49
s_add_u32 s51, s51, 2
s_min_i32 s82, s82, s83
s_cmp_lt_i32 s82, s51
s_cbranch_scc1 Lrec03_kva
Lrec03_kvda:
s_add_u32 s45, s81, 8192
s_cmp_eq_u32 s45, s71
s_cselect_b32 s51, 24576, 0
s_sub_u32 s45, s45, s51
s_mov_b32 m0, 27648
s_add_u32 s65, s65, 0x4000
buffer_load_dwordx4 v0, s[4:7], s65 offen sc1 lds
s_mov_b32 m0, 31744
s_add_u32 s66, s66, 0x4000
buffer_load_dwordx4 v5, s[4:7], s66 offen sc1 lds
v_pk_mul_f32 v[96:97], v[14:15], v[14:15] op_sel:[1,1] op_sel_hi:[1,1]
v_pk_mul_f32 v[98:99], v[14:15], v[14:15] op_sel:[1,1] op_sel_hi:[1,1]
v_pk_mul_f32 v[100:101], v[14:15], v[14:15] op_sel:[1,1] op_sel_hi:[1,1]
v_pk_mul_f32 v[102:103], v[14:15], v[14:15] op_sel:[1,1] op_sel_hi:[1,1]
ds_read_b128 v[16:19], v0 offset:0
ds_read_b128 v[20:23], v0 offset:1024
ds_read_b128 v[24:27], v0 offset:2048
s_waitcnt lgkmcnt(2)
v_smfmac_f32_16x16x64_bf16 v[96:99], v[16:19], a[0:7], v13
ds_read_b128 v[28:31], v0 offset:3072
v_smfmac_f32_16x16x64_bf16 v[100:103], v[16:19], a[128:135], v13
s_waitcnt lgkmcnt(1)
v_smfmac_f32_16x16x64_bf16 v[96:99], v[20:23], a[8:15], v13
ds_read_b128 v[32:35], v0 offset:4096
v_smfmac_f32_16x16x64_bf16 v[100:103], v[20:23], a[136:143], v13
v_smfmac_f32_16x16x64_bf16 v[96:99], v[24:27], a[16:23], v13
ds_read_b128 v[36:39], v0 offset:5120
v_smfmac_f32_16x16x64_bf16 v[100:103], v[24:27], a[144:151], v13
s_waitcnt lgkmcnt(1)
v_smfmac_f32_16x16x64_bf16 v[96:99], v[28:31], a[24:31], v13
ds_read_b128 v[40:43], v0 offset:6144
v_smfmac_f32_16x16x64_bf16 v[100:103], v[28:31], a[152:159], v13
v_smfmac_f32_16x16x64_bf16 v[96:99], v[32:35], a[32:39], v13
ds_read_b128 v[44:47], v0 offset:7168
v_smfmac_f32_16x16x64_bf16 v[100:103], v[32:35], a[160:167], v13
s_waitcnt lgkmcnt(1)
v_smfmac_f32_16x16x64_bf16 v[96:99], v[36:39], a[40:47], v13
ds_read_b128 v[48:51], v0 offset:8192
v_smfmac_f32_16x16x64_bf16 v[100:103], v[36:39], a[168:175], v13
v_smfmac_f32_16x16x64_bf16 v[96:99], v[40:43], a[48:55], v13
ds_read_b128 v[52:55], v0 offset:9216
v_smfmac_f32_16x16x64_bf16 v[100:103], v[40:43], a[176:183], v13
s_waitcnt lgkmcnt(1)
v_smfmac_f32_16x16x64_bf16 v[96:99], v[44:47], a[56:63], v13
ds_read_b128 v[56:59], v0 offset:10240
v_smfmac_f32_16x16x64_bf16 v[100:103], v[44:47], a[184:191], v13
s_branch Lrec03_p2
.p2align 10
Lrec03_p1:
s_add_u32 s49, s49, 1
v_mov_b32 v116, -1
v_mov_b32 v117, -1
s_cmp_le_u32 s49, 61
s_subb_u32 s50, s49, 0
v_mov_b32 v112, s50
s_add_u32 s81, s81, 8192
s_cmp_eq_u32 s81, s71
s_cselect_b32 s51, 24576, 0
s_sub_u32 s81, s81, s51
s_cmp_eq_u32 s49, 63
s_cselect_b32 s51, -2, s49
s_add_u32 s51, s51, 2
s_min_i32 s82, s82, s83
s_cmp_lt_i32 s82, s51
s_cbranch_scc1 Lrec03_kvb
Lrec03_kvdb:
s_add_u32 s45, s81, 8192
s_cmp_eq_u32 s45, s71
s_cselect_b32 s51, 24576, 0
s_sub_u32 s45, s45, s51
s_mov_b32 m0, 0
ds_read_b128 v[80:83], v5 offset:24576
ds_read_b128 v[84:87], v5 offset:26624
ds_read_b128 v[88:91], v5 offset:24832
ds_read_b128 v[92:95], v5 offset:26880
ds_read_b128 v[124:127], v0 offset:31744
s_barrier
buffer_load_dwordx4 v[48:51], v0, s[8:11], s56 offen offset:3072 sc1
buffer_load_dwordx4 v[52:55], v0, s[8:11], s56 offen offset:0 sc1
buffer_load_dwordx4 v[56:59], v0, s[8:11], s56 offen offset:1024 sc1
buffer_load_dwordx4 v[60:63], v0, s[8:11], s56 offen offset:2048 sc1
Lrec03_g_64w:
s_waitcnt vmcnt(3)
v_max3_u32 v122, v48, v49, v50
v_max_u32 v122, v51, v122
s_waitcnt vmcnt(2)
v_max3_u32 v122, v52, v53, v122
v_max3_u32 v122, v54, v55, v122
v_cmp_eq_u32 vcc, -1, v122
buffer_load_dwordx4 v[64:67], v0, s[8:11], s57 offen offset:3072 sc1
buffer_load_dwordx4 v[68:71], v0, s[8:11], s57 offen offset:0 sc1
s_cbranch_vccnz Lrec03_r_63
Lrec03_g_64:
v_lshlrev_b32 v16, 16, v48
v_and_b32 v17, 0xffff0000, v48
v_lshlrev_b32 v18, 16, v49
v_and_b32 v19, 0xffff0000, v49
v_lshlrev_b32 v20, 16, v50
v_and_b32 v21, 0xffff0000, v50
v_lshlrev_b32 v22, 16, v51
v_and_b32 v23, 0xffff0000, v51
v_lshlrev_b32 v24, 16, v52
v_and_b32 v25, 0xffff0000, v52
v_lshlrev_b32 v26, 16, v53
v_and_b32 v27, 0xffff0000, v53
v_lshlrev_b32 v28, 16, v54
v_and_b32 v29, 0xffff0000, v54
v_lshlrev_b32 v30, 16, v55
v_and_b32 v31, 0xffff0000, v55
Lrec03_g_66w:
s_waitcnt vmcnt(3)
v_max3_u32 v122, v56, v57, v58
v_max_u32 v122, v59, v122
s_waitcnt vmcnt(2)
v_max3_u32 v122, v60, v61, v122
v_max3_u32 v122, v62, v63, v122
v_cmp_eq_u32 vcc, -1, v122
buffer_load_dwordx4 v[72:75], v0, s[8:11], s57 offen offset:1024 sc1
buffer_load_dwordx4 v[76:79], v0, s[8:11], s57 offen offset:2048 sc1
s_cbranch_vccnz Lrec03_r_65
Lrec03_g_66:
v_lshlrev_b32 v32, 16, v56
v_and_b32 v33, 0xffff0000, v56
v_lshlrev_b32 v34, 16, v57
v_and_b32 v35, 0xffff0000, v57
v_lshlrev_b32 v36, 16, v58
v_and_b32 v37, 0xffff0000, v58
v_lshlrev_b32 v38, 16, v59
v_and_b32 v39, 0xffff0000, v59
v_lshlrev_b32 v40, 16, v60
v_and_b32 v41, 0xffff0000, v60
v_lshlrev_b32 v42, 16, v61
v_and_b32 v43, 0xffff0000, v61
v_lshlrev_b32 v44, 16, v62
v_and_b32 v45, 0xffff0000, v62
v_lshlrev_b32 v46, 16, v63
v_and_b32 v47, 0xffff0000, v63
Lrec03_g_68w:
s_waitcnt vmcnt(3)
v_max3_u32 v122, v64, v65, v66
v_max_u32 v122, v67, v122
s_waitcnt vmcnt(2)
v_max3_u32 v122, v68, v69, v122
v_max3_u32 v122, v70, v71, v122
v_cmp_eq_u32 vcc, -1, v122
s_cbranch_vccnz Lrec03_r_67
Lrec03_g_68:
v_dot2_f32_bf16 v16, v64, s69, v16
v_dot2_f32_bf16 v17, v64, s70, v17
v_dot2_f32_bf16 v18, v65, s69, v18
v_dot2_f32_bf16 v19, v65, s70, v19
v_dot2_f32_bf16 v20, v66, s69, v20
v_dot2_f32_bf16 v21, v66, s70, v21
v_dot2_f32_bf16 v22, v67, s69, v22
v_dot2_f32_bf16 v23, v67, s70, v23
v_cvt_pk_bf16_f32 v48, v16, v17
v_cvt_pk_bf16_f32 v49, v18, v19
v_cvt_pk_bf16_f32 v50, v20, v21
v_cvt_pk_bf16_f32 v51, v22, v23
ds_write_addtid_b32 v48 offset:15360
ds_write_addtid_b32 v49 offset:15616
ds_write_addtid_b32 v50 offset:15872
ds_write_addtid_b32 v51 offset:16128
v_dot2_f32_bf16 v24, v68, s69, v24
v_dot2_f32_bf16 v25, v68, s70, v25
v_dot2_f32_bf16 v26, v69, s69, v26
v_dot2_f32_bf16 v27, v69, s70, v27
v_dot2_f32_bf16 v28, v70, s69, v28
v_dot2_f32_bf16 v29, v70, s70, v29
v_dot2_f32_bf16 v30, v71, s69, v30
v_dot2_f32_bf16 v31, v71, s70, v31
v_cvt_pk_bf16_f32 v52, v24, v25
v_cvt_pk_bf16_f32 v53, v26, v27
v_cvt_pk_bf16_f32 v54, v28, v29
v_cvt_pk_bf16_f32 v55, v30, v31
ds_write_addtid_b32 v52 offset:12288
ds_write_addtid_b32 v53 offset:12544
ds_write_addtid_b32 v54 offset:12800
ds_write_addtid_b32 v55 offset:13056
Lrec03_g_70w:
s_waitcnt vmcnt(1)
v_max3_u32 v122, v72, v73, v74
v_max_u32 v122, v75, v122
s_waitcnt vmcnt(0)
v_max3_u32 v122, v76, v77, v122
v_max3_u32 v122, v78, v79, v122
v_cmp_eq_u32 vcc, -1, v122
s_cbranch_vccnz Lrec03_r_69
Lrec03_g_70:
v_dot2_f32_bf16 v32, v72, s69, v32
v_dot2_f32_bf16 v33, v72, s70, v33
v_dot2_f32_bf16 v34, v73, s69, v34
v_dot2_f32_bf16 v35, v73, s70, v35
v_dot2_f32_bf16 v36, v74, s69, v36
v_dot2_f32_bf16 v37, v74, s70, v37
v_dot2_f32_bf16 v38, v75, s69, v38
v_dot2_f32_bf16 v39, v75, s70, v39
v_cvt_pk_bf16_f32 v56, v32, v33
v_cvt_pk_bf16_f32 v57, v34, v35
v_cvt_pk_bf16_f32 v58, v36, v37
v_cvt_pk_bf16_f32 v59, v38, v39
ds_write_addtid_b32 v56 offset:13312
ds_write_addtid_b32 v57 offset:13568
ds_write_addtid_b32 v58 offset:13824
ds_write_addtid_b32 v59 offset:14080
v_dot2_f32_bf16 v40, v76, s69, v40
v_dot2_f32_bf16 v41, v76, s70, v41
v_dot2_f32_bf16 v42, v77, s69, v42
v_dot2_f32_bf16 v43, v77, s70, v43
v_dot2_f32_bf16 v44, v78, s69, v44
v_dot2_f32_bf16 v45, v78, s70, v45
v_dot2_f32_bf16 v46, v79, s69, v46
v_dot2_f32_bf16 v47, v79, s70, v47
v_cvt_pk_bf16_f32 v60, v40, v41
v_cvt_pk_bf16_f32 v61, v42, v43
v_cvt_pk_bf16_f32 v62, v44, v45
v_cvt_pk_bf16_f32 v63, v46, v47
ds_write_addtid_b32 v60 offset:14336
ds_write_addtid_b32 v61 offset:14592
ds_write_addtid_b32 v62 offset:14848
ds_write_addtid_b32 v63 offset:15104
v_pk_mul_f32 v[96:97], v[14:15], v[14:15] op_sel:[1,1] op_sel_hi:[1,1]
v_pk_mul_f32 v[98:99], v[14:15], v[14:15] op_sel:[1,1] op_sel_hi:[1,1]
v_pk_mul_f32 v[100:101], v[14:15], v[14:15] op_sel:[1,1] op_sel_hi:[1,1]
v_pk_mul_f32 v[102:103], v[14:15], v[14:15] op_sel:[1,1] op_sel_hi:[1,1]
s_waitcnt lgkmcnt(0)
s_barrier
ds_read_b128 v[16:19], v0 offset:0
ds_read_b128 v[20:23], v0 offset:1024
ds_read_b128 v[24:27], v0 offset:2048
s_mov_b32 m0, 27648
s_add_u32 s65, s65, 0x4000
buffer_load_dwordx4 v0, s[4:7], s65 offen sc1 lds
s_waitcnt lgkmcnt(2)
v_smfmac_f32_16x16x64_bf16 v[96:99], v[16:19], a[0:7], v13
ds_read_b128 v[28:31], v0 offset:3072
v_smfmac_f32_16x16x64_bf16 v[100:103], v[16:19], a[128:135], v13
s_mov_b32 m0, 31744
s_add_u32 s66, s66, 0x4000
buffer_load_dwordx4 v5, s[4:7], s66 offen sc1 lds
s_waitcnt lgkmcnt(1)
v_smfmac_f32_16x16x64_bf16 v[96:99], v[20:23], a[8:15], v13
ds_read_b128 v[32:35], v0 offset:4096
v_smfmac_f32_16x16x64_bf16 v[100:103], v[20:23], a[136:143], v13
buffer_store_dword v108, v7, s[4:7], s68 offen sc1
v_smfmac_f32_16x16x64_bf16 v[96:99], v[24:27], a[16:23], v13
ds_read_b128 v[36:39], v0 offset:5120
v_smfmac_f32_16x16x64_bf16 v[100:103], v[24:27], a[144:151], v13
buffer_store_dwordx2 v[116:117], v2, s[12:15], s59 offen sc1
s_waitcnt lgkmcnt(1)
v_smfmac_f32_16x16x64_bf16 v[96:99], v[28:31], a[24:31], v13
ds_read_b128 v[40:43], v0 offset:6144
v_smfmac_f32_16x16x64_bf16 v[100:103], v[28:31], a[152:159], v13
s_mov_b64 exec, 1
buffer_store_dword v112, v15, s[4:7], s80 offen sc1
s_mov_b64 exec, -1
v_smfmac_f32_16x16x64_bf16 v[96:99], v[32:35], a[32:39], v13
ds_read_b128 v[44:47], v0 offset:7168
v_smfmac_f32_16x16x64_bf16 v[100:103], v[32:35], a[160:167], v13
s_waitcnt lgkmcnt(1)
v_smfmac_f32_16x16x64_bf16 v[96:99], v[36:39], a[40:47], v13
ds_read_b128 v[48:51], v0 offset:8192
v_smfmac_f32_16x16x64_bf16 v[100:103], v[36:39], a[168:175], v13
v_smfmac_f32_16x16x64_bf16 v[96:99], v[40:43], a[48:55], v13
ds_read_b128 v[52:55], v0 offset:9216
v_smfmac_f32_16x16x64_bf16 v[100:103], v[40:43], a[176:183], v13
s_waitcnt lgkmcnt(1)
v_smfmac_f32_16x16x64_bf16 v[96:99], v[44:47], a[56:63], v13
ds_read_b128 v[56:59], v0 offset:10240
v_smfmac_f32_16x16x64_bf16 v[100:103], v[44:47], a[184:191], v13
Lrec03_p2:
v_smfmac_f32_16x16x64_bf16 v[96:99], v[48:51], a[64:71], v13
ds_read_b128 v[60:63], v0 offset:11264
v_smfmac_f32_16x16x64_bf16 v[100:103], v[48:51], a[192:199], v13
s_add_u32 s72, s72, 524288
s_waitcnt lgkmcnt(1)
v_smfmac_f32_16x16x64_bf16 v[96:99], v[52:55], a[72:79], v13
ds_read_b128 v[64:67], v0 offset:12288
v_smfmac_f32_16x16x64_bf16 v[100:103], v[52:55], a[200:207], v13
s_and_b32 s72, s72, 1572864
v_smfmac_f32_16x16x64_bf16 v[96:99], v[56:59], a[80:87], v13
ds_read_b128 v[68:71], v0 offset:13312
v_smfmac_f32_16x16x64_bf16 v[100:103], v[56:59], a[208:215], v13
s_or_b32 s8, s73, s72
s_waitcnt lgkmcnt(1)
v_smfmac_f32_16x16x64_bf16 v[96:99], v[60:63], a[88:95], v13
ds_read_b128 v[72:75], v0 offset:14336
v_smfmac_f32_16x16x64_bf16 v[100:103], v[60:63], a[216:223], v13
s_xor_b32 s12, s8, 1048576
v_smfmac_f32_16x16x64_bf16 v[96:99], v[64:67], a[96:103], v13
ds_read_b128 v[76:79], v0 offset:15360
v_smfmac_f32_16x16x64_bf16 v[100:103], v[64:67], a[224:231], v13
s_and_b32 s50, s49, 3
s_cselect_b32 s50, 0, 0x2000
s_waitcnt lgkmcnt(1)
v_smfmac_f32_16x16x64_bf16 v[96:99], v[68:71], a[104:111], v13
v_smfmac_f32_16x16x64_bf16 v[100:103], v[68:71], a[232:239], v13
s_add_u32 s50, s50, 0x800
v_smfmac_f32_16x16x64_bf16 v[96:99], v[72:75], a[112:119], v13
v_smfmac_f32_16x16x64_bf16 v[100:103], v[72:75], a[240:247], v13
s_add_u32 s68, s68, s50
s_waitcnt lgkmcnt(0)
v_smfmac_f32_16x16x64_bf16 v[96:99], v[76:79], a[120:127], v13
v_smfmac_f32_16x16x64_bf16 v[100:103], v[76:79], a[248:255], v13
s_add_u32 s67, s67, s50
s_nop 6
v_permlane32_swap_b32 v96, v100
v_permlane32_swap_b32 v97, v101
v_permlane32_swap_b32 v98, v102
v_permlane32_swap_b32 v99, v103
v_pk_add_f32 v[96:97], v[96:97], v[100:101]
v_pk_add_f32 v[98:99], v[98:99], v[102:103]
v_cvt_pk_bf16_f32 v96, v96, v97
v_cvt_pk_bf16_f32 v97, v98, v99
ds_write_b64 v8, v[96:97]
s_waitcnt lgkmcnt(0)
s_barrier
ds_read_b64_tr_b16 v[96:97], v9 offset:0
ds_read_b64_tr_b16 v[98:99], v9 offset:64
ds_read_b64_tr_b16 v[104:105], v9 offset:1152
ds_read_b64_tr_b16 v[106:107], v9 offset:1216
ds_read_b64_tr_b16 v[100:101], v9 offset:256
ds_read_b64_tr_b16 v[102:103], v9 offset:320
ds_read_b64_tr_b16 v[108:109], v9 offset:1408
ds_read_b64_tr_b16 v[110:111], v9 offset:1472
s_waitcnt lgkmcnt(4)
v_mfma_f32_16x16x32_bf16 v[120:123], v[104:107], v[96:99], 0
s_waitcnt lgkmcnt(0)
v_mfma_f32_16x16x32_bf16 v[120:123], v[108:111], v[100:103], v[120:123]
v_mfma_f32_16x16x32_bf16 v[112:115], v[80:83], v[96:99], 0
v_mfma_f32_16x16x32_bf16 v[112:115], v[84:87], v[100:103], v[112:115]
s_mov_b32 exec_lo, 0x0
s_mov_b32 exec_hi, 0xff00ff
s_nop 3
buffer_store_dword v122, v3, s[8:11], s63 offen offset:1024
s_lshl_b64 exec, exec, 8
buffer_store_dword v123, v3, s[8:11], s63 offen offset:1024
s_mov_b64 exec, -1
v_mfma_f32_16x16x32_bf16 v[116:119], v[88:91], v[96:99], 0
v_mfma_f32_16x16x32_bf16 v[116:119], v[92:95], v[100:103], v[116:119]
v_pk_mul_f32 v[104:105], v[14:15], v[14:15] op_sel:[1,1] op_sel_hi:[1,1]
v_pk_mul_f32 v[106:107], v[14:15], v[14:15] op_sel:[1,1] op_sel_hi:[1,1]
s_nop 1
v_smfmac_f32_16x16x64_bf16 v[104:107], v[16:19], v[128:135], v13
s_buffer_load_dword s82, s[4:7], s45 glc
v_smfmac_f32_16x16x64_bf16 v[104:107], v[20:23], v[136:143], v13
s_buffer_load_dword s83, s[4:7], s45 offset:128 glc
v_smfmac_f32_16x16x64_bf16 v[104:107], v[24:27], v[144:151], v13
v_cndmask_b32 v112, v112, v116, s[76:77]
v_smfmac_f32_16x16x64_bf16 v[104:107], v[28:31], v[152:159], v13
v_cndmask_b32 v113, v113, v117, s[76:77]
v_smfmac_f32_16x16x64_bf16 v[104:107], v[32:35], v[160:167], v13
v_cndmask_b32 v114, v114, v118, s[76:77]
v_smfmac_f32_16x16x64_bf16 v[104:107], v[36:39], v[168:175], v13
v_cndmask_b32 v115, v115, v119, s[76:77]
buffer_load_dwordx4 v[88:91], v0, s[8:11], s64 offen sc1
buffer_load_dword v92, v3, s[8:11], s64 offen offset:1024 sc1
v_smfmac_f32_16x16x64_bf16 v[104:107], v[40:43], v[176:183], v13
v_cndmask_b32 v120, v120, v122, s[78:79]
v_smfmac_f32_16x16x64_bf16 v[104:107], v[44:47], v[184:191], v13
v_cndmask_b32 v121, v121, v123, s[78:79]
v_smfmac_f32_16x16x64_bf16 v[104:107], v[48:51], v[192:199], v13
v_cndmask_b32 v116, v120, v121, s[76:77]
v_smfmac_f32_16x16x64_bf16 v[104:107], v[52:55], v[200:207], v13
s_cmp_eq_u32 s49, 63
v_smfmac_f32_16x16x64_bf16 v[104:107], v[56:59], v[208:215], v13
v_smfmac_f32_16x16x64_bf16 v[104:107], v[60:63], v[216:223], v13
v_smfmac_f32_16x16x64_bf16 v[104:107], v[64:67], v[224:231], v13
v_smfmac_f32_16x16x64_bf16 v[104:107], v[68:71], v[232:239], v13
v_smfmac_f32_16x16x64_bf16 v[104:107], v[72:75], v[240:247], v13
v_smfmac_f32_16x16x64_bf16 v[104:107], v[76:79], v[248:255], v13
buffer_load_dwordx4 v[54:57], v0, s[8:11], s64 offen sc1
buffer_load_dword v58, v3, s[8:11], s64 offen offset:1024 sc1
s_cbranch_scc1 Lrec03_last
s_waitcnt vmcnt(2)
v_max3_u32 v53, v88, v89, v90
v_max3_u32 v53, v91, v92, v53
v_cmp_eq_u32 vcc, -1, v53
s_cbranch_vccnz Lrec03_ps
Lrec03_ps1:
v_pk_add_f32 v[112:113], v[112:113], v[88:89]
v_pk_add_f32 v[114:115], v[114:115], v[90:91]
v_add_f32 v116, v116, v92
Lrec03_ps2:
v_max3_f32 v60, v112, v113, v114
v_max3_f32 v60, v115, v116, v60
v_mov_b32 v65, 0
v_mov_b32 v109, 0
v_max_f32_dpp v60, v60, v60 row_ror:8 row_mask:0xf bank_mask:0xf
v_mov_b32 v61, v60
v_permlane32_swap_b32 v104, v106
v_permlane32_swap_b32 v105, v107
v_permlane32_swap_b32 v60, v61
v_max_f32 v60, v60, v61
v_mov_b32 v61, v60
v_pk_add_f32 v[104:105], v[104:105], v[106:107]
v_cvt_pk_bf16_f32 v108, v104, v105
v_permlane16_swap_b32 v60, v61
v_max_f32 v60, v60, v61
v_mul_f32 v60, s84, v60
v_fma_f32 v116, v116, s84, -v60
v_pk_fma_f32 v[112:113], v[112:113], s[84:85], v[60:61] op_sel_hi:[1,1,0] neg_lo:[0,0,1] neg_hi:[0,0,1]
v_exp_f32 v116, v116
v_pk_fma_f32 v[114:115], v[114:115], s[84:85], v[60:61] op_sel_hi:[1,1,0] neg_lo:[0,0,1] neg_hi:[0,0,1]
v_exp_f32 v112, v112
v_cvt_pk_bf16_f32 v64, v116, v15
v_exp_f32 v113, v113
v_lshlrev_b32 v64, v14, v64
v_exp_f32 v114, v114
v_exp_f32 v115, v115
v_mfma_f32_16x16x16_bf16 v[68:71], v[108:109], v[64:65], 0
v_cvt_pk_bf16_f32 v62, v112, v113
v_cvt_pk_bf16_f32 v63, v114, v115
v_pk_add_f32 v[112:113], v[112:113], v[114:115]
v_add_f32 v60, v116, v112
v_mfma_f32_16x16x16_bf16 v[76:79], v[126:127], v[62:63], v[68:71]
v_mfma_f32_16x16x16_bf16 v[72:75], v[124:125], v[62:63], v[68:71]
v_add_f32 v60, v60, v113
s_nop 1
v_add_f32_dpp v60, v60, v60 row_ror:8 row_mask:0xf bank_mask:0xf
v_mov_b32 v61, v60
s_nop 1
v_permlane32_swap_b32 v60, v61
v_add_f32 v60, v60, v61
v_mov_b32 v61, v60
v_add_f32_dpp v72, v76, v72 row_ror:8 row_mask:0xf bank_mask:0xf
v_add_f32_dpp v73, v77, v73 row_ror:8 row_mask:0xf bank_mask:0xf
v_permlane16_swap_b32 v60, v61
v_add_f32 v60, v60, v61
v_rcp_f32 v60, v60
v_add_f32_dpp v74, v78, v74 row_ror:8 row_mask:0xf bank_mask:0xf
v_add_f32_dpp v75, v79, v75 row_ror:8 row_mask:0xf bank_mask:0xf
v_pk_mul_f32 v[72:73], v[72:73], v[60:61] op_sel_hi:[1,0]
v_pk_mul_f32 v[74:75], v[74:75], v[60:61] op_sel_hi:[1,0]
v_cvt_pk_bf16_f32 v120, v72, v73
v_cvt_pk_bf16_f32 v121, v74, v75
s_mov_b64 exec, s[74:75]
buffer_store_dwordx2 v[120:121], v4, s[8:11], s62 offen offset:0
s_mov_b64 exec, -1
s_cmp_ge_u32 s49, 61
s_cbranch_scc1 Lrec03_early
Lrec03_earlyd:
v_pk_mul_f32 v[112:113], v[14:15], v[14:15] op_sel:[1,1] op_sel_hi:[1,1]
v_pk_mul_f32 v[114:115], v[14:15], v[14:15] op_sel:[1,1] op_sel_hi:[1,1]
v_pk_mul_f32 v[116:117], v[14:15], v[14:15] op_sel:[1,1] op_sel_hi:[1,1]
v_pk_mul_f32 v[118:119], v[14:15], v[14:15] op_sel:[1,1] op_sel_hi:[1,1]
s_waitcnt vmcnt(1)
ds_read_b128 v[80:83], v12 offset:12288
ds_read_b128 v[84:87], v12 offset:13312
ds_read_b128 v[88:91], v12 offset:14336
ds_read_b128 v[92:95], v12 offset:15360
ds_read_b128 v[96:99], v6 offset:0
ds_read_b128 v[100:103], v6 offset:1024
ds_read_b128 v[16:19], v6 offset:2048
ds_read_b128 v[20:23], v6 offset:3072
ds_read_b128 v[24:27], v6 offset:4096
ds_read_b128 v[28:31], v6 offset:5120
ds_read_b128 v[32:35], v6 offset:6144
ds_read_b128 v[36:39], v6 offset:7168
ds_read_b128 v[40:43], v6 offset:8192
ds_read_b128 v[44:47], v6 offset:9216
s_waitcnt vmcnt(0)
buffer_load_dwordx4 v[48:51], v0, s[8:11], s60 offen offset:3072 sc1
buffer_load_dwordx4 v[52:55], v0, s[8:11], s61 offen offset:0 sc1
buffer_load_dwordx4 v[56:59], v0, s[8:11], s61 offen offset:1024 sc1
buffer_load_dwordx4 v[60:63], v0, s[8:11], s61 offen offset:2048 sc1
Lrec03_g_72w:
s_waitcnt vmcnt(3)
v_max3_u32 v104, v48, v49, v50
v_max_u32 v104, v51, v104
s_waitcnt vmcnt(2)
v_max3_u32 v104, v52, v53, v104
v_max3_u32 v104, v54, v55, v104
v_cmp_eq_u32 vcc, -1, v104
buffer_load_dwordx4 v[64:67], v0, s[8:11], s61 offen offset:3072 sc1
buffer_load_dwordx4 v[68:71], v0, s[8:11], s60 offen offset:0 sc1
s_cbranch_vccnz Lrec03_r_71
Lrec03_g_72:
s_waitcnt lgkmcnt(12)
v_smfmac_f32_16x16x64_bf16 v[112:115], v[48:51], v[80:87], v13
ds_read_b128 v[80:83], v6 offset:10240
ds_read_b128 v[84:87], v6 offset:11264
s_waitcnt lgkmcnt(12)
v_smfmac_f32_16x16x64_bf16 v[116:119], v[48:51], v[88:95], v13
ds_read_b128 v[88:91], v6 offset:12288
ds_read_b128 v[92:95], v6 offset:13312
s_waitcnt lgkmcnt(12)
v_smfmac_f32_16x16x64_bf16 v[112:115], v[52:55], v[96:103], v13
ds_read_b128 v[96:99], v6 offset:14336
ds_read_b128 v[100:103], v6 offset:15360
s_waitcnt lgkmcnt(12)
v_smfmac_f32_16x16x64_bf16 v[116:119], v[52:55], v[16:23], v13
ds_read_b128 v[16:19], v12 offset:0
ds_read_b128 v[20:23], v12 offset:1024
Lrec03_g_74w:
s_waitcnt vmcnt(3)
v_max3_u32 v104, v56, v57, v58
v_max_u32 v104, v59, v104
s_waitcnt vmcnt(2)
v_max3_u32 v104, v60, v61, v104
v_max3_u32 v104, v62, v63, v104
v_cmp_eq_u32 vcc, -1, v104
buffer_load_dwordx4 v[72:75], v0, s[8:11], s60 offen offset:1024 sc1
buffer_load_dwordx4 v[76:79], v0, s[8:11], s60 offen offset:2048 sc1
s_cbranch_vccnz Lrec03_r_73
Lrec03_g_74:
s_waitcnt lgkmcnt(12)
v_smfmac_f32_16x16x64_bf16 v[112:115], v[56:59], v[24:31], v13
ds_read_b128 v[24:27], v12 offset:2048
ds_read_b128 v[28:31], v12 offset:3072
s_waitcnt lgkmcnt(12)
v_smfmac_f32_16x16x64_bf16 v[116:119], v[56:59], v[32:39], v13
ds_read_b128 v[32:35], v12 offset:4096
ds_read_b128 v[36:39], v12 offset:5120
s_waitcnt lgkmcnt(12)
v_smfmac_f32_16x16x64_bf16 v[112:115], v[60:63], v[40:47], v13
ds_read_b128 v[40:43], v12 offset:6144
ds_read_b128 v[44:47], v12 offset:7168
s_waitcnt lgkmcnt(12)
v_smfmac_f32_16x16x64_bf16 v[116:119], v[60:63], v[80:87], v13
ds_read_b128 v[80:83], v12 offset:8192
ds_read_b128 v[84:87], v12 offset:9216
Lrec03_g_76w:
s_waitcnt vmcnt(3)
v_max3_u32 v104, v64, v65, v66
v_max_u32 v104, v67, v104
s_waitcnt vmcnt(2)
v_max3_u32 v104, v68, v69, v104
v_max3_u32 v104, v70, v71, v104
v_cmp_eq_u32 vcc, -1, v104
s_cbranch_vccnz Lrec03_r_75
Lrec03_g_76:
s_waitcnt lgkmcnt(12)
v_smfmac_f32_16x16x64_bf16 v[112:115], v[64:67], v[88:95], v13
ds_read_b128 v[88:91], v12 offset:10240
ds_read_b128 v[92:95], v12 offset:11264
s_waitcnt lgkmcnt(12)
v_smfmac_f32_16x16x64_bf16 v[116:119], v[64:67], v[96:103], v13
s_waitcnt lgkmcnt(10)
v_smfmac_f32_16x16x64_bf16 v[112:115], v[68:71], v[16:23], v13
s_waitcnt lgkmcnt(8)
v_smfmac_f32_16x16x64_bf16 v[116:119], v[68:71], v[24:31], v13
Lrec03_g_78w:
s_waitcnt vmcnt(1)
v_max3_u32 v104, v72, v73, v74
v_max_u32 v104, v75, v104
s_waitcnt vmcnt(0)
v_max3_u32 v104, v76, v77, v104
v_max3_u32 v104, v78, v79, v104
v_cmp_eq_u32 vcc, -1, v104
s_cbranch_vccnz Lrec03_r_77
Lrec03_g_78:
s_waitcnt lgkmcnt(6)
v_smfmac_f32_16x16x64_bf16 v[112:115], v[72:75], v[32:39], v13
s_waitcnt lgkmcnt(4)
v_smfmac_f32_16x16x64_bf16 v[116:119], v[72:75], v[40:47], v13
s_waitcnt lgkmcnt(2)
v_smfmac_f32_16x16x64_bf16 v[112:115], v[76:79], v[80:87], v13
s_waitcnt lgkmcnt(0)
v_smfmac_f32_16x16x64_bf16 v[116:119], v[76:79], v[88:95], v13
s_nop 7
v_permlane32_swap_b32 v112, v116
v_permlane32_swap_b32 v113, v117
v_permlane32_swap_b32 v114, v118
v_permlane32_swap_b32 v115, v119
v_pk_add_f32 v[112:113], v[112:113], v[116:117]
ds_write2_b32 v10, v112, v113 offset1:32
v_pk_add_f32 v[114:115], v[114:115], v[118:119]
ds_write2_b32 v10, v114, v115 offset0:64 offset1:96
s_waitcnt lgkmcnt(0)
s_barrier
v_mov_b32 v16, -1
v_mov_b32 v17, -1
buffer_store_dwordx2 v[16:17], v2, s[12:15], s46 offen offset:512
s_branch Lrec03_p1
Lrec03_kva:
s_sub_u32 s43, s43, 1
s_cbranch_scc1 Lrec03_kvxa
s_buffer_load_dword s82, s[4:7], s81 glc
s_buffer_load_dword s83, s[4:7], s81 offset:128 glc
s_waitcnt lgkmcnt(0)
s_min_i32 s82, s82, s83
s_cmp_lt_i32 s82, s51
s_cbranch_scc1 Lrec03_kva
s_branch Lrec03_kvda
Lrec03_kvxa:
s_mov_b32 s43, 0
s_branch Lrec03_kvda
Lrec03_kvb:
s_sub_u32 s43, s43, 1
s_cbranch_scc1 Lrec03_kvxb
s_buffer_load_dword s82, s[4:7], s81 glc
s_buffer_load_dword s83, s[4:7], s81 offset:128 glc
s_waitcnt lgkmcnt(0)
s_min_i32 s82, s82, s83
s_cmp_lt_i32 s82, s51
s_cbranch_scc1 Lrec03_kvb
s_branch Lrec03_kvdb
Lrec03_kvxb:
s_mov_b32 s43, 0
s_branch Lrec03_kvdb
Lrec03_r_63:
s_sub_u32 s43, s43, 1
s_cbranch_scc1 Lrec03_r_63x
buffer_load_dwordx4 v[48:51], v0, s[8:11], s56 offen offset:3072 sc1
buffer_load_dwordx4 v[52:55], v0, s[8:11], s56 offen offset:0 sc1
buffer_load_dwordx4 v[56:59], v0, s[8:11], s56 offen offset:1024 sc1
buffer_load_dwordx4 v[60:63], v0, s[8:11], s56 offen offset:2048 sc1
s_branch Lrec03_g_64w
Lrec03_r_63x:
s_mov_b32 s43, 0
s_branch Lrec03_g_64
Lrec03_r_65:
s_sub_u32 s43, s43, 1
s_cbranch_scc1 Lrec03_r_65x
buffer_load_dwordx4 v[56:59], v0, s[8:11], s56 offen offset:1024 sc1
buffer_load_dwordx4 v[60:63], v0, s[8:11], s56 offen offset:2048 sc1
buffer_load_dwordx4 v[64:67], v0, s[8:11], s57 offen offset:3072 sc1
buffer_load_dwordx4 v[68:71], v0, s[8:11], s57 offen offset:0 sc1
s_branch Lrec03_g_66w
Lrec03_r_65x:
s_mov_b32 s43, 0
s_branch Lrec03_g_66
Lrec03_r_67:
s_sub_u32 s43, s43, 1
s_cbranch_scc1 Lrec03_r_67x
buffer_load_dwordx4 v[64:67], v0, s[8:11], s57 offen offset:3072 sc1
buffer_load_dwordx4 v[68:71], v0, s[8:11], s57 offen offset:0 sc1
buffer_load_dwordx4 v[72:75], v0, s[8:11], s57 offen offset:1024 sc1
buffer_load_dwordx4 v[76:79], v0, s[8:11], s57 offen offset:2048 sc1
s_branch Lrec03_g_68w
Lrec03_r_67x:
s_mov_b32 s43, 0
s_branch Lrec03_g_68
Lrec03_r_69:
s_sub_u32 s43, s43, 1
s_cbranch_scc1 Lrec03_r_69x
buffer_load_dwordx4 v[72:75], v0, s[8:11], s57 offen offset:1024 sc1
buffer_load_dwordx4 v[76:79], v0, s[8:11], s57 offen offset:2048 sc1
s_branch Lrec03_g_70w
Lrec03_r_69x:
s_mov_b32 s43, 0
s_branch Lrec03_g_70
Lrec03_ps:
buffer_load_dwordx4 v[88:91], v0, s[8:11], s64 offen sc1
buffer_load_dword v92, v3, s[8:11], s64 offen offset:1024 sc1
s_waitcnt vmcnt(2)
v_max3_u32 v53, v54, v55, v56
v_max3_u32 v53, v57, v58, v53
v_cmp_eq_u32 vcc, -1, v53
s_cbranch_vccz Lrec03_psq
buffer_load_dwordx4 v[54:57], v0, s[8:11], s64 offen sc1
buffer_load_dword v58, v3, s[8:11], s64 offen offset:1024 sc1
s_waitcnt vmcnt(2)
v_max3_u32 v53, v88, v89, v90
v_max3_u32 v53, v91, v92, v53
v_cmp_eq_u32 vcc, -1, v53
s_cbranch_vccz Lrec03_ps1
s_sub_u32 s43, s43, 1
s_cbranch_scc0 Lrec03_ps
s_mov_b32 s43, 0
s_branch Lrec03_ps1
Lrec03_psq:
v_pk_add_f32 v[112:113], v[112:113], v[54:55]
v_pk_add_f32 v[114:115], v[114:115], v[56:57]
v_add_f32 v116, v116, v58
s_branch Lrec03_ps2
Lrec03_early:
s_waitcnt lgkmcnt(0)
buffer_store_dword v108, v7, s[4:7], s68 offen sc1
s_branch Lrec03_earlyd
Lrec03_r_71:
s_sub_u32 s43, s43, 1
s_cbranch_scc1 Lrec03_r_71x
buffer_load_dwordx4 v[48:51], v0, s[8:11], s60 offen offset:3072 sc1
buffer_load_dwordx4 v[52:55], v0, s[8:11], s61 offen offset:0 sc1
buffer_load_dwordx4 v[56:59], v0, s[8:11], s61 offen offset:1024 sc1
buffer_load_dwordx4 v[60:63], v0, s[8:11], s61 offen offset:2048 sc1
s_branch Lrec03_g_72w
Lrec03_r_71x:
s_mov_b32 s43, 0
s_branch Lrec03_g_72
Lrec03_r_73:
s_sub_u32 s43, s43, 1
s_cbranch_scc1 Lrec03_r_73x
buffer_load_dwordx4 v[56:59], v0, s[8:11], s61 offen offset:1024 sc1
buffer_load_dwordx4 v[60:63], v0, s[8:11], s61 offen offset:2048 sc1
buffer_load_dwordx4 v[64:67], v0, s[8:11], s61 offen offset:3072 sc1
buffer_load_dwordx4 v[68:71], v0, s[8:11], s60 offen offset:0 sc1
s_branch Lrec03_g_74w
Lrec03_r_73x:
s_mov_b32 s43, 0
s_branch Lrec03_g_74
Lrec03_r_75:
s_sub_u32 s43, s43, 1
s_cbranch_scc1 Lrec03_r_75x
buffer_load_dwordx4 v[64:67], v0, s[8:11], s61 offen offset:3072 sc1
buffer_load_dwordx4 v[68:71], v0, s[8:11], s60 offen offset:0 sc1
buffer_load_dwordx4 v[72:75], v0, s[8:11], s60 offen offset:1024 sc1
buffer_load_dwordx4 v[76:79], v0, s[8:11], s60 offen offset:2048 sc1
s_branch Lrec03_g_76w
Lrec03_r_75x:
s_mov_b32 s43, 0
s_branch Lrec03_g_76
Lrec03_r_77:
s_sub_u32 s43, s43, 1
s_cbranch_scc1 Lrec03_r_77x
buffer_load_dwordx4 v[72:75], v0, s[8:11], s60 offen offset:1024 sc1
buffer_load_dwordx4 v[76:79], v0, s[8:11], s60 offen offset:2048 sc1
s_branch Lrec03_g_78w
Lrec03_r_77x:
s_mov_b32 s43, 0
s_branch Lrec03_g_78
Lrec03_last:
s_nop 4
v_permlane32_swap_b32 v104, v106
v_permlane32_swap_b32 v105, v107
v_pk_add_f32 v[104:105], v[104:105], v[106:107]
v_cvt_pk_bf16_f32 v108, v104, v105
v_mov_b32 v109, 0
s_waitcnt lgkmcnt(0)
buffer_store_dword v108, v7, s[4:7], s68 offen sc1
s_branch Lrec_end
Lrec10_in:
ds_read_b128 v[80:83], v5 offset:24576
ds_read_b128 v[84:87], v5 offset:26624
ds_read_b128 v[88:91], v5 offset:24832
ds_read_b128 v[92:95], v5 offset:26880
ds_read_b128 v[124:127], v0 offset:28672
s_waitcnt lgkmcnt(0)
s_barrier
s_add_u32 s81, s81, 8192
s_cmp_eq_u32 s81, s71
s_cselect_b32 s51, 24576, 0
s_sub_u32 s81, s81, s51
s_cmp_eq_u32 s49, 63
s_cselect_b32 s51, -2, s49
s_add_u32 s51, s51, 2
s_min_i32 s82, s82, s83
s_cmp_lt_i32 s82, s51
s_cbranch_scc1 Lrec10_kva
Lrec10_kvda:
s_add_u32 s45, s81, 8192
s_cmp_eq_u32 s45, s71
s_cselect_b32 s51, 24576, 0
s_sub_u32 s45, s45, s51
s_mov_b32 m0, 24576
s_add_u32 s65, s65, 0x4000
buffer_load_dwordx4 v0, s[4:7], s65 offen sc1 lds
s_mov_b32 m0, 28672
s_add_u32 s66, s66, 0x4000
buffer_load_dwordx4 v5, s[4:7], s66 offen sc1 lds
v_pk_mul_f32 v[96:97], v[14:15], v[14:15] op_sel:[1,1] op_sel_hi:[1,1]
v_pk_mul_f32 v[98:99], v[14:15], v[14:15] op_sel:[1,1] op_sel_hi:[1,1]
v_pk_mul_f32 v[100:101], v[14:15], v[14:15] op_sel:[1,1] op_sel_hi:[1,1]
v_pk_mul_f32 v[102:103], v[14:15], v[14:15] op_sel:[1,1] op_sel_hi:[1,1]
ds_read_b128 v[16:19], v0 offset:0
ds_read_b128 v[20:23], v0 offset:1024
ds_read_b128 v[24:27], v0 offset:2048
s_waitcnt lgkmcnt(2)
v_smfmac_f32_16x16x64_bf16 v[96:99], v[16:19], a[0:7], v13
ds_read_b128 v[28:31], v0 offset:3072
v_smfmac_f32_16x16x64_bf16 v[100:103], v[16:19], a[128:135], v13
s_waitcnt lgkmcnt(1)
v_smfmac_f32_16x16x64_bf16 v[96:99], v[20:23], a[8:15], v13
ds_read_b128 v[32:35], v0 offset:4096
v_smfmac_f32_16x16x64_bf16 v[100:103], v[20:23], a[136:143], v13
v_smfmac_f32_16x16x64_bf16 v[96:99], v[24:27], a[16:23], v13
ds_read_b128 v[36:39], v0 offset:5120
v_smfmac_f32_16x16x64_bf16 v[100:103], v[24:27], a[144:151], v13
s_waitcnt lgkmcnt(1)
v_smfmac_f32_16x16x64_bf16 v[96:99], v[28:31], a[24:31], v13
ds_read_b128 v[40:43], v0 offset:6144
v_smfmac_f32_16x16x64_bf16 v[100:103], v[28:31], a[152:159], v13
v_smfmac_f32_16x16x64_bf16 v[96:99], v[32:35], a[32:39], v13
ds_read_b128 v[44:47], v0 offset:7168
v_smfmac_f32_16x16x64_bf16 v[100:103], v[32:35], a[160:167], v13
s_waitcnt lgkmcnt(1)
v_smfmac_f32_16x16x64_bf16 v[96:99], v[36:39], a[40:47], v13
ds_read_b128 v[48:51], v0 offset:8192
v_smfmac_f32_16x16x64_bf16 v[100:103], v[36:39], a[168:175], v13
v_smfmac_f32_16x16x64_bf16 v[96:99], v[40:43], a[48:55], v13
ds_read_b128 v[52:55], v0 offset:9216
v_smfmac_f32_16x16x64_bf16 v[100:103], v[40:43], a[176:183], v13
s_waitcnt lgkmcnt(1)
v_smfmac_f32_16x16x64_bf16 v[96:99], v[44:47], a[56:63], v13
ds_read_b128 v[56:59], v0 offset:10240
v_smfmac_f32_16x16x64_bf16 v[100:103], v[44:47], a[184:191], v13
s_branch Lrec10_p2
Lrec10_p1:
ds_read_b128 v[80:83], v5 offset:24576
ds_read_b128 v[84:87], v5 offset:26624
ds_read_b128 v[88:91], v5 offset:24832
ds_read_b128 v[92:95], v5 offset:26880
ds_read_b128 v[124:127], v0 offset:28672
ds_read_b64_tr_b16 v[112:113], v9 offset:1152
ds_read_b64_tr_b16 v[114:115], v9 offset:1216
s_add_u32 s49, s49, 1
v_mov_b32 v116, -1
v_mov_b32 v117, -1
s_add_u32 s81, s81, 8192
s_cmp_eq_u32 s81, s71
s_cselect_b32 s51, 24576, 0
s_sub_u32 s81, s81, s51
s_cmp_eq_u32 s49, 63
s_cselect_b32 s51, -2, s49
s_add_u32 s51, s51, 2
s_min_i32 s82, s82, s83
s_cmp_lt_i32 s82, s51
s_cbranch_scc1 Lrec10_kvb
Lrec10_kvdb:
s_add_u32 s45, s81, 8192
s_cmp_eq_u32 s45, s71
s_cselect_b32 s51, 24576, 0
s_sub_u32 s45, s45, s51
s_mov_b32 m0, 0
s_waitcnt vmcnt(1)
s_barrier
buffer_load_dwordx4 v[48:51], v0, s[8:11], s56 offen offset:0 sc1
buffer_load_dwordx4 v[52:55], v0, s[8:11], s56 offen offset:1024 sc1
buffer_load_dwordx4 v[56:59], v0, s[8:11], s56 offen offset:2048 sc1
buffer_load_dwordx4 v[60:63], v0, s[8:11], s56 offen offset:3072 sc1
Lrec10_g_80w:
s_waitcnt vmcnt(3)
v_max3_u32 v122, v48, v49, v50
v_max_u32 v122, v51, v122
s_waitcnt vmcnt(2)
v_max3_u32 v122, v52, v53, v122
v_max3_u32 v122, v54, v55, v122
v_cmp_eq_u32 vcc, -1, v122
buffer_load_dwordx4 v[64:67], v0, s[8:11], s57 offen offset:0 sc1
buffer_load_dwordx4 v[68:71], v0, s[8:11], s57 offen offset:1024 sc1
s_cbranch_vccnz Lrec10_r_79
Lrec10_g_80:
v_lshlrev_b32 v16, 16, v48
v_and_b32 v17, 0xffff0000, v48
v_lshlrev_b32 v18, 16, v49
v_and_b32 v19, 0xffff0000, v49
v_lshlrev_b32 v20, 16, v50
v_and_b32 v21, 0xffff0000, v50
v_lshlrev_b32 v22, 16, v51
v_and_b32 v23, 0xffff0000, v51
v_lshlrev_b32 v24, 16, v52
v_and_b32 v25, 0xffff0000, v52
v_lshlrev_b32 v26, 16, v53
v_and_b32 v27, 0xffff0000, v53
v_lshlrev_b32 v28, 16, v54
v_and_b32 v29, 0xffff0000, v54
v_lshlrev_b32 v30, 16, v55
v_and_b32 v31, 0xffff0000, v55
Lrec10_g_82w:
s_waitcnt vmcnt(3)
v_max3_u32 v122, v56, v57, v58
v_max_u32 v122, v59, v122
s_waitcnt vmcnt(2)
v_max3_u32 v122, v60, v61, v122
v_max3_u32 v122, v62, v63, v122
v_cmp_eq_u32 vcc, -1, v122
buffer_load_dwordx4 v[72:75], v0, s[8:11], s57 offen offset:2048 sc1
buffer_load_dwordx4 v[76:79], v0, s[8:11], s57 offen offset:3072 sc1
s_cbranch_vccnz Lrec10_r_81
Lrec10_g_82:
v_lshlrev_b32 v32, 16, v56
v_and_b32 v33, 0xffff0000, v56
v_lshlrev_b32 v34, 16, v57
v_and_b32 v35, 0xffff0000, v57
v_lshlrev_b32 v36, 16, v58
v_and_b32 v37, 0xffff0000, v58
v_lshlrev_b32 v38, 16, v59
v_and_b32 v39, 0xffff0000, v59
v_lshlrev_b32 v40, 16, v60
v_and_b32 v41, 0xffff0000, v60
v_lshlrev_b32 v42, 16, v61
v_and_b32 v43, 0xffff0000, v61
v_lshlrev_b32 v44, 16, v62
v_and_b32 v45, 0xffff0000, v62
v_lshlrev_b32 v46, 16, v63
v_and_b32 v47, 0xffff0000, v63
Lrec10_g_84w:
s_waitcnt vmcnt(3)
v_max3_u32 v122, v64, v65, v66
v_max_u32 v122, v67, v122
s_waitcnt vmcnt(2)
v_max3_u32 v122, v68, v69, v122
v_max3_u32 v122, v70, v71, v122
v_cmp_eq_u32 vcc, -1, v122
s_cbranch_vccnz Lrec10_r_83
Lrec10_g_84:
v_dot2_f32_bf16 v16, v64, s69, v16
v_dot2_f32_bf16 v17, v64, s70, v17
v_dot2_f32_bf16 v18, v65, s69, v18
v_dot2_f32_bf16 v19, v65, s70, v19
v_dot2_f32_bf16 v20, v66, s69, v20
v_dot2_f32_bf16 v21, v66, s70, v21
v_dot2_f32_bf16 v22, v67, s69, v22
v_dot2_f32_bf16 v23, v67, s70, v23
v_cvt_pk_bf16_f32 v48, v16, v17
v_cvt_pk_bf16_f32 v49, v18, v19
v_cvt_pk_bf16_f32 v50, v20, v21
v_cvt_pk_bf16_f32 v51, v22, v23
ds_write_addtid_b32 v48 offset:0
ds_write_addtid_b32 v49 offset:256
ds_write_addtid_b32 v50 offset:512
ds_write_addtid_b32 v51 offset:768
v_dot2_f32_bf16 v24, v68, s69, v24
v_dot2_f32_bf16 v25, v68, s70, v25
v_dot2_f32_bf16 v26, v69, s69, v26
v_dot2_f32_bf16 v27, v69, s70, v27
v_dot2_f32_bf16 v28, v70, s69, v28
v_dot2_f32_bf16 v29, v70, s70, v29
v_dot2_f32_bf16 v30, v71, s69, v30
v_dot2_f32_bf16 v31, v71, s70, v31
v_cvt_pk_bf16_f32 v52, v24, v25
v_cvt_pk_bf16_f32 v53, v26, v27
v_cvt_pk_bf16_f32 v54, v28, v29
v_cvt_pk_bf16_f32 v55, v30, v31
ds_write_addtid_b32 v52 offset:1024
ds_write_addtid_b32 v53 offset:1280
ds_write_addtid_b32 v54 offset:1536
ds_write_addtid_b32 v55 offset:1792
Lrec10_g_86w:
s_waitcnt vmcnt(1)
v_max3_u32 v122, v72, v73, v74
v_max_u32 v122, v75, v122
s_waitcnt vmcnt(0)
v_max3_u32 v122, v76, v77, v122
v_max3_u32 v122, v78, v79, v122
v_cmp_eq_u32 vcc, -1, v122
s_cbranch_vccnz Lrec10_r_85
Lrec10_g_86:
v_dot2_f32_bf16 v32, v72, s69, v32
v_dot2_f32_bf16 v33, v72, s70, v33
v_dot2_f32_bf16 v34, v73, s69, v34
v_dot2_f32_bf16 v35, v73, s70, v35
v_dot2_f32_bf16 v36, v74, s69, v36
v_dot2_f32_bf16 v37, v74, s70, v37
v_dot2_f32_bf16 v38, v75, s69, v38
v_dot2_f32_bf16 v39, v75, s70, v39
v_cvt_pk_bf16_f32 v56, v32, v33
v_cvt_pk_bf16_f32 v57, v34, v35
v_cvt_pk_bf16_f32 v58, v36, v37
v_cvt_pk_bf16_f32 v59, v38, v39
ds_write_addtid_b32 v56 offset:2048
ds_write_addtid_b32 v57 offset:2304
ds_write_addtid_b32 v58 offset:2560
ds_write_addtid_b32 v59 offset:2816
v_dot2_f32_bf16 v40, v76, s69, v40
v_dot2_f32_bf16 v41, v76, s70, v41
v_dot2_f32_bf16 v42, v77, s69, v42
v_dot2_f32_bf16 v43, v77, s70, v43
v_dot2_f32_bf16 v44, v78, s69, v44
v_dot2_f32_bf16 v45, v78, s70, v45
v_dot2_f32_bf16 v46, v79, s69, v46
v_dot2_f32_bf16 v47, v79, s70, v47
v_cvt_pk_bf16_f32 v60, v40, v41
v_cvt_pk_bf16_f32 v61, v42, v43
v_cvt_pk_bf16_f32 v62, v44, v45
v_cvt_pk_bf16_f32 v63, v46, v47
ds_write_addtid_b32 v60 offset:3072
ds_write_addtid_b32 v61 offset:3328
ds_write_addtid_b32 v62 offset:3584
ds_write_addtid_b32 v63 offset:3840
v_pk_mul_f32 v[96:97], v[14:15], v[14:15] op_sel:[1,1] op_sel_hi:[1,1]
v_pk_mul_f32 v[98:99], v[14:15], v[14:15] op_sel:[1,1] op_sel_hi:[1,1]
v_pk_mul_f32 v[100:101], v[14:15], v[14:15] op_sel:[1,1] op_sel_hi:[1,1]
v_pk_mul_f32 v[102:103], v[14:15], v[14:15] op_sel:[1,1] op_sel_hi:[1,1]
s_waitcnt lgkmcnt(0)
s_barrier
ds_read_b128 v[16:19], v0 offset:0
ds_read_b128 v[20:23], v0 offset:1024
ds_read_b128 v[24:27], v0 offset:2048
s_mov_b32 m0, 24576
s_add_u32 s65, s65, 0x4000
buffer_load_dwordx4 v0, s[4:7], s65 offen sc1 lds
s_waitcnt lgkmcnt(2)
v_smfmac_f32_16x16x64_bf16 v[96:99], v[16:19], a[0:7], v13
ds_read_b128 v[28:31], v0 offset:3072
v_smfmac_f32_16x16x64_bf16 v[100:103], v[16:19], a[128:135], v13
s_mov_b32 m0, 28672
s_add_u32 s66, s66, 0x4000
buffer_load_dwordx4 v5, s[4:7], s66 offen sc1 lds
s_waitcnt lgkmcnt(1)
v_smfmac_f32_16x16x64_bf16 v[96:99], v[20:23], a[8:15], v13
ds_read_b128 v[32:35], v0 offset:4096
v_smfmac_f32_16x16x64_bf16 v[100:103], v[20:23], a[136:143], v13
buffer_store_dword v108, v7, s[4:7], s68 offen sc1
v_smfmac_f32_16x16x64_bf16 v[96:99], v[24:27], a[16:23], v13
ds_read_b128 v[36:39], v0 offset:5120
v_smfmac_f32_16x16x64_bf16 v[100:103], v[24:27], a[144:151], v13
s_mov_b64 exec, s[74:75]
buffer_store_dwordx4 v[112:115], v1, s[4:7], s67 offen sc1
s_mov_b64 exec, -1
s_waitcnt lgkmcnt(1)
v_smfmac_f32_16x16x64_bf16 v[96:99], v[28:31], a[24:31], v13
ds_read_b128 v[40:43], v0 offset:6144
v_smfmac_f32_16x16x64_bf16 v[100:103], v[28:31], a[152:159], v13
buffer_store_dwordx2 v[116:117], v2, s[12:15], s63 offen offset:0 sc1
v_smfmac_f32_16x16x64_bf16 v[96:99], v[32:35], a[32:39], v13
ds_read_b128 v[44:47], v0 offset:7168
v_smfmac_f32_16x16x64_bf16 v[100:103], v[32:35], a[160:167], v13
s_waitcnt lgkmcnt(1)
v_smfmac_f32_16x16x64_bf16 v[96:99], v[36:39], a[40:47], v13
ds_read_b128 v[48:51], v0 offset:8192
v_smfmac_f32_16x16x64_bf16 v[100:103], v[36:39], a[168:175], v13
v_smfmac_f32_16x16x64_bf16 v[96:99], v[40:43], a[48:55], v13
ds_read_b128 v[52:55], v0 offset:9216
v_smfmac_f32_16x16x64_bf16 v[100:103], v[40:43], a[176:183], v13
s_waitcnt lgkmcnt(1)
v_smfmac_f32_16x16x64_bf16 v[96:99], v[44:47], a[56:63], v13
ds_read_b128 v[56:59], v0 offset:10240
v_smfmac_f32_16x16x64_bf16 v[100:103], v[44:47], a[184:191], v13
Lrec10_p2:
v_smfmac_f32_16x16x64_bf16 v[96:99], v[48:51], a[64:71], v13
ds_read_b128 v[60:63], v0 offset:11264
v_smfmac_f32_16x16x64_bf16 v[100:103], v[48:51], a[192:199], v13
s_add_u32 s72, s72, 524288
s_waitcnt lgkmcnt(1)
v_smfmac_f32_16x16x64_bf16 v[96:99], v[52:55], a[72:79], v13
ds_read_b128 v[64:67], v0 offset:12288
v_smfmac_f32_16x16x64_bf16 v[100:103], v[52:55], a[200:207], v13
s_and_b32 s72, s72, 1572864
v_smfmac_f32_16x16x64_bf16 v[96:99], v[56:59], a[80:87], v13
ds_read_b128 v[68:71], v0 offset:13312
v_smfmac_f32_16x16x64_bf16 v[100:103], v[56:59], a[208:215], v13
s_or_b32 s8, s73, s72
s_waitcnt lgkmcnt(1)
v_smfmac_f32_16x16x64_bf16 v[96:99], v[60:63], a[88:95], v13
ds_read_b128 v[72:75], v0 offset:14336
v_smfmac_f32_16x16x64_bf16 v[100:103], v[60:63], a[216:223], v13
s_xor_b32 s12, s8, 1048576
v_smfmac_f32_16x16x64_bf16 v[96:99], v[64:67], a[96:103], v13
ds_read_b128 v[76:79], v0 offset:15360
v_smfmac_f32_16x16x64_bf16 v[100:103], v[64:67], a[224:231], v13
s_and_b32 s50, s49, 3
s_cselect_b32 s50, 0, 0x2000
s_waitcnt lgkmcnt(1)
v_smfmac_f32_16x16x64_bf16 v[96:99], v[68:71], a[104:111], v13
v_smfmac_f32_16x16x64_bf16 v[100:103], v[68:71], a[232:239], v13
s_add_u32 s50, s50, 0x800
v_smfmac_f32_16x16x64_bf16 v[96:99], v[72:75], a[112:119], v13
v_smfmac_f32_16x16x64_bf16 v[100:103], v[72:75], a[240:247], v13
s_add_u32 s68, s68, s50
s_waitcnt lgkmcnt(0)
v_smfmac_f32_16x16x64_bf16 v[96:99], v[76:79], a[120:127], v13
v_smfmac_f32_16x16x64_bf16 v[100:103], v[76:79], a[248:255], v13
s_add_u32 s67, s67, s50
s_nop 6
v_permlane32_swap_b32 v96, v100
v_permlane32_swap_b32 v97, v101
v_permlane32_swap_b32 v98, v102
v_permlane32_swap_b32 v99, v103
v_pk_add_f32 v[96:97], v[96:97], v[100:101]
v_pk_add_f32 v[98:99], v[98:99], v[102:103]
v_cvt_pk_bf16_f32 v96, v96, v97
v_cvt_pk_bf16_f32 v97, v98, v99
ds_write_b64 v8, v[96:97]
s_waitcnt lgkmcnt(0)
s_barrier
ds_read_b64_tr_b16 v[96:97], v9 offset:0
ds_read_b64_tr_b16 v[98:99], v9 offset:64
ds_read_b64_tr_b16 v[100:101], v9 offset:256
ds_read_b64_tr_b16 v[102:103], v9 offset:320
s_waitcnt lgkmcnt(2)
v_mfma_f32_16x16x32_bf16 v[112:115], v[80:83], v[96:99], 0
s_waitcnt lgkmcnt(0)
v_mfma_f32_16x16x32_bf16 v[112:115], v[84:87], v[100:103], v[112:115]
ds_read_b64_tr_b16 v[104:105], v9 offset:1152
ds_read_b64_tr_b16 v[106:107], v9 offset:1216
v_mfma_f32_16x16x32_bf16 v[116:119], v[88:91], v[96:99], 0
ds_read_b64_tr_b16 v[108:109], v9 offset:1408
ds_read_b64_tr_b16 v[110:111], v9 offset:1472
v_mfma_f32_16x16x32_bf16 v[116:119], v[92:95], v[100:103], v[116:119]
s_mov_b64 exec, s[74:75]
s_nop 0
buffer_store_dwordx4 v[112:115], v0, s[8:11], s63 offen sc1
s_mov_b64 exec, -1
s_waitcnt lgkmcnt(0)
v_mfma_f32_16x16x32_bf16 v[120:123], v[104:107], v[96:99], 0
v_mfma_f32_16x16x32_bf16 v[120:123], v[108:111], v[100:103], v[120:123]
v_pk_mul_f32 v[104:105], v[14:15], v[14:15] op_sel:[1,1] op_sel_hi:[1,1]
v_pk_mul_f32 v[106:107], v[14:15], v[14:15] op_sel:[1,1] op_sel_hi:[1,1]
s_nop 1
v_smfmac_f32_16x16x64_bf16 v[104:107], v[16:19], v[128:135], v13
s_buffer_load_dword s82, s[4:7], s45 glc
v_smfmac_f32_16x16x64_bf16 v[104:107], v[20:23], v[136:143], v13
s_buffer_load_dword s83, s[4:7], s45 offset:128 glc
v_smfmac_f32_16x16x64_bf16 v[104:107], v[24:27], v[144:151], v13
v_cndmask_b32 v112, v112, v116, s[76:77]
v_smfmac_f32_16x16x64_bf16 v[104:107], v[28:31], v[152:159], v13
v_cndmask_b32 v113, v113, v117, s[76:77]
v_smfmac_f32_16x16x64_bf16 v[104:107], v[32:35], v[160:167], v13
v_cndmask_b32 v114, v114, v118, s[76:77]
v_smfmac_f32_16x16x64_bf16 v[104:107], v[36:39], v[168:175], v13
v_cndmask_b32 v115, v115, v119, s[76:77]
buffer_load_dwordx4 v[88:91], v0, s[8:11], s64 offen sc1
buffer_load_dword v92, v3, s[8:11], s64 offen offset:1024 sc1
v_smfmac_f32_16x16x64_bf16 v[104:107], v[40:43], v[176:183], v13
v_cndmask_b32 v120, v120, v122, s[78:79]
v_smfmac_f32_16x16x64_bf16 v[104:107], v[44:47], v[184:191], v13
v_cndmask_b32 v121, v121, v123, s[78:79]
v_smfmac_f32_16x16x64_bf16 v[104:107], v[48:51], v[192:199], v13
v_cndmask_b32 v116, v120, v121, s[76:77]
v_smfmac_f32_16x16x64_bf16 v[104:107], v[52:55], v[200:207], v13
s_cmp_eq_u32 s49, 63
v_smfmac_f32_16x16x64_bf16 v[104:107], v[56:59], v[208:215], v13
v_smfmac_f32_16x16x64_bf16 v[104:107], v[60:63], v[216:223], v13
v_smfmac_f32_16x16x64_bf16 v[104:107], v[64:67], v[224:231], v13
v_smfmac_f32_16x16x64_bf16 v[104:107], v[68:71], v[232:239], v13
v_smfmac_f32_16x16x64_bf16 v[104:107], v[72:75], v[240:247], v13
v_smfmac_f32_16x16x64_bf16 v[104:107], v[76:79], v[248:255], v13
buffer_load_dwordx4 v[54:57], v0, s[8:11], s64 offen sc1
buffer_load_dword v58, v3, s[8:11], s64 offen offset:1024 sc1
s_cbranch_scc1 Lrec10_last
s_waitcnt vmcnt(2)
v_max3_u32 v53, v88, v89, v90
v_max3_u32 v53, v91, v92, v53
v_cmp_eq_u32 vcc, -1, v53
s_cbranch_vccnz Lrec10_ps
Lrec10_ps1:
v_pk_add_f32 v[112:113], v[112:113], v[88:89]
v_pk_add_f32 v[114:115], v[114:115], v[90:91]
v_add_f32 v116, v116, v92
Lrec10_ps2:
v_max3_f32 v60, v112, v113, v114
v_max3_f32 v60, v115, v116, v60
v_mov_b32 v65, 0
v_mov_b32 v109, 0
v_max_f32_dpp v60, v60, v60 row_ror:8 row_mask:0xf bank_mask:0xf
v_mov_b32 v61, v60
v_permlane32_swap_b32 v104, v106
v_permlane32_swap_b32 v105, v107
v_permlane32_swap_b32 v60, v61
v_max_f32 v60, v60, v61
v_mov_b32 v61, v60
v_pk_add_f32 v[104:105], v[104:105], v[106:107]
v_cvt_pk_bf16_f32 v108, v104, v105
v_permlane16_swap_b32 v60, v61
v_max_f32 v60, v60, v61
v_mul_f32 v60, s84, v60
v_fma_f32 v116, v116, s84, -v60
v_pk_fma_f32 v[112:113], v[112:113], s[84:85], v[60:61] op_sel_hi:[1,1,0] neg_lo:[0,0,1] neg_hi:[0,0,1]
v_exp_f32 v116, v116
v_pk_fma_f32 v[114:115], v[114:115], s[84:85], v[60:61] op_sel_hi:[1,1,0] neg_lo:[0,0,1] neg_hi:[0,0,1]
v_exp_f32 v112, v112
v_cvt_pk_bf16_f32 v64, v116, v15
v_exp_f32 v113, v113
v_lshlrev_b32 v64, v14, v64
v_exp_f32 v114, v114
v_exp_f32 v115, v115
v_mfma_f32_16x16x16_bf16 v[68:71], v[108:109], v[64:65], 0
v_cvt_pk_bf16_f32 v62, v112, v113
v_cvt_pk_bf16_f32 v63, v114, v115
v_pk_add_f32 v[112:113], v[112:113], v[114:115]
v_add_f32 v60, v116, v112
v_mfma_f32_16x16x16_bf16 v[76:79], v[126:127], v[62:63], v[68:71]
v_mfma_f32_16x16x16_bf16 v[72:75], v[124:125], v[62:63], v[68:71]
v_add_f32 v60, v60, v113
s_nop 1
v_add_f32_dpp v60, v60, v60 row_ror:8 row_mask:0xf bank_mask:0xf
v_mov_b32 v61, v60
s_nop 1
v_permlane32_swap_b32 v60, v61
v_add_f32 v60, v60, v61
v_mov_b32 v61, v60
v_add_f32_dpp v72, v76, v72 row_ror:8 row_mask:0xf bank_mask:0xf
v_add_f32_dpp v73, v77, v73 row_ror:8 row_mask:0xf bank_mask:0xf
v_permlane16_swap_b32 v60, v61
v_add_f32 v60, v60, v61
v_rcp_f32 v60, v60
v_add_f32_dpp v74, v78, v74 row_ror:8 row_mask:0xf bank_mask:0xf
v_add_f32_dpp v75, v79, v75 row_ror:8 row_mask:0xf bank_mask:0xf
v_pk_mul_f32 v[72:73], v[72:73], v[60:61] op_sel_hi:[1,0]
v_pk_mul_f32 v[74:75], v[74:75], v[60:61] op_sel_hi:[1,0]
v_cvt_pk_bf16_f32 v120, v72, v73
v_cvt_pk_bf16_f32 v121, v74, v75
s_mov_b64 exec, s[74:75]
buffer_store_dwordx2 v[120:121], v4, s[8:11], s62 offen offset:0 sc1
s_mov_b64 exec, -1
s_cmp_ge_u32 s49, 61
s_cbranch_scc1 Lrec10_early
Lrec10_earlyd:
v_pk_mul_f32 v[112:113], v[14:15], v[14:15] op_sel:[1,1] op_sel_hi:[1,1]
v_pk_mul_f32 v[114:115], v[14:15], v[14:15] op_sel:[1,1] op_sel_hi:[1,1]
v_pk_mul_f32 v[116:117], v[14:15], v[14:15] op_sel:[1,1] op_sel_hi:[1,1]
v_pk_mul_f32 v[118:119], v[14:15], v[14:15] op_sel:[1,1] op_sel_hi:[1,1]
s_waitcnt vmcnt(1)
ds_read_b128 v[80:83], v12 offset:0
ds_read_b128 v[84:87], v12 offset:1024
ds_read_b128 v[88:91], v12 offset:2048
ds_read_b128 v[92:95], v12 offset:3072
ds_read_b128 v[96:99], v12 offset:4096
ds_read_b128 v[100:103], v12 offset:5120
ds_read_b128 v[16:19], v12 offset:6144
ds_read_b128 v[20:23], v12 offset:7168
ds_read_b128 v[24:27], v12 offset:8192
ds_read_b128 v[28:31], v12 offset:9216
ds_read_b128 v[32:35], v12 offset:10240
ds_read_b128 v[36:39], v12 offset:11264
ds_read_b128 v[40:43], v12 offset:12288
ds_read_b128 v[44:47], v12 offset:13312
s_waitcnt vmcnt(0)
buffer_load_dwordx4 v[48:51], v0, s[8:11], s60 offen offset:0 sc1
buffer_load_dwordx4 v[52:55], v0, s[8:11], s60 offen offset:1024 sc1
buffer_load_dwordx4 v[56:59], v0, s[8:11], s60 offen offset:2048 sc1
buffer_load_dwordx4 v[60:63], v0, s[8:11], s60 offen offset:3072 sc1
Lrec10_g_88w:
s_waitcnt vmcnt(3)
v_max3_u32 v104, v48, v49, v50
v_max_u32 v104, v51, v104
s_waitcnt vmcnt(2)
v_max3_u32 v104, v52, v53, v104
v_max3_u32 v104, v54, v55, v104
v_cmp_eq_u32 vcc, -1, v104
buffer_load_dwordx4 v[64:67], v0, s[8:11], s61 offen offset:0 sc1
buffer_load_dwordx4 v[68:71], v0, s[8:11], s61 offen offset:1024 sc1
s_cbranch_vccnz Lrec10_r_87
Lrec10_g_88:
s_waitcnt lgkmcnt(12)
v_smfmac_f32_16x16x64_bf16 v[112:115], v[48:51], v[80:87], v13
ds_read_b128 v[80:83], v12 offset:14336
ds_read_b128 v[84:87], v12 offset:15360
s_waitcnt lgkmcnt(12)
v_smfmac_f32_16x16x64_bf16 v[116:119], v[48:51], v[88:95], v13
ds_read_b128 v[88:91], v6 offset:0
ds_read_b128 v[92:95], v6 offset:1024
s_waitcnt lgkmcnt(12)
v_smfmac_f32_16x16x64_bf16 v[112:115], v[52:55], v[96:103], v13
ds_read_b128 v[96:99], v6 offset:2048
ds_read_b128 v[100:103], v6 offset:3072
s_waitcnt lgkmcnt(12)
v_smfmac_f32_16x16x64_bf16 v[116:119], v[52:55], v[16:23], v13
ds_read_b128 v[16:19], v6 offset:4096
ds_read_b128 v[20:23], v6 offset:5120
Lrec10_g_90w:
s_waitcnt vmcnt(3)
v_max3_u32 v104, v56, v57, v58
v_max_u32 v104, v59, v104
s_waitcnt vmcnt(2)
v_max3_u32 v104, v60, v61, v104
v_max3_u32 v104, v62, v63, v104
v_cmp_eq_u32 vcc, -1, v104
buffer_load_dwordx4 v[72:75], v0, s[8:11], s61 offen offset:2048 sc1
buffer_load_dwordx4 v[76:79], v0, s[8:11], s61 offen offset:3072 sc1
s_cbranch_vccnz Lrec10_r_89
Lrec10_g_90:
s_waitcnt lgkmcnt(12)
v_smfmac_f32_16x16x64_bf16 v[112:115], v[56:59], v[24:31], v13
ds_read_b128 v[24:27], v6 offset:6144
ds_read_b128 v[28:31], v6 offset:7168
s_waitcnt lgkmcnt(12)
v_smfmac_f32_16x16x64_bf16 v[116:119], v[56:59], v[32:39], v13
ds_read_b128 v[32:35], v6 offset:8192
ds_read_b128 v[36:39], v6 offset:9216
s_waitcnt lgkmcnt(12)
v_smfmac_f32_16x16x64_bf16 v[112:115], v[60:63], v[40:47], v13
ds_read_b128 v[40:43], v6 offset:10240
ds_read_b128 v[44:47], v6 offset:11264
s_waitcnt lgkmcnt(12)
v_smfmac_f32_16x16x64_bf16 v[116:119], v[60:63], v[80:87], v13
ds_read_b128 v[80:83], v6 offset:12288
ds_read_b128 v[84:87], v6 offset:13312
Lrec10_g_92w:
s_waitcnt vmcnt(3)
v_max3_u32 v104, v64, v65, v66
v_max_u32 v104, v67, v104
s_waitcnt vmcnt(2)
v_max3_u32 v104, v68, v69, v104
v_max3_u32 v104, v70, v71, v104
v_cmp_eq_u32 vcc, -1, v104
s_cbranch_vccnz Lrec10_r_91
Lrec10_g_92:
s_waitcnt lgkmcnt(12)
v_smfmac_f32_16x16x64_bf16 v[112:115], v[64:67], v[88:95], v13
ds_read_b128 v[88:91], v6 offset:14336
ds_read_b128 v[92:95], v6 offset:15360
s_waitcnt lgkmcnt(12)
v_smfmac_f32_16x16x64_bf16 v[116:119], v[64:67], v[96:103], v13
s_waitcnt lgkmcnt(10)
v_smfmac_f32_16x16x64_bf16 v[112:115], v[68:71], v[16:23], v13
s_waitcnt lgkmcnt(8)
v_smfmac_f32_16x16x64_bf16 v[116:119], v[68:71], v[24:31], v13
Lrec10_g_94w:
s_waitcnt vmcnt(1)
v_max3_u32 v104, v72, v73, v74
v_max_u32 v104, v75, v104
s_waitcnt vmcnt(0)
v_max3_u32 v104, v76, v77, v104
v_max3_u32 v104, v78, v79, v104
v_cmp_eq_u32 vcc, -1, v104
s_cbranch_vccnz Lrec10_r_93
Lrec10_g_94:
s_waitcnt lgkmcnt(6)
v_smfmac_f32_16x16x64_bf16 v[112:115], v[72:75], v[32:39], v13
s_waitcnt lgkmcnt(4)
v_smfmac_f32_16x16x64_bf16 v[116:119], v[72:75], v[40:47], v13
s_waitcnt lgkmcnt(2)
v_smfmac_f32_16x16x64_bf16 v[112:115], v[76:79], v[80:87], v13
s_waitcnt lgkmcnt(0)
v_smfmac_f32_16x16x64_bf16 v[116:119], v[76:79], v[88:95], v13
s_nop 7
v_permlane32_swap_b32 v112, v116
v_permlane32_swap_b32 v113, v117
v_permlane32_swap_b32 v114, v118
v_permlane32_swap_b32 v115, v119
v_pk_add_f32 v[112:113], v[112:113], v[116:117]
ds_write2_b32 v10, v112, v113 offset1:32
v_pk_add_f32 v[114:115], v[114:115], v[118:119]
ds_write2_b32 v10, v114, v115 offset0:64 offset1:96
s_waitcnt lgkmcnt(0)
s_barrier
ds_read_b128 v[16:19], v11 offset:0
ds_read_b128 v[20:23], v11 offset:1024
ds_read_b128 v[24:27], v11 offset:2048
ds_read_b128 v[28:31], v11 offset:3072
s_waitcnt lgkmcnt(2)
v_pk_add_f32 v[16:17], v[16:17], v[20:21]
v_pk_add_f32 v[18:19], v[18:19], v[22:23]
s_waitcnt lgkmcnt(1)
v_pk_add_f32 v[16:17], v[16:17], v[24:25]
v_pk_add_f32 v[18:19], v[18:19], v[26:27]
s_waitcnt lgkmcnt(0)
v_pk_add_f32 v[16:17], v[16:17], v[28:29]
v_pk_add_f32 v[18:19], v[18:19], v[30:31]
v_cvt_pk_bf16_f32 v16, v16, v17
v_cvt_pk_bf16_f32 v17, v18, v19
buffer_store_dwordx2 v[16:17], v2, s[8:11], s58 offen sc1
buffer_store_dwordx2 v[16:17], v2, s[8:11], s59 offen sc1
s_branch Lrec10_p1
Lrec10_kva:
s_sub_u32 s43, s43, 1
s_cbranch_scc1 Lrec10_kvxa
s_buffer_load_dword s82, s[4:7], s81 glc
s_buffer_load_dword s83, s[4:7], s81 offset:128 glc
s_waitcnt lgkmcnt(0)
s_min_i32 s82, s82, s83
s_cmp_lt_i32 s82, s51
s_cbranch_scc1 Lrec10_kva
s_branch Lrec10_kvda
Lrec10_kvxa:
s_mov_b32 s43, 0
s_branch Lrec10_kvda
Lrec10_kvb:
s_sub_u32 s43, s43, 1
s_cbranch_scc1 Lrec10_kvxb
s_buffer_load_dword s82, s[4:7], s81 glc
s_buffer_load_dword s83, s[4:7], s81 offset:128 glc
s_waitcnt lgkmcnt(0)
s_min_i32 s82, s82, s83
s_cmp_lt_i32 s82, s51
s_cbranch_scc1 Lrec10_kvb
s_branch Lrec10_kvdb
Lrec10_kvxb:
s_mov_b32 s43, 0
s_branch Lrec10_kvdb
Lrec10_r_79:
s_sub_u32 s43, s43, 1
s_cbranch_scc1 Lrec10_r_79x
buffer_load_dwordx4 v[48:51], v0, s[8:11], s56 offen offset:0 sc1
buffer_load_dwordx4 v[52:55], v0, s[8:11], s56 offen offset:1024 sc1
buffer_load_dwordx4 v[56:59], v0, s[8:11], s56 offen offset:2048 sc1
buffer_load_dwordx4 v[60:63], v0, s[8:11], s56 offen offset:3072 sc1
s_branch Lrec10_g_80w
Lrec10_r_79x:
s_mov_b32 s43, 0
s_branch Lrec10_g_80
Lrec10_r_81:
s_sub_u32 s43, s43, 1
s_cbranch_scc1 Lrec10_r_81x
buffer_load_dwordx4 v[56:59], v0, s[8:11], s56 offen offset:2048 sc1
buffer_load_dwordx4 v[60:63], v0, s[8:11], s56 offen offset:3072 sc1
buffer_load_dwordx4 v[64:67], v0, s[8:11], s57 offen offset:0 sc1
buffer_load_dwordx4 v[68:71], v0, s[8:11], s57 offen offset:1024 sc1
s_branch Lrec10_g_82w
Lrec10_r_81x:
s_mov_b32 s43, 0
s_branch Lrec10_g_82
Lrec10_r_83:
s_sub_u32 s43, s43, 1
s_cbranch_scc1 Lrec10_r_83x
buffer_load_dwordx4 v[64:67], v0, s[8:11], s57 offen offset:0 sc1
buffer_load_dwordx4 v[68:71], v0, s[8:11], s57 offen offset:1024 sc1
buffer_load_dwordx4 v[72:75], v0, s[8:11], s57 offen offset:2048 sc1
buffer_load_dwordx4 v[76:79], v0, s[8:11], s57 offen offset:3072 sc1
s_branch Lrec10_g_84w
Lrec10_r_83x:
s_mov_b32 s43, 0
s_branch Lrec10_g_84
Lrec10_r_85:
s_sub_u32 s43, s43, 1
s_cbranch_scc1 Lrec10_r_85x
buffer_load_dwordx4 v[72:75], v0, s[8:11], s57 offen offset:2048 sc1
buffer_load_dwordx4 v[76:79], v0, s[8:11], s57 offen offset:3072 sc1
s_branch Lrec10_g_86w
Lrec10_r_85x:
s_mov_b32 s43, 0
s_branch Lrec10_g_86
Lrec10_ps:
buffer_load_dwordx4 v[88:91], v0, s[8:11], s64 offen sc1
buffer_load_dword v92, v3, s[8:11], s64 offen offset:1024 sc1
s_waitcnt vmcnt(2)
v_max3_u32 v53, v54, v55, v56
v_max3_u32 v53, v57, v58, v53
v_cmp_eq_u32 vcc, -1, v53
s_cbranch_vccz Lrec10_psq
buffer_load_dwordx4 v[54:57], v0, s[8:11], s64 offen sc1
buffer_load_dword v58, v3, s[8:11], s64 offen offset:1024 sc1
s_waitcnt vmcnt(2)
v_max3_u32 v53, v88, v89, v90
v_max3_u32 v53, v91, v92, v53
v_cmp_eq_u32 vcc, -1, v53
s_cbranch_vccz Lrec10_ps1
s_sub_u32 s43, s43, 1
s_cbranch_scc0 Lrec10_ps
s_mov_b32 s43, 0
s_branch Lrec10_ps1
Lrec10_psq:
v_pk_add_f32 v[112:113], v[112:113], v[54:55]
v_pk_add_f32 v[114:115], v[114:115], v[56:57]
v_add_f32 v116, v116, v58
s_branch Lrec10_ps2
Lrec10_early:
ds_read_b64_tr_b16 v[112:113], v9 offset:1152
ds_read_b64_tr_b16 v[114:115], v9 offset:1216
s_waitcnt lgkmcnt(0)
buffer_store_dword v108, v7, s[4:7], s68 offen sc1
s_mov_b64 exec, s[74:75]
buffer_store_dwordx4 v[112:115], v1, s[4:7], s67 offen sc1
s_mov_b64 exec, -1
s_nop 1
s_branch Lrec10_earlyd
Lrec10_r_87:
s_sub_u32 s43, s43, 1
s_cbranch_scc1 Lrec10_r_87x
buffer_load_dwordx4 v[48:51], v0, s[8:11], s60 offen offset:0 sc1
buffer_load_dwordx4 v[52:55], v0, s[8:11], s60 offen offset:1024 sc1
buffer_load_dwordx4 v[56:59], v0, s[8:11], s60 offen offset:2048 sc1
buffer_load_dwordx4 v[60:63], v0, s[8:11], s60 offen offset:3072 sc1
s_branch Lrec10_g_88w
Lrec10_r_87x:
s_mov_b32 s43, 0
s_branch Lrec10_g_88
Lrec10_r_89:
s_sub_u32 s43, s43, 1
s_cbranch_scc1 Lrec10_r_89x
buffer_load_dwordx4 v[56:59], v0, s[8:11], s60 offen offset:2048 sc1
buffer_load_dwordx4 v[60:63], v0, s[8:11], s60 offen offset:3072 sc1
buffer_load_dwordx4 v[64:67], v0, s[8:11], s61 offen offset:0 sc1
buffer_load_dwordx4 v[68:71], v0, s[8:11], s61 offen offset:1024 sc1
s_branch Lrec10_g_90w
Lrec10_r_89x:
s_mov_b32 s43, 0
s_branch Lrec10_g_90
Lrec10_r_91:
s_sub_u32 s43, s43, 1
s_cbranch_scc1 Lrec10_r_91x
buffer_load_dwordx4 v[64:67], v0, s[8:11], s61 offen offset:0 sc1
buffer_load_dwordx4 v[68:71], v0, s[8:11], s61 offen offset:1024 sc1
buffer_load_dwordx4 v[72:75], v0, s[8:11], s61 offen offset:2048 sc1
buffer_load_dwordx4 v[76:79], v0, s[8:11], s61 offen offset:3072 sc1
s_branch Lrec10_g_92w
Lrec10_r_91x:
s_mov_b32 s43, 0
s_branch Lrec10_g_92
Lrec10_r_93:
s_sub_u32 s43, s43, 1
s_cbranch_scc1 Lrec10_r_93x
buffer_load_dwordx4 v[72:75], v0, s[8:11], s61 offen offset:2048 sc1
buffer_load_dwordx4 v[76:79], v0, s[8:11], s61 offen offset:3072 sc1
s_branch Lrec10_g_94w
Lrec10_r_93x:
s_mov_b32 s43, 0
s_branch Lrec10_g_94
Lrec10_last:
s_nop 4
v_permlane32_swap_b32 v104, v106
v_permlane32_swap_b32 v105, v107
v_pk_add_f32 v[104:105], v[104:105], v[106:107]
v_cvt_pk_bf16_f32 v108, v104, v105
v_mov_b32 v109, 0
ds_read_b64_tr_b16 v[112:113], v9 offset:1152
ds_read_b64_tr_b16 v[114:115], v9 offset:1216
s_waitcnt lgkmcnt(0)
buffer_store_dword v108, v7, s[4:7], s68 offen sc1
s_mov_b64 exec, s[74:75]
buffer_store_dwordx4 v[112:115], v1, s[4:7], s67 offen sc1
s_mov_b64 exec, -1
s_branch Lrec_end
Lrec11_in:
ds_read_b128 v[80:83], v5 offset:24576
ds_read_b128 v[84:87], v5 offset:26624
ds_read_b128 v[88:91], v5 offset:24832
ds_read_b128 v[92:95], v5 offset:26880
ds_read_b128 v[124:127], v0 offset:29696
s_waitcnt lgkmcnt(0)
s_barrier
s_add_u32 s81, s81, 8192
s_cmp_eq_u32 s81, s71
s_cselect_b32 s51, 24576, 0
s_sub_u32 s81, s81, s51
s_cmp_eq_u32 s49, 63
s_cselect_b32 s51, -2, s49
s_add_u32 s51, s51, 2
s_min_i32 s82, s82, s83
s_cmp_lt_i32 s82, s51
s_cbranch_scc1 Lrec11_kva
Lrec11_kvda:
s_add_u32 s45, s81, 8192
s_cmp_eq_u32 s45, s71
s_cselect_b32 s51, 24576, 0
s_sub_u32 s45, s45, s51
s_mov_b32 m0, 25600
s_add_u32 s65, s65, 0x4000
buffer_load_dwordx4 v0, s[4:7], s65 offen sc1 lds
s_mov_b32 m0, 29696
s_add_u32 s66, s66, 0x4000
buffer_load_dwordx4 v5, s[4:7], s66 offen sc1 lds
v_pk_mul_f32 v[96:97], v[14:15], v[14:15] op_sel:[1,1] op_sel_hi:[1,1]
v_pk_mul_f32 v[98:99], v[14:15], v[14:15] op_sel:[1,1] op_sel_hi:[1,1]
v_pk_mul_f32 v[100:101], v[14:15], v[14:15] op_sel:[1,1] op_sel_hi:[1,1]
v_pk_mul_f32 v[102:103], v[14:15], v[14:15] op_sel:[1,1] op_sel_hi:[1,1]
ds_read_b128 v[16:19], v0 offset:0
ds_read_b128 v[20:23], v0 offset:1024
ds_read_b128 v[24:27], v0 offset:2048
s_waitcnt lgkmcnt(2)
v_smfmac_f32_16x16x64_bf16 v[96:99], v[16:19], a[0:7], v13
ds_read_b128 v[28:31], v0 offset:3072
v_smfmac_f32_16x16x64_bf16 v[100:103], v[16:19], a[128:135], v13
s_waitcnt lgkmcnt(1)
v_smfmac_f32_16x16x64_bf16 v[96:99], v[20:23], a[8:15], v13
ds_read_b128 v[32:35], v0 offset:4096
v_smfmac_f32_16x16x64_bf16 v[100:103], v[20:23], a[136:143], v13
v_smfmac_f32_16x16x64_bf16 v[96:99], v[24:27], a[16:23], v13
ds_read_b128 v[36:39], v0 offset:5120
v_smfmac_f32_16x16x64_bf16 v[100:103], v[24:27], a[144:151], v13
s_waitcnt lgkmcnt(1)
v_smfmac_f32_16x16x64_bf16 v[96:99], v[28:31], a[24:31], v13
ds_read_b128 v[40:43], v0 offset:6144
v_smfmac_f32_16x16x64_bf16 v[100:103], v[28:31], a[152:159], v13
v_smfmac_f32_16x16x64_bf16 v[96:99], v[32:35], a[32:39], v13
ds_read_b128 v[44:47], v0 offset:7168
v_smfmac_f32_16x16x64_bf16 v[100:103], v[32:35], a[160:167], v13
s_waitcnt lgkmcnt(1)
v_smfmac_f32_16x16x64_bf16 v[96:99], v[36:39], a[40:47], v13
ds_read_b128 v[48:51], v0 offset:8192
v_smfmac_f32_16x16x64_bf16 v[100:103], v[36:39], a[168:175], v13
v_smfmac_f32_16x16x64_bf16 v[96:99], v[40:43], a[48:55], v13
ds_read_b128 v[52:55], v0 offset:9216
v_smfmac_f32_16x16x64_bf16 v[100:103], v[40:43], a[176:183], v13
s_waitcnt lgkmcnt(1)
v_smfmac_f32_16x16x64_bf16 v[96:99], v[44:47], a[56:63], v13
ds_read_b128 v[56:59], v0 offset:10240
v_smfmac_f32_16x16x64_bf16 v[100:103], v[44:47], a[184:191], v13
s_branch Lrec11_p2
Lrec11_p1:
s_add_u32 s49, s49, 1
v_mov_b32 v116, -1
v_mov_b32 v117, -1
s_add_u32 s81, s81, 8192
s_cmp_eq_u32 s81, s71
s_cselect_b32 s51, 24576, 0
s_sub_u32 s81, s81, s51
s_cmp_eq_u32 s49, 63
s_cselect_b32 s51, -2, s49
s_add_u32 s51, s51, 2
s_min_i32 s82, s82, s83
s_cmp_lt_i32 s82, s51
s_cbranch_scc1 Lrec11_kvb
Lrec11_kvdb:
s_add_u32 s45, s81, 8192
s_cmp_eq_u32 s45, s71
s_cselect_b32 s51, 24576, 0
s_sub_u32 s45, s45, s51
s_mov_b32 m0, 0
ds_read_b128 v[80:83], v5 offset:24576
ds_read_b128 v[84:87], v5 offset:26624
ds_read_b128 v[88:91], v5 offset:24832
ds_read_b128 v[92:95], v5 offset:26880
ds_read_b128 v[124:127], v0 offset:29696
ds_read_b64_tr_b16 v[112:113], v9 offset:1408
ds_read_b64_tr_b16 v[114:115], v9 offset:1472
s_barrier
buffer_load_dwordx4 v[48:51], v0, s[8:11], s56 offen offset:1024 sc1
buffer_load_dwordx4 v[52:55], v0, s[8:11], s56 offen offset:2048 sc1
buffer_load_dwordx4 v[56:59], v0, s[8:11], s56 offen offset:3072 sc1
buffer_load_dwordx4 v[60:63], v0, s[8:11], s56 offen offset:0 sc1
Lrec11_g_96w:
s_waitcnt vmcnt(3)
v_max3_u32 v122, v48, v49, v50
v_max_u32 v122, v51, v122
s_waitcnt vmcnt(2)
v_max3_u32 v122, v52, v53, v122
v_max3_u32 v122, v54, v55, v122
v_cmp_eq_u32 vcc, -1, v122
buffer_load_dwordx4 v[64:67], v0, s[8:11], s57 offen offset:1024 sc1
buffer_load_dwordx4 v[68:71], v0, s[8:11], s57 offen offset:2048 sc1
s_cbranch_vccnz Lrec11_r_95
Lrec11_g_96:
v_lshlrev_b32 v16, 16, v48
v_and_b32 v17, 0xffff0000, v48
v_lshlrev_b32 v18, 16, v49
v_and_b32 v19, 0xffff0000, v49
v_lshlrev_b32 v20, 16, v50
v_and_b32 v21, 0xffff0000, v50
v_lshlrev_b32 v22, 16, v51
v_and_b32 v23, 0xffff0000, v51
v_lshlrev_b32 v24, 16, v52
v_and_b32 v25, 0xffff0000, v52
v_lshlrev_b32 v26, 16, v53
v_and_b32 v27, 0xffff0000, v53
v_lshlrev_b32 v28, 16, v54
v_and_b32 v29, 0xffff0000, v54
v_lshlrev_b32 v30, 16, v55
v_and_b32 v31, 0xffff0000, v55
Lrec11_g_98w:
s_waitcnt vmcnt(3)
v_max3_u32 v122, v56, v57, v58
v_max_u32 v122, v59, v122
s_waitcnt vmcnt(2)
v_max3_u32 v122, v60, v61, v122
v_max3_u32 v122, v62, v63, v122
v_cmp_eq_u32 vcc, -1, v122
buffer_load_dwordx4 v[72:75], v0, s[8:11], s57 offen offset:3072 sc1
buffer_load_dwordx4 v[76:79], v0, s[8:11], s57 offen offset:0 sc1
s_cbranch_vccnz Lrec11_r_97
Lrec11_g_98:
v_lshlrev_b32 v32, 16, v56
v_and_b32 v33, 0xffff0000, v56
v_lshlrev_b32 v34, 16, v57
v_and_b32 v35, 0xffff0000, v57
v_lshlrev_b32 v36, 16, v58
v_and_b32 v37, 0xffff0000, v58
v_lshlrev_b32 v38, 16, v59
v_and_b32 v39, 0xffff0000, v59
v_lshlrev_b32 v40, 16, v60
v_and_b32 v41, 0xffff0000, v60
v_lshlrev_b32 v42, 16, v61
v_and_b32 v43, 0xffff0000, v61
v_lshlrev_b32 v44, 16, v62
v_and_b32 v45, 0xffff0000, v62
v_lshlrev_b32 v46, 16, v63
v_and_b32 v47, 0xffff0000, v63
Lrec11_g_100w:
s_waitcnt vmcnt(3)
v_max3_u32 v122, v64, v65, v66
v_max_u32 v122, v67, v122
s_waitcnt vmcnt(2)
v_max3_u32 v122, v68, v69, v122
v_max3_u32 v122, v70, v71, v122
v_cmp_eq_u32 vcc, -1, v122
s_cbranch_vccnz Lrec11_r_99
Lrec11_g_100:
v_dot2_f32_bf16 v16, v64, s69, v16
v_dot2_f32_bf16 v17, v64, s70, v17
v_dot2_f32_bf16 v18, v65, s69, v18
v_dot2_f32_bf16 v19, v65, s70, v19
v_dot2_f32_bf16 v20, v66, s69, v20
v_dot2_f32_bf16 v21, v66, s70, v21
v_dot2_f32_bf16 v22, v67, s69, v22
v_dot2_f32_bf16 v23, v67, s70, v23
v_cvt_pk_bf16_f32 v48, v16, v17
v_cvt_pk_bf16_f32 v49, v18, v19
v_cvt_pk_bf16_f32 v50, v20, v21
v_cvt_pk_bf16_f32 v51, v22, v23
ds_write_addtid_b32 v48 offset:5120
ds_write_addtid_b32 v49 offset:5376
ds_write_addtid_b32 v50 offset:5632
ds_write_addtid_b32 v51 offset:5888
v_dot2_f32_bf16 v24, v68, s69, v24
v_dot2_f32_bf16 v25, v68, s70, v25
v_dot2_f32_bf16 v26, v69, s69, v26
v_dot2_f32_bf16 v27, v69, s70, v27
v_dot2_f32_bf16 v28, v70, s69, v28
v_dot2_f32_bf16 v29, v70, s70, v29
v_dot2_f32_bf16 v30, v71, s69, v30
v_dot2_f32_bf16 v31, v71, s70, v31
v_cvt_pk_bf16_f32 v52, v24, v25
v_cvt_pk_bf16_f32 v53, v26, v27
v_cvt_pk_bf16_f32 v54, v28, v29
v_cvt_pk_bf16_f32 v55, v30, v31
ds_write_addtid_b32 v52 offset:6144
ds_write_addtid_b32 v53 offset:6400
ds_write_addtid_b32 v54 offset:6656
ds_write_addtid_b32 v55 offset:6912
Lrec11_g_102w:
s_waitcnt vmcnt(1)
v_max3_u32 v122, v72, v73, v74
v_max_u32 v122, v75, v122
s_waitcnt vmcnt(0)
v_max3_u32 v122, v76, v77, v122
v_max3_u32 v122, v78, v79, v122
v_cmp_eq_u32 vcc, -1, v122
s_cbranch_vccnz Lrec11_r_101
Lrec11_g_102:
v_dot2_f32_bf16 v32, v72, s69, v32
v_dot2_f32_bf16 v33, v72, s70, v33
v_dot2_f32_bf16 v34, v73, s69, v34
v_dot2_f32_bf16 v35, v73, s70, v35
v_dot2_f32_bf16 v36, v74, s69, v36
v_dot2_f32_bf16 v37, v74, s70, v37
v_dot2_f32_bf16 v38, v75, s69, v38
v_dot2_f32_bf16 v39, v75, s70, v39
v_cvt_pk_bf16_f32 v56, v32, v33
v_cvt_pk_bf16_f32 v57, v34, v35
v_cvt_pk_bf16_f32 v58, v36, v37
v_cvt_pk_bf16_f32 v59, v38, v39
ds_write_addtid_b32 v56 offset:7168
ds_write_addtid_b32 v57 offset:7424
ds_write_addtid_b32 v58 offset:7680
ds_write_addtid_b32 v59 offset:7936
v_dot2_f32_bf16 v40, v76, s69, v40
v_dot2_f32_bf16 v41, v76, s70, v41
v_dot2_f32_bf16 v42, v77, s69, v42
v_dot2_f32_bf16 v43, v77, s70, v43
v_dot2_f32_bf16 v44, v78, s69, v44
v_dot2_f32_bf16 v45, v78, s70, v45
v_dot2_f32_bf16 v46, v79, s69, v46
v_dot2_f32_bf16 v47, v79, s70, v47
v_cvt_pk_bf16_f32 v60, v40, v41
v_cvt_pk_bf16_f32 v61, v42, v43
v_cvt_pk_bf16_f32 v62, v44, v45
v_cvt_pk_bf16_f32 v63, v46, v47
ds_write_addtid_b32 v60 offset:4096
ds_write_addtid_b32 v61 offset:4352
ds_write_addtid_b32 v62 offset:4608
ds_write_addtid_b32 v63 offset:4864
v_pk_mul_f32 v[96:97], v[14:15], v[14:15] op_sel:[1,1] op_sel_hi:[1,1]
v_pk_mul_f32 v[98:99], v[14:15], v[14:15] op_sel:[1,1] op_sel_hi:[1,1]
v_pk_mul_f32 v[100:101], v[14:15], v[14:15] op_sel:[1,1] op_sel_hi:[1,1]
v_pk_mul_f32 v[102:103], v[14:15], v[14:15] op_sel:[1,1] op_sel_hi:[1,1]
s_waitcnt lgkmcnt(0)
s_barrier
ds_read_b128 v[16:19], v0 offset:0
ds_read_b128 v[20:23], v0 offset:1024
ds_read_b128 v[24:27], v0 offset:2048
s_mov_b32 m0, 25600
s_add_u32 s65, s65, 0x4000
buffer_load_dwordx4 v0, s[4:7], s65 offen sc1 lds
s_waitcnt lgkmcnt(2)
v_smfmac_f32_16x16x64_bf16 v[96:99], v[16:19], a[0:7], v13
ds_read_b128 v[28:31], v0 offset:3072
v_smfmac_f32_16x16x64_bf16 v[100:103], v[16:19], a[128:135], v13
s_mov_b32 m0, 29696
s_add_u32 s66, s66, 0x4000
buffer_load_dwordx4 v5, s[4:7], s66 offen sc1 lds
s_waitcnt lgkmcnt(1)
v_smfmac_f32_16x16x64_bf16 v[96:99], v[20:23], a[8:15], v13
ds_read_b128 v[32:35], v0 offset:4096
v_smfmac_f32_16x16x64_bf16 v[100:103], v[20:23], a[136:143], v13
buffer_store_dword v108, v7, s[4:7], s68 offen sc1
v_smfmac_f32_16x16x64_bf16 v[96:99], v[24:27], a[16:23], v13
ds_read_b128 v[36:39], v0 offset:5120
v_smfmac_f32_16x16x64_bf16 v[100:103], v[24:27], a[144:151], v13
s_mov_b64 exec, s[74:75]
buffer_store_dwordx4 v[112:115], v1, s[4:7], s67 offen sc1
s_mov_b64 exec, -1
s_waitcnt lgkmcnt(1)
v_smfmac_f32_16x16x64_bf16 v[96:99], v[28:31], a[24:31], v13
ds_read_b128 v[40:43], v0 offset:6144
v_smfmac_f32_16x16x64_bf16 v[100:103], v[28:31], a[152:159], v13
buffer_store_dwordx2 v[116:117], v2, s[12:15], s63 offen offset:512 sc1
v_smfmac_f32_16x16x64_bf16 v[96:99], v[32:35], a[32:39], v13
ds_read_b128 v[44:47], v0 offset:7168
v_smfmac_f32_16x16x64_bf16 v[100:103], v[32:35], a[160:167], v13
s_waitcnt lgkmcnt(1)
v_smfmac_f32_16x16x64_bf16 v[96:99], v[36:39], a[40:47], v13
ds_read_b128 v[48:51], v0 offset:8192
v_smfmac_f32_16x16x64_bf16 v[100:103], v[36:39], a[168:175], v13
v_smfmac_f32_16x16x64_bf16 v[96:99], v[40:43], a[48:55], v13
ds_read_b128 v[52:55], v0 offset:9216
v_smfmac_f32_16x16x64_bf16 v[100:103], v[40:43], a[176:183], v13
s_waitcnt lgkmcnt(1)
v_smfmac_f32_16x16x64_bf16 v[96:99], v[44:47], a[56:63], v13
ds_read_b128 v[56:59], v0 offset:10240
v_smfmac_f32_16x16x64_bf16 v[100:103], v[44:47], a[184:191], v13
Lrec11_p2:
v_smfmac_f32_16x16x64_bf16 v[96:99], v[48:51], a[64:71], v13
ds_read_b128 v[60:63], v0 offset:11264
v_smfmac_f32_16x16x64_bf16 v[100:103], v[48:51], a[192:199], v13
s_add_u32 s72, s72, 524288
s_waitcnt lgkmcnt(1)
v_smfmac_f32_16x16x64_bf16 v[96:99], v[52:55], a[72:79], v13
ds_read_b128 v[64:67], v0 offset:12288
v_smfmac_f32_16x16x64_bf16 v[100:103], v[52:55], a[200:207], v13
s_and_b32 s72, s72, 1572864
v_smfmac_f32_16x16x64_bf16 v[96:99], v[56:59], a[80:87], v13
ds_read_b128 v[68:71], v0 offset:13312
v_smfmac_f32_16x16x64_bf16 v[100:103], v[56:59], a[208:215], v13
s_or_b32 s8, s73, s72
s_waitcnt lgkmcnt(1)
v_smfmac_f32_16x16x64_bf16 v[96:99], v[60:63], a[88:95], v13
ds_read_b128 v[72:75], v0 offset:14336
v_smfmac_f32_16x16x64_bf16 v[100:103], v[60:63], a[216:223], v13
s_xor_b32 s12, s8, 1048576
v_smfmac_f32_16x16x64_bf16 v[96:99], v[64:67], a[96:103], v13
ds_read_b128 v[76:79], v0 offset:15360
v_smfmac_f32_16x16x64_bf16 v[100:103], v[64:67], a[224:231], v13
s_and_b32 s50, s49, 3
s_cselect_b32 s50, 0, 0x2000
s_waitcnt lgkmcnt(1)
v_smfmac_f32_16x16x64_bf16 v[96:99], v[68:71], a[104:111], v13
v_smfmac_f32_16x16x64_bf16 v[100:103], v[68:71], a[232:239], v13
s_add_u32 s50, s50, 0x800
v_smfmac_f32_16x16x64_bf16 v[96:99], v[72:75], a[112:119], v13
v_smfmac_f32_16x16x64_bf16 v[100:103], v[72:75], a[240:247], v13
s_add_u32 s68, s68, s50
s_waitcnt lgkmcnt(0)
v_smfmac_f32_16x16x64_bf16 v[96:99], v[76:79], a[120:127], v13
v_smfmac_f32_16x16x64_bf16 v[100:103], v[76:79], a[248:255], v13
s_add_u32 s67, s67, s50
s_nop 6
v_permlane32_swap_b32 v96, v100
v_permlane32_swap_b32 v97, v101
v_permlane32_swap_b32 v98, v102
v_permlane32_swap_b32 v99, v103
v_pk_add_f32 v[96:97], v[96:97], v[100:101]
v_pk_add_f32 v[98:99], v[98:99], v[102:103]
v_cvt_pk_bf16_f32 v96, v96, v97
v_cvt_pk_bf16_f32 v97, v98, v99
ds_write_b64 v8, v[96:97]
s_waitcnt lgkmcnt(0)
s_barrier
ds_read_b64_tr_b16 v[96:97], v9 offset:0
ds_read_b64_tr_b16 v[98:99], v9 offset:64
ds_read_b64_tr_b16 v[100:101], v9 offset:256
ds_read_b64_tr_b16 v[102:103], v9 offset:320
s_waitcnt lgkmcnt(2)
v_mfma_f32_16x16x32_bf16 v[116:119], v[88:91], v[96:99], 0
s_waitcnt lgkmcnt(0)
v_mfma_f32_16x16x32_bf16 v[116:119], v[92:95], v[100:103], v[116:119]
ds_read_b64_tr_b16 v[104:105], v9 offset:1152
ds_read_b64_tr_b16 v[106:107], v9 offset:1216
v_mfma_f32_16x16x32_bf16 v[112:115], v[80:83], v[96:99], 0
ds_read_b64_tr_b16 v[108:109], v9 offset:1408
ds_read_b64_tr_b16 v[110:111], v9 offset:1472
v_mfma_f32_16x16x32_bf16 v[112:115], v[84:87], v[100:103], v[112:115]
s_mov_b64 exec, s[76:77]
s_nop 0
buffer_store_dwordx4 v[116:119], v0, s[8:11], s63 offen sc1
s_mov_b64 exec, -1
s_waitcnt lgkmcnt(0)
v_mfma_f32_16x16x32_bf16 v[120:123], v[104:107], v[96:99], 0
v_mfma_f32_16x16x32_bf16 v[120:123], v[108:111], v[100:103], v[120:123]
v_pk_mul_f32 v[104:105], v[14:15], v[14:15] op_sel:[1,1] op_sel_hi:[1,1]
v_pk_mul_f32 v[106:107], v[14:15], v[14:15] op_sel:[1,1] op_sel_hi:[1,1]
s_nop 1
v_smfmac_f32_16x16x64_bf16 v[104:107], v[16:19], v[128:135], v13
s_buffer_load_dword s82, s[4:7], s45 glc
v_smfmac_f32_16x16x64_bf16 v[104:107], v[20:23], v[136:143], v13
s_buffer_load_dword s83, s[4:7], s45 offset:128 glc
v_smfmac_f32_16x16x64_bf16 v[104:107], v[24:27], v[144:151], v13
v_cndmask_b32 v112, v112, v116, s[76:77]
v_smfmac_f32_16x16x64_bf16 v[104:107], v[28:31], v[152:159], v13
v_cndmask_b32 v113, v113, v117, s[76:77]
v_smfmac_f32_16x16x64_bf16 v[104:107], v[32:35], v[160:167], v13
v_cndmask_b32 v114, v114, v118, s[76:77]
v_smfmac_f32_16x16x64_bf16 v[104:107], v[36:39], v[168:175], v13
v_cndmask_b32 v115, v115, v119, s[76:77]
buffer_load_dwordx4 v[88:91], v0, s[8:11], s64 offen sc1
buffer_load_dword v92, v3, s[8:11], s64 offen offset:1024 sc1
v_smfmac_f32_16x16x64_bf16 v[104:107], v[40:43], v[176:183], v13
v_cndmask_b32 v120, v120, v122, s[78:79]
v_smfmac_f32_16x16x64_bf16 v[104:107], v[44:47], v[184:191], v13
v_cndmask_b32 v121, v121, v123, s[78:79]
v_smfmac_f32_16x16x64_bf16 v[104:107], v[48:51], v[192:199], v13
v_cndmask_b32 v116, v120, v121, s[76:77]
v_smfmac_f32_16x16x64_bf16 v[104:107], v[52:55], v[200:207], v13
s_cmp_eq_u32 s49, 63
v_smfmac_f32_16x16x64_bf16 v[104:107], v[56:59], v[208:215], v13
v_smfmac_f32_16x16x64_bf16 v[104:107], v[60:63], v[216:223], v13
v_smfmac_f32_16x16x64_bf16 v[104:107], v[64:67], v[224:231], v13
v_smfmac_f32_16x16x64_bf16 v[104:107], v[68:71], v[232:239], v13
v_smfmac_f32_16x16x64_bf16 v[104:107], v[72:75], v[240:247], v13
v_smfmac_f32_16x16x64_bf16 v[104:107], v[76:79], v[248:255], v13
buffer_load_dwordx4 v[54:57], v0, s[8:11], s64 offen sc1
buffer_load_dword v58, v3, s[8:11], s64 offen offset:1024 sc1
s_cbranch_scc1 Lrec11_last
s_waitcnt vmcnt(2)
v_max3_u32 v53, v88, v89, v90
v_max3_u32 v53, v91, v92, v53
v_cmp_eq_u32 vcc, -1, v53
s_cbranch_vccnz Lrec11_ps
Lrec11_ps1:
v_pk_add_f32 v[112:113], v[112:113], v[88:89]
v_pk_add_f32 v[114:115], v[114:115], v[90:91]
v_add_f32 v116, v116, v92
Lrec11_ps2:
v_max3_f32 v60, v112, v113, v114
v_max3_f32 v60, v115, v116, v60
v_mov_b32 v65, 0
v_mov_b32 v109, 0
v_max_f32_dpp v60, v60, v60 row_ror:8 row_mask:0xf bank_mask:0xf
v_mov_b32 v61, v60
v_permlane32_swap_b32 v104, v106
v_permlane32_swap_b32 v105, v107
v_permlane32_swap_b32 v60, v61
v_max_f32 v60, v60, v61
v_mov_b32 v61, v60
v_pk_add_f32 v[104:105], v[104:105], v[106:107]
v_cvt_pk_bf16_f32 v108, v104, v105
v_permlane16_swap_b32 v60, v61
v_max_f32 v60, v60, v61
v_mul_f32 v60, s84, v60
v_fma_f32 v116, v116, s84, -v60
v_pk_fma_f32 v[112:113], v[112:113], s[84:85], v[60:61] op_sel_hi:[1,1,0] neg_lo:[0,0,1] neg_hi:[0,0,1]
v_exp_f32 v116, v116
v_pk_fma_f32 v[114:115], v[114:115], s[84:85], v[60:61] op_sel_hi:[1,1,0] neg_lo:[0,0,1] neg_hi:[0,0,1]
v_exp_f32 v112, v112
v_cvt_pk_bf16_f32 v64, v116, v15
v_exp_f32 v113, v113
v_lshlrev_b32 v64, v14, v64
v_exp_f32 v114, v114
v_exp_f32 v115, v115
v_mfma_f32_16x16x16_bf16 v[68:71], v[108:109], v[64:65], 0
v_cvt_pk_bf16_f32 v62, v112, v113
v_cvt_pk_bf16_f32 v63, v114, v115
v_pk_add_f32 v[112:113], v[112:113], v[114:115]
v_add_f32 v60, v116, v112
v_mfma_f32_16x16x16_bf16 v[76:79], v[126:127], v[62:63], v[68:71]
v_mfma_f32_16x16x16_bf16 v[72:75], v[124:125], v[62:63], v[68:71]
v_add_f32 v60, v60, v113
s_nop 1
v_add_f32_dpp v60, v60, v60 row_ror:8 row_mask:0xf bank_mask:0xf
v_mov_b32 v61, v60
s_nop 1
v_permlane32_swap_b32 v60, v61
v_add_f32 v60, v60, v61
v_mov_b32 v61, v60
v_add_f32_dpp v72, v76, v72 row_ror:8 row_mask:0xf bank_mask:0xf
v_add_f32_dpp v73, v77, v73 row_ror:8 row_mask:0xf bank_mask:0xf
v_permlane16_swap_b32 v60, v61
v_add_f32 v60, v60, v61
v_rcp_f32 v60, v60
v_add_f32_dpp v74, v78, v74 row_ror:8 row_mask:0xf bank_mask:0xf
v_add_f32_dpp v75, v79, v75 row_ror:8 row_mask:0xf bank_mask:0xf
v_pk_mul_f32 v[72:73], v[72:73], v[60:61] op_sel_hi:[1,0]
v_pk_mul_f32 v[74:75], v[74:75], v[60:61] op_sel_hi:[1,0]
v_cvt_pk_bf16_f32 v120, v72, v73
v_cvt_pk_bf16_f32 v121, v74, v75
s_mov_b64 exec, s[74:75]
buffer_store_dwordx2 v[120:121], v4, s[8:11], s62 offen offset:0 sc1
s_mov_b64 exec, -1
s_cmp_ge_u32 s49, 61
s_cbranch_scc1 Lrec11_early
Lrec11_earlyd:
v_pk_mul_f32 v[112:113], v[14:15], v[14:15] op_sel:[1,1] op_sel_hi:[1,1]
v_pk_mul_f32 v[114:115], v[14:15], v[14:15] op_sel:[1,1] op_sel_hi:[1,1]
v_pk_mul_f32 v[116:117], v[14:15], v[14:15] op_sel:[1,1] op_sel_hi:[1,1]
v_pk_mul_f32 v[118:119], v[14:15], v[14:15] op_sel:[1,1] op_sel_hi:[1,1]
s_waitcnt vmcnt(1)
ds_read_b128 v[80:83], v12 offset:4096
ds_read_b128 v[84:87], v12 offset:5120
ds_read_b128 v[88:91], v12 offset:6144
ds_read_b128 v[92:95], v12 offset:7168
ds_read_b128 v[96:99], v12 offset:8192
ds_read_b128 v[100:103], v12 offset:9216
ds_read_b128 v[16:19], v12 offset:10240
ds_read_b128 v[20:23], v12 offset:11264
ds_read_b128 v[24:27], v12 offset:12288
ds_read_b128 v[28:31], v12 offset:13312
ds_read_b128 v[32:35], v12 offset:14336
ds_read_b128 v[36:39], v12 offset:15360
ds_read_b128 v[40:43], v6 offset:0
ds_read_b128 v[44:47], v6 offset:1024
s_waitcnt vmcnt(0)
buffer_load_dwordx4 v[48:51], v0, s[8:11], s60 offen offset:1024 sc1
buffer_load_dwordx4 v[52:55], v0, s[8:11], s60 offen offset:2048 sc1
buffer_load_dwordx4 v[56:59], v0, s[8:11], s60 offen offset:3072 sc1
buffer_load_dwordx4 v[60:63], v0, s[8:11], s61 offen offset:0 sc1
Lrec11_g_104w:
s_waitcnt vmcnt(3)
v_max3_u32 v104, v48, v49, v50
v_max_u32 v104, v51, v104
s_waitcnt vmcnt(2)
v_max3_u32 v104, v52, v53, v104
v_max3_u32 v104, v54, v55, v104
v_cmp_eq_u32 vcc, -1, v104
buffer_load_dwordx4 v[64:67], v0, s[8:11], s61 offen offset:1024 sc1
buffer_load_dwordx4 v[68:71], v0, s[8:11], s61 offen offset:2048 sc1
s_cbranch_vccnz Lrec11_r_103
Lrec11_g_104:
s_waitcnt lgkmcnt(12)
v_smfmac_f32_16x16x64_bf16 v[112:115], v[48:51], v[80:87], v13
ds_read_b128 v[80:83], v6 offset:2048
ds_read_b128 v[84:87], v6 offset:3072
s_waitcnt lgkmcnt(12)
v_smfmac_f32_16x16x64_bf16 v[116:119], v[48:51], v[88:95], v13
ds_read_b128 v[88:91], v6 offset:4096
ds_read_b128 v[92:95], v6 offset:5120
s_waitcnt lgkmcnt(12)
v_smfmac_f32_16x16x64_bf16 v[112:115], v[52:55], v[96:103], v13
ds_read_b128 v[96:99], v6 offset:6144
ds_read_b128 v[100:103], v6 offset:7168
s_waitcnt lgkmcnt(12)
v_smfmac_f32_16x16x64_bf16 v[116:119], v[52:55], v[16:23], v13
ds_read_b128 v[16:19], v6 offset:8192
ds_read_b128 v[20:23], v6 offset:9216
Lrec11_g_106w:
s_waitcnt vmcnt(3)
v_max3_u32 v104, v56, v57, v58
v_max_u32 v104, v59, v104
s_waitcnt vmcnt(2)
v_max3_u32 v104, v60, v61, v104
v_max3_u32 v104, v62, v63, v104
v_cmp_eq_u32 vcc, -1, v104
buffer_load_dwordx4 v[72:75], v0, s[8:11], s61 offen offset:3072 sc1
buffer_load_dwordx4 v[76:79], v0, s[8:11], s60 offen offset:0 sc1
s_cbranch_vccnz Lrec11_r_105
Lrec11_g_106:
s_waitcnt lgkmcnt(12)
v_smfmac_f32_16x16x64_bf16 v[112:115], v[56:59], v[24:31], v13
ds_read_b128 v[24:27], v6 offset:10240
ds_read_b128 v[28:31], v6 offset:11264
s_waitcnt lgkmcnt(12)
v_smfmac_f32_16x16x64_bf16 v[116:119], v[56:59], v[32:39], v13
ds_read_b128 v[32:35], v6 offset:12288
ds_read_b128 v[36:39], v6 offset:13312
s_waitcnt lgkmcnt(12)
v_smfmac_f32_16x16x64_bf16 v[112:115], v[60:63], v[40:47], v13
ds_read_b128 v[40:43], v6 offset:14336
ds_read_b128 v[44:47], v6 offset:15360
s_waitcnt lgkmcnt(12)
v_smfmac_f32_16x16x64_bf16 v[116:119], v[60:63], v[80:87], v13
ds_read_b128 v[80:83], v12 offset:0
ds_read_b128 v[84:87], v12 offset:1024
Lrec11_g_108w:
s_waitcnt vmcnt(3)
v_max3_u32 v104, v64, v65, v66
v_max_u32 v104, v67, v104
s_waitcnt vmcnt(2)
v_max3_u32 v104, v68, v69, v104
v_max3_u32 v104, v70, v71, v104
v_cmp_eq_u32 vcc, -1, v104
s_cbranch_vccnz Lrec11_r_107
Lrec11_g_108:
s_waitcnt lgkmcnt(12)
v_smfmac_f32_16x16x64_bf16 v[112:115], v[64:67], v[88:95], v13
ds_read_b128 v[88:91], v12 offset:2048
ds_read_b128 v[92:95], v12 offset:3072
s_waitcnt lgkmcnt(12)
v_smfmac_f32_16x16x64_bf16 v[116:119], v[64:67], v[96:103], v13
s_waitcnt lgkmcnt(10)
v_smfmac_f32_16x16x64_bf16 v[112:115], v[68:71], v[16:23], v13
s_waitcnt lgkmcnt(8)
v_smfmac_f32_16x16x64_bf16 v[116:119], v[68:71], v[24:31], v13
Lrec11_g_110w:
s_waitcnt vmcnt(1)
v_max3_u32 v104, v72, v73, v74
v_max_u32 v104, v75, v104
s_waitcnt vmcnt(0)
v_max3_u32 v104, v76, v77, v104
v_max3_u32 v104, v78, v79, v104
v_cmp_eq_u32 vcc, -1, v104
s_cbranch_vccnz Lrec11_r_109
Lrec11_g_110:
s_waitcnt lgkmcnt(6)
v_smfmac_f32_16x16x64_bf16 v[112:115], v[72:75], v[32:39], v13
s_waitcnt lgkmcnt(4)
v_smfmac_f32_16x16x64_bf16 v[116:119], v[72:75], v[40:47], v13
s_waitcnt lgkmcnt(2)
v_smfmac_f32_16x16x64_bf16 v[112:115], v[76:79], v[80:87], v13
s_waitcnt lgkmcnt(0)
v_smfmac_f32_16x16x64_bf16 v[116:119], v[76:79], v[88:95], v13
s_nop 7
v_permlane32_swap_b32 v112, v116
v_permlane32_swap_b32 v113, v117
v_permlane32_swap_b32 v114, v118
v_permlane32_swap_b32 v115, v119
v_pk_add_f32 v[112:113], v[112:113], v[116:117]
ds_write2_b32 v10, v112, v113 offset1:32
v_pk_add_f32 v[114:115], v[114:115], v[118:119]
ds_write2_b32 v10, v114, v115 offset0:64 offset1:96
s_waitcnt lgkmcnt(0)
s_barrier
s_cmp_ge_u32 s49, 61
s_cbranch_scc1 Lrec11_eflag
Lrec11_eflagd:
s_branch Lrec11_p1
Lrec11_kva:
s_sub_u32 s43, s43, 1
s_cbranch_scc1 Lrec11_kvxa
s_buffer_load_dword s82, s[4:7], s81 glc
s_buffer_load_dword s83, s[4:7], s81 offset:128 glc
s_waitcnt lgkmcnt(0)
s_min_i32 s82, s82, s83
s_cmp_lt_i32 s82, s51
s_cbranch_scc1 Lrec11_kva
s_branch Lrec11_kvda
Lrec11_kvxa:
s_mov_b32 s43, 0
s_branch Lrec11_kvda
Lrec11_kvb:
s_sub_u32 s43, s43, 1
s_cbranch_scc1 Lrec11_kvxb
s_buffer_load_dword s82, s[4:7], s81 glc
s_buffer_load_dword s83, s[4:7], s81 offset:128 glc
s_waitcnt lgkmcnt(0)
s_min_i32 s82, s82, s83
s_cmp_lt_i32 s82, s51
s_cbranch_scc1 Lrec11_kvb
s_branch Lrec11_kvdb
Lrec11_kvxb:
s_mov_b32 s43, 0
s_branch Lrec11_kvdb
Lrec11_r_95:
s_sub_u32 s43, s43, 1
s_cbranch_scc1 Lrec11_r_95x
buffer_load_dwordx4 v[48:51], v0, s[8:11], s56 offen offset:1024 sc1
buffer_load_dwordx4 v[52:55], v0, s[8:11], s56 offen offset:2048 sc1
buffer_load_dwordx4 v[56:59], v0, s[8:11], s56 offen offset:3072 sc1
buffer_load_dwordx4 v[60:63], v0, s[8:11], s56 offen offset:0 sc1
s_branch Lrec11_g_96w
Lrec11_r_95x:
s_mov_b32 s43, 0
s_branch Lrec11_g_96
Lrec11_r_97:
s_sub_u32 s43, s43, 1
s_cbranch_scc1 Lrec11_r_97x
buffer_load_dwordx4 v[56:59], v0, s[8:11], s56 offen offset:3072 sc1
buffer_load_dwordx4 v[60:63], v0, s[8:11], s56 offen offset:0 sc1
buffer_load_dwordx4 v[64:67], v0, s[8:11], s57 offen offset:1024 sc1
buffer_load_dwordx4 v[68:71], v0, s[8:11], s57 offen offset:2048 sc1
s_branch Lrec11_g_98w
Lrec11_r_97x:
s_mov_b32 s43, 0
s_branch Lrec11_g_98
Lrec11_r_99:
s_sub_u32 s43, s43, 1
s_cbranch_scc1 Lrec11_r_99x
buffer_load_dwordx4 v[64:67], v0, s[8:11], s57 offen offset:1024 sc1
buffer_load_dwordx4 v[68:71], v0, s[8:11], s57 offen offset:2048 sc1
buffer_load_dwordx4 v[72:75], v0, s[8:11], s57 offen offset:3072 sc1
buffer_load_dwordx4 v[76:79], v0, s[8:11], s57 offen offset:0 sc1
s_branch Lrec11_g_100w
Lrec11_r_99x:
s_mov_b32 s43, 0
s_branch Lrec11_g_100
Lrec11_r_101:
s_sub_u32 s43, s43, 1
s_cbranch_scc1 Lrec11_r_101x
buffer_load_dwordx4 v[72:75], v0, s[8:11], s57 offen offset:3072 sc1
buffer_load_dwordx4 v[76:79], v0, s[8:11], s57 offen offset:0 sc1
s_branch Lrec11_g_102w
Lrec11_r_101x:
s_mov_b32 s43, 0
s_branch Lrec11_g_102
Lrec11_ps:
buffer_load_dwordx4 v[88:91], v0, s[8:11], s64 offen sc1
buffer_load_dword v92, v3, s[8:11], s64 offen offset:1024 sc1
s_waitcnt vmcnt(2)
v_max3_u32 v53, v54, v55, v56
v_max3_u32 v53, v57, v58, v53
v_cmp_eq_u32 vcc, -1, v53
s_cbranch_vccz Lrec11_psq
buffer_load_dwordx4 v[54:57], v0, s[8:11], s64 offen sc1
buffer_load_dword v58, v3, s[8:11], s64 offen offset:1024 sc1
s_waitcnt vmcnt(2)
v_max3_u32 v53, v88, v89, v90
v_max3_u32 v53, v91, v92, v53
v_cmp_eq_u32 vcc, -1, v53
s_cbranch_vccz Lrec11_ps1
s_sub_u32 s43, s43, 1
s_cbranch_scc0 Lrec11_ps
s_mov_b32 s43, 0
s_branch Lrec11_ps1
Lrec11_psq:
v_pk_add_f32 v[112:113], v[112:113], v[54:55]
v_pk_add_f32 v[114:115], v[114:115], v[56:57]
v_add_f32 v116, v116, v58
s_branch Lrec11_ps2
Lrec11_early:
ds_read_b64_tr_b16 v[112:113], v9 offset:1408
ds_read_b64_tr_b16 v[114:115], v9 offset:1472
s_waitcnt lgkmcnt(0)
buffer_store_dword v108, v7, s[4:7], s68 offen sc1
s_mov_b64 exec, s[74:75]
buffer_store_dwordx4 v[112:115], v1, s[4:7], s67 offen sc1
s_mov_b64 exec, -1
s_nop 1
s_branch Lrec11_earlyd
Lrec11_r_103:
s_sub_u32 s43, s43, 1
s_cbranch_scc1 Lrec11_r_103x
buffer_load_dwordx4 v[48:51], v0, s[8:11], s60 offen offset:1024 sc1
buffer_load_dwordx4 v[52:55], v0, s[8:11], s60 offen offset:2048 sc1
buffer_load_dwordx4 v[56:59], v0, s[8:11], s60 offen offset:3072 sc1
buffer_load_dwordx4 v[60:63], v0, s[8:11], s61 offen offset:0 sc1
s_branch Lrec11_g_104w
Lrec11_r_103x:
s_mov_b32 s43, 0
s_branch Lrec11_g_104
Lrec11_r_105:
s_sub_u32 s43, s43, 1
s_cbranch_scc1 Lrec11_r_105x
buffer_load_dwordx4 v[56:59], v0, s[8:11], s60 offen offset:3072 sc1
buffer_load_dwordx4 v[60:63], v0, s[8:11], s61 offen offset:0 sc1
buffer_load_dwordx4 v[64:67], v0, s[8:11], s61 offen offset:1024 sc1
buffer_load_dwordx4 v[68:71], v0, s[8:11], s61 offen offset:2048 sc1
s_branch Lrec11_g_106w
Lrec11_r_105x:
s_mov_b32 s43, 0
s_branch Lrec11_g_106
Lrec11_r_107:
s_sub_u32 s43, s43, 1
s_cbranch_scc1 Lrec11_r_107x
buffer_load_dwordx4 v[64:67], v0, s[8:11], s61 offen offset:1024 sc1
buffer_load_dwordx4 v[68:71], v0, s[8:11], s61 offen offset:2048 sc1
buffer_load_dwordx4 v[72:75], v0, s[8:11], s61 offen offset:3072 sc1
buffer_load_dwordx4 v[76:79], v0, s[8:11], s60 offen offset:0 sc1
s_branch Lrec11_g_108w
Lrec11_r_107x:
s_mov_b32 s43, 0
s_branch Lrec11_g_108
Lrec11_r_109:
s_sub_u32 s43, s43, 1
s_cbranch_scc1 Lrec11_r_109x
buffer_load_dwordx4 v[72:75], v0, s[8:11], s61 offen offset:3072 sc1
buffer_load_dwordx4 v[76:79], v0, s[8:11], s60 offen offset:0 sc1
s_branch Lrec11_g_110w
Lrec11_r_109x:
s_mov_b32 s43, 0
s_branch Lrec11_g_110
Lrec11_eflag:
s_add_u32 s50, s49, 1
v_mov_b32 v16, s50
s_mov_b64 exec, 1
buffer_store_dword v16, v15, s[4:7], s80 offen sc1
s_mov_b64 exec, -1
s_branch Lrec11_eflagd
Lrec11_last:
s_nop 4
v_permlane32_swap_b32 v104, v106
v_permlane32_swap_b32 v105, v107
v_pk_add_f32 v[104:105], v[104:105], v[106:107]
v_cvt_pk_bf16_f32 v108, v104, v105
v_mov_b32 v109, 0
ds_read_b64_tr_b16 v[112:113], v9 offset:1408
ds_read_b64_tr_b16 v[114:115], v9 offset:1472
s_waitcnt lgkmcnt(0)
buffer_store_dword v108, v7, s[4:7], s68 offen sc1
s_mov_b64 exec, s[74:75]
buffer_store_dwordx4 v[112:115], v1, s[4:7], s67 offen sc1
s_mov_b64 exec, -1
s_branch Lrec_end
Lrec12_in:
ds_read_b128 v[80:83], v5 offset:24576
ds_read_b128 v[84:87], v5 offset:26624
ds_read_b128 v[88:91], v5 offset:24832
ds_read_b128 v[92:95], v5 offset:26880
ds_read_b128 v[124:127], v0 offset:30720
s_waitcnt lgkmcnt(0)
s_barrier
s_add_u32 s81, s81, 8192
s_cmp_eq_u32 s81, s71
s_cselect_b32 s51, 24576, 0
s_sub_u32 s81, s81, s51
s_cmp_eq_u32 s49, 63
s_cselect_b32 s51, -2, s49
s_add_u32 s51, s51, 2
s_min_i32 s82, s82, s83
s_cmp_lt_i32 s82, s51
s_cbranch_scc1 Lrec12_kva
Lrec12_kvda:
s_add_u32 s45, s81, 8192
s_cmp_eq_u32 s45, s71
s_cselect_b32 s51, 24576, 0
s_sub_u32 s45, s45, s51
s_mov_b32 m0, 26624
s_add_u32 s65, s65, 0x4000
buffer_load_dwordx4 v0, s[4:7], s65 offen sc1 lds
s_mov_b32 m0, 30720
s_add_u32 s66, s66, 0x4000
buffer_load_dwordx4 v5, s[4:7], s66 offen sc1 lds
v_pk_mul_f32 v[96:97], v[14:15], v[14:15] op_sel:[1,1] op_sel_hi:[1,1]
v_pk_mul_f32 v[98:99], v[14:15], v[14:15] op_sel:[1,1] op_sel_hi:[1,1]
v_pk_mul_f32 v[100:101], v[14:15], v[14:15] op_sel:[1,1] op_sel_hi:[1,1]
v_pk_mul_f32 v[102:103], v[14:15], v[14:15] op_sel:[1,1] op_sel_hi:[1,1]
ds_read_b128 v[16:19], v0 offset:0
ds_read_b128 v[20:23], v0 offset:1024
ds_read_b128 v[24:27], v0 offset:2048
s_waitcnt lgkmcnt(2)
v_smfmac_f32_16x16x64_bf16 v[96:99], v[16:19], a[0:7], v13
ds_read_b128 v[28:31], v0 offset:3072
v_smfmac_f32_16x16x64_bf16 v[100:103], v[16:19], a[128:135], v13
s_waitcnt lgkmcnt(1)
v_smfmac_f32_16x16x64_bf16 v[96:99], v[20:23], a[8:15], v13
ds_read_b128 v[32:35], v0 offset:4096
v_smfmac_f32_16x16x64_bf16 v[100:103], v[20:23], a[136:143], v13
v_smfmac_f32_16x16x64_bf16 v[96:99], v[24:27], a[16:23], v13
ds_read_b128 v[36:39], v0 offset:5120
v_smfmac_f32_16x16x64_bf16 v[100:103], v[24:27], a[144:151], v13
s_waitcnt lgkmcnt(1)
v_smfmac_f32_16x16x64_bf16 v[96:99], v[28:31], a[24:31], v13
ds_read_b128 v[40:43], v0 offset:6144
v_smfmac_f32_16x16x64_bf16 v[100:103], v[28:31], a[152:159], v13
v_smfmac_f32_16x16x64_bf16 v[96:99], v[32:35], a[32:39], v13
ds_read_b128 v[44:47], v0 offset:7168
v_smfmac_f32_16x16x64_bf16 v[100:103], v[32:35], a[160:167], v13
s_waitcnt lgkmcnt(1)
v_smfmac_f32_16x16x64_bf16 v[96:99], v[36:39], a[40:47], v13
ds_read_b128 v[48:51], v0 offset:8192
v_smfmac_f32_16x16x64_bf16 v[100:103], v[36:39], a[168:175], v13
v_smfmac_f32_16x16x64_bf16 v[96:99], v[40:43], a[48:55], v13
ds_read_b128 v[52:55], v0 offset:9216
v_smfmac_f32_16x16x64_bf16 v[100:103], v[40:43], a[176:183], v13
s_waitcnt lgkmcnt(1)
v_smfmac_f32_16x16x64_bf16 v[96:99], v[44:47], a[56:63], v13
ds_read_b128 v[56:59], v0 offset:10240
v_smfmac_f32_16x16x64_bf16 v[100:103], v[44:47], a[184:191], v13
s_branch Lrec12_p2
Lrec12_p1:
s_add_u32 s49, s49, 1
v_mov_b32 v116, -1
v_mov_b32 v117, -1
s_add_u32 s81, s81, 8192
s_cmp_eq_u32 s81, s71
s_cselect_b32 s51, 24576, 0
s_sub_u32 s81, s81, s51
s_cmp_eq_u32 s49, 63
s_cselect_b32 s51, -2, s49
s_add_u32 s51, s51, 2
s_min_i32 s82, s82, s83
s_cmp_lt_i32 s82, s51
s_cbranch_scc1 Lrec12_kvb
Lrec12_kvdb:
s_add_u32 s45, s81, 8192
s_cmp_eq_u32 s45, s71
s_cselect_b32 s51, 24576, 0
s_sub_u32 s45, s45, s51
s_mov_b32 m0, 0
ds_read_b128 v[80:83], v5 offset:24576
ds_read_b128 v[84:87], v5 offset:26624
ds_read_b128 v[88:91], v5 offset:24832
ds_read_b128 v[92:95], v5 offset:26880
ds_read_b128 v[124:127], v0 offset:30720
s_barrier
buffer_load_dwordx4 v[48:51], v0, s[8:11], s56 offen offset:2048 sc1
buffer_load_dwordx4 v[52:55], v0, s[8:11], s56 offen offset:3072 sc1
buffer_load_dwordx4 v[56:59], v0, s[8:11], s56 offen offset:0 sc1
buffer_load_dwordx4 v[60:63], v0, s[8:11], s56 offen offset:1024 sc1
Lrec12_g_112w:
s_waitcnt vmcnt(3)
v_max3_u32 v122, v48, v49, v50
v_max_u32 v122, v51, v122
s_waitcnt vmcnt(2)
v_max3_u32 v122, v52, v53, v122
v_max3_u32 v122, v54, v55, v122
v_cmp_eq_u32 vcc, -1, v122
buffer_load_dwordx4 v[64:67], v0, s[8:11], s57 offen offset:2048 sc1
buffer_load_dwordx4 v[68:71], v0, s[8:11], s57 offen offset:3072 sc1
s_cbranch_vccnz Lrec12_r_111
Lrec12_g_112:
v_lshlrev_b32 v16, 16, v48
v_and_b32 v17, 0xffff0000, v48
v_lshlrev_b32 v18, 16, v49
v_and_b32 v19, 0xffff0000, v49
v_lshlrev_b32 v20, 16, v50
v_and_b32 v21, 0xffff0000, v50
v_lshlrev_b32 v22, 16, v51
v_and_b32 v23, 0xffff0000, v51
v_lshlrev_b32 v24, 16, v52
v_and_b32 v25, 0xffff0000, v52
v_lshlrev_b32 v26, 16, v53
v_and_b32 v27, 0xffff0000, v53
v_lshlrev_b32 v28, 16, v54
v_and_b32 v29, 0xffff0000, v54
v_lshlrev_b32 v30, 16, v55
v_and_b32 v31, 0xffff0000, v55
Lrec12_g_114w:
s_waitcnt vmcnt(3)
v_max3_u32 v122, v56, v57, v58
v_max_u32 v122, v59, v122
s_waitcnt vmcnt(2)
v_max3_u32 v122, v60, v61, v122
v_max3_u32 v122, v62, v63, v122
v_cmp_eq_u32 vcc, -1, v122
buffer_load_dwordx4 v[72:75], v0, s[8:11], s57 offen offset:0 sc1
buffer_load_dwordx4 v[76:79], v0, s[8:11], s57 offen offset:1024 sc1
s_cbranch_vccnz Lrec12_r_113
Lrec12_g_114:
v_lshlrev_b32 v32, 16, v56
v_and_b32 v33, 0xffff0000, v56
v_lshlrev_b32 v34, 16, v57
v_and_b32 v35, 0xffff0000, v57
v_lshlrev_b32 v36, 16, v58
v_and_b32 v37, 0xffff0000, v58
v_lshlrev_b32 v38, 16, v59
v_and_b32 v39, 0xffff0000, v59
v_lshlrev_b32 v40, 16, v60
v_and_b32 v41, 0xffff0000, v60
v_lshlrev_b32 v42, 16, v61
v_and_b32 v43, 0xffff0000, v61
v_lshlrev_b32 v44, 16, v62
v_and_b32 v45, 0xffff0000, v62
v_lshlrev_b32 v46, 16, v63
v_and_b32 v47, 0xffff0000, v63
Lrec12_g_116w:
s_waitcnt vmcnt(3)
v_max3_u32 v122, v64, v65, v66
v_max_u32 v122, v67, v122
s_waitcnt vmcnt(2)
v_max3_u32 v122, v68, v69, v122
v_max3_u32 v122, v70, v71, v122
v_cmp_eq_u32 vcc, -1, v122
s_cbranch_vccnz Lrec12_r_115
Lrec12_g_116:
v_dot2_f32_bf16 v16, v64, s69, v16
v_dot2_f32_bf16 v17, v64, s70, v17
v_dot2_f32_bf16 v18, v65, s69, v18
v_dot2_f32_bf16 v19, v65, s70, v19
v_dot2_f32_bf16 v20, v66, s69, v20
v_dot2_f32_bf16 v21, v66, s70, v21
v_dot2_f32_bf16 v22, v67, s69, v22
v_dot2_f32_bf16 v23, v67, s70, v23
v_cvt_pk_bf16_f32 v48, v16, v17
v_cvt_pk_bf16_f32 v49, v18, v19
v_cvt_pk_bf16_f32 v50, v20, v21
v_cvt_pk_bf16_f32 v51, v22, v23
ds_write_addtid_b32 v48 offset:10240
ds_write_addtid_b32 v49 offset:10496
ds_write_addtid_b32 v50 offset:10752
ds_write_addtid_b32 v51 offset:11008
v_dot2_f32_bf16 v24, v68, s69, v24
v_dot2_f32_bf16 v25, v68, s70, v25
v_dot2_f32_bf16 v26, v69, s69, v26
v_dot2_f32_bf16 v27, v69, s70, v27
v_dot2_f32_bf16 v28, v70, s69, v28
v_dot2_f32_bf16 v29, v70, s70, v29
v_dot2_f32_bf16 v30, v71, s69, v30
v_dot2_f32_bf16 v31, v71, s70, v31
v_cvt_pk_bf16_f32 v52, v24, v25
v_cvt_pk_bf16_f32 v53, v26, v27
v_cvt_pk_bf16_f32 v54, v28, v29
v_cvt_pk_bf16_f32 v55, v30, v31
ds_write_addtid_b32 v52 offset:11264
ds_write_addtid_b32 v53 offset:11520
ds_write_addtid_b32 v54 offset:11776
ds_write_addtid_b32 v55 offset:12032
Lrec12_g_118w:
s_waitcnt vmcnt(1)
v_max3_u32 v122, v72, v73, v74
v_max_u32 v122, v75, v122
s_waitcnt vmcnt(0)
v_max3_u32 v122, v76, v77, v122
v_max3_u32 v122, v78, v79, v122
v_cmp_eq_u32 vcc, -1, v122
s_cbranch_vccnz Lrec12_r_117
Lrec12_g_118:
v_dot2_f32_bf16 v32, v72, s69, v32
v_dot2_f32_bf16 v33, v72, s70, v33
v_dot2_f32_bf16 v34, v73, s69, v34
v_dot2_f32_bf16 v35, v73, s70, v35
v_dot2_f32_bf16 v36, v74, s69, v36
v_dot2_f32_bf16 v37, v74, s70, v37
v_dot2_f32_bf16 v38, v75, s69, v38
v_dot2_f32_bf16 v39, v75, s70, v39
v_cvt_pk_bf16_f32 v56, v32, v33
v_cvt_pk_bf16_f32 v57, v34, v35
v_cvt_pk_bf16_f32 v58, v36, v37
v_cvt_pk_bf16_f32 v59, v38, v39
ds_write_addtid_b32 v56 offset:8192
ds_write_addtid_b32 v57 offset:8448
ds_write_addtid_b32 v58 offset:8704
ds_write_addtid_b32 v59 offset:8960
v_dot2_f32_bf16 v40, v76, s69, v40
v_dot2_f32_bf16 v41, v76, s70, v41
v_dot2_f32_bf16 v42, v77, s69, v42
v_dot2_f32_bf16 v43, v77, s70, v43
v_dot2_f32_bf16 v44, v78, s69, v44
v_dot2_f32_bf16 v45, v78, s70, v45
v_dot2_f32_bf16 v46, v79, s69, v46
v_dot2_f32_bf16 v47, v79, s70, v47
v_cvt_pk_bf16_f32 v60, v40, v41
v_cvt_pk_bf16_f32 v61, v42, v43
v_cvt_pk_bf16_f32 v62, v44, v45
v_cvt_pk_bf16_f32 v63, v46, v47
ds_write_addtid_b32 v60 offset:9216
ds_write_addtid_b32 v61 offset:9472
ds_write_addtid_b32 v62 offset:9728
ds_write_addtid_b32 v63 offset:9984
v_pk_mul_f32 v[96:97], v[14:15], v[14:15] op_sel:[1,1] op_sel_hi:[1,1]
v_pk_mul_f32 v[98:99], v[14:15], v[14:15] op_sel:[1,1] op_sel_hi:[1,1]
v_pk_mul_f32 v[100:101], v[14:15], v[14:15] op_sel:[1,1] op_sel_hi:[1,1]
v_pk_mul_f32 v[102:103], v[14:15], v[14:15] op_sel:[1,1] op_sel_hi:[1,1]
s_waitcnt lgkmcnt(0)
s_barrier
ds_read_b128 v[16:19], v0 offset:0
ds_read_b128 v[20:23], v0 offset:1024
ds_read_b128 v[24:27], v0 offset:2048
s_mov_b32 m0, 26624
s_add_u32 s65, s65, 0x4000
buffer_load_dwordx4 v0, s[4:7], s65 offen sc1 lds
s_waitcnt lgkmcnt(2)
v_smfmac_f32_16x16x64_bf16 v[96:99], v[16:19], a[0:7], v13
ds_read_b128 v[28:31], v0 offset:3072
v_smfmac_f32_16x16x64_bf16 v[100:103], v[16:19], a[128:135], v13
s_mov_b32 m0, 30720
s_add_u32 s66, s66, 0x4000
buffer_load_dwordx4 v5, s[4:7], s66 offen sc1 lds
s_waitcnt lgkmcnt(1)
v_smfmac_f32_16x16x64_bf16 v[96:99], v[20:23], a[8:15], v13
ds_read_b128 v[32:35], v0 offset:4096
v_smfmac_f32_16x16x64_bf16 v[100:103], v[20:23], a[136:143], v13
buffer_store_dword v108, v7, s[4:7], s68 offen sc1
v_smfmac_f32_16x16x64_bf16 v[96:99], v[24:27], a[16:23], v13
ds_read_b128 v[36:39], v0 offset:5120
v_smfmac_f32_16x16x64_bf16 v[100:103], v[24:27], a[144:151], v13
buffer_store_dwordx2 v[116:117], v2, s[12:15], s63 offen offset:1024 sc1
s_waitcnt lgkmcnt(1)
v_smfmac_f32_16x16x64_bf16 v[96:99], v[28:31], a[24:31], v13
ds_read_b128 v[40:43], v0 offset:6144
v_smfmac_f32_16x16x64_bf16 v[100:103], v[28:31], a[152:159], v13
buffer_store_dwordx2 v[116:117], v2, s[12:15], s58 offen sc1
v_smfmac_f32_16x16x64_bf16 v[96:99], v[32:35], a[32:39], v13
ds_read_b128 v[44:47], v0 offset:7168
v_smfmac_f32_16x16x64_bf16 v[100:103], v[32:35], a[160:167], v13
s_waitcnt lgkmcnt(1)
v_smfmac_f32_16x16x64_bf16 v[96:99], v[36:39], a[40:47], v13
ds_read_b128 v[48:51], v0 offset:8192
v_smfmac_f32_16x16x64_bf16 v[100:103], v[36:39], a[168:175], v13
v_smfmac_f32_16x16x64_bf16 v[96:99], v[40:43], a[48:55], v13
ds_read_b128 v[52:55], v0 offset:9216
v_smfmac_f32_16x16x64_bf16 v[100:103], v[40:43], a[176:183], v13
s_waitcnt lgkmcnt(1)
v_smfmac_f32_16x16x64_bf16 v[96:99], v[44:47], a[56:63], v13
ds_read_b128 v[56:59], v0 offset:10240
v_smfmac_f32_16x16x64_bf16 v[100:103], v[44:47], a[184:191], v13
Lrec12_p2:
v_smfmac_f32_16x16x64_bf16 v[96:99], v[48:51], a[64:71], v13
ds_read_b128 v[60:63], v0 offset:11264
v_smfmac_f32_16x16x64_bf16 v[100:103], v[48:51], a[192:199], v13
s_add_u32 s72, s72, 524288
s_waitcnt lgkmcnt(1)
v_smfmac_f32_16x16x64_bf16 v[96:99], v[52:55], a[72:79], v13
ds_read_b128 v[64:67], v0 offset:12288
v_smfmac_f32_16x16x64_bf16 v[100:103], v[52:55], a[200:207], v13
s_and_b32 s72, s72, 1572864
v_smfmac_f32_16x16x64_bf16 v[96:99], v[56:59], a[80:87], v13
ds_read_b128 v[68:71], v0 offset:13312
v_smfmac_f32_16x16x64_bf16 v[100:103], v[56:59], a[208:215], v13
s_or_b32 s8, s73, s72
s_waitcnt lgkmcnt(1)
v_smfmac_f32_16x16x64_bf16 v[96:99], v[60:63], a[88:95], v13
ds_read_b128 v[72:75], v0 offset:14336
v_smfmac_f32_16x16x64_bf16 v[100:103], v[60:63], a[216:223], v13
s_xor_b32 s12, s8, 1048576
v_smfmac_f32_16x16x64_bf16 v[96:99], v[64:67], a[96:103], v13
ds_read_b128 v[76:79], v0 offset:15360
v_smfmac_f32_16x16x64_bf16 v[100:103], v[64:67], a[224:231], v13
s_and_b32 s50, s49, 3
s_cselect_b32 s50, 0, 0x2000
s_waitcnt lgkmcnt(1)
v_smfmac_f32_16x16x64_bf16 v[96:99], v[68:71], a[104:111], v13
v_smfmac_f32_16x16x64_bf16 v[100:103], v[68:71], a[232:239], v13
s_add_u32 s50, s50, 0x800
v_smfmac_f32_16x16x64_bf16 v[96:99], v[72:75], a[112:119], v13
v_smfmac_f32_16x16x64_bf16 v[100:103], v[72:75], a[240:247], v13
s_add_u32 s68, s68, s50
s_waitcnt lgkmcnt(0)
v_smfmac_f32_16x16x64_bf16 v[96:99], v[76:79], a[120:127], v13
v_smfmac_f32_16x16x64_bf16 v[100:103], v[76:79], a[248:255], v13
s_add_u32 s67, s67, s50
s_nop 6
v_permlane32_swap_b32 v96, v100
v_permlane32_swap_b32 v97, v101
v_permlane32_swap_b32 v98, v102
v_permlane32_swap_b32 v99, v103
v_pk_add_f32 v[96:97], v[96:97], v[100:101]
v_pk_add_f32 v[98:99], v[98:99], v[102:103]
v_cvt_pk_bf16_f32 v96, v96, v97
v_cvt_pk_bf16_f32 v97, v98, v99
ds_write_b64 v8, v[96:97]
s_waitcnt lgkmcnt(0)
s_barrier
ds_read_b64_tr_b16 v[96:97], v9 offset:0
ds_read_b64_tr_b16 v[98:99], v9 offset:64
ds_read_b64_tr_b16 v[104:105], v9 offset:1152
ds_read_b64_tr_b16 v[106:107], v9 offset:1216
ds_read_b64_tr_b16 v[100:101], v9 offset:256
ds_read_b64_tr_b16 v[102:103], v9 offset:320
ds_read_b64_tr_b16 v[108:109], v9 offset:1408
ds_read_b64_tr_b16 v[110:111], v9 offset:1472
s_waitcnt lgkmcnt(4)
v_mfma_f32_16x16x32_bf16 v[120:123], v[104:107], v[96:99], 0
s_waitcnt lgkmcnt(0)
v_mfma_f32_16x16x32_bf16 v[120:123], v[108:111], v[100:103], v[120:123]
v_mfma_f32_16x16x32_bf16 v[112:115], v[80:83], v[96:99], 0
v_mfma_f32_16x16x32_bf16 v[112:115], v[84:87], v[100:103], v[112:115]
s_mov_b32 exec_lo, 0xff00ff
s_mov_b32 exec_hi, 0x0
s_nop 3
buffer_store_dword v120, v3, s[8:11], s63 offen offset:1024 sc1
s_lshl_b64 exec, exec, 8
buffer_store_dword v121, v3, s[8:11], s63 offen offset:1024 sc1
s_mov_b64 exec, -1
v_mfma_f32_16x16x32_bf16 v[116:119], v[88:91], v[96:99], 0
v_mfma_f32_16x16x32_bf16 v[116:119], v[92:95], v[100:103], v[116:119]
v_pk_mul_f32 v[104:105], v[14:15], v[14:15] op_sel:[1,1] op_sel_hi:[1,1]
v_pk_mul_f32 v[106:107], v[14:15], v[14:15] op_sel:[1,1] op_sel_hi:[1,1]
s_nop 1
v_smfmac_f32_16x16x64_bf16 v[104:107], v[16:19], v[128:135], v13
s_buffer_load_dword s82, s[4:7], s45 glc
v_smfmac_f32_16x16x64_bf16 v[104:107], v[20:23], v[136:143], v13
s_buffer_load_dword s83, s[4:7], s45 offset:128 glc
v_smfmac_f32_16x16x64_bf16 v[104:107], v[24:27], v[144:151], v13
v_cndmask_b32 v112, v112, v116, s[76:77]
v_smfmac_f32_16x16x64_bf16 v[104:107], v[28:31], v[152:159], v13
v_cndmask_b32 v113, v113, v117, s[76:77]
v_smfmac_f32_16x16x64_bf16 v[104:107], v[32:35], v[160:167], v13
v_cndmask_b32 v114, v114, v118, s[76:77]
v_smfmac_f32_16x16x64_bf16 v[104:107], v[36:39], v[168:175], v13
v_cndmask_b32 v115, v115, v119, s[76:77]
buffer_load_dwordx4 v[88:91], v0, s[8:11], s64 offen sc1
buffer_load_dword v92, v3, s[8:11], s64 offen offset:1024 sc1
v_smfmac_f32_16x16x64_bf16 v[104:107], v[40:43], v[176:183], v13
v_cndmask_b32 v120, v120, v122, s[78:79]
v_smfmac_f32_16x16x64_bf16 v[104:107], v[44:47], v[184:191], v13
v_cndmask_b32 v121, v121, v123, s[78:79]
v_smfmac_f32_16x16x64_bf16 v[104:107], v[48:51], v[192:199], v13
v_cndmask_b32 v116, v120, v121, s[76:77]
v_smfmac_f32_16x16x64_bf16 v[104:107], v[52:55], v[200:207], v13
s_cmp_eq_u32 s49, 63
v_smfmac_f32_16x16x64_bf16 v[104:107], v[56:59], v[208:215], v13
v_smfmac_f32_16x16x64_bf16 v[104:107], v[60:63], v[216:223], v13
v_smfmac_f32_16x16x64_bf16 v[104:107], v[64:67], v[224:231], v13
v_smfmac_f32_16x16x64_bf16 v[104:107], v[68:71], v[232:239], v13
v_smfmac_f32_16x16x64_bf16 v[104:107], v[72:75], v[240:247], v13
v_smfmac_f32_16x16x64_bf16 v[104:107], v[76:79], v[248:255], v13
buffer_load_dwordx4 v[54:57], v0, s[8:11], s64 offen sc1
buffer_load_dword v58, v3, s[8:11], s64 offen offset:1024 sc1
s_cbranch_scc1 Lrec12_last
s_waitcnt vmcnt(2)
v_max3_u32 v53, v88, v89, v90
v_max3_u32 v53, v91, v92, v53
v_cmp_eq_u32 vcc, -1, v53
s_cbranch_vccnz Lrec12_ps
Lrec12_ps1:
v_pk_add_f32 v[112:113], v[112:113], v[88:89]
v_pk_add_f32 v[114:115], v[114:115], v[90:91]
v_add_f32 v116, v116, v92
Lrec12_ps2:
v_max3_f32 v60, v112, v113, v114
v_max3_f32 v60, v115, v116, v60
v_mov_b32 v65, 0
v_mov_b32 v109, 0
v_max_f32_dpp v60, v60, v60 row_ror:8 row_mask:0xf bank_mask:0xf
v_mov_b32 v61, v60
v_permlane32_swap_b32 v104, v106
v_permlane32_swap_b32 v105, v107
v_permlane32_swap_b32 v60, v61
v_max_f32 v60, v60, v61
v_mov_b32 v61, v60
v_pk_add_f32 v[104:105], v[104:105], v[106:107]
v_cvt_pk_bf16_f32 v108, v104, v105
v_permlane16_swap_b32 v60, v61
v_max_f32 v60, v60, v61
v_mul_f32 v60, s84, v60
v_fma_f32 v116, v116, s84, -v60
v_pk_fma_f32 v[112:113], v[112:113], s[84:85], v[60:61] op_sel_hi:[1,1,0] neg_lo:[0,0,1] neg_hi:[0,0,1]
v_exp_f32 v116, v116
v_pk_fma_f32 v[114:115], v[114:115], s[84:85], v[60:61] op_sel_hi:[1,1,0] neg_lo:[0,0,1] neg_hi:[0,0,1]
v_exp_f32 v112, v112
v_cvt_pk_bf16_f32 v64, v116, v15
v_exp_f32 v113, v113
v_lshlrev_b32 v64, v14, v64
v_exp_f32 v114, v114
v_exp_f32 v115, v115
v_mfma_f32_16x16x16_bf16 v[68:71], v[108:109], v[64:65], 0
v_cvt_pk_bf16_f32 v62, v112, v113
v_cvt_pk_bf16_f32 v63, v114, v115
v_pk_add_f32 v[112:113], v[112:113], v[114:115]
v_add_f32 v60, v116, v112
v_mfma_f32_16x16x16_bf16 v[76:79], v[126:127], v[62:63], v[68:71]
v_mfma_f32_16x16x16_bf16 v[72:75], v[124:125], v[62:63], v[68:71]
v_add_f32 v60, v60, v113
s_nop 1
v_add_f32_dpp v60, v60, v60 row_ror:8 row_mask:0xf bank_mask:0xf
v_mov_b32 v61, v60
s_nop 1
v_permlane32_swap_b32 v60, v61
v_add_f32 v60, v60, v61
v_mov_b32 v61, v60
v_add_f32_dpp v72, v76, v72 row_ror:8 row_mask:0xf bank_mask:0xf
v_add_f32_dpp v73, v77, v73 row_ror:8 row_mask:0xf bank_mask:0xf
v_permlane16_swap_b32 v60, v61
v_add_f32 v60, v60, v61
v_rcp_f32 v60, v60
v_add_f32_dpp v74, v78, v74 row_ror:8 row_mask:0xf bank_mask:0xf
v_add_f32_dpp v75, v79, v75 row_ror:8 row_mask:0xf bank_mask:0xf
v_pk_mul_f32 v[72:73], v[72:73], v[60:61] op_sel_hi:[1,0]
v_pk_mul_f32 v[74:75], v[74:75], v[60:61] op_sel_hi:[1,0]
v_cvt_pk_bf16_f32 v120, v72, v73
v_cvt_pk_bf16_f32 v121, v74, v75
s_mov_b64 exec, s[74:75]
buffer_store_dwordx2 v[120:121], v4, s[8:11], s62 offen offset:0 sc1
s_mov_b64 exec, -1
s_cmp_ge_u32 s49, 61
s_cbranch_scc1 Lrec12_early
Lrec12_earlyd:
v_pk_mul_f32 v[112:113], v[14:15], v[14:15] op_sel:[1,1] op_sel_hi:[1,1]
v_pk_mul_f32 v[114:115], v[14:15], v[14:15] op_sel:[1,1] op_sel_hi:[1,1]
v_pk_mul_f32 v[116:117], v[14:15], v[14:15] op_sel:[1,1] op_sel_hi:[1,1]
v_pk_mul_f32 v[118:119], v[14:15], v[14:15] op_sel:[1,1] op_sel_hi:[1,1]
s_waitcnt vmcnt(1)
ds_read_b128 v[80:83], v12 offset:8192
ds_read_b128 v[84:87], v12 offset:9216
ds_read_b128 v[88:91], v12 offset:10240
ds_read_b128 v[92:95], v12 offset:11264
ds_read_b128 v[96:99], v12 offset:12288
ds_read_b128 v[100:103], v12 offset:13312
ds_read_b128 v[16:19], v12 offset:14336
ds_read_b128 v[20:23], v12 offset:15360
ds_read_b128 v[24:27], v6 offset:0
ds_read_b128 v[28:31], v6 offset:1024
ds_read_b128 v[32:35], v6 offset:2048
ds_read_b128 v[36:39], v6 offset:3072
ds_read_b128 v[40:43], v6 offset:4096
ds_read_b128 v[44:47], v6 offset:5120
s_waitcnt vmcnt(0)
buffer_load_dwordx4 v[48:51], v0, s[8:11], s60 offen offset:2048 sc1
buffer_load_dwordx4 v[52:55], v0, s[8:11], s60 offen offset:3072 sc1
buffer_load_dwordx4 v[56:59], v0, s[8:11], s61 offen offset:0 sc1
buffer_load_dwordx4 v[60:63], v0, s[8:11], s61 offen offset:1024 sc1
Lrec12_g_120w:
s_waitcnt vmcnt(3)
v_max3_u32 v104, v48, v49, v50
v_max_u32 v104, v51, v104
s_waitcnt vmcnt(2)
v_max3_u32 v104, v52, v53, v104
v_max3_u32 v104, v54, v55, v104
v_cmp_eq_u32 vcc, -1, v104
buffer_load_dwordx4 v[64:67], v0, s[8:11], s61 offen offset:2048 sc1
buffer_load_dwordx4 v[68:71], v0, s[8:11], s61 offen offset:3072 sc1
s_cbranch_vccnz Lrec12_r_119
Lrec12_g_120:
s_waitcnt lgkmcnt(12)
v_smfmac_f32_16x16x64_bf16 v[112:115], v[48:51], v[80:87], v13
ds_read_b128 v[80:83], v6 offset:6144
ds_read_b128 v[84:87], v6 offset:7168
s_waitcnt lgkmcnt(12)
v_smfmac_f32_16x16x64_bf16 v[116:119], v[48:51], v[88:95], v13
ds_read_b128 v[88:91], v6 offset:8192
ds_read_b128 v[92:95], v6 offset:9216
s_waitcnt lgkmcnt(12)
v_smfmac_f32_16x16x64_bf16 v[112:115], v[52:55], v[96:103], v13
ds_read_b128 v[96:99], v6 offset:10240
ds_read_b128 v[100:103], v6 offset:11264
s_waitcnt lgkmcnt(12)
v_smfmac_f32_16x16x64_bf16 v[116:119], v[52:55], v[16:23], v13
ds_read_b128 v[16:19], v6 offset:12288
ds_read_b128 v[20:23], v6 offset:13312
Lrec12_g_122w:
s_waitcnt vmcnt(3)
v_max3_u32 v104, v56, v57, v58
v_max_u32 v104, v59, v104
s_waitcnt vmcnt(2)
v_max3_u32 v104, v60, v61, v104
v_max3_u32 v104, v62, v63, v104
v_cmp_eq_u32 vcc, -1, v104
buffer_load_dwordx4 v[72:75], v0, s[8:11], s60 offen offset:0 sc1
buffer_load_dwordx4 v[76:79], v0, s[8:11], s60 offen offset:1024 sc1
s_cbranch_vccnz Lrec12_r_121
Lrec12_g_122:
s_waitcnt lgkmcnt(12)
v_smfmac_f32_16x16x64_bf16 v[112:115], v[56:59], v[24:31], v13
ds_read_b128 v[24:27], v6 offset:14336
ds_read_b128 v[28:31], v6 offset:15360
s_waitcnt lgkmcnt(12)
v_smfmac_f32_16x16x64_bf16 v[116:119], v[56:59], v[32:39], v13
ds_read_b128 v[32:35], v12 offset:0
ds_read_b128 v[36:39], v12 offset:1024
s_waitcnt lgkmcnt(12)
v_smfmac_f32_16x16x64_bf16 v[112:115], v[60:63], v[40:47], v13
ds_read_b128 v[40:43], v12 offset:2048
ds_read_b128 v[44:47], v12 offset:3072
s_waitcnt lgkmcnt(12)
v_smfmac_f32_16x16x64_bf16 v[116:119], v[60:63], v[80:87], v13
ds_read_b128 v[80:83], v12 offset:4096
ds_read_b128 v[84:87], v12 offset:5120
Lrec12_g_124w:
s_waitcnt vmcnt(3)
v_max3_u32 v104, v64, v65, v66
v_max_u32 v104, v67, v104
s_waitcnt vmcnt(2)
v_max3_u32 v104, v68, v69, v104
v_max3_u32 v104, v70, v71, v104
v_cmp_eq_u32 vcc, -1, v104
s_cbranch_vccnz Lrec12_r_123
Lrec12_g_124:
s_waitcnt lgkmcnt(12)
v_smfmac_f32_16x16x64_bf16 v[112:115], v[64:67], v[88:95], v13
ds_read_b128 v[88:91], v12 offset:6144
ds_read_b128 v[92:95], v12 offset:7168
s_waitcnt lgkmcnt(12)
v_smfmac_f32_16x16x64_bf16 v[116:119], v[64:67], v[96:103], v13
s_waitcnt lgkmcnt(10)
v_smfmac_f32_16x16x64_bf16 v[112:115], v[68:71], v[16:23], v13
s_waitcnt lgkmcnt(8)
v_smfmac_f32_16x16x64_bf16 v[116:119], v[68:71], v[24:31], v13
Lrec12_g_126w:
s_waitcnt vmcnt(1)
v_max3_u32 v104, v72, v73, v74
v_max_u32 v104, v75, v104
s_waitcnt vmcnt(0)
v_max3_u32 v104, v76, v77, v104
v_max3_u32 v104, v78, v79, v104
v_cmp_eq_u32 vcc, -1, v104
s_cbranch_vccnz Lrec12_r_125
Lrec12_g_126:
s_waitcnt lgkmcnt(6)
v_smfmac_f32_16x16x64_bf16 v[112:115], v[72:75], v[32:39], v13
s_waitcnt lgkmcnt(4)
v_smfmac_f32_16x16x64_bf16 v[116:119], v[72:75], v[40:47], v13
s_waitcnt lgkmcnt(2)
v_smfmac_f32_16x16x64_bf16 v[112:115], v[76:79], v[80:87], v13
s_waitcnt lgkmcnt(0)
v_smfmac_f32_16x16x64_bf16 v[116:119], v[76:79], v[88:95], v13
s_nop 7
v_permlane32_swap_b32 v112, v116
v_permlane32_swap_b32 v113, v117
v_permlane32_swap_b32 v114, v118
v_permlane32_swap_b32 v115, v119
v_pk_add_f32 v[112:113], v[112:113], v[116:117]
ds_write2_b32 v10, v112, v113 offset1:32
v_pk_add_f32 v[114:115], v[114:115], v[118:119]
ds_write2_b32 v10, v114, v115 offset0:64 offset1:96
s_waitcnt lgkmcnt(0)
s_barrier
v_mov_b32 v16, -1
v_mov_b32 v17, -1
buffer_store_dwordx2 v[16:17], v2, s[12:15], s46 offen offset:0 sc1
s_branch Lrec12_p1
Lrec12_kva:
s_sub_u32 s43, s43, 1
s_cbranch_scc1 Lrec12_kvxa
s_buffer_load_dword s82, s[4:7], s81 glc
s_buffer_load_dword s83, s[4:7], s81 offset:128 glc
s_waitcnt lgkmcnt(0)
s_min_i32 s82, s82, s83
s_cmp_lt_i32 s82, s51
s_cbranch_scc1 Lrec12_kva
s_branch Lrec12_kvda
Lrec12_kvxa:
s_mov_b32 s43, 0
s_branch Lrec12_kvda
Lrec12_kvb:
s_sub_u32 s43, s43, 1
s_cbranch_scc1 Lrec12_kvxb
s_buffer_load_dword s82, s[4:7], s81 glc
s_buffer_load_dword s83, s[4:7], s81 offset:128 glc
s_waitcnt lgkmcnt(0)
s_min_i32 s82, s82, s83
s_cmp_lt_i32 s82, s51
s_cbranch_scc1 Lrec12_kvb
s_branch Lrec12_kvdb
Lrec12_kvxb:
s_mov_b32 s43, 0
s_branch Lrec12_kvdb
Lrec12_r_111:
s_sub_u32 s43, s43, 1
s_cbranch_scc1 Lrec12_r_111x
buffer_load_dwordx4 v[48:51], v0, s[8:11], s56 offen offset:2048 sc1
buffer_load_dwordx4 v[52:55], v0, s[8:11], s56 offen offset:3072 sc1
buffer_load_dwordx4 v[56:59], v0, s[8:11], s56 offen offset:0 sc1
buffer_load_dwordx4 v[60:63], v0, s[8:11], s56 offen offset:1024 sc1
s_branch Lrec12_g_112w
Lrec12_r_111x:
s_mov_b32 s43, 0
s_branch Lrec12_g_112
Lrec12_r_113:
s_sub_u32 s43, s43, 1
s_cbranch_scc1 Lrec12_r_113x
buffer_load_dwordx4 v[56:59], v0, s[8:11], s56 offen offset:0 sc1
buffer_load_dwordx4 v[60:63], v0, s[8:11], s56 offen offset:1024 sc1
buffer_load_dwordx4 v[64:67], v0, s[8:11], s57 offen offset:2048 sc1
buffer_load_dwordx4 v[68:71], v0, s[8:11], s57 offen offset:3072 sc1
s_branch Lrec12_g_114w
Lrec12_r_113x:
s_mov_b32 s43, 0
s_branch Lrec12_g_114
Lrec12_r_115:
s_sub_u32 s43, s43, 1
s_cbranch_scc1 Lrec12_r_115x
buffer_load_dwordx4 v[64:67], v0, s[8:11], s57 offen offset:2048 sc1
buffer_load_dwordx4 v[68:71], v0, s[8:11], s57 offen offset:3072 sc1
buffer_load_dwordx4 v[72:75], v0, s[8:11], s57 offen offset:0 sc1
buffer_load_dwordx4 v[76:79], v0, s[8:11], s57 offen offset:1024 sc1
s_branch Lrec12_g_116w
Lrec12_r_115x:
s_mov_b32 s43, 0
s_branch Lrec12_g_116
Lrec12_r_117:
s_sub_u32 s43, s43, 1
s_cbranch_scc1 Lrec12_r_117x
buffer_load_dwordx4 v[72:75], v0, s[8:11], s57 offen offset:0 sc1
buffer_load_dwordx4 v[76:79], v0, s[8:11], s57 offen offset:1024 sc1
s_branch Lrec12_g_118w
Lrec12_r_117x:
s_mov_b32 s43, 0
s_branch Lrec12_g_118
Lrec12_ps:
buffer_load_dwordx4 v[88:91], v0, s[8:11], s64 offen sc1
buffer_load_dword v92, v3, s[8:11], s64 offen offset:1024 sc1
s_waitcnt vmcnt(2)
v_max3_u32 v53, v54, v55, v56
v_max3_u32 v53, v57, v58, v53
v_cmp_eq_u32 vcc, -1, v53
s_cbranch_vccz Lrec12_psq
buffer_load_dwordx4 v[54:57], v0, s[8:11], s64 offen sc1
buffer_load_dword v58, v3, s[8:11], s64 offen offset:1024 sc1
s_waitcnt vmcnt(2)
v_max3_u32 v53, v88, v89, v90
v_max3_u32 v53, v91, v92, v53
v_cmp_eq_u32 vcc, -1, v53
s_cbranch_vccz Lrec12_ps1
s_sub_u32 s43, s43, 1
s_cbranch_scc0 Lrec12_ps
s_mov_b32 s43, 0
s_branch Lrec12_ps1
Lrec12_psq:
v_pk_add_f32 v[112:113], v[112:113], v[54:55]
v_pk_add_f32 v[114:115], v[114:115], v[56:57]
v_add_f32 v116, v116, v58
s_branch Lrec12_ps2
Lrec12_early:
s_waitcnt lgkmcnt(0)
buffer_store_dword v108, v7, s[4:7], s68 offen sc1
s_branch Lrec12_earlyd
Lrec12_r_119:
s_sub_u32 s43, s43, 1
s_cbranch_scc1 Lrec12_r_119x
buffer_load_dwordx4 v[48:51], v0, s[8:11], s60 offen offset:2048 sc1
buffer_load_dwordx4 v[52:55], v0, s[8:11], s60 offen offset:3072 sc1
buffer_load_dwordx4 v[56:59], v0, s[8:11], s61 offen offset:0 sc1
buffer_load_dwordx4 v[60:63], v0, s[8:11], s61 offen offset:1024 sc1
s_branch Lrec12_g_120w
Lrec12_r_119x:
s_mov_b32 s43, 0
s_branch Lrec12_g_120
Lrec12_r_121:
s_sub_u32 s43, s43, 1
s_cbranch_scc1 Lrec12_r_121x
buffer_load_dwordx4 v[56:59], v0, s[8:11], s61 offen offset:0 sc1
buffer_load_dwordx4 v[60:63], v0, s[8:11], s61 offen offset:1024 sc1
buffer_load_dwordx4 v[64:67], v0, s[8:11], s61 offen offset:2048 sc1
buffer_load_dwordx4 v[68:71], v0, s[8:11], s61 offen offset:3072 sc1
s_branch Lrec12_g_122w
Lrec12_r_121x:
s_mov_b32 s43, 0
s_branch Lrec12_g_122
Lrec12_r_123:
s_sub_u32 s43, s43, 1
s_cbranch_scc1 Lrec12_r_123x
buffer_load_dwordx4 v[64:67], v0, s[8:11], s61 offen offset:2048 sc1
buffer_load_dwordx4 v[68:71], v0, s[8:11], s61 offen offset:3072 sc1
buffer_load_dwordx4 v[72:75], v0, s[8:11], s60 offen offset:0 sc1
buffer_load_dwordx4 v[76:79], v0, s[8:11], s60 offen offset:1024 sc1
s_branch Lrec12_g_124w
Lrec12_r_123x:
s_mov_b32 s43, 0
s_branch Lrec12_g_124
Lrec12_r_125:
s_sub_u32 s43, s43, 1
s_cbranch_scc1 Lrec12_r_125x
buffer_load_dwordx4 v[72:75], v0, s[8:11], s60 offen offset:0 sc1
buffer_load_dwordx4 v[76:79], v0, s[8:11], s60 offen offset:1024 sc1
s_branch Lrec12_g_126w
Lrec12_r_125x:
s_mov_b32 s43, 0
s_branch Lrec12_g_126
Lrec12_last:
s_nop 4
v_permlane32_swap_b32 v104, v106
v_permlane32_swap_b32 v105, v107
v_pk_add_f32 v[104:105], v[104:105], v[106:107]
v_cvt_pk_bf16_f32 v108, v104, v105
v_mov_b32 v109, 0
s_waitcnt lgkmcnt(0)
buffer_store_dword v108, v7, s[4:7], s68 offen sc1
s_branch Lrec_end
Lrec13_in:
ds_read_b128 v[80:83], v5 offset:24576
ds_read_b128 v[84:87], v5 offset:26624
ds_read_b128 v[88:91], v5 offset:24832
ds_read_b128 v[92:95], v5 offset:26880
ds_read_b128 v[124:127], v0 offset:31744
s_waitcnt lgkmcnt(0)
s_barrier
s_add_u32 s81, s81, 8192
s_cmp_eq_u32 s81, s71
s_cselect_b32 s51, 24576, 0
s_sub_u32 s81, s81, s51
s_cmp_eq_u32 s49, 63
s_cselect_b32 s51, -2, s49
s_add_u32 s51, s51, 2
s_min_i32 s82, s82, s83
s_cmp_lt_i32 s82, s51
s_cbranch_scc1 Lrec13_kva
Lrec13_kvda:
s_add_u32 s45, s81, 8192
s_cmp_eq_u32 s45, s71
s_cselect_b32 s51, 24576, 0
s_sub_u32 s45, s45, s51
s_mov_b32 m0, 27648
s_add_u32 s65, s65, 0x4000
buffer_load_dwordx4 v0, s[4:7], s65 offen sc1 lds
s_mov_b32 m0, 31744
s_add_u32 s66, s66, 0x4000
buffer_load_dwordx4 v5, s[4:7], s66 offen sc1 lds
v_pk_mul_f32 v[96:97], v[14:15], v[14:15] op_sel:[1,1] op_sel_hi:[1,1]
v_pk_mul_f32 v[98:99], v[14:15], v[14:15] op_sel:[1,1] op_sel_hi:[1,1]
v_pk_mul_f32 v[100:101], v[14:15], v[14:15] op_sel:[1,1] op_sel_hi:[1,1]
v_pk_mul_f32 v[102:103], v[14:15], v[14:15] op_sel:[1,1] op_sel_hi:[1,1]
ds_read_b128 v[16:19], v0 offset:0
ds_read_b128 v[20:23], v0 offset:1024
ds_read_b128 v[24:27], v0 offset:2048
s_waitcnt lgkmcnt(2)
v_smfmac_f32_16x16x64_bf16 v[96:99], v[16:19], a[0:7], v13
ds_read_b128 v[28:31], v0 offset:3072
v_smfmac_f32_16x16x64_bf16 v[100:103], v[16:19], a[128:135], v13
s_waitcnt lgkmcnt(1)
v_smfmac_f32_16x16x64_bf16 v[96:99], v[20:23], a[8:15], v13
ds_read_b128 v[32:35], v0 offset:4096
v_smfmac_f32_16x16x64_bf16 v[100:103], v[20:23], a[136:143], v13
v_smfmac_f32_16x16x64_bf16 v[96:99], v[24:27], a[16:23], v13
ds_read_b128 v[36:39], v0 offset:5120
v_smfmac_f32_16x16x64_bf16 v[100:103], v[24:27], a[144:151], v13
s_waitcnt lgkmcnt(1)
v_smfmac_f32_16x16x64_bf16 v[96:99], v[28:31], a[24:31], v13
ds_read_b128 v[40:43], v0 offset:6144
v_smfmac_f32_16x16x64_bf16 v[100:103], v[28:31], a[152:159], v13
v_smfmac_f32_16x16x64_bf16 v[96:99], v[32:35], a[32:39], v13
ds_read_b128 v[44:47], v0 offset:7168
v_smfmac_f32_16x16x64_bf16 v[100:103], v[32:35], a[160:167], v13
s_waitcnt lgkmcnt(1)
v_smfmac_f32_16x16x64_bf16 v[96:99], v[36:39], a[40:47], v13
ds_read_b128 v[48:51], v0 offset:8192
v_smfmac_f32_16x16x64_bf16 v[100:103], v[36:39], a[168:175], v13
v_smfmac_f32_16x16x64_bf16 v[96:99], v[40:43], a[48:55], v13
ds_read_b128 v[52:55], v0 offset:9216
v_smfmac_f32_16x16x64_bf16 v[100:103], v[40:43], a[176:183], v13
s_waitcnt lgkmcnt(1)
v_smfmac_f32_16x16x64_bf16 v[96:99], v[44:47], a[56:63], v13
ds_read_b128 v[56:59], v0 offset:10240
v_smfmac_f32_16x16x64_bf16 v[100:103], v[44:47], a[184:191], v13
s_branch Lrec13_p2
Lrec13_p1:
s_add_u32 s49, s49, 1
v_mov_b32 v116, -1
v_mov_b32 v117, -1
s_cmp_le_u32 s49, 61
s_subb_u32 s50, s49, 0
v_mov_b32 v112, s50
s_add_u32 s81, s81, 8192
s_cmp_eq_u32 s81, s71
s_cselect_b32 s51, 24576, 0
s_sub_u32 s81, s81, s51
s_cmp_eq_u32 s49, 63
s_cselect_b32 s51, -2, s49
s_add_u32 s51, s51, 2
s_min_i32 s82, s82, s83
s_cmp_lt_i32 s82, s51
s_cbranch_scc1 Lrec13_kvb
Lrec13_kvdb:
s_add_u32 s45, s81, 8192
s_cmp_eq_u32 s45, s71
s_cselect_b32 s51, 24576, 0
s_sub_u32 s45, s45, s51
s_mov_b32 m0, 0
ds_read_b128 v[80:83], v5 offset:24576
ds_read_b128 v[84:87], v5 offset:26624
ds_read_b128 v[88:91], v5 offset:24832
ds_read_b128 v[92:95], v5 offset:26880
ds_read_b128 v[124:127], v0 offset:31744
s_barrier
buffer_load_dwordx4 v[48:51], v0, s[8:11], s56 offen offset:3072 sc1
buffer_load_dwordx4 v[52:55], v0, s[8:11], s56 offen offset:0 sc1
buffer_load_dwordx4 v[56:59], v0, s[8:11], s56 offen offset:1024 sc1
buffer_load_dwordx4 v[60:63], v0, s[8:11], s56 offen offset:2048 sc1
Lrec13_g_128w:
s_waitcnt vmcnt(3)
v_max3_u32 v122, v48, v49, v50
v_max_u32 v122, v51, v122
s_waitcnt vmcnt(2)
v_max3_u32 v122, v52, v53, v122
v_max3_u32 v122, v54, v55, v122
v_cmp_eq_u32 vcc, -1, v122
buffer_load_dwordx4 v[64:67], v0, s[8:11], s57 offen offset:3072 sc1
buffer_load_dwordx4 v[68:71], v0, s[8:11], s57 offen offset:0 sc1
s_cbranch_vccnz Lrec13_r_127
Lrec13_g_128:
v_lshlrev_b32 v16, 16, v48
v_and_b32 v17, 0xffff0000, v48
v_lshlrev_b32 v18, 16, v49
v_and_b32 v19, 0xffff0000, v49
v_lshlrev_b32 v20, 16, v50
v_and_b32 v21, 0xffff0000, v50
v_lshlrev_b32 v22, 16, v51
v_and_b32 v23, 0xffff0000, v51
v_lshlrev_b32 v24, 16, v52
v_and_b32 v25, 0xffff0000, v52
v_lshlrev_b32 v26, 16, v53
v_and_b32 v27, 0xffff0000, v53
v_lshlrev_b32 v28, 16, v54
v_and_b32 v29, 0xffff0000, v54
v_lshlrev_b32 v30, 16, v55
v_and_b32 v31, 0xffff0000, v55
Lrec13_g_130w:
s_waitcnt vmcnt(3)
v_max3_u32 v122, v56, v57, v58
v_max_u32 v122, v59, v122
s_waitcnt vmcnt(2)
v_max3_u32 v122, v60, v61, v122
v_max3_u32 v122, v62, v63, v122
v_cmp_eq_u32 vcc, -1, v122
buffer_load_dwordx4 v[72:75], v0, s[8:11], s57 offen offset:1024 sc1
buffer_load_dwordx4 v[76:79], v0, s[8:11], s57 offen offset:2048 sc1
s_cbranch_vccnz Lrec13_r_129
Lrec13_g_130:
v_lshlrev_b32 v32, 16, v56
v_and_b32 v33, 0xffff0000, v56
v_lshlrev_b32 v34, 16, v57
v_and_b32 v35, 0xffff0000, v57
v_lshlrev_b32 v36, 16, v58
v_and_b32 v37, 0xffff0000, v58
v_lshlrev_b32 v38, 16, v59
v_and_b32 v39, 0xffff0000, v59
v_lshlrev_b32 v40, 16, v60
v_and_b32 v41, 0xffff0000, v60
v_lshlrev_b32 v42, 16, v61
v_and_b32 v43, 0xffff0000, v61
v_lshlrev_b32 v44, 16, v62
v_and_b32 v45, 0xffff0000, v62
v_lshlrev_b32 v46, 16, v63
v_and_b32 v47, 0xffff0000, v63
Lrec13_g_132w:
s_waitcnt vmcnt(3)
v_max3_u32 v122, v64, v65, v66
v_max_u32 v122, v67, v122
s_waitcnt vmcnt(2)
v_max3_u32 v122, v68, v69, v122
v_max3_u32 v122, v70, v71, v122
v_cmp_eq_u32 vcc, -1, v122
s_cbranch_vccnz Lrec13_r_131
Lrec13_g_132:
v_dot2_f32_bf16 v16, v64, s69, v16
v_dot2_f32_bf16 v17, v64, s70, v17
v_dot2_f32_bf16 v18, v65, s69, v18
v_dot2_f32_bf16 v19, v65, s70, v19
v_dot2_f32_bf16 v20, v66, s69, v20
v_dot2_f32_bf16 v21, v66, s70, v21
v_dot2_f32_bf16 v22, v67, s69, v22
v_dot2_f32_bf16 v23, v67, s70, v23
v_cvt_pk_bf16_f32 v48, v16, v17
v_cvt_pk_bf16_f32 v49, v18, v19
v_cvt_pk_bf16_f32 v50, v20, v21
v_cvt_pk_bf16_f32 v51, v22, v23
ds_write_addtid_b32 v48 offset:15360
ds_write_addtid_b32 v49 offset:15616
ds_write_addtid_b32 v50 offset:15872
ds_write_addtid_b32 v51 offset:16128
v_dot2_f32_bf16 v24, v68, s69, v24
v_dot2_f32_bf16 v25, v68, s70, v25
v_dot2_f32_bf16 v26, v69, s69, v26
v_dot2_f32_bf16 v27, v69, s70, v27
v_dot2_f32_bf16 v28, v70, s69, v28
v_dot2_f32_bf16 v29, v70, s70, v29
v_dot2_f32_bf16 v30, v71, s69, v30
v_dot2_f32_bf16 v31, v71, s70, v31
v_cvt_pk_bf16_f32 v52, v24, v25
v_cvt_pk_bf16_f32 v53, v26, v27
v_cvt_pk_bf16_f32 v54, v28, v29
v_cvt_pk_bf16_f32 v55, v30, v31
ds_write_addtid_b32 v52 offset:12288
ds_write_addtid_b32 v53 offset:12544
ds_write_addtid_b32 v54 offset:12800
ds_write_addtid_b32 v55 offset:13056
Lrec13_g_134w:
s_waitcnt vmcnt(1)
v_max3_u32 v122, v72, v73, v74
v_max_u32 v122, v75, v122
s_waitcnt vmcnt(0)
v_max3_u32 v122, v76, v77, v122
v_max3_u32 v122, v78, v79, v122
v_cmp_eq_u32 vcc, -1, v122
s_cbranch_vccnz Lrec13_r_133
Lrec13_g_134:
v_dot2_f32_bf16 v32, v72, s69, v32
v_dot2_f32_bf16 v33, v72, s70, v33
v_dot2_f32_bf16 v34, v73, s69, v34
v_dot2_f32_bf16 v35, v73, s70, v35
v_dot2_f32_bf16 v36, v74, s69, v36
v_dot2_f32_bf16 v37, v74, s70, v37
v_dot2_f32_bf16 v38, v75, s69, v38
v_dot2_f32_bf16 v39, v75, s70, v39
v_cvt_pk_bf16_f32 v56, v32, v33
v_cvt_pk_bf16_f32 v57, v34, v35
v_cvt_pk_bf16_f32 v58, v36, v37
v_cvt_pk_bf16_f32 v59, v38, v39
ds_write_addtid_b32 v56 offset:13312
ds_write_addtid_b32 v57 offset:13568
ds_write_addtid_b32 v58 offset:13824
ds_write_addtid_b32 v59 offset:14080
v_dot2_f32_bf16 v40, v76, s69, v40
v_dot2_f32_bf16 v41, v76, s70, v41
v_dot2_f32_bf16 v42, v77, s69, v42
v_dot2_f32_bf16 v43, v77, s70, v43
v_dot2_f32_bf16 v44, v78, s69, v44
v_dot2_f32_bf16 v45, v78, s70, v45
v_dot2_f32_bf16 v46, v79, s69, v46
v_dot2_f32_bf16 v47, v79, s70, v47
v_cvt_pk_bf16_f32 v60, v40, v41
v_cvt_pk_bf16_f32 v61, v42, v43
v_cvt_pk_bf16_f32 v62, v44, v45
v_cvt_pk_bf16_f32 v63, v46, v47
ds_write_addtid_b32 v60 offset:14336
ds_write_addtid_b32 v61 offset:14592
ds_write_addtid_b32 v62 offset:14848
ds_write_addtid_b32 v63 offset:15104
v_pk_mul_f32 v[96:97], v[14:15], v[14:15] op_sel:[1,1] op_sel_hi:[1,1]
v_pk_mul_f32 v[98:99], v[14:15], v[14:15] op_sel:[1,1] op_sel_hi:[1,1]
v_pk_mul_f32 v[100:101], v[14:15], v[14:15] op_sel:[1,1] op_sel_hi:[1,1]
v_pk_mul_f32 v[102:103], v[14:15], v[14:15] op_sel:[1,1] op_sel_hi:[1,1]
s_waitcnt lgkmcnt(0)
s_barrier
ds_read_b128 v[16:19], v0 offset:0
ds_read_b128 v[20:23], v0 offset:1024
ds_read_b128 v[24:27], v0 offset:2048
s_mov_b32 m0, 27648
s_add_u32 s65, s65, 0x4000
buffer_load_dwordx4 v0, s[4:7], s65 offen sc1 lds
s_waitcnt lgkmcnt(2)
v_smfmac_f32_16x16x64_bf16 v[96:99], v[16:19], a[0:7], v13
ds_read_b128 v[28:31], v0 offset:3072
v_smfmac_f32_16x16x64_bf16 v[100:103], v[16:19], a[128:135], v13
s_mov_b32 m0, 31744
s_add_u32 s66, s66, 0x4000
buffer_load_dwordx4 v5, s[4:7], s66 offen sc1 lds
s_waitcnt lgkmcnt(1)
v_smfmac_f32_16x16x64_bf16 v[96:99], v[20:23], a[8:15], v13
ds_read_b128 v[32:35], v0 offset:4096
v_smfmac_f32_16x16x64_bf16 v[100:103], v[20:23], a[136:143], v13
buffer_store_dword v108, v7, s[4:7], s68 offen sc1
v_smfmac_f32_16x16x64_bf16 v[96:99], v[24:27], a[16:23], v13
ds_read_b128 v[36:39], v0 offset:5120
v_smfmac_f32_16x16x64_bf16 v[100:103], v[24:27], a[144:151], v13
buffer_store_dwordx2 v[116:117], v2, s[12:15], s59 offen sc1
s_waitcnt lgkmcnt(1)
v_smfmac_f32_16x16x64_bf16 v[96:99], v[28:31], a[24:31], v13
ds_read_b128 v[40:43], v0 offset:6144
v_smfmac_f32_16x16x64_bf16 v[100:103], v[28:31], a[152:159], v13
s_mov_b64 exec, 1
buffer_store_dword v112, v15, s[4:7], s80 offen sc1
s_mov_b64 exec, -1
v_smfmac_f32_16x16x64_bf16 v[96:99], v[32:35], a[32:39], v13
ds_read_b128 v[44:47], v0 offset:7168
v_smfmac_f32_16x16x64_bf16 v[100:103], v[32:35], a[160:167], v13
s_waitcnt lgkmcnt(1)
v_smfmac_f32_16x16x64_bf16 v[96:99], v[36:39], a[40:47], v13
ds_read_b128 v[48:51], v0 offset:8192
v_smfmac_f32_16x16x64_bf16 v[100:103], v[36:39], a[168:175], v13
v_smfmac_f32_16x16x64_bf16 v[96:99], v[40:43], a[48:55], v13
ds_read_b128 v[52:55], v0 offset:9216
v_smfmac_f32_16x16x64_bf16 v[100:103], v[40:43], a[176:183], v13
s_waitcnt lgkmcnt(1)
v_smfmac_f32_16x16x64_bf16 v[96:99], v[44:47], a[56:63], v13
ds_read_b128 v[56:59], v0 offset:10240
v_smfmac_f32_16x16x64_bf16 v[100:103], v[44:47], a[184:191], v13
Lrec13_p2:
v_smfmac_f32_16x16x64_bf16 v[96:99], v[48:51], a[64:71], v13
ds_read_b128 v[60:63], v0 offset:11264
v_smfmac_f32_16x16x64_bf16 v[100:103], v[48:51], a[192:199], v13
s_add_u32 s72, s72, 524288
s_waitcnt lgkmcnt(1)
v_smfmac_f32_16x16x64_bf16 v[96:99], v[52:55], a[72:79], v13
ds_read_b128 v[64:67], v0 offset:12288
v_smfmac_f32_16x16x64_bf16 v[100:103], v[52:55], a[200:207], v13
s_and_b32 s72, s72, 1572864
v_smfmac_f32_16x16x64_bf16 v[96:99], v[56:59], a[80:87], v13
ds_read_b128 v[68:71], v0 offset:13312
v_smfmac_f32_16x16x64_bf16 v[100:103], v[56:59], a[208:215], v13
s_or_b32 s8, s73, s72
s_waitcnt lgkmcnt(1)
v_smfmac_f32_16x16x64_bf16 v[96:99], v[60:63], a[88:95], v13
ds_read_b128 v[72:75], v0 offset:14336
v_smfmac_f32_16x16x64_bf16 v[100:103], v[60:63], a[216:223], v13
s_xor_b32 s12, s8, 1048576
v_smfmac_f32_16x16x64_bf16 v[96:99], v[64:67], a[96:103], v13
ds_read_b128 v[76:79], v0 offset:15360
v_smfmac_f32_16x16x64_bf16 v[100:103], v[64:67], a[224:231], v13
s_and_b32 s50, s49, 3
s_cselect_b32 s50, 0, 0x2000
s_waitcnt lgkmcnt(1)
v_smfmac_f32_16x16x64_bf16 v[96:99], v[68:71], a[104:111], v13
v_smfmac_f32_16x16x64_bf16 v[100:103], v[68:71], a[232:239], v13
s_add_u32 s50, s50, 0x800
v_smfmac_f32_16x16x64_bf16 v[96:99], v[72:75], a[112:119], v13
v_smfmac_f32_16x16x64_bf16 v[100:103], v[72:75], a[240:247], v13
s_add_u32 s68, s68, s50
s_waitcnt lgkmcnt(0)
v_smfmac_f32_16x16x64_bf16 v[96:99], v[76:79], a[120:127], v13
v_smfmac_f32_16x16x64_bf16 v[100:103], v[76:79], a[248:255], v13
s_add_u32 s67, s67, s50
s_nop 6
v_permlane32_swap_b32 v96, v100
v_permlane32_swap_b32 v97, v101
v_permlane32_swap_b32 v98, v102
v_permlane32_swap_b32 v99, v103
v_pk_add_f32 v[96:97], v[96:97], v[100:101]
v_pk_add_f32 v[98:99], v[98:99], v[102:103]
v_cvt_pk_bf16_f32 v96, v96, v97
v_cvt_pk_bf16_f32 v97, v98, v99
ds_write_b64 v8, v[96:97]
s_waitcnt lgkmcnt(0)
s_barrier
ds_read_b64_tr_b16 v[96:97], v9 offset:0
ds_read_b64_tr_b16 v[98:99], v9 offset:64
ds_read_b64_tr_b16 v[104:105], v9 offset:1152
ds_read_b64_tr_b16 v[106:107], v9 offset:1216
ds_read_b64_tr_b16 v[100:101], v9 offset:256
ds_read_b64_tr_b16 v[102:103], v9 offset:320
ds_read_b64_tr_b16 v[108:109], v9 offset:1408
ds_read_b64_tr_b16 v[110:111], v9 offset:1472
s_waitcnt lgkmcnt(4)
v_mfma_f32_16x16x32_bf16 v[120:123], v[104:107], v[96:99], 0
s_waitcnt lgkmcnt(0)
v_mfma_f32_16x16x32_bf16 v[120:123], v[108:111], v[100:103], v[120:123]
v_mfma_f32_16x16x32_bf16 v[112:115], v[80:83], v[96:99], 0
v_mfma_f32_16x16x32_bf16 v[112:115], v[84:87], v[100:103], v[112:115]
s_mov_b32 exec_lo, 0x0
s_mov_b32 exec_hi, 0xff00ff
s_nop 3
buffer_store_dword v122, v3, s[8:11], s63 offen offset:1024 sc1
s_lshl_b64 exec, exec, 8
buffer_store_dword v123, v3, s[8:11], s63 offen offset:1024 sc1
s_mov_b64 exec, -1
v_mfma_f32_16x16x32_bf16 v[116:119], v[88:91], v[96:99], 0
v_mfma_f32_16x16x32_bf16 v[116:119], v[92:95], v[100:103], v[116:119]
v_pk_mul_f32 v[104:105], v[14:15], v[14:15] op_sel:[1,1] op_sel_hi:[1,1]
v_pk_mul_f32 v[106:107], v[14:15], v[14:15] op_sel:[1,1] op_sel_hi:[1,1]
s_nop 1
v_smfmac_f32_16x16x64_bf16 v[104:107], v[16:19], v[128:135], v13
s_buffer_load_dword s82, s[4:7], s45 glc
v_smfmac_f32_16x16x64_bf16 v[104:107], v[20:23], v[136:143], v13
s_buffer_load_dword s83, s[4:7], s45 offset:128 glc
v_smfmac_f32_16x16x64_bf16 v[104:107], v[24:27], v[144:151], v13
v_cndmask_b32 v112, v112, v116, s[76:77]
v_smfmac_f32_16x16x64_bf16 v[104:107], v[28:31], v[152:159], v13
v_cndmask_b32 v113, v113, v117, s[76:77]
v_smfmac_f32_16x16x64_bf16 v[104:107], v[32:35], v[160:167], v13
v_cndmask_b32 v114, v114, v118, s[76:77]
v_smfmac_f32_16x16x64_bf16 v[104:107], v[36:39], v[168:175], v13
v_cndmask_b32 v115, v115, v119, s[76:77]
buffer_load_dwordx4 v[88:91], v0, s[8:11], s64 offen sc1
buffer_load_dword v92, v3, s[8:11], s64 offen offset:1024 sc1
v_smfmac_f32_16x16x64_bf16 v[104:107], v[40:43], v[176:183], v13
v_cndmask_b32 v120, v120, v122, s[78:79]
v_smfmac_f32_16x16x64_bf16 v[104:107], v[44:47], v[184:191], v13
v_cndmask_b32 v121, v121, v123, s[78:79]
v_smfmac_f32_16x16x64_bf16 v[104:107], v[48:51], v[192:199], v13
v_cndmask_b32 v116, v120, v121, s[76:77]
v_smfmac_f32_16x16x64_bf16 v[104:107], v[52:55], v[200:207], v13
s_cmp_eq_u32 s49, 63
v_smfmac_f32_16x16x64_bf16 v[104:107], v[56:59], v[208:215], v13
v_smfmac_f32_16x16x64_bf16 v[104:107], v[60:63], v[216:223], v13
v_smfmac_f32_16x16x64_bf16 v[104:107], v[64:67], v[224:231], v13
v_smfmac_f32_16x16x64_bf16 v[104:107], v[68:71], v[232:239], v13
v_smfmac_f32_16x16x64_bf16 v[104:107], v[72:75], v[240:247], v13
v_smfmac_f32_16x16x64_bf16 v[104:107], v[76:79], v[248:255], v13
buffer_load_dwordx4 v[54:57], v0, s[8:11], s64 offen sc1
buffer_load_dword v58, v3, s[8:11], s64 offen offset:1024 sc1
s_cbranch_scc1 Lrec13_last
s_waitcnt vmcnt(2)
v_max3_u32 v53, v88, v89, v90
v_max3_u32 v53, v91, v92, v53
v_cmp_eq_u32 vcc, -1, v53
s_cbranch_vccnz Lrec13_ps
Lrec13_ps1:
v_pk_add_f32 v[112:113], v[112:113], v[88:89]
v_pk_add_f32 v[114:115], v[114:115], v[90:91]
v_add_f32 v116, v116, v92
Lrec13_ps2:
v_max3_f32 v60, v112, v113, v114
v_max3_f32 v60, v115, v116, v60
v_mov_b32 v65, 0
v_mov_b32 v109, 0
v_max_f32_dpp v60, v60, v60 row_ror:8 row_mask:0xf bank_mask:0xf
v_mov_b32 v61, v60
v_permlane32_swap_b32 v104, v106
v_permlane32_swap_b32 v105, v107
v_permlane32_swap_b32 v60, v61
v_max_f32 v60, v60, v61
v_mov_b32 v61, v60
v_pk_add_f32 v[104:105], v[104:105], v[106:107]
v_cvt_pk_bf16_f32 v108, v104, v105
v_permlane16_swap_b32 v60, v61
v_max_f32 v60, v60, v61
v_mul_f32 v60, s84, v60
v_fma_f32 v116, v116, s84, -v60
v_pk_fma_f32 v[112:113], v[112:113], s[84:85], v[60:61] op_sel_hi:[1,1,0] neg_lo:[0,0,1] neg_hi:[0,0,1]
v_exp_f32 v116, v116
v_pk_fma_f32 v[114:115], v[114:115], s[84:85], v[60:61] op_sel_hi:[1,1,0] neg_lo:[0,0,1] neg_hi:[0,0,1]
v_exp_f32 v112, v112
v_cvt_pk_bf16_f32 v64, v116, v15
v_exp_f32 v113, v113
v_lshlrev_b32 v64, v14, v64
v_exp_f32 v114, v114
v_exp_f32 v115, v115
v_mfma_f32_16x16x16_bf16 v[68:71], v[108:109], v[64:65], 0
v_cvt_pk_bf16_f32 v62, v112, v113
v_cvt_pk_bf16_f32 v63, v114, v115
v_pk_add_f32 v[112:113], v[112:113], v[114:115]
v_add_f32 v60, v116, v112
v_mfma_f32_16x16x16_bf16 v[76:79], v[126:127], v[62:63], v[68:71]
v_mfma_f32_16x16x16_bf16 v[72:75], v[124:125], v[62:63], v[68:71]
v_add_f32 v60, v60, v113
s_nop 1
v_add_f32_dpp v60, v60, v60 row_ror:8 row_mask:0xf bank_mask:0xf
v_mov_b32 v61, v60
s_nop 1
v_permlane32_swap_b32 v60, v61
v_add_f32 v60, v60, v61
v_mov_b32 v61, v60
v_add_f32_dpp v72, v76, v72 row_ror:8 row_mask:0xf bank_mask:0xf
v_add_f32_dpp v73, v77, v73 row_ror:8 row_mask:0xf bank_mask:0xf
v_permlane16_swap_b32 v60, v61
v_add_f32 v60, v60, v61
v_rcp_f32 v60, v60
v_add_f32_dpp v74, v78, v74 row_ror:8 row_mask:0xf bank_mask:0xf
v_add_f32_dpp v75, v79, v75 row_ror:8 row_mask:0xf bank_mask:0xf
v_pk_mul_f32 v[72:73], v[72:73], v[60:61] op_sel_hi:[1,0]
v_pk_mul_f32 v[74:75], v[74:75], v[60:61] op_sel_hi:[1,0]
v_cvt_pk_bf16_f32 v120, v72, v73
v_cvt_pk_bf16_f32 v121, v74, v75
s_mov_b64 exec, s[74:75]
buffer_store_dwordx2 v[120:121], v4, s[8:11], s62 offen offset:0 sc1
s_mov_b64 exec, -1
s_cmp_ge_u32 s49, 61
s_cbranch_scc1 Lrec13_early
Lrec13_earlyd:
v_pk_mul_f32 v[112:113], v[14:15], v[14:15] op_sel:[1,1] op_sel_hi:[1,1]
v_pk_mul_f32 v[114:115], v[14:15], v[14:15] op_sel:[1,1] op_sel_hi:[1,1]
v_pk_mul_f32 v[116:117], v[14:15], v[14:15] op_sel:[1,1] op_sel_hi:[1,1]
v_pk_mul_f32 v[118:119], v[14:15], v[14:15] op_sel:[1,1] op_sel_hi:[1,1]
s_waitcnt vmcnt(1)
ds_read_b128 v[80:83], v12 offset:12288
ds_read_b128 v[84:87], v12 offset:13312
ds_read_b128 v[88:91], v12 offset:14336
ds_read_b128 v[92:95], v12 offset:15360
ds_read_b128 v[96:99], v6 offset:0
ds_read_b128 v[100:103], v6 offset:1024
ds_read_b128 v[16:19], v6 offset:2048
ds_read_b128 v[20:23], v6 offset:3072
ds_read_b128 v[24:27], v6 offset:4096
ds_read_b128 v[28:31], v6 offset:5120
ds_read_b128 v[32:35], v6 offset:6144
ds_read_b128 v[36:39], v6 offset:7168
ds_read_b128 v[40:43], v6 offset:8192
ds_read_b128 v[44:47], v6 offset:9216
s_waitcnt vmcnt(0)
buffer_load_dwordx4 v[48:51], v0, s[8:11], s60 offen offset:3072 sc1
buffer_load_dwordx4 v[52:55], v0, s[8:11], s61 offen offset:0 sc1
buffer_load_dwordx4 v[56:59], v0, s[8:11], s61 offen offset:1024 sc1
buffer_load_dwordx4 v[60:63], v0, s[8:11], s61 offen offset:2048 sc1
Lrec13_g_136w:
s_waitcnt vmcnt(3)
v_max3_u32 v104, v48, v49, v50
v_max_u32 v104, v51, v104
s_waitcnt vmcnt(2)
v_max3_u32 v104, v52, v53, v104
v_max3_u32 v104, v54, v55, v104
v_cmp_eq_u32 vcc, -1, v104
buffer_load_dwordx4 v[64:67], v0, s[8:11], s61 offen offset:3072 sc1
buffer_load_dwordx4 v[68:71], v0, s[8:11], s60 offen offset:0 sc1
s_cbranch_vccnz Lrec13_r_135
Lrec13_g_136:
s_waitcnt lgkmcnt(12)
v_smfmac_f32_16x16x64_bf16 v[112:115], v[48:51], v[80:87], v13
ds_read_b128 v[80:83], v6 offset:10240
ds_read_b128 v[84:87], v6 offset:11264
s_waitcnt lgkmcnt(12)
v_smfmac_f32_16x16x64_bf16 v[116:119], v[48:51], v[88:95], v13
ds_read_b128 v[88:91], v6 offset:12288
ds_read_b128 v[92:95], v6 offset:13312
s_waitcnt lgkmcnt(12)
v_smfmac_f32_16x16x64_bf16 v[112:115], v[52:55], v[96:103], v13
ds_read_b128 v[96:99], v6 offset:14336
ds_read_b128 v[100:103], v6 offset:15360
s_waitcnt lgkmcnt(12)
v_smfmac_f32_16x16x64_bf16 v[116:119], v[52:55], v[16:23], v13
ds_read_b128 v[16:19], v12 offset:0
ds_read_b128 v[20:23], v12 offset:1024
Lrec13_g_138w:
s_waitcnt vmcnt(3)
v_max3_u32 v104, v56, v57, v58
v_max_u32 v104, v59, v104
s_waitcnt vmcnt(2)
v_max3_u32 v104, v60, v61, v104
v_max3_u32 v104, v62, v63, v104
v_cmp_eq_u32 vcc, -1, v104
buffer_load_dwordx4 v[72:75], v0, s[8:11], s60 offen offset:1024 sc1
buffer_load_dwordx4 v[76:79], v0, s[8:11], s60 offen offset:2048 sc1
s_cbranch_vccnz Lrec13_r_137
Lrec13_g_138:
s_waitcnt lgkmcnt(12)
v_smfmac_f32_16x16x64_bf16 v[112:115], v[56:59], v[24:31], v13
ds_read_b128 v[24:27], v12 offset:2048
ds_read_b128 v[28:31], v12 offset:3072
s_waitcnt lgkmcnt(12)
v_smfmac_f32_16x16x64_bf16 v[116:119], v[56:59], v[32:39], v13
ds_read_b128 v[32:35], v12 offset:4096
ds_read_b128 v[36:39], v12 offset:5120
s_waitcnt lgkmcnt(12)
v_smfmac_f32_16x16x64_bf16 v[112:115], v[60:63], v[40:47], v13
ds_read_b128 v[40:43], v12 offset:6144
ds_read_b128 v[44:47], v12 offset:7168
s_waitcnt lgkmcnt(12)
v_smfmac_f32_16x16x64_bf16 v[116:119], v[60:63], v[80:87], v13
ds_read_b128 v[80:83], v12 offset:8192
ds_read_b128 v[84:87], v12 offset:9216
Lrec13_g_140w:
s_waitcnt vmcnt(3)
v_max3_u32 v104, v64, v65, v66
v_max_u32 v104, v67, v104
s_waitcnt vmcnt(2)
v_max3_u32 v104, v68, v69, v104
v_max3_u32 v104, v70, v71, v104
v_cmp_eq_u32 vcc, -1, v104
s_cbranch_vccnz Lrec13_r_139
Lrec13_g_140:
s_waitcnt lgkmcnt(12)
v_smfmac_f32_16x16x64_bf16 v[112:115], v[64:67], v[88:95], v13
ds_read_b128 v[88:91], v12 offset:10240
ds_read_b128 v[92:95], v12 offset:11264
s_waitcnt lgkmcnt(12)
v_smfmac_f32_16x16x64_bf16 v[116:119], v[64:67], v[96:103], v13
s_waitcnt lgkmcnt(10)
v_smfmac_f32_16x16x64_bf16 v[112:115], v[68:71], v[16:23], v13
s_waitcnt lgkmcnt(8)
v_smfmac_f32_16x16x64_bf16 v[116:119], v[68:71], v[24:31], v13
Lrec13_g_142w:
s_waitcnt vmcnt(1)
v_max3_u32 v104, v72, v73, v74
v_max_u32 v104, v75, v104
s_waitcnt vmcnt(0)
v_max3_u32 v104, v76, v77, v104
v_max3_u32 v104, v78, v79, v104
v_cmp_eq_u32 vcc, -1, v104
s_cbranch_vccnz Lrec13_r_141
Lrec13_g_142:
s_waitcnt lgkmcnt(6)
v_smfmac_f32_16x16x64_bf16 v[112:115], v[72:75], v[32:39], v13
s_waitcnt lgkmcnt(4)
v_smfmac_f32_16x16x64_bf16 v[116:119], v[72:75], v[40:47], v13
s_waitcnt lgkmcnt(2)
v_smfmac_f32_16x16x64_bf16 v[112:115], v[76:79], v[80:87], v13
s_waitcnt lgkmcnt(0)
v_smfmac_f32_16x16x64_bf16 v[116:119], v[76:79], v[88:95], v13
s_nop 7
v_permlane32_swap_b32 v112, v116
v_permlane32_swap_b32 v113, v117
v_permlane32_swap_b32 v114, v118
v_permlane32_swap_b32 v115, v119
v_pk_add_f32 v[112:113], v[112:113], v[116:117]
ds_write2_b32 v10, v112, v113 offset1:32
v_pk_add_f32 v[114:115], v[114:115], v[118:119]
ds_write2_b32 v10, v114, v115 offset0:64 offset1:96
s_waitcnt lgkmcnt(0)
s_barrier
v_mov_b32 v16, -1
v_mov_b32 v17, -1
buffer_store_dwordx2 v[16:17], v2, s[12:15], s46 offen offset:512 sc1
s_branch Lrec13_p1
Lrec13_kva:
s_sub_u32 s43, s43, 1
s_cbranch_scc1 Lrec13_kvxa
s_buffer_load_dword s82, s[4:7], s81 glc
s_buffer_load_dword s83, s[4:7], s81 offset:128 glc
s_waitcnt lgkmcnt(0)
s_min_i32 s82, s82, s83
s_cmp_lt_i32 s82, s51
s_cbranch_scc1 Lrec13_kva
s_branch Lrec13_kvda
Lrec13_kvxa:
s_mov_b32 s43, 0
s_branch Lrec13_kvda
Lrec13_kvb:
s_sub_u32 s43, s43, 1
s_cbranch_scc1 Lrec13_kvxb
s_buffer_load_dword s82, s[4:7], s81 glc
s_buffer_load_dword s83, s[4:7], s81 offset:128 glc
s_waitcnt lgkmcnt(0)
s_min_i32 s82, s82, s83
s_cmp_lt_i32 s82, s51
s_cbranch_scc1 Lrec13_kvb
s_branch Lrec13_kvdb
Lrec13_kvxb:
s_mov_b32 s43, 0
s_branch Lrec13_kvdb
Lrec13_r_127:
s_sub_u32 s43, s43, 1
s_cbranch_scc1 Lrec13_r_127x
buffer_load_dwordx4 v[48:51], v0, s[8:11], s56 offen offset:3072 sc1
buffer_load_dwordx4 v[52:55], v0, s[8:11], s56 offen offset:0 sc1
buffer_load_dwordx4 v[56:59], v0, s[8:11], s56 offen offset:1024 sc1
buffer_load_dwordx4 v[60:63], v0, s[8:11], s56 offen offset:2048 sc1
s_branch Lrec13_g_128w
Lrec13_r_127x:
s_mov_b32 s43, 0
s_branch Lrec13_g_128
Lrec13_r_129:
s_sub_u32 s43, s43, 1
s_cbranch_scc1 Lrec13_r_129x
buffer_load_dwordx4 v[56:59], v0, s[8:11], s56 offen offset:1024 sc1
buffer_load_dwordx4 v[60:63], v0, s[8:11], s56 offen offset:2048 sc1
buffer_load_dwordx4 v[64:67], v0, s[8:11], s57 offen offset:3072 sc1
buffer_load_dwordx4 v[68:71], v0, s[8:11], s57 offen offset:0 sc1
s_branch Lrec13_g_130w
Lrec13_r_129x:
s_mov_b32 s43, 0
s_branch Lrec13_g_130
Lrec13_r_131:
s_sub_u32 s43, s43, 1
s_cbranch_scc1 Lrec13_r_131x
buffer_load_dwordx4 v[64:67], v0, s[8:11], s57 offen offset:3072 sc1
buffer_load_dwordx4 v[68:71], v0, s[8:11], s57 offen offset:0 sc1
buffer_load_dwordx4 v[72:75], v0, s[8:11], s57 offen offset:1024 sc1
buffer_load_dwordx4 v[76:79], v0, s[8:11], s57 offen offset:2048 sc1
s_branch Lrec13_g_132w
Lrec13_r_131x:
s_mov_b32 s43, 0
s_branch Lrec13_g_132
Lrec13_r_133:
s_sub_u32 s43, s43, 1
s_cbranch_scc1 Lrec13_r_133x
buffer_load_dwordx4 v[72:75], v0, s[8:11], s57 offen offset:1024 sc1
buffer_load_dwordx4 v[76:79], v0, s[8:11], s57 offen offset:2048 sc1
s_branch Lrec13_g_134w
Lrec13_r_133x:
s_mov_b32 s43, 0
s_branch Lrec13_g_134
Lrec13_ps:
buffer_load_dwordx4 v[88:91], v0, s[8:11], s64 offen sc1
buffer_load_dword v92, v3, s[8:11], s64 offen offset:1024 sc1
s_waitcnt vmcnt(2)
v_max3_u32 v53, v54, v55, v56
v_max3_u32 v53, v57, v58, v53
v_cmp_eq_u32 vcc, -1, v53
s_cbranch_vccz Lrec13_psq
buffer_load_dwordx4 v[54:57], v0, s[8:11], s64 offen sc1
buffer_load_dword v58, v3, s[8:11], s64 offen offset:1024 sc1
s_waitcnt vmcnt(2)
v_max3_u32 v53, v88, v89, v90
v_max3_u32 v53, v91, v92, v53
v_cmp_eq_u32 vcc, -1, v53
s_cbranch_vccz Lrec13_ps1
s_sub_u32 s43, s43, 1
s_cbranch_scc0 Lrec13_ps
s_mov_b32 s43, 0
s_branch Lrec13_ps1
Lrec13_psq:
v_pk_add_f32 v[112:113], v[112:113], v[54:55]
v_pk_add_f32 v[114:115], v[114:115], v[56:57]
v_add_f32 v116, v116, v58
s_branch Lrec13_ps2
Lrec13_early:
s_waitcnt lgkmcnt(0)
buffer_store_dword v108, v7, s[4:7], s68 offen sc1
s_branch Lrec13_earlyd
Lrec13_r_135:
s_sub_u32 s43, s43, 1
s_cbranch_scc1 Lrec13_r_135x
buffer_load_dwordx4 v[48:51], v0, s[8:11], s60 offen offset:3072 sc1
buffer_load_dwordx4 v[52:55], v0, s[8:11], s61 offen offset:0 sc1
buffer_load_dwordx4 v[56:59], v0, s[8:11], s61 offen offset:1024 sc1
buffer_load_dwordx4 v[60:63], v0, s[8:11], s61 offen offset:2048 sc1
s_branch Lrec13_g_136w
Lrec13_r_135x:
s_mov_b32 s43, 0
s_branch Lrec13_g_136
Lrec13_r_137:
s_sub_u32 s43, s43, 1
s_cbranch_scc1 Lrec13_r_137x
buffer_load_dwordx4 v[56:59], v0, s[8:11], s61 offen offset:1024 sc1
buffer_load_dwordx4 v[60:63], v0, s[8:11], s61 offen offset:2048 sc1
buffer_load_dwordx4 v[64:67], v0, s[8:11], s61 offen offset:3072 sc1
buffer_load_dwordx4 v[68:71], v0, s[8:11], s60 offen offset:0 sc1
s_branch Lrec13_g_138w
Lrec13_r_137x:
s_mov_b32 s43, 0
s_branch Lrec13_g_138
Lrec13_r_139:
s_sub_u32 s43, s43, 1
s_cbranch_scc1 Lrec13_r_139x
buffer_load_dwordx4 v[64:67], v0, s[8:11], s61 offen offset:3072 sc1
buffer_load_dwordx4 v[68:71], v0, s[8:11], s60 offen offset:0 sc1
buffer_load_dwordx4 v[72:75], v0, s[8:11], s60 offen offset:1024 sc1
buffer_load_dwordx4 v[76:79], v0, s[8:11], s60 offen offset:2048 sc1
s_branch Lrec13_g_140w
Lrec13_r_139x:
s_mov_b32 s43, 0
s_branch Lrec13_g_140
Lrec13_r_141:
s_sub_u32 s43, s43, 1
s_cbranch_scc1 Lrec13_r_141x
buffer_load_dwordx4 v[72:75], v0, s[8:11], s60 offen offset:1024 sc1
buffer_load_dwordx4 v[76:79], v0, s[8:11], s60 offen offset:2048 sc1
s_branch Lrec13_g_142w
Lrec13_r_141x:
s_mov_b32 s43, 0
s_branch Lrec13_g_142
Lrec13_last:
s_nop 4
v_permlane32_swap_b32 v104, v106
v_permlane32_swap_b32 v105, v107
v_pk_add_f32 v[104:105], v[104:105], v[106:107]
v_cvt_pk_bf16_f32 v108, v104, v105
v_mov_b32 v109, 0
s_waitcnt lgkmcnt(0)
buffer_store_dword v108, v7, s[4:7], s68 offen sc1
s_branch Lrec_end
Lrec_end:
s_waitcnt vmcnt(0) lgkmcnt(0)
s_barrier
s_cmp_lg_u32 s42, 0
s_cbranch_scc1 Lrec_end2
v_mov_b32 v16, 64
s_mov_b64 exec, 1
buffer_store_dword v16, v15, s[4:7], s80 offen sc1
s_mov_b64 exec, -1
Lrec_end2:
s_branch Lp4
Lbulk:
s_sub_u32 s45, s40, 64
v_mbcnt_lo_u32_b32 v56, -1, 0
v_mbcnt_hi_u32_b32 v56, -1, v56
v_lshlrev_b32 v0, 4, v56
v_mov_b32 v3, 0
v_lshrrev_b32 v88, 9, v0
s_mov_b32 s79, 0
s_lshr_b32 s46, s45, 6
s_cmp_lt_u32 s46, 2
s_cselect_b32 s50, 1, 0
s_xor_b32 s46, s46, s50
s_bfe_u32 s68, s45, 0x10005
s_and_b32 s50, s45, 31
s_cmp_eq_u32 s68, 0
s_cselect_b32 s74, s22, s24
s_cselect_b32 s75, s23, s25
s_mov_b32 s57, 67108864
s_cselect_b32 s57, 33554432, s57
s_cselect_b32 s53, 10, 11
s_add_u32 s76, s74, 128
s_addc_u32 s77, s75, 0
s_mov_b32 s14, 8388480
s_mov_b32 s66, 8192
s_lshl_b32 s67, s50, 8
s_lshl_b32 s51, s46, 5
s_add_u32 s51, s51, s50
s_lshl_b32 s52, s51, 1
s_add_u32 s59, s52, s68
s_lshl_b32 s59, s59, 7
s_add_u32 s59, s59, 133169152
s_lshl_b32 s51, s50, 6
s_add_u32 s51, s51, s46
s_lshl_b32 s51, s51, 14
s_add_u32 s57, s57, s51
s_lshl_b32 s51, s42, s53
s_add_u32 s57, s57, s51
s_sub_u32 s51, s8, s38
s_add_u32 s57, s57, s51
s_mov_b32 s58, 0xc000
s_lshl_b32 s49, s46, 16
s_mov_b32 s56, 0x30000
s_mov_b32 s48, 3
s_cmp_eq_u32 s46, 0
s_cselect_b32 s47, 22, 21
s_cmp_lg_u32 s2, 0
s_cbranch_scc1 Lln_143
v_add_u32 v246, 131072, v246
v_add_u32 v247, 131072, v247
s_waitcnt vmcnt(4)
v_lshlrev_b32 v208, 16, v192
v_and_b32 v209, 0xffff0000, v192
v_lshlrev_b32 v210, 16, v193
v_and_b32 v211, 0xffff0000, v193
v_lshlrev_b32 v212, 16, v194
v_and_b32 v213, 0xffff0000, v194
v_lshlrev_b32 v214, 16, v195
v_and_b32 v215, 0xffff0000, v195
v_lshlrev_b32 v216, 16, v196
v_and_b32 v217, 0xffff0000, v196
v_lshlrev_b32 v218, 16, v197
v_and_b32 v219, 0xffff0000, v197
v_lshlrev_b32 v220, 16, v198
v_and_b32 v221, 0xffff0000, v198
v_lshlrev_b32 v222, 16, v199
v_and_b32 v223, 0xffff0000, v199
v_lshlrev_b32 v224, 16, v200
v_and_b32 v225, 0xffff0000, v200
v_lshlrev_b32 v226, 16, v201
v_and_b32 v227, 0xffff0000, v201
v_lshlrev_b32 v228, 16, v202
v_and_b32 v229, 0xffff0000, v202
v_lshlrev_b32 v230, 16, v203
v_and_b32 v231, 0xffff0000, v203
v_lshlrev_b32 v232, 16, v204
v_and_b32 v233, 0xffff0000, v204
v_lshlrev_b32 v234, 16, v205
v_and_b32 v235, 0xffff0000, v205
v_lshlrev_b32 v236, 16, v206
v_and_b32 v237, 0xffff0000, v206
v_lshlrev_b32 v238, 16, v207
v_and_b32 v239, 0xffff0000, v207
v_pk_add_f32 v[242:243], v[208:209], v[210:211]
v_pk_add_f32 v[242:243], v[242:243], v[212:213]
v_pk_add_f32 v[242:243], v[242:243], v[214:215]
v_pk_add_f32 v[242:243], v[242:243], v[216:217]
v_pk_add_f32 v[242:243], v[242:243], v[218:219]
v_pk_add_f32 v[242:243], v[242:243], v[220:221]
v_pk_add_f32 v[242:243], v[242:243], v[222:223]
v_pk_add_f32 v[242:243], v[242:243], v[224:225]
v_pk_add_f32 v[242:243], v[242:243], v[226:227]
v_pk_add_f32 v[242:243], v[242:243], v[228:229]
v_pk_add_f32 v[242:243], v[242:243], v[230:231]
v_pk_add_f32 v[242:243], v[242:243], v[232:233]
v_pk_add_f32 v[242:243], v[242:243], v[234:235]
v_pk_add_f32 v[242:243], v[242:243], v[236:237]
v_pk_add_f32 v[242:243], v[242:243], v[238:239]
v_add_f32 v240, v242, v243
s_nop 1
v_add_f32_dpp v240, v240, v240 row_ror:8 row_mask:0xf bank_mask:0xf
v_mov_b32 v241, v240
s_nop 1
v_permlane16_swap_b32 v240, v241
v_add_f32 v240, v240, v241
v_mov_b32 v241, v240
s_nop 1
v_permlane32_swap_b32 v240, v241
v_add_f32 v240, v240, v241
ds_write_b32 v246, v240 offset:0
s_waitcnt lgkmcnt(0)
s_barrier
ds_read_b128 v[242:245], v247 offset:0
s_waitcnt lgkmcnt(0)
v_pk_add_f32 v[242:243], v[242:243], v[244:245]
v_add_f32 v240, v242, v243
v_mul_f32 v240, 0xba800000, v240
v_mov_b32 v250, v240
v_cvt_pk_bf16_f32 v250, v250, v250
v_and_b32 v250, 0xffff0000, v250
v_sub_f32 v250, v250, v240
v_pk_add_f32 v[208:209], v[208:209], v[240:241] op_sel_hi:[1,0]
v_pk_add_f32 v[210:211], v[210:211], v[240:241] op_sel_hi:[1,0]
v_pk_add_f32 v[212:213], v[212:213], v[240:241] op_sel_hi:[1,0]
v_pk_add_f32 v[214:215], v[214:215], v[240:241] op_sel_hi:[1,0]
v_pk_add_f32 v[216:217], v[216:217], v[240:241] op_sel_hi:[1,0]
v_pk_add_f32 v[218:219], v[218:219], v[240:241] op_sel_hi:[1,0]
v_pk_add_f32 v[220:221], v[220:221], v[240:241] op_sel_hi:[1,0]
v_pk_add_f32 v[222:223], v[222:223], v[240:241] op_sel_hi:[1,0]
v_pk_add_f32 v[224:225], v[224:225], v[240:241] op_sel_hi:[1,0]
v_pk_add_f32 v[226:227], v[226:227], v[240:241] op_sel_hi:[1,0]
v_pk_add_f32 v[228:229], v[228:229], v[240:241] op_sel_hi:[1,0]
v_pk_add_f32 v[230:231], v[230:231], v[240:241] op_sel_hi:[1,0]
v_pk_add_f32 v[232:233], v[232:233], v[240:241] op_sel_hi:[1,0]
v_pk_add_f32 v[234:235], v[234:235], v[240:241] op_sel_hi:[1,0]
v_pk_add_f32 v[236:237], v[236:237], v[240:241] op_sel_hi:[1,0]
v_pk_add_f32 v[238:239], v[238:239], v[240:241] op_sel_hi:[1,0]
v_pk_mul_f32 v[242:243], v[208:209], v[208:209]
v_pk_fma_f32 v[242:243], v[210:211], v[210:211], v[242:243]
v_pk_fma_f32 v[242:243], v[212:213], v[212:213], v[242:243]
v_pk_fma_f32 v[242:243], v[214:215], v[214:215], v[242:243]
v_pk_fma_f32 v[242:243], v[216:217], v[216:217], v[242:243]
v_pk_fma_f32 v[242:243], v[218:219], v[218:219], v[242:243]
v_pk_fma_f32 v[242:243], v[220:221], v[220:221], v[242:243]
v_pk_fma_f32 v[242:243], v[222:223], v[222:223], v[242:243]
v_pk_fma_f32 v[242:243], v[224:225], v[224:225], v[242:243]
v_pk_fma_f32 v[242:243], v[226:227], v[226:227], v[242:243]
v_pk_fma_f32 v[242:243], v[228:229], v[228:229], v[242:243]
v_pk_fma_f32 v[242:243], v[230:231], v[230:231], v[242:243]
v_pk_fma_f32 v[242:243], v[232:233], v[232:233], v[242:243]
v_pk_fma_f32 v[242:243], v[234:235], v[234:235], v[242:243]
v_pk_fma_f32 v[242:243], v[236:237], v[236:237], v[242:243]
v_pk_fma_f32 v[242:243], v[238:239], v[238:239], v[242:243]
v_add_f32 v240, v242, v243
v_pk_add_f32 v[208:209], v[208:209], v[250:251] op_sel_hi:[1,0]
v_pk_add_f32 v[210:211], v[210:211], v[250:251] op_sel_hi:[1,0]
v_pk_add_f32 v[212:213], v[212:213], v[250:251] op_sel_hi:[1,0]
v_pk_add_f32 v[214:215], v[214:215], v[250:251] op_sel_hi:[1,0]
v_pk_add_f32 v[216:217], v[216:217], v[250:251] op_sel_hi:[1,0]
v_pk_add_f32 v[218:219], v[218:219], v[250:251] op_sel_hi:[1,0]
v_pk_add_f32 v[220:221], v[220:221], v[250:251] op_sel_hi:[1,0]
v_pk_add_f32 v[222:223], v[222:223], v[250:251] op_sel_hi:[1,0]
v_pk_add_f32 v[224:225], v[224:225], v[250:251] op_sel_hi:[1,0]
v_pk_add_f32 v[226:227], v[226:227], v[250:251] op_sel_hi:[1,0]
v_pk_add_f32 v[228:229], v[228:229], v[250:251] op_sel_hi:[1,0]
v_pk_add_f32 v[230:231], v[230:231], v[250:251] op_sel_hi:[1,0]
v_pk_add_f32 v[232:233], v[232:233], v[250:251] op_sel_hi:[1,0]
v_pk_add_f32 v[234:235], v[234:235], v[250:251] op_sel_hi:[1,0]
v_pk_add_f32 v[236:237], v[236:237], v[250:251] op_sel_hi:[1,0]
v_pk_add_f32 v[238:239], v[238:239], v[250:251] op_sel_hi:[1,0]
v_cvt_pk_bf16_f32 v192, v208, v209
v_cvt_pk_bf16_f32 v193, v210, v211
v_cvt_pk_bf16_f32 v194, v212, v213
v_cvt_pk_bf16_f32 v195, v214, v215
v_cvt_pk_bf16_f32 v196, v216, v217
v_cvt_pk_bf16_f32 v197, v218, v219
v_cvt_pk_bf16_f32 v198, v220, v221
v_cvt_pk_bf16_f32 v199, v222, v223
v_cvt_pk_bf16_f32 v200, v224, v225
v_cvt_pk_bf16_f32 v201, v226, v227
v_cvt_pk_bf16_f32 v202, v228, v229
v_cvt_pk_bf16_f32 v203, v230, v231
v_cvt_pk_bf16_f32 v204, v232, v233
v_cvt_pk_bf16_f32 v205, v234, v235
v_cvt_pk_bf16_f32 v206, v236, v237
v_cvt_pk_bf16_f32 v207, v238, v239
v_lshlrev_b32 v208, 16, v192
v_and_b32 v209, 0xffff0000, v192
v_lshlrev_b32 v210, 16, v193
v_and_b32 v211, 0xffff0000, v193
v_lshlrev_b32 v212, 16, v194
v_and_b32 v213, 0xffff0000, v194
v_lshlrev_b32 v214, 16, v195
v_and_b32 v215, 0xffff0000, v195
v_lshlrev_b32 v216, 16, v196
v_and_b32 v217, 0xffff0000, v196
v_lshlrev_b32 v218, 16, v197
v_and_b32 v219, 0xffff0000, v197
v_lshlrev_b32 v220, 16, v198
v_and_b32 v221, 0xffff0000, v198
v_lshlrev_b32 v222, 16, v199
v_and_b32 v223, 0xffff0000, v199
v_lshlrev_b32 v224, 16, v200
v_and_b32 v225, 0xffff0000, v200
v_lshlrev_b32 v226, 16, v201
v_and_b32 v227, 0xffff0000, v201
v_lshlrev_b32 v228, 16, v202
v_and_b32 v229, 0xffff0000, v202
v_lshlrev_b32 v230, 16, v203
v_and_b32 v231, 0xffff0000, v203
v_lshlrev_b32 v232, 16, v204
v_and_b32 v233, 0xffff0000, v204
v_lshlrev_b32 v234, 16, v205
v_and_b32 v235, 0xffff0000, v205
v_lshlrev_b32 v236, 16, v206
v_and_b32 v237, 0xffff0000, v206
v_lshlrev_b32 v238, 16, v207
v_and_b32 v239, 0xffff0000, v207
v_add_f32_dpp v240, v240, v240 row_ror:8 row_mask:0xf bank_mask:0xf
v_mov_b32 v241, v240
s_nop 1
v_permlane16_swap_b32 v240, v241
v_add_f32 v240, v240, v241
v_mov_b32 v241, v240
s_nop 1
v_permlane32_swap_b32 v240, v241
v_add_f32 v240, v240, v241
ds_write_b32 v246, v240 offset:128
s_waitcnt lgkmcnt(0)
s_barrier
ds_read_b128 v[242:245], v247 offset:128
s_waitcnt lgkmcnt(0)
v_pk_add_f32 v[242:243], v[242:243], v[244:245]
v_add_f32 v240, v242, v243
v_mul_f32 v240, 0x3a800000, v240
v_cvt_pk_bf16_f32 v240, v240, v240
v_and_b32 v240, 0xffff0000, v240
v_add_f32 v240, 0x3727c5ac, v240
v_cvt_pk_bf16_f32 v240, v240, v240
v_and_b32 v240, 0xffff0000, v240
v_sqrt_f32 v240, v240
s_nop 0
v_cvt_pk_bf16_f32 v240, v240, v240
v_and_b32 v240, 0xffff0000, v240
v_rcp_f32 v240, v240
s_nop 0
v_pk_mul_f32 v[208:209], v[208:209], v[240:241] op_sel_hi:[1,0]
v_pk_mul_f32 v[210:211], v[210:211], v[240:241] op_sel_hi:[1,0]
v_pk_mul_f32 v[212:213], v[212:213], v[240:241] op_sel_hi:[1,0]
v_pk_mul_f32 v[214:215], v[214:215], v[240:241] op_sel_hi:[1,0]
v_pk_mul_f32 v[216:217], v[216:217], v[240:241] op_sel_hi:[1,0]
v_pk_mul_f32 v[218:219], v[218:219], v[240:241] op_sel_hi:[1,0]
v_pk_mul_f32 v[220:221], v[220:221], v[240:241] op_sel_hi:[1,0]
v_pk_mul_f32 v[222:223], v[222:223], v[240:241] op_sel_hi:[1,0]
v_pk_mul_f32 v[224:225], v[224:225], v[240:241] op_sel_hi:[1,0]
v_pk_mul_f32 v[226:227], v[226:227], v[240:241] op_sel_hi:[1,0]
v_pk_mul_f32 v[228:229], v[228:229], v[240:241] op_sel_hi:[1,0]
v_pk_mul_f32 v[230:231], v[230:231], v[240:241] op_sel_hi:[1,0]
v_pk_mul_f32 v[232:233], v[232:233], v[240:241] op_sel_hi:[1,0]
v_pk_mul_f32 v[234:235], v[234:235], v[240:241] op_sel_hi:[1,0]
v_pk_mul_f32 v[236:237], v[236:237], v[240:241] op_sel_hi:[1,0]
v_pk_mul_f32 v[238:239], v[238:239], v[240:241] op_sel_hi:[1,0]
v_cvt_pk_bf16_f32 v192, v208, v209
v_cvt_pk_bf16_f32 v193, v210, v211
v_cvt_pk_bf16_f32 v194, v212, v213
v_cvt_pk_bf16_f32 v195, v214, v215
v_cvt_pk_bf16_f32 v196, v216, v217
v_cvt_pk_bf16_f32 v197, v218, v219
v_cvt_pk_bf16_f32 v198, v220, v221
v_cvt_pk_bf16_f32 v199, v222, v223
v_cvt_pk_bf16_f32 v200, v224, v225
v_cvt_pk_bf16_f32 v201, v226, v227
v_cvt_pk_bf16_f32 v202, v228, v229
v_cvt_pk_bf16_f32 v203, v230, v231
v_cvt_pk_bf16_f32 v204, v232, v233
v_cvt_pk_bf16_f32 v205, v234, v235
v_cvt_pk_bf16_f32 v206, v236, v237
v_cvt_pk_bf16_f32 v207, v238, v239
s_lshr_b32 s50, s44, 2
s_lshl_b32 s50, s50, 16
s_and_b32 s54, s44, 3
s_lshl_b32 s54, s54, 7
s_add_u32 s50, s50, s54
s_lshl_b32 s54, s42, 14
s_add_u32 s50, s50, s54
buffer_store_dwordx4 v[192:195], v248, s[4:7], s50 offen sc1
s_add_u32 s50, s50, 4096
buffer_store_dwordx4 v[196:199], v248, s[4:7], s50 offen sc1
s_add_u32 s50, s50, 4096
buffer_store_dwordx4 v[200:203], v248, s[4:7], s50 offen sc1
s_add_u32 s50, s50, 4096
buffer_store_dwordx4 v[204:207], v248, s[4:7], s50 offen sc1
s_branch Lln_144
Lln_143:
s_waitcnt vmcnt(0)
Lln_144:
s_waitcnt vmcnt(0)
s_barrier
s_or_b32 s50, s42, s2
s_cbranch_scc1 Larr_145
s_lshr_b32 s50, s44, 3
s_lshl_b32 s50, 1, s50
v_mov_b32 v110, s50
v_mov_b32 v111, 0x10000
s_lshl_b32 s50, s3, 3
v_mov_b32 v112, s50
s_mov_b64 exec, 1
global_atomic_add_x2 v[110:111], v112, v[110:111], s[36:37] offset:128 sc0
s_mov_b64 exec, -1
Larr_145:
s_waitcnt vmcnt(0)
s_or_b32 s50, s42, s2
s_cbranch_scc1 Ltk_146
v_readfirstlane_b32 s99, v111
s_nop 0
s_lshr_b32 s99, s99, 16
Ltk_146:
s_lshr_b32 s55, s45, 2
s_min_u32 s55, s55, 9
s_lshl_b32 s53, s55, 23
s_add_u32 s53, s53, 33554432
s_sub_u32 s54, s8, s38
s_add_u32 s53, s53, s54
s_cmp_gt_u32 s45, 40
s_cbranch_scc1 Lnt_done
v_and_b32 v56, 16, v0
v_lshlrev_b32 v56, 9, v56
buffer_load_dword v2, v56, s[4:7], s53 offen sc1
Lnt_done:
v_lshrrev_b32 v56, 4, v0
s_and_b32 s50, s42, 1
s_cmp_eq_u32 s50, 0
s_cselect_b32 s12, s74, s76
s_cselect_b32 s13, s75, s77
s_mov_b32 s15, 0x20000
s_lshl_b32 s50, s50, 1
v_bfe_u32 v57, v56, 4, 1
v_or_b32 v57, s50, v57
v_lshlrev_b32 v57, 1, v57
v_and_b32 v58, 7, v56
v_xor_b32 v57, v57, v58
v_lshrrev_b32 v58, 3, v56
v_mul_lo_u32 v58, v58, s66
v_lshl_add_u32 v59, v57, 4, v58
v_bfe_u32 v57, v56, 4, 1
v_bfe_u32 v58, v56, 3, 1
v_lshl_add_u32 v58, v57, 1, v58
v_xor_b32 v58, s42, v58
v_lshlrev_b32 v58, 5, v58
v_lshl_add_u32 v58, v57, 15, v58
v_and_b32 v57, 3, v56
v_lshl_add_u32 v58, v57, 3, v58
v_bfe_u32 v57, v56, 2, 2
v_lshl_add_u32 v58, v57, 7, v58
v_lshrrev_b32 v57, 5, v56
v_lshl_add_u32 v60, v57, 10, v58
v_add_u32 v61, 0x10000, v60
s_lshl_b32 s51, s66, 3
s_lshr_b32 s50, s42, 1
s_lshl_b32 s52, s50, 4
s_mul_i32 s52, s52, s51
s_add_u32 s52, s52, s67
s_lshl_b32 s50, s50, 14
s_and_b32 s53, s42, 1
s_lshl_b32 s53, s53, 15
s_add_u32 s53, s53, s50
s_lshl_b32 s55, s51, 4
s_add_u32 m0, s53, 0
s_nop 0
buffer_load_dwordx4 v59, s[12:15], s52 offen lds
s_add_u32 m0, s53, 1024
s_add_u32 s52, s52, s51
buffer_load_dwordx4 v59, s[12:15], s52 offen lds
s_add_u32 m0, s53, 2048
s_add_u32 s52, s52, s51
buffer_load_dwordx4 v59, s[12:15], s52 offen lds
s_add_u32 m0, s53, 3072
s_add_u32 s52, s52, s51
buffer_load_dwordx4 v59, s[12:15], s52 offen lds
s_add_u32 m0, s53, 4096
s_add_u32 s52, s52, s51
buffer_load_dwordx4 v59, s[12:15], s52 offen lds
s_add_u32 m0, s53, 5120
s_add_u32 s52, s52, s51
buffer_load_dwordx4 v59, s[12:15], s52 offen lds
s_add_u32 m0, s53, 6144
s_add_u32 s52, s52, s51
buffer_load_dwordx4 v59, s[12:15], s52 offen lds
s_add_u32 m0, s53, 7168
s_add_u32 s52, s52, s51
buffer_load_dwordx4 v59, s[12:15], s52 offen lds
s_add_u32 m0, s53, 8192
s_add_u32 s52, s52, s51
buffer_load_dwordx4 v59, s[12:15], s52 offen lds
s_add_u32 m0, s53, 9216
s_add_u32 s52, s52, s51
buffer_load_dwordx4 v59, s[12:15], s52 offen lds
s_add_u32 m0, s53, 10240
s_add_u32 s52, s52, s51
buffer_load_dwordx4 v59, s[12:15], s52 offen lds
s_add_u32 m0, s53, 11264
s_add_u32 s52, s52, s51
buffer_load_dwordx4 v59, s[12:15], s52 offen lds
s_add_u32 m0, s53, 12288
s_add_u32 s52, s52, s51
buffer_load_dwordx4 v59, s[12:15], s52 offen lds
s_add_u32 m0, s53, 13312
s_add_u32 s52, s52, s51
buffer_load_dwordx4 v59, s[12:15], s52 offen lds
s_add_u32 m0, s53, 14336
s_add_u32 s52, s52, s51
buffer_load_dwordx4 v59, s[12:15], s52 offen lds
s_add_u32 m0, s53, 15360
s_add_u32 s52, s52, s51
buffer_load_dwordx4 v59, s[12:15], s52 offen lds
s_add_u32 m0, s53, 65536
s_add_u32 s52, s52, s51
s_add_u32 s52, s52, s55
buffer_load_dwordx4 v59, s[12:15], s52 offen lds
s_add_u32 m0, s53, 66560
s_add_u32 s52, s52, s51
buffer_load_dwordx4 v59, s[12:15], s52 offen lds
s_add_u32 m0, s53, 67584
s_add_u32 s52, s52, s51
buffer_load_dwordx4 v59, s[12:15], s52 offen lds
s_add_u32 m0, s53, 68608
s_add_u32 s52, s52, s51
buffer_load_dwordx4 v59, s[12:15], s52 offen lds
s_add_u32 m0, s53, 69632
s_add_u32 s52, s52, s51
buffer_load_dwordx4 v59, s[12:15], s52 offen lds
s_add_u32 m0, s53, 70656
s_add_u32 s52, s52, s51
buffer_load_dwordx4 v59, s[12:15], s52 offen lds
s_add_u32 m0, s53, 71680
s_add_u32 s52, s52, s51
buffer_load_dwordx4 v59, s[12:15], s52 offen lds
s_add_u32 m0, s53, 72704
s_add_u32 s52, s52, s51
buffer_load_dwordx4 v59, s[12:15], s52 offen lds
s_add_u32 m0, s53, 73728
s_add_u32 s52, s52, s51
buffer_load_dwordx4 v59, s[12:15], s52 offen lds
s_add_u32 m0, s53, 74752
s_add_u32 s52, s52, s51
buffer_load_dwordx4 v59, s[12:15], s52 offen lds
s_add_u32 m0, s53, 75776
s_add_u32 s52, s52, s51
buffer_load_dwordx4 v59, s[12:15], s52 offen lds
s_add_u32 m0, s53, 76800
s_add_u32 s52, s52, s51
buffer_load_dwordx4 v59, s[12:15], s52 offen lds
s_add_u32 m0, s53, 77824
s_add_u32 s52, s52, s51
buffer_load_dwordx4 v59, s[12:15], s52 offen lds
s_add_u32 m0, s53, 78848
s_add_u32 s52, s52, s51
buffer_load_dwordx4 v59, s[12:15], s52 offen lds
s_add_u32 m0, s53, 79872
s_add_u32 s52, s52, s51
buffer_load_dwordx4 v59, s[12:15], s52 offen lds
s_add_u32 m0, s53, 80896
s_add_u32 s52, s52, s51
buffer_load_dwordx4 v59, s[12:15], s52 offen lds
s_waitcnt vmcnt(16)
s_barrier
ds_read_b64_tr_b16 a[0:1], v60 offset:0
ds_read_b64_tr_b16 a[2:3], v60 offset:512
ds_read_b64_tr_b16 a[4:5], v60 offset:2048
ds_read_b64_tr_b16 a[6:7], v60 offset:2560
ds_read_b64_tr_b16 a[8:9], v60 offset:4096
ds_read_b64_tr_b16 a[10:11], v60 offset:4608
ds_read_b64_tr_b16 a[12:13], v60 offset:6144
ds_read_b64_tr_b16 a[14:15], v60 offset:6656
ds_read_b64_tr_b16 a[16:17], v60 offset:8192
ds_read_b64_tr_b16 a[18:19], v60 offset:8704
ds_read_b64_tr_b16 a[20:21], v60 offset:10240
ds_read_b64_tr_b16 a[22:23], v60 offset:10752
ds_read_b64_tr_b16 a[24:25], v60 offset:12288
ds_read_b64_tr_b16 a[26:27], v60 offset:12800
ds_read_b64_tr_b16 a[28:29], v60 offset:14336
ds_read_b64_tr_b16 a[30:31], v60 offset:14848
ds_read_b64_tr_b16 a[32:33], v60 offset:16384
ds_read_b64_tr_b16 a[34:35], v60 offset:16896
ds_read_b64_tr_b16 a[36:37], v60 offset:18432
ds_read_b64_tr_b16 a[38:39], v60 offset:18944
ds_read_b64_tr_b16 a[40:41], v60 offset:20480
ds_read_b64_tr_b16 a[42:43], v60 offset:20992
ds_read_b64_tr_b16 a[44:45], v60 offset:22528
ds_read_b64_tr_b16 a[46:47], v60 offset:23040
ds_read_b64_tr_b16 a[48:49], v60 offset:24576
ds_read_b64_tr_b16 a[50:51], v60 offset:25088
ds_read_b64_tr_b16 a[52:53], v60 offset:26624
ds_read_b64_tr_b16 a[54:55], v60 offset:27136
ds_read_b64_tr_b16 a[56:57], v60 offset:28672
ds_read_b64_tr_b16 a[58:59], v60 offset:29184
ds_read_b64_tr_b16 a[60:61], v60 offset:30720
ds_read_b64_tr_b16 a[62:63], v60 offset:31232
s_waitcnt lgkmcnt(0)
s_barrier
s_add_u32 m0, s53, 0
s_add_u32 s52, s52, s51
s_add_u32 s52, s52, s55
buffer_load_dwordx4 v59, s[12:15], s52 offen lds
s_add_u32 m0, s53, 1024
s_add_u32 s52, s52, s51
buffer_load_dwordx4 v59, s[12:15], s52 offen lds
s_add_u32 m0, s53, 2048
s_add_u32 s52, s52, s51
buffer_load_dwordx4 v59, s[12:15], s52 offen lds
s_add_u32 m0, s53, 3072
s_add_u32 s52, s52, s51
buffer_load_dwordx4 v59, s[12:15], s52 offen lds
s_add_u32 m0, s53, 4096
s_add_u32 s52, s52, s51
buffer_load_dwordx4 v59, s[12:15], s52 offen lds
s_add_u32 m0, s53, 5120
s_add_u32 s52, s52, s51
buffer_load_dwordx4 v59, s[12:15], s52 offen lds
s_add_u32 m0, s53, 6144
s_add_u32 s52, s52, s51
buffer_load_dwordx4 v59, s[12:15], s52 offen lds
s_add_u32 m0, s53, 7168
s_add_u32 s52, s52, s51
buffer_load_dwordx4 v59, s[12:15], s52 offen lds
s_add_u32 m0, s53, 8192
s_add_u32 s52, s52, s51
buffer_load_dwordx4 v59, s[12:15], s52 offen lds
s_add_u32 m0, s53, 9216
s_add_u32 s52, s52, s51
buffer_load_dwordx4 v59, s[12:15], s52 offen lds
s_add_u32 m0, s53, 10240
s_add_u32 s52, s52, s51
buffer_load_dwordx4 v59, s[12:15], s52 offen lds
s_add_u32 m0, s53, 11264
s_add_u32 s52, s52, s51
buffer_load_dwordx4 v59, s[12:15], s52 offen lds
s_add_u32 m0, s53, 12288
s_add_u32 s52, s52, s51
buffer_load_dwordx4 v59, s[12:15], s52 offen lds
s_add_u32 m0, s53, 13312
s_add_u32 s52, s52, s51
buffer_load_dwordx4 v59, s[12:15], s52 offen lds
s_add_u32 m0, s53, 14336
s_add_u32 s52, s52, s51
buffer_load_dwordx4 v59, s[12:15], s52 offen lds
s_add_u32 m0, s53, 15360
s_add_u32 s52, s52, s51
buffer_load_dwordx4 v59, s[12:15], s52 offen lds
s_waitcnt vmcnt(16)
s_barrier
ds_read_b64_tr_b16 a[64:65], v61 offset:0
ds_read_b64_tr_b16 a[66:67], v61 offset:512
ds_read_b64_tr_b16 a[68:69], v61 offset:2048
ds_read_b64_tr_b16 a[70:71], v61 offset:2560
ds_read_b64_tr_b16 a[72:73], v61 offset:4096
ds_read_b64_tr_b16 a[74:75], v61 offset:4608
ds_read_b64_tr_b16 a[76:77], v61 offset:6144
ds_read_b64_tr_b16 a[78:79], v61 offset:6656
ds_read_b64_tr_b16 a[80:81], v61 offset:8192
ds_read_b64_tr_b16 a[82:83], v61 offset:8704
ds_read_b64_tr_b16 a[84:85], v61 offset:10240
ds_read_b64_tr_b16 a[86:87], v61 offset:10752
ds_read_b64_tr_b16 a[88:89], v61 offset:12288
ds_read_b64_tr_b16 a[90:91], v61 offset:12800
ds_read_b64_tr_b16 a[92:93], v61 offset:14336
ds_read_b64_tr_b16 a[94:95], v61 offset:14848
ds_read_b64_tr_b16 a[96:97], v61 offset:16384
ds_read_b64_tr_b16 a[98:99], v61 offset:16896
ds_read_b64_tr_b16 a[100:101], v61 offset:18432
ds_read_b64_tr_b16 a[102:103], v61 offset:18944
ds_read_b64_tr_b16 a[104:105], v61 offset:20480
ds_read_b64_tr_b16 a[106:107], v61 offset:20992
ds_read_b64_tr_b16 a[108:109], v61 offset:22528
ds_read_b64_tr_b16 a[110:111], v61 offset:23040
ds_read_b64_tr_b16 a[112:113], v61 offset:24576
ds_read_b64_tr_b16 a[114:115], v61 offset:25088
ds_read_b64_tr_b16 a[116:117], v61 offset:26624
ds_read_b64_tr_b16 a[118:119], v61 offset:27136
ds_read_b64_tr_b16 a[120:121], v61 offset:28672
ds_read_b64_tr_b16 a[122:123], v61 offset:29184
ds_read_b64_tr_b16 a[124:125], v61 offset:30720
ds_read_b64_tr_b16 a[126:127], v61 offset:31232
s_waitcnt lgkmcnt(0)
s_barrier
s_add_u32 m0, s53, 65536
s_add_u32 s52, s52, s51
s_add_u32 s52, s52, s55
buffer_load_dwordx4 v59, s[12:15], s52 offen lds
s_add_u32 m0, s53, 66560
s_add_u32 s52, s52, s51
buffer_load_dwordx4 v59, s[12:15], s52 offen lds
s_add_u32 m0, s53, 67584
s_add_u32 s52, s52, s51
buffer_load_dwordx4 v59, s[12:15], s52 offen lds
s_add_u32 m0, s53, 68608
s_add_u32 s52, s52, s51
buffer_load_dwordx4 v59, s[12:15], s52 offen lds
s_add_u32 m0, s53, 69632
s_add_u32 s52, s52, s51
buffer_load_dwordx4 v59, s[12:15], s52 offen lds
s_add_u32 m0, s53, 70656
s_add_u32 s52, s52, s51
buffer_load_dwordx4 v59, s[12:15], s52 offen lds
s_add_u32 m0, s53, 71680
s_add_u32 s52, s52, s51
buffer_load_dwordx4 v59, s[12:15], s52 offen lds
s_add_u32 m0, s53, 72704
s_add_u32 s52, s52, s51
buffer_load_dwordx4 v59, s[12:15], s52 offen lds
s_add_u32 m0, s53, 73728
s_add_u32 s52, s52, s51
buffer_load_dwordx4 v59, s[12:15], s52 offen lds
s_add_u32 m0, s53, 74752
s_add_u32 s52, s52, s51
buffer_load_dwordx4 v59, s[12:15], s52 offen lds
s_add_u32 m0, s53, 75776
s_add_u32 s52, s52, s51
buffer_load_dwordx4 v59, s[12:15], s52 offen lds
s_add_u32 m0, s53, 76800
s_add_u32 s52, s52, s51
buffer_load_dwordx4 v59, s[12:15], s52 offen lds
s_add_u32 m0, s53, 77824
s_add_u32 s52, s52, s51
buffer_load_dwordx4 v59, s[12:15], s52 offen lds
s_add_u32 m0, s53, 78848
s_add_u32 s52, s52, s51
buffer_load_dwordx4 v59, s[12:15], s52 offen lds
s_add_u32 m0, s53, 79872
s_add_u32 s52, s52, s51
buffer_load_dwordx4 v59, s[12:15], s52 offen lds
s_add_u32 m0, s53, 80896
s_add_u32 s52, s52, s51
buffer_load_dwordx4 v59, s[12:15], s52 offen lds
s_waitcnt vmcnt(16)
s_barrier
ds_read_b64_tr_b16 a[128:129], v60 offset:0
ds_read_b64_tr_b16 a[130:131], v60 offset:512
ds_read_b64_tr_b16 a[132:133], v60 offset:2048
ds_read_b64_tr_b16 a[134:135], v60 offset:2560
ds_read_b64_tr_b16 a[136:137], v60 offset:4096
ds_read_b64_tr_b16 a[138:139], v60 offset:4608
ds_read_b64_tr_b16 a[140:141], v60 offset:6144
ds_read_b64_tr_b16 a[142:143], v60 offset:6656
ds_read_b64_tr_b16 a[144:145], v60 offset:8192
ds_read_b64_tr_b16 a[146:147], v60 offset:8704
ds_read_b64_tr_b16 a[148:149], v60 offset:10240
ds_read_b64_tr_b16 a[150:151], v60 offset:10752
ds_read_b64_tr_b16 a[152:153], v60 offset:12288
ds_read_b64_tr_b16 a[154:155], v60 offset:12800
ds_read_b64_tr_b16 a[156:157], v60 offset:14336
ds_read_b64_tr_b16 a[158:159], v60 offset:14848
ds_read_b64_tr_b16 a[160:161], v60 offset:16384
ds_read_b64_tr_b16 a[162:163], v60 offset:16896
ds_read_b64_tr_b16 a[164:165], v60 offset:18432
ds_read_b64_tr_b16 a[166:167], v60 offset:18944
ds_read_b64_tr_b16 a[168:169], v60 offset:20480
ds_read_b64_tr_b16 a[170:171], v60 offset:20992
ds_read_b64_tr_b16 a[172:173], v60 offset:22528
ds_read_b64_tr_b16 a[174:175], v60 offset:23040
ds_read_b64_tr_b16 a[176:177], v60 offset:24576
ds_read_b64_tr_b16 a[178:179], v60 offset:25088
ds_read_b64_tr_b16 a[180:181], v60 offset:26624
ds_read_b64_tr_b16 a[182:183], v60 offset:27136
ds_read_b64_tr_b16 a[184:185], v60 offset:28672
ds_read_b64_tr_b16 a[186:187], v60 offset:29184
ds_read_b64_tr_b16 a[188:189], v60 offset:30720
ds_read_b64_tr_b16 a[190:191], v60 offset:31232
s_waitcnt lgkmcnt(0)
s_barrier
s_waitcnt vmcnt(0)
s_barrier
ds_read_b64_tr_b16 a[192:193], v61 offset:0
ds_read_b64_tr_b16 a[194:195], v61 offset:512
ds_read_b64_tr_b16 a[196:197], v61 offset:2048
ds_read_b64_tr_b16 a[198:199], v61 offset:2560
ds_read_b64_tr_b16 a[200:201], v61 offset:4096
ds_read_b64_tr_b16 a[202:203], v61 offset:4608
ds_read_b64_tr_b16 a[204:205], v61 offset:6144
ds_read_b64_tr_b16 a[206:207], v61 offset:6656
ds_read_b64_tr_b16 a[208:209], v61 offset:8192
ds_read_b64_tr_b16 a[210:211], v61 offset:8704
ds_read_b64_tr_b16 a[212:213], v61 offset:10240
ds_read_b64_tr_b16 a[214:215], v61 offset:10752
ds_read_b64_tr_b16 a[216:217], v61 offset:12288
ds_read_b64_tr_b16 a[218:219], v61 offset:12800
ds_read_b64_tr_b16 a[220:221], v61 offset:14336
ds_read_b64_tr_b16 a[222:223], v61 offset:14848
ds_read_b64_tr_b16 a[224:225], v61 offset:16384
ds_read_b64_tr_b16 a[226:227], v61 offset:16896
ds_read_b64_tr_b16 a[228:229], v61 offset:18432
ds_read_b64_tr_b16 a[230:231], v61 offset:18944
ds_read_b64_tr_b16 a[232:233], v61 offset:20480
ds_read_b64_tr_b16 a[234:235], v61 offset:20992
ds_read_b64_tr_b16 a[236:237], v61 offset:22528
ds_read_b64_tr_b16 a[238:239], v61 offset:23040
ds_read_b64_tr_b16 a[240:241], v61 offset:24576
ds_read_b64_tr_b16 a[242:243], v61 offset:25088
ds_read_b64_tr_b16 a[244:245], v61 offset:26624
ds_read_b64_tr_b16 a[246:247], v61 offset:27136
ds_read_b64_tr_b16 a[248:249], v61 offset:28672
ds_read_b64_tr_b16 a[250:251], v61 offset:29184
ds_read_b64_tr_b16 a[252:253], v61 offset:30720
ds_read_b64_tr_b16 a[254:255], v61 offset:31232
s_waitcnt lgkmcnt(0)
s_barrier
v_mbcnt_lo_u32_b32 v64, -1, 0
v_mbcnt_hi_u32_b32 v64, -1, v64
v_lshlrev_b32 v64, 2, v64
Lbw_147:
global_load_dword v65, v64, s[36:37] sc1
s_waitcnt vmcnt(0)
Lbw_147s:
s_cmp_lg_u32 s2, 0
s_cbranch_scc1 Lbw_149
v_cmp_ne_u32 vcc, -1, v65
s_nop 0
s_and_b32 s50, vcc_hi, 0x5555
v_cmp_ne_u32 vcc, 0x200000, v65
s_nop 0
s_and_b32 s54, vcc_hi, 0xaaaa
s_or_b32 s50, s50, s54
s_cbranch_scc0 Lbw_149
s_mov_b32 s50, 0
v_readlane_b32 s54, v65, 33
s_nop 0
s_lshr_b32 s54, s54, 16
s_add_u32 s50, s50, s54
v_readlane_b32 s54, v65, 35
s_nop 0
s_lshr_b32 s54, s54, 16
s_add_u32 s50, s50, s54
v_readlane_b32 s54, v65, 37
s_nop 0
s_lshr_b32 s54, s54, 16
s_add_u32 s50, s50, s54
v_readlane_b32 s54, v65, 39
s_nop 0
s_lshr_b32 s54, s54, 16
s_add_u32 s50, s50, s54
v_readlane_b32 s54, v65, 41
s_nop 0
s_lshr_b32 s54, s54, 16
s_add_u32 s50, s50, s54
v_readlane_b32 s54, v65, 43
s_nop 0
s_lshr_b32 s54, s54, 16
s_add_u32 s50, s50, s54
v_readlane_b32 s54, v65, 45
s_nop 0
s_lshr_b32 s54, s54, 16
s_add_u32 s50, s50, s54
v_readlane_b32 s54, v65, 47
s_nop 0
s_lshr_b32 s54, s54, 16
s_add_u32 s50, s50, s54
v_readlane_b32 s54, v65, 49
s_nop 0
s_lshr_b32 s54, s54, 16
s_add_u32 s50, s50, s54
v_readlane_b32 s54, v65, 51
s_nop 0
s_lshr_b32 s54, s54, 16
s_add_u32 s50, s50, s54
v_readlane_b32 s54, v65, 53
s_nop 0
s_lshr_b32 s54, s54, 16
s_add_u32 s50, s50, s54
v_readlane_b32 s54, v65, 55
s_nop 0
s_lshr_b32 s54, s54, 16
s_add_u32 s50, s50, s54
v_readlane_b32 s54, v65, 57
s_nop 0
s_lshr_b32 s54, s54, 16
s_add_u32 s50, s50, s54
v_readlane_b32 s54, v65, 59
s_nop 0
s_lshr_b32 s54, s54, 16
s_add_u32 s50, s50, s54
v_readlane_b32 s54, v65, 61
s_nop 0
s_lshr_b32 s54, s54, 16
s_add_u32 s50, s50, s54
v_readlane_b32 s54, v65, 63
s_nop 0
s_lshr_b32 s54, s54, 16
s_add_u32 s50, s50, s54
s_cmp_ge_u32 s50, 256
s_cbranch_scc1 Lbw_148
s_sleep 8
s_sub_u32 s43, s43, 1
s_cbranch_scc0 Lbw_147
s_mov_b32 s43, 0
Lbw_148:
v_lshrrev_b32 v65, 16, v65
v_cmp_ne_u32 vcc, 32, v65
s_nop 0
s_and_b32 s54, vcc_hi, 0xaaaa
s_or_b32 s54, s54, 0
s_branch Lrestart
Lbw_149:
s_and_b32 s50, s45, 3
s_or_b32 s50, s50, s42
s_cbranch_scc1 Lnp_done
s_lshr_b32 s55, s45, 2
s_cmp_gt_u32 s55, 10
s_cbranch_scc1 Lnp_done
s_mov_b64 exec, 1
s_mov_b32 s51, -1
s_mov_b32 s52, -1
s_lshl_b32 s53, s55, 23
s_add_u32 s53, s53, 33554432
s_cmp_eq_u32 s55, 10
s_cselect_b32 s53, 294912, s53
s_sub_u32 s54, s8, s38
s_add_u32 s53, s53, s54
s_add_u32 s54, s53, 8192
s_waitcnt vmcnt(0)
s_memtime s[94:95]
s_waitcnt lgkmcnt(0)
buffer_store_dword v3, v3, s[4:7], s53 offen sc1
s_waitcnt vmcnt(0)
s_memtime s[92:93]
s_waitcnt lgkmcnt(0)
s_sub_u32 s50, s92, s94
s_min_u32 s51, s51, s50
s_memtime s[94:95]
s_waitcnt lgkmcnt(0)
buffer_store_dword v3, v3, s[4:7], s54 offen sc1
s_waitcnt vmcnt(0)
s_memtime s[92:93]
s_waitcnt lgkmcnt(0)
s_sub_u32 s50, s92, s94
s_min_u32 s52, s52, s50
s_memtime s[94:95]
s_waitcnt lgkmcnt(0)
buffer_store_dword v3, v3, s[4:7], s53 offen sc1
s_waitcnt vmcnt(0)
s_memtime s[92:93]
s_waitcnt lgkmcnt(0)
s_sub_u32 s50, s92, s94
s_min_u32 s51, s51, s50
s_memtime s[94:95]
s_waitcnt lgkmcnt(0)
buffer_store_dword v3, v3, s[4:7], s54 offen sc1
s_waitcnt vmcnt(0)
s_memtime s[92:93]
s_waitcnt lgkmcnt(0)
s_sub_u32 s50, s92, s94
s_min_u32 s52, s52, s50
s_memtime s[94:95]
s_waitcnt lgkmcnt(0)
buffer_store_dword v3, v3, s[4:7], s53 offen sc1
s_waitcnt vmcnt(0)
s_memtime s[92:93]
s_waitcnt lgkmcnt(0)
s_sub_u32 s50, s92, s94
s_min_u32 s51, s51, s50
s_memtime s[94:95]
s_waitcnt lgkmcnt(0)
buffer_store_dword v3, v3, s[4:7], s54 offen sc1
s_waitcnt vmcnt(0)
s_memtime s[92:93]
s_waitcnt lgkmcnt(0)
s_sub_u32 s50, s92, s94
s_min_u32 s52, s52, s50
s_cmp_lt_u32 s52, s51
s_cselect_b32 s50, 2, 1
s_lshl_b32 s51, s55, 1
s_lshl_b32 s50, s50, s51
v_mov_b32 v2, s50
s_lshl_b32 s50, s2, 2
v_mov_b32 v56, s50
global_atomic_or v56, v2, s[36:37] offset:32
s_mov_b64 exec, -1
Lnp_done:
s_and_b32 s53, s45, 31
v_lshrrev_b32 v56, 2, v0
Lngb:
global_load_dword v57, v56, s[36:37] sc1
s_waitcnt vmcnt(0)
Lngbs:
s_add_u32 s55, s2, 8
v_readlane_b32 s98, v57, s55
s_nop 0
s_lshr_b32 s55, s98, 1
s_or_b32 s55, s55, s98
s_and_b32 s55, s55, 0x155555
s_cmp_eq_u32 s55, 0x155555
s_cbranch_scc1 Lngbd
s_sleep 4
s_sub_u32 s43, s43, 1
s_cbranch_scc0 Lngb
s_mov_b32 s43, 0
Lngbd:
s_lshr_b32 s51, s53, 3
s_lshl_b32 s51, s51, 1
s_add_u32 s51, s51, 0
s_lshr_b32 s51, s98, s51
s_xor_b32 s51, s51, s53
s_and_b32 s51, s51, 2
s_lshl_b32 s51, s51, 12
s_lshr_b32 s52, s53, 3
s_lshl_b32 s52, s52, 1
s_add_u32 s52, s52, 8
s_lshr_b32 s52, s98, s52
s_xor_b32 s52, s52, s53
s_and_b32 s52, s52, 2
s_lshl_b32 s52, s52, 12
s_lshr_b32 s50, s98, 8
s_and_b32 s50, s50, 0x2000
s_cmp_eq_u32 s68, 0
s_cselect_b32 s51, s51, s52
s_add_u32 s57, s57, s51
s_sub_u32 s99, s8, s38
s_add_u32 s99, s99, s50
s_add_u32 s99, s99, 311296
s_cmp_eq_u32 s68, 1
s_cbranch_scc1 Lgv
Lgk:
s_mov_b32 s65, 0x10000
v_mov_b32 v71, 131072
v_mov_b32 v4, 0
Lgk_cold:
s_lshl_b32 s53, s42, 10
s_xor_b32 s54, s65, 0x10000
s_add_u32 s54, s54, s53
s_add_u32 s53, s53, s49
s_add_u32 m0, s54, 0
s_add_u32 s55, s53, 0
buffer_load_dwordx4 v0, s[4:7], s55 offen sc1 lds
s_add_u32 m0, s54, 4096
s_add_u32 s55, s53, 4096
buffer_load_dwordx4 v0, s[4:7], s55 offen sc1 lds
s_add_u32 m0, s54, 8192
s_add_u32 s55, s53, 8192
buffer_load_dwordx4 v0, s[4:7], s55 offen sc1 lds
s_add_u32 m0, s54, 12288
s_add_u32 s55, s53, 12288
buffer_load_dwordx4 v0, s[4:7], s55 offen sc1 lds
s_add_u32 m0, s54, 16384
s_add_u32 s55, s53, 16384
buffer_load_dwordx4 v0, s[4:7], s55 offen sc1 lds
s_add_u32 m0, s54, 20480
s_add_u32 s55, s53, 20480
buffer_load_dwordx4 v0, s[4:7], s55 offen sc1 lds
s_add_u32 m0, s54, 24576
s_add_u32 s55, s53, 24576
buffer_load_dwordx4 v0, s[4:7], s55 offen sc1 lds
s_add_u32 m0, s54, 28672
s_add_u32 s55, s53, 28672
buffer_load_dwordx4 v0, s[4:7], s55 offen sc1 lds
s_add_u32 m0, s54, 32768
s_add_u32 s55, s53, 32768
buffer_load_dwordx4 v0, s[4:7], s55 offen sc1 lds
s_add_u32 m0, s54, 36864
s_add_u32 s55, s53, 36864
buffer_load_dwordx4 v0, s[4:7], s55 offen sc1 lds
s_add_u32 m0, s54, 40960
s_add_u32 s55, s53, 40960
buffer_load_dwordx4 v0, s[4:7], s55 offen sc1 lds
s_add_u32 m0, s54, 45056
s_add_u32 s55, s53, 45056
buffer_load_dwordx4 v0, s[4:7], s55 offen sc1 lds
s_add_u32 m0, s54, 49152
s_add_u32 s55, s53, 49152
buffer_load_dwordx4 v0, s[4:7], s55 offen sc1 lds
s_add_u32 m0, s54, 53248
s_add_u32 s55, s53, 53248
buffer_load_dwordx4 v0, s[4:7], s55 offen sc1 lds
s_add_u32 m0, s54, 57344
s_add_u32 s55, s53, 57344
buffer_load_dwordx4 v0, s[4:7], s55 offen sc1 lds
s_add_u32 m0, s54, 61440
s_add_u32 s55, s53, 61440
buffer_load_dwordx4 v0, s[4:7], s55 offen sc1 lds
s_lshl_b32 s64, s40, 14
s_lshl_b32 s50, s42, 11
s_add_u32 s64, s64, s50
s_add_u32 s64, s64, 155189248
s_waitcnt vmcnt(8)
Lgk_top0:
s_xor_b32 s65, s65, 0x10000
s_add_u32 s49, s49, s56
v_add_u32 v5, s65, v0
s_barrier
ds_read_b128 v[8:11], v5 offset:0
ds_read_b128 v[12:15], v5 offset:1024
ds_read_b128 v[16:19], v5 offset:2048
s_lshl_b32 s53, s42, 10
s_xor_b32 s54, s65, 0x10000
s_add_u32 s54, s54, s53
s_add_u32 s53, s53, s49
s_waitcnt lgkmcnt(2)
v_mfma_f32_32x32x16_bf16 v[40:55], a[0:3], v[8:11], 0
ds_read_b128 v[20:23], v5 offset:3072
ds_read_b128 v[24:27], v5 offset:4096
ds_read_b128 v[28:31], v5 offset:5120
ds_read_b128 v[32:35], v5 offset:6144
s_waitcnt lgkmcnt(5)
v_mfma_f32_32x32x16_bf16 v[40:55], a[4:7], v[12:15], v[40:55]
ds_read_b128 v[36:39], v5 offset:7168
ds_read_b128 v[8:11], v5 offset:8192
s_cmp_le_u32 s47, 1
s_cbranch_scc1 Lgk_nop0
s_waitcnt lgkmcnt(6)
v_mfma_f32_32x32x16_bf16 v[40:55], a[8:11], v[16:19], v[40:55]
ds_read_b128 v[12:15], v5 offset:9216
s_add_u32 m0, s54, 0
s_add_u32 s55, s53, 0
buffer_load_dwordx4 v0, s[4:7], s55 offen sc1 lds
v_cvt_pk_bf16_f32 v56, v72, v73
s_waitcnt lgkmcnt(6)
v_mfma_f32_32x32x16_bf16 v[40:55], a[12:15], v[20:23], v[40:55]
ds_read_b128 v[16:19], v5 offset:10240
v_cvt_pk_bf16_f32 v57, v74, v75
v_cvt_pk_bf16_f32 v58, v76, v77
v_cvt_pk_bf16_f32 v59, v78, v79
buffer_store_dwordx4 v[56:59], v0, s[4:7], s64 offen sc1
s_waitcnt lgkmcnt(6)
v_mfma_f32_32x32x16_bf16 v[40:55], a[16:19], v[24:27], v[40:55]
ds_read_b128 v[20:23], v5 offset:11264
s_add_u32 m0, s54, 4096
s_add_u32 s55, s53, 4096
buffer_load_dwordx4 v0, s[4:7], s55 offen sc1 lds
s_add_u32 s64, s64, 4096
s_waitcnt lgkmcnt(6)
v_mfma_f32_32x32x16_bf16 v[40:55], a[20:23], v[28:31], v[40:55]
ds_read_b128 v[24:27], v5 offset:12288
v_cvt_pk_bf16_f32 v60, v80, v81
v_cvt_pk_bf16_f32 v61, v82, v83
v_cvt_pk_bf16_f32 v62, v84, v85
v_cvt_pk_bf16_f32 v63, v86, v87
s_waitcnt lgkmcnt(6)
v_mfma_f32_32x32x16_bf16 v[40:55], a[24:27], v[32:35], v[40:55]
ds_read_b128 v[28:31], v5 offset:13312
s_add_u32 m0, s54, 8192
s_add_u32 s55, s53, 8192
buffer_load_dwordx4 v0, s[4:7], s55 offen sc1 lds
buffer_store_dwordx4 v[60:63], v0, s[4:7], s64 offen sc1
s_waitcnt lgkmcnt(6)
v_mfma_f32_32x32x16_bf16 v[40:55], a[28:31], v[36:39], v[40:55]
ds_read_b128 v[32:35], v5 offset:14336
s_waitcnt lgkmcnt(6)
v_mfma_f32_32x32x16_bf16 v[40:55], a[32:35], v[8:11], v[40:55]
ds_read_b128 v[36:39], v5 offset:15360
s_add_u32 m0, s54, 12288
s_add_u32 s55, s53, 12288
buffer_load_dwordx4 v0, s[4:7], s55 offen sc1 lds
s_waitcnt lgkmcnt(6)
v_mfma_f32_32x32x16_bf16 v[40:55], a[36:39], v[12:15], v[40:55]
ds_read_b128 v[8:11], v5 offset:16384
s_waitcnt lgkmcnt(6)
v_mfma_f32_32x32x16_bf16 v[40:55], a[40:43], v[16:19], v[40:55]
ds_read_b128 v[12:15], v5 offset:17408
s_add_u32 m0, s54, 16384
s_add_u32 s55, s53, 16384
buffer_load_dwordx4 v0, s[4:7], s55 offen sc1 lds
s_waitcnt lgkmcnt(6)
v_mfma_f32_32x32x16_bf16 v[40:55], a[44:47], v[20:23], v[40:55]
ds_read_b128 v[16:19], v5 offset:18432
s_waitcnt lgkmcnt(6)
v_mfma_f32_32x32x16_bf16 v[40:55], a[48:51], v[24:27], v[40:55]
ds_read_b128 v[20:23], v5 offset:19456
s_add_u32 m0, s54, 20480
s_add_u32 s55, s53, 20480
buffer_load_dwordx4 v0, s[4:7], s55 offen sc1 lds
s_waitcnt lgkmcnt(6)
v_mfma_f32_32x32x16_bf16 v[40:55], a[52:55], v[28:31], v[40:55]
ds_read_b128 v[24:27], v5 offset:20480
s_waitcnt lgkmcnt(6)
v_mfma_f32_32x32x16_bf16 v[40:55], a[56:59], v[32:35], v[40:55]
ds_read_b128 v[28:31], v5 offset:21504
s_add_u32 m0, s54, 24576
s_add_u32 s55, s53, 24576
buffer_load_dwordx4 v0, s[4:7], s55 offen sc1 lds
s_waitcnt lgkmcnt(6)
v_mfma_f32_32x32x16_bf16 v[40:55], a[60:63], v[36:39], v[40:55]
ds_read_b128 v[32:35], v5 offset:22528
s_waitcnt lgkmcnt(6)
v_mfma_f32_32x32x16_bf16 v[40:55], a[64:67], v[8:11], v[40:55]
ds_read_b128 v[36:39], v5 offset:23552
s_add_u32 m0, s54, 28672
s_add_u32 s55, s53, 28672
buffer_load_dwordx4 v0, s[4:7], s55 offen sc1 lds
s_waitcnt lgkmcnt(6)
v_mfma_f32_32x32x16_bf16 v[40:55], a[68:71], v[12:15], v[40:55]
ds_read_b128 v[8:11], v5 offset:24576
s_waitcnt lgkmcnt(6)
v_mfma_f32_32x32x16_bf16 v[40:55], a[72:75], v[16:19], v[40:55]
ds_read_b128 v[12:15], v5 offset:25600
s_add_u32 m0, s54, 32768
s_add_u32 s55, s53, 32768
buffer_load_dwordx4 v0, s[4:7], s55 offen sc1 lds
s_waitcnt lgkmcnt(6)
v_mfma_f32_32x32x16_bf16 v[40:55], a[76:79], v[20:23], v[40:55]
ds_read_b128 v[16:19], v5 offset:26624
s_waitcnt lgkmcnt(6)
v_mfma_f32_32x32x16_bf16 v[40:55], a[80:83], v[24:27], v[40:55]
ds_read_b128 v[20:23], v5 offset:27648
s_add_u32 m0, s54, 36864
s_add_u32 s55, s53, 36864
buffer_load_dwordx4 v0, s[4:7], s55 offen sc1 lds
s_waitcnt lgkmcnt(6)
v_mfma_f32_32x32x16_bf16 v[40:55], a[84:87], v[28:31], v[40:55]
ds_read_b128 v[24:27], v5 offset:28672
s_waitcnt lgkmcnt(6)
v_mfma_f32_32x32x16_bf16 v[40:55], a[88:91], v[32:35], v[40:55]
ds_read_b128 v[28:31], v5 offset:29696
s_add_u32 m0, s54, 40960
s_add_u32 s55, s53, 40960
buffer_load_dwordx4 v0, s[4:7], s55 offen sc1 lds
s_waitcnt lgkmcnt(6)
v_mfma_f32_32x32x16_bf16 v[40:55], a[92:95], v[36:39], v[40:55]
ds_read_b128 v[32:35], v5 offset:30720
s_waitcnt vmcnt(13) lgkmcnt(2)
s_barrier
s_waitcnt lgkmcnt(6)
v_mfma_f32_32x32x16_bf16 v[40:55], a[96:99], v[8:11], v[40:55]
ds_read_b128 v[36:39], v5 offset:31744
s_add_u32 m0, s54, 45056
s_add_u32 s55, s53, 45056
buffer_load_dwordx4 v0, s[4:7], s55 offen sc1 lds
s_waitcnt lgkmcnt(6)
v_mfma_f32_32x32x16_bf16 v[40:55], a[100:103], v[12:15], v[40:55]
ds_read_b128 v[8:11], v5 offset:32768
s_waitcnt lgkmcnt(6)
v_mfma_f32_32x32x16_bf16 v[40:55], a[104:107], v[16:19], v[40:55]
ds_read_b128 v[12:15], v5 offset:33792
s_add_u32 m0, s54, 49152
s_add_u32 s55, s53, 49152
buffer_load_dwordx4 v0, s[4:7], s55 offen sc1 lds
s_waitcnt lgkmcnt(6)
v_mfma_f32_32x32x16_bf16 v[40:55], a[108:111], v[20:23], v[40:55]
ds_read_b128 v[16:19], v5 offset:34816
s_waitcnt lgkmcnt(6)
v_mfma_f32_32x32x16_bf16 v[40:55], a[112:115], v[24:27], v[40:55]
ds_read_b128 v[20:23], v5 offset:35840
s_add_u32 m0, s54, 53248
s_add_u32 s55, s53, 53248
buffer_load_dwordx4 v0, s[4:7], s55 offen sc1 lds
s_waitcnt lgkmcnt(6)
v_mfma_f32_32x32x16_bf16 v[40:55], a[116:119], v[28:31], v[40:55]
ds_read_b128 v[24:27], v5 offset:36864
s_waitcnt lgkmcnt(6)
v_mfma_f32_32x32x16_bf16 v[40:55], a[120:123], v[32:35], v[40:55]
ds_read_b128 v[28:31], v5 offset:37888
s_add_u32 m0, s54, 57344
s_add_u32 s55, s53, 57344
buffer_load_dwordx4 v0, s[4:7], s55 offen sc1 lds
s_waitcnt lgkmcnt(6)
v_mfma_f32_32x32x16_bf16 v[40:55], a[124:127], v[36:39], v[40:55]
ds_read_b128 v[32:35], v5 offset:38912
s_waitcnt lgkmcnt(6)
v_mfma_f32_32x32x16_bf16 v[40:55], a[128:131], v[8:11], v[40:55]
ds_read_b128 v[36:39], v5 offset:39936
s_add_u32 m0, s54, 61440
s_add_u32 s55, s53, 61440
buffer_load_dwordx4 v0, s[4:7], s55 offen sc1 lds
s_waitcnt lgkmcnt(6)
v_mfma_f32_32x32x16_bf16 v[40:55], a[132:135], v[12:15], v[40:55]
ds_read_b128 v[8:11], v5 offset:40960
s_waitcnt vmcnt(13)
s_barrier
s_waitcnt lgkmcnt(6)
v_mfma_f32_32x32x16_bf16 v[40:55], a[136:139], v[16:19], v[40:55]
ds_read_b128 v[12:15], v5 offset:41984
s_cmp_lg_u32 s42, 0
s_cbranch_scc1 Lgk_w_150
s_mov_b64 exec, 1
buffer_store_dword v4, v3, s[4:7], s59 offen sc1
s_mov_b64 exec, -1
Lgk_w_150:
s_waitcnt lgkmcnt(6)
v_mfma_f32_32x32x16_bf16 v[40:55], a[140:143], v[20:23], v[40:55]
ds_read_b128 v[16:19], v5 offset:43008
s_waitcnt lgkmcnt(6)
v_mfma_f32_32x32x16_bf16 v[40:55], a[144:147], v[24:27], v[40:55]
ds_read_b128 v[20:23], v5 offset:44032
s_waitcnt lgkmcnt(6)
v_mfma_f32_32x32x16_bf16 v[40:55], a[148:151], v[28:31], v[40:55]
ds_read_b128 v[24:27], v5 offset:45056
s_waitcnt lgkmcnt(6)
v_mfma_f32_32x32x16_bf16 v[40:55], a[152:155], v[32:35], v[40:55]
ds_read_b128 v[28:31], v5 offset:46080
s_waitcnt lgkmcnt(6)
v_mfma_f32_32x32x16_bf16 v[40:55], a[156:159], v[36:39], v[40:55]
ds_read_b128 v[32:35], v5 offset:47104
s_waitcnt lgkmcnt(6)
v_mfma_f32_32x32x16_bf16 v[40:55], a[160:163], v[8:11], v[40:55]
ds_read_b128 v[36:39], v5 offset:48128
s_waitcnt lgkmcnt(6)
v_mfma_f32_32x32x16_bf16 v[40:55], a[164:167], v[12:15], v[40:55]
ds_read_b128 v[8:11], v5 offset:49152
s_waitcnt lgkmcnt(6)
v_mfma_f32_32x32x16_bf16 v[40:55], a[168:171], v[16:19], v[40:55]
ds_read_b128 v[12:15], v5 offset:50176
s_waitcnt lgkmcnt(6)
v_mfma_f32_32x32x16_bf16 v[40:55], a[172:175], v[20:23], v[40:55]
ds_read_b128 v[16:19], v5 offset:51200
s_waitcnt lgkmcnt(6)
v_mfma_f32_32x32x16_bf16 v[40:55], a[176:179], v[24:27], v[40:55]
ds_read_b128 v[20:23], v5 offset:52224
s_waitcnt lgkmcnt(6)
v_mfma_f32_32x32x16_bf16 v[40:55], a[180:183], v[28:31], v[40:55]
ds_read_b128 v[24:27], v5 offset:53248
s_waitcnt lgkmcnt(6)
v_mfma_f32_32x32x16_bf16 v[40:55], a[184:187], v[32:35], v[40:55]
ds_read_b128 v[28:31], v5 offset:54272
s_waitcnt lgkmcnt(6)
v_mfma_f32_32x32x16_bf16 v[40:55], a[188:191], v[36:39], v[40:55]
ds_read_b128 v[32:35], v5 offset:55296
s_waitcnt lgkmcnt(6)
v_mfma_f32_32x32x16_bf16 v[40:55], a[192:195], v[8:11], v[40:55]
ds_read_b128 v[36:39], v5 offset:56320
s_waitcnt lgkmcnt(6)
v_mfma_f32_32x32x16_bf16 v[40:55], a[196:199], v[12:15], v[40:55]
ds_read_b128 v[8:11], v5 offset:57344
s_waitcnt lgkmcnt(6)
v_mfma_f32_32x32x16_bf16 v[40:55], a[200:203], v[16:19], v[40:55]
ds_read_b128 v[12:15], v5 offset:58368
s_waitcnt lgkmcnt(6)
v_mfma_f32_32x32x16_bf16 v[40:55], a[204:207], v[20:23], v[40:55]
ds_read_b128 v[16:19], v5 offset:59392
s_waitcnt lgkmcnt(6)
v_mfma_f32_32x32x16_bf16 v[40:55], a[208:211], v[24:27], v[40:55]
ds_read_b128 v[20:23], v5 offset:60416
s_waitcnt lgkmcnt(6)
v_mfma_f32_32x32x16_bf16 v[40:55], a[212:215], v[28:31], v[40:55]
ds_read_b128 v[24:27], v5 offset:61440
s_waitcnt lgkmcnt(6)
v_mfma_f32_32x32x16_bf16 v[40:55], a[216:219], v[32:35], v[40:55]
ds_read_b128 v[28:31], v5 offset:62464
s_waitcnt lgkmcnt(6)
v_mfma_f32_32x32x16_bf16 v[40:55], a[220:223], v[36:39], v[40:55]
ds_read_b128 v[32:35], v5 offset:63488
s_waitcnt lgkmcnt(6)
v_mfma_f32_32x32x16_bf16 v[40:55], a[224:227], v[8:11], v[40:55]
ds_read_b128 v[36:39], v5 offset:64512
s_waitcnt lgkmcnt(6)
v_mfma_f32_32x32x16_bf16 v[40:55], a[228:231], v[12:15], v[40:55]
s_waitcnt lgkmcnt(5)
v_mfma_f32_32x32x16_bf16 v[40:55], a[232:235], v[16:19], v[40:55]
s_waitcnt lgkmcnt(4)
v_mfma_f32_32x32x16_bf16 v[40:55], a[236:239], v[20:23], v[40:55]
s_waitcnt lgkmcnt(3)
v_mfma_f32_32x32x16_bf16 v[40:55], a[240:243], v[24:27], v[40:55]
s_waitcnt lgkmcnt(2)
v_mfma_f32_32x32x16_bf16 v[40:55], a[244:247], v[28:31], v[40:55]
s_waitcnt lgkmcnt(1)
v_mfma_f32_32x32x16_bf16 v[40:55], a[248:251], v[32:35], v[40:55]
s_waitcnt lgkmcnt(0)
v_mfma_f32_32x32x16_bf16 v[40:55], a[252:255], v[36:39], v[40:55]
s_mov_b32 s64, s57
s_add_u32 s50, s46, 1
s_add_u32 s57, s57, s58
v_mov_b32 v4, s50
s_add_u32 s46, s46, s48
s_sub_u32 s47, s47, 1
s_waitcnt vmcnt(8)
s_branch Lgk_top1
Lgk_nop0:
s_waitcnt lgkmcnt(6)
v_mfma_f32_32x32x16_bf16 v[40:55], a[8:11], v[16:19], v[40:55]
ds_read_b128 v[12:15], v5 offset:9216
v_cvt_pk_bf16_f32 v56, v72, v73
v_cvt_pk_bf16_f32 v57, v74, v75
v_cvt_pk_bf16_f32 v58, v76, v77
v_cvt_pk_bf16_f32 v59, v78, v79
s_waitcnt lgkmcnt(6)
v_mfma_f32_32x32x16_bf16 v[40:55], a[12:15], v[20:23], v[40:55]
ds_read_b128 v[16:19], v5 offset:10240
buffer_store_dwordx4 v[56:59], v0, s[4:7], s64 offen sc1
s_add_u32 s64, s64, 4096
v_cvt_pk_bf16_f32 v60, v80, v81
v_cvt_pk_bf16_f32 v61, v82, v83
s_waitcnt lgkmcnt(6)
v_mfma_f32_32x32x16_bf16 v[40:55], a[16:19], v[24:27], v[40:55]
ds_read_b128 v[20:23], v5 offset:11264
v_cvt_pk_bf16_f32 v62, v84, v85
v_cvt_pk_bf16_f32 v63, v86, v87
buffer_store_dwordx4 v[60:63], v0, s[4:7], s64 offen sc1
s_waitcnt lgkmcnt(6)
v_mfma_f32_32x32x16_bf16 v[40:55], a[20:23], v[28:31], v[40:55]
ds_read_b128 v[24:27], v5 offset:12288
s_waitcnt lgkmcnt(6)
v_mfma_f32_32x32x16_bf16 v[40:55], a[24:27], v[32:35], v[40:55]
ds_read_b128 v[28:31], v5 offset:13312
s_waitcnt lgkmcnt(6)
v_mfma_f32_32x32x16_bf16 v[40:55], a[28:31], v[36:39], v[40:55]
ds_read_b128 v[32:35], v5 offset:14336
s_waitcnt lgkmcnt(6)
v_mfma_f32_32x32x16_bf16 v[40:55], a[32:35], v[8:11], v[40:55]
ds_read_b128 v[36:39], v5 offset:15360
s_waitcnt lgkmcnt(6)
v_mfma_f32_32x32x16_bf16 v[40:55], a[36:39], v[12:15], v[40:55]
ds_read_b128 v[8:11], v5 offset:16384
s_waitcnt lgkmcnt(6)
v_mfma_f32_32x32x16_bf16 v[40:55], a[40:43], v[16:19], v[40:55]
ds_read_b128 v[12:15], v5 offset:17408
s_waitcnt lgkmcnt(6)
v_mfma_f32_32x32x16_bf16 v[40:55], a[44:47], v[20:23], v[40:55]
ds_read_b128 v[16:19], v5 offset:18432
s_waitcnt lgkmcnt(6)
v_mfma_f32_32x32x16_bf16 v[40:55], a[48:51], v[24:27], v[40:55]
ds_read_b128 v[20:23], v5 offset:19456
s_waitcnt lgkmcnt(6)
v_mfma_f32_32x32x16_bf16 v[40:55], a[52:55], v[28:31], v[40:55]
ds_read_b128 v[24:27], v5 offset:20480
s_waitcnt lgkmcnt(6)
v_mfma_f32_32x32x16_bf16 v[40:55], a[56:59], v[32:35], v[40:55]
ds_read_b128 v[28:31], v5 offset:21504
s_waitcnt lgkmcnt(6)
v_mfma_f32_32x32x16_bf16 v[40:55], a[60:63], v[36:39], v[40:55]
ds_read_b128 v[32:35], v5 offset:22528
s_waitcnt lgkmcnt(6)
v_mfma_f32_32x32x16_bf16 v[40:55], a[64:67], v[8:11], v[40:55]
ds_read_b128 v[36:39], v5 offset:23552
s_waitcnt lgkmcnt(6)
v_mfma_f32_32x32x16_bf16 v[40:55], a[68:71], v[12:15], v[40:55]
ds_read_b128 v[8:11], v5 offset:24576
s_waitcnt lgkmcnt(6)
v_mfma_f32_32x32x16_bf16 v[40:55], a[72:75], v[16:19], v[40:55]
ds_read_b128 v[12:15], v5 offset:25600
s_waitcnt lgkmcnt(6)
v_mfma_f32_32x32x16_bf16 v[40:55], a[76:79], v[20:23], v[40:55]
ds_read_b128 v[16:19], v5 offset:26624
s_waitcnt lgkmcnt(6)
v_mfma_f32_32x32x16_bf16 v[40:55], a[80:83], v[24:27], v[40:55]
ds_read_b128 v[20:23], v5 offset:27648
s_waitcnt lgkmcnt(6)
v_mfma_f32_32x32x16_bf16 v[40:55], a[84:87], v[28:31], v[40:55]
ds_read_b128 v[24:27], v5 offset:28672
s_waitcnt lgkmcnt(6)
v_mfma_f32_32x32x16_bf16 v[40:55], a[88:91], v[32:35], v[40:55]
ds_read_b128 v[28:31], v5 offset:29696
s_waitcnt lgkmcnt(6)
v_mfma_f32_32x32x16_bf16 v[40:55], a[92:95], v[36:39], v[40:55]
ds_read_b128 v[32:35], v5 offset:30720
s_waitcnt vmcnt(2) lgkmcnt(2)
s_barrier
s_waitcnt lgkmcnt(6)
v_mfma_f32_32x32x16_bf16 v[40:55], a[96:99], v[8:11], v[40:55]
ds_read_b128 v[36:39], v5 offset:31744
s_waitcnt lgkmcnt(6)
v_mfma_f32_32x32x16_bf16 v[40:55], a[100:103], v[12:15], v[40:55]
ds_read_b128 v[8:11], v5 offset:32768
s_waitcnt lgkmcnt(6)
v_mfma_f32_32x32x16_bf16 v[40:55], a[104:107], v[16:19], v[40:55]
ds_read_b128 v[12:15], v5 offset:33792
s_waitcnt lgkmcnt(6)
v_mfma_f32_32x32x16_bf16 v[40:55], a[108:111], v[20:23], v[40:55]
ds_read_b128 v[16:19], v5 offset:34816
s_waitcnt lgkmcnt(6)
v_mfma_f32_32x32x16_bf16 v[40:55], a[112:115], v[24:27], v[40:55]
ds_read_b128 v[20:23], v5 offset:35840
s_waitcnt lgkmcnt(6)
v_mfma_f32_32x32x16_bf16 v[40:55], a[116:119], v[28:31], v[40:55]
ds_read_b128 v[24:27], v5 offset:36864
s_waitcnt lgkmcnt(6)
v_mfma_f32_32x32x16_bf16 v[40:55], a[120:123], v[32:35], v[40:55]
ds_read_b128 v[28:31], v5 offset:37888
s_waitcnt lgkmcnt(6)
v_mfma_f32_32x32x16_bf16 v[40:55], a[124:127], v[36:39], v[40:55]
ds_read_b128 v[32:35], v5 offset:38912
s_waitcnt lgkmcnt(6)
v_mfma_f32_32x32x16_bf16 v[40:55], a[128:131], v[8:11], v[40:55]
ds_read_b128 v[36:39], v5 offset:39936
s_waitcnt lgkmcnt(6)
v_mfma_f32_32x32x16_bf16 v[40:55], a[132:135], v[12:15], v[40:55]
ds_read_b128 v[8:11], v5 offset:40960
s_waitcnt vmcnt(0)
s_barrier
s_waitcnt lgkmcnt(6)
v_mfma_f32_32x32x16_bf16 v[40:55], a[136:139], v[16:19], v[40:55]
ds_read_b128 v[12:15], v5 offset:41984
s_cmp_lg_u32 s42, 0
s_cbranch_scc1 Lgk_w_151
s_mov_b64 exec, 1
buffer_store_dword v4, v3, s[4:7], s59 offen sc1
s_mov_b64 exec, -1
Lgk_w_151:
s_waitcnt lgkmcnt(6)
v_mfma_f32_32x32x16_bf16 v[40:55], a[140:143], v[20:23], v[40:55]
ds_read_b128 v[16:19], v5 offset:43008
s_waitcnt lgkmcnt(6)
v_mfma_f32_32x32x16_bf16 v[40:55], a[144:147], v[24:27], v[40:55]
ds_read_b128 v[20:23], v5 offset:44032
s_waitcnt lgkmcnt(6)
v_mfma_f32_32x32x16_bf16 v[40:55], a[148:151], v[28:31], v[40:55]
ds_read_b128 v[24:27], v5 offset:45056
s_waitcnt lgkmcnt(6)
v_mfma_f32_32x32x16_bf16 v[40:55], a[152:155], v[32:35], v[40:55]
ds_read_b128 v[28:31], v5 offset:46080
s_waitcnt lgkmcnt(6)
v_mfma_f32_32x32x16_bf16 v[40:55], a[156:159], v[36:39], v[40:55]
ds_read_b128 v[32:35], v5 offset:47104
s_waitcnt lgkmcnt(6)
v_mfma_f32_32x32x16_bf16 v[40:55], a[160:163], v[8:11], v[40:55]
ds_read_b128 v[36:39], v5 offset:48128
s_waitcnt lgkmcnt(6)
v_mfma_f32_32x32x16_bf16 v[40:55], a[164:167], v[12:15], v[40:55]
ds_read_b128 v[8:11], v5 offset:49152
s_waitcnt lgkmcnt(6)
v_mfma_f32_32x32x16_bf16 v[40:55], a[168:171], v[16:19], v[40:55]
ds_read_b128 v[12:15], v5 offset:50176
s_waitcnt lgkmcnt(6)
v_mfma_f32_32x32x16_bf16 v[40:55], a[172:175], v[20:23], v[40:55]
ds_read_b128 v[16:19], v5 offset:51200
s_waitcnt lgkmcnt(6)
v_mfma_f32_32x32x16_bf16 v[40:55], a[176:179], v[24:27], v[40:55]
ds_read_b128 v[20:23], v5 offset:52224
s_waitcnt lgkmcnt(6)
v_mfma_f32_32x32x16_bf16 v[40:55], a[180:183], v[28:31], v[40:55]
ds_read_b128 v[24:27], v5 offset:53248
s_waitcnt lgkmcnt(6)
v_mfma_f32_32x32x16_bf16 v[40:55], a[184:187], v[32:35], v[40:55]
ds_read_b128 v[28:31], v5 offset:54272
s_waitcnt lgkmcnt(6)
v_mfma_f32_32x32x16_bf16 v[40:55], a[188:191], v[36:39], v[40:55]
ds_read_b128 v[32:35], v5 offset:55296
s_waitcnt lgkmcnt(6)
v_mfma_f32_32x32x16_bf16 v[40:55], a[192:195], v[8:11], v[40:55]
ds_read_b128 v[36:39], v5 offset:56320
s_waitcnt lgkmcnt(6)
v_mfma_f32_32x32x16_bf16 v[40:55], a[196:199], v[12:15], v[40:55]
ds_read_b128 v[8:11], v5 offset:57344
s_waitcnt lgkmcnt(6)
v_mfma_f32_32x32x16_bf16 v[40:55], a[200:203], v[16:19], v[40:55]
ds_read_b128 v[12:15], v5 offset:58368
s_waitcnt lgkmcnt(6)
v_mfma_f32_32x32x16_bf16 v[40:55], a[204:207], v[20:23], v[40:55]
ds_read_b128 v[16:19], v5 offset:59392
s_waitcnt lgkmcnt(6)
v_mfma_f32_32x32x16_bf16 v[40:55], a[208:211], v[24:27], v[40:55]
ds_read_b128 v[20:23], v5 offset:60416
s_waitcnt lgkmcnt(6)
v_mfma_f32_32x32x16_bf16 v[40:55], a[212:215], v[28:31], v[40:55]
ds_read_b128 v[24:27], v5 offset:61440
s_waitcnt lgkmcnt(6)
v_mfma_f32_32x32x16_bf16 v[40:55], a[216:219], v[32:35], v[40:55]
ds_read_b128 v[28:31], v5 offset:62464
s_waitcnt lgkmcnt(6)
v_mfma_f32_32x32x16_bf16 v[40:55], a[220:223], v[36:39], v[40:55]
ds_read_b128 v[32:35], v5 offset:63488
s_waitcnt lgkmcnt(6)
v_mfma_f32_32x32x16_bf16 v[40:55], a[224:227], v[8:11], v[40:55]
ds_read_b128 v[36:39], v5 offset:64512
s_waitcnt lgkmcnt(6)
v_mfma_f32_32x32x16_bf16 v[40:55], a[228:231], v[12:15], v[40:55]
s_waitcnt lgkmcnt(5)
v_mfma_f32_32x32x16_bf16 v[40:55], a[232:235], v[16:19], v[40:55]
s_waitcnt lgkmcnt(4)
v_mfma_f32_32x32x16_bf16 v[40:55], a[236:239], v[20:23], v[40:55]
s_waitcnt lgkmcnt(3)
v_mfma_f32_32x32x16_bf16 v[40:55], a[240:243], v[24:27], v[40:55]
s_waitcnt lgkmcnt(2)
v_mfma_f32_32x32x16_bf16 v[40:55], a[244:247], v[28:31], v[40:55]
s_waitcnt lgkmcnt(1)
v_mfma_f32_32x32x16_bf16 v[40:55], a[248:251], v[32:35], v[40:55]
s_waitcnt lgkmcnt(0)
v_mfma_f32_32x32x16_bf16 v[40:55], a[252:255], v[36:39], v[40:55]
s_mov_b32 s64, s57
s_add_u32 s50, s46, 1
s_add_u32 s57, s57, s58
v_mov_b32 v4, s50
s_nop 7
v_cvt_pk_bf16_f32 v56, v40, v41
v_cvt_pk_bf16_f32 v57, v42, v43
v_cvt_pk_bf16_f32 v58, v44, v45
v_cvt_pk_bf16_f32 v59, v46, v47
buffer_store_dwordx4 v[56:59], v0, s[4:7], s64 offen sc1
s_add_u32 s64, s64, 4096
v_cvt_pk_bf16_f32 v60, v48, v49
v_cvt_pk_bf16_f32 v61, v50, v51
v_cvt_pk_bf16_f32 v62, v52, v53
v_cvt_pk_bf16_f32 v63, v54, v55
buffer_store_dwordx4 v[60:63], v0, s[4:7], s64 offen sc1
s_waitcnt vmcnt(0)
s_barrier
s_cmp_lg_u32 s42, 0
s_cbranch_scc1 Lgk_w_152
s_mov_b64 exec, 1
buffer_store_dword v4, v3, s[4:7], s59 offen sc1
s_mov_b64 exec, -1
Lgk_w_152:
s_branch Lkdone
Lgk_top1:
s_xor_b32 s65, s65, 0x10000
s_add_u32 s49, s49, s56
v_add_u32 v5, s65, v0
s_barrier
ds_read_b128 v[8:11], v5 offset:0
ds_read_b128 v[12:15], v5 offset:1024
ds_read_b128 v[16:19], v5 offset:2048
s_lshl_b32 s53, s42, 10
s_xor_b32 s54, s65, 0x10000
s_add_u32 s54, s54, s53
s_add_u32 s53, s53, s49
s_waitcnt lgkmcnt(2)
v_mfma_f32_32x32x16_bf16 v[72:87], a[0:3], v[8:11], 0
ds_read_b128 v[20:23], v5 offset:3072
ds_read_b128 v[24:27], v5 offset:4096
ds_read_b128 v[28:31], v5 offset:5120
ds_read_b128 v[32:35], v5 offset:6144
s_waitcnt lgkmcnt(5)
v_mfma_f32_32x32x16_bf16 v[72:87], a[4:7], v[12:15], v[72:87]
ds_read_b128 v[36:39], v5 offset:7168
ds_read_b128 v[8:11], v5 offset:8192
s_cmp_le_u32 s47, 1
s_cbranch_scc1 Lgk_nop1
s_waitcnt lgkmcnt(6)
v_mfma_f32_32x32x16_bf16 v[72:87], a[8:11], v[16:19], v[72:87]
ds_read_b128 v[12:15], v5 offset:9216
s_add_u32 m0, s54, 0
s_add_u32 s55, s53, 0
buffer_load_dwordx4 v0, s[4:7], s55 offen sc1 lds
v_cvt_pk_bf16_f32 v56, v40, v41
s_waitcnt lgkmcnt(6)
v_mfma_f32_32x32x16_bf16 v[72:87], a[12:15], v[20:23], v[72:87]
ds_read_b128 v[16:19], v5 offset:10240
v_cvt_pk_bf16_f32 v57, v42, v43
v_cvt_pk_bf16_f32 v58, v44, v45
v_cvt_pk_bf16_f32 v59, v46, v47
buffer_store_dwordx4 v[56:59], v0, s[4:7], s64 offen sc1
s_waitcnt lgkmcnt(6)
v_mfma_f32_32x32x16_bf16 v[72:87], a[16:19], v[24:27], v[72:87]
ds_read_b128 v[20:23], v5 offset:11264
s_add_u32 m0, s54, 4096
s_add_u32 s55, s53, 4096
buffer_load_dwordx4 v0, s[4:7], s55 offen sc1 lds
s_add_u32 s64, s64, 4096
s_waitcnt lgkmcnt(6)
v_mfma_f32_32x32x16_bf16 v[72:87], a[20:23], v[28:31], v[72:87]
ds_read_b128 v[24:27], v5 offset:12288
v_cvt_pk_bf16_f32 v60, v48, v49
v_cvt_pk_bf16_f32 v61, v50, v51
v_cvt_pk_bf16_f32 v62, v52, v53
v_cvt_pk_bf16_f32 v63, v54, v55
s_waitcnt lgkmcnt(6)
v_mfma_f32_32x32x16_bf16 v[72:87], a[24:27], v[32:35], v[72:87]
ds_read_b128 v[28:31], v5 offset:13312
s_add_u32 m0, s54, 8192
s_add_u32 s55, s53, 8192
buffer_load_dwordx4 v0, s[4:7], s55 offen sc1 lds
buffer_store_dwordx4 v[60:63], v0, s[4:7], s64 offen sc1
s_waitcnt lgkmcnt(6)
v_mfma_f32_32x32x16_bf16 v[72:87], a[28:31], v[36:39], v[72:87]
ds_read_b128 v[32:35], v5 offset:14336
s_waitcnt lgkmcnt(6)
v_mfma_f32_32x32x16_bf16 v[72:87], a[32:35], v[8:11], v[72:87]
ds_read_b128 v[36:39], v5 offset:15360
s_add_u32 m0, s54, 12288
s_add_u32 s55, s53, 12288
buffer_load_dwordx4 v0, s[4:7], s55 offen sc1 lds
s_waitcnt lgkmcnt(6)
v_mfma_f32_32x32x16_bf16 v[72:87], a[36:39], v[12:15], v[72:87]
ds_read_b128 v[8:11], v5 offset:16384
s_waitcnt lgkmcnt(6)
v_mfma_f32_32x32x16_bf16 v[72:87], a[40:43], v[16:19], v[72:87]
ds_read_b128 v[12:15], v5 offset:17408
s_add_u32 m0, s54, 16384
s_add_u32 s55, s53, 16384
buffer_load_dwordx4 v0, s[4:7], s55 offen sc1 lds
s_waitcnt lgkmcnt(6)
v_mfma_f32_32x32x16_bf16 v[72:87], a[44:47], v[20:23], v[72:87]
ds_read_b128 v[16:19], v5 offset:18432
s_waitcnt lgkmcnt(6)
v_mfma_f32_32x32x16_bf16 v[72:87], a[48:51], v[24:27], v[72:87]
ds_read_b128 v[20:23], v5 offset:19456
s_add_u32 m0, s54, 20480
s_add_u32 s55, s53, 20480
buffer_load_dwordx4 v0, s[4:7], s55 offen sc1 lds
s_waitcnt lgkmcnt(6)
v_mfma_f32_32x32x16_bf16 v[72:87], a[52:55], v[28:31], v[72:87]
ds_read_b128 v[24:27], v5 offset:20480
s_waitcnt lgkmcnt(6)
v_mfma_f32_32x32x16_bf16 v[72:87], a[56:59], v[32:35], v[72:87]
ds_read_b128 v[28:31], v5 offset:21504
s_add_u32 m0, s54, 24576
s_add_u32 s55, s53, 24576
buffer_load_dwordx4 v0, s[4:7], s55 offen sc1 lds
s_waitcnt lgkmcnt(6)
v_mfma_f32_32x32x16_bf16 v[72:87], a[60:63], v[36:39], v[72:87]
ds_read_b128 v[32:35], v5 offset:22528
s_waitcnt lgkmcnt(6)
v_mfma_f32_32x32x16_bf16 v[72:87], a[64:67], v[8:11], v[72:87]
ds_read_b128 v[36:39], v5 offset:23552
s_add_u32 m0, s54, 28672
s_add_u32 s55, s53, 28672
buffer_load_dwordx4 v0, s[4:7], s55 offen sc1 lds
s_waitcnt lgkmcnt(6)
v_mfma_f32_32x32x16_bf16 v[72:87], a[68:71], v[12:15], v[72:87]
ds_read_b128 v[8:11], v5 offset:24576
s_waitcnt lgkmcnt(6)
v_mfma_f32_32x32x16_bf16 v[72:87], a[72:75], v[16:19], v[72:87]
ds_read_b128 v[12:15], v5 offset:25600
s_add_u32 m0, s54, 32768
s_add_u32 s55, s53, 32768
buffer_load_dwordx4 v0, s[4:7], s55 offen sc1 lds
s_waitcnt lgkmcnt(6)
v_mfma_f32_32x32x16_bf16 v[72:87], a[76:79], v[20:23], v[72:87]
ds_read_b128 v[16:19], v5 offset:26624
s_waitcnt lgkmcnt(6)
v_mfma_f32_32x32x16_bf16 v[72:87], a[80:83], v[24:27], v[72:87]
ds_read_b128 v[20:23], v5 offset:27648
s_add_u32 m0, s54, 36864
s_add_u32 s55, s53, 36864
buffer_load_dwordx4 v0, s[4:7], s55 offen sc1 lds
s_waitcnt lgkmcnt(6)
v_mfma_f32_32x32x16_bf16 v[72:87], a[84:87], v[28:31], v[72:87]
ds_read_b128 v[24:27], v5 offset:28672
s_waitcnt lgkmcnt(6)
v_mfma_f32_32x32x16_bf16 v[72:87], a[88:91], v[32:35], v[72:87]
ds_read_b128 v[28:31], v5 offset:29696
s_add_u32 m0, s54, 40960
s_add_u32 s55, s53, 40960
buffer_load_dwordx4 v0, s[4:7], s55 offen sc1 lds
s_waitcnt lgkmcnt(6)
v_mfma_f32_32x32x16_bf16 v[72:87], a[92:95], v[36:39], v[72:87]
ds_read_b128 v[32:35], v5 offset:30720
s_waitcnt vmcnt(13) lgkmcnt(2)
s_barrier
s_waitcnt lgkmcnt(6)
v_mfma_f32_32x32x16_bf16 v[72:87], a[96:99], v[8:11], v[72:87]
ds_read_b128 v[36:39], v5 offset:31744
s_add_u32 m0, s54, 45056
s_add_u32 s55, s53, 45056
buffer_load_dwordx4 v0, s[4:7], s55 offen sc1 lds
s_waitcnt lgkmcnt(6)
v_mfma_f32_32x32x16_bf16 v[72:87], a[100:103], v[12:15], v[72:87]
ds_read_b128 v[8:11], v5 offset:32768
s_waitcnt lgkmcnt(6)
v_mfma_f32_32x32x16_bf16 v[72:87], a[104:107], v[16:19], v[72:87]
ds_read_b128 v[12:15], v5 offset:33792
s_add_u32 m0, s54, 49152
s_add_u32 s55, s53, 49152
buffer_load_dwordx4 v0, s[4:7], s55 offen sc1 lds
s_waitcnt lgkmcnt(6)
v_mfma_f32_32x32x16_bf16 v[72:87], a[108:111], v[20:23], v[72:87]
ds_read_b128 v[16:19], v5 offset:34816
s_waitcnt lgkmcnt(6)
v_mfma_f32_32x32x16_bf16 v[72:87], a[112:115], v[24:27], v[72:87]
ds_read_b128 v[20:23], v5 offset:35840
s_add_u32 m0, s54, 53248
s_add_u32 s55, s53, 53248
buffer_load_dwordx4 v0, s[4:7], s55 offen sc1 lds
s_waitcnt lgkmcnt(6)
v_mfma_f32_32x32x16_bf16 v[72:87], a[116:119], v[28:31], v[72:87]
ds_read_b128 v[24:27], v5 offset:36864
s_waitcnt lgkmcnt(6)
v_mfma_f32_32x32x16_bf16 v[72:87], a[120:123], v[32:35], v[72:87]
ds_read_b128 v[28:31], v5 offset:37888
s_add_u32 m0, s54, 57344
s_add_u32 s55, s53, 57344
buffer_load_dwordx4 v0, s[4:7], s55 offen sc1 lds
s_waitcnt lgkmcnt(6)
v_mfma_f32_32x32x16_bf16 v[72:87], a[124:127], v[36:39], v[72:87]
ds_read_b128 v[32:35], v5 offset:38912
s_waitcnt lgkmcnt(6)
v_mfma_f32_32x32x16_bf16 v[72:87], a[128:131], v[8:11], v[72:87]
ds_read_b128 v[36:39], v5 offset:39936
s_add_u32 m0, s54, 61440
s_add_u32 s55, s53, 61440
buffer_load_dwordx4 v0, s[4:7], s55 offen sc1 lds
s_waitcnt lgkmcnt(6)
v_mfma_f32_32x32x16_bf16 v[72:87], a[132:135], v[12:15], v[72:87]
ds_read_b128 v[8:11], v5 offset:40960
s_waitcnt vmcnt(13)
s_barrier
s_waitcnt lgkmcnt(6)
v_mfma_f32_32x32x16_bf16 v[72:87], a[136:139], v[16:19], v[72:87]
ds_read_b128 v[12:15], v5 offset:41984
s_cmp_lg_u32 s42, 0
s_cbranch_scc1 Lgk_w_153
s_mov_b64 exec, 1
buffer_store_dword v4, v3, s[4:7], s59 offen sc1
s_mov_b64 exec, -1
Lgk_w_153:
s_waitcnt lgkmcnt(6)
v_mfma_f32_32x32x16_bf16 v[72:87], a[140:143], v[20:23], v[72:87]
ds_read_b128 v[16:19], v5 offset:43008
s_waitcnt lgkmcnt(6)
v_mfma_f32_32x32x16_bf16 v[72:87], a[144:147], v[24:27], v[72:87]
ds_read_b128 v[20:23], v5 offset:44032
s_waitcnt lgkmcnt(6)
v_mfma_f32_32x32x16_bf16 v[72:87], a[148:151], v[28:31], v[72:87]
ds_read_b128 v[24:27], v5 offset:45056
s_waitcnt lgkmcnt(6)
v_mfma_f32_32x32x16_bf16 v[72:87], a[152:155], v[32:35], v[72:87]
ds_read_b128 v[28:31], v5 offset:46080
s_waitcnt lgkmcnt(6)
v_mfma_f32_32x32x16_bf16 v[72:87], a[156:159], v[36:39], v[72:87]
ds_read_b128 v[32:35], v5 offset:47104
s_waitcnt lgkmcnt(6)
v_mfma_f32_32x32x16_bf16 v[72:87], a[160:163], v[8:11], v[72:87]
ds_read_b128 v[36:39], v5 offset:48128
s_waitcnt lgkmcnt(6)
v_mfma_f32_32x32x16_bf16 v[72:87], a[164:167], v[12:15], v[72:87]
ds_read_b128 v[8:11], v5 offset:49152
s_waitcnt lgkmcnt(6)
v_mfma_f32_32x32x16_bf16 v[72:87], a[168:171], v[16:19], v[72:87]
ds_read_b128 v[12:15], v5 offset:50176
s_waitcnt lgkmcnt(6)
v_mfma_f32_32x32x16_bf16 v[72:87], a[172:175], v[20:23], v[72:87]
ds_read_b128 v[16:19], v5 offset:51200
s_waitcnt lgkmcnt(6)
v_mfma_f32_32x32x16_bf16 v[72:87], a[176:179], v[24:27], v[72:87]
ds_read_b128 v[20:23], v5 offset:52224
s_waitcnt lgkmcnt(6)
v_mfma_f32_32x32x16_bf16 v[72:87], a[180:183], v[28:31], v[72:87]
ds_read_b128 v[24:27], v5 offset:53248
s_waitcnt lgkmcnt(6)
v_mfma_f32_32x32x16_bf16 v[72:87], a[184:187], v[32:35], v[72:87]
ds_read_b128 v[28:31], v5 offset:54272
s_waitcnt lgkmcnt(6)
v_mfma_f32_32x32x16_bf16 v[72:87], a[188:191], v[36:39], v[72:87]
ds_read_b128 v[32:35], v5 offset:55296
s_waitcnt lgkmcnt(6)
v_mfma_f32_32x32x16_bf16 v[72:87], a[192:195], v[8:11], v[72:87]
ds_read_b128 v[36:39], v5 offset:56320
s_waitcnt lgkmcnt(6)
v_mfma_f32_32x32x16_bf16 v[72:87], a[196:199], v[12:15], v[72:87]
ds_read_b128 v[8:11], v5 offset:57344
s_waitcnt lgkmcnt(6)
v_mfma_f32_32x32x16_bf16 v[72:87], a[200:203], v[16:19], v[72:87]
ds_read_b128 v[12:15], v5 offset:58368
s_waitcnt lgkmcnt(6)
v_mfma_f32_32x32x16_bf16 v[72:87], a[204:207], v[20:23], v[72:87]
ds_read_b128 v[16:19], v5 offset:59392
s_waitcnt lgkmcnt(6)
v_mfma_f32_32x32x16_bf16 v[72:87], a[208:211], v[24:27], v[72:87]
ds_read_b128 v[20:23], v5 offset:60416
s_waitcnt lgkmcnt(6)
v_mfma_f32_32x32x16_bf16 v[72:87], a[212:215], v[28:31], v[72:87]
ds_read_b128 v[24:27], v5 offset:61440
s_waitcnt lgkmcnt(6)
v_mfma_f32_32x32x16_bf16 v[72:87], a[216:219], v[32:35], v[72:87]
ds_read_b128 v[28:31], v5 offset:62464
s_waitcnt lgkmcnt(6)
v_mfma_f32_32x32x16_bf16 v[72:87], a[220:223], v[36:39], v[72:87]
ds_read_b128 v[32:35], v5 offset:63488
s_waitcnt lgkmcnt(6)
v_mfma_f32_32x32x16_bf16 v[72:87], a[224:227], v[8:11], v[72:87]
ds_read_b128 v[36:39], v5 offset:64512
s_waitcnt lgkmcnt(6)
v_mfma_f32_32x32x16_bf16 v[72:87], a[228:231], v[12:15], v[72:87]
s_waitcnt lgkmcnt(5)
v_mfma_f32_32x32x16_bf16 v[72:87], a[232:235], v[16:19], v[72:87]
s_waitcnt lgkmcnt(4)
v_mfma_f32_32x32x16_bf16 v[72:87], a[236:239], v[20:23], v[72:87]
s_waitcnt lgkmcnt(3)
v_mfma_f32_32x32x16_bf16 v[72:87], a[240:243], v[24:27], v[72:87]
s_waitcnt lgkmcnt(2)
v_mfma_f32_32x32x16_bf16 v[72:87], a[244:247], v[28:31], v[72:87]
s_waitcnt lgkmcnt(1)
v_mfma_f32_32x32x16_bf16 v[72:87], a[248:251], v[32:35], v[72:87]
s_waitcnt lgkmcnt(0)
v_mfma_f32_32x32x16_bf16 v[72:87], a[252:255], v[36:39], v[72:87]
s_mov_b32 s64, s57
s_add_u32 s50, s46, 1
s_add_u32 s57, s57, s58
v_mov_b32 v4, s50
s_add_u32 s46, s46, s48
s_sub_u32 s47, s47, 1
s_waitcnt vmcnt(8)
s_branch Lgk_top0
Lgk_nop1:
s_waitcnt lgkmcnt(6)
v_mfma_f32_32x32x16_bf16 v[72:87], a[8:11], v[16:19], v[72:87]
ds_read_b128 v[12:15], v5 offset:9216
v_cvt_pk_bf16_f32 v56, v40, v41
v_cvt_pk_bf16_f32 v57, v42, v43
v_cvt_pk_bf16_f32 v58, v44, v45
v_cvt_pk_bf16_f32 v59, v46, v47
s_waitcnt lgkmcnt(6)
v_mfma_f32_32x32x16_bf16 v[72:87], a[12:15], v[20:23], v[72:87]
ds_read_b128 v[16:19], v5 offset:10240
buffer_store_dwordx4 v[56:59], v0, s[4:7], s64 offen sc1
s_add_u32 s64, s64, 4096
v_cvt_pk_bf16_f32 v60, v48, v49
v_cvt_pk_bf16_f32 v61, v50, v51
s_waitcnt lgkmcnt(6)
v_mfma_f32_32x32x16_bf16 v[72:87], a[16:19], v[24:27], v[72:87]
ds_read_b128 v[20:23], v5 offset:11264
v_cvt_pk_bf16_f32 v62, v52, v53
v_cvt_pk_bf16_f32 v63, v54, v55
buffer_store_dwordx4 v[60:63], v0, s[4:7], s64 offen sc1
s_waitcnt lgkmcnt(6)
v_mfma_f32_32x32x16_bf16 v[72:87], a[20:23], v[28:31], v[72:87]
ds_read_b128 v[24:27], v5 offset:12288
s_waitcnt lgkmcnt(6)
v_mfma_f32_32x32x16_bf16 v[72:87], a[24:27], v[32:35], v[72:87]
ds_read_b128 v[28:31], v5 offset:13312
s_waitcnt lgkmcnt(6)
v_mfma_f32_32x32x16_bf16 v[72:87], a[28:31], v[36:39], v[72:87]
ds_read_b128 v[32:35], v5 offset:14336
s_waitcnt lgkmcnt(6)
v_mfma_f32_32x32x16_bf16 v[72:87], a[32:35], v[8:11], v[72:87]
ds_read_b128 v[36:39], v5 offset:15360
s_waitcnt lgkmcnt(6)
v_mfma_f32_32x32x16_bf16 v[72:87], a[36:39], v[12:15], v[72:87]
ds_read_b128 v[8:11], v5 offset:16384
s_waitcnt lgkmcnt(6)
v_mfma_f32_32x32x16_bf16 v[72:87], a[40:43], v[16:19], v[72:87]
ds_read_b128 v[12:15], v5 offset:17408
s_waitcnt lgkmcnt(6)
v_mfma_f32_32x32x16_bf16 v[72:87], a[44:47], v[20:23], v[72:87]
ds_read_b128 v[16:19], v5 offset:18432
s_waitcnt lgkmcnt(6)
v_mfma_f32_32x32x16_bf16 v[72:87], a[48:51], v[24:27], v[72:87]
ds_read_b128 v[20:23], v5 offset:19456
s_waitcnt lgkmcnt(6)
v_mfma_f32_32x32x16_bf16 v[72:87], a[52:55], v[28:31], v[72:87]
ds_read_b128 v[24:27], v5 offset:20480
s_waitcnt lgkmcnt(6)
v_mfma_f32_32x32x16_bf16 v[72:87], a[56:59], v[32:35], v[72:87]
ds_read_b128 v[28:31], v5 offset:21504
s_waitcnt lgkmcnt(6)
v_mfma_f32_32x32x16_bf16 v[72:87], a[60:63], v[36:39], v[72:87]
ds_read_b128 v[32:35], v5 offset:22528
s_waitcnt lgkmcnt(6)
v_mfma_f32_32x32x16_bf16 v[72:87], a[64:67], v[8:11], v[72:87]
ds_read_b128 v[36:39], v5 offset:23552
s_waitcnt lgkmcnt(6)
v_mfma_f32_32x32x16_bf16 v[72:87], a[68:71], v[12:15], v[72:87]
ds_read_b128 v[8:11], v5 offset:24576
s_waitcnt lgkmcnt(6)
v_mfma_f32_32x32x16_bf16 v[72:87], a[72:75], v[16:19], v[72:87]
ds_read_b128 v[12:15], v5 offset:25600
s_waitcnt lgkmcnt(6)
v_mfma_f32_32x32x16_bf16 v[72:87], a[76:79], v[20:23], v[72:87]
ds_read_b128 v[16:19], v5 offset:26624
s_waitcnt lgkmcnt(6)
v_mfma_f32_32x32x16_bf16 v[72:87], a[80:83], v[24:27], v[72:87]
ds_read_b128 v[20:23], v5 offset:27648
s_waitcnt lgkmcnt(6)
v_mfma_f32_32x32x16_bf16 v[72:87], a[84:87], v[28:31], v[72:87]
ds_read_b128 v[24:27], v5 offset:28672
s_waitcnt lgkmcnt(6)
v_mfma_f32_32x32x16_bf16 v[72:87], a[88:91], v[32:35], v[72:87]
ds_read_b128 v[28:31], v5 offset:29696
s_waitcnt lgkmcnt(6)
v_mfma_f32_32x32x16_bf16 v[72:87], a[92:95], v[36:39], v[72:87]
ds_read_b128 v[32:35], v5 offset:30720
s_waitcnt vmcnt(2) lgkmcnt(2)
s_barrier
s_waitcnt lgkmcnt(6)
v_mfma_f32_32x32x16_bf16 v[72:87], a[96:99], v[8:11], v[72:87]
ds_read_b128 v[36:39], v5 offset:31744
s_waitcnt lgkmcnt(6)
v_mfma_f32_32x32x16_bf16 v[72:87], a[100:103], v[12:15], v[72:87]
ds_read_b128 v[8:11], v5 offset:32768
s_waitcnt lgkmcnt(6)
v_mfma_f32_32x32x16_bf16 v[72:87], a[104:107], v[16:19], v[72:87]
ds_read_b128 v[12:15], v5 offset:33792
s_waitcnt lgkmcnt(6)
v_mfma_f32_32x32x16_bf16 v[72:87], a[108:111], v[20:23], v[72:87]
ds_read_b128 v[16:19], v5 offset:34816
s_waitcnt lgkmcnt(6)
v_mfma_f32_32x32x16_bf16 v[72:87], a[112:115], v[24:27], v[72:87]
ds_read_b128 v[20:23], v5 offset:35840
s_waitcnt lgkmcnt(6)
v_mfma_f32_32x32x16_bf16 v[72:87], a[116:119], v[28:31], v[72:87]
ds_read_b128 v[24:27], v5 offset:36864
s_waitcnt lgkmcnt(6)
v_mfma_f32_32x32x16_bf16 v[72:87], a[120:123], v[32:35], v[72:87]
ds_read_b128 v[28:31], v5 offset:37888
s_waitcnt lgkmcnt(6)
v_mfma_f32_32x32x16_bf16 v[72:87], a[124:127], v[36:39], v[72:87]
ds_read_b128 v[32:35], v5 offset:38912
s_waitcnt lgkmcnt(6)
v_mfma_f32_32x32x16_bf16 v[72:87], a[128:131], v[8:11], v[72:87]
ds_read_b128 v[36:39], v5 offset:39936
s_waitcnt lgkmcnt(6)
v_mfma_f32_32x32x16_bf16 v[72:87], a[132:135], v[12:15], v[72:87]
ds_read_b128 v[8:11], v5 offset:40960
s_waitcnt vmcnt(0)
s_barrier
s_waitcnt lgkmcnt(6)
v_mfma_f32_32x32x16_bf16 v[72:87], a[136:139], v[16:19], v[72:87]
ds_read_b128 v[12:15], v5 offset:41984
s_cmp_lg_u32 s42, 0
s_cbranch_scc1 Lgk_w_154
s_mov_b64 exec, 1
buffer_store_dword v4, v3, s[4:7], s59 offen sc1
s_mov_b64 exec, -1
Lgk_w_154:
s_waitcnt lgkmcnt(6)
v_mfma_f32_32x32x16_bf16 v[72:87], a[140:143], v[20:23], v[72:87]
ds_read_b128 v[16:19], v5 offset:43008
s_waitcnt lgkmcnt(6)
v_mfma_f32_32x32x16_bf16 v[72:87], a[144:147], v[24:27], v[72:87]
ds_read_b128 v[20:23], v5 offset:44032
s_waitcnt lgkmcnt(6)
v_mfma_f32_32x32x16_bf16 v[72:87], a[148:151], v[28:31], v[72:87]
ds_read_b128 v[24:27], v5 offset:45056
s_waitcnt lgkmcnt(6)
v_mfma_f32_32x32x16_bf16 v[72:87], a[152:155], v[32:35], v[72:87]
ds_read_b128 v[28:31], v5 offset:46080
s_waitcnt lgkmcnt(6)
v_mfma_f32_32x32x16_bf16 v[72:87], a[156:159], v[36:39], v[72:87]
ds_read_b128 v[32:35], v5 offset:47104
s_waitcnt lgkmcnt(6)
v_mfma_f32_32x32x16_bf16 v[72:87], a[160:163], v[8:11], v[72:87]
ds_read_b128 v[36:39], v5 offset:48128
s_waitcnt lgkmcnt(6)
v_mfma_f32_32x32x16_bf16 v[72:87], a[164:167], v[12:15], v[72:87]
ds_read_b128 v[8:11], v5 offset:49152
s_waitcnt lgkmcnt(6)
v_mfma_f32_32x32x16_bf16 v[72:87], a[168:171], v[16:19], v[72:87]
ds_read_b128 v[12:15], v5 offset:50176
s_waitcnt lgkmcnt(6)
v_mfma_f32_32x32x16_bf16 v[72:87], a[172:175], v[20:23], v[72:87]
ds_read_b128 v[16:19], v5 offset:51200
s_waitcnt lgkmcnt(6)
v_mfma_f32_32x32x16_bf16 v[72:87], a[176:179], v[24:27], v[72:87]
ds_read_b128 v[20:23], v5 offset:52224
s_waitcnt lgkmcnt(6)
v_mfma_f32_32x32x16_bf16 v[72:87], a[180:183], v[28:31], v[72:87]
ds_read_b128 v[24:27], v5 offset:53248
s_waitcnt lgkmcnt(6)
v_mfma_f32_32x32x16_bf16 v[72:87], a[184:187], v[32:35], v[72:87]
ds_read_b128 v[28:31], v5 offset:54272
s_waitcnt lgkmcnt(6)
v_mfma_f32_32x32x16_bf16 v[72:87], a[188:191], v[36:39], v[72:87]
ds_read_b128 v[32:35], v5 offset:55296
s_waitcnt lgkmcnt(6)
v_mfma_f32_32x32x16_bf16 v[72:87], a[192:195], v[8:11], v[72:87]
ds_read_b128 v[36:39], v5 offset:56320
s_waitcnt lgkmcnt(6)
v_mfma_f32_32x32x16_bf16 v[72:87], a[196:199], v[12:15], v[72:87]
ds_read_b128 v[8:11], v5 offset:57344
s_waitcnt lgkmcnt(6)
v_mfma_f32_32x32x16_bf16 v[72:87], a[200:203], v[16:19], v[72:87]
ds_read_b128 v[12:15], v5 offset:58368
s_waitcnt lgkmcnt(6)
v_mfma_f32_32x32x16_bf16 v[72:87], a[204:207], v[20:23], v[72:87]
ds_read_b128 v[16:19], v5 offset:59392
s_waitcnt lgkmcnt(6)
v_mfma_f32_32x32x16_bf16 v[72:87], a[208:211], v[24:27], v[72:87]
ds_read_b128 v[20:23], v5 offset:60416
s_waitcnt lgkmcnt(6)
v_mfma_f32_32x32x16_bf16 v[72:87], a[212:215], v[28:31], v[72:87]
ds_read_b128 v[24:27], v5 offset:61440
s_waitcnt lgkmcnt(6)
v_mfma_f32_32x32x16_bf16 v[72:87], a[216:219], v[32:35], v[72:87]
ds_read_b128 v[28:31], v5 offset:62464
s_waitcnt lgkmcnt(6)
v_mfma_f32_32x32x16_bf16 v[72:87], a[220:223], v[36:39], v[72:87]
ds_read_b128 v[32:35], v5 offset:63488
s_waitcnt lgkmcnt(6)
v_mfma_f32_32x32x16_bf16 v[72:87], a[224:227], v[8:11], v[72:87]
ds_read_b128 v[36:39], v5 offset:64512
s_waitcnt lgkmcnt(6)
v_mfma_f32_32x32x16_bf16 v[72:87], a[228:231], v[12:15], v[72:87]
s_waitcnt lgkmcnt(5)
v_mfma_f32_32x32x16_bf16 v[72:87], a[232:235], v[16:19], v[72:87]
s_waitcnt lgkmcnt(4)
v_mfma_f32_32x32x16_bf16 v[72:87], a[236:239], v[20:23], v[72:87]
s_waitcnt lgkmcnt(3)
v_mfma_f32_32x32x16_bf16 v[72:87], a[240:243], v[24:27], v[72:87]
s_waitcnt lgkmcnt(2)
v_mfma_f32_32x32x16_bf16 v[72:87], a[244:247], v[28:31], v[72:87]
s_waitcnt lgkmcnt(1)
v_mfma_f32_32x32x16_bf16 v[72:87], a[248:251], v[32:35], v[72:87]
s_waitcnt lgkmcnt(0)
v_mfma_f32_32x32x16_bf16 v[72:87], a[252:255], v[36:39], v[72:87]
s_mov_b32 s64, s57
s_add_u32 s50, s46, 1
s_add_u32 s57, s57, s58
v_mov_b32 v4, s50
s_nop 7
v_cvt_pk_bf16_f32 v56, v72, v73
v_cvt_pk_bf16_f32 v57, v74, v75
v_cvt_pk_bf16_f32 v58, v76, v77
v_cvt_pk_bf16_f32 v59, v78, v79
buffer_store_dwordx4 v[56:59], v0, s[4:7], s64 offen sc1
s_add_u32 s64, s64, 4096
v_cvt_pk_bf16_f32 v60, v80, v81
v_cvt_pk_bf16_f32 v61, v82, v83
v_cvt_pk_bf16_f32 v62, v84, v85
v_cvt_pk_bf16_f32 v63, v86, v87
buffer_store_dwordx4 v[60:63], v0, s[4:7], s64 offen sc1
s_waitcnt vmcnt(0)
s_barrier
s_cmp_lg_u32 s42, 0
s_cbranch_scc1 Lgk_w_155
s_mov_b64 exec, 1
buffer_store_dword v4, v3, s[4:7], s59 offen sc1
s_mov_b64 exec, -1
Lgk_w_155:
s_branch Lkdone
Lgv:
s_mov_b32 s65, 0x10000
v_mov_b32 v71, 131072
v_mov_b32 v4, 0
Lgv_cold:
s_lshl_b32 s53, s42, 10
s_xor_b32 s54, s65, 0x10000
s_add_u32 s54, s54, s53
s_add_u32 s53, s53, s49
s_add_u32 m0, s54, 0
s_add_u32 s55, s53, 0
buffer_load_dwordx4 v0, s[4:7], s55 offen sc1 lds
s_add_u32 m0, s54, 4096
s_add_u32 s55, s53, 4096
buffer_load_dwordx4 v0, s[4:7], s55 offen sc1 lds
s_add_u32 m0, s54, 8192
s_add_u32 s55, s53, 8192
buffer_load_dwordx4 v0, s[4:7], s55 offen sc1 lds
s_add_u32 m0, s54, 12288
s_add_u32 s55, s53, 12288
buffer_load_dwordx4 v0, s[4:7], s55 offen sc1 lds
s_add_u32 m0, s54, 16384
s_add_u32 s55, s53, 16384
buffer_load_dwordx4 v0, s[4:7], s55 offen sc1 lds
s_add_u32 m0, s54, 20480
s_add_u32 s55, s53, 20480
buffer_load_dwordx4 v0, s[4:7], s55 offen sc1 lds
s_add_u32 m0, s54, 24576
s_add_u32 s55, s53, 24576
buffer_load_dwordx4 v0, s[4:7], s55 offen sc1 lds
s_add_u32 m0, s54, 28672
s_add_u32 s55, s53, 28672
buffer_load_dwordx4 v0, s[4:7], s55 offen sc1 lds
s_add_u32 m0, s54, 32768
s_add_u32 s55, s53, 32768
buffer_load_dwordx4 v0, s[4:7], s55 offen sc1 lds
s_add_u32 m0, s54, 36864
s_add_u32 s55, s53, 36864
buffer_load_dwordx4 v0, s[4:7], s55 offen sc1 lds
s_add_u32 m0, s54, 40960
s_add_u32 s55, s53, 40960
buffer_load_dwordx4 v0, s[4:7], s55 offen sc1 lds
s_add_u32 m0, s54, 45056
s_add_u32 s55, s53, 45056
buffer_load_dwordx4 v0, s[4:7], s55 offen sc1 lds
s_add_u32 m0, s54, 49152
s_add_u32 s55, s53, 49152
buffer_load_dwordx4 v0, s[4:7], s55 offen sc1 lds
s_add_u32 m0, s54, 53248
s_add_u32 s55, s53, 53248
buffer_load_dwordx4 v0, s[4:7], s55 offen sc1 lds
s_add_u32 m0, s54, 57344
s_add_u32 s55, s53, 57344
buffer_load_dwordx4 v0, s[4:7], s55 offen sc1 lds
s_add_u32 m0, s54, 61440
s_add_u32 s55, s53, 61440
buffer_load_dwordx4 v0, s[4:7], s55 offen sc1 lds
s_lshl_b32 s64, s40, 14
s_lshl_b32 s50, s42, 11
s_add_u32 s64, s64, s50
s_add_u32 s64, s64, 155189248
s_waitcnt vmcnt(8)
Lgv_top0:
s_xor_b32 s65, s65, 0x10000
s_add_u32 s49, s49, s56
v_add_u32 v5, s65, v0
s_barrier
ds_read_b128 v[8:11], v5 offset:0
ds_read_b128 v[12:15], v5 offset:1024
ds_read_b128 v[16:19], v5 offset:2048
s_lshl_b32 s53, s42, 10
s_xor_b32 s54, s65, 0x10000
s_add_u32 s54, s54, s53
s_add_u32 s53, s53, s49
s_waitcnt lgkmcnt(2)
v_mfma_f32_32x32x16_bf16 v[40:55], v[8:11], a[0:3], 0
ds_read_b128 v[20:23], v5 offset:3072
ds_read_b128 v[24:27], v5 offset:4096
ds_read_b128 v[28:31], v5 offset:5120
ds_read_b128 v[32:35], v5 offset:6144
s_waitcnt lgkmcnt(5)
v_mfma_f32_32x32x16_bf16 v[40:55], v[12:15], a[4:7], v[40:55]
ds_read_b128 v[36:39], v5 offset:7168
ds_read_b128 v[8:11], v5 offset:8192
s_cmp_le_u32 s47, 1
s_cbranch_scc1 Lgv_nop0
s_waitcnt lgkmcnt(6)
v_mfma_f32_32x32x16_bf16 v[40:55], v[16:19], a[8:11], v[40:55]
ds_read_b128 v[12:15], v5 offset:9216
s_add_u32 m0, s54, 0
s_add_u32 s55, s53, 0
buffer_load_dwordx4 v0, s[4:7], s55 offen sc1 lds
v_cvt_pk_bf16_f32 v56, v72, v73
s_waitcnt lgkmcnt(6)
v_mfma_f32_32x32x16_bf16 v[40:55], v[20:23], a[12:15], v[40:55]
ds_read_b128 v[16:19], v5 offset:10240
v_cvt_pk_bf16_f32 v57, v74, v75
v_cvt_pk_bf16_f32 v58, v80, v81
v_cvt_pk_bf16_f32 v59, v82, v83
buffer_store_dwordx4 v[56:59], v0, s[4:7], s64 offen offset:0 sc1
s_waitcnt lgkmcnt(6)
v_mfma_f32_32x32x16_bf16 v[40:55], v[24:27], a[16:19], v[40:55]
ds_read_b128 v[20:23], v5 offset:11264
s_add_u32 m0, s54, 4096
s_add_u32 s55, s53, 4096
buffer_load_dwordx4 v0, s[4:7], s55 offen sc1 lds
v_cvt_pk_bf16_f32 v60, v76, v77
s_waitcnt lgkmcnt(6)
v_mfma_f32_32x32x16_bf16 v[40:55], v[28:31], a[20:23], v[40:55]
ds_read_b128 v[24:27], v5 offset:12288
v_cvt_pk_bf16_f32 v61, v78, v79
v_cvt_pk_bf16_f32 v62, v84, v85
v_cvt_pk_bf16_f32 v63, v86, v87
buffer_store_dwordx4 v[60:63], v0, s[4:7], s64 offen offset:1024 sc1
s_waitcnt lgkmcnt(6)
v_mfma_f32_32x32x16_bf16 v[40:55], v[32:35], a[24:27], v[40:55]
ds_read_b128 v[28:31], v5 offset:13312
s_add_u32 m0, s54, 8192
s_add_u32 s55, s53, 8192
buffer_load_dwordx4 v0, s[4:7], s55 offen sc1 lds
s_waitcnt lgkmcnt(6)
v_mfma_f32_32x32x16_bf16 v[40:55], v[36:39], a[28:31], v[40:55]
ds_read_b128 v[32:35], v5 offset:14336
s_waitcnt lgkmcnt(6)
v_mfma_f32_32x32x16_bf16 v[40:55], v[8:11], a[32:35], v[40:55]
ds_read_b128 v[36:39], v5 offset:15360
s_add_u32 m0, s54, 12288
s_add_u32 s55, s53, 12288
buffer_load_dwordx4 v0, s[4:7], s55 offen sc1 lds
s_waitcnt lgkmcnt(6)
v_mfma_f32_32x32x16_bf16 v[40:55], v[12:15], a[36:39], v[40:55]
ds_read_b128 v[8:11], v5 offset:16384
s_waitcnt lgkmcnt(6)
v_mfma_f32_32x32x16_bf16 v[40:55], v[16:19], a[40:43], v[40:55]
ds_read_b128 v[12:15], v5 offset:17408
s_add_u32 m0, s54, 16384
s_add_u32 s55, s53, 16384
buffer_load_dwordx4 v0, s[4:7], s55 offen sc1 lds
s_waitcnt lgkmcnt(6)
v_mfma_f32_32x32x16_bf16 v[40:55], v[20:23], a[44:47], v[40:55]
ds_read_b128 v[16:19], v5 offset:18432
s_waitcnt lgkmcnt(6)
v_mfma_f32_32x32x16_bf16 v[40:55], v[24:27], a[48:51], v[40:55]
ds_read_b128 v[20:23], v5 offset:19456
s_add_u32 m0, s54, 20480
s_add_u32 s55, s53, 20480
buffer_load_dwordx4 v0, s[4:7], s55 offen sc1 lds
s_waitcnt lgkmcnt(6)
v_mfma_f32_32x32x16_bf16 v[40:55], v[28:31], a[52:55], v[40:55]
ds_read_b128 v[24:27], v5 offset:20480
s_waitcnt lgkmcnt(6)
v_mfma_f32_32x32x16_bf16 v[40:55], v[32:35], a[56:59], v[40:55]
ds_read_b128 v[28:31], v5 offset:21504
s_add_u32 m0, s54, 24576
s_add_u32 s55, s53, 24576
buffer_load_dwordx4 v0, s[4:7], s55 offen sc1 lds
s_waitcnt lgkmcnt(6)
v_mfma_f32_32x32x16_bf16 v[40:55], v[36:39], a[60:63], v[40:55]
ds_read_b128 v[32:35], v5 offset:22528
s_waitcnt lgkmcnt(6)
v_mfma_f32_32x32x16_bf16 v[40:55], v[8:11], a[64:67], v[40:55]
ds_read_b128 v[36:39], v5 offset:23552
s_add_u32 m0, s54, 28672
s_add_u32 s55, s53, 28672
buffer_load_dwordx4 v0, s[4:7], s55 offen sc1 lds
s_waitcnt lgkmcnt(6)
v_mfma_f32_32x32x16_bf16 v[40:55], v[12:15], a[68:71], v[40:55]
ds_read_b128 v[8:11], v5 offset:24576
s_waitcnt lgkmcnt(6)
v_mfma_f32_32x32x16_bf16 v[40:55], v[16:19], a[72:75], v[40:55]
ds_read_b128 v[12:15], v5 offset:25600
s_add_u32 m0, s54, 32768
s_add_u32 s55, s53, 32768
buffer_load_dwordx4 v0, s[4:7], s55 offen sc1 lds
s_waitcnt lgkmcnt(6)
v_mfma_f32_32x32x16_bf16 v[40:55], v[20:23], a[76:79], v[40:55]
ds_read_b128 v[16:19], v5 offset:26624
s_waitcnt lgkmcnt(6)
v_mfma_f32_32x32x16_bf16 v[40:55], v[24:27], a[80:83], v[40:55]
ds_read_b128 v[20:23], v5 offset:27648
s_add_u32 m0, s54, 36864
s_add_u32 s55, s53, 36864
buffer_load_dwordx4 v0, s[4:7], s55 offen sc1 lds
s_waitcnt lgkmcnt(6)
v_mfma_f32_32x32x16_bf16 v[40:55], v[28:31], a[84:87], v[40:55]
ds_read_b128 v[24:27], v5 offset:28672
s_waitcnt lgkmcnt(6)
v_mfma_f32_32x32x16_bf16 v[40:55], v[32:35], a[88:91], v[40:55]
ds_read_b128 v[28:31], v5 offset:29696
s_add_u32 m0, s54, 40960
s_add_u32 s55, s53, 40960
buffer_load_dwordx4 v0, s[4:7], s55 offen sc1 lds
s_waitcnt lgkmcnt(6)
v_mfma_f32_32x32x16_bf16 v[40:55], v[36:39], a[92:95], v[40:55]
ds_read_b128 v[32:35], v5 offset:30720
s_waitcnt vmcnt(13) lgkmcnt(2)
s_barrier
s_waitcnt lgkmcnt(6)
v_mfma_f32_32x32x16_bf16 v[40:55], v[8:11], a[96:99], v[40:55]
ds_read_b128 v[36:39], v5 offset:31744
s_add_u32 m0, s54, 45056
s_add_u32 s55, s53, 45056
buffer_load_dwordx4 v0, s[4:7], s55 offen sc1 lds
s_waitcnt lgkmcnt(6)
v_mfma_f32_32x32x16_bf16 v[40:55], v[12:15], a[100:103], v[40:55]
ds_read_b128 v[8:11], v5 offset:32768
s_waitcnt lgkmcnt(6)
v_mfma_f32_32x32x16_bf16 v[40:55], v[16:19], a[104:107], v[40:55]
ds_read_b128 v[12:15], v5 offset:33792
s_add_u32 m0, s54, 49152
s_add_u32 s55, s53, 49152
buffer_load_dwordx4 v0, s[4:7], s55 offen sc1 lds
s_waitcnt lgkmcnt(6)
v_mfma_f32_32x32x16_bf16 v[40:55], v[20:23], a[108:111], v[40:55]
ds_read_b128 v[16:19], v5 offset:34816
s_waitcnt lgkmcnt(6)
v_mfma_f32_32x32x16_bf16 v[40:55], v[24:27], a[112:115], v[40:55]
ds_read_b128 v[20:23], v5 offset:35840
s_add_u32 m0, s54, 53248
s_add_u32 s55, s53, 53248
buffer_load_dwordx4 v0, s[4:7], s55 offen sc1 lds
s_waitcnt lgkmcnt(6)
v_mfma_f32_32x32x16_bf16 v[40:55], v[28:31], a[116:119], v[40:55]
ds_read_b128 v[24:27], v5 offset:36864
s_waitcnt lgkmcnt(6)
v_mfma_f32_32x32x16_bf16 v[40:55], v[32:35], a[120:123], v[40:55]
ds_read_b128 v[28:31], v5 offset:37888
s_add_u32 m0, s54, 57344
s_add_u32 s55, s53, 57344
buffer_load_dwordx4 v0, s[4:7], s55 offen sc1 lds
s_waitcnt lgkmcnt(6)
v_mfma_f32_32x32x16_bf16 v[40:55], v[36:39], a[124:127], v[40:55]
ds_read_b128 v[32:35], v5 offset:38912
s_waitcnt lgkmcnt(6)
v_mfma_f32_32x32x16_bf16 v[40:55], v[8:11], a[128:131], v[40:55]
ds_read_b128 v[36:39], v5 offset:39936
s_add_u32 m0, s54, 61440
s_add_u32 s55, s53, 61440
buffer_load_dwordx4 v0, s[4:7], s55 offen sc1 lds
s_waitcnt lgkmcnt(6)
v_mfma_f32_32x32x16_bf16 v[40:55], v[12:15], a[132:135], v[40:55]
ds_read_b128 v[8:11], v5 offset:40960
s_waitcnt vmcnt(14)
s_barrier
s_waitcnt lgkmcnt(6)
v_mfma_f32_32x32x16_bf16 v[40:55], v[16:19], a[136:139], v[40:55]
ds_read_b128 v[12:15], v5 offset:41984
s_cmp_lg_u32 s42, 0
s_cbranch_scc1 Lgv_w_156
s_mov_b64 exec, 1
buffer_store_dword v4, v3, s[4:7], s59 offen sc1
s_mov_b64 exec, -1
Lgv_w_156:
s_waitcnt lgkmcnt(6)
v_mfma_f32_32x32x16_bf16 v[40:55], v[20:23], a[140:143], v[40:55]
ds_read_b128 v[16:19], v5 offset:43008
s_waitcnt lgkmcnt(6)
v_mfma_f32_32x32x16_bf16 v[40:55], v[24:27], a[144:147], v[40:55]
ds_read_b128 v[20:23], v5 offset:44032
s_waitcnt lgkmcnt(6)
v_mfma_f32_32x32x16_bf16 v[40:55], v[28:31], a[148:151], v[40:55]
ds_read_b128 v[24:27], v5 offset:45056
s_waitcnt lgkmcnt(6)
v_mfma_f32_32x32x16_bf16 v[40:55], v[32:35], a[152:155], v[40:55]
ds_read_b128 v[28:31], v5 offset:46080
s_waitcnt lgkmcnt(6)
v_mfma_f32_32x32x16_bf16 v[40:55], v[36:39], a[156:159], v[40:55]
ds_read_b128 v[32:35], v5 offset:47104
s_waitcnt lgkmcnt(6)
v_mfma_f32_32x32x16_bf16 v[40:55], v[8:11], a[160:163], v[40:55]
ds_read_b128 v[36:39], v5 offset:48128
s_waitcnt lgkmcnt(6)
v_mfma_f32_32x32x16_bf16 v[40:55], v[12:15], a[164:167], v[40:55]
ds_read_b128 v[8:11], v5 offset:49152
s_waitcnt lgkmcnt(6)
v_mfma_f32_32x32x16_bf16 v[40:55], v[16:19], a[168:171], v[40:55]
ds_read_b128 v[12:15], v5 offset:50176
s_waitcnt lgkmcnt(6)
v_mfma_f32_32x32x16_bf16 v[40:55], v[20:23], a[172:175], v[40:55]
ds_read_b128 v[16:19], v5 offset:51200
s_waitcnt lgkmcnt(6)
v_mfma_f32_32x32x16_bf16 v[40:55], v[24:27], a[176:179], v[40:55]
ds_read_b128 v[20:23], v5 offset:52224
s_waitcnt lgkmcnt(6)
v_mfma_f32_32x32x16_bf16 v[40:55], v[28:31], a[180:183], v[40:55]
ds_read_b128 v[24:27], v5 offset:53248
s_waitcnt lgkmcnt(6)
v_mfma_f32_32x32x16_bf16 v[40:55], v[32:35], a[184:187], v[40:55]
ds_read_b128 v[28:31], v5 offset:54272
s_waitcnt lgkmcnt(6)
v_mfma_f32_32x32x16_bf16 v[40:55], v[36:39], a[188:191], v[40:55]
ds_read_b128 v[32:35], v5 offset:55296
s_waitcnt lgkmcnt(6)
v_mfma_f32_32x32x16_bf16 v[40:55], v[8:11], a[192:195], v[40:55]
ds_read_b128 v[36:39], v5 offset:56320
s_waitcnt lgkmcnt(6)
v_mfma_f32_32x32x16_bf16 v[40:55], v[12:15], a[196:199], v[40:55]
ds_read_b128 v[8:11], v5 offset:57344
s_waitcnt lgkmcnt(6)
v_mfma_f32_32x32x16_bf16 v[40:55], v[16:19], a[200:203], v[40:55]
ds_read_b128 v[12:15], v5 offset:58368
s_waitcnt lgkmcnt(6)
v_mfma_f32_32x32x16_bf16 v[40:55], v[20:23], a[204:207], v[40:55]
ds_read_b128 v[16:19], v5 offset:59392
s_waitcnt lgkmcnt(6)
v_mfma_f32_32x32x16_bf16 v[40:55], v[24:27], a[208:211], v[40:55]
ds_read_b128 v[20:23], v5 offset:60416
s_waitcnt lgkmcnt(6)
v_mfma_f32_32x32x16_bf16 v[40:55], v[28:31], a[212:215], v[40:55]
ds_read_b128 v[24:27], v5 offset:61440
s_waitcnt lgkmcnt(6)
v_mfma_f32_32x32x16_bf16 v[40:55], v[32:35], a[216:219], v[40:55]
ds_read_b128 v[28:31], v5 offset:62464
s_waitcnt lgkmcnt(6)
v_mfma_f32_32x32x16_bf16 v[40:55], v[36:39], a[220:223], v[40:55]
ds_read_b128 v[32:35], v5 offset:63488
s_waitcnt lgkmcnt(6)
v_mfma_f32_32x32x16_bf16 v[40:55], v[8:11], a[224:227], v[40:55]
ds_read_b128 v[36:39], v5 offset:64512
s_waitcnt lgkmcnt(6)
v_mfma_f32_32x32x16_bf16 v[40:55], v[12:15], a[228:231], v[40:55]
s_waitcnt lgkmcnt(5)
v_mfma_f32_32x32x16_bf16 v[40:55], v[16:19], a[232:235], v[40:55]
s_waitcnt lgkmcnt(4)
v_mfma_f32_32x32x16_bf16 v[40:55], v[20:23], a[236:239], v[40:55]
s_waitcnt lgkmcnt(3)
v_mfma_f32_32x32x16_bf16 v[40:55], v[24:27], a[240:243], v[40:55]
s_waitcnt lgkmcnt(2)
v_mfma_f32_32x32x16_bf16 v[40:55], v[28:31], a[244:247], v[40:55]
s_waitcnt lgkmcnt(1)
v_mfma_f32_32x32x16_bf16 v[40:55], v[32:35], a[248:251], v[40:55]
s_waitcnt lgkmcnt(0)
v_mfma_f32_32x32x16_bf16 v[40:55], v[36:39], a[252:255], v[40:55]
s_mov_b32 s64, s57
s_add_u32 s50, s46, 1
s_add_u32 s57, s57, s58
v_mov_b32 v4, s50
s_add_u32 s46, s46, s48
s_sub_u32 s47, s47, 1
s_waitcnt vmcnt(8)
s_branch Lgv_top1
Lgv_nop0:
s_waitcnt lgkmcnt(6)
v_mfma_f32_32x32x16_bf16 v[40:55], v[16:19], a[8:11], v[40:55]
ds_read_b128 v[12:15], v5 offset:9216
v_cvt_pk_bf16_f32 v56, v72, v73
v_cvt_pk_bf16_f32 v57, v74, v75
v_cvt_pk_bf16_f32 v58, v80, v81
v_cvt_pk_bf16_f32 v59, v82, v83
s_waitcnt lgkmcnt(6)
v_mfma_f32_32x32x16_bf16 v[40:55], v[20:23], a[12:15], v[40:55]
ds_read_b128 v[16:19], v5 offset:10240
buffer_store_dwordx4 v[56:59], v0, s[4:7], s64 offen offset:0 sc1
v_cvt_pk_bf16_f32 v60, v76, v77
v_cvt_pk_bf16_f32 v61, v78, v79
v_cvt_pk_bf16_f32 v62, v84, v85
s_waitcnt lgkmcnt(6)
v_mfma_f32_32x32x16_bf16 v[40:55], v[24:27], a[16:19], v[40:55]
ds_read_b128 v[20:23], v5 offset:11264
v_cvt_pk_bf16_f32 v63, v86, v87
buffer_store_dwordx4 v[60:63], v0, s[4:7], s64 offen offset:1024 sc1
s_waitcnt lgkmcnt(6)
v_mfma_f32_32x32x16_bf16 v[40:55], v[28:31], a[20:23], v[40:55]
ds_read_b128 v[24:27], v5 offset:12288
s_waitcnt lgkmcnt(6)
v_mfma_f32_32x32x16_bf16 v[40:55], v[32:35], a[24:27], v[40:55]
ds_read_b128 v[28:31], v5 offset:13312
s_waitcnt lgkmcnt(6)
v_mfma_f32_32x32x16_bf16 v[40:55], v[36:39], a[28:31], v[40:55]
ds_read_b128 v[32:35], v5 offset:14336
s_waitcnt lgkmcnt(6)
v_mfma_f32_32x32x16_bf16 v[40:55], v[8:11], a[32:35], v[40:55]
ds_read_b128 v[36:39], v5 offset:15360
s_waitcnt lgkmcnt(6)
v_mfma_f32_32x32x16_bf16 v[40:55], v[12:15], a[36:39], v[40:55]
ds_read_b128 v[8:11], v5 offset:16384
s_waitcnt lgkmcnt(6)
v_mfma_f32_32x32x16_bf16 v[40:55], v[16:19], a[40:43], v[40:55]
ds_read_b128 v[12:15], v5 offset:17408
s_waitcnt lgkmcnt(6)
v_mfma_f32_32x32x16_bf16 v[40:55], v[20:23], a[44:47], v[40:55]
ds_read_b128 v[16:19], v5 offset:18432
s_waitcnt lgkmcnt(6)
v_mfma_f32_32x32x16_bf16 v[40:55], v[24:27], a[48:51], v[40:55]
ds_read_b128 v[20:23], v5 offset:19456
s_waitcnt lgkmcnt(6)
v_mfma_f32_32x32x16_bf16 v[40:55], v[28:31], a[52:55], v[40:55]
ds_read_b128 v[24:27], v5 offset:20480
s_waitcnt lgkmcnt(6)
v_mfma_f32_32x32x16_bf16 v[40:55], v[32:35], a[56:59], v[40:55]
ds_read_b128 v[28:31], v5 offset:21504
s_waitcnt lgkmcnt(6)
v_mfma_f32_32x32x16_bf16 v[40:55], v[36:39], a[60:63], v[40:55]
ds_read_b128 v[32:35], v5 offset:22528
s_waitcnt lgkmcnt(6)
v_mfma_f32_32x32x16_bf16 v[40:55], v[8:11], a[64:67], v[40:55]
ds_read_b128 v[36:39], v5 offset:23552
s_waitcnt lgkmcnt(6)
v_mfma_f32_32x32x16_bf16 v[40:55], v[12:15], a[68:71], v[40:55]
ds_read_b128 v[8:11], v5 offset:24576
s_waitcnt lgkmcnt(6)
v_mfma_f32_32x32x16_bf16 v[40:55], v[16:19], a[72:75], v[40:55]
ds_read_b128 v[12:15], v5 offset:25600
s_waitcnt lgkmcnt(6)
v_mfma_f32_32x32x16_bf16 v[40:55], v[20:23], a[76:79], v[40:55]
ds_read_b128 v[16:19], v5 offset:26624
s_waitcnt lgkmcnt(6)
v_mfma_f32_32x32x16_bf16 v[40:55], v[24:27], a[80:83], v[40:55]
ds_read_b128 v[20:23], v5 offset:27648
s_waitcnt lgkmcnt(6)
v_mfma_f32_32x32x16_bf16 v[40:55], v[28:31], a[84:87], v[40:55]
ds_read_b128 v[24:27], v5 offset:28672
s_waitcnt lgkmcnt(6)
v_mfma_f32_32x32x16_bf16 v[40:55], v[32:35], a[88:91], v[40:55]
ds_read_b128 v[28:31], v5 offset:29696
s_waitcnt lgkmcnt(6)
v_mfma_f32_32x32x16_bf16 v[40:55], v[36:39], a[92:95], v[40:55]
ds_read_b128 v[32:35], v5 offset:30720
s_waitcnt vmcnt(2) lgkmcnt(2)
s_barrier
s_waitcnt lgkmcnt(6)
v_mfma_f32_32x32x16_bf16 v[40:55], v[8:11], a[96:99], v[40:55]
ds_read_b128 v[36:39], v5 offset:31744
s_waitcnt lgkmcnt(6)
v_mfma_f32_32x32x16_bf16 v[40:55], v[12:15], a[100:103], v[40:55]
ds_read_b128 v[8:11], v5 offset:32768
s_waitcnt lgkmcnt(6)
v_mfma_f32_32x32x16_bf16 v[40:55], v[16:19], a[104:107], v[40:55]
ds_read_b128 v[12:15], v5 offset:33792
s_waitcnt lgkmcnt(6)
v_mfma_f32_32x32x16_bf16 v[40:55], v[20:23], a[108:111], v[40:55]
ds_read_b128 v[16:19], v5 offset:34816
s_waitcnt lgkmcnt(6)
v_mfma_f32_32x32x16_bf16 v[40:55], v[24:27], a[112:115], v[40:55]
ds_read_b128 v[20:23], v5 offset:35840
s_waitcnt lgkmcnt(6)
v_mfma_f32_32x32x16_bf16 v[40:55], v[28:31], a[116:119], v[40:55]
ds_read_b128 v[24:27], v5 offset:36864
s_waitcnt lgkmcnt(6)
v_mfma_f32_32x32x16_bf16 v[40:55], v[32:35], a[120:123], v[40:55]
ds_read_b128 v[28:31], v5 offset:37888
s_waitcnt lgkmcnt(6)
v_mfma_f32_32x32x16_bf16 v[40:55], v[36:39], a[124:127], v[40:55]
ds_read_b128 v[32:35], v5 offset:38912
s_waitcnt lgkmcnt(6)
v_mfma_f32_32x32x16_bf16 v[40:55], v[8:11], a[128:131], v[40:55]
ds_read_b128 v[36:39], v5 offset:39936
s_waitcnt lgkmcnt(6)
v_mfma_f32_32x32x16_bf16 v[40:55], v[12:15], a[132:135], v[40:55]
ds_read_b128 v[8:11], v5 offset:40960
s_waitcnt vmcnt(0)
s_barrier
s_waitcnt lgkmcnt(6)
v_mfma_f32_32x32x16_bf16 v[40:55], v[16:19], a[136:139], v[40:55]
ds_read_b128 v[12:15], v5 offset:41984
s_cmp_lg_u32 s42, 0
s_cbranch_scc1 Lgv_w_157
s_mov_b64 exec, 1
buffer_store_dword v4, v3, s[4:7], s59 offen sc1
s_mov_b64 exec, -1
Lgv_w_157:
s_waitcnt lgkmcnt(6)
v_mfma_f32_32x32x16_bf16 v[40:55], v[20:23], a[140:143], v[40:55]
ds_read_b128 v[16:19], v5 offset:43008
s_waitcnt lgkmcnt(6)
v_mfma_f32_32x32x16_bf16 v[40:55], v[24:27], a[144:147], v[40:55]
ds_read_b128 v[20:23], v5 offset:44032
s_waitcnt lgkmcnt(6)
v_mfma_f32_32x32x16_bf16 v[40:55], v[28:31], a[148:151], v[40:55]
ds_read_b128 v[24:27], v5 offset:45056
s_waitcnt lgkmcnt(6)
v_mfma_f32_32x32x16_bf16 v[40:55], v[32:35], a[152:155], v[40:55]
ds_read_b128 v[28:31], v5 offset:46080
s_waitcnt lgkmcnt(6)
v_mfma_f32_32x32x16_bf16 v[40:55], v[36:39], a[156:159], v[40:55]
ds_read_b128 v[32:35], v5 offset:47104
s_waitcnt lgkmcnt(6)
v_mfma_f32_32x32x16_bf16 v[40:55], v[8:11], a[160:163], v[40:55]
ds_read_b128 v[36:39], v5 offset:48128
s_waitcnt lgkmcnt(6)
v_mfma_f32_32x32x16_bf16 v[40:55], v[12:15], a[164:167], v[40:55]
ds_read_b128 v[8:11], v5 offset:49152
s_waitcnt lgkmcnt(6)
v_mfma_f32_32x32x16_bf16 v[40:55], v[16:19], a[168:171], v[40:55]
ds_read_b128 v[12:15], v5 offset:50176
s_waitcnt lgkmcnt(6)
v_mfma_f32_32x32x16_bf16 v[40:55], v[20:23], a[172:175], v[40:55]
ds_read_b128 v[16:19], v5 offset:51200
s_waitcnt lgkmcnt(6)
v_mfma_f32_32x32x16_bf16 v[40:55], v[24:27], a[176:179], v[40:55]
ds_read_b128 v[20:23], v5 offset:52224
s_waitcnt lgkmcnt(6)
v_mfma_f32_32x32x16_bf16 v[40:55], v[28:31], a[180:183], v[40:55]
ds_read_b128 v[24:27], v5 offset:53248
s_waitcnt lgkmcnt(6)
v_mfma_f32_32x32x16_bf16 v[40:55], v[32:35], a[184:187], v[40:55]
ds_read_b128 v[28:31], v5 offset:54272
s_waitcnt lgkmcnt(6)
v_mfma_f32_32x32x16_bf16 v[40:55], v[36:39], a[188:191], v[40:55]
ds_read_b128 v[32:35], v5 offset:55296
s_waitcnt lgkmcnt(6)
v_mfma_f32_32x32x16_bf16 v[40:55], v[8:11], a[192:195], v[40:55]
ds_read_b128 v[36:39], v5 offset:56320
s_waitcnt lgkmcnt(6)
v_mfma_f32_32x32x16_bf16 v[40:55], v[12:15], a[196:199], v[40:55]
ds_read_b128 v[8:11], v5 offset:57344
s_waitcnt lgkmcnt(6)
v_mfma_f32_32x32x16_bf16 v[40:55], v[16:19], a[200:203], v[40:55]
ds_read_b128 v[12:15], v5 offset:58368
s_waitcnt lgkmcnt(6)
v_mfma_f32_32x32x16_bf16 v[40:55], v[20:23], a[204:207], v[40:55]
ds_read_b128 v[16:19], v5 offset:59392
s_waitcnt lgkmcnt(6)
v_mfma_f32_32x32x16_bf16 v[40:55], v[24:27], a[208:211], v[40:55]
ds_read_b128 v[20:23], v5 offset:60416
s_waitcnt lgkmcnt(6)
v_mfma_f32_32x32x16_bf16 v[40:55], v[28:31], a[212:215], v[40:55]
ds_read_b128 v[24:27], v5 offset:61440
s_waitcnt lgkmcnt(6)
v_mfma_f32_32x32x16_bf16 v[40:55], v[32:35], a[216:219], v[40:55]
ds_read_b128 v[28:31], v5 offset:62464
s_waitcnt lgkmcnt(6)
v_mfma_f32_32x32x16_bf16 v[40:55], v[36:39], a[220:223], v[40:55]
ds_read_b128 v[32:35], v5 offset:63488
s_waitcnt lgkmcnt(6)
v_mfma_f32_32x32x16_bf16 v[40:55], v[8:11], a[224:227], v[40:55]
ds_read_b128 v[36:39], v5 offset:64512
s_waitcnt lgkmcnt(6)
v_mfma_f32_32x32x16_bf16 v[40:55], v[12:15], a[228:231], v[40:55]
s_waitcnt lgkmcnt(5)
v_mfma_f32_32x32x16_bf16 v[40:55], v[16:19], a[232:235], v[40:55]
s_waitcnt lgkmcnt(4)
v_mfma_f32_32x32x16_bf16 v[40:55], v[20:23], a[236:239], v[40:55]
s_waitcnt lgkmcnt(3)
v_mfma_f32_32x32x16_bf16 v[40:55], v[24:27], a[240:243], v[40:55]
s_waitcnt lgkmcnt(2)
v_mfma_f32_32x32x16_bf16 v[40:55], v[28:31], a[244:247], v[40:55]
s_waitcnt lgkmcnt(1)
v_mfma_f32_32x32x16_bf16 v[40:55], v[32:35], a[248:251], v[40:55]
s_waitcnt lgkmcnt(0)
v_mfma_f32_32x32x16_bf16 v[40:55], v[36:39], a[252:255], v[40:55]
s_mov_b32 s64, s57
s_add_u32 s50, s46, 1
s_add_u32 s57, s57, s58
v_mov_b32 v4, s50
s_nop 7
v_cvt_pk_bf16_f32 v56, v40, v41
v_cvt_pk_bf16_f32 v57, v42, v43
v_cvt_pk_bf16_f32 v58, v48, v49
v_cvt_pk_bf16_f32 v59, v50, v51
buffer_store_dwordx4 v[56:59], v0, s[4:7], s64 offen offset:0 sc1
v_cvt_pk_bf16_f32 v60, v44, v45
v_cvt_pk_bf16_f32 v61, v46, v47
v_cvt_pk_bf16_f32 v62, v52, v53
v_cvt_pk_bf16_f32 v63, v54, v55
buffer_store_dwordx4 v[60:63], v0, s[4:7], s64 offen offset:1024 sc1
s_waitcnt vmcnt(0)
s_barrier
s_cmp_lg_u32 s42, 0
s_cbranch_scc1 Lgv_w_158
s_mov_b64 exec, 1
buffer_store_dword v4, v3, s[4:7], s59 offen sc1
s_mov_b64 exec, -1
Lgv_w_158:
s_branch Lphase2
Lgv_top1:
s_xor_b32 s65, s65, 0x10000
s_add_u32 s49, s49, s56
v_add_u32 v5, s65, v0
s_barrier
ds_read_b128 v[8:11], v5 offset:0
ds_read_b128 v[12:15], v5 offset:1024
ds_read_b128 v[16:19], v5 offset:2048
s_lshl_b32 s53, s42, 10
s_xor_b32 s54, s65, 0x10000
s_add_u32 s54, s54, s53
s_add_u32 s53, s53, s49
s_waitcnt lgkmcnt(2)
v_mfma_f32_32x32x16_bf16 v[72:87], v[8:11], a[0:3], 0
ds_read_b128 v[20:23], v5 offset:3072
ds_read_b128 v[24:27], v5 offset:4096
ds_read_b128 v[28:31], v5 offset:5120
ds_read_b128 v[32:35], v5 offset:6144
s_waitcnt lgkmcnt(5)
v_mfma_f32_32x32x16_bf16 v[72:87], v[12:15], a[4:7], v[72:87]
ds_read_b128 v[36:39], v5 offset:7168
ds_read_b128 v[8:11], v5 offset:8192
s_cmp_le_u32 s47, 1
s_cbranch_scc1 Lgv_nop1
s_waitcnt lgkmcnt(6)
v_mfma_f32_32x32x16_bf16 v[72:87], v[16:19], a[8:11], v[72:87]
ds_read_b128 v[12:15], v5 offset:9216
s_add_u32 m0, s54, 0
s_add_u32 s55, s53, 0
buffer_load_dwordx4 v0, s[4:7], s55 offen sc1 lds
v_cvt_pk_bf16_f32 v56, v40, v41
s_waitcnt lgkmcnt(6)
v_mfma_f32_32x32x16_bf16 v[72:87], v[20:23], a[12:15], v[72:87]
ds_read_b128 v[16:19], v5 offset:10240
v_cvt_pk_bf16_f32 v57, v42, v43
v_cvt_pk_bf16_f32 v58, v48, v49
v_cvt_pk_bf16_f32 v59, v50, v51
buffer_store_dwordx4 v[56:59], v0, s[4:7], s64 offen offset:0 sc1
s_waitcnt lgkmcnt(6)
v_mfma_f32_32x32x16_bf16 v[72:87], v[24:27], a[16:19], v[72:87]
ds_read_b128 v[20:23], v5 offset:11264
s_add_u32 m0, s54, 4096
s_add_u32 s55, s53, 4096
buffer_load_dwordx4 v0, s[4:7], s55 offen sc1 lds
v_cvt_pk_bf16_f32 v60, v44, v45
s_waitcnt lgkmcnt(6)
v_mfma_f32_32x32x16_bf16 v[72:87], v[28:31], a[20:23], v[72:87]
ds_read_b128 v[24:27], v5 offset:12288
v_cvt_pk_bf16_f32 v61, v46, v47
v_cvt_pk_bf16_f32 v62, v52, v53
v_cvt_pk_bf16_f32 v63, v54, v55
buffer_store_dwordx4 v[60:63], v0, s[4:7], s64 offen offset:1024 sc1
s_waitcnt lgkmcnt(6)
v_mfma_f32_32x32x16_bf16 v[72:87], v[32:35], a[24:27], v[72:87]
ds_read_b128 v[28:31], v5 offset:13312
s_add_u32 m0, s54, 8192
s_add_u32 s55, s53, 8192
buffer_load_dwordx4 v0, s[4:7], s55 offen sc1 lds
s_waitcnt lgkmcnt(6)
v_mfma_f32_32x32x16_bf16 v[72:87], v[36:39], a[28:31], v[72:87]
ds_read_b128 v[32:35], v5 offset:14336
s_waitcnt lgkmcnt(6)
v_mfma_f32_32x32x16_bf16 v[72:87], v[8:11], a[32:35], v[72:87]
ds_read_b128 v[36:39], v5 offset:15360
s_add_u32 m0, s54, 12288
s_add_u32 s55, s53, 12288
buffer_load_dwordx4 v0, s[4:7], s55 offen sc1 lds
s_waitcnt lgkmcnt(6)
v_mfma_f32_32x32x16_bf16 v[72:87], v[12:15], a[36:39], v[72:87]
ds_read_b128 v[8:11], v5 offset:16384
s_waitcnt lgkmcnt(6)
v_mfma_f32_32x32x16_bf16 v[72:87], v[16:19], a[40:43], v[72:87]
ds_read_b128 v[12:15], v5 offset:17408
s_add_u32 m0, s54, 16384
s_add_u32 s55, s53, 16384
buffer_load_dwordx4 v0, s[4:7], s55 offen sc1 lds
s_waitcnt lgkmcnt(6)
v_mfma_f32_32x32x16_bf16 v[72:87], v[20:23], a[44:47], v[72:87]
ds_read_b128 v[16:19], v5 offset:18432
s_waitcnt lgkmcnt(6)
v_mfma_f32_32x32x16_bf16 v[72:87], v[24:27], a[48:51], v[72:87]
ds_read_b128 v[20:23], v5 offset:19456
s_add_u32 m0, s54, 20480
s_add_u32 s55, s53, 20480
buffer_load_dwordx4 v0, s[4:7], s55 offen sc1 lds
s_waitcnt lgkmcnt(6)
v_mfma_f32_32x32x16_bf16 v[72:87], v[28:31], a[52:55], v[72:87]
ds_read_b128 v[24:27], v5 offset:20480
s_waitcnt lgkmcnt(6)
v_mfma_f32_32x32x16_bf16 v[72:87], v[32:35], a[56:59], v[72:87]
ds_read_b128 v[28:31], v5 offset:21504
s_add_u32 m0, s54, 24576
s_add_u32 s55, s53, 24576
buffer_load_dwordx4 v0, s[4:7], s55 offen sc1 lds
s_waitcnt lgkmcnt(6)
v_mfma_f32_32x32x16_bf16 v[72:87], v[36:39], a[60:63], v[72:87]
ds_read_b128 v[32:35], v5 offset:22528
s_waitcnt lgkmcnt(6)
v_mfma_f32_32x32x16_bf16 v[72:87], v[8:11], a[64:67], v[72:87]
ds_read_b128 v[36:39], v5 offset:23552
s_add_u32 m0, s54, 28672
s_add_u32 s55, s53, 28672
buffer_load_dwordx4 v0, s[4:7], s55 offen sc1 lds
s_waitcnt lgkmcnt(6)
v_mfma_f32_32x32x16_bf16 v[72:87], v[12:15], a[68:71], v[72:87]
ds_read_b128 v[8:11], v5 offset:24576
s_waitcnt lgkmcnt(6)
v_mfma_f32_32x32x16_bf16 v[72:87], v[16:19], a[72:75], v[72:87]
ds_read_b128 v[12:15], v5 offset:25600
s_add_u32 m0, s54, 32768
s_add_u32 s55, s53, 32768
buffer_load_dwordx4 v0, s[4:7], s55 offen sc1 lds
s_waitcnt lgkmcnt(6)
v_mfma_f32_32x32x16_bf16 v[72:87], v[20:23], a[76:79], v[72:87]
ds_read_b128 v[16:19], v5 offset:26624
s_waitcnt lgkmcnt(6)
v_mfma_f32_32x32x16_bf16 v[72:87], v[24:27], a[80:83], v[72:87]
ds_read_b128 v[20:23], v5 offset:27648
s_add_u32 m0, s54, 36864
s_add_u32 s55, s53, 36864
buffer_load_dwordx4 v0, s[4:7], s55 offen sc1 lds
s_waitcnt lgkmcnt(6)
v_mfma_f32_32x32x16_bf16 v[72:87], v[28:31], a[84:87], v[72:87]
ds_read_b128 v[24:27], v5 offset:28672
s_waitcnt lgkmcnt(6)
v_mfma_f32_32x32x16_bf16 v[72:87], v[32:35], a[88:91], v[72:87]
ds_read_b128 v[28:31], v5 offset:29696
s_add_u32 m0, s54, 40960
s_add_u32 s55, s53, 40960
buffer_load_dwordx4 v0, s[4:7], s55 offen sc1 lds
s_waitcnt lgkmcnt(6)
v_mfma_f32_32x32x16_bf16 v[72:87], v[36:39], a[92:95], v[72:87]
ds_read_b128 v[32:35], v5 offset:30720
s_waitcnt vmcnt(13) lgkmcnt(2)
s_barrier
s_waitcnt lgkmcnt(6)
v_mfma_f32_32x32x16_bf16 v[72:87], v[8:11], a[96:99], v[72:87]
ds_read_b128 v[36:39], v5 offset:31744
s_add_u32 m0, s54, 45056
s_add_u32 s55, s53, 45056
buffer_load_dwordx4 v0, s[4:7], s55 offen sc1 lds
s_waitcnt lgkmcnt(6)
v_mfma_f32_32x32x16_bf16 v[72:87], v[12:15], a[100:103], v[72:87]
ds_read_b128 v[8:11], v5 offset:32768
s_waitcnt lgkmcnt(6)
v_mfma_f32_32x32x16_bf16 v[72:87], v[16:19], a[104:107], v[72:87]
ds_read_b128 v[12:15], v5 offset:33792
s_add_u32 m0, s54, 49152
s_add_u32 s55, s53, 49152
buffer_load_dwordx4 v0, s[4:7], s55 offen sc1 lds
s_waitcnt lgkmcnt(6)
v_mfma_f32_32x32x16_bf16 v[72:87], v[20:23], a[108:111], v[72:87]
ds_read_b128 v[16:19], v5 offset:34816
s_waitcnt lgkmcnt(6)
v_mfma_f32_32x32x16_bf16 v[72:87], v[24:27], a[112:115], v[72:87]
ds_read_b128 v[20:23], v5 offset:35840
s_add_u32 m0, s54, 53248
s_add_u32 s55, s53, 53248
buffer_load_dwordx4 v0, s[4:7], s55 offen sc1 lds
s_waitcnt lgkmcnt(6)
v_mfma_f32_32x32x16_bf16 v[72:87], v[28:31], a[116:119], v[72:87]
ds_read_b128 v[24:27], v5 offset:36864
s_waitcnt lgkmcnt(6)
v_mfma_f32_32x32x16_bf16 v[72:87], v[32:35], a[120:123], v[72:87]
ds_read_b128 v[28:31], v5 offset:37888
s_add_u32 m0, s54, 57344
s_add_u32 s55, s53, 57344
buffer_load_dwordx4 v0, s[4:7], s55 offen sc1 lds
s_waitcnt lgkmcnt(6)
v_mfma_f32_32x32x16_bf16 v[72:87], v[36:39], a[124:127], v[72:87]
ds_read_b128 v[32:35], v5 offset:38912
s_waitcnt lgkmcnt(6)
v_mfma_f32_32x32x16_bf16 v[72:87], v[8:11], a[128:131], v[72:87]
ds_read_b128 v[36:39], v5 offset:39936
s_add_u32 m0, s54, 61440
s_add_u32 s55, s53, 61440
buffer_load_dwordx4 v0, s[4:7], s55 offen sc1 lds
s_waitcnt lgkmcnt(6)
v_mfma_f32_32x32x16_bf16 v[72:87], v[12:15], a[132:135], v[72:87]
ds_read_b128 v[8:11], v5 offset:40960
s_waitcnt vmcnt(14)
s_barrier
s_waitcnt lgkmcnt(6)
v_mfma_f32_32x32x16_bf16 v[72:87], v[16:19], a[136:139], v[72:87]
ds_read_b128 v[12:15], v5 offset:41984
s_cmp_lg_u32 s42, 0
s_cbranch_scc1 Lgv_w_159
s_mov_b64 exec, 1
buffer_store_dword v4, v3, s[4:7], s59 offen sc1
s_mov_b64 exec, -1
Lgv_w_159:
s_waitcnt lgkmcnt(6)
v_mfma_f32_32x32x16_bf16 v[72:87], v[20:23], a[140:143], v[72:87]
ds_read_b128 v[16:19], v5 offset:43008
s_waitcnt lgkmcnt(6)
v_mfma_f32_32x32x16_bf16 v[72:87], v[24:27], a[144:147], v[72:87]
ds_read_b128 v[20:23], v5 offset:44032
s_waitcnt lgkmcnt(6)
v_mfma_f32_32x32x16_bf16 v[72:87], v[28:31], a[148:151], v[72:87]
ds_read_b128 v[24:27], v5 offset:45056
s_waitcnt lgkmcnt(6)
v_mfma_f32_32x32x16_bf16 v[72:87], v[32:35], a[152:155], v[72:87]
ds_read_b128 v[28:31], v5 offset:46080
s_waitcnt lgkmcnt(6)
v_mfma_f32_32x32x16_bf16 v[72:87], v[36:39], a[156:159], v[72:87]
ds_read_b128 v[32:35], v5 offset:47104
s_waitcnt lgkmcnt(6)
v_mfma_f32_32x32x16_bf16 v[72:87], v[8:11], a[160:163], v[72:87]
ds_read_b128 v[36:39], v5 offset:48128
s_waitcnt lgkmcnt(6)
v_mfma_f32_32x32x16_bf16 v[72:87], v[12:15], a[164:167], v[72:87]
ds_read_b128 v[8:11], v5 offset:49152
s_waitcnt lgkmcnt(6)
v_mfma_f32_32x32x16_bf16 v[72:87], v[16:19], a[168:171], v[72:87]
ds_read_b128 v[12:15], v5 offset:50176
s_waitcnt lgkmcnt(6)
v_mfma_f32_32x32x16_bf16 v[72:87], v[20:23], a[172:175], v[72:87]
ds_read_b128 v[16:19], v5 offset:51200
s_waitcnt lgkmcnt(6)
v_mfma_f32_32x32x16_bf16 v[72:87], v[24:27], a[176:179], v[72:87]
ds_read_b128 v[20:23], v5 offset:52224
s_waitcnt lgkmcnt(6)
v_mfma_f32_32x32x16_bf16 v[72:87], v[28:31], a[180:183], v[72:87]
ds_read_b128 v[24:27], v5 offset:53248
s_waitcnt lgkmcnt(6)
v_mfma_f32_32x32x16_bf16 v[72:87], v[32:35], a[184:187], v[72:87]
ds_read_b128 v[28:31], v5 offset:54272
s_waitcnt lgkmcnt(6)
v_mfma_f32_32x32x16_bf16 v[72:87], v[36:39], a[188:191], v[72:87]
ds_read_b128 v[32:35], v5 offset:55296
s_waitcnt lgkmcnt(6)
v_mfma_f32_32x32x16_bf16 v[72:87], v[8:11], a[192:195], v[72:87]
ds_read_b128 v[36:39], v5 offset:56320
s_waitcnt lgkmcnt(6)
v_mfma_f32_32x32x16_bf16 v[72:87], v[12:15], a[196:199], v[72:87]
ds_read_b128 v[8:11], v5 offset:57344
s_waitcnt lgkmcnt(6)
v_mfma_f32_32x32x16_bf16 v[72:87], v[16:19], a[200:203], v[72:87]
ds_read_b128 v[12:15], v5 offset:58368
s_waitcnt lgkmcnt(6)
v_mfma_f32_32x32x16_bf16 v[72:87], v[20:23], a[204:207], v[72:87]
ds_read_b128 v[16:19], v5 offset:59392
s_waitcnt lgkmcnt(6)
v_mfma_f32_32x32x16_bf16 v[72:87], v[24:27], a[208:211], v[72:87]
ds_read_b128 v[20:23], v5 offset:60416
s_waitcnt lgkmcnt(6)
v_mfma_f32_32x32x16_bf16 v[72:87], v[28:31], a[212:215], v[72:87]
ds_read_b128 v[24:27], v5 offset:61440
s_waitcnt lgkmcnt(6)
v_mfma_f32_32x32x16_bf16 v[72:87], v[32:35], a[216:219], v[72:87]
ds_read_b128 v[28:31], v5 offset:62464
s_waitcnt lgkmcnt(6)
v_mfma_f32_32x32x16_bf16 v[72:87], v[36:39], a[220:223], v[72:87]
ds_read_b128 v[32:35], v5 offset:63488
s_waitcnt lgkmcnt(6)
v_mfma_f32_32x32x16_bf16 v[72:87], v[8:11], a[224:227], v[72:87]
ds_read_b128 v[36:39], v5 offset:64512
s_waitcnt lgkmcnt(6)
v_mfma_f32_32x32x16_bf16 v[72:87], v[12:15], a[228:231], v[72:87]
s_waitcnt lgkmcnt(5)
v_mfma_f32_32x32x16_bf16 v[72:87], v[16:19], a[232:235], v[72:87]
s_waitcnt lgkmcnt(4)
v_mfma_f32_32x32x16_bf16 v[72:87], v[20:23], a[236:239], v[72:87]
s_waitcnt lgkmcnt(3)
v_mfma_f32_32x32x16_bf16 v[72:87], v[24:27], a[240:243], v[72:87]
s_waitcnt lgkmcnt(2)
v_mfma_f32_32x32x16_bf16 v[72:87], v[28:31], a[244:247], v[72:87]
s_waitcnt lgkmcnt(1)
v_mfma_f32_32x32x16_bf16 v[72:87], v[32:35], a[248:251], v[72:87]
s_waitcnt lgkmcnt(0)
v_mfma_f32_32x32x16_bf16 v[72:87], v[36:39], a[252:255], v[72:87]
s_mov_b32 s64, s57
s_add_u32 s50, s46, 1
s_add_u32 s57, s57, s58
v_mov_b32 v4, s50
s_add_u32 s46, s46, s48
s_sub_u32 s47, s47, 1
s_waitcnt vmcnt(8)
s_branch Lgv_top0
Lgv_nop1:
s_waitcnt lgkmcnt(6)
v_mfma_f32_32x32x16_bf16 v[72:87], v[16:19], a[8:11], v[72:87]
ds_read_b128 v[12:15], v5 offset:9216
v_cvt_pk_bf16_f32 v56, v40, v41
v_cvt_pk_bf16_f32 v57, v42, v43
v_cvt_pk_bf16_f32 v58, v48, v49
v_cvt_pk_bf16_f32 v59, v50, v51
s_waitcnt lgkmcnt(6)
v_mfma_f32_32x32x16_bf16 v[72:87], v[20:23], a[12:15], v[72:87]
ds_read_b128 v[16:19], v5 offset:10240
buffer_store_dwordx4 v[56:59], v0, s[4:7], s64 offen offset:0 sc1
v_cvt_pk_bf16_f32 v60, v44, v45
v_cvt_pk_bf16_f32 v61, v46, v47
v_cvt_pk_bf16_f32 v62, v52, v53
s_waitcnt lgkmcnt(6)
v_mfma_f32_32x32x16_bf16 v[72:87], v[24:27], a[16:19], v[72:87]
ds_read_b128 v[20:23], v5 offset:11264
v_cvt_pk_bf16_f32 v63, v54, v55
buffer_store_dwordx4 v[60:63], v0, s[4:7], s64 offen offset:1024 sc1
s_waitcnt lgkmcnt(6)
v_mfma_f32_32x32x16_bf16 v[72:87], v[28:31], a[20:23], v[72:87]
ds_read_b128 v[24:27], v5 offset:12288
s_waitcnt lgkmcnt(6)
v_mfma_f32_32x32x16_bf16 v[72:87], v[32:35], a[24:27], v[72:87]
ds_read_b128 v[28:31], v5 offset:13312
s_waitcnt lgkmcnt(6)
v_mfma_f32_32x32x16_bf16 v[72:87], v[36:39], a[28:31], v[72:87]
ds_read_b128 v[32:35], v5 offset:14336
s_waitcnt lgkmcnt(6)
v_mfma_f32_32x32x16_bf16 v[72:87], v[8:11], a[32:35], v[72:87]
ds_read_b128 v[36:39], v5 offset:15360
s_waitcnt lgkmcnt(6)
v_mfma_f32_32x32x16_bf16 v[72:87], v[12:15], a[36:39], v[72:87]
ds_read_b128 v[8:11], v5 offset:16384
s_waitcnt lgkmcnt(6)
v_mfma_f32_32x32x16_bf16 v[72:87], v[16:19], a[40:43], v[72:87]
ds_read_b128 v[12:15], v5 offset:17408
s_waitcnt lgkmcnt(6)
v_mfma_f32_32x32x16_bf16 v[72:87], v[20:23], a[44:47], v[72:87]
ds_read_b128 v[16:19], v5 offset:18432
s_waitcnt lgkmcnt(6)
v_mfma_f32_32x32x16_bf16 v[72:87], v[24:27], a[48:51], v[72:87]
ds_read_b128 v[20:23], v5 offset:19456
s_waitcnt lgkmcnt(6)
v_mfma_f32_32x32x16_bf16 v[72:87], v[28:31], a[52:55], v[72:87]
ds_read_b128 v[24:27], v5 offset:20480
s_waitcnt lgkmcnt(6)
v_mfma_f32_32x32x16_bf16 v[72:87], v[32:35], a[56:59], v[72:87]
ds_read_b128 v[28:31], v5 offset:21504
s_waitcnt lgkmcnt(6)
v_mfma_f32_32x32x16_bf16 v[72:87], v[36:39], a[60:63], v[72:87]
ds_read_b128 v[32:35], v5 offset:22528
s_waitcnt lgkmcnt(6)
v_mfma_f32_32x32x16_bf16 v[72:87], v[8:11], a[64:67], v[72:87]
ds_read_b128 v[36:39], v5 offset:23552
s_waitcnt lgkmcnt(6)
v_mfma_f32_32x32x16_bf16 v[72:87], v[12:15], a[68:71], v[72:87]
ds_read_b128 v[8:11], v5 offset:24576
s_waitcnt lgkmcnt(6)
v_mfma_f32_32x32x16_bf16 v[72:87], v[16:19], a[72:75], v[72:87]
ds_read_b128 v[12:15], v5 offset:25600
s_waitcnt lgkmcnt(6)
v_mfma_f32_32x32x16_bf16 v[72:87], v[20:23], a[76:79], v[72:87]
ds_read_b128 v[16:19], v5 offset:26624
s_waitcnt lgkmcnt(6)
v_mfma_f32_32x32x16_bf16 v[72:87], v[24:27], a[80:83], v[72:87]
ds_read_b128 v[20:23], v5 offset:27648
s_waitcnt lgkmcnt(6)
v_mfma_f32_32x32x16_bf16 v[72:87], v[28:31], a[84:87], v[72:87]
ds_read_b128 v[24:27], v5 offset:28672
s_waitcnt lgkmcnt(6)
v_mfma_f32_32x32x16_bf16 v[72:87], v[32:35], a[88:91], v[72:87]
ds_read_b128 v[28:31], v5 offset:29696
s_waitcnt lgkmcnt(6)
v_mfma_f32_32x32x16_bf16 v[72:87], v[36:39], a[92:95], v[72:87]
ds_read_b128 v[32:35], v5 offset:30720
s_waitcnt vmcnt(2) lgkmcnt(2)
s_barrier
s_waitcnt lgkmcnt(6)
v_mfma_f32_32x32x16_bf16 v[72:87], v[8:11], a[96:99], v[72:87]
ds_read_b128 v[36:39], v5 offset:31744
s_waitcnt lgkmcnt(6)
v_mfma_f32_32x32x16_bf16 v[72:87], v[12:15], a[100:103], v[72:87]
ds_read_b128 v[8:11], v5 offset:32768
s_waitcnt lgkmcnt(6)
v_mfma_f32_32x32x16_bf16 v[72:87], v[16:19], a[104:107], v[72:87]
ds_read_b128 v[12:15], v5 offset:33792
s_waitcnt lgkmcnt(6)
v_mfma_f32_32x32x16_bf16 v[72:87], v[20:23], a[108:111], v[72:87]
ds_read_b128 v[16:19], v5 offset:34816
s_waitcnt lgkmcnt(6)
v_mfma_f32_32x32x16_bf16 v[72:87], v[24:27], a[112:115], v[72:87]
ds_read_b128 v[20:23], v5 offset:35840
s_waitcnt lgkmcnt(6)
v_mfma_f32_32x32x16_bf16 v[72:87], v[28:31], a[116:119], v[72:87]
ds_read_b128 v[24:27], v5 offset:36864
s_waitcnt lgkmcnt(6)
v_mfma_f32_32x32x16_bf16 v[72:87], v[32:35], a[120:123], v[72:87]
ds_read_b128 v[28:31], v5 offset:37888
s_waitcnt lgkmcnt(6)
v_mfma_f32_32x32x16_bf16 v[72:87], v[36:39], a[124:127], v[72:87]
ds_read_b128 v[32:35], v5 offset:38912
s_waitcnt lgkmcnt(6)
v_mfma_f32_32x32x16_bf16 v[72:87], v[8:11], a[128:131], v[72:87]
ds_read_b128 v[36:39], v5 offset:39936
s_waitcnt lgkmcnt(6)
v_mfma_f32_32x32x16_bf16 v[72:87], v[12:15], a[132:135], v[72:87]
ds_read_b128 v[8:11], v5 offset:40960
s_waitcnt vmcnt(0)
s_barrier
s_waitcnt lgkmcnt(6)
v_mfma_f32_32x32x16_bf16 v[72:87], v[16:19], a[136:139], v[72:87]
ds_read_b128 v[12:15], v5 offset:41984
s_cmp_lg_u32 s42, 0
s_cbranch_scc1 Lgv_w_160
s_mov_b64 exec, 1
buffer_store_dword v4, v3, s[4:7], s59 offen sc1
s_mov_b64 exec, -1
Lgv_w_160:
s_waitcnt lgkmcnt(6)
v_mfma_f32_32x32x16_bf16 v[72:87], v[20:23], a[140:143], v[72:87]
ds_read_b128 v[16:19], v5 offset:43008
s_waitcnt lgkmcnt(6)
v_mfma_f32_32x32x16_bf16 v[72:87], v[24:27], a[144:147], v[72:87]
ds_read_b128 v[20:23], v5 offset:44032
s_waitcnt lgkmcnt(6)
v_mfma_f32_32x32x16_bf16 v[72:87], v[28:31], a[148:151], v[72:87]
ds_read_b128 v[24:27], v5 offset:45056
s_waitcnt lgkmcnt(6)
v_mfma_f32_32x32x16_bf16 v[72:87], v[32:35], a[152:155], v[72:87]
ds_read_b128 v[28:31], v5 offset:46080
s_waitcnt lgkmcnt(6)
v_mfma_f32_32x32x16_bf16 v[72:87], v[36:39], a[156:159], v[72:87]
ds_read_b128 v[32:35], v5 offset:47104
s_waitcnt lgkmcnt(6)
v_mfma_f32_32x32x16_bf16 v[72:87], v[8:11], a[160:163], v[72:87]
ds_read_b128 v[36:39], v5 offset:48128
s_waitcnt lgkmcnt(6)
v_mfma_f32_32x32x16_bf16 v[72:87], v[12:15], a[164:167], v[72:87]
ds_read_b128 v[8:11], v5 offset:49152
s_waitcnt lgkmcnt(6)
v_mfma_f32_32x32x16_bf16 v[72:87], v[16:19], a[168:171], v[72:87]
ds_read_b128 v[12:15], v5 offset:50176
s_waitcnt lgkmcnt(6)
v_mfma_f32_32x32x16_bf16 v[72:87], v[20:23], a[172:175], v[72:87]
ds_read_b128 v[16:19], v5 offset:51200
s_waitcnt lgkmcnt(6)
v_mfma_f32_32x32x16_bf16 v[72:87], v[24:27], a[176:179], v[72:87]
ds_read_b128 v[20:23], v5 offset:52224
s_waitcnt lgkmcnt(6)
v_mfma_f32_32x32x16_bf16 v[72:87], v[28:31], a[180:183], v[72:87]
ds_read_b128 v[24:27], v5 offset:53248
s_waitcnt lgkmcnt(6)
v_mfma_f32_32x32x16_bf16 v[72:87], v[32:35], a[184:187], v[72:87]
ds_read_b128 v[28:31], v5 offset:54272
s_waitcnt lgkmcnt(6)
v_mfma_f32_32x32x16_bf16 v[72:87], v[36:39], a[188:191], v[72:87]
ds_read_b128 v[32:35], v5 offset:55296
s_waitcnt lgkmcnt(6)
v_mfma_f32_32x32x16_bf16 v[72:87], v[8:11], a[192:195], v[72:87]
ds_read_b128 v[36:39], v5 offset:56320
s_waitcnt lgkmcnt(6)
v_mfma_f32_32x32x16_bf16 v[72:87], v[12:15], a[196:199], v[72:87]
ds_read_b128 v[8:11], v5 offset:57344
s_waitcnt lgkmcnt(6)
v_mfma_f32_32x32x16_bf16 v[72:87], v[16:19], a[200:203], v[72:87]
ds_read_b128 v[12:15], v5 offset:58368
s_waitcnt lgkmcnt(6)
v_mfma_f32_32x32x16_bf16 v[72:87], v[20:23], a[204:207], v[72:87]
ds_read_b128 v[16:19], v5 offset:59392
s_waitcnt lgkmcnt(6)
v_mfma_f32_32x32x16_bf16 v[72:87], v[24:27], a[208:211], v[72:87]
ds_read_b128 v[20:23], v5 offset:60416
s_waitcnt lgkmcnt(6)
v_mfma_f32_32x32x16_bf16 v[72:87], v[28:31], a[212:215], v[72:87]
ds_read_b128 v[24:27], v5 offset:61440
s_waitcnt lgkmcnt(6)
v_mfma_f32_32x32x16_bf16 v[72:87], v[32:35], a[216:219], v[72:87]
ds_read_b128 v[28:31], v5 offset:62464
s_waitcnt lgkmcnt(6)
v_mfma_f32_32x32x16_bf16 v[72:87], v[36:39], a[220:223], v[72:87]
ds_read_b128 v[32:35], v5 offset:63488
s_waitcnt lgkmcnt(6)
v_mfma_f32_32x32x16_bf16 v[72:87], v[8:11], a[224:227], v[72:87]
ds_read_b128 v[36:39], v5 offset:64512
s_waitcnt lgkmcnt(6)
v_mfma_f32_32x32x16_bf16 v[72:87], v[12:15], a[228:231], v[72:87]
s_waitcnt lgkmcnt(5)
v_mfma_f32_32x32x16_bf16 v[72:87], v[16:19], a[232:235], v[72:87]
s_waitcnt lgkmcnt(4)
v_mfma_f32_32x32x16_bf16 v[72:87], v[20:23], a[236:239], v[72:87]
s_waitcnt lgkmcnt(3)
v_mfma_f32_32x32x16_bf16 v[72:87], v[24:27], a[240:243], v[72:87]
s_waitcnt lgkmcnt(2)
v_mfma_f32_32x32x16_bf16 v[72:87], v[28:31], a[244:247], v[72:87]
s_waitcnt lgkmcnt(1)
v_mfma_f32_32x32x16_bf16 v[72:87], v[32:35], a[248:251], v[72:87]
s_waitcnt lgkmcnt(0)
v_mfma_f32_32x32x16_bf16 v[72:87], v[36:39], a[252:255], v[72:87]
s_mov_b32 s64, s57
s_add_u32 s50, s46, 1
s_add_u32 s57, s57, s58
v_mov_b32 v4, s50
s_nop 7
v_cvt_pk_bf16_f32 v56, v72, v73
v_cvt_pk_bf16_f32 v57, v74, v75
v_cvt_pk_bf16_f32 v58, v80, v81
v_cvt_pk_bf16_f32 v59, v82, v83
buffer_store_dwordx4 v[56:59], v0, s[4:7], s64 offen offset:0 sc1
v_cvt_pk_bf16_f32 v60, v76, v77
v_cvt_pk_bf16_f32 v61, v78, v79
v_cvt_pk_bf16_f32 v62, v84, v85
v_cvt_pk_bf16_f32 v63, v86, v87
buffer_store_dwordx4 v[60:63], v0, s[4:7], s64 offen offset:1024 sc1
s_waitcnt vmcnt(0)
s_barrier
s_cmp_lg_u32 s42, 0
s_cbranch_scc1 Lgv_w_161
s_mov_b64 exec, 1
buffer_store_dword v4, v3, s[4:7], s59 offen sc1
s_mov_b64 exec, -1
Lgv_w_161:
s_branch Lphase2
Lkdone:
s_cmp_lg_u32 s79, 0
s_cbranch_scc1 Lp3
Lphase2:
s_mov_b32 s79, 1
s_lshr_b32 s50, s45, 5
s_and_b32 s51, s45, 31
s_min_u32 s52, s50, 2
s_cmp_lt_u32 s50, 2
s_cselect_b32 s53, 26, 25
s_cmp_lt_u32 s51, s53
s_cbranch_scc1 Lp2gemm
s_mul_i32 s50, s50, 7
s_add_u32 s50, s50, s51
s_sub_u32 s50, s50, s52
s_sub_u32 s50, s50, s53
s_mul_i32 s45, s50, 52
s_lshr_b32 s45, s45, 8
s_mul_i32 s51, s45, 5
s_sub_u32 s51, s50, s51
s_cmp_eq_u32 s51, 3
s_cbranch_scc1 Lred1
s_cmp_eq_u32 s51, 4
s_cbranch_scc1 Lred2
s_mul_i32 s45, s45, 3
s_add_u32 s45, s45, s51
s_branch Latt
Lp2gemm:
s_mul_i32 s50, s50, 25
s_add_u32 s45, s50, s51
s_add_u32 s45, s45, s52
s_mov_b32 s46, 0
s_mov_b32 s48, 1
s_mov_b32 s47, 64
v_lshrrev_b32 v56, 4, v0
s_lshl_b32 s57, s42, 10
s_cmp_ge_u32 s45, 120
s_cbranch_scc1 Lp2q
s_cmp_ge_u32 s45, 88
s_cbranch_scc1 Lp2down
s_cmp_ge_u32 s45, 32
s_cbranch_scc1 Lp2up
s_lshr_b32 s50, s45, 3
s_and_b32 s51, s45, 7
s_mov_b32 s74, s26
s_mov_b32 s75, s27
s_mov_b32 s14, 8388480
s_lshl_b32 s67, s50, 21
s_lshl_b32 s49, s50, 16
s_add_u32 s49, s49, 62914560
s_mov_b32 s56, 0x40000
s_add_u32 s57, s57, 79691776
s_lshl_b32 s59, s45, 7
s_add_u32 s59, s59, 65536
s_lshl_b32 s60, s50, 10
s_add_u32 s60, s60, 16384
s_mov_b32 s61, 0x4000
s_mov_b32 s78, 3
v_and_b32 v1, 7, v56
s_mov_b32 s68, 0
s_branch Lp2common
Lp2down:
s_sub_u32 s45, s45, 88
s_mov_b32 s47, 63
Lp2down2:
s_lshr_b32 s50, s45, 3
s_and_b32 s51, s45, 7
s_mov_b32 s74, s32
s_mov_b32 s75, s33
s_mov_b32 s14, 7339904
s_mul_i32 s67, s50, 1835008
s_mul_i32 s49, s50, 57344
s_add_u32 s49, s49, 104857600
s_mov_b32 s56, 229376
s_add_u32 s57, s57, 138412032
s_lshl_b32 s59, s45, 7
s_add_u32 s59, s59, 98304
s_mul_i32 s60, s50, 1792
s_add_u32 s60, s60, 81920
s_mov_b32 s61, 0
s_mov_b32 s78, 1
v_and_b32 v1, 15, v56
v_min_u32 v1, 13, v1
s_mov_b32 s68, 2
Lp2common:
s_lshl_b32 s52, s51, 8
s_add_u32 s67, s67, s52
s_lshl_b32 s50, s50, 16
s_lshl_b32 s51, s51, 13
s_add_u32 s57, s57, s50
s_add_u32 s57, s57, s51
s_mov_b32 s58, 0x40000
s_add_u32 s76, s74, 128
s_addc_u32 s77, s75, 0
s_mov_b32 s66, 2048
s_branch Lp2load
Lp2up:
s_sub_u32 s45, s45, 32
s_mov_b32 s47, 63
Lp2up2:
s_mov_b32 s74, s28
s_mov_b32 s75, s29
s_mov_b32 s76, s30
s_mov_b32 s77, s31
s_mov_b32 s14, 7340032
s_mov_b32 s66, 7168
s_lshl_b32 s67, s45, 7
s_mov_b32 s49, 100663296
s_mov_b32 s56, 0x10000
s_lshl_b32 s50, s45, 12
s_add_u32 s57, s57, s50
s_add_u32 s57, s57, 104857600
s_mov_b32 s58, 229376
s_lshl_b32 s59, s45, 7
s_add_u32 s59, s59, 81920
s_mov_b32 s60, 69632
s_mov_b32 s61, 512
s_mov_b32 s78, 2
v_and_b32 v1, 3, v56
s_mov_b32 s68, 1
Lp2load:
v_lshlrev_b32 v1, 7, v1
s_add_u32 s59, s59, s99
s_add_u32 s60, s60, s99
s_cmp_lg_u32 s79, 2
s_cbranch_scc1 Lp2load2
s_add_u32 s49, s49, 14450688
s_add_u32 s57, s57, 16515072
s_add_u32 s59, s59, 4096
s_add_u32 s60, s60, 32768
v_mov_b32 v4, 63
s_mov_b64 exec, 1
buffer_store_dword v4, v3, s[4:7], s59 offen sc1
s_mov_b64 exec, -1
Lp2load2:
s_cmp_lg_u32 s79, 3
s_cbranch_scc1 Lp2load3
s_add_u32 s49, s49, 4128768
s_add_u32 s57, s57, 14450688
s_add_u32 s59, s59, 32768
s_add_u32 s60, s60, 1024
v_lshrrev_b32 v56, 4, v0
s_and_b32 s50, s42, 1
s_cmp_eq_u32 s50, 0
s_cselect_b32 s12, s74, s76
s_cselect_b32 s13, s75, s77
s_mov_b32 s15, 0x20000
s_lshl_b32 s50, s50, 1
v_bfe_u32 v57, v56, 4, 1
v_or_b32 v57, s50, v57
v_lshlrev_b32 v57, 1, v57
v_and_b32 v58, 7, v56
v_xor_b32 v57, v57, v58
v_lshrrev_b32 v58, 3, v56
v_mul_lo_u32 v58, v58, s66
v_lshl_add_u32 v59, v57, 4, v58
v_bfe_u32 v57, v56, 4, 1
v_bfe_u32 v58, v56, 3, 1
v_lshl_add_u32 v58, v57, 1, v58
v_xor_b32 v58, s42, v58
v_lshlrev_b32 v58, 5, v58
v_lshl_add_u32 v58, v57, 15, v58
v_and_b32 v57, 3, v56
v_lshl_add_u32 v58, v57, 3, v58
v_bfe_u32 v57, v56, 2, 2
v_lshl_add_u32 v58, v57, 7, v58
v_lshrrev_b32 v57, 5, v56
v_lshl_add_u32 v60, v57, 9, v58
v_add_u32 v61, 0x10000, v60
s_lshl_b32 s51, s66, 3
s_lshr_b32 s50, s42, 1
s_lshl_b32 s52, s50, 4
s_mul_i32 s52, s52, s51
s_add_u32 s52, s52, s67
s_lshl_b32 s50, s50, 14
s_and_b32 s53, s42, 1
s_lshl_b32 s53, s53, 15
s_add_u32 s53, s53, s50
s_lshl_b32 s55, s51, 4
s_add_u32 m0, s53, 0
s_nop 0
buffer_load_dwordx4 v59, s[12:15], s52 offen lds
s_add_u32 m0, s53, 1024
s_add_u32 s52, s52, s51
buffer_load_dwordx4 v59, s[12:15], s52 offen lds
s_add_u32 m0, s53, 2048
s_add_u32 s52, s52, s51
buffer_load_dwordx4 v59, s[12:15], s52 offen lds
s_add_u32 m0, s53, 3072
s_add_u32 s52, s52, s51
buffer_load_dwordx4 v59, s[12:15], s52 offen lds
s_add_u32 m0, s53, 4096
s_add_u32 s52, s52, s51
buffer_load_dwordx4 v59, s[12:15], s52 offen lds
s_add_u32 m0, s53, 5120
s_add_u32 s52, s52, s51
buffer_load_dwordx4 v59, s[12:15], s52 offen lds
s_add_u32 m0, s53, 6144
s_add_u32 s52, s52, s51
buffer_load_dwordx4 v59, s[12:15], s52 offen lds
s_add_u32 m0, s53, 7168
s_add_u32 s52, s52, s51
buffer_load_dwordx4 v59, s[12:15], s52 offen lds
s_add_u32 m0, s53, 8192
s_add_u32 s52, s52, s51
buffer_load_dwordx4 v59, s[12:15], s52 offen lds
s_add_u32 m0, s53, 9216
s_add_u32 s52, s52, s51
buffer_load_dwordx4 v59, s[12:15], s52 offen lds
s_add_u32 m0, s53, 10240
s_add_u32 s52, s52, s51
buffer_load_dwordx4 v59, s[12:15], s52 offen lds
s_add_u32 m0, s53, 11264
s_add_u32 s52, s52, s51
buffer_load_dwordx4 v59, s[12:15], s52 offen lds
s_add_u32 m0, s53, 12288
s_add_u32 s52, s52, s51
buffer_load_dwordx4 v59, s[12:15], s52 offen lds
s_add_u32 m0, s53, 13312
s_add_u32 s52, s52, s51
buffer_load_dwordx4 v59, s[12:15], s52 offen lds
s_add_u32 m0, s53, 14336
s_add_u32 s52, s52, s51
buffer_load_dwordx4 v59, s[12:15], s52 offen lds
s_add_u32 m0, s53, 15360
s_add_u32 s52, s52, s51
buffer_load_dwordx4 v59, s[12:15], s52 offen lds
s_add_u32 m0, s53, 65536
s_add_u32 s52, s52, s51
s_add_u32 s52, s52, s55
buffer_load_dwordx4 v59, s[12:15], s52 offen lds
s_add_u32 m0, s53, 66560
s_add_u32 s52, s52, s51
buffer_load_dwordx4 v59, s[12:15], s52 offen lds
s_add_u32 m0, s53, 67584
s_add_u32 s52, s52, s51
buffer_load_dwordx4 v59, s[12:15], s52 offen lds
s_add_u32 m0, s53, 68608
s_add_u32 s52, s52, s51
buffer_load_dwordx4 v59, s[12:15], s52 offen lds
s_add_u32 m0, s53, 69632
s_add_u32 s52, s52, s51
buffer_load_dwordx4 v59, s[12:15], s52 offen lds
s_add_u32 m0, s53, 70656
s_add_u32 s52, s52, s51
buffer_load_dwordx4 v59, s[12:15], s52 offen lds
s_add_u32 m0, s53, 71680
s_add_u32 s52, s52, s51
buffer_load_dwordx4 v59, s[12:15], s52 offen lds
s_add_u32 m0, s53, 72704
s_add_u32 s52, s52, s51
buffer_load_dwordx4 v59, s[12:15], s52 offen lds
s_add_u32 m0, s53, 73728
s_add_u32 s52, s52, s51
buffer_load_dwordx4 v59, s[12:15], s52 offen lds
s_add_u32 m0, s53, 74752
s_add_u32 s52, s52, s51
buffer_load_dwordx4 v59, s[12:15], s52 offen lds
s_add_u32 m0, s53, 75776
s_add_u32 s52, s52, s51
buffer_load_dwordx4 v59, s[12:15], s52 offen lds
s_add_u32 m0, s53, 76800
s_add_u32 s52, s52, s51
buffer_load_dwordx4 v59, s[12:15], s52 offen lds
s_add_u32 m0, s53, 77824
s_add_u32 s52, s52, s51
buffer_load_dwordx4 v59, s[12:15], s52 offen lds
s_add_u32 m0, s53, 78848
s_add_u32 s52, s52, s51
buffer_load_dwordx4 v59, s[12:15], s52 offen lds
s_add_u32 m0, s53, 79872
s_add_u32 s52, s52, s51
buffer_load_dwordx4 v59, s[12:15], s52 offen lds
s_add_u32 m0, s53, 80896
s_add_u32 s52, s52, s51
buffer_load_dwordx4 v59, s[12:15], s52 offen lds
s_waitcnt vmcnt(16)
s_barrier
ds_read_b64_tr_b16 a[0:1], v60 offset:0
ds_read_b64_tr_b16 a[2:3], v60 offset:1024
ds_read_b64_tr_b16 a[4:5], v60 offset:2048
ds_read_b64_tr_b16 a[6:7], v60 offset:3072
ds_read_b64_tr_b16 a[8:9], v60 offset:4096
ds_read_b64_tr_b16 a[10:11], v60 offset:5120
ds_read_b64_tr_b16 a[12:13], v60 offset:6144
ds_read_b64_tr_b16 a[14:15], v60 offset:7168
ds_read_b64_tr_b16 a[16:17], v60 offset:8192
ds_read_b64_tr_b16 a[18:19], v60 offset:9216
ds_read_b64_tr_b16 a[20:21], v60 offset:10240
ds_read_b64_tr_b16 a[22:23], v60 offset:11264
ds_read_b64_tr_b16 a[24:25], v60 offset:12288
ds_read_b64_tr_b16 a[26:27], v60 offset:13312
ds_read_b64_tr_b16 a[28:29], v60 offset:14336
ds_read_b64_tr_b16 a[30:31], v60 offset:15360
ds_read_b64_tr_b16 a[32:33], v60 offset:16384
ds_read_b64_tr_b16 a[34:35], v60 offset:17408
ds_read_b64_tr_b16 a[36:37], v60 offset:18432
ds_read_b64_tr_b16 a[38:39], v60 offset:19456
ds_read_b64_tr_b16 a[40:41], v60 offset:20480
ds_read_b64_tr_b16 a[42:43], v60 offset:21504
ds_read_b64_tr_b16 a[44:45], v60 offset:22528
ds_read_b64_tr_b16 a[46:47], v60 offset:23552
ds_read_b64_tr_b16 a[48:49], v60 offset:24576
ds_read_b64_tr_b16 a[50:51], v60 offset:25600
ds_read_b64_tr_b16 a[52:53], v60 offset:26624
ds_read_b64_tr_b16 a[54:55], v60 offset:27648
ds_read_b64_tr_b16 a[56:57], v60 offset:28672
ds_read_b64_tr_b16 a[58:59], v60 offset:29696
ds_read_b64_tr_b16 a[60:61], v60 offset:30720
ds_read_b64_tr_b16 a[62:63], v60 offset:31744
s_waitcnt lgkmcnt(0)
s_barrier
s_add_u32 m0, s53, 0
s_add_u32 s52, s52, s51
s_add_u32 s52, s52, s55
buffer_load_dwordx4 v59, s[12:15], s52 offen lds
s_add_u32 m0, s53, 1024
s_add_u32 s52, s52, s51
buffer_load_dwordx4 v59, s[12:15], s52 offen lds
s_add_u32 m0, s53, 2048
s_add_u32 s52, s52, s51
buffer_load_dwordx4 v59, s[12:15], s52 offen lds
s_add_u32 m0, s53, 3072
s_add_u32 s52, s52, s51
buffer_load_dwordx4 v59, s[12:15], s52 offen lds
s_add_u32 m0, s53, 4096
s_add_u32 s52, s52, s51
buffer_load_dwordx4 v59, s[12:15], s52 offen lds
s_add_u32 m0, s53, 5120
s_add_u32 s52, s52, s51
buffer_load_dwordx4 v59, s[12:15], s52 offen lds
s_add_u32 m0, s53, 6144
s_add_u32 s52, s52, s51
buffer_load_dwordx4 v59, s[12:15], s52 offen lds
s_add_u32 m0, s53, 7168
s_add_u32 s52, s52, s51
buffer_load_dwordx4 v59, s[12:15], s52 offen lds
s_add_u32 m0, s53, 8192
s_add_u32 s52, s52, s51
buffer_load_dwordx4 v59, s[12:15], s52 offen lds
s_add_u32 m0, s53, 9216
s_add_u32 s52, s52, s51
buffer_load_dwordx4 v59, s[12:15], s52 offen lds
s_add_u32 m0, s53, 10240
s_add_u32 s52, s52, s51
buffer_load_dwordx4 v59, s[12:15], s52 offen lds
s_add_u32 m0, s53, 11264
s_add_u32 s52, s52, s51
buffer_load_dwordx4 v59, s[12:15], s52 offen lds
s_add_u32 m0, s53, 12288
s_add_u32 s52, s52, s51
buffer_load_dwordx4 v59, s[12:15], s52 offen lds
s_add_u32 m0, s53, 13312
s_add_u32 s52, s52, s51
buffer_load_dwordx4 v59, s[12:15], s52 offen lds
s_add_u32 m0, s53, 14336
s_add_u32 s52, s52, s51
buffer_load_dwordx4 v59, s[12:15], s52 offen lds
s_add_u32 m0, s53, 15360
s_add_u32 s52, s52, s51
buffer_load_dwordx4 v59, s[12:15], s52 offen lds
s_waitcnt vmcnt(16)
s_barrier
ds_read_b64_tr_b16 a[64:65], v61 offset:0
ds_read_b64_tr_b16 a[66:67], v61 offset:1024
ds_read_b64_tr_b16 a[68:69], v61 offset:2048
ds_read_b64_tr_b16 a[70:71], v61 offset:3072
ds_read_b64_tr_b16 a[72:73], v61 offset:4096
ds_read_b64_tr_b16 a[74:75], v61 offset:5120
ds_read_b64_tr_b16 a[76:77], v61 offset:6144
ds_read_b64_tr_b16 a[78:79], v61 offset:7168
ds_read_b64_tr_b16 a[80:81], v61 offset:8192
ds_read_b64_tr_b16 a[82:83], v61 offset:9216
ds_read_b64_tr_b16 a[84:85], v61 offset:10240
ds_read_b64_tr_b16 a[86:87], v61 offset:11264
ds_read_b64_tr_b16 a[88:89], v61 offset:12288
ds_read_b64_tr_b16 a[90:91], v61 offset:13312
ds_read_b64_tr_b16 a[92:93], v61 offset:14336
ds_read_b64_tr_b16 a[94:95], v61 offset:15360
ds_read_b64_tr_b16 a[96:97], v61 offset:16384
ds_read_b64_tr_b16 a[98:99], v61 offset:17408
ds_read_b64_tr_b16 a[100:101], v61 offset:18432
ds_read_b64_tr_b16 a[102:103], v61 offset:19456
ds_read_b64_tr_b16 a[104:105], v61 offset:20480
ds_read_b64_tr_b16 a[106:107], v61 offset:21504
ds_read_b64_tr_b16 a[108:109], v61 offset:22528
ds_read_b64_tr_b16 a[110:111], v61 offset:23552
ds_read_b64_tr_b16 a[112:113], v61 offset:24576
ds_read_b64_tr_b16 a[114:115], v61 offset:25600
ds_read_b64_tr_b16 a[116:117], v61 offset:26624
ds_read_b64_tr_b16 a[118:119], v61 offset:27648
ds_read_b64_tr_b16 a[120:121], v61 offset:28672
ds_read_b64_tr_b16 a[122:123], v61 offset:29696
ds_read_b64_tr_b16 a[124:125], v61 offset:30720
ds_read_b64_tr_b16 a[126:127], v61 offset:31744
s_waitcnt lgkmcnt(0)
s_barrier
s_add_u32 m0, s53, 65536
s_add_u32 s52, s52, s51
s_add_u32 s52, s52, s55
buffer_load_dwordx4 v59, s[12:15], s52 offen lds
s_add_u32 m0, s53, 66560
s_add_u32 s52, s52, s51
buffer_load_dwordx4 v59, s[12:15], s52 offen lds
s_add_u32 m0, s53, 67584
s_add_u32 s52, s52, s51
buffer_load_dwordx4 v59, s[12:15], s52 offen lds
s_add_u32 m0, s53, 68608
s_add_u32 s52, s52, s51
buffer_load_dwordx4 v59, s[12:15], s52 offen lds
s_add_u32 m0, s53, 69632
s_add_u32 s52, s52, s51
buffer_load_dwordx4 v59, s[12:15], s52 offen lds
s_add_u32 m0, s53, 70656
s_add_u32 s52, s52, s51
buffer_load_dwordx4 v59, s[12:15], s52 offen lds
s_add_u32 m0, s53, 71680
s_add_u32 s52, s52, s51
buffer_load_dwordx4 v59, s[12:15], s52 offen lds
s_add_u32 m0, s53, 72704
s_add_u32 s52, s52, s51
buffer_load_dwordx4 v59, s[12:15], s52 offen lds
s_add_u32 m0, s53, 73728
s_add_u32 s52, s52, s51
buffer_load_dwordx4 v59, s[12:15], s52 offen lds
s_add_u32 m0, s53, 74752
s_add_u32 s52, s52, s51
buffer_load_dwordx4 v59, s[12:15], s52 offen lds
s_add_u32 m0, s53, 75776
s_add_u32 s52, s52, s51
buffer_load_dwordx4 v59, s[12:15], s52 offen lds
s_add_u32 m0, s53, 76800
s_add_u32 s52, s52, s51
buffer_load_dwordx4 v59, s[12:15], s52 offen lds
s_add_u32 m0, s53, 77824
s_add_u32 s52, s52, s51
buffer_load_dwordx4 v59, s[12:15], s52 offen lds
s_add_u32 m0, s53, 78848
s_add_u32 s52, s52, s51
buffer_load_dwordx4 v59, s[12:15], s52 offen lds
s_add_u32 m0, s53, 79872
s_add_u32 s52, s52, s51
buffer_load_dwordx4 v59, s[12:15], s52 offen lds
s_add_u32 m0, s53, 80896
s_add_u32 s52, s52, s51
buffer_load_dwordx4 v59, s[12:15], s52 offen lds
s_waitcnt vmcnt(16)
s_barrier
ds_read_b64_tr_b16 a[128:129], v60 offset:0
ds_read_b64_tr_b16 a[130:131], v60 offset:1024
ds_read_b64_tr_b16 a[132:133], v60 offset:2048
ds_read_b64_tr_b16 a[134:135], v60 offset:3072
ds_read_b64_tr_b16 a[136:137], v60 offset:4096
ds_read_b64_tr_b16 a[138:139], v60 offset:5120
ds_read_b64_tr_b16 a[140:141], v60 offset:6144
ds_read_b64_tr_b16 a[142:143], v60 offset:7168
ds_read_b64_tr_b16 a[144:145], v60 offset:8192
ds_read_b64_tr_b16 a[146:147], v60 offset:9216
ds_read_b64_tr_b16 a[148:149], v60 offset:10240
ds_read_b64_tr_b16 a[150:151], v60 offset:11264
ds_read_b64_tr_b16 a[152:153], v60 offset:12288
ds_read_b64_tr_b16 a[154:155], v60 offset:13312
ds_read_b64_tr_b16 a[156:157], v60 offset:14336
ds_read_b64_tr_b16 a[158:159], v60 offset:15360
ds_read_b64_tr_b16 a[160:161], v60 offset:16384
ds_read_b64_tr_b16 a[162:163], v60 offset:17408
ds_read_b64_tr_b16 a[164:165], v60 offset:18432
ds_read_b64_tr_b16 a[166:167], v60 offset:19456
ds_read_b64_tr_b16 a[168:169], v60 offset:20480
ds_read_b64_tr_b16 a[170:171], v60 offset:21504
ds_read_b64_tr_b16 a[172:173], v60 offset:22528
ds_read_b64_tr_b16 a[174:175], v60 offset:23552
ds_read_b64_tr_b16 a[176:177], v60 offset:24576
ds_read_b64_tr_b16 a[178:179], v60 offset:25600
ds_read_b64_tr_b16 a[180:181], v60 offset:26624
ds_read_b64_tr_b16 a[182:183], v60 offset:27648
ds_read_b64_tr_b16 a[184:185], v60 offset:28672
ds_read_b64_tr_b16 a[186:187], v60 offset:29696
ds_read_b64_tr_b16 a[188:189], v60 offset:30720
ds_read_b64_tr_b16 a[190:191], v60 offset:31744
s_waitcnt lgkmcnt(0)
s_barrier
s_waitcnt vmcnt(0)
s_barrier
ds_read_b64_tr_b16 a[192:193], v61 offset:0
ds_read_b64_tr_b16 a[194:195], v61 offset:1024
ds_read_b64_tr_b16 a[196:197], v61 offset:2048
ds_read_b64_tr_b16 a[198:199], v61 offset:3072
ds_read_b64_tr_b16 a[200:201], v61 offset:4096
ds_read_b64_tr_b16 a[202:203], v61 offset:5120
ds_read_b64_tr_b16 a[204:205], v61 offset:6144
ds_read_b64_tr_b16 a[206:207], v61 offset:7168
ds_read_b64_tr_b16 a[208:209], v61 offset:8192
ds_read_b64_tr_b16 a[210:211], v61 offset:9216
ds_read_b64_tr_b16 a[212:213], v61 offset:10240
ds_read_b64_tr_b16 a[214:215], v61 offset:11264
ds_read_b64_tr_b16 a[216:217], v61 offset:12288
ds_read_b64_tr_b16 a[218:219], v61 offset:13312
ds_read_b64_tr_b16 a[220:221], v61 offset:14336
ds_read_b64_tr_b16 a[222:223], v61 offset:15360
ds_read_b64_tr_b16 a[224:225], v61 offset:16384
ds_read_b64_tr_b16 a[226:227], v61 offset:17408
ds_read_b64_tr_b16 a[228:229], v61 offset:18432
ds_read_b64_tr_b16 a[230:231], v61 offset:19456
ds_read_b64_tr_b16 a[232:233], v61 offset:20480
ds_read_b64_tr_b16 a[234:235], v61 offset:21504
ds_read_b64_tr_b16 a[236:237], v61 offset:22528
ds_read_b64_tr_b16 a[238:239], v61 offset:23552
ds_read_b64_tr_b16 a[240:241], v61 offset:24576
ds_read_b64_tr_b16 a[242:243], v61 offset:25600
ds_read_b64_tr_b16 a[244:245], v61 offset:26624
ds_read_b64_tr_b16 a[246:247], v61 offset:27648
ds_read_b64_tr_b16 a[248:249], v61 offset:28672
ds_read_b64_tr_b16 a[250:251], v61 offset:29696
ds_read_b64_tr_b16 a[252:253], v61 offset:30720
ds_read_b64_tr_b16 a[254:255], v61 offset:31744
s_waitcnt lgkmcnt(0)
s_barrier
s_branch Lp2loaded
Lp2load3:
v_lshrrev_b32 v56, 4, v0
s_and_b32 s50, s42, 1
s_cmp_eq_u32 s50, 0
s_cselect_b32 s12, s74, s76
s_cselect_b32 s13, s75, s77
s_mov_b32 s15, 0x20000
s_lshl_b32 s50, s50, 1
v_bfe_u32 v57, v56, 4, 1
v_or_b32 v57, s50, v57
v_lshlrev_b32 v57, 1, v57
v_and_b32 v58, 7, v56
v_xor_b32 v57, v57, v58
v_lshrrev_b32 v58, 3, v56
v_mul_lo_u32 v58, v58, s66
v_lshl_add_u32 v59, v57, 4, v58
v_bfe_u32 v57, v56, 4, 1
v_bfe_u32 v58, v56, 3, 1
v_lshl_add_u32 v58, v57, 1, v58
v_xor_b32 v58, s42, v58
v_lshlrev_b32 v58, 5, v58
v_lshl_add_u32 v58, v57, 15, v58
v_and_b32 v57, 3, v56
v_lshl_add_u32 v58, v57, 3, v58
v_bfe_u32 v57, v56, 2, 2
v_lshl_add_u32 v58, v57, 7, v58
v_lshrrev_b32 v57, 5, v56
v_lshl_add_u32 v60, v57, 9, v58
v_add_u32 v61, 0x10000, v60
s_lshl_b32 s51, s66, 3
s_lshr_b32 s50, s42, 1
s_lshl_b32 s52, s50, 4
s_mul_i32 s52, s52, s51
s_add_u32 s52, s52, s67
s_lshl_b32 s50, s50, 14
s_and_b32 s53, s42, 1
s_lshl_b32 s53, s53, 15
s_add_u32 s53, s53, s50
s_lshl_b32 s55, s51, 4
s_add_u32 m0, s53, 0
s_nop 0
buffer_load_dwordx4 v59, s[12:15], s52 offen lds
s_add_u32 m0, s53, 1024
s_add_u32 s52, s52, s51
buffer_load_dwordx4 v59, s[12:15], s52 offen lds
s_add_u32 m0, s53, 2048
s_add_u32 s52, s52, s51
buffer_load_dwordx4 v59, s[12:15], s52 offen lds
s_add_u32 m0, s53, 3072
s_add_u32 s52, s52, s51
buffer_load_dwordx4 v59, s[12:15], s52 offen lds
s_add_u32 m0, s53, 4096
s_add_u32 s52, s52, s51
buffer_load_dwordx4 v59, s[12:15], s52 offen lds
s_add_u32 m0, s53, 5120
s_add_u32 s52, s52, s51
buffer_load_dwordx4 v59, s[12:15], s52 offen lds
s_add_u32 m0, s53, 6144
s_add_u32 s52, s52, s51
buffer_load_dwordx4 v59, s[12:15], s52 offen lds
s_add_u32 m0, s53, 7168
s_add_u32 s52, s52, s51
buffer_load_dwordx4 v59, s[12:15], s52 offen lds
s_add_u32 m0, s53, 8192
s_add_u32 s52, s52, s51
buffer_load_dwordx4 v59, s[12:15], s52 offen lds
s_add_u32 m0, s53, 9216
s_add_u32 s52, s52, s51
buffer_load_dwordx4 v59, s[12:15], s52 offen lds
s_add_u32 m0, s53, 10240
s_add_u32 s52, s52, s51
buffer_load_dwordx4 v59, s[12:15], s52 offen lds
s_add_u32 m0, s53, 11264
s_add_u32 s52, s52, s51
buffer_load_dwordx4 v59, s[12:15], s52 offen lds
s_add_u32 m0, s53, 12288
s_add_u32 s52, s52, s51
buffer_load_dwordx4 v59, s[12:15], s52 offen lds
s_add_u32 m0, s53, 13312
s_add_u32 s52, s52, s51
buffer_load_dwordx4 v59, s[12:15], s52 offen lds
s_add_u32 m0, s53, 14336
s_add_u32 s52, s52, s51
buffer_load_dwordx4 v59, s[12:15], s52 offen lds
s_add_u32 m0, s53, 15360
s_add_u32 s52, s52, s51
buffer_load_dwordx4 v59, s[12:15], s52 offen lds
s_waitcnt vmcnt(0)
s_barrier
s_add_u32 m0, s53, 65536
s_add_u32 s52, s52, s51
s_add_u32 s52, s52, s55
buffer_load_dwordx4 v59, s[12:15], s52 offen lds
s_add_u32 m0, s53, 66560
s_add_u32 s52, s52, s51
buffer_load_dwordx4 v59, s[12:15], s52 offen lds
s_add_u32 m0, s53, 67584
s_add_u32 s52, s52, s51
buffer_load_dwordx4 v59, s[12:15], s52 offen lds
s_add_u32 m0, s53, 68608
s_add_u32 s52, s52, s51
buffer_load_dwordx4 v59, s[12:15], s52 offen lds
s_add_u32 m0, s53, 69632
s_add_u32 s52, s52, s51
buffer_load_dwordx4 v59, s[12:15], s52 offen lds
s_add_u32 m0, s53, 70656
s_add_u32 s52, s52, s51
buffer_load_dwordx4 v59, s[12:15], s52 offen lds
s_add_u32 m0, s53, 71680
s_add_u32 s52, s52, s51
buffer_load_dwordx4 v59, s[12:15], s52 offen lds
s_add_u32 m0, s53, 72704
s_add_u32 s52, s52, s51
buffer_load_dwordx4 v59, s[12:15], s52 offen lds
s_add_u32 m0, s53, 73728
s_add_u32 s52, s52, s51
buffer_load_dwordx4 v59, s[12:15], s52 offen lds
s_add_u32 m0, s53, 74752
s_add_u32 s52, s52, s51
buffer_load_dwordx4 v59, s[12:15], s52 offen lds
s_add_u32 m0, s53, 75776
s_add_u32 s52, s52, s51
buffer_load_dwordx4 v59, s[12:15], s52 offen lds
s_add_u32 m0, s53, 76800
s_add_u32 s52, s52, s51
buffer_load_dwordx4 v59, s[12:15], s52 offen lds
s_add_u32 m0, s53, 77824
s_add_u32 s52, s52, s51
buffer_load_dwordx4 v59, s[12:15], s52 offen lds
s_add_u32 m0, s53, 78848
s_add_u32 s52, s52, s51
buffer_load_dwordx4 v59, s[12:15], s52 offen lds
s_add_u32 m0, s53, 79872
s_add_u32 s52, s52, s51
buffer_load_dwordx4 v59, s[12:15], s52 offen lds
s_add_u32 m0, s53, 80896
s_add_u32 s52, s52, s51
buffer_load_dwordx4 v59, s[12:15], s52 offen lds
ds_read_b64_tr_b16 a[0:1], v60 offset:0
ds_read_b64_tr_b16 a[2:3], v60 offset:1024
ds_read_b64_tr_b16 a[4:5], v60 offset:2048
ds_read_b64_tr_b16 a[6:7], v60 offset:3072
ds_read_b64_tr_b16 a[8:9], v60 offset:4096
ds_read_b64_tr_b16 a[10:11], v60 offset:5120
ds_read_b64_tr_b16 a[12:13], v60 offset:6144
ds_read_b64_tr_b16 a[14:15], v60 offset:7168
ds_read_b64_tr_b16 a[16:17], v60 offset:8192
ds_read_b64_tr_b16 a[18:19], v60 offset:9216
ds_read_b64_tr_b16 a[20:21], v60 offset:10240
ds_read_b64_tr_b16 a[22:23], v60 offset:11264
ds_read_b64_tr_b16 a[24:25], v60 offset:12288
ds_read_b64_tr_b16 a[26:27], v60 offset:13312
ds_read_b64_tr_b16 a[28:29], v60 offset:14336
ds_read_b64_tr_b16 a[30:31], v60 offset:15360
ds_read_b64_tr_b16 a[32:33], v60 offset:16384
ds_read_b64_tr_b16 a[34:35], v60 offset:17408
ds_read_b64_tr_b16 a[36:37], v60 offset:18432
ds_read_b64_tr_b16 a[38:39], v60 offset:19456
ds_read_b64_tr_b16 a[40:41], v60 offset:20480
ds_read_b64_tr_b16 a[42:43], v60 offset:21504
ds_read_b64_tr_b16 a[44:45], v60 offset:22528
ds_read_b64_tr_b16 a[46:47], v60 offset:23552
ds_read_b64_tr_b16 a[48:49], v60 offset:24576
ds_read_b64_tr_b16 a[50:51], v60 offset:25600
ds_read_b64_tr_b16 a[52:53], v60 offset:26624
ds_read_b64_tr_b16 a[54:55], v60 offset:27648
ds_read_b64_tr_b16 a[56:57], v60 offset:28672
ds_read_b64_tr_b16 a[58:59], v60 offset:29696
ds_read_b64_tr_b16 a[60:61], v60 offset:30720
ds_read_b64_tr_b16 a[62:63], v60 offset:31744
s_waitcnt lgkmcnt(0)
s_waitcnt vmcnt(0)
s_barrier
s_add_u32 m0, s53, 0
s_add_u32 s52, s52, s51
s_add_u32 s52, s52, s55
buffer_load_dwordx4 v59, s[12:15], s52 offen lds
s_add_u32 m0, s53, 1024
s_add_u32 s52, s52, s51
buffer_load_dwordx4 v59, s[12:15], s52 offen lds
s_add_u32 m0, s53, 2048
s_add_u32 s52, s52, s51
buffer_load_dwordx4 v59, s[12:15], s52 offen lds
s_add_u32 m0, s53, 3072
s_add_u32 s52, s52, s51
buffer_load_dwordx4 v59, s[12:15], s52 offen lds
s_add_u32 m0, s53, 4096
s_add_u32 s52, s52, s51
buffer_load_dwordx4 v59, s[12:15], s52 offen lds
s_add_u32 m0, s53, 5120
s_add_u32 s52, s52, s51
buffer_load_dwordx4 v59, s[12:15], s52 offen lds
s_add_u32 m0, s53, 6144
s_add_u32 s52, s52, s51
buffer_load_dwordx4 v59, s[12:15], s52 offen lds
s_add_u32 m0, s53, 7168
s_add_u32 s52, s52, s51
buffer_load_dwordx4 v59, s[12:15], s52 offen lds
s_add_u32 m0, s53, 8192
s_add_u32 s52, s52, s51
buffer_load_dwordx4 v59, s[12:15], s52 offen lds
s_add_u32 m0, s53, 9216
s_add_u32 s52, s52, s51
buffer_load_dwordx4 v59, s[12:15], s52 offen lds
s_add_u32 m0, s53, 10240
s_add_u32 s52, s52, s51
buffer_load_dwordx4 v59, s[12:15], s52 offen lds
s_add_u32 m0, s53, 11264
s_add_u32 s52, s52, s51
buffer_load_dwordx4 v59, s[12:15], s52 offen lds
s_add_u32 m0, s53, 12288
s_add_u32 s52, s52, s51
buffer_load_dwordx4 v59, s[12:15], s52 offen lds
s_add_u32 m0, s53, 13312
s_add_u32 s52, s52, s51
buffer_load_dwordx4 v59, s[12:15], s52 offen lds
s_add_u32 m0, s53, 14336
s_add_u32 s52, s52, s51
buffer_load_dwordx4 v59, s[12:15], s52 offen lds
s_add_u32 m0, s53, 15360
s_add_u32 s52, s52, s51
buffer_load_dwordx4 v59, s[12:15], s52 offen lds
ds_read_b64_tr_b16 a[64:65], v61 offset:0
ds_read_b64_tr_b16 a[66:67], v61 offset:1024
ds_read_b64_tr_b16 a[68:69], v61 offset:2048
ds_read_b64_tr_b16 a[70:71], v61 offset:3072
ds_read_b64_tr_b16 a[72:73], v61 offset:4096
ds_read_b64_tr_b16 a[74:75], v61 offset:5120
ds_read_b64_tr_b16 a[76:77], v61 offset:6144
ds_read_b64_tr_b16 a[78:79], v61 offset:7168
ds_read_b64_tr_b16 a[80:81], v61 offset:8192
ds_read_b64_tr_b16 a[82:83], v61 offset:9216
ds_read_b64_tr_b16 a[84:85], v61 offset:10240
ds_read_b64_tr_b16 a[86:87], v61 offset:11264
ds_read_b64_tr_b16 a[88:89], v61 offset:12288
ds_read_b64_tr_b16 a[90:91], v61 offset:13312
ds_read_b64_tr_b16 a[92:93], v61 offset:14336
ds_read_b64_tr_b16 a[94:95], v61 offset:15360
ds_read_b64_tr_b16 a[96:97], v61 offset:16384
ds_read_b64_tr_b16 a[98:99], v61 offset:17408
ds_read_b64_tr_b16 a[100:101], v61 offset:18432
ds_read_b64_tr_b16 a[102:103], v61 offset:19456
ds_read_b64_tr_b16 a[104:105], v61 offset:20480
ds_read_b64_tr_b16 a[106:107], v61 offset:21504
ds_read_b64_tr_b16 a[108:109], v61 offset:22528
ds_read_b64_tr_b16 a[110:111], v61 offset:23552
ds_read_b64_tr_b16 a[112:113], v61 offset:24576
ds_read_b64_tr_b16 a[114:115], v61 offset:25600
ds_read_b64_tr_b16 a[116:117], v61 offset:26624
ds_read_b64_tr_b16 a[118:119], v61 offset:27648
ds_read_b64_tr_b16 a[120:121], v61 offset:28672
ds_read_b64_tr_b16 a[122:123], v61 offset:29696
ds_read_b64_tr_b16 a[124:125], v61 offset:30720
ds_read_b64_tr_b16 a[126:127], v61 offset:31744
s_waitcnt lgkmcnt(0)
s_waitcnt vmcnt(0)
s_barrier
s_add_u32 m0, s53, 65536
s_add_u32 s52, s52, s51
s_add_u32 s52, s52, s55
buffer_load_dwordx4 v59, s[12:15], s52 offen lds
s_add_u32 m0, s53, 66560
s_add_u32 s52, s52, s51
buffer_load_dwordx4 v59, s[12:15], s52 offen lds
s_add_u32 m0, s53, 67584
s_add_u32 s52, s52, s51
buffer_load_dwordx4 v59, s[12:15], s52 offen lds
s_add_u32 m0, s53, 68608
s_add_u32 s52, s52, s51
buffer_load_dwordx4 v59, s[12:15], s52 offen lds
s_add_u32 m0, s53, 69632
s_add_u32 s52, s52, s51
buffer_load_dwordx4 v59, s[12:15], s52 offen lds
s_add_u32 m0, s53, 70656
s_add_u32 s52, s52, s51
buffer_load_dwordx4 v59, s[12:15], s52 offen lds
s_add_u32 m0, s53, 71680
s_add_u32 s52, s52, s51
buffer_load_dwordx4 v59, s[12:15], s52 offen lds
s_add_u32 m0, s53, 72704
s_add_u32 s52, s52, s51
buffer_load_dwordx4 v59, s[12:15], s52 offen lds
s_add_u32 m0, s53, 73728
s_add_u32 s52, s52, s51
buffer_load_dwordx4 v59, s[12:15], s52 offen lds
s_add_u32 m0, s53, 74752
s_add_u32 s52, s52, s51
buffer_load_dwordx4 v59, s[12:15], s52 offen lds
s_add_u32 m0, s53, 75776
s_add_u32 s52, s52, s51
buffer_load_dwordx4 v59, s[12:15], s52 offen lds
s_add_u32 m0, s53, 76800
s_add_u32 s52, s52, s51
buffer_load_dwordx4 v59, s[12:15], s52 offen lds
s_add_u32 m0, s53, 77824
s_add_u32 s52, s52, s51
buffer_load_dwordx4 v59, s[12:15], s52 offen lds
s_add_u32 m0, s53, 78848
s_add_u32 s52, s52, s51
buffer_load_dwordx4 v59, s[12:15], s52 offen lds
s_add_u32 m0, s53, 79872
s_add_u32 s52, s52, s51
buffer_load_dwordx4 v59, s[12:15], s52 offen lds
s_add_u32 m0, s53, 80896
s_add_u32 s52, s52, s51
buffer_load_dwordx4 v59, s[12:15], s52 offen lds
ds_read_b64_tr_b16 a[128:129], v60 offset:0
ds_read_b64_tr_b16 a[130:131], v60 offset:1024
ds_read_b64_tr_b16 a[132:133], v60 offset:2048
ds_read_b64_tr_b16 a[134:135], v60 offset:3072
ds_read_b64_tr_b16 a[136:137], v60 offset:4096
ds_read_b64_tr_b16 a[138:139], v60 offset:5120
ds_read_b64_tr_b16 a[140:141], v60 offset:6144
ds_read_b64_tr_b16 a[142:143], v60 offset:7168
ds_read_b64_tr_b16 a[144:145], v60 offset:8192
ds_read_b64_tr_b16 a[146:147], v60 offset:9216
ds_read_b64_tr_b16 a[148:149], v60 offset:10240
ds_read_b64_tr_b16 a[150:151], v60 offset:11264
ds_read_b64_tr_b16 a[152:153], v60 offset:12288
ds_read_b64_tr_b16 a[154:155], v60 offset:13312
ds_read_b64_tr_b16 a[156:157], v60 offset:14336
ds_read_b64_tr_b16 a[158:159], v60 offset:15360
ds_read_b64_tr_b16 a[160:161], v60 offset:16384
ds_read_b64_tr_b16 a[162:163], v60 offset:17408
ds_read_b64_tr_b16 a[164:165], v60 offset:18432
ds_read_b64_tr_b16 a[166:167], v60 offset:19456
ds_read_b64_tr_b16 a[168:169], v60 offset:20480
ds_read_b64_tr_b16 a[170:171], v60 offset:21504
ds_read_b64_tr_b16 a[172:173], v60 offset:22528
ds_read_b64_tr_b16 a[174:175], v60 offset:23552
ds_read_b64_tr_b16 a[176:177], v60 offset:24576
ds_read_b64_tr_b16 a[178:179], v60 offset:25600
ds_read_b64_tr_b16 a[180:181], v60 offset:26624
ds_read_b64_tr_b16 a[182:183], v60 offset:27648
ds_read_b64_tr_b16 a[184:185], v60 offset:28672
ds_read_b64_tr_b16 a[186:187], v60 offset:29696
ds_read_b64_tr_b16 a[188:189], v60 offset:30720
ds_read_b64_tr_b16 a[190:191], v60 offset:31744
s_waitcnt lgkmcnt(0)
s_waitcnt vmcnt(0)
s_barrier
ds_read_b64_tr_b16 a[192:193], v61 offset:0
ds_read_b64_tr_b16 a[194:195], v61 offset:1024
ds_read_b64_tr_b16 a[196:197], v61 offset:2048
ds_read_b64_tr_b16 a[198:199], v61 offset:3072
ds_read_b64_tr_b16 a[200:201], v61 offset:4096
ds_read_b64_tr_b16 a[202:203], v61 offset:5120
ds_read_b64_tr_b16 a[204:205], v61 offset:6144
ds_read_b64_tr_b16 a[206:207], v61 offset:7168
ds_read_b64_tr_b16 a[208:209], v61 offset:8192
ds_read_b64_tr_b16 a[210:211], v61 offset:9216
ds_read_b64_tr_b16 a[212:213], v61 offset:10240
ds_read_b64_tr_b16 a[214:215], v61 offset:11264
ds_read_b64_tr_b16 a[216:217], v61 offset:12288
ds_read_b64_tr_b16 a[218:219], v61 offset:13312
ds_read_b64_tr_b16 a[220:221], v61 offset:14336
ds_read_b64_tr_b16 a[222:223], v61 offset:15360
ds_read_b64_tr_b16 a[224:225], v61 offset:16384
ds_read_b64_tr_b16 a[226:227], v61 offset:17408
ds_read_b64_tr_b16 a[228:229], v61 offset:18432
ds_read_b64_tr_b16 a[230:231], v61 offset:19456
ds_read_b64_tr_b16 a[232:233], v61 offset:20480
ds_read_b64_tr_b16 a[234:235], v61 offset:21504
ds_read_b64_tr_b16 a[236:237], v61 offset:22528
ds_read_b64_tr_b16 a[238:239], v61 offset:23552
ds_read_b64_tr_b16 a[240:241], v61 offset:24576
ds_read_b64_tr_b16 a[242:243], v61 offset:25600
ds_read_b64_tr_b16 a[244:245], v61 offset:26624
ds_read_b64_tr_b16 a[246:247], v61 offset:27648
ds_read_b64_tr_b16 a[248:249], v61 offset:28672
ds_read_b64_tr_b16 a[250:251], v61 offset:29696
ds_read_b64_tr_b16 a[252:253], v61 offset:30720
ds_read_b64_tr_b16 a[254:255], v61 offset:31744
s_waitcnt lgkmcnt(0)
s_barrier
Lp2loaded:
s_mov_b32 s72, 0xbdd2d3e8
s_mov_b32 s73, s72
v_mov_b32 v6, 0xc0135761
v_mov_b32 v7, 0xc0135761
s_cmp_eq_u32 s68, 1
s_cbranch_scc1 Lgup
s_cmp_eq_u32 s68, 2
s_cbranch_scc1 Lgdown
s_branch Lgwo
Lp3:
s_mov_b32 s79, 2
s_mov_b32 s46, 63
s_mov_b32 s47, 1
v_lshrrev_b32 v56, 4, v0
s_lshl_b32 s57, s42, 10
s_branch Lp2down2
Lp4:
v_mbcnt_lo_u32_b32 v56, -1, 0
v_mbcnt_hi_u32_b32 v56, -1, v56
v_lshlrev_b32 v0, 4, v56
v_mov_b32 v3, 0
s_lshl_b32 s50, s40, 7
s_sub_u32 s99, s80, s50
s_mov_b32 s79, 4
s_sub_u32 s45, s40, 56
s_cmp_ge_u32 s40, 60
s_cbranch_scc1 Lred1
s_cmp_ge_u32 s40, 56
s_cbranch_scc1 Lred2
v_lshrrev_b32 v88, 9, v0
s_mov_b32 s45, s40
s_mov_b32 s79, 3
s_mov_b32 s46, 63
s_mov_b32 s48, 1
s_mov_b32 s47, 1
s_lshl_b32 s57, s42, 10
s_branch Lp2up2
Lp2q:
s_sub_u32 s45, s45, 120
s_mov_b32 s74, s20
s_mov_b32 s75, s21
s_add_u32 s76, s74, 128
s_addc_u32 s77, s75, 0
s_mov_b32 s14, 8388480
s_mov_b32 s66, 8192
s_lshl_b32 s67, s45, 8
s_lshl_b32 s59, s45, 7
s_add_u32 s59, s59, 133193728
s_lshl_b32 s50, s45, 19
s_add_u32 s57, s57, s50
s_add_u32 s57, s57, 4194304
s_mov_b32 s58, 0x2000
s_mov_b32 s49, 0
s_mov_b32 s56, 0x10000
v_lshrrev_b32 v56, 4, v0
s_and_b32 s50, s42, 1
s_cmp_eq_u32 s50, 0
s_cselect_b32 s12, s74, s76
s_cselect_b32 s13, s75, s77
s_mov_b32 s15, 0x20000
s_lshl_b32 s50, s50, 1
v_bfe_u32 v57, v56, 4, 1
v_or_b32 v57, s50, v57
v_lshlrev_b32 v57, 1, v57
v_and_b32 v58, 7, v56
v_xor_b32 v57, v57, v58
v_lshrrev_b32 v58, 3, v56
v_mul_lo_u32 v58, v58, s66
v_lshl_add_u32 v59, v57, 4, v58
v_bfe_u32 v57, v56, 4, 1
v_bfe_u32 v58, v56, 3, 1
v_lshl_add_u32 v58, v57, 1, v58
v_xor_b32 v58, s42, v58
v_lshlrev_b32 v58, 5, v58
v_lshl_add_u32 v58, v57, 15, v58
v_and_b32 v57, 3, v56
v_lshl_add_u32 v58, v57, 3, v58
v_bfe_u32 v57, v56, 2, 2
v_lshl_add_u32 v58, v57, 7, v58
v_lshrrev_b32 v57, 5, v56
v_lshl_add_u32 v60, v57, 10, v58
v_add_u32 v61, 0x10000, v60
s_lshl_b32 s51, s66, 3
s_lshr_b32 s50, s42, 1
s_lshl_b32 s52, s50, 4
s_mul_i32 s52, s52, s51
s_add_u32 s52, s52, s67
s_lshl_b32 s50, s50, 14
s_and_b32 s53, s42, 1
s_lshl_b32 s53, s53, 15
s_add_u32 s53, s53, s50
s_lshl_b32 s55, s51, 4
s_add_u32 m0, s53, 0
s_nop 0
buffer_load_dwordx4 v59, s[12:15], s52 offen lds
s_add_u32 m0, s53, 1024
s_add_u32 s52, s52, s51
buffer_load_dwordx4 v59, s[12:15], s52 offen lds
s_add_u32 m0, s53, 2048
s_add_u32 s52, s52, s51
buffer_load_dwordx4 v59, s[12:15], s52 offen lds
s_add_u32 m0, s53, 3072
s_add_u32 s52, s52, s51
buffer_load_dwordx4 v59, s[12:15], s52 offen lds
s_add_u32 m0, s53, 4096
s_add_u32 s52, s52, s51
buffer_load_dwordx4 v59, s[12:15], s52 offen lds
s_add_u32 m0, s53, 5120
s_add_u32 s52, s52, s51
buffer_load_dwordx4 v59, s[12:15], s52 offen lds
s_add_u32 m0, s53, 6144
s_add_u32 s52, s52, s51
buffer_load_dwordx4 v59, s[12:15], s52 offen lds
s_add_u32 m0, s53, 7168
s_add_u32 s52, s52, s51
buffer_load_dwordx4 v59, s[12:15], s52 offen lds
s_add_u32 m0, s53, 8192
s_add_u32 s52, s52, s51
buffer_load_dwordx4 v59, s[12:15], s52 offen lds
s_add_u32 m0, s53, 9216
s_add_u32 s52, s52, s51
buffer_load_dwordx4 v59, s[12:15], s52 offen lds
s_add_u32 m0, s53, 10240
s_add_u32 s52, s52, s51
buffer_load_dwordx4 v59, s[12:15], s52 offen lds
s_add_u32 m0, s53, 11264
s_add_u32 s52, s52, s51
buffer_load_dwordx4 v59, s[12:15], s52 offen lds
s_add_u32 m0, s53, 12288
s_add_u32 s52, s52, s51
buffer_load_dwordx4 v59, s[12:15], s52 offen lds
s_add_u32 m0, s53, 13312
s_add_u32 s52, s52, s51
buffer_load_dwordx4 v59, s[12:15], s52 offen lds
s_add_u32 m0, s53, 14336
s_add_u32 s52, s52, s51
buffer_load_dwordx4 v59, s[12:15], s52 offen lds
s_add_u32 m0, s53, 15360
s_add_u32 s52, s52, s51
buffer_load_dwordx4 v59, s[12:15], s52 offen lds
s_waitcnt vmcnt(0)
s_barrier
s_add_u32 m0, s53, 65536
s_add_u32 s52, s52, s51
s_add_u32 s52, s52, s55
buffer_load_dwordx4 v59, s[12:15], s52 offen lds
s_add_u32 m0, s53, 66560
s_add_u32 s52, s52, s51
buffer_load_dwordx4 v59, s[12:15], s52 offen lds
s_add_u32 m0, s53, 67584
s_add_u32 s52, s52, s51
buffer_load_dwordx4 v59, s[12:15], s52 offen lds
s_add_u32 m0, s53, 68608
s_add_u32 s52, s52, s51
buffer_load_dwordx4 v59, s[12:15], s52 offen lds
s_add_u32 m0, s53, 69632
s_add_u32 s52, s52, s51
buffer_load_dwordx4 v59, s[12:15], s52 offen lds
s_add_u32 m0, s53, 70656
s_add_u32 s52, s52, s51
buffer_load_dwordx4 v59, s[12:15], s52 offen lds
s_add_u32 m0, s53, 71680
s_add_u32 s52, s52, s51
buffer_load_dwordx4 v59, s[12:15], s52 offen lds
s_add_u32 m0, s53, 72704
s_add_u32 s52, s52, s51
buffer_load_dwordx4 v59, s[12:15], s52 offen lds
s_add_u32 m0, s53, 73728
s_add_u32 s52, s52, s51
buffer_load_dwordx4 v59, s[12:15], s52 offen lds
s_add_u32 m0, s53, 74752
s_add_u32 s52, s52, s51
buffer_load_dwordx4 v59, s[12:15], s52 offen lds
s_add_u32 m0, s53, 75776
s_add_u32 s52, s52, s51
buffer_load_dwordx4 v59, s[12:15], s52 offen lds
s_add_u32 m0, s53, 76800
s_add_u32 s52, s52, s51
buffer_load_dwordx4 v59, s[12:15], s52 offen lds
s_add_u32 m0, s53, 77824
s_add_u32 s52, s52, s51
buffer_load_dwordx4 v59, s[12:15], s52 offen lds
s_add_u32 m0, s53, 78848
s_add_u32 s52, s52, s51
buffer_load_dwordx4 v59, s[12:15], s52 offen lds
s_add_u32 m0, s53, 79872
s_add_u32 s52, s52, s51
buffer_load_dwordx4 v59, s[12:15], s52 offen lds
s_add_u32 m0, s53, 80896
s_add_u32 s52, s52, s51
buffer_load_dwordx4 v59, s[12:15], s52 offen lds
ds_read_b64_tr_b16 a[0:1], v60 offset:0
ds_read_b64_tr_b16 a[2:3], v60 offset:512
ds_read_b64_tr_b16 a[4:5], v60 offset:2048
ds_read_b64_tr_b16 a[6:7], v60 offset:2560
ds_read_b64_tr_b16 a[8:9], v60 offset:4096
ds_read_b64_tr_b16 a[10:11], v60 offset:4608
ds_read_b64_tr_b16 a[12:13], v60 offset:6144
ds_read_b64_tr_b16 a[14:15], v60 offset:6656
ds_read_b64_tr_b16 a[16:17], v60 offset:8192
ds_read_b64_tr_b16 a[18:19], v60 offset:8704
ds_read_b64_tr_b16 a[20:21], v60 offset:10240
ds_read_b64_tr_b16 a[22:23], v60 offset:10752
ds_read_b64_tr_b16 a[24:25], v60 offset:12288
ds_read_b64_tr_b16 a[26:27], v60 offset:12800
ds_read_b64_tr_b16 a[28:29], v60 offset:14336
ds_read_b64_tr_b16 a[30:31], v60 offset:14848
ds_read_b64_tr_b16 a[32:33], v60 offset:16384
ds_read_b64_tr_b16 a[34:35], v60 offset:16896
ds_read_b64_tr_b16 a[36:37], v60 offset:18432
ds_read_b64_tr_b16 a[38:39], v60 offset:18944
ds_read_b64_tr_b16 a[40:41], v60 offset:20480
ds_read_b64_tr_b16 a[42:43], v60 offset:20992
ds_read_b64_tr_b16 a[44:45], v60 offset:22528
ds_read_b64_tr_b16 a[46:47], v60 offset:23040
ds_read_b64_tr_b16 a[48:49], v60 offset:24576
ds_read_b64_tr_b16 a[50:51], v60 offset:25088
ds_read_b64_tr_b16 a[52:53], v60 offset:26624
ds_read_b64_tr_b16 a[54:55], v60 offset:27136
ds_read_b64_tr_b16 a[56:57], v60 offset:28672
ds_read_b64_tr_b16 a[58:59], v60 offset:29184
ds_read_b64_tr_b16 a[60:61], v60 offset:30720
ds_read_b64_tr_b16 a[62:63], v60 offset:31232
s_waitcnt lgkmcnt(0)
s_waitcnt vmcnt(0)
s_barrier
s_add_u32 m0, s53, 0
s_add_u32 s52, s52, s51
s_add_u32 s52, s52, s55
buffer_load_dwordx4 v59, s[12:15], s52 offen lds
s_add_u32 m0, s53, 1024
s_add_u32 s52, s52, s51
buffer_load_dwordx4 v59, s[12:15], s52 offen lds
s_add_u32 m0, s53, 2048
s_add_u32 s52, s52, s51
buffer_load_dwordx4 v59, s[12:15], s52 offen lds
s_add_u32 m0, s53, 3072
s_add_u32 s52, s52, s51
buffer_load_dwordx4 v59, s[12:15], s52 offen lds
s_add_u32 m0, s53, 4096
s_add_u32 s52, s52, s51
buffer_load_dwordx4 v59, s[12:15], s52 offen lds
s_add_u32 m0, s53, 5120
s_add_u32 s52, s52, s51
buffer_load_dwordx4 v59, s[12:15], s52 offen lds
s_add_u32 m0, s53, 6144
s_add_u32 s52, s52, s51
buffer_load_dwordx4 v59, s[12:15], s52 offen lds
s_add_u32 m0, s53, 7168
s_add_u32 s52, s52, s51
buffer_load_dwordx4 v59, s[12:15], s52 offen lds
s_add_u32 m0, s53, 8192
s_add_u32 s52, s52, s51
buffer_load_dwordx4 v59, s[12:15], s52 offen lds
s_add_u32 m0, s53, 9216
s_add_u32 s52, s52, s51
buffer_load_dwordx4 v59, s[12:15], s52 offen lds
s_add_u32 m0, s53, 10240
s_add_u32 s52, s52, s51
buffer_load_dwordx4 v59, s[12:15], s52 offen lds
s_add_u32 m0, s53, 11264
s_add_u32 s52, s52, s51
buffer_load_dwordx4 v59, s[12:15], s52 offen lds
s_add_u32 m0, s53, 12288
s_add_u32 s52, s52, s51
buffer_load_dwordx4 v59, s[12:15], s52 offen lds
s_add_u32 m0, s53, 13312
s_add_u32 s52, s52, s51
buffer_load_dwordx4 v59, s[12:15], s52 offen lds
s_add_u32 m0, s53, 14336
s_add_u32 s52, s52, s51
buffer_load_dwordx4 v59, s[12:15], s52 offen lds
s_add_u32 m0, s53, 15360
s_add_u32 s52, s52, s51
buffer_load_dwordx4 v59, s[12:15], s52 offen lds
ds_read_b64_tr_b16 a[64:65], v61 offset:0
ds_read_b64_tr_b16 a[66:67], v61 offset:512
ds_read_b64_tr_b16 a[68:69], v61 offset:2048
ds_read_b64_tr_b16 a[70:71], v61 offset:2560
ds_read_b64_tr_b16 a[72:73], v61 offset:4096
ds_read_b64_tr_b16 a[74:75], v61 offset:4608
ds_read_b64_tr_b16 a[76:77], v61 offset:6144
ds_read_b64_tr_b16 a[78:79], v61 offset:6656
ds_read_b64_tr_b16 a[80:81], v61 offset:8192
ds_read_b64_tr_b16 a[82:83], v61 offset:8704
ds_read_b64_tr_b16 a[84:85], v61 offset:10240
ds_read_b64_tr_b16 a[86:87], v61 offset:10752
ds_read_b64_tr_b16 a[88:89], v61 offset:12288
ds_read_b64_tr_b16 a[90:91], v61 offset:12800
ds_read_b64_tr_b16 a[92:93], v61 offset:14336
ds_read_b64_tr_b16 a[94:95], v61 offset:14848
ds_read_b64_tr_b16 a[96:97], v61 offset:16384
ds_read_b64_tr_b16 a[98:99], v61 offset:16896
ds_read_b64_tr_b16 a[100:101], v61 offset:18432
ds_read_b64_tr_b16 a[102:103], v61 offset:18944
ds_read_b64_tr_b16 a[104:105], v61 offset:20480
ds_read_b64_tr_b16 a[106:107], v61 offset:20992
ds_read_b64_tr_b16 a[108:109], v61 offset:22528
ds_read_b64_tr_b16 a[110:111], v61 offset:23040
ds_read_b64_tr_b16 a[112:113], v61 offset:24576
ds_read_b64_tr_b16 a[114:115], v61 offset:25088
ds_read_b64_tr_b16 a[116:117], v61 offset:26624
ds_read_b64_tr_b16 a[118:119], v61 offset:27136
ds_read_b64_tr_b16 a[120:121], v61 offset:28672
ds_read_b64_tr_b16 a[122:123], v61 offset:29184
ds_read_b64_tr_b16 a[124:125], v61 offset:30720
ds_read_b64_tr_b16 a[126:127], v61 offset:31232
s_waitcnt lgkmcnt(0)
s_waitcnt vmcnt(0)
s_barrier
s_add_u32 m0, s53, 65536
s_add_u32 s52, s52, s51
s_add_u32 s52, s52, s55
buffer_load_dwordx4 v59, s[12:15], s52 offen lds
s_add_u32 m0, s53, 66560
s_add_u32 s52, s52, s51
buffer_load_dwordx4 v59, s[12:15], s52 offen lds
s_add_u32 m0, s53, 67584
s_add_u32 s52, s52, s51
buffer_load_dwordx4 v59, s[12:15], s52 offen lds
s_add_u32 m0, s53, 68608
s_add_u32 s52, s52, s51
buffer_load_dwordx4 v59, s[12:15], s52 offen lds
s_add_u32 m0, s53, 69632
s_add_u32 s52, s52, s51
buffer_load_dwordx4 v59, s[12:15], s52 offen lds
s_add_u32 m0, s53, 70656
s_add_u32 s52, s52, s51
buffer_load_dwordx4 v59, s[12:15], s52 offen lds
s_add_u32 m0, s53, 71680
s_add_u32 s52, s52, s51
buffer_load_dwordx4 v59, s[12:15], s52 offen lds
s_add_u32 m0, s53, 72704
s_add_u32 s52, s52, s51
buffer_load_dwordx4 v59, s[12:15], s52 offen lds
s_add_u32 m0, s53, 73728
s_add_u32 s52, s52, s51
buffer_load_dwordx4 v59, s[12:15], s52 offen lds
s_add_u32 m0, s53, 74752
s_add_u32 s52, s52, s51
buffer_load_dwordx4 v59, s[12:15], s52 offen lds
s_add_u32 m0, s53, 75776
s_add_u32 s52, s52, s51
buffer_load_dwordx4 v59, s[12:15], s52 offen lds
s_add_u32 m0, s53, 76800
s_add_u32 s52, s52, s51
buffer_load_dwordx4 v59, s[12:15], s52 offen lds
s_add_u32 m0, s53, 77824
s_add_u32 s52, s52, s51
buffer_load_dwordx4 v59, s[12:15], s52 offen lds
s_add_u32 m0, s53, 78848
s_add_u32 s52, s52, s51
buffer_load_dwordx4 v59, s[12:15], s52 offen lds
s_add_u32 m0, s53, 79872
s_add_u32 s52, s52, s51
buffer_load_dwordx4 v59, s[12:15], s52 offen lds
s_add_u32 m0, s53, 80896
s_add_u32 s52, s52, s51
buffer_load_dwordx4 v59, s[12:15], s52 offen lds
ds_read_b64_tr_b16 a[128:129], v60 offset:0
ds_read_b64_tr_b16 a[130:131], v60 offset:512
ds_read_b64_tr_b16 a[132:133], v60 offset:2048
ds_read_b64_tr_b16 a[134:135], v60 offset:2560
ds_read_b64_tr_b16 a[136:137], v60 offset:4096
ds_read_b64_tr_b16 a[138:139], v60 offset:4608
ds_read_b64_tr_b16 a[140:141], v60 offset:6144
ds_read_b64_tr_b16 a[142:143], v60 offset:6656
ds_read_b64_tr_b16 a[144:145], v60 offset:8192
ds_read_b64_tr_b16 a[146:147], v60 offset:8704
ds_read_b64_tr_b16 a[148:149], v60 offset:10240
ds_read_b64_tr_b16 a[150:151], v60 offset:10752
ds_read_b64_tr_b16 a[152:153], v60 offset:12288
ds_read_b64_tr_b16 a[154:155], v60 offset:12800
ds_read_b64_tr_b16 a[156:157], v60 offset:14336
ds_read_b64_tr_b16 a[158:159], v60 offset:14848
ds_read_b64_tr_b16 a[160:161], v60 offset:16384
ds_read_b64_tr_b16 a[162:163], v60 offset:16896
ds_read_b64_tr_b16 a[164:165], v60 offset:18432
ds_read_b64_tr_b16 a[166:167], v60 offset:18944
ds_read_b64_tr_b16 a[168:169], v60 offset:20480
ds_read_b64_tr_b16 a[170:171], v60 offset:20992
ds_read_b64_tr_b16 a[172:173], v60 offset:22528
ds_read_b64_tr_b16 a[174:175], v60 offset:23040
ds_read_b64_tr_b16 a[176:177], v60 offset:24576
ds_read_b64_tr_b16 a[178:179], v60 offset:25088
ds_read_b64_tr_b16 a[180:181], v60 offset:26624
ds_read_b64_tr_b16 a[182:183], v60 offset:27136
ds_read_b64_tr_b16 a[184:185], v60 offset:28672
ds_read_b64_tr_b16 a[186:187], v60 offset:29184
ds_read_b64_tr_b16 a[188:189], v60 offset:30720
ds_read_b64_tr_b16 a[190:191], v60 offset:31232
s_waitcnt lgkmcnt(0)
s_waitcnt vmcnt(0)
s_barrier
ds_read_b64_tr_b16 a[192:193], v61 offset:0
ds_read_b64_tr_b16 a[194:195], v61 offset:512
ds_read_b64_tr_b16 a[196:197], v61 offset:2048
ds_read_b64_tr_b16 a[198:199], v61 offset:2560
ds_read_b64_tr_b16 a[200:201], v61 offset:4096
ds_read_b64_tr_b16 a[202:203], v61 offset:4608
ds_read_b64_tr_b16 a[204:205], v61 offset:6144
ds_read_b64_tr_b16 a[206:207], v61 offset:6656
ds_read_b64_tr_b16 a[208:209], v61 offset:8192
ds_read_b64_tr_b16 a[210:211], v61 offset:8704
ds_read_b64_tr_b16 a[212:213], v61 offset:10240
ds_read_b64_tr_b16 a[214:215], v61 offset:10752
ds_read_b64_tr_b16 a[216:217], v61 offset:12288
ds_read_b64_tr_b16 a[218:219], v61 offset:12800
ds_read_b64_tr_b16 a[220:221], v61 offset:14336
ds_read_b64_tr_b16 a[222:223], v61 offset:14848
ds_read_b64_tr_b16 a[224:225], v61 offset:16384
ds_read_b64_tr_b16 a[226:227], v61 offset:16896
ds_read_b64_tr_b16 a[228:229], v61 offset:18432
ds_read_b64_tr_b16 a[230:231], v61 offset:18944
ds_read_b64_tr_b16 a[232:233], v61 offset:20480
ds_read_b64_tr_b16 a[234:235], v61 offset:20992
ds_read_b64_tr_b16 a[236:237], v61 offset:22528
ds_read_b64_tr_b16 a[238:239], v61 offset:23040
ds_read_b64_tr_b16 a[240:241], v61 offset:24576
ds_read_b64_tr_b16 a[242:243], v61 offset:25088
ds_read_b64_tr_b16 a[244:245], v61 offset:26624
ds_read_b64_tr_b16 a[246:247], v61 offset:27136
ds_read_b64_tr_b16 a[248:249], v61 offset:28672
ds_read_b64_tr_b16 a[250:251], v61 offset:29184
ds_read_b64_tr_b16 a[252:253], v61 offset:30720
ds_read_b64_tr_b16 a[254:255], v61 offset:31232
s_waitcnt lgkmcnt(0)
s_barrier
s_branch Lgk
Lgwo:
s_mov_b32 s65, 0x10000
v_mov_b32 v71, 131072
v_mov_b32 v4, s46
s_mov_b32 s62, 0
s_mul_i32 s50, s62, s61
s_add_u32 s62, s62, 1
s_cmp_eq_u32 s62, s78
s_cselect_b32 s62, 0, s62
s_mul_i32 s51, s62, s61
s_sub_u32 s51, s51, s50
s_add_u32 s63, s46, 1
v_mad_i32_i24 v68, v88, s51, v1
v_add_u32 v68, s50, v68
v_add_u32 v69, s63, v88
Lgwo_cold:
s_cmp_lg_u32 s42, 0
s_cbranch_scc1 Lgwo_w_162
Lgwo_sp:
buffer_load_dword v2, v68, s[4:7], s60 offen sc1
s_waitcnt vmcnt(0)
v_cmp_gt_i32 vcc, v69, v2
s_nop 0
s_cmp_eq_u32 vcc_lo, 0
s_cbranch_scc1 Lgwo_spd
s_sleep 2
s_sub_u32 s43, s43, 1
s_cbranch_scc0 Lgwo_sp
s_mov_b32 s43, 0
Lgwo_spd:
v_mov_b32 v70, vcc_hi
ds_write_b32 v71, v70
s_waitcnt lgkmcnt(0)
Lgwo_w_162:
s_barrier
Lgwo_fetch:
s_lshl_b32 s53, s42, 10
s_xor_b32 s54, s65, 0x10000
s_add_u32 s54, s54, s53
s_add_u32 s53, s53, s49
s_add_u32 m0, s54, 0
s_add_u32 s55, s53, 0
buffer_load_dwordx4 v0, s[4:7], s55 offen sc1 lds
s_add_u32 m0, s54, 4096
s_add_u32 s55, s53, 4096
buffer_load_dwordx4 v0, s[4:7], s55 offen sc1 lds
s_add_u32 m0, s54, 8192
s_add_u32 s55, s53, 8192
buffer_load_dwordx4 v0, s[4:7], s55 offen sc1 lds
s_add_u32 m0, s54, 12288
s_add_u32 s55, s53, 12288
buffer_load_dwordx4 v0, s[4:7], s55 offen sc1 lds
s_add_u32 m0, s54, 16384
s_add_u32 s55, s53, 16384
buffer_load_dwordx4 v0, s[4:7], s55 offen sc1 lds
s_add_u32 m0, s54, 20480
s_add_u32 s55, s53, 20480
buffer_load_dwordx4 v0, s[4:7], s55 offen sc1 lds
s_add_u32 m0, s54, 24576
s_add_u32 s55, s53, 24576
buffer_load_dwordx4 v0, s[4:7], s55 offen sc1 lds
s_add_u32 m0, s54, 28672
s_add_u32 s55, s53, 28672
buffer_load_dwordx4 v0, s[4:7], s55 offen sc1 lds
s_add_u32 m0, s54, 32768
s_add_u32 s55, s53, 32768
buffer_load_dwordx4 v0, s[4:7], s55 offen sc1 lds
s_add_u32 m0, s54, 36864
s_add_u32 s55, s53, 36864
buffer_load_dwordx4 v0, s[4:7], s55 offen sc1 lds
s_add_u32 m0, s54, 40960
s_add_u32 s55, s53, 40960
buffer_load_dwordx4 v0, s[4:7], s55 offen sc1 lds
s_add_u32 m0, s54, 45056
s_add_u32 s55, s53, 45056
buffer_load_dwordx4 v0, s[4:7], s55 offen sc1 lds
s_add_u32 m0, s54, 49152
s_add_u32 s55, s53, 49152
buffer_load_dwordx4 v0, s[4:7], s55 offen sc1 lds
s_add_u32 m0, s54, 53248
s_add_u32 s55, s53, 53248
buffer_load_dwordx4 v0, s[4:7], s55 offen sc1 lds
s_add_u32 m0, s54, 57344
s_add_u32 s55, s53, 57344
buffer_load_dwordx4 v0, s[4:7], s55 offen sc1 lds
s_add_u32 m0, s54, 61440
s_add_u32 s55, s53, 61440
buffer_load_dwordx4 v0, s[4:7], s55 offen sc1 lds
s_lshl_b32 s64, s40, 14
s_lshl_b32 s50, s42, 11
s_add_u32 s64, s64, s50
s_add_u32 s64, s64, 155189248
s_waitcnt vmcnt(8)
Lgwo_top0:
s_cmp_lg_u32 s42, 0
s_cbranch_scc1 Lgwo_w_163
s_mul_i32 s50, s62, s61
s_add_u32 s62, s62, 1
s_cmp_eq_u32 s62, s78
s_cselect_b32 s62, 0, s62
s_mul_i32 s51, s62, s61
s_sub_u32 s51, s51, s50
s_add_u32 s63, s46, 2
v_mad_i32_i24 v68, v88, s51, v1
v_add_u32 v68, s50, v68
v_add_u32 v69, s63, v88
buffer_load_dword v2, v68, s[4:7], s60 offen sc1
Lgwo_w_163:
s_xor_b32 s65, s65, 0x10000
s_add_u32 s49, s49, s56
v_add_u32 v5, s65, v0
s_barrier
ds_read_b128 v[8:11], v5 offset:0
ds_read_b128 v[12:15], v5 offset:1024
ds_read_b32 v70, v71 offset:0
ds_read_b128 v[16:19], v5 offset:2048
s_lshl_b32 s53, s42, 10
s_xor_b32 s54, s65, 0x10000
s_add_u32 s54, s54, s53
s_add_u32 s53, s53, s49
s_waitcnt lgkmcnt(3)
v_mfma_f32_32x32x16_bf16 v[40:55], a[0:3], v[8:11], 0
ds_read_b128 v[20:23], v5 offset:3072
ds_read_b128 v[24:27], v5 offset:4096
ds_read_b128 v[28:31], v5 offset:5120
ds_read_b128 v[32:35], v5 offset:6144
s_waitcnt lgkmcnt(5)
v_mfma_f32_32x32x16_bf16 v[40:55], a[4:7], v[12:15], v[40:55]
ds_read_b128 v[36:39], v5 offset:7168
ds_read_b128 v[8:11], v5 offset:8192
v_readfirstlane_b32 s50, v70
s_cmp_le_u32 s47, 1
s_cbranch_scc1 Lgwo_last0
s_cmp_lg_u32 s50, 0
s_cbranch_scc1 Lgwo_nop0
s_waitcnt lgkmcnt(6)
v_mfma_f32_32x32x16_bf16 v[40:55], a[8:11], v[16:19], v[40:55]
ds_read_b128 v[12:15], v5 offset:9216
s_add_u32 m0, s54, 0
s_add_u32 s55, s53, 0
buffer_load_dwordx4 v0, s[4:7], s55 offen sc1 lds
v_cvt_pk_bf16_f32 v56, v72, v73
s_waitcnt lgkmcnt(6)
v_mfma_f32_32x32x16_bf16 v[40:55], a[12:15], v[20:23], v[40:55]
ds_read_b128 v[16:19], v5 offset:10240
v_cvt_pk_bf16_f32 v57, v74, v75
v_cvt_pk_bf16_f32 v58, v76, v77
v_cvt_pk_bf16_f32 v59, v78, v79
buffer_store_dwordx4 v[56:59], v0, s[4:7], s64 offen sc1
s_waitcnt lgkmcnt(6)
v_mfma_f32_32x32x16_bf16 v[40:55], a[16:19], v[24:27], v[40:55]
ds_read_b128 v[20:23], v5 offset:11264
s_add_u32 m0, s54, 4096
s_add_u32 s55, s53, 4096
buffer_load_dwordx4 v0, s[4:7], s55 offen sc1 lds
s_add_u32 s64, s64, 4096
s_waitcnt lgkmcnt(6)
v_mfma_f32_32x32x16_bf16 v[40:55], a[20:23], v[28:31], v[40:55]
ds_read_b128 v[24:27], v5 offset:12288
v_cvt_pk_bf16_f32 v60, v80, v81
v_cvt_pk_bf16_f32 v61, v82, v83
v_cvt_pk_bf16_f32 v62, v84, v85
v_cvt_pk_bf16_f32 v63, v86, v87
s_waitcnt lgkmcnt(6)
v_mfma_f32_32x32x16_bf16 v[40:55], a[24:27], v[32:35], v[40:55]
ds_read_b128 v[28:31], v5 offset:13312
s_add_u32 m0, s54, 8192
s_add_u32 s55, s53, 8192
buffer_load_dwordx4 v0, s[4:7], s55 offen sc1 lds
buffer_store_dwordx4 v[60:63], v0, s[4:7], s64 offen sc1
s_waitcnt lgkmcnt(6)
v_mfma_f32_32x32x16_bf16 v[40:55], a[28:31], v[36:39], v[40:55]
ds_read_b128 v[32:35], v5 offset:14336
s_waitcnt lgkmcnt(6)
v_mfma_f32_32x32x16_bf16 v[40:55], a[32:35], v[8:11], v[40:55]
ds_read_b128 v[36:39], v5 offset:15360
s_add_u32 m0, s54, 12288
s_add_u32 s55, s53, 12288
buffer_load_dwordx4 v0, s[4:7], s55 offen sc1 lds
s_waitcnt lgkmcnt(6)
v_mfma_f32_32x32x16_bf16 v[40:55], a[36:39], v[12:15], v[40:55]
ds_read_b128 v[8:11], v5 offset:16384
s_waitcnt lgkmcnt(6)
v_mfma_f32_32x32x16_bf16 v[40:55], a[40:43], v[16:19], v[40:55]
ds_read_b128 v[12:15], v5 offset:17408
s_add_u32 m0, s54, 16384
s_add_u32 s55, s53, 16384
buffer_load_dwordx4 v0, s[4:7], s55 offen sc1 lds
s_waitcnt lgkmcnt(6)
v_mfma_f32_32x32x16_bf16 v[40:55], a[44:47], v[20:23], v[40:55]
ds_read_b128 v[16:19], v5 offset:18432
s_waitcnt lgkmcnt(6)
v_mfma_f32_32x32x16_bf16 v[40:55], a[48:51], v[24:27], v[40:55]
ds_read_b128 v[20:23], v5 offset:19456
s_add_u32 m0, s54, 20480
s_add_u32 s55, s53, 20480
buffer_load_dwordx4 v0, s[4:7], s55 offen sc1 lds
s_waitcnt lgkmcnt(6)
v_mfma_f32_32x32x16_bf16 v[40:55], a[52:55], v[28:31], v[40:55]
ds_read_b128 v[24:27], v5 offset:20480
s_waitcnt lgkmcnt(6)
v_mfma_f32_32x32x16_bf16 v[40:55], a[56:59], v[32:35], v[40:55]
ds_read_b128 v[28:31], v5 offset:21504
s_add_u32 m0, s54, 24576
s_add_u32 s55, s53, 24576
buffer_load_dwordx4 v0, s[4:7], s55 offen sc1 lds
s_waitcnt lgkmcnt(6)
v_mfma_f32_32x32x16_bf16 v[40:55], a[60:63], v[36:39], v[40:55]
ds_read_b128 v[32:35], v5 offset:22528
s_waitcnt lgkmcnt(6)
v_mfma_f32_32x32x16_bf16 v[40:55], a[64:67], v[8:11], v[40:55]
ds_read_b128 v[36:39], v5 offset:23552
s_add_u32 m0, s54, 28672
s_add_u32 s55, s53, 28672
buffer_load_dwordx4 v0, s[4:7], s55 offen sc1 lds
s_waitcnt lgkmcnt(6)
v_mfma_f32_32x32x16_bf16 v[40:55], a[68:71], v[12:15], v[40:55]
ds_read_b128 v[8:11], v5 offset:24576
s_waitcnt lgkmcnt(6)
v_mfma_f32_32x32x16_bf16 v[40:55], a[72:75], v[16:19], v[40:55]
ds_read_b128 v[12:15], v5 offset:25600
s_add_u32 m0, s54, 32768
s_add_u32 s55, s53, 32768
buffer_load_dwordx4 v0, s[4:7], s55 offen sc1 lds
s_waitcnt lgkmcnt(6)
v_mfma_f32_32x32x16_bf16 v[40:55], a[76:79], v[20:23], v[40:55]
ds_read_b128 v[16:19], v5 offset:26624
s_waitcnt lgkmcnt(6)
v_mfma_f32_32x32x16_bf16 v[40:55], a[80:83], v[24:27], v[40:55]
ds_read_b128 v[20:23], v5 offset:27648
s_add_u32 m0, s54, 36864
s_add_u32 s55, s53, 36864
buffer_load_dwordx4 v0, s[4:7], s55 offen sc1 lds
s_waitcnt lgkmcnt(6)
v_mfma_f32_32x32x16_bf16 v[40:55], a[84:87], v[28:31], v[40:55]
ds_read_b128 v[24:27], v5 offset:28672
s_cmp_lg_u32 s42, 0
s_cbranch_scc1 Lgwo_w_164
s_waitcnt vmcnt(12)
v_cmp_gt_i32 vcc, v69, v2
s_nop 1
v_mov_b32 v70, vcc_hi
v_mov_b32 v2, vcc_lo
ds_write2_b32 v71, v70, v2 offset0:4 offset1:1
Lgwo_w_164:
s_waitcnt lgkmcnt(6)
v_mfma_f32_32x32x16_bf16 v[40:55], a[88:91], v[32:35], v[40:55]
ds_read_b128 v[28:31], v5 offset:29696
s_add_u32 m0, s54, 40960
s_add_u32 s55, s53, 40960
buffer_load_dwordx4 v0, s[4:7], s55 offen sc1 lds
s_waitcnt lgkmcnt(6)
v_mfma_f32_32x32x16_bf16 v[40:55], a[92:95], v[36:39], v[40:55]
ds_read_b128 v[32:35], v5 offset:30720
s_waitcnt vmcnt(13) lgkmcnt(2)
s_barrier
s_waitcnt lgkmcnt(6)
v_mfma_f32_32x32x16_bf16 v[40:55], a[96:99], v[8:11], v[40:55]
ds_read_b128 v[36:39], v5 offset:31744
s_add_u32 m0, s54, 45056
s_add_u32 s55, s53, 45056
buffer_load_dwordx4 v0, s[4:7], s55 offen sc1 lds
s_waitcnt lgkmcnt(6)
v_mfma_f32_32x32x16_bf16 v[40:55], a[100:103], v[12:15], v[40:55]
ds_read_b128 v[8:11], v5 offset:32768
s_waitcnt lgkmcnt(6)
v_mfma_f32_32x32x16_bf16 v[40:55], a[104:107], v[16:19], v[40:55]
ds_read_b128 v[12:15], v5 offset:33792
s_add_u32 m0, s54, 49152
s_add_u32 s55, s53, 49152
buffer_load_dwordx4 v0, s[4:7], s55 offen sc1 lds
s_waitcnt lgkmcnt(6)
v_mfma_f32_32x32x16_bf16 v[40:55], a[108:111], v[20:23], v[40:55]
ds_read_b128 v[16:19], v5 offset:34816
s_waitcnt lgkmcnt(6)
v_mfma_f32_32x32x16_bf16 v[40:55], a[112:115], v[24:27], v[40:55]
ds_read_b128 v[20:23], v5 offset:35840
s_add_u32 m0, s54, 53248
s_add_u32 s55, s53, 53248
buffer_load_dwordx4 v0, s[4:7], s55 offen sc1 lds
s_waitcnt lgkmcnt(6)
v_mfma_f32_32x32x16_bf16 v[40:55], a[116:119], v[28:31], v[40:55]
ds_read_b128 v[24:27], v5 offset:36864
s_waitcnt lgkmcnt(6)
v_mfma_f32_32x32x16_bf16 v[40:55], a[120:123], v[32:35], v[40:55]
ds_read_b128 v[28:31], v5 offset:37888
s_add_u32 m0, s54, 57344
s_add_u32 s55, s53, 57344
buffer_load_dwordx4 v0, s[4:7], s55 offen sc1 lds
s_waitcnt lgkmcnt(6)
v_mfma_f32_32x32x16_bf16 v[40:55], a[124:127], v[36:39], v[40:55]
ds_read_b128 v[32:35], v5 offset:38912
s_waitcnt lgkmcnt(6)
v_mfma_f32_32x32x16_bf16 v[40:55], a[128:131], v[8:11], v[40:55]
ds_read_b128 v[36:39], v5 offset:39936
s_add_u32 m0, s54, 61440
s_add_u32 s55, s53, 61440
buffer_load_dwordx4 v0, s[4:7], s55 offen sc1 lds
s_waitcnt lgkmcnt(6)
v_mfma_f32_32x32x16_bf16 v[40:55], a[132:135], v[12:15], v[40:55]
ds_read_b128 v[8:11], v5 offset:40960
s_waitcnt vmcnt(13)
s_barrier
s_waitcnt lgkmcnt(6)
v_mfma_f32_32x32x16_bf16 v[40:55], a[136:139], v[16:19], v[40:55]
ds_read_b128 v[12:15], v5 offset:41984
s_cmp_lg_u32 s42, 0
s_cbranch_scc1 Lgwo_w_165
s_mov_b64 exec, 1
buffer_store_dword v4, v3, s[4:7], s59 offen sc1
s_mov_b64 exec, -1
Lgwo_w_165:
s_waitcnt lgkmcnt(6)
v_mfma_f32_32x32x16_bf16 v[40:55], a[140:143], v[20:23], v[40:55]
ds_read_b128 v[16:19], v5 offset:43008
s_waitcnt lgkmcnt(6)
v_mfma_f32_32x32x16_bf16 v[40:55], a[144:147], v[24:27], v[40:55]
ds_read_b128 v[20:23], v5 offset:44032
s_waitcnt lgkmcnt(6)
v_mfma_f32_32x32x16_bf16 v[40:55], a[148:151], v[28:31], v[40:55]
ds_read_b128 v[24:27], v5 offset:45056
s_waitcnt lgkmcnt(6)
v_mfma_f32_32x32x16_bf16 v[40:55], a[152:155], v[32:35], v[40:55]
ds_read_b128 v[28:31], v5 offset:46080
s_waitcnt lgkmcnt(6)
v_mfma_f32_32x32x16_bf16 v[40:55], a[156:159], v[36:39], v[40:55]
ds_read_b128 v[32:35], v5 offset:47104
s_waitcnt lgkmcnt(6)
v_mfma_f32_32x32x16_bf16 v[40:55], a[160:163], v[8:11], v[40:55]
ds_read_b128 v[36:39], v5 offset:48128
s_waitcnt lgkmcnt(6)
v_mfma_f32_32x32x16_bf16 v[40:55], a[164:167], v[12:15], v[40:55]
ds_read_b128 v[8:11], v5 offset:49152
s_waitcnt lgkmcnt(6)
v_mfma_f32_32x32x16_bf16 v[40:55], a[168:171], v[16:19], v[40:55]
ds_read_b128 v[12:15], v5 offset:50176
s_waitcnt lgkmcnt(6)
v_mfma_f32_32x32x16_bf16 v[40:55], a[172:175], v[20:23], v[40:55]
ds_read_b128 v[16:19], v5 offset:51200
s_waitcnt lgkmcnt(6)
v_mfma_f32_32x32x16_bf16 v[40:55], a[176:179], v[24:27], v[40:55]
ds_read_b128 v[20:23], v5 offset:52224
s_waitcnt lgkmcnt(6)
v_mfma_f32_32x32x16_bf16 v[40:55], a[180:183], v[28:31], v[40:55]
ds_read_b128 v[24:27], v5 offset:53248
s_waitcnt lgkmcnt(6)
v_mfma_f32_32x32x16_bf16 v[40:55], a[184:187], v[32:35], v[40:55]
ds_read_b128 v[28:31], v5 offset:54272
s_waitcnt lgkmcnt(6)
v_mfma_f32_32x32x16_bf16 v[40:55], a[188:191], v[36:39], v[40:55]
ds_read_b128 v[32:35], v5 offset:55296
s_waitcnt lgkmcnt(6)
v_mfma_f32_32x32x16_bf16 v[40:55], a[192:195], v[8:11], v[40:55]
ds_read_b128 v[36:39], v5 offset:56320
s_waitcnt lgkmcnt(6)
v_mfma_f32_32x32x16_bf16 v[40:55], a[196:199], v[12:15], v[40:55]
ds_read_b128 v[8:11], v5 offset:57344
s_waitcnt lgkmcnt(6)
v_mfma_f32_32x32x16_bf16 v[40:55], a[200:203], v[16:19], v[40:55]
ds_read_b128 v[12:15], v5 offset:58368
s_waitcnt lgkmcnt(6)
v_mfma_f32_32x32x16_bf16 v[40:55], a[204:207], v[20:23], v[40:55]
ds_read_b128 v[16:19], v5 offset:59392
s_waitcnt lgkmcnt(6)
v_mfma_f32_32x32x16_bf16 v[40:55], a[208:211], v[24:27], v[40:55]
ds_read_b128 v[20:23], v5 offset:60416
s_waitcnt lgkmcnt(6)
v_mfma_f32_32x32x16_bf16 v[40:55], a[212:215], v[28:31], v[40:55]
ds_read_b128 v[24:27], v5 offset:61440
s_waitcnt lgkmcnt(6)
v_mfma_f32_32x32x16_bf16 v[40:55], a[216:219], v[32:35], v[40:55]
ds_read_b128 v[28:31], v5 offset:62464
s_waitcnt lgkmcnt(6)
v_mfma_f32_32x32x16_bf16 v[40:55], a[220:223], v[36:39], v[40:55]
ds_read_b128 v[32:35], v5 offset:63488
s_waitcnt lgkmcnt(6)
v_mfma_f32_32x32x16_bf16 v[40:55], a[224:227], v[8:11], v[40:55]
ds_read_b128 v[36:39], v5 offset:64512
s_waitcnt lgkmcnt(6)
v_mfma_f32_32x32x16_bf16 v[40:55], a[228:231], v[12:15], v[40:55]
s_waitcnt lgkmcnt(5)
v_mfma_f32_32x32x16_bf16 v[40:55], a[232:235], v[16:19], v[40:55]
s_waitcnt lgkmcnt(4)
v_mfma_f32_32x32x16_bf16 v[40:55], a[236:239], v[20:23], v[40:55]
s_waitcnt lgkmcnt(3)
v_mfma_f32_32x32x16_bf16 v[40:55], a[240:243], v[24:27], v[40:55]
s_waitcnt lgkmcnt(2)
v_mfma_f32_32x32x16_bf16 v[40:55], a[244:247], v[28:31], v[40:55]
s_waitcnt lgkmcnt(1)
v_mfma_f32_32x32x16_bf16 v[40:55], a[248:251], v[32:35], v[40:55]
s_waitcnt lgkmcnt(0)
v_mfma_f32_32x32x16_bf16 v[40:55], a[252:255], v[36:39], v[40:55]
s_mov_b32 s64, s57
s_add_u32 s50, s46, 1
s_add_u32 s57, s57, s58
v_mov_b32 v4, s50
s_add_u32 s46, s46, s48
s_sub_u32 s47, s47, 1
s_waitcnt vmcnt(8)
s_branch Lgwo_top1
Lgwo_nop0:
s_waitcnt lgkmcnt(6)
v_mfma_f32_32x32x16_bf16 v[40:55], a[8:11], v[16:19], v[40:55]
ds_read_b128 v[12:15], v5 offset:9216
v_cvt_pk_bf16_f32 v56, v72, v73
v_cvt_pk_bf16_f32 v57, v74, v75
v_cvt_pk_bf16_f32 v58, v76, v77
v_cvt_pk_bf16_f32 v59, v78, v79
s_waitcnt lgkmcnt(6)
v_mfma_f32_32x32x16_bf16 v[40:55], a[12:15], v[20:23], v[40:55]
ds_read_b128 v[16:19], v5 offset:10240
buffer_store_dwordx4 v[56:59], v0, s[4:7], s64 offen sc1
s_add_u32 s64, s64, 4096
v_cvt_pk_bf16_f32 v60, v80, v81
v_cvt_pk_bf16_f32 v61, v82, v83
s_waitcnt lgkmcnt(6)
v_mfma_f32_32x32x16_bf16 v[40:55], a[16:19], v[24:27], v[40:55]
ds_read_b128 v[20:23], v5 offset:11264
v_cvt_pk_bf16_f32 v62, v84, v85
v_cvt_pk_bf16_f32 v63, v86, v87
buffer_store_dwordx4 v[60:63], v0, s[4:7], s64 offen sc1
s_waitcnt lgkmcnt(6)
v_mfma_f32_32x32x16_bf16 v[40:55], a[20:23], v[28:31], v[40:55]
ds_read_b128 v[24:27], v5 offset:12288
s_waitcnt lgkmcnt(6)
v_mfma_f32_32x32x16_bf16 v[40:55], a[24:27], v[32:35], v[40:55]
ds_read_b128 v[28:31], v5 offset:13312
s_waitcnt lgkmcnt(6)
v_mfma_f32_32x32x16_bf16 v[40:55], a[28:31], v[36:39], v[40:55]
ds_read_b128 v[32:35], v5 offset:14336
s_waitcnt lgkmcnt(6)
v_mfma_f32_32x32x16_bf16 v[40:55], a[32:35], v[8:11], v[40:55]
ds_read_b128 v[36:39], v5 offset:15360
s_waitcnt lgkmcnt(6)
v_mfma_f32_32x32x16_bf16 v[40:55], a[36:39], v[12:15], v[40:55]
ds_read_b128 v[8:11], v5 offset:16384
s_waitcnt lgkmcnt(6)
v_mfma_f32_32x32x16_bf16 v[40:55], a[40:43], v[16:19], v[40:55]
ds_read_b128 v[12:15], v5 offset:17408
s_waitcnt lgkmcnt(6)
v_mfma_f32_32x32x16_bf16 v[40:55], a[44:47], v[20:23], v[40:55]
ds_read_b128 v[16:19], v5 offset:18432
s_waitcnt lgkmcnt(6)
v_mfma_f32_32x32x16_bf16 v[40:55], a[48:51], v[24:27], v[40:55]
ds_read_b128 v[20:23], v5 offset:19456
s_waitcnt lgkmcnt(6)
v_mfma_f32_32x32x16_bf16 v[40:55], a[52:55], v[28:31], v[40:55]
ds_read_b128 v[24:27], v5 offset:20480
s_waitcnt lgkmcnt(6)
v_mfma_f32_32x32x16_bf16 v[40:55], a[56:59], v[32:35], v[40:55]
ds_read_b128 v[28:31], v5 offset:21504
s_waitcnt lgkmcnt(6)
v_mfma_f32_32x32x16_bf16 v[40:55], a[60:63], v[36:39], v[40:55]
ds_read_b128 v[32:35], v5 offset:22528
s_waitcnt lgkmcnt(6)
v_mfma_f32_32x32x16_bf16 v[40:55], a[64:67], v[8:11], v[40:55]
ds_read_b128 v[36:39], v5 offset:23552
s_waitcnt lgkmcnt(6)
v_mfma_f32_32x32x16_bf16 v[40:55], a[68:71], v[12:15], v[40:55]
ds_read_b128 v[8:11], v5 offset:24576
s_waitcnt lgkmcnt(6)
v_mfma_f32_32x32x16_bf16 v[40:55], a[72:75], v[16:19], v[40:55]
ds_read_b128 v[12:15], v5 offset:25600
s_waitcnt lgkmcnt(6)
v_mfma_f32_32x32x16_bf16 v[40:55], a[76:79], v[20:23], v[40:55]
ds_read_b128 v[16:19], v5 offset:26624
s_waitcnt lgkmcnt(6)
v_mfma_f32_32x32x16_bf16 v[40:55], a[80:83], v[24:27], v[40:55]
ds_read_b128 v[20:23], v5 offset:27648
s_waitcnt lgkmcnt(6)
v_mfma_f32_32x32x16_bf16 v[40:55], a[84:87], v[28:31], v[40:55]
ds_read_b128 v[24:27], v5 offset:28672
s_cmp_lg_u32 s42, 0
s_cbranch_scc1 Lgwo_w_166
s_waitcnt vmcnt(2)
v_cmp_gt_i32 vcc, v69, v2
s_nop 1
v_mov_b32 v70, vcc_hi
v_mov_b32 v2, vcc_lo
ds_write2_b32 v71, v70, v2 offset0:4 offset1:1
Lgwo_w_166:
s_waitcnt lgkmcnt(6)
v_mfma_f32_32x32x16_bf16 v[40:55], a[88:91], v[32:35], v[40:55]
ds_read_b128 v[28:31], v5 offset:29696
s_waitcnt lgkmcnt(6)
v_mfma_f32_32x32x16_bf16 v[40:55], a[92:95], v[36:39], v[40:55]
ds_read_b128 v[32:35], v5 offset:30720
s_waitcnt vmcnt(2) lgkmcnt(2)
s_barrier
ds_read_b32 v70, v71 offset:4
s_waitcnt lgkmcnt(6)
v_mfma_f32_32x32x16_bf16 v[40:55], a[96:99], v[8:11], v[40:55]
ds_read_b128 v[36:39], v5 offset:31744
s_waitcnt lgkmcnt(6)
v_mfma_f32_32x32x16_bf16 v[40:55], a[100:103], v[12:15], v[40:55]
ds_read_b128 v[8:11], v5 offset:32768
s_waitcnt lgkmcnt(2)
v_readfirstlane_b32 s50, v70
s_nop 0
s_cmp_eq_u32 s50, 0
s_cbranch_scc1 Lgwo_late0
s_waitcnt lgkmcnt(6)
v_mfma_f32_32x32x16_bf16 v[40:55], a[104:107], v[16:19], v[40:55]
ds_read_b128 v[12:15], v5 offset:33792
s_cmp_lg_u32 s42, 0
s_cbranch_scc1 Lgwo_w_167
buffer_load_dword v2, v68, s[4:7], s60 offen sc1
Lgwo_w_167:
s_waitcnt lgkmcnt(6)
v_mfma_f32_32x32x16_bf16 v[40:55], a[108:111], v[20:23], v[40:55]
ds_read_b128 v[16:19], v5 offset:34816
s_waitcnt lgkmcnt(6)
v_mfma_f32_32x32x16_bf16 v[40:55], a[112:115], v[24:27], v[40:55]
ds_read_b128 v[20:23], v5 offset:35840
s_waitcnt lgkmcnt(6)
v_mfma_f32_32x32x16_bf16 v[40:55], a[116:119], v[28:31], v[40:55]
ds_read_b128 v[24:27], v5 offset:36864
s_waitcnt lgkmcnt(6)
v_mfma_f32_32x32x16_bf16 v[40:55], a[120:123], v[32:35], v[40:55]
ds_read_b128 v[28:31], v5 offset:37888
s_waitcnt lgkmcnt(6)
v_mfma_f32_32x32x16_bf16 v[40:55], a[124:127], v[36:39], v[40:55]
ds_read_b128 v[32:35], v5 offset:38912
s_waitcnt lgkmcnt(6)
v_mfma_f32_32x32x16_bf16 v[40:55], a[128:131], v[8:11], v[40:55]
ds_read_b128 v[36:39], v5 offset:39936
s_waitcnt lgkmcnt(6)
v_mfma_f32_32x32x16_bf16 v[40:55], a[132:135], v[12:15], v[40:55]
ds_read_b128 v[8:11], v5 offset:40960
s_cmp_eq_u32 s42, 0
s_cbranch_scc1 Lgwo_z_168
s_waitcnt vmcnt(0)
Lgwo_z_168:
s_waitcnt vmcnt(1)
s_barrier
s_waitcnt lgkmcnt(6)
v_mfma_f32_32x32x16_bf16 v[40:55], a[136:139], v[16:19], v[40:55]
ds_read_b128 v[12:15], v5 offset:41984
s_cmp_lg_u32 s42, 0
s_cbranch_scc1 Lgwo_w_169
s_mov_b64 exec, 1
buffer_store_dword v4, v3, s[4:7], s59 offen sc1
s_mov_b64 exec, -1
Lgwo_w_169:
s_waitcnt lgkmcnt(6)
v_mfma_f32_32x32x16_bf16 v[40:55], a[140:143], v[20:23], v[40:55]
ds_read_b128 v[16:19], v5 offset:43008
s_waitcnt lgkmcnt(6)
v_mfma_f32_32x32x16_bf16 v[40:55], a[144:147], v[24:27], v[40:55]
ds_read_b128 v[20:23], v5 offset:44032
s_waitcnt lgkmcnt(6)
v_mfma_f32_32x32x16_bf16 v[40:55], a[148:151], v[28:31], v[40:55]
ds_read_b128 v[24:27], v5 offset:45056
s_waitcnt lgkmcnt(6)
v_mfma_f32_32x32x16_bf16 v[40:55], a[152:155], v[32:35], v[40:55]
ds_read_b128 v[28:31], v5 offset:46080
s_waitcnt lgkmcnt(6)
v_mfma_f32_32x32x16_bf16 v[40:55], a[156:159], v[36:39], v[40:55]
ds_read_b128 v[32:35], v5 offset:47104
s_waitcnt lgkmcnt(6)
v_mfma_f32_32x32x16_bf16 v[40:55], a[160:163], v[8:11], v[40:55]
ds_read_b128 v[36:39], v5 offset:48128
s_waitcnt lgkmcnt(6)
v_mfma_f32_32x32x16_bf16 v[40:55], a[164:167], v[12:15], v[40:55]
ds_read_b128 v[8:11], v5 offset:49152
s_waitcnt lgkmcnt(6)
v_mfma_f32_32x32x16_bf16 v[40:55], a[168:171], v[16:19], v[40:55]
ds_read_b128 v[12:15], v5 offset:50176
s_waitcnt lgkmcnt(6)
v_mfma_f32_32x32x16_bf16 v[40:55], a[172:175], v[20:23], v[40:55]
ds_read_b128 v[16:19], v5 offset:51200
s_waitcnt lgkmcnt(6)
v_mfma_f32_32x32x16_bf16 v[40:55], a[176:179], v[24:27], v[40:55]
ds_read_b128 v[20:23], v5 offset:52224
s_waitcnt lgkmcnt(6)
v_mfma_f32_32x32x16_bf16 v[40:55], a[180:183], v[28:31], v[40:55]
ds_read_b128 v[24:27], v5 offset:53248
s_waitcnt lgkmcnt(6)
v_mfma_f32_32x32x16_bf16 v[40:55], a[184:187], v[32:35], v[40:55]
ds_read_b128 v[28:31], v5 offset:54272
s_waitcnt lgkmcnt(6)
v_mfma_f32_32x32x16_bf16 v[40:55], a[188:191], v[36:39], v[40:55]
ds_read_b128 v[32:35], v5 offset:55296
s_waitcnt lgkmcnt(6)
v_mfma_f32_32x32x16_bf16 v[40:55], a[192:195], v[8:11], v[40:55]
ds_read_b128 v[36:39], v5 offset:56320
s_waitcnt lgkmcnt(6)
v_mfma_f32_32x32x16_bf16 v[40:55], a[196:199], v[12:15], v[40:55]
ds_read_b128 v[8:11], v5 offset:57344
s_waitcnt lgkmcnt(6)
v_mfma_f32_32x32x16_bf16 v[40:55], a[200:203], v[16:19], v[40:55]
ds_read_b128 v[12:15], v5 offset:58368
s_waitcnt lgkmcnt(6)
v_mfma_f32_32x32x16_bf16 v[40:55], a[204:207], v[20:23], v[40:55]
ds_read_b128 v[16:19], v5 offset:59392
s_waitcnt lgkmcnt(6)
v_mfma_f32_32x32x16_bf16 v[40:55], a[208:211], v[24:27], v[40:55]
ds_read_b128 v[20:23], v5 offset:60416
s_waitcnt lgkmcnt(6)
v_mfma_f32_32x32x16_bf16 v[40:55], a[212:215], v[28:31], v[40:55]
ds_read_b128 v[24:27], v5 offset:61440
s_waitcnt lgkmcnt(6)
v_mfma_f32_32x32x16_bf16 v[40:55], a[216:219], v[32:35], v[40:55]
ds_read_b128 v[28:31], v5 offset:62464
s_waitcnt lgkmcnt(6)
v_mfma_f32_32x32x16_bf16 v[40:55], a[220:223], v[36:39], v[40:55]
ds_read_b128 v[32:35], v5 offset:63488
s_cmp_lg_u32 s42, 0
s_cbranch_scc1 Lgwo_w_170
s_waitcnt vmcnt(1)
v_cmp_gt_i32 vcc, v69, v2
s_nop 1
v_mov_b32 v70, vcc_hi
v_mov_b32 v2, vcc_lo
ds_write2_b32 v71, v70, v2 offset0:4 offset1:2
Lgwo_w_170:
s_waitcnt lgkmcnt(6)
v_mfma_f32_32x32x16_bf16 v[40:55], a[224:227], v[8:11], v[40:55]
ds_read_b128 v[36:39], v5 offset:64512
s_waitcnt lgkmcnt(6)
v_mfma_f32_32x32x16_bf16 v[40:55], a[228:231], v[12:15], v[40:55]
s_waitcnt lgkmcnt(0)
s_barrier
ds_read_b32 v70, v71 offset:8
s_waitcnt lgkmcnt(5)
v_mfma_f32_32x32x16_bf16 v[40:55], a[232:235], v[16:19], v[40:55]
s_waitcnt lgkmcnt(4)
v_mfma_f32_32x32x16_bf16 v[40:55], a[236:239], v[20:23], v[40:55]
s_waitcnt lgkmcnt(0)
v_readfirstlane_b32 s50, v70
s_nop 0
s_cmp_eq_u32 s50, 0
s_cbranch_scc1 Lgwo_late20
s_waitcnt lgkmcnt(3)
v_mfma_f32_32x32x16_bf16 v[40:55], a[240:243], v[24:27], v[40:55]
s_waitcnt lgkmcnt(2)
v_mfma_f32_32x32x16_bf16 v[40:55], a[244:247], v[28:31], v[40:55]
s_waitcnt lgkmcnt(1)
v_mfma_f32_32x32x16_bf16 v[40:55], a[248:251], v[32:35], v[40:55]
s_waitcnt lgkmcnt(0)
v_mfma_f32_32x32x16_bf16 v[40:55], a[252:255], v[36:39], v[40:55]
s_mov_b32 s64, s57
s_add_u32 s50, s46, 1
s_add_u32 s57, s57, s58
v_mov_b32 v4, s50
s_nop 7
v_cvt_pk_bf16_f32 v56, v40, v41
v_cvt_pk_bf16_f32 v57, v42, v43
v_cvt_pk_bf16_f32 v58, v44, v45
v_cvt_pk_bf16_f32 v59, v46, v47
buffer_store_dwordx4 v[56:59], v0, s[4:7], s64 offen sc1
s_add_u32 s64, s64, 4096
v_cvt_pk_bf16_f32 v60, v48, v49
v_cvt_pk_bf16_f32 v61, v50, v51
v_cvt_pk_bf16_f32 v62, v52, v53
v_cvt_pk_bf16_f32 v63, v54, v55
buffer_store_dwordx4 v[60:63], v0, s[4:7], s64 offen sc1
s_cmp_lg_u32 s42, 0
s_cbranch_scc1 Lgwo_w_171
buffer_load_dword v2, v68, s[4:7], s60 offen sc1
s_waitcnt vmcnt(0)
v_cmp_gt_i32 vcc, v69, v2
s_nop 1
v_mov_b32 v70, vcc_hi
v_mov_b32 v2, vcc_lo
ds_write2_b32 v71, v70, v2 offset1:1
s_waitcnt lgkmcnt(0)
Lgwo_w_171:
s_add_u32 s46, s46, s48
s_sub_u32 s47, s47, 1
s_waitcnt vmcnt(0)
s_barrier
ds_read_b32 v70, v71 offset:4
s_cmp_lg_u32 s42, 0
s_cbranch_scc1 Lgwo_w_172
s_mov_b64 exec, 1
buffer_store_dword v4, v3, s[4:7], s59 offen sc1
s_mov_b64 exec, -1
Lgwo_w_172:
s_waitcnt lgkmcnt(0)
v_readfirstlane_b32 s50, v70
s_nop 0
s_cmp_eq_u32 s50, 0
s_cbranch_scc1 Lgwo_fetch
s_branch Lgwo_cold
Lgwo_late0:
s_waitcnt lgkmcnt(6)
v_mfma_f32_32x32x16_bf16 v[40:55], a[104:107], v[16:19], v[40:55]
ds_read_b128 v[12:15], v5 offset:33792
s_add_u32 m0, s54, 0
s_add_u32 s55, s53, 0
buffer_load_dwordx4 v0, s[4:7], s55 offen sc1 lds
s_waitcnt lgkmcnt(6)
v_mfma_f32_32x32x16_bf16 v[40:55], a[108:111], v[20:23], v[40:55]
ds_read_b128 v[16:19], v5 offset:34816
s_add_u32 m0, s54, 4096
s_add_u32 s55, s53, 4096
buffer_load_dwordx4 v0, s[4:7], s55 offen sc1 lds
s_waitcnt lgkmcnt(6)
v_mfma_f32_32x32x16_bf16 v[40:55], a[112:115], v[24:27], v[40:55]
ds_read_b128 v[20:23], v5 offset:35840
s_add_u32 m0, s54, 8192
s_add_u32 s55, s53, 8192
buffer_load_dwordx4 v0, s[4:7], s55 offen sc1 lds
s_waitcnt lgkmcnt(6)
v_mfma_f32_32x32x16_bf16 v[40:55], a[116:119], v[28:31], v[40:55]
ds_read_b128 v[24:27], v5 offset:36864
s_add_u32 m0, s54, 12288
s_add_u32 s55, s53, 12288
buffer_load_dwordx4 v0, s[4:7], s55 offen sc1 lds
s_waitcnt lgkmcnt(6)
v_mfma_f32_32x32x16_bf16 v[40:55], a[120:123], v[32:35], v[40:55]
ds_read_b128 v[28:31], v5 offset:37888
s_add_u32 m0, s54, 16384
s_add_u32 s55, s53, 16384
buffer_load_dwordx4 v0, s[4:7], s55 offen sc1 lds
s_waitcnt lgkmcnt(6)
v_mfma_f32_32x32x16_bf16 v[40:55], a[124:127], v[36:39], v[40:55]
ds_read_b128 v[32:35], v5 offset:38912
s_add_u32 m0, s54, 20480
s_add_u32 s55, s53, 20480
buffer_load_dwordx4 v0, s[4:7], s55 offen sc1 lds
s_waitcnt lgkmcnt(6)
v_mfma_f32_32x32x16_bf16 v[40:55], a[128:131], v[8:11], v[40:55]
ds_read_b128 v[36:39], v5 offset:39936
s_add_u32 m0, s54, 24576
s_add_u32 s55, s53, 24576
buffer_load_dwordx4 v0, s[4:7], s55 offen sc1 lds
s_waitcnt lgkmcnt(6)
v_mfma_f32_32x32x16_bf16 v[40:55], a[132:135], v[12:15], v[40:55]
ds_read_b128 v[8:11], v5 offset:40960
s_add_u32 m0, s54, 28672
s_add_u32 s55, s53, 28672
buffer_load_dwordx4 v0, s[4:7], s55 offen sc1 lds
s_waitcnt vmcnt(8)
s_barrier
s_waitcnt lgkmcnt(6)
v_mfma_f32_32x32x16_bf16 v[40:55], a[136:139], v[16:19], v[40:55]
ds_read_b128 v[12:15], v5 offset:41984
s_cmp_lg_u32 s42, 0
s_cbranch_scc1 Lgwo_w_173
s_mov_b64 exec, 1
buffer_store_dword v4, v3, s[4:7], s59 offen sc1
s_mov_b64 exec, -1
Lgwo_w_173:
s_waitcnt lgkmcnt(6)
v_mfma_f32_32x32x16_bf16 v[40:55], a[140:143], v[20:23], v[40:55]
ds_read_b128 v[16:19], v5 offset:43008
s_waitcnt lgkmcnt(6)
v_mfma_f32_32x32x16_bf16 v[40:55], a[144:147], v[24:27], v[40:55]
ds_read_b128 v[20:23], v5 offset:44032
s_add_u32 m0, s54, 32768
s_add_u32 s55, s53, 32768
buffer_load_dwordx4 v0, s[4:7], s55 offen sc1 lds
s_waitcnt lgkmcnt(6)
v_mfma_f32_32x32x16_bf16 v[40:55], a[148:151], v[28:31], v[40:55]
ds_read_b128 v[24:27], v5 offset:45056
s_waitcnt lgkmcnt(6)
v_mfma_f32_32x32x16_bf16 v[40:55], a[152:155], v[32:35], v[40:55]
ds_read_b128 v[28:31], v5 offset:46080
s_add_u32 m0, s54, 36864
s_add_u32 s55, s53, 36864
buffer_load_dwordx4 v0, s[4:7], s55 offen sc1 lds
s_waitcnt lgkmcnt(6)
v_mfma_f32_32x32x16_bf16 v[40:55], a[156:159], v[36:39], v[40:55]
ds_read_b128 v[32:35], v5 offset:47104
s_waitcnt lgkmcnt(6)
v_mfma_f32_32x32x16_bf16 v[40:55], a[160:163], v[8:11], v[40:55]
ds_read_b128 v[36:39], v5 offset:48128
s_add_u32 m0, s54, 40960
s_add_u32 s55, s53, 40960
buffer_load_dwordx4 v0, s[4:7], s55 offen sc1 lds
s_waitcnt lgkmcnt(6)
v_mfma_f32_32x32x16_bf16 v[40:55], a[164:167], v[12:15], v[40:55]
ds_read_b128 v[8:11], v5 offset:49152
s_waitcnt lgkmcnt(6)
v_mfma_f32_32x32x16_bf16 v[40:55], a[168:171], v[16:19], v[40:55]
ds_read_b128 v[12:15], v5 offset:50176
s_add_u32 m0, s54, 45056
s_add_u32 s55, s53, 45056
buffer_load_dwordx4 v0, s[4:7], s55 offen sc1 lds
s_waitcnt lgkmcnt(6)
v_mfma_f32_32x32x16_bf16 v[40:55], a[172:175], v[20:23], v[40:55]
ds_read_b128 v[16:19], v5 offset:51200
s_waitcnt lgkmcnt(6)
v_mfma_f32_32x32x16_bf16 v[40:55], a[176:179], v[24:27], v[40:55]
ds_read_b128 v[20:23], v5 offset:52224
s_add_u32 m0, s54, 49152
s_add_u32 s55, s53, 49152
buffer_load_dwordx4 v0, s[4:7], s55 offen sc1 lds
s_waitcnt lgkmcnt(6)
v_mfma_f32_32x32x16_bf16 v[40:55], a[180:183], v[28:31], v[40:55]
ds_read_b128 v[24:27], v5 offset:53248
s_waitcnt lgkmcnt(6)
v_mfma_f32_32x32x16_bf16 v[40:55], a[184:187], v[32:35], v[40:55]
ds_read_b128 v[28:31], v5 offset:54272
s_add_u32 m0, s54, 53248
s_add_u32 s55, s53, 53248
buffer_load_dwordx4 v0, s[4:7], s55 offen sc1 lds
s_waitcnt lgkmcnt(6)
v_mfma_f32_32x32x16_bf16 v[40:55], a[188:191], v[36:39], v[40:55]
ds_read_b128 v[32:35], v5 offset:55296
s_waitcnt lgkmcnt(6)
v_mfma_f32_32x32x16_bf16 v[40:55], a[192:195], v[8:11], v[40:55]
ds_read_b128 v[36:39], v5 offset:56320
s_add_u32 m0, s54, 57344
s_add_u32 s55, s53, 57344
buffer_load_dwordx4 v0, s[4:7], s55 offen sc1 lds
s_waitcnt lgkmcnt(6)
v_mfma_f32_32x32x16_bf16 v[40:55], a[196:199], v[12:15], v[40:55]
ds_read_b128 v[8:11], v5 offset:57344
s_waitcnt lgkmcnt(6)
v_mfma_f32_32x32x16_bf16 v[40:55], a[200:203], v[16:19], v[40:55]
ds_read_b128 v[12:15], v5 offset:58368
s_add_u32 m0, s54, 61440
s_add_u32 s55, s53, 61440
buffer_load_dwordx4 v0, s[4:7], s55 offen sc1 lds
s_waitcnt lgkmcnt(6)
v_mfma_f32_32x32x16_bf16 v[40:55], a[204:207], v[20:23], v[40:55]
ds_read_b128 v[16:19], v5 offset:59392
s_waitcnt lgkmcnt(6)
v_mfma_f32_32x32x16_bf16 v[40:55], a[208:211], v[24:27], v[40:55]
ds_read_b128 v[20:23], v5 offset:60416
s_waitcnt lgkmcnt(6)
v_mfma_f32_32x32x16_bf16 v[40:55], a[212:215], v[28:31], v[40:55]
ds_read_b128 v[24:27], v5 offset:61440
s_waitcnt lgkmcnt(6)
v_mfma_f32_32x32x16_bf16 v[40:55], a[216:219], v[32:35], v[40:55]
ds_read_b128 v[28:31], v5 offset:62464
s_waitcnt lgkmcnt(6)
v_mfma_f32_32x32x16_bf16 v[40:55], a[220:223], v[36:39], v[40:55]
ds_read_b128 v[32:35], v5 offset:63488
s_waitcnt lgkmcnt(6)
v_mfma_f32_32x32x16_bf16 v[40:55], a[224:227], v[8:11], v[40:55]
ds_read_b128 v[36:39], v5 offset:64512
s_waitcnt lgkmcnt(6)
v_mfma_f32_32x32x16_bf16 v[40:55], a[228:231], v[12:15], v[40:55]
s_waitcnt lgkmcnt(5)
v_mfma_f32_32x32x16_bf16 v[40:55], a[232:235], v[16:19], v[40:55]
s_waitcnt lgkmcnt(4)
v_mfma_f32_32x32x16_bf16 v[40:55], a[236:239], v[20:23], v[40:55]
s_waitcnt lgkmcnt(3)
v_mfma_f32_32x32x16_bf16 v[40:55], a[240:243], v[24:27], v[40:55]
s_waitcnt lgkmcnt(2)
v_mfma_f32_32x32x16_bf16 v[40:55], a[244:247], v[28:31], v[40:55]
s_waitcnt lgkmcnt(1)
v_mfma_f32_32x32x16_bf16 v[40:55], a[248:251], v[32:35], v[40:55]
s_waitcnt lgkmcnt(0)
v_mfma_f32_32x32x16_bf16 v[40:55], a[252:255], v[36:39], v[40:55]
s_mov_b32 s64, s57
s_add_u32 s50, s46, 1
s_add_u32 s57, s57, s58
v_mov_b32 v4, s50
s_add_u32 s46, s46, s48
s_sub_u32 s47, s47, 1
s_waitcnt vmcnt(8)
s_branch Lgwo_top1
Lgwo_late20:
s_waitcnt lgkmcnt(3)
v_mfma_f32_32x32x16_bf16 v[40:55], a[240:243], v[24:27], v[40:55]
s_waitcnt lgkmcnt(2)
v_mfma_f32_32x32x16_bf16 v[40:55], a[244:247], v[28:31], v[40:55]
s_waitcnt lgkmcnt(1)
v_mfma_f32_32x32x16_bf16 v[40:55], a[248:251], v[32:35], v[40:55]
s_waitcnt lgkmcnt(0)
v_mfma_f32_32x32x16_bf16 v[40:55], a[252:255], v[36:39], v[40:55]
s_mov_b32 s64, s57
s_add_u32 s50, s46, 1
s_add_u32 s57, s57, s58
v_mov_b32 v4, s50
s_nop 7
v_cvt_pk_bf16_f32 v56, v40, v41
v_cvt_pk_bf16_f32 v57, v42, v43
v_cvt_pk_bf16_f32 v58, v44, v45
v_cvt_pk_bf16_f32 v59, v46, v47
buffer_store_dwordx4 v[56:59], v0, s[4:7], s64 offen sc1
s_add_u32 s64, s64, 4096
v_cvt_pk_bf16_f32 v60, v48, v49
v_cvt_pk_bf16_f32 v61, v50, v51
v_cvt_pk_bf16_f32 v62, v52, v53
v_cvt_pk_bf16_f32 v63, v54, v55
buffer_store_dwordx4 v[60:63], v0, s[4:7], s64 offen sc1
s_add_u32 s46, s46, s48
s_sub_u32 s47, s47, 1
s_add_u32 m0, s54, 0
s_add_u32 s55, s53, 0
buffer_load_dwordx4 v0, s[4:7], s55 offen sc1 lds
s_add_u32 m0, s54, 4096
s_add_u32 s55, s53, 4096
buffer_load_dwordx4 v0, s[4:7], s55 offen sc1 lds
s_add_u32 m0, s54, 8192
s_add_u32 s55, s53, 8192
buffer_load_dwordx4 v0, s[4:7], s55 offen sc1 lds
s_add_u32 m0, s54, 12288
s_add_u32 s55, s53, 12288
buffer_load_dwordx4 v0, s[4:7], s55 offen sc1 lds
s_add_u32 m0, s54, 16384
s_add_u32 s55, s53, 16384
buffer_load_dwordx4 v0, s[4:7], s55 offen sc1 lds
s_add_u32 m0, s54, 20480
s_add_u32 s55, s53, 20480
buffer_load_dwordx4 v0, s[4:7], s55 offen sc1 lds
s_add_u32 m0, s54, 24576
s_add_u32 s55, s53, 24576
buffer_load_dwordx4 v0, s[4:7], s55 offen sc1 lds
s_add_u32 m0, s54, 28672
s_add_u32 s55, s53, 28672
buffer_load_dwordx4 v0, s[4:7], s55 offen sc1 lds
s_add_u32 m0, s54, 32768
s_add_u32 s55, s53, 32768
buffer_load_dwordx4 v0, s[4:7], s55 offen sc1 lds
s_add_u32 m0, s54, 36864
s_add_u32 s55, s53, 36864
buffer_load_dwordx4 v0, s[4:7], s55 offen sc1 lds
s_add_u32 m0, s54, 40960
s_add_u32 s55, s53, 40960
buffer_load_dwordx4 v0, s[4:7], s55 offen sc1 lds
s_add_u32 m0, s54, 45056
s_add_u32 s55, s53, 45056
buffer_load_dwordx4 v0, s[4:7], s55 offen sc1 lds
s_add_u32 m0, s54, 49152
s_add_u32 s55, s53, 49152
buffer_load_dwordx4 v0, s[4:7], s55 offen sc1 lds
s_add_u32 m0, s54, 53248
s_add_u32 s55, s53, 53248
buffer_load_dwordx4 v0, s[4:7], s55 offen sc1 lds
s_add_u32 m0, s54, 57344
s_add_u32 s55, s53, 57344
buffer_load_dwordx4 v0, s[4:7], s55 offen sc1 lds
s_add_u32 m0, s54, 61440
s_add_u32 s55, s53, 61440
buffer_load_dwordx4 v0, s[4:7], s55 offen sc1 lds
s_lshl_b32 s64, s40, 14
s_lshl_b32 s50, s42, 11
s_add_u32 s64, s64, s50
s_add_u32 s64, s64, 155189248
s_waitcnt vmcnt(16)
s_barrier
s_cmp_lg_u32 s42, 0
s_cbranch_scc1 Lgwo_w_174
s_mov_b64 exec, 1
buffer_store_dword v4, v3, s[4:7], s59 offen sc1
s_mov_b64 exec, -1
Lgwo_w_174:
s_waitcnt vmcnt(8)
s_branch Lgwo_top1
Lgwo_last0:
s_waitcnt lgkmcnt(6)
v_mfma_f32_32x32x16_bf16 v[40:55], a[8:11], v[16:19], v[40:55]
ds_read_b128 v[12:15], v5 offset:9216
v_cvt_pk_bf16_f32 v56, v72, v73
v_cvt_pk_bf16_f32 v57, v74, v75
v_cvt_pk_bf16_f32 v58, v76, v77
v_cvt_pk_bf16_f32 v59, v78, v79
s_waitcnt lgkmcnt(6)
v_mfma_f32_32x32x16_bf16 v[40:55], a[12:15], v[20:23], v[40:55]
ds_read_b128 v[16:19], v5 offset:10240
buffer_store_dwordx4 v[56:59], v0, s[4:7], s64 offen sc1
s_add_u32 s64, s64, 4096
v_cvt_pk_bf16_f32 v60, v80, v81
v_cvt_pk_bf16_f32 v61, v82, v83
s_waitcnt lgkmcnt(6)
v_mfma_f32_32x32x16_bf16 v[40:55], a[16:19], v[24:27], v[40:55]
ds_read_b128 v[20:23], v5 offset:11264
v_cvt_pk_bf16_f32 v62, v84, v85
v_cvt_pk_bf16_f32 v63, v86, v87
buffer_store_dwordx4 v[60:63], v0, s[4:7], s64 offen sc1
s_waitcnt lgkmcnt(6)
v_mfma_f32_32x32x16_bf16 v[40:55], a[20:23], v[28:31], v[40:55]
ds_read_b128 v[24:27], v5 offset:12288
s_waitcnt lgkmcnt(6)
v_mfma_f32_32x32x16_bf16 v[40:55], a[24:27], v[32:35], v[40:55]
ds_read_b128 v[28:31], v5 offset:13312
s_waitcnt lgkmcnt(6)
v_mfma_f32_32x32x16_bf16 v[40:55], a[28:31], v[36:39], v[40:55]
ds_read_b128 v[32:35], v5 offset:14336
s_waitcnt lgkmcnt(6)
v_mfma_f32_32x32x16_bf16 v[40:55], a[32:35], v[8:11], v[40:55]
ds_read_b128 v[36:39], v5 offset:15360
s_waitcnt lgkmcnt(6)
v_mfma_f32_32x32x16_bf16 v[40:55], a[36:39], v[12:15], v[40:55]
ds_read_b128 v[8:11], v5 offset:16384
s_waitcnt lgkmcnt(6)
v_mfma_f32_32x32x16_bf16 v[40:55], a[40:43], v[16:19], v[40:55]
ds_read_b128 v[12:15], v5 offset:17408
s_waitcnt lgkmcnt(6)
v_mfma_f32_32x32x16_bf16 v[40:55], a[44:47], v[20:23], v[40:55]
ds_read_b128 v[16:19], v5 offset:18432
s_waitcnt lgkmcnt(6)
v_mfma_f32_32x32x16_bf16 v[40:55], a[48:51], v[24:27], v[40:55]
ds_read_b128 v[20:23], v5 offset:19456
s_waitcnt lgkmcnt(6)
v_mfma_f32_32x32x16_bf16 v[40:55], a[52:55], v[28:31], v[40:55]
ds_read_b128 v[24:27], v5 offset:20480
s_waitcnt lgkmcnt(6)
v_mfma_f32_32x32x16_bf16 v[40:55], a[56:59], v[32:35], v[40:55]
ds_read_b128 v[28:31], v5 offset:21504
s_waitcnt lgkmcnt(6)
v_mfma_f32_32x32x16_bf16 v[40:55], a[60:63], v[36:39], v[40:55]
ds_read_b128 v[32:35], v5 offset:22528
s_waitcnt lgkmcnt(6)
v_mfma_f32_32x32x16_bf16 v[40:55], a[64:67], v[8:11], v[40:55]
ds_read_b128 v[36:39], v5 offset:23552
s_waitcnt lgkmcnt(6)
v_mfma_f32_32x32x16_bf16 v[40:55], a[68:71], v[12:15], v[40:55]
ds_read_b128 v[8:11], v5 offset:24576
s_waitcnt lgkmcnt(6)
v_mfma_f32_32x32x16_bf16 v[40:55], a[72:75], v[16:19], v[40:55]
ds_read_b128 v[12:15], v5 offset:25600
s_waitcnt lgkmcnt(6)
v_mfma_f32_32x32x16_bf16 v[40:55], a[76:79], v[20:23], v[40:55]
ds_read_b128 v[16:19], v5 offset:26624
s_waitcnt lgkmcnt(6)
v_mfma_f32_32x32x16_bf16 v[40:55], a[80:83], v[24:27], v[40:55]
ds_read_b128 v[20:23], v5 offset:27648
s_waitcnt lgkmcnt(6)
v_mfma_f32_32x32x16_bf16 v[40:55], a[84:87], v[28:31], v[40:55]
ds_read_b128 v[24:27], v5 offset:28672
s_waitcnt lgkmcnt(6)
v_mfma_f32_32x32x16_bf16 v[40:55], a[88:91], v[32:35], v[40:55]
ds_read_b128 v[28:31], v5 offset:29696
s_waitcnt lgkmcnt(6)
v_mfma_f32_32x32x16_bf16 v[40:55], a[92:95], v[36:39], v[40:55]
ds_read_b128 v[32:35], v5 offset:30720
s_waitcnt vmcnt(2) lgkmcnt(2)
s_barrier
s_waitcnt lgkmcnt(6)
v_mfma_f32_32x32x16_bf16 v[40:55], a[96:99], v[8:11], v[40:55]
ds_read_b128 v[36:39], v5 offset:31744
s_waitcnt lgkmcnt(6)
v_mfma_f32_32x32x16_bf16 v[40:55], a[100:103], v[12:15], v[40:55]
ds_read_b128 v[8:11], v5 offset:32768
s_waitcnt lgkmcnt(6)
v_mfma_f32_32x32x16_bf16 v[40:55], a[104:107], v[16:19], v[40:55]
ds_read_b128 v[12:15], v5 offset:33792
s_waitcnt lgkmcnt(6)
v_mfma_f32_32x32x16_bf16 v[40:55], a[108:111], v[20:23], v[40:55]
ds_read_b128 v[16:19], v5 offset:34816
s_waitcnt lgkmcnt(6)
v_mfma_f32_32x32x16_bf16 v[40:55], a[112:115], v[24:27], v[40:55]
ds_read_b128 v[20:23], v5 offset:35840
s_waitcnt lgkmcnt(6)
v_mfma_f32_32x32x16_bf16 v[40:55], a[116:119], v[28:31], v[40:55]
ds_read_b128 v[24:27], v5 offset:36864
s_waitcnt lgkmcnt(6)
v_mfma_f32_32x32x16_bf16 v[40:55], a[120:123], v[32:35], v[40:55]
ds_read_b128 v[28:31], v5 offset:37888
s_waitcnt lgkmcnt(6)
v_mfma_f32_32x32x16_bf16 v[40:55], a[124:127], v[36:39], v[40:55]
ds_read_b128 v[32:35], v5 offset:38912
s_waitcnt lgkmcnt(6)
v_mfma_f32_32x32x16_bf16 v[40:55], a[128:131], v[8:11], v[40:55]
ds_read_b128 v[36:39], v5 offset:39936
s_waitcnt lgkmcnt(6)
v_mfma_f32_32x32x16_bf16 v[40:55], a[132:135], v[12:15], v[40:55]
ds_read_b128 v[8:11], v5 offset:40960
s_waitcnt vmcnt(0)
s_barrier
s_waitcnt lgkmcnt(6)
v_mfma_f32_32x32x16_bf16 v[40:55], a[136:139], v[16:19], v[40:55]
ds_read_b128 v[12:15], v5 offset:41984
s_cmp_lg_u32 s42, 0
s_cbranch_scc1 Lgwo_w_175
s_mov_b64 exec, 1
buffer_store_dword v4, v3, s[4:7], s59 offen sc1
s_mov_b64 exec, -1
Lgwo_w_175:
s_waitcnt lgkmcnt(6)
v_mfma_f32_32x32x16_bf16 v[40:55], a[140:143], v[20:23], v[40:55]
ds_read_b128 v[16:19], v5 offset:43008
s_waitcnt lgkmcnt(6)
v_mfma_f32_32x32x16_bf16 v[40:55], a[144:147], v[24:27], v[40:55]
ds_read_b128 v[20:23], v5 offset:44032
s_waitcnt lgkmcnt(6)
v_mfma_f32_32x32x16_bf16 v[40:55], a[148:151], v[28:31], v[40:55]
ds_read_b128 v[24:27], v5 offset:45056
s_waitcnt lgkmcnt(6)
v_mfma_f32_32x32x16_bf16 v[40:55], a[152:155], v[32:35], v[40:55]
ds_read_b128 v[28:31], v5 offset:46080
s_waitcnt lgkmcnt(6)
v_mfma_f32_32x32x16_bf16 v[40:55], a[156:159], v[36:39], v[40:55]
ds_read_b128 v[32:35], v5 offset:47104
s_waitcnt lgkmcnt(6)
v_mfma_f32_32x32x16_bf16 v[40:55], a[160:163], v[8:11], v[40:55]
ds_read_b128 v[36:39], v5 offset:48128
s_waitcnt lgkmcnt(6)
v_mfma_f32_32x32x16_bf16 v[40:55], a[164:167], v[12:15], v[40:55]
ds_read_b128 v[8:11], v5 offset:49152
s_waitcnt lgkmcnt(6)
v_mfma_f32_32x32x16_bf16 v[40:55], a[168:171], v[16:19], v[40:55]
ds_read_b128 v[12:15], v5 offset:50176
s_waitcnt lgkmcnt(6)
v_mfma_f32_32x32x16_bf16 v[40:55], a[172:175], v[20:23], v[40:55]
ds_read_b128 v[16:19], v5 offset:51200
s_waitcnt lgkmcnt(6)
v_mfma_f32_32x32x16_bf16 v[40:55], a[176:179], v[24:27], v[40:55]
ds_read_b128 v[20:23], v5 offset:52224
s_waitcnt lgkmcnt(6)
v_mfma_f32_32x32x16_bf16 v[40:55], a[180:183], v[28:31], v[40:55]
ds_read_b128 v[24:27], v5 offset:53248
s_waitcnt lgkmcnt(6)
v_mfma_f32_32x32x16_bf16 v[40:55], a[184:187], v[32:35], v[40:55]
ds_read_b128 v[28:31], v5 offset:54272
s_waitcnt lgkmcnt(6)
v_mfma_f32_32x32x16_bf16 v[40:55], a[188:191], v[36:39], v[40:55]
ds_read_b128 v[32:35], v5 offset:55296
s_waitcnt lgkmcnt(6)
v_mfma_f32_32x32x16_bf16 v[40:55], a[192:195], v[8:11], v[40:55]
ds_read_b128 v[36:39], v5 offset:56320
s_waitcnt lgkmcnt(6)
v_mfma_f32_32x32x16_bf16 v[40:55], a[196:199], v[12:15], v[40:55]
ds_read_b128 v[8:11], v5 offset:57344
s_waitcnt lgkmcnt(6)
v_mfma_f32_32x32x16_bf16 v[40:55], a[200:203], v[16:19], v[40:55]
ds_read_b128 v[12:15], v5 offset:58368
s_waitcnt lgkmcnt(6)
v_mfma_f32_32x32x16_bf16 v[40:55], a[204:207], v[20:23], v[40:55]
ds_read_b128 v[16:19], v5 offset:59392
s_waitcnt lgkmcnt(6)
v_mfma_f32_32x32x16_bf16 v[40:55], a[208:211], v[24:27], v[40:55]
ds_read_b128 v[20:23], v5 offset:60416
s_waitcnt lgkmcnt(6)
v_mfma_f32_32x32x16_bf16 v[40:55], a[212:215], v[28:31], v[40:55]
ds_read_b128 v[24:27], v5 offset:61440
s_waitcnt lgkmcnt(6)
v_mfma_f32_32x32x16_bf16 v[40:55], a[216:219], v[32:35], v[40:55]
ds_read_b128 v[28:31], v5 offset:62464
s_waitcnt lgkmcnt(6)
v_mfma_f32_32x32x16_bf16 v[40:55], a[220:223], v[36:39], v[40:55]
ds_read_b128 v[32:35], v5 offset:63488
s_waitcnt lgkmcnt(6)
v_mfma_f32_32x32x16_bf16 v[40:55], a[224:227], v[8:11], v[40:55]
ds_read_b128 v[36:39], v5 offset:64512
s_waitcnt lgkmcnt(6)
v_mfma_f32_32x32x16_bf16 v[40:55], a[228:231], v[12:15], v[40:55]
s_waitcnt lgkmcnt(5)
v_mfma_f32_32x32x16_bf16 v[40:55], a[232:235], v[16:19], v[40:55]
s_waitcnt lgkmcnt(4)
v_mfma_f32_32x32x16_bf16 v[40:55], a[236:239], v[20:23], v[40:55]
s_waitcnt lgkmcnt(3)
v_mfma_f32_32x32x16_bf16 v[40:55], a[240:243], v[24:27], v[40:55]
s_waitcnt lgkmcnt(2)
v_mfma_f32_32x32x16_bf16 v[40:55], a[244:247], v[28:31], v[40:55]
s_waitcnt lgkmcnt(1)
v_mfma_f32_32x32x16_bf16 v[40:55], a[248:251], v[32:35], v[40:55]
s_waitcnt lgkmcnt(0)
v_mfma_f32_32x32x16_bf16 v[40:55], a[252:255], v[36:39], v[40:55]
s_mov_b32 s64, s57
s_add_u32 s50, s46, 1
s_add_u32 s57, s57, s58
v_mov_b32 v4, s50
s_nop 7
v_cvt_pk_bf16_f32 v56, v40, v41
v_cvt_pk_bf16_f32 v57, v42, v43
v_cvt_pk_bf16_f32 v58, v44, v45
v_cvt_pk_bf16_f32 v59, v46, v47
buffer_store_dwordx4 v[56:59], v0, s[4:7], s64 offen sc1
s_add_u32 s64, s64, 4096
v_cvt_pk_bf16_f32 v60, v48, v49
v_cvt_pk_bf16_f32 v61, v50, v51
v_cvt_pk_bf16_f32 v62, v52, v53
v_cvt_pk_bf16_f32 v63, v54, v55
buffer_store_dwordx4 v[60:63], v0, s[4:7], s64 offen sc1
s_waitcnt vmcnt(0)
s_barrier
s_cmp_lg_u32 s42, 0
s_cbranch_scc1 Lgwo_w_176
s_mov_b64 exec, 1
buffer_store_dword v4, v3, s[4:7], s59 offen sc1
s_mov_b64 exec, -1
Lgwo_w_176:
s_branch Lend
Lgwo_top1:
s_cmp_lg_u32 s42, 0
s_cbranch_scc1 Lgwo_w_177
s_mul_i32 s50, s62, s61
s_add_u32 s62, s62, 1
s_cmp_eq_u32 s62, s78
s_cselect_b32 s62, 0, s62
s_mul_i32 s51, s62, s61
s_sub_u32 s51, s51, s50
s_add_u32 s63, s46, 2
v_mad_i32_i24 v68, v88, s51, v1
v_add_u32 v68, s50, v68
v_add_u32 v69, s63, v88
buffer_load_dword v2, v68, s[4:7], s60 offen sc1
Lgwo_w_177:
s_xor_b32 s65, s65, 0x10000
s_add_u32 s49, s49, s56
v_add_u32 v5, s65, v0
s_barrier
ds_read_b128 v[8:11], v5 offset:0
ds_read_b128 v[12:15], v5 offset:1024
ds_read_b32 v70, v71 offset:16
ds_read_b128 v[16:19], v5 offset:2048
s_lshl_b32 s53, s42, 10
s_xor_b32 s54, s65, 0x10000
s_add_u32 s54, s54, s53
s_add_u32 s53, s53, s49
s_waitcnt lgkmcnt(3)
v_mfma_f32_32x32x16_bf16 v[72:87], a[0:3], v[8:11], 0
ds_read_b128 v[20:23], v5 offset:3072
ds_read_b128 v[24:27], v5 offset:4096
ds_read_b128 v[28:31], v5 offset:5120
ds_read_b128 v[32:35], v5 offset:6144
s_waitcnt lgkmcnt(5)
v_mfma_f32_32x32x16_bf16 v[72:87], a[4:7], v[12:15], v[72:87]
ds_read_b128 v[36:39], v5 offset:7168
ds_read_b128 v[8:11], v5 offset:8192
v_readfirstlane_b32 s50, v70
s_cmp_le_u32 s47, 1
s_cbranch_scc1 Lgwo_last1
s_cmp_lg_u32 s50, 0
s_cbranch_scc1 Lgwo_nop1
s_waitcnt lgkmcnt(6)
v_mfma_f32_32x32x16_bf16 v[72:87], a[8:11], v[16:19], v[72:87]
ds_read_b128 v[12:15], v5 offset:9216
s_add_u32 m0, s54, 0
s_add_u32 s55, s53, 0
buffer_load_dwordx4 v0, s[4:7], s55 offen sc1 lds
v_cvt_pk_bf16_f32 v56, v40, v41
s_waitcnt lgkmcnt(6)
v_mfma_f32_32x32x16_bf16 v[72:87], a[12:15], v[20:23], v[72:87]
ds_read_b128 v[16:19], v5 offset:10240
v_cvt_pk_bf16_f32 v57, v42, v43
v_cvt_pk_bf16_f32 v58, v44, v45
v_cvt_pk_bf16_f32 v59, v46, v47
buffer_store_dwordx4 v[56:59], v0, s[4:7], s64 offen sc1
s_waitcnt lgkmcnt(6)
v_mfma_f32_32x32x16_bf16 v[72:87], a[16:19], v[24:27], v[72:87]
ds_read_b128 v[20:23], v5 offset:11264
s_add_u32 m0, s54, 4096
s_add_u32 s55, s53, 4096
buffer_load_dwordx4 v0, s[4:7], s55 offen sc1 lds
s_add_u32 s64, s64, 4096
s_waitcnt lgkmcnt(6)
v_mfma_f32_32x32x16_bf16 v[72:87], a[20:23], v[28:31], v[72:87]
ds_read_b128 v[24:27], v5 offset:12288
v_cvt_pk_bf16_f32 v60, v48, v49
v_cvt_pk_bf16_f32 v61, v50, v51
v_cvt_pk_bf16_f32 v62, v52, v53
v_cvt_pk_bf16_f32 v63, v54, v55
s_waitcnt lgkmcnt(6)
v_mfma_f32_32x32x16_bf16 v[72:87], a[24:27], v[32:35], v[72:87]
ds_read_b128 v[28:31], v5 offset:13312
s_add_u32 m0, s54, 8192
s_add_u32 s55, s53, 8192
buffer_load_dwordx4 v0, s[4:7], s55 offen sc1 lds
buffer_store_dwordx4 v[60:63], v0, s[4:7], s64 offen sc1
s_waitcnt lgkmcnt(6)
v_mfma_f32_32x32x16_bf16 v[72:87], a[28:31], v[36:39], v[72:87]
ds_read_b128 v[32:35], v5 offset:14336
s_waitcnt lgkmcnt(6)
v_mfma_f32_32x32x16_bf16 v[72:87], a[32:35], v[8:11], v[72:87]
ds_read_b128 v[36:39], v5 offset:15360
s_add_u32 m0, s54, 12288
s_add_u32 s55, s53, 12288
buffer_load_dwordx4 v0, s[4:7], s55 offen sc1 lds
s_waitcnt lgkmcnt(6)
v_mfma_f32_32x32x16_bf16 v[72:87], a[36:39], v[12:15], v[72:87]
ds_read_b128 v[8:11], v5 offset:16384
s_waitcnt lgkmcnt(6)
v_mfma_f32_32x32x16_bf16 v[72:87], a[40:43], v[16:19], v[72:87]
ds_read_b128 v[12:15], v5 offset:17408
s_add_u32 m0, s54, 16384
s_add_u32 s55, s53, 16384
buffer_load_dwordx4 v0, s[4:7], s55 offen sc1 lds
s_waitcnt lgkmcnt(6)
v_mfma_f32_32x32x16_bf16 v[72:87], a[44:47], v[20:23], v[72:87]
ds_read_b128 v[16:19], v5 offset:18432
s_waitcnt lgkmcnt(6)
v_mfma_f32_32x32x16_bf16 v[72:87], a[48:51], v[24:27], v[72:87]
ds_read_b128 v[20:23], v5 offset:19456
s_add_u32 m0, s54, 20480
s_add_u32 s55, s53, 20480
buffer_load_dwordx4 v0, s[4:7], s55 offen sc1 lds
s_waitcnt lgkmcnt(6)
v_mfma_f32_32x32x16_bf16 v[72:87], a[52:55], v[28:31], v[72:87]
ds_read_b128 v[24:27], v5 offset:20480
s_waitcnt lgkmcnt(6)
v_mfma_f32_32x32x16_bf16 v[72:87], a[56:59], v[32:35], v[72:87]
ds_read_b128 v[28:31], v5 offset:21504
s_add_u32 m0, s54, 24576
s_add_u32 s55, s53, 24576
buffer_load_dwordx4 v0, s[4:7], s55 offen sc1 lds
s_waitcnt lgkmcnt(6)
v_mfma_f32_32x32x16_bf16 v[72:87], a[60:63], v[36:39], v[72:87]
ds_read_b128 v[32:35], v5 offset:22528
s_waitcnt lgkmcnt(6)
v_mfma_f32_32x32x16_bf16 v[72:87], a[64:67], v[8:11], v[72:87]
ds_read_b128 v[36:39], v5 offset:23552
s_add_u32 m0, s54, 28672
s_add_u32 s55, s53, 28672
buffer_load_dwordx4 v0, s[4:7], s55 offen sc1 lds
s_waitcnt lgkmcnt(6)
v_mfma_f32_32x32x16_bf16 v[72:87], a[68:71], v[12:15], v[72:87]
ds_read_b128 v[8:11], v5 offset:24576
s_waitcnt lgkmcnt(6)
v_mfma_f32_32x32x16_bf16 v[72:87], a[72:75], v[16:19], v[72:87]
ds_read_b128 v[12:15], v5 offset:25600
s_add_u32 m0, s54, 32768
s_add_u32 s55, s53, 32768
buffer_load_dwordx4 v0, s[4:7], s55 offen sc1 lds
s_waitcnt lgkmcnt(6)
v_mfma_f32_32x32x16_bf16 v[72:87], a[76:79], v[20:23], v[72:87]
ds_read_b128 v[16:19], v5 offset:26624
s_waitcnt lgkmcnt(6)
v_mfma_f32_32x32x16_bf16 v[72:87], a[80:83], v[24:27], v[72:87]
ds_read_b128 v[20:23], v5 offset:27648
s_add_u32 m0, s54, 36864
s_add_u32 s55, s53, 36864
buffer_load_dwordx4 v0, s[4:7], s55 offen sc1 lds
s_waitcnt lgkmcnt(6)
v_mfma_f32_32x32x16_bf16 v[72:87], a[84:87], v[28:31], v[72:87]
ds_read_b128 v[24:27], v5 offset:28672
s_cmp_lg_u32 s42, 0
s_cbranch_scc1 Lgwo_w_178
s_waitcnt vmcnt(12)
v_cmp_gt_i32 vcc, v69, v2
s_nop 1
v_mov_b32 v70, vcc_hi
v_mov_b32 v2, vcc_lo
ds_write2_b32 v71, v70, v2 offset0:0 offset1:1
Lgwo_w_178:
s_waitcnt lgkmcnt(6)
v_mfma_f32_32x32x16_bf16 v[72:87], a[88:91], v[32:35], v[72:87]
ds_read_b128 v[28:31], v5 offset:29696
s_add_u32 m0, s54, 40960
s_add_u32 s55, s53, 40960
buffer_load_dwordx4 v0, s[4:7], s55 offen sc1 lds
s_waitcnt lgkmcnt(6)
v_mfma_f32_32x32x16_bf16 v[72:87], a[92:95], v[36:39], v[72:87]
ds_read_b128 v[32:35], v5 offset:30720
s_waitcnt vmcnt(13) lgkmcnt(2)
s_barrier
s_waitcnt lgkmcnt(6)
v_mfma_f32_32x32x16_bf16 v[72:87], a[96:99], v[8:11], v[72:87]
ds_read_b128 v[36:39], v5 offset:31744
s_add_u32 m0, s54, 45056
s_add_u32 s55, s53, 45056
buffer_load_dwordx4 v0, s[4:7], s55 offen sc1 lds
s_waitcnt lgkmcnt(6)
v_mfma_f32_32x32x16_bf16 v[72:87], a[100:103], v[12:15], v[72:87]
ds_read_b128 v[8:11], v5 offset:32768
s_waitcnt lgkmcnt(6)
v_mfma_f32_32x32x16_bf16 v[72:87], a[104:107], v[16:19], v[72:87]
ds_read_b128 v[12:15], v5 offset:33792
s_add_u32 m0, s54, 49152
s_add_u32 s55, s53, 49152
buffer_load_dwordx4 v0, s[4:7], s55 offen sc1 lds
s_waitcnt lgkmcnt(6)
v_mfma_f32_32x32x16_bf16 v[72:87], a[108:111], v[20:23], v[72:87]
ds_read_b128 v[16:19], v5 offset:34816
s_waitcnt lgkmcnt(6)
v_mfma_f32_32x32x16_bf16 v[72:87], a[112:115], v[24:27], v[72:87]
ds_read_b128 v[20:23], v5 offset:35840
s_add_u32 m0, s54, 53248
s_add_u32 s55, s53, 53248
buffer_load_dwordx4 v0, s[4:7], s55 offen sc1 lds
s_waitcnt lgkmcnt(6)
v_mfma_f32_32x32x16_bf16 v[72:87], a[116:119], v[28:31], v[72:87]
ds_read_b128 v[24:27], v5 offset:36864
s_waitcnt lgkmcnt(6)
v_mfma_f32_32x32x16_bf16 v[72:87], a[120:123], v[32:35], v[72:87]
ds_read_b128 v[28:31], v5 offset:37888
s_add_u32 m0, s54, 57344
s_add_u32 s55, s53, 57344
buffer_load_dwordx4 v0, s[4:7], s55 offen sc1 lds
s_waitcnt lgkmcnt(6)
v_mfma_f32_32x32x16_bf16 v[72:87], a[124:127], v[36:39], v[72:87]
ds_read_b128 v[32:35], v5 offset:38912
s_waitcnt lgkmcnt(6)
v_mfma_f32_32x32x16_bf16 v[72:87], a[128:131], v[8:11], v[72:87]
ds_read_b128 v[36:39], v5 offset:39936
s_add_u32 m0, s54, 61440
s_add_u32 s55, s53, 61440
buffer_load_dwordx4 v0, s[4:7], s55 offen sc1 lds
s_waitcnt lgkmcnt(6)
v_mfma_f32_32x32x16_bf16 v[72:87], a[132:135], v[12:15], v[72:87]
ds_read_b128 v[8:11], v5 offset:40960
s_waitcnt vmcnt(13)
s_barrier
s_waitcnt lgkmcnt(6)
v_mfma_f32_32x32x16_bf16 v[72:87], a[136:139], v[16:19], v[72:87]
ds_read_b128 v[12:15], v5 offset:41984
s_cmp_lg_u32 s42, 0
s_cbranch_scc1 Lgwo_w_179
s_mov_b64 exec, 1
buffer_store_dword v4, v3, s[4:7], s59 offen sc1
s_mov_b64 exec, -1
Lgwo_w_179:
s_waitcnt lgkmcnt(6)
v_mfma_f32_32x32x16_bf16 v[72:87], a[140:143], v[20:23], v[72:87]
ds_read_b128 v[16:19], v5 offset:43008
s_waitcnt lgkmcnt(6)
v_mfma_f32_32x32x16_bf16 v[72:87], a[144:147], v[24:27], v[72:87]
ds_read_b128 v[20:23], v5 offset:44032
s_waitcnt lgkmcnt(6)
v_mfma_f32_32x32x16_bf16 v[72:87], a[148:151], v[28:31], v[72:87]
ds_read_b128 v[24:27], v5 offset:45056
s_waitcnt lgkmcnt(6)
v_mfma_f32_32x32x16_bf16 v[72:87], a[152:155], v[32:35], v[72:87]
ds_read_b128 v[28:31], v5 offset:46080
s_waitcnt lgkmcnt(6)
v_mfma_f32_32x32x16_bf16 v[72:87], a[156:159], v[36:39], v[72:87]
ds_read_b128 v[32:35], v5 offset:47104
s_waitcnt lgkmcnt(6)
v_mfma_f32_32x32x16_bf16 v[72:87], a[160:163], v[8:11], v[72:87]
ds_read_b128 v[36:39], v5 offset:48128
s_waitcnt lgkmcnt(6)
v_mfma_f32_32x32x16_bf16 v[72:87], a[164:167], v[12:15], v[72:87]
ds_read_b128 v[8:11], v5 offset:49152
s_waitcnt lgkmcnt(6)
v_mfma_f32_32x32x16_bf16 v[72:87], a[168:171], v[16:19], v[72:87]
ds_read_b128 v[12:15], v5 offset:50176
s_waitcnt lgkmcnt(6)
v_mfma_f32_32x32x16_bf16 v[72:87], a[172:175], v[20:23], v[72:87]
ds_read_b128 v[16:19], v5 offset:51200
s_waitcnt lgkmcnt(6)
v_mfma_f32_32x32x16_bf16 v[72:87], a[176:179], v[24:27], v[72:87]
ds_read_b128 v[20:23], v5 offset:52224
s_waitcnt lgkmcnt(6)
v_mfma_f32_32x32x16_bf16 v[72:87], a[180:183], v[28:31], v[72:87]
ds_read_b128 v[24:27], v5 offset:53248
s_waitcnt lgkmcnt(6)
v_mfma_f32_32x32x16_bf16 v[72:87], a[184:187], v[32:35], v[72:87]
ds_read_b128 v[28:31], v5 offset:54272
s_waitcnt lgkmcnt(6)
v_mfma_f32_32x32x16_bf16 v[72:87], a[188:191], v[36:39], v[72:87]
ds_read_b128 v[32:35], v5 offset:55296
s_waitcnt lgkmcnt(6)
v_mfma_f32_32x32x16_bf16 v[72:87], a[192:195], v[8:11], v[72:87]
ds_read_b128 v[36:39], v5 offset:56320
s_waitcnt lgkmcnt(6)
v_mfma_f32_32x32x16_bf16 v[72:87], a[196:199], v[12:15], v[72:87]
ds_read_b128 v[8:11], v5 offset:57344
s_waitcnt lgkmcnt(6)
v_mfma_f32_32x32x16_bf16 v[72:87], a[200:203], v[16:19], v[72:87]
ds_read_b128 v[12:15], v5 offset:58368
s_waitcnt lgkmcnt(6)
v_mfma_f32_32x32x16_bf16 v[72:87], a[204:207], v[20:23], v[72:87]
ds_read_b128 v[16:19], v5 offset:59392
s_waitcnt lgkmcnt(6)
v_mfma_f32_32x32x16_bf16 v[72:87], a[208:211], v[24:27], v[72:87]
ds_read_b128 v[20:23], v5 offset:60416
s_waitcnt lgkmcnt(6)
v_mfma_f32_32x32x16_bf16 v[72:87], a[212:215], v[28:31], v[72:87]
ds_read_b128 v[24:27], v5 offset:61440
s_waitcnt lgkmcnt(6)
v_mfma_f32_32x32x16_bf16 v[72:87], a[216:219], v[32:35], v[72:87]
ds_read_b128 v[28:31], v5 offset:62464
s_waitcnt lgkmcnt(6)
v_mfma_f32_32x32x16_bf16 v[72:87], a[220:223], v[36:39], v[72:87]
ds_read_b128 v[32:35], v5 offset:63488
s_waitcnt lgkmcnt(6)
v_mfma_f32_32x32x16_bf16 v[72:87], a[224:227], v[8:11], v[72:87]
ds_read_b128 v[36:39], v5 offset:64512
s_waitcnt lgkmcnt(6)
v_mfma_f32_32x32x16_bf16 v[72:87], a[228:231], v[12:15], v[72:87]
s_waitcnt lgkmcnt(5)
v_mfma_f32_32x32x16_bf16 v[72:87], a[232:235], v[16:19], v[72:87]
s_waitcnt lgkmcnt(4)
v_mfma_f32_32x32x16_bf16 v[72:87], a[236:239], v[20:23], v[72:87]
s_waitcnt lgkmcnt(3)
v_mfma_f32_32x32x16_bf16 v[72:87], a[240:243], v[24:27], v[72:87]
s_waitcnt lgkmcnt(2)
v_mfma_f32_32x32x16_bf16 v[72:87], a[244:247], v[28:31], v[72:87]
s_waitcnt lgkmcnt(1)
v_mfma_f32_32x32x16_bf16 v[72:87], a[248:251], v[32:35], v[72:87]
s_waitcnt lgkmcnt(0)
v_mfma_f32_32x32x16_bf16 v[72:87], a[252:255], v[36:39], v[72:87]
s_mov_b32 s64, s57
s_add_u32 s50, s46, 1
s_add_u32 s57, s57, s58
v_mov_b32 v4, s50
s_add_u32 s46, s46, s48
s_sub_u32 s47, s47, 1
s_waitcnt vmcnt(8)
s_branch Lgwo_top0
Lgwo_nop1:
s_waitcnt lgkmcnt(6)
v_mfma_f32_32x32x16_bf16 v[72:87], a[8:11], v[16:19], v[72:87]
ds_read_b128 v[12:15], v5 offset:9216
v_cvt_pk_bf16_f32 v56, v40, v41
v_cvt_pk_bf16_f32 v57, v42, v43
v_cvt_pk_bf16_f32 v58, v44, v45
v_cvt_pk_bf16_f32 v59, v46, v47
s_waitcnt lgkmcnt(6)
v_mfma_f32_32x32x16_bf16 v[72:87], a[12:15], v[20:23], v[72:87]
ds_read_b128 v[16:19], v5 offset:10240
buffer_store_dwordx4 v[56:59], v0, s[4:7], s64 offen sc1
s_add_u32 s64, s64, 4096
v_cvt_pk_bf16_f32 v60, v48, v49
v_cvt_pk_bf16_f32 v61, v50, v51
s_waitcnt lgkmcnt(6)
v_mfma_f32_32x32x16_bf16 v[72:87], a[16:19], v[24:27], v[72:87]
ds_read_b128 v[20:23], v5 offset:11264
v_cvt_pk_bf16_f32 v62, v52, v53
v_cvt_pk_bf16_f32 v63, v54, v55
buffer_store_dwordx4 v[60:63], v0, s[4:7], s64 offen sc1
s_waitcnt lgkmcnt(6)
v_mfma_f32_32x32x16_bf16 v[72:87], a[20:23], v[28:31], v[72:87]
ds_read_b128 v[24:27], v5 offset:12288
s_waitcnt lgkmcnt(6)
v_mfma_f32_32x32x16_bf16 v[72:87], a[24:27], v[32:35], v[72:87]
ds_read_b128 v[28:31], v5 offset:13312
s_waitcnt lgkmcnt(6)
v_mfma_f32_32x32x16_bf16 v[72:87], a[28:31], v[36:39], v[72:87]
ds_read_b128 v[32:35], v5 offset:14336
s_waitcnt lgkmcnt(6)
v_mfma_f32_32x32x16_bf16 v[72:87], a[32:35], v[8:11], v[72:87]
ds_read_b128 v[36:39], v5 offset:15360
s_waitcnt lgkmcnt(6)
v_mfma_f32_32x32x16_bf16 v[72:87], a[36:39], v[12:15], v[72:87]
ds_read_b128 v[8:11], v5 offset:16384
s_waitcnt lgkmcnt(6)
v_mfma_f32_32x32x16_bf16 v[72:87], a[40:43], v[16:19], v[72:87]
ds_read_b128 v[12:15], v5 offset:17408
s_waitcnt lgkmcnt(6)
v_mfma_f32_32x32x16_bf16 v[72:87], a[44:47], v[20:23], v[72:87]
ds_read_b128 v[16:19], v5 offset:18432
s_waitcnt lgkmcnt(6)
v_mfma_f32_32x32x16_bf16 v[72:87], a[48:51], v[24:27], v[72:87]
ds_read_b128 v[20:23], v5 offset:19456
s_waitcnt lgkmcnt(6)
v_mfma_f32_32x32x16_bf16 v[72:87], a[52:55], v[28:31], v[72:87]
ds_read_b128 v[24:27], v5 offset:20480
s_waitcnt lgkmcnt(6)
v_mfma_f32_32x32x16_bf16 v[72:87], a[56:59], v[32:35], v[72:87]
ds_read_b128 v[28:31], v5 offset:21504
s_waitcnt lgkmcnt(6)
v_mfma_f32_32x32x16_bf16 v[72:87], a[60:63], v[36:39], v[72:87]
ds_read_b128 v[32:35], v5 offset:22528
s_waitcnt lgkmcnt(6)
v_mfma_f32_32x32x16_bf16 v[72:87], a[64:67], v[8:11], v[72:87]
ds_read_b128 v[36:39], v5 offset:23552
s_waitcnt lgkmcnt(6)
v_mfma_f32_32x32x16_bf16 v[72:87], a[68:71], v[12:15], v[72:87]
ds_read_b128 v[8:11], v5 offset:24576
s_waitcnt lgkmcnt(6)
v_mfma_f32_32x32x16_bf16 v[72:87], a[72:75], v[16:19], v[72:87]
ds_read_b128 v[12:15], v5 offset:25600
s_waitcnt lgkmcnt(6)
v_mfma_f32_32x32x16_bf16 v[72:87], a[76:79], v[20:23], v[72:87]
ds_read_b128 v[16:19], v5 offset:26624
s_waitcnt lgkmcnt(6)
v_mfma_f32_32x32x16_bf16 v[72:87], a[80:83], v[24:27], v[72:87]
ds_read_b128 v[20:23], v5 offset:27648
s_waitcnt lgkmcnt(6)
v_mfma_f32_32x32x16_bf16 v[72:87], a[84:87], v[28:31], v[72:87]
ds_read_b128 v[24:27], v5 offset:28672
s_cmp_lg_u32 s42, 0
s_cbranch_scc1 Lgwo_w_180
s_waitcnt vmcnt(2)
v_cmp_gt_i32 vcc, v69, v2
s_nop 1
v_mov_b32 v70, vcc_hi
v_mov_b32 v2, vcc_lo
ds_write2_b32 v71, v70, v2 offset0:0 offset1:1
Lgwo_w_180:
s_waitcnt lgkmcnt(6)
v_mfma_f32_32x32x16_bf16 v[72:87], a[88:91], v[32:35], v[72:87]
ds_read_b128 v[28:31], v5 offset:29696
s_waitcnt lgkmcnt(6)
v_mfma_f32_32x32x16_bf16 v[72:87], a[92:95], v[36:39], v[72:87]
ds_read_b128 v[32:35], v5 offset:30720
s_waitcnt vmcnt(2) lgkmcnt(2)
s_barrier
ds_read_b32 v70, v71 offset:4
s_waitcnt lgkmcnt(6)
v_mfma_f32_32x32x16_bf16 v[72:87], a[96:99], v[8:11], v[72:87]
ds_read_b128 v[36:39], v5 offset:31744
s_waitcnt lgkmcnt(6)
v_mfma_f32_32x32x16_bf16 v[72:87], a[100:103], v[12:15], v[72:87]
ds_read_b128 v[8:11], v5 offset:32768
s_waitcnt lgkmcnt(2)
v_readfirstlane_b32 s50, v70
s_nop 0
s_cmp_eq_u32 s50, 0
s_cbranch_scc1 Lgwo_late1
s_waitcnt lgkmcnt(6)
v_mfma_f32_32x32x16_bf16 v[72:87], a[104:107], v[16:19], v[72:87]
ds_read_b128 v[12:15], v5 offset:33792
s_cmp_lg_u32 s42, 0
s_cbranch_scc1 Lgwo_w_181
buffer_load_dword v2, v68, s[4:7], s60 offen sc1
Lgwo_w_181:
s_waitcnt lgkmcnt(6)
v_mfma_f32_32x32x16_bf16 v[72:87], a[108:111], v[20:23], v[72:87]
ds_read_b128 v[16:19], v5 offset:34816
s_waitcnt lgkmcnt(6)
v_mfma_f32_32x32x16_bf16 v[72:87], a[112:115], v[24:27], v[72:87]
ds_read_b128 v[20:23], v5 offset:35840
s_waitcnt lgkmcnt(6)
v_mfma_f32_32x32x16_bf16 v[72:87], a[116:119], v[28:31], v[72:87]
ds_read_b128 v[24:27], v5 offset:36864
s_waitcnt lgkmcnt(6)
v_mfma_f32_32x32x16_bf16 v[72:87], a[120:123], v[32:35], v[72:87]
ds_read_b128 v[28:31], v5 offset:37888
s_waitcnt lgkmcnt(6)
v_mfma_f32_32x32x16_bf16 v[72:87], a[124:127], v[36:39], v[72:87]
ds_read_b128 v[32:35], v5 offset:38912
s_waitcnt lgkmcnt(6)
v_mfma_f32_32x32x16_bf16 v[72:87], a[128:131], v[8:11], v[72:87]
ds_read_b128 v[36:39], v5 offset:39936
s_waitcnt lgkmcnt(6)
v_mfma_f32_32x32x16_bf16 v[72:87], a[132:135], v[12:15], v[72:87]
ds_read_b128 v[8:11], v5 offset:40960
s_cmp_eq_u32 s42, 0
s_cbranch_scc1 Lgwo_z_182
s_waitcnt vmcnt(0)
Lgwo_z_182:
s_waitcnt vmcnt(1)
s_barrier
s_waitcnt lgkmcnt(6)
v_mfma_f32_32x32x16_bf16 v[72:87], a[136:139], v[16:19], v[72:87]
ds_read_b128 v[12:15], v5 offset:41984
s_cmp_lg_u32 s42, 0
s_cbranch_scc1 Lgwo_w_183
s_mov_b64 exec, 1
buffer_store_dword v4, v3, s[4:7], s59 offen sc1
s_mov_b64 exec, -1
Lgwo_w_183:
s_waitcnt lgkmcnt(6)
v_mfma_f32_32x32x16_bf16 v[72:87], a[140:143], v[20:23], v[72:87]
ds_read_b128 v[16:19], v5 offset:43008
s_waitcnt lgkmcnt(6)
v_mfma_f32_32x32x16_bf16 v[72:87], a[144:147], v[24:27], v[72:87]
ds_read_b128 v[20:23], v5 offset:44032
s_waitcnt lgkmcnt(6)
v_mfma_f32_32x32x16_bf16 v[72:87], a[148:151], v[28:31], v[72:87]
ds_read_b128 v[24:27], v5 offset:45056
s_waitcnt lgkmcnt(6)
v_mfma_f32_32x32x16_bf16 v[72:87], a[152:155], v[32:35], v[72:87]
ds_read_b128 v[28:31], v5 offset:46080
s_waitcnt lgkmcnt(6)
v_mfma_f32_32x32x16_bf16 v[72:87], a[156:159], v[36:39], v[72:87]
ds_read_b128 v[32:35], v5 offset:47104
s_waitcnt lgkmcnt(6)
v_mfma_f32_32x32x16_bf16 v[72:87], a[160:163], v[8:11], v[72:87]
ds_read_b128 v[36:39], v5 offset:48128
s_waitcnt lgkmcnt(6)
v_mfma_f32_32x32x16_bf16 v[72:87], a[164:167], v[12:15], v[72:87]
ds_read_b128 v[8:11], v5 offset:49152
s_waitcnt lgkmcnt(6)
v_mfma_f32_32x32x16_bf16 v[72:87], a[168:171], v[16:19], v[72:87]
ds_read_b128 v[12:15], v5 offset:50176
s_waitcnt lgkmcnt(6)
v_mfma_f32_32x32x16_bf16 v[72:87], a[172:175], v[20:23], v[72:87]
ds_read_b128 v[16:19], v5 offset:51200
s_waitcnt lgkmcnt(6)
v_mfma_f32_32x32x16_bf16 v[72:87], a[176:179], v[24:27], v[72:87]
ds_read_b128 v[20:23], v5 offset:52224
s_waitcnt lgkmcnt(6)
v_mfma_f32_32x32x16_bf16 v[72:87], a[180:183], v[28:31], v[72:87]
ds_read_b128 v[24:27], v5 offset:53248
s_waitcnt lgkmcnt(6)
v_mfma_f32_32x32x16_bf16 v[72:87], a[184:187], v[32:35], v[72:87]
ds_read_b128 v[28:31], v5 offset:54272
s_waitcnt lgkmcnt(6)
v_mfma_f32_32x32x16_bf16 v[72:87], a[188:191], v[36:39], v[72:87]
ds_read_b128 v[32:35], v5 offset:55296
s_waitcnt lgkmcnt(6)
v_mfma_f32_32x32x16_bf16 v[72:87], a[192:195], v[8:11], v[72:87]
ds_read_b128 v[36:39], v5 offset:56320
s_waitcnt lgkmcnt(6)
v_mfma_f32_32x32x16_bf16 v[72:87], a[196:199], v[12:15], v[72:87]
ds_read_b128 v[8:11], v5 offset:57344
s_waitcnt lgkmcnt(6)
v_mfma_f32_32x32x16_bf16 v[72:87], a[200:203], v[16:19], v[72:87]
ds_read_b128 v[12:15], v5 offset:58368
s_waitcnt lgkmcnt(6)
v_mfma_f32_32x32x16_bf16 v[72:87], a[204:207], v[20:23], v[72:87]
ds_read_b128 v[16:19], v5 offset:59392
s_waitcnt lgkmcnt(6)
v_mfma_f32_32x32x16_bf16 v[72:87], a[208:211], v[24:27], v[72:87]
ds_read_b128 v[20:23], v5 offset:60416
s_waitcnt lgkmcnt(6)
v_mfma_f32_32x32x16_bf16 v[72:87], a[212:215], v[28:31], v[72:87]
ds_read_b128 v[24:27], v5 offset:61440
s_waitcnt lgkmcnt(6)
v_mfma_f32_32x32x16_bf16 v[72:87], a[216:219], v[32:35], v[72:87]
ds_read_b128 v[28:31], v5 offset:62464
s_waitcnt lgkmcnt(6)
v_mfma_f32_32x32x16_bf16 v[72:87], a[220:223], v[36:39], v[72:87]
ds_read_b128 v[32:35], v5 offset:63488
s_cmp_lg_u32 s42, 0
s_cbranch_scc1 Lgwo_w_184
s_waitcnt vmcnt(1)
v_cmp_gt_i32 vcc, v69, v2
s_nop 1
v_mov_b32 v70, vcc_hi
v_mov_b32 v2, vcc_lo
ds_write2_b32 v71, v70, v2 offset0:0 offset1:2
Lgwo_w_184:
s_waitcnt lgkmcnt(6)
v_mfma_f32_32x32x16_bf16 v[72:87], a[224:227], v[8:11], v[72:87]
ds_read_b128 v[36:39], v5 offset:64512
s_waitcnt lgkmcnt(6)
v_mfma_f32_32x32x16_bf16 v[72:87], a[228:231], v[12:15], v[72:87]
s_waitcnt lgkmcnt(0)
s_barrier
ds_read_b32 v70, v71 offset:8
s_waitcnt lgkmcnt(5)
v_mfma_f32_32x32x16_bf16 v[72:87], a[232:235], v[16:19], v[72:87]
s_waitcnt lgkmcnt(4)
v_mfma_f32_32x32x16_bf16 v[72:87], a[236:239], v[20:23], v[72:87]
s_waitcnt lgkmcnt(0)
v_readfirstlane_b32 s50, v70
s_nop 0
s_cmp_eq_u32 s50, 0
s_cbranch_scc1 Lgwo_late21
s_waitcnt lgkmcnt(3)
v_mfma_f32_32x32x16_bf16 v[72:87], a[240:243], v[24:27], v[72:87]
s_waitcnt lgkmcnt(2)
v_mfma_f32_32x32x16_bf16 v[72:87], a[244:247], v[28:31], v[72:87]
s_waitcnt lgkmcnt(1)
v_mfma_f32_32x32x16_bf16 v[72:87], a[248:251], v[32:35], v[72:87]
s_waitcnt lgkmcnt(0)
v_mfma_f32_32x32x16_bf16 v[72:87], a[252:255], v[36:39], v[72:87]
s_mov_b32 s64, s57
s_add_u32 s50, s46, 1
s_add_u32 s57, s57, s58
v_mov_b32 v4, s50
s_nop 7
v_cvt_pk_bf16_f32 v56, v72, v73
v_cvt_pk_bf16_f32 v57, v74, v75
v_cvt_pk_bf16_f32 v58, v76, v77
v_cvt_pk_bf16_f32 v59, v78, v79
buffer_store_dwordx4 v[56:59], v0, s[4:7], s64 offen sc1
s_add_u32 s64, s64, 4096
v_cvt_pk_bf16_f32 v60, v80, v81
v_cvt_pk_bf16_f32 v61, v82, v83
v_cvt_pk_bf16_f32 v62, v84, v85
v_cvt_pk_bf16_f32 v63, v86, v87
buffer_store_dwordx4 v[60:63], v0, s[4:7], s64 offen sc1
s_cmp_lg_u32 s42, 0
s_cbranch_scc1 Lgwo_w_185
buffer_load_dword v2, v68, s[4:7], s60 offen sc1
s_waitcnt vmcnt(0)
v_cmp_gt_i32 vcc, v69, v2
s_nop 1
v_mov_b32 v70, vcc_hi
v_mov_b32 v2, vcc_lo
ds_write2_b32 v71, v70, v2 offset1:1
s_waitcnt lgkmcnt(0)
Lgwo_w_185:
s_add_u32 s46, s46, s48
s_sub_u32 s47, s47, 1
s_waitcnt vmcnt(0)
s_barrier
ds_read_b32 v70, v71 offset:4
s_cmp_lg_u32 s42, 0
s_cbranch_scc1 Lgwo_w_186
s_mov_b64 exec, 1
buffer_store_dword v4, v3, s[4:7], s59 offen sc1
s_mov_b64 exec, -1
Lgwo_w_186:
s_waitcnt lgkmcnt(0)
v_readfirstlane_b32 s50, v70
s_nop 0
s_cmp_eq_u32 s50, 0
s_cbranch_scc1 Lgwo_fetch
s_branch Lgwo_cold
Lgwo_late1:
s_waitcnt lgkmcnt(6)
v_mfma_f32_32x32x16_bf16 v[72:87], a[104:107], v[16:19], v[72:87]
ds_read_b128 v[12:15], v5 offset:33792
s_add_u32 m0, s54, 0
s_add_u32 s55, s53, 0
buffer_load_dwordx4 v0, s[4:7], s55 offen sc1 lds
s_waitcnt lgkmcnt(6)
v_mfma_f32_32x32x16_bf16 v[72:87], a[108:111], v[20:23], v[72:87]
ds_read_b128 v[16:19], v5 offset:34816
s_add_u32 m0, s54, 4096
s_add_u32 s55, s53, 4096
buffer_load_dwordx4 v0, s[4:7], s55 offen sc1 lds
s_waitcnt lgkmcnt(6)
v_mfma_f32_32x32x16_bf16 v[72:87], a[112:115], v[24:27], v[72:87]
ds_read_b128 v[20:23], v5 offset:35840
s_add_u32 m0, s54, 8192
s_add_u32 s55, s53, 8192
buffer_load_dwordx4 v0, s[4:7], s55 offen sc1 lds
s_waitcnt lgkmcnt(6)
v_mfma_f32_32x32x16_bf16 v[72:87], a[116:119], v[28:31], v[72:87]
ds_read_b128 v[24:27], v5 offset:36864
s_add_u32 m0, s54, 12288
s_add_u32 s55, s53, 12288
buffer_load_dwordx4 v0, s[4:7], s55 offen sc1 lds
s_waitcnt lgkmcnt(6)
v_mfma_f32_32x32x16_bf16 v[72:87], a[120:123], v[32:35], v[72:87]
ds_read_b128 v[28:31], v5 offset:37888
s_add_u32 m0, s54, 16384
s_add_u32 s55, s53, 16384
buffer_load_dwordx4 v0, s[4:7], s55 offen sc1 lds
s_waitcnt lgkmcnt(6)
v_mfma_f32_32x32x16_bf16 v[72:87], a[124:127], v[36:39], v[72:87]
ds_read_b128 v[32:35], v5 offset:38912
s_add_u32 m0, s54, 20480
s_add_u32 s55, s53, 20480
buffer_load_dwordx4 v0, s[4:7], s55 offen sc1 lds
s_waitcnt lgkmcnt(6)
v_mfma_f32_32x32x16_bf16 v[72:87], a[128:131], v[8:11], v[72:87]
ds_read_b128 v[36:39], v5 offset:39936
s_add_u32 m0, s54, 24576
s_add_u32 s55, s53, 24576
buffer_load_dwordx4 v0, s[4:7], s55 offen sc1 lds
s_waitcnt lgkmcnt(6)
v_mfma_f32_32x32x16_bf16 v[72:87], a[132:135], v[12:15], v[72:87]
ds_read_b128 v[8:11], v5 offset:40960
s_add_u32 m0, s54, 28672
s_add_u32 s55, s53, 28672
buffer_load_dwordx4 v0, s[4:7], s55 offen sc1 lds
s_waitcnt vmcnt(8)
s_barrier
s_waitcnt lgkmcnt(6)
v_mfma_f32_32x32x16_bf16 v[72:87], a[136:139], v[16:19], v[72:87]
ds_read_b128 v[12:15], v5 offset:41984
s_cmp_lg_u32 s42, 0
s_cbranch_scc1 Lgwo_w_187
s_mov_b64 exec, 1
buffer_store_dword v4, v3, s[4:7], s59 offen sc1
s_mov_b64 exec, -1
Lgwo_w_187:
s_waitcnt lgkmcnt(6)
v_mfma_f32_32x32x16_bf16 v[72:87], a[140:143], v[20:23], v[72:87]
ds_read_b128 v[16:19], v5 offset:43008
s_waitcnt lgkmcnt(6)
v_mfma_f32_32x32x16_bf16 v[72:87], a[144:147], v[24:27], v[72:87]
ds_read_b128 v[20:23], v5 offset:44032
s_add_u32 m0, s54, 32768
s_add_u32 s55, s53, 32768
buffer_load_dwordx4 v0, s[4:7], s55 offen sc1 lds
s_waitcnt lgkmcnt(6)
v_mfma_f32_32x32x16_bf16 v[72:87], a[148:151], v[28:31], v[72:87]
ds_read_b128 v[24:27], v5 offset:45056
s_waitcnt lgkmcnt(6)
v_mfma_f32_32x32x16_bf16 v[72:87], a[152:155], v[32:35], v[72:87]
ds_read_b128 v[28:31], v5 offset:46080
s_add_u32 m0, s54, 36864
s_add_u32 s55, s53, 36864
buffer_load_dwordx4 v0, s[4:7], s55 offen sc1 lds
s_waitcnt lgkmcnt(6)
v_mfma_f32_32x32x16_bf16 v[72:87], a[156:159], v[36:39], v[72:87]
ds_read_b128 v[32:35], v5 offset:47104
s_waitcnt lgkmcnt(6)
v_mfma_f32_32x32x16_bf16 v[72:87], a[160:163], v[8:11], v[72:87]
ds_read_b128 v[36:39], v5 offset:48128
s_add_u32 m0, s54, 40960
s_add_u32 s55, s53, 40960
buffer_load_dwordx4 v0, s[4:7], s55 offen sc1 lds
s_waitcnt lgkmcnt(6)
v_mfma_f32_32x32x16_bf16 v[72:87], a[164:167], v[12:15], v[72:87]
ds_read_b128 v[8:11], v5 offset:49152
s_waitcnt lgkmcnt(6)
v_mfma_f32_32x32x16_bf16 v[72:87], a[168:171], v[16:19], v[72:87]
ds_read_b128 v[12:15], v5 offset:50176
s_add_u32 m0, s54, 45056
s_add_u32 s55, s53, 45056
buffer_load_dwordx4 v0, s[4:7], s55 offen sc1 lds
s_waitcnt lgkmcnt(6)
v_mfma_f32_32x32x16_bf16 v[72:87], a[172:175], v[20:23], v[72:87]
ds_read_b128 v[16:19], v5 offset:51200
s_waitcnt lgkmcnt(6)
v_mfma_f32_32x32x16_bf16 v[72:87], a[176:179], v[24:27], v[72:87]
ds_read_b128 v[20:23], v5 offset:52224
s_add_u32 m0, s54, 49152
s_add_u32 s55, s53, 49152
buffer_load_dwordx4 v0, s[4:7], s55 offen sc1 lds
s_waitcnt lgkmcnt(6)
v_mfma_f32_32x32x16_bf16 v[72:87], a[180:183], v[28:31], v[72:87]
ds_read_b128 v[24:27], v5 offset:53248
s_waitcnt lgkmcnt(6)
v_mfma_f32_32x32x16_bf16 v[72:87], a[184:187], v[32:35], v[72:87]
ds_read_b128 v[28:31], v5 offset:54272
s_add_u32 m0, s54, 53248
s_add_u32 s55, s53, 53248
buffer_load_dwordx4 v0, s[4:7], s55 offen sc1 lds
s_waitcnt lgkmcnt(6)
v_mfma_f32_32x32x16_bf16 v[72:87], a[188:191], v[36:39], v[72:87]
ds_read_b128 v[32:35], v5 offset:55296
s_waitcnt lgkmcnt(6)
v_mfma_f32_32x32x16_bf16 v[72:87], a[192:195], v[8:11], v[72:87]
ds_read_b128 v[36:39], v5 offset:56320
s_add_u32 m0, s54, 57344
s_add_u32 s55, s53, 57344
buffer_load_dwordx4 v0, s[4:7], s55 offen sc1 lds
s_waitcnt lgkmcnt(6)
v_mfma_f32_32x32x16_bf16 v[72:87], a[196:199], v[12:15], v[72:87]
ds_read_b128 v[8:11], v5 offset:57344
s_waitcnt lgkmcnt(6)
v_mfma_f32_32x32x16_bf16 v[72:87], a[200:203], v[16:19], v[72:87]
ds_read_b128 v[12:15], v5 offset:58368
s_add_u32 m0, s54, 61440
s_add_u32 s55, s53, 61440
buffer_load_dwordx4 v0, s[4:7], s55 offen sc1 lds
s_waitcnt lgkmcnt(6)
v_mfma_f32_32x32x16_bf16 v[72:87], a[204:207], v[20:23], v[72:87]
ds_read_b128 v[16:19], v5 offset:59392
s_waitcnt lgkmcnt(6)
v_mfma_f32_32x32x16_bf16 v[72:87], a[208:211], v[24:27], v[72:87]
ds_read_b128 v[20:23], v5 offset:60416
s_waitcnt lgkmcnt(6)
v_mfma_f32_32x32x16_bf16 v[72:87], a[212:215], v[28:31], v[72:87]
ds_read_b128 v[24:27], v5 offset:61440
s_waitcnt lgkmcnt(6)
v_mfma_f32_32x32x16_bf16 v[72:87], a[216:219], v[32:35], v[72:87]
ds_read_b128 v[28:31], v5 offset:62464
s_waitcnt lgkmcnt(6)
v_mfma_f32_32x32x16_bf16 v[72:87], a[220:223], v[36:39], v[72:87]
ds_read_b128 v[32:35], v5 offset:63488
s_waitcnt lgkmcnt(6)
v_mfma_f32_32x32x16_bf16 v[72:87], a[224:227], v[8:11], v[72:87]
ds_read_b128 v[36:39], v5 offset:64512
s_waitcnt lgkmcnt(6)
v_mfma_f32_32x32x16_bf16 v[72:87], a[228:231], v[12:15], v[72:87]
s_waitcnt lgkmcnt(5)
v_mfma_f32_32x32x16_bf16 v[72:87], a[232:235], v[16:19], v[72:87]
s_waitcnt lgkmcnt(4)
v_mfma_f32_32x32x16_bf16 v[72:87], a[236:239], v[20:23], v[72:87]
s_waitcnt lgkmcnt(3)
v_mfma_f32_32x32x16_bf16 v[72:87], a[240:243], v[24:27], v[72:87]
s_waitcnt lgkmcnt(2)
v_mfma_f32_32x32x16_bf16 v[72:87], a[244:247], v[28:31], v[72:87]
s_waitcnt lgkmcnt(1)
v_mfma_f32_32x32x16_bf16 v[72:87], a[248:251], v[32:35], v[72:87]
s_waitcnt lgkmcnt(0)
v_mfma_f32_32x32x16_bf16 v[72:87], a[252:255], v[36:39], v[72:87]
s_mov_b32 s64, s57
s_add_u32 s50, s46, 1
s_add_u32 s57, s57, s58
v_mov_b32 v4, s50
s_add_u32 s46, s46, s48
s_sub_u32 s47, s47, 1
s_waitcnt vmcnt(8)
s_branch Lgwo_top0
Lgwo_late21:
s_waitcnt lgkmcnt(3)
v_mfma_f32_32x32x16_bf16 v[72:87], a[240:243], v[24:27], v[72:87]
s_waitcnt lgkmcnt(2)
v_mfma_f32_32x32x16_bf16 v[72:87], a[244:247], v[28:31], v[72:87]
s_waitcnt lgkmcnt(1)
v_mfma_f32_32x32x16_bf16 v[72:87], a[248:251], v[32:35], v[72:87]
s_waitcnt lgkmcnt(0)
v_mfma_f32_32x32x16_bf16 v[72:87], a[252:255], v[36:39], v[72:87]
s_mov_b32 s64, s57
s_add_u32 s50, s46, 1
s_add_u32 s57, s57, s58
v_mov_b32 v4, s50
s_nop 7
v_cvt_pk_bf16_f32 v56, v72, v73
v_cvt_pk_bf16_f32 v57, v74, v75
v_cvt_pk_bf16_f32 v58, v76, v77
v_cvt_pk_bf16_f32 v59, v78, v79
buffer_store_dwordx4 v[56:59], v0, s[4:7], s64 offen sc1
s_add_u32 s64, s64, 4096
v_cvt_pk_bf16_f32 v60, v80, v81
v_cvt_pk_bf16_f32 v61, v82, v83
v_cvt_pk_bf16_f32 v62, v84, v85
v_cvt_pk_bf16_f32 v63, v86, v87
buffer_store_dwordx4 v[60:63], v0, s[4:7], s64 offen sc1
s_add_u32 s46, s46, s48
s_sub_u32 s47, s47, 1
s_add_u32 m0, s54, 0
s_add_u32 s55, s53, 0
buffer_load_dwordx4 v0, s[4:7], s55 offen sc1 lds
s_add_u32 m0, s54, 4096
s_add_u32 s55, s53, 4096
buffer_load_dwordx4 v0, s[4:7], s55 offen sc1 lds
s_add_u32 m0, s54, 8192
s_add_u32 s55, s53, 8192
buffer_load_dwordx4 v0, s[4:7], s55 offen sc1 lds
s_add_u32 m0, s54, 12288
s_add_u32 s55, s53, 12288
buffer_load_dwordx4 v0, s[4:7], s55 offen sc1 lds
s_add_u32 m0, s54, 16384
s_add_u32 s55, s53, 16384
buffer_load_dwordx4 v0, s[4:7], s55 offen sc1 lds
s_add_u32 m0, s54, 20480
s_add_u32 s55, s53, 20480
buffer_load_dwordx4 v0, s[4:7], s55 offen sc1 lds
s_add_u32 m0, s54, 24576
s_add_u32 s55, s53, 24576
buffer_load_dwordx4 v0, s[4:7], s55 offen sc1 lds
s_add_u32 m0, s54, 28672
s_add_u32 s55, s53, 28672
buffer_load_dwordx4 v0, s[4:7], s55 offen sc1 lds
s_add_u32 m0, s54, 32768
s_add_u32 s55, s53, 32768
buffer_load_dwordx4 v0, s[4:7], s55 offen sc1 lds
s_add_u32 m0, s54, 36864
s_add_u32 s55, s53, 36864
buffer_load_dwordx4 v0, s[4:7], s55 offen sc1 lds
s_add_u32 m0, s54, 40960
s_add_u32 s55, s53, 40960
buffer_load_dwordx4 v0, s[4:7], s55 offen sc1 lds
s_add_u32 m0, s54, 45056
s_add_u32 s55, s53, 45056
buffer_load_dwordx4 v0, s[4:7], s55 offen sc1 lds
s_add_u32 m0, s54, 49152
s_add_u32 s55, s53, 49152
buffer_load_dwordx4 v0, s[4:7], s55 offen sc1 lds
s_add_u32 m0, s54, 53248
s_add_u32 s55, s53, 53248
buffer_load_dwordx4 v0, s[4:7], s55 offen sc1 lds
s_add_u32 m0, s54, 57344
s_add_u32 s55, s53, 57344
buffer_load_dwordx4 v0, s[4:7], s55 offen sc1 lds
s_add_u32 m0, s54, 61440
s_add_u32 s55, s53, 61440
buffer_load_dwordx4 v0, s[4:7], s55 offen sc1 lds
s_lshl_b32 s64, s40, 14
s_lshl_b32 s50, s42, 11
s_add_u32 s64, s64, s50
s_add_u32 s64, s64, 155189248
s_waitcnt vmcnt(16)
s_barrier
s_cmp_lg_u32 s42, 0
s_cbranch_scc1 Lgwo_w_188
s_mov_b64 exec, 1
buffer_store_dword v4, v3, s[4:7], s59 offen sc1
s_mov_b64 exec, -1
Lgwo_w_188:
s_waitcnt vmcnt(8)
s_branch Lgwo_top0
Lgwo_last1:
s_waitcnt lgkmcnt(6)
v_mfma_f32_32x32x16_bf16 v[72:87], a[8:11], v[16:19], v[72:87]
ds_read_b128 v[12:15], v5 offset:9216
v_cvt_pk_bf16_f32 v56, v40, v41
v_cvt_pk_bf16_f32 v57, v42, v43
v_cvt_pk_bf16_f32 v58, v44, v45
v_cvt_pk_bf16_f32 v59, v46, v47
s_waitcnt lgkmcnt(6)
v_mfma_f32_32x32x16_bf16 v[72:87], a[12:15], v[20:23], v[72:87]
ds_read_b128 v[16:19], v5 offset:10240
buffer_store_dwordx4 v[56:59], v0, s[4:7], s64 offen sc1
s_add_u32 s64, s64, 4096
v_cvt_pk_bf16_f32 v60, v48, v49
v_cvt_pk_bf16_f32 v61, v50, v51
s_waitcnt lgkmcnt(6)
v_mfma_f32_32x32x16_bf16 v[72:87], a[16:19], v[24:27], v[72:87]
ds_read_b128 v[20:23], v5 offset:11264
v_cvt_pk_bf16_f32 v62, v52, v53
v_cvt_pk_bf16_f32 v63, v54, v55
buffer_store_dwordx4 v[60:63], v0, s[4:7], s64 offen sc1
s_waitcnt lgkmcnt(6)
v_mfma_f32_32x32x16_bf16 v[72:87], a[20:23], v[28:31], v[72:87]
ds_read_b128 v[24:27], v5 offset:12288
s_waitcnt lgkmcnt(6)
v_mfma_f32_32x32x16_bf16 v[72:87], a[24:27], v[32:35], v[72:87]
ds_read_b128 v[28:31], v5 offset:13312
s_waitcnt lgkmcnt(6)
v_mfma_f32_32x32x16_bf16 v[72:87], a[28:31], v[36:39], v[72:87]
ds_read_b128 v[32:35], v5 offset:14336
s_waitcnt lgkmcnt(6)
v_mfma_f32_32x32x16_bf16 v[72:87], a[32:35], v[8:11], v[72:87]
ds_read_b128 v[36:39], v5 offset:15360
s_waitcnt lgkmcnt(6)
v_mfma_f32_32x32x16_bf16 v[72:87], a[36:39], v[12:15], v[72:87]
ds_read_b128 v[8:11], v5 offset:16384
s_waitcnt lgkmcnt(6)
v_mfma_f32_32x32x16_bf16 v[72:87], a[40:43], v[16:19], v[72:87]
ds_read_b128 v[12:15], v5 offset:17408
s_waitcnt lgkmcnt(6)
v_mfma_f32_32x32x16_bf16 v[72:87], a[44:47], v[20:23], v[72:87]
ds_read_b128 v[16:19], v5 offset:18432
s_waitcnt lgkmcnt(6)
v_mfma_f32_32x32x16_bf16 v[72:87], a[48:51], v[24:27], v[72:87]
ds_read_b128 v[20:23], v5 offset:19456
s_waitcnt lgkmcnt(6)
v_mfma_f32_32x32x16_bf16 v[72:87], a[52:55], v[28:31], v[72:87]
ds_read_b128 v[24:27], v5 offset:20480
s_waitcnt lgkmcnt(6)
v_mfma_f32_32x32x16_bf16 v[72:87], a[56:59], v[32:35], v[72:87]
ds_read_b128 v[28:31], v5 offset:21504
s_waitcnt lgkmcnt(6)
v_mfma_f32_32x32x16_bf16 v[72:87], a[60:63], v[36:39], v[72:87]
ds_read_b128 v[32:35], v5 offset:22528
s_waitcnt lgkmcnt(6)
v_mfma_f32_32x32x16_bf16 v[72:87], a[64:67], v[8:11], v[72:87]
ds_read_b128 v[36:39], v5 offset:23552
s_waitcnt lgkmcnt(6)
v_mfma_f32_32x32x16_bf16 v[72:87], a[68:71], v[12:15], v[72:87]
ds_read_b128 v[8:11], v5 offset:24576
s_waitcnt lgkmcnt(6)
v_mfma_f32_32x32x16_bf16 v[72:87], a[72:75], v[16:19], v[72:87]
ds_read_b128 v[12:15], v5 offset:25600
s_waitcnt lgkmcnt(6)
v_mfma_f32_32x32x16_bf16 v[72:87], a[76:79], v[20:23], v[72:87]
ds_read_b128 v[16:19], v5 offset:26624
s_waitcnt lgkmcnt(6)
v_mfma_f32_32x32x16_bf16 v[72:87], a[80:83], v[24:27], v[72:87]
ds_read_b128 v[20:23], v5 offset:27648
s_waitcnt lgkmcnt(6)
v_mfma_f32_32x32x16_bf16 v[72:87], a[84:87], v[28:31], v[72:87]
ds_read_b128 v[24:27], v5 offset:28672
s_waitcnt lgkmcnt(6)
v_mfma_f32_32x32x16_bf16 v[72:87], a[88:91], v[32:35], v[72:87]
ds_read_b128 v[28:31], v5 offset:29696
s_waitcnt lgkmcnt(6)
v_mfma_f32_32x32x16_bf16 v[72:87], a[92:95], v[36:39], v[72:87]
ds_read_b128 v[32:35], v5 offset:30720
s_waitcnt vmcnt(2) lgkmcnt(2)
s_barrier
s_waitcnt lgkmcnt(6)
v_mfma_f32_32x32x16_bf16 v[72:87], a[96:99], v[8:11], v[72:87]
ds_read_b128 v[36:39], v5 offset:31744
s_waitcnt lgkmcnt(6)
v_mfma_f32_32x32x16_bf16 v[72:87], a[100:103], v[12:15], v[72:87]
ds_read_b128 v[8:11], v5 offset:32768
s_waitcnt lgkmcnt(6)
v_mfma_f32_32x32x16_bf16 v[72:87], a[104:107], v[16:19], v[72:87]
ds_read_b128 v[12:15], v5 offset:33792
s_waitcnt lgkmcnt(6)
v_mfma_f32_32x32x16_bf16 v[72:87], a[108:111], v[20:23], v[72:87]
ds_read_b128 v[16:19], v5 offset:34816
s_waitcnt lgkmcnt(6)
v_mfma_f32_32x32x16_bf16 v[72:87], a[112:115], v[24:27], v[72:87]
ds_read_b128 v[20:23], v5 offset:35840
s_waitcnt lgkmcnt(6)
v_mfma_f32_32x32x16_bf16 v[72:87], a[116:119], v[28:31], v[72:87]
ds_read_b128 v[24:27], v5 offset:36864
s_waitcnt lgkmcnt(6)
v_mfma_f32_32x32x16_bf16 v[72:87], a[120:123], v[32:35], v[72:87]
ds_read_b128 v[28:31], v5 offset:37888
s_waitcnt lgkmcnt(6)
v_mfma_f32_32x32x16_bf16 v[72:87], a[124:127], v[36:39], v[72:87]
ds_read_b128 v[32:35], v5 offset:38912
s_waitcnt lgkmcnt(6)
v_mfma_f32_32x32x16_bf16 v[72:87], a[128:131], v[8:11], v[72:87]
ds_read_b128 v[36:39], v5 offset:39936
s_waitcnt lgkmcnt(6)
v_mfma_f32_32x32x16_bf16 v[72:87], a[132:135], v[12:15], v[72:87]
ds_read_b128 v[8:11], v5 offset:40960
s_waitcnt vmcnt(0)
s_barrier
s_waitcnt lgkmcnt(6)
v_mfma_f32_32x32x16_bf16 v[72:87], a[136:139], v[16:19], v[72:87]
ds_read_b128 v[12:15], v5 offset:41984
s_cmp_lg_u32 s42, 0
s_cbranch_scc1 Lgwo_w_189
s_mov_b64 exec, 1
buffer_store_dword v4, v3, s[4:7], s59 offen sc1
s_mov_b64 exec, -1
Lgwo_w_189:
s_waitcnt lgkmcnt(6)
v_mfma_f32_32x32x16_bf16 v[72:87], a[140:143], v[20:23], v[72:87]
ds_read_b128 v[16:19], v5 offset:43008
s_waitcnt lgkmcnt(6)
v_mfma_f32_32x32x16_bf16 v[72:87], a[144:147], v[24:27], v[72:87]
ds_read_b128 v[20:23], v5 offset:44032
s_waitcnt lgkmcnt(6)
v_mfma_f32_32x32x16_bf16 v[72:87], a[148:151], v[28:31], v[72:87]
ds_read_b128 v[24:27], v5 offset:45056
s_waitcnt lgkmcnt(6)
v_mfma_f32_32x32x16_bf16 v[72:87], a[152:155], v[32:35], v[72:87]
ds_read_b128 v[28:31], v5 offset:46080
s_waitcnt lgkmcnt(6)
v_mfma_f32_32x32x16_bf16 v[72:87], a[156:159], v[36:39], v[72:87]
ds_read_b128 v[32:35], v5 offset:47104
s_waitcnt lgkmcnt(6)
v_mfma_f32_32x32x16_bf16 v[72:87], a[160:163], v[8:11], v[72:87]
ds_read_b128 v[36:39], v5 offset:48128
s_waitcnt lgkmcnt(6)
v_mfma_f32_32x32x16_bf16 v[72:87], a[164:167], v[12:15], v[72:87]
ds_read_b128 v[8:11], v5 offset:49152
s_waitcnt lgkmcnt(6)
v_mfma_f32_32x32x16_bf16 v[72:87], a[168:171], v[16:19], v[72:87]
ds_read_b128 v[12:15], v5 offset:50176
s_waitcnt lgkmcnt(6)
v_mfma_f32_32x32x16_bf16 v[72:87], a[172:175], v[20:23], v[72:87]
ds_read_b128 v[16:19], v5 offset:51200
s_waitcnt lgkmcnt(6)
v_mfma_f32_32x32x16_bf16 v[72:87], a[176:179], v[24:27], v[72:87]
ds_read_b128 v[20:23], v5 offset:52224
s_waitcnt lgkmcnt(6)
v_mfma_f32_32x32x16_bf16 v[72:87], a[180:183], v[28:31], v[72:87]
ds_read_b128 v[24:27], v5 offset:53248
s_waitcnt lgkmcnt(6)
v_mfma_f32_32x32x16_bf16 v[72:87], a[184:187], v[32:35], v[72:87]
ds_read_b128 v[28:31], v5 offset:54272
s_waitcnt lgkmcnt(6)
v_mfma_f32_32x32x16_bf16 v[72:87], a[188:191], v[36:39], v[72:87]
ds_read_b128 v[32:35], v5 offset:55296
s_waitcnt lgkmcnt(6)
v_mfma_f32_32x32x16_bf16 v[72:87], a[192:195], v[8:11], v[72:87]
ds_read_b128 v[36:39], v5 offset:56320
s_waitcnt lgkmcnt(6)
v_mfma_f32_32x32x16_bf16 v[72:87], a[196:199], v[12:15], v[72:87]
ds_read_b128 v[8:11], v5 offset:57344
s_waitcnt lgkmcnt(6)
v_mfma_f32_32x32x16_bf16 v[72:87], a[200:203], v[16:19], v[72:87]
ds_read_b128 v[12:15], v5 offset:58368
s_waitcnt lgkmcnt(6)
v_mfma_f32_32x32x16_bf16 v[72:87], a[204:207], v[20:23], v[72:87]
ds_read_b128 v[16:19], v5 offset:59392
s_waitcnt lgkmcnt(6)
v_mfma_f32_32x32x16_bf16 v[72:87], a[208:211], v[24:27], v[72:87]
ds_read_b128 v[20:23], v5 offset:60416
s_waitcnt lgkmcnt(6)
v_mfma_f32_32x32x16_bf16 v[72:87], a[212:215], v[28:31], v[72:87]
ds_read_b128 v[24:27], v5 offset:61440
s_waitcnt lgkmcnt(6)
v_mfma_f32_32x32x16_bf16 v[72:87], a[216:219], v[32:35], v[72:87]
ds_read_b128 v[28:31], v5 offset:62464
s_waitcnt lgkmcnt(6)
v_mfma_f32_32x32x16_bf16 v[72:87], a[220:223], v[36:39], v[72:87]
ds_read_b128 v[32:35], v5 offset:63488
s_waitcnt lgkmcnt(6)
v_mfma_f32_32x32x16_bf16 v[72:87], a[224:227], v[8:11], v[72:87]
ds_read_b128 v[36:39], v5 offset:64512
s_waitcnt lgkmcnt(6)
v_mfma_f32_32x32x16_bf16 v[72:87], a[228:231], v[12:15], v[72:87]
s_waitcnt lgkmcnt(5)
v_mfma_f32_32x32x16_bf16 v[72:87], a[232:235], v[16:19], v[72:87]
s_waitcnt lgkmcnt(4)
v_mfma_f32_32x32x16_bf16 v[72:87], a[236:239], v[20:23], v[72:87]
s_waitcnt lgkmcnt(3)
v_mfma_f32_32x32x16_bf16 v[72:87], a[240:243], v[24:27], v[72:87]
s_waitcnt lgkmcnt(2)
v_mfma_f32_32x32x16_bf16 v[72:87], a[244:247], v[28:31], v[72:87]
s_waitcnt lgkmcnt(1)
v_mfma_f32_32x32x16_bf16 v[72:87], a[248:251], v[32:35], v[72:87]
s_waitcnt lgkmcnt(0)
v_mfma_f32_32x32x16_bf16 v[72:87], a[252:255], v[36:39], v[72:87]
s_mov_b32 s64, s57
s_add_u32 s50, s46, 1
s_add_u32 s57, s57, s58
v_mov_b32 v4, s50
s_nop 7
v_cvt_pk_bf16_f32 v56, v72, v73
v_cvt_pk_bf16_f32 v57, v74, v75
v_cvt_pk_bf16_f32 v58, v76, v77
v_cvt_pk_bf16_f32 v59, v78, v79
buffer_store_dwordx4 v[56:59], v0, s[4:7], s64 offen sc1
s_add_u32 s64, s64, 4096
v_cvt_pk_bf16_f32 v60, v80, v81
v_cvt_pk_bf16_f32 v61, v82, v83
v_cvt_pk_bf16_f32 v62, v84, v85
v_cvt_pk_bf16_f32 v63, v86, v87
buffer_store_dwordx4 v[60:63], v0, s[4:7], s64 offen sc1
s_waitcnt vmcnt(0)
s_barrier
s_cmp_lg_u32 s42, 0
s_cbranch_scc1 Lgwo_w_190
s_mov_b64 exec, 1
buffer_store_dword v4, v3, s[4:7], s59 offen sc1
s_mov_b64 exec, -1
Lgwo_w_190:
s_branch Lend
Lgup:
s_mov_b32 s65, 0x10000
v_mov_b32 v71, 131072
v_mov_b32 v4, s46
s_mov_b32 s62, 0
s_mul_i32 s50, s62, s61
s_add_u32 s62, s62, 1
s_cmp_eq_u32 s62, s78
s_cselect_b32 s62, 0, s62
s_mul_i32 s51, s62, s61
s_sub_u32 s51, s51, s50
s_add_u32 s63, s46, 1
v_mad_i32_i24 v68, v88, s51, v1
v_add_u32 v68, s50, v68
v_add_u32 v69, s63, v88
Lgup_cold:
s_cmp_lg_u32 s42, 0
s_cbranch_scc1 Lgup_w_191
Lgup_sp:
buffer_load_dword v2, v68, s[4:7], s60 offen sc1
s_waitcnt vmcnt(0)
v_cmp_gt_i32 vcc, v69, v2
s_nop 0
s_cmp_eq_u32 vcc_lo, 0
s_cbranch_scc1 Lgup_spd
s_sleep 2
s_sub_u32 s43, s43, 1
s_cbranch_scc0 Lgup_sp
s_mov_b32 s43, 0
Lgup_spd:
v_mov_b32 v70, vcc_hi
ds_write_b32 v71, v70
s_waitcnt lgkmcnt(0)
Lgup_w_191:
s_barrier
Lgup_fetch:
s_lshl_b32 s53, s42, 10
s_xor_b32 s54, s65, 0x10000
s_add_u32 s54, s54, s53
s_add_u32 s53, s53, s49
s_add_u32 m0, s54, 0
s_add_u32 s55, s53, 0
buffer_load_dwordx4 v0, s[4:7], s55 offen sc1 lds
s_add_u32 m0, s54, 4096
s_add_u32 s55, s53, 4096
buffer_load_dwordx4 v0, s[4:7], s55 offen sc1 lds
s_add_u32 m0, s54, 8192
s_add_u32 s55, s53, 8192
buffer_load_dwordx4 v0, s[4:7], s55 offen sc1 lds
s_add_u32 m0, s54, 12288
s_add_u32 s55, s53, 12288
buffer_load_dwordx4 v0, s[4:7], s55 offen sc1 lds
s_add_u32 m0, s54, 16384
s_add_u32 s55, s53, 16384
buffer_load_dwordx4 v0, s[4:7], s55 offen sc1 lds
s_add_u32 m0, s54, 20480
s_add_u32 s55, s53, 20480
buffer_load_dwordx4 v0, s[4:7], s55 offen sc1 lds
s_add_u32 m0, s54, 24576
s_add_u32 s55, s53, 24576
buffer_load_dwordx4 v0, s[4:7], s55 offen sc1 lds
s_add_u32 m0, s54, 28672
s_add_u32 s55, s53, 28672
buffer_load_dwordx4 v0, s[4:7], s55 offen sc1 lds
s_add_u32 m0, s54, 32768
s_add_u32 s55, s53, 32768
buffer_load_dwordx4 v0, s[4:7], s55 offen sc1 lds
s_add_u32 m0, s54, 36864
s_add_u32 s55, s53, 36864
buffer_load_dwordx4 v0, s[4:7], s55 offen sc1 lds
s_add_u32 m0, s54, 40960
s_add_u32 s55, s53, 40960
buffer_load_dwordx4 v0, s[4:7], s55 offen sc1 lds
s_add_u32 m0, s54, 45056
s_add_u32 s55, s53, 45056
buffer_load_dwordx4 v0, s[4:7], s55 offen sc1 lds
s_add_u32 m0, s54, 49152
s_add_u32 s55, s53, 49152
buffer_load_dwordx4 v0, s[4:7], s55 offen sc1 lds
s_add_u32 m0, s54, 53248
s_add_u32 s55, s53, 53248
buffer_load_dwordx4 v0, s[4:7], s55 offen sc1 lds
s_add_u32 m0, s54, 57344
s_add_u32 s55, s53, 57344
buffer_load_dwordx4 v0, s[4:7], s55 offen sc1 lds
s_add_u32 m0, s54, 61440
s_add_u32 s55, s53, 61440
buffer_load_dwordx4 v0, s[4:7], s55 offen sc1 lds
s_lshl_b32 s64, s40, 14
s_lshl_b32 s50, s42, 11
s_add_u32 s64, s64, s50
s_add_u32 s64, s64, 155189248
s_waitcnt vmcnt(8)
Lgup_top0:
s_cmp_lg_u32 s42, 0
s_cbranch_scc1 Lgup_w_192
s_mul_i32 s50, s62, s61
s_add_u32 s62, s62, 1
s_cmp_eq_u32 s62, s78
s_cselect_b32 s62, 0, s62
s_mul_i32 s51, s62, s61
s_sub_u32 s51, s51, s50
s_add_u32 s63, s46, 2
v_mad_i32_i24 v68, v88, s51, v1
v_add_u32 v68, s50, v68
v_add_u32 v69, s63, v88
buffer_load_dword v2, v68, s[4:7], s60 offen sc1
Lgup_w_192:
s_xor_b32 s65, s65, 0x10000
s_add_u32 s49, s49, s56
v_add_u32 v5, s65, v0
s_barrier
ds_read_b128 v[8:11], v5 offset:0
ds_read_b128 v[12:15], v5 offset:1024
ds_read_b32 v70, v71 offset:0
ds_read_b128 v[16:19], v5 offset:2048
s_lshl_b32 s53, s42, 10
s_xor_b32 s54, s65, 0x10000
s_add_u32 s54, s54, s53
s_add_u32 s53, s53, s49
s_waitcnt lgkmcnt(3)
v_mfma_f32_32x32x16_bf16 v[40:55], a[0:3], v[8:11], 0
ds_read_b128 v[20:23], v5 offset:3072
ds_read_b128 v[24:27], v5 offset:4096
ds_read_b128 v[28:31], v5 offset:5120
ds_read_b128 v[32:35], v5 offset:6144
s_waitcnt lgkmcnt(5)
v_mfma_f32_32x32x16_bf16 v[40:55], a[4:7], v[12:15], v[40:55]
ds_read_b128 v[36:39], v5 offset:7168
ds_read_b128 v[8:11], v5 offset:8192
v_readfirstlane_b32 s50, v70
s_cmp_le_u32 s47, 1
s_cbranch_scc1 Lgup_last0
s_cmp_lg_u32 s50, 0
s_cbranch_scc1 Lgup_nop0
s_waitcnt lgkmcnt(6)
v_mfma_f32_32x32x16_bf16 v[40:55], a[8:11], v[16:19], v[40:55]
ds_read_b128 v[12:15], v5 offset:9216
s_add_u32 m0, s54, 0
s_add_u32 s55, s53, 0
buffer_load_dwordx4 v0, s[4:7], s55 offen sc1 lds
v_mul_f32 v56, v72, v72
s_waitcnt lgkmcnt(6)
v_mfma_f32_32x32x16_bf16 v[40:55], a[12:15], v[20:23], v[40:55]
ds_read_b128 v[16:19], v5 offset:10240
v_mul_f32 v57, v73, v73
v_mul_f32 v58, v74, v74
v_mul_f32 v59, v75, v75
v_mul_f32 v60, v76, v76
s_waitcnt lgkmcnt(6)
v_mfma_f32_32x32x16_bf16 v[40:55], a[16:19], v[24:27], v[40:55]
ds_read_b128 v[20:23], v5 offset:11264
s_add_u32 m0, s54, 4096
s_add_u32 s55, s53, 4096
buffer_load_dwordx4 v0, s[4:7], s55 offen sc1 lds
v_mul_f32 v61, v77, v77
s_waitcnt lgkmcnt(6)
v_mfma_f32_32x32x16_bf16 v[40:55], a[20:23], v[28:31], v[40:55]
ds_read_b128 v[24:27], v5 offset:12288
v_mul_f32 v62, v78, v78
v_mul_f32 v63, v79, v79
v_fma_f32 v56, v56, s72, v6
v_fma_f32 v57, v57, s72, v6
s_waitcnt lgkmcnt(6)
v_mfma_f32_32x32x16_bf16 v[40:55], a[24:27], v[32:35], v[40:55]
ds_read_b128 v[28:31], v5 offset:13312
s_add_u32 m0, s54, 8192
s_add_u32 s55, s53, 8192
buffer_load_dwordx4 v0, s[4:7], s55 offen sc1 lds
v_fma_f32 v58, v58, s72, v6
s_waitcnt lgkmcnt(6)
v_mfma_f32_32x32x16_bf16 v[40:55], a[28:31], v[36:39], v[40:55]
ds_read_b128 v[32:35], v5 offset:14336
v_fma_f32 v59, v59, s72, v6
v_fma_f32 v60, v60, s72, v6
v_fma_f32 v61, v61, s72, v6
v_fma_f32 v62, v62, s72, v6
s_waitcnt lgkmcnt(6)
v_mfma_f32_32x32x16_bf16 v[40:55], a[32:35], v[8:11], v[40:55]
ds_read_b128 v[36:39], v5 offset:15360
s_add_u32 m0, s54, 12288
s_add_u32 s55, s53, 12288
buffer_load_dwordx4 v0, s[4:7], s55 offen sc1 lds
v_fma_f32 v63, v63, s72, v6
s_waitcnt lgkmcnt(6)
v_mfma_f32_32x32x16_bf16 v[40:55], a[36:39], v[12:15], v[40:55]
ds_read_b128 v[8:11], v5 offset:16384
v_mul_f32 v56, v56, v72
v_mul_f32 v57, v57, v73
v_mul_f32 v58, v58, v74
v_mul_f32 v59, v59, v75
s_waitcnt lgkmcnt(6)
v_mfma_f32_32x32x16_bf16 v[40:55], a[40:43], v[16:19], v[40:55]
ds_read_b128 v[12:15], v5 offset:17408
s_add_u32 m0, s54, 16384
s_add_u32 s55, s53, 16384
buffer_load_dwordx4 v0, s[4:7], s55 offen sc1 lds
v_mul_f32 v60, v60, v76
s_waitcnt lgkmcnt(6)
v_mfma_f32_32x32x16_bf16 v[40:55], a[44:47], v[20:23], v[40:55]
ds_read_b128 v[16:19], v5 offset:18432
v_mul_f32 v61, v61, v77
v_mul_f32 v62, v62, v78
v_mul_f32 v63, v63, v79
v_exp_f32 v56, v56
s_waitcnt lgkmcnt(6)
v_mfma_f32_32x32x16_bf16 v[40:55], a[48:51], v[24:27], v[40:55]
ds_read_b128 v[20:23], v5 offset:19456
s_add_u32 m0, s54, 20480
s_add_u32 s55, s53, 20480
buffer_load_dwordx4 v0, s[4:7], s55 offen sc1 lds
v_mul_f32 v72, v72, v80
s_waitcnt lgkmcnt(6)
v_mfma_f32_32x32x16_bf16 v[40:55], a[52:55], v[28:31], v[40:55]
ds_read_b128 v[24:27], v5 offset:20480
v_exp_f32 v57, v57
v_mul_f32 v73, v73, v81
v_exp_f32 v58, v58
s_waitcnt lgkmcnt(6)
v_mfma_f32_32x32x16_bf16 v[40:55], a[56:59], v[32:35], v[40:55]
ds_read_b128 v[28:31], v5 offset:21504
s_add_u32 m0, s54, 24576
s_add_u32 s55, s53, 24576
buffer_load_dwordx4 v0, s[4:7], s55 offen sc1 lds
v_mul_f32 v74, v74, v82
s_waitcnt lgkmcnt(6)
v_mfma_f32_32x32x16_bf16 v[40:55], a[60:63], v[36:39], v[40:55]
ds_read_b128 v[32:35], v5 offset:22528
v_exp_f32 v59, v59
v_mul_f32 v75, v75, v83
v_exp_f32 v60, v60
s_waitcnt lgkmcnt(6)
v_mfma_f32_32x32x16_bf16 v[40:55], a[64:67], v[8:11], v[40:55]
ds_read_b128 v[36:39], v5 offset:23552
s_add_u32 m0, s54, 28672
s_add_u32 s55, s53, 28672
buffer_load_dwordx4 v0, s[4:7], s55 offen sc1 lds
v_mul_f32 v76, v76, v84
s_waitcnt lgkmcnt(6)
v_mfma_f32_32x32x16_bf16 v[40:55], a[68:71], v[12:15], v[40:55]
ds_read_b128 v[8:11], v5 offset:24576
v_exp_f32 v61, v61
v_mul_f32 v77, v77, v85
v_exp_f32 v62, v62
s_waitcnt lgkmcnt(6)
v_mfma_f32_32x32x16_bf16 v[40:55], a[72:75], v[16:19], v[40:55]
ds_read_b128 v[12:15], v5 offset:25600
s_add_u32 m0, s54, 32768
s_add_u32 s55, s53, 32768
buffer_load_dwordx4 v0, s[4:7], s55 offen sc1 lds
v_mul_f32 v78, v78, v86
s_waitcnt lgkmcnt(6)
v_mfma_f32_32x32x16_bf16 v[40:55], a[76:79], v[20:23], v[40:55]
ds_read_b128 v[16:19], v5 offset:26624
v_exp_f32 v63, v63
v_mul_f32 v79, v79, v87
v_add_f32 v56, 1.0, v56
s_waitcnt lgkmcnt(6)
v_mfma_f32_32x32x16_bf16 v[40:55], a[80:83], v[24:27], v[40:55]
ds_read_b128 v[20:23], v5 offset:27648
s_add_u32 m0, s54, 36864
s_add_u32 s55, s53, 36864
buffer_load_dwordx4 v0, s[4:7], s55 offen sc1 lds
v_add_f32 v57, 1.0, v57
s_waitcnt lgkmcnt(6)
v_mfma_f32_32x32x16_bf16 v[40:55], a[84:87], v[28:31], v[40:55]
ds_read_b128 v[24:27], v5 offset:28672
v_add_f32 v58, 1.0, v58
v_add_f32 v59, 1.0, v59
v_add_f32 v60, 1.0, v60
v_add_f32 v61, 1.0, v61
s_cmp_lg_u32 s42, 0
s_cbranch_scc1 Lgup_w_193
s_waitcnt vmcnt(10)
v_cmp_gt_i32 vcc, v69, v2
s_nop 1
v_mov_b32 v70, vcc_hi
v_mov_b32 v2, vcc_lo
ds_write2_b32 v71, v70, v2 offset0:4 offset1:1
Lgup_w_193:
s_waitcnt lgkmcnt(6)
v_mfma_f32_32x32x16_bf16 v[40:55], a[88:91], v[32:35], v[40:55]
ds_read_b128 v[28:31], v5 offset:29696
s_add_u32 m0, s54, 40960
s_add_u32 s55, s53, 40960
buffer_load_dwordx4 v0, s[4:7], s55 offen sc1 lds
v_add_f32 v62, 1.0, v62
s_waitcnt lgkmcnt(6)
v_mfma_f32_32x32x16_bf16 v[40:55], a[92:95], v[36:39], v[40:55]
ds_read_b128 v[32:35], v5 offset:30720
v_add_f32 v63, 1.0, v63
v_rcp_f32 v56, v56
v_rcp_f32 v57, v57
s_waitcnt vmcnt(11) lgkmcnt(2)
s_barrier
s_waitcnt lgkmcnt(6)
v_mfma_f32_32x32x16_bf16 v[40:55], a[96:99], v[8:11], v[40:55]
ds_read_b128 v[36:39], v5 offset:31744
s_add_u32 m0, s54, 45056
s_add_u32 s55, s53, 45056
buffer_load_dwordx4 v0, s[4:7], s55 offen sc1 lds
v_rcp_f32 v58, v58
s_waitcnt lgkmcnt(6)
v_mfma_f32_32x32x16_bf16 v[40:55], a[100:103], v[12:15], v[40:55]
ds_read_b128 v[8:11], v5 offset:32768
v_rcp_f32 v59, v59
v_rcp_f32 v60, v60
s_waitcnt lgkmcnt(6)
v_mfma_f32_32x32x16_bf16 v[40:55], a[104:107], v[16:19], v[40:55]
ds_read_b128 v[12:15], v5 offset:33792
s_add_u32 m0, s54, 49152
s_add_u32 s55, s53, 49152
buffer_load_dwordx4 v0, s[4:7], s55 offen sc1 lds
v_rcp_f32 v61, v61
s_waitcnt lgkmcnt(6)
v_mfma_f32_32x32x16_bf16 v[40:55], a[108:111], v[20:23], v[40:55]
ds_read_b128 v[16:19], v5 offset:34816
v_rcp_f32 v62, v62
v_rcp_f32 v63, v63
s_waitcnt lgkmcnt(6)
v_mfma_f32_32x32x16_bf16 v[40:55], a[112:115], v[24:27], v[40:55]
ds_read_b128 v[20:23], v5 offset:35840
s_add_u32 m0, s54, 53248
s_add_u32 s55, s53, 53248
buffer_load_dwordx4 v0, s[4:7], s55 offen sc1 lds
v_mul_f32 v72, v72, v56
s_waitcnt lgkmcnt(6)
v_mfma_f32_32x32x16_bf16 v[40:55], a[116:119], v[28:31], v[40:55]
ds_read_b128 v[24:27], v5 offset:36864
v_mul_f32 v73, v73, v57
v_mul_f32 v74, v74, v58
v_mul_f32 v75, v75, v59
v_mul_f32 v76, v76, v60
s_waitcnt lgkmcnt(6)
v_mfma_f32_32x32x16_bf16 v[40:55], a[120:123], v[32:35], v[40:55]
ds_read_b128 v[28:31], v5 offset:37888
s_add_u32 m0, s54, 57344
s_add_u32 s55, s53, 57344
buffer_load_dwordx4 v0, s[4:7], s55 offen sc1 lds
v_mul_f32 v77, v77, v61
s_waitcnt lgkmcnt(6)
v_mfma_f32_32x32x16_bf16 v[40:55], a[124:127], v[36:39], v[40:55]
ds_read_b128 v[32:35], v5 offset:38912
v_mul_f32 v78, v78, v62
v_mul_f32 v79, v79, v63
v_cvt_pk_bf16_f32 v64, v72, v73
v_cvt_pk_bf16_f32 v65, v74, v75
s_waitcnt lgkmcnt(6)
v_mfma_f32_32x32x16_bf16 v[40:55], a[128:131], v[8:11], v[40:55]
ds_read_b128 v[36:39], v5 offset:39936
s_add_u32 m0, s54, 61440
s_add_u32 s55, s53, 61440
buffer_load_dwordx4 v0, s[4:7], s55 offen sc1 lds
v_cvt_pk_bf16_f32 v66, v76, v77
s_waitcnt lgkmcnt(6)
v_mfma_f32_32x32x16_bf16 v[40:55], a[132:135], v[12:15], v[40:55]
ds_read_b128 v[8:11], v5 offset:40960
v_cvt_pk_bf16_f32 v67, v78, v79
buffer_store_dwordx4 v[64:67], v0, s[4:7], s64 offen sc1
s_waitcnt lgkmcnt(6)
v_mfma_f32_32x32x16_bf16 v[40:55], a[136:139], v[16:19], v[40:55]
ds_read_b128 v[12:15], v5 offset:41984
s_waitcnt lgkmcnt(6)
v_mfma_f32_32x32x16_bf16 v[40:55], a[140:143], v[20:23], v[40:55]
ds_read_b128 v[16:19], v5 offset:43008
s_waitcnt lgkmcnt(6)
v_mfma_f32_32x32x16_bf16 v[40:55], a[144:147], v[24:27], v[40:55]
ds_read_b128 v[20:23], v5 offset:44032
s_waitcnt lgkmcnt(6)
v_mfma_f32_32x32x16_bf16 v[40:55], a[148:151], v[28:31], v[40:55]
ds_read_b128 v[24:27], v5 offset:45056
s_waitcnt lgkmcnt(6)
v_mfma_f32_32x32x16_bf16 v[40:55], a[152:155], v[32:35], v[40:55]
ds_read_b128 v[28:31], v5 offset:46080
s_waitcnt lgkmcnt(6)
v_mfma_f32_32x32x16_bf16 v[40:55], a[156:159], v[36:39], v[40:55]
ds_read_b128 v[32:35], v5 offset:47104
s_waitcnt lgkmcnt(6)
v_mfma_f32_32x32x16_bf16 v[40:55], a[160:163], v[8:11], v[40:55]
ds_read_b128 v[36:39], v5 offset:48128
s_waitcnt lgkmcnt(6)
v_mfma_f32_32x32x16_bf16 v[40:55], a[164:167], v[12:15], v[40:55]
ds_read_b128 v[8:11], v5 offset:49152
s_waitcnt lgkmcnt(6)
v_mfma_f32_32x32x16_bf16 v[40:55], a[168:171], v[16:19], v[40:55]
ds_read_b128 v[12:15], v5 offset:50176
s_waitcnt lgkmcnt(6)
v_mfma_f32_32x32x16_bf16 v[40:55], a[172:175], v[20:23], v[40:55]
ds_read_b128 v[16:19], v5 offset:51200
s_waitcnt lgkmcnt(6)
v_mfma_f32_32x32x16_bf16 v[40:55], a[176:179], v[24:27], v[40:55]
ds_read_b128 v[20:23], v5 offset:52224
s_waitcnt lgkmcnt(6)
v_mfma_f32_32x32x16_bf16 v[40:55], a[180:183], v[28:31], v[40:55]
ds_read_b128 v[24:27], v5 offset:53248
s_waitcnt lgkmcnt(6)
v_mfma_f32_32x32x16_bf16 v[40:55], a[184:187], v[32:35], v[40:55]
ds_read_b128 v[28:31], v5 offset:54272
s_waitcnt lgkmcnt(6)
v_mfma_f32_32x32x16_bf16 v[40:55], a[188:191], v[36:39], v[40:55]
ds_read_b128 v[32:35], v5 offset:55296
s_waitcnt lgkmcnt(6)
v_mfma_f32_32x32x16_bf16 v[40:55], a[192:195], v[8:11], v[40:55]
ds_read_b128 v[36:39], v5 offset:56320
s_waitcnt lgkmcnt(6)
v_mfma_f32_32x32x16_bf16 v[40:55], a[196:199], v[12:15], v[40:55]
ds_read_b128 v[8:11], v5 offset:57344
s_waitcnt lgkmcnt(6)
v_mfma_f32_32x32x16_bf16 v[40:55], a[200:203], v[16:19], v[40:55]
ds_read_b128 v[12:15], v5 offset:58368
s_waitcnt lgkmcnt(6)
v_mfma_f32_32x32x16_bf16 v[40:55], a[204:207], v[20:23], v[40:55]
ds_read_b128 v[16:19], v5 offset:59392
s_waitcnt lgkmcnt(6)
v_mfma_f32_32x32x16_bf16 v[40:55], a[208:211], v[24:27], v[40:55]
ds_read_b128 v[20:23], v5 offset:60416
s_waitcnt lgkmcnt(6)
v_mfma_f32_32x32x16_bf16 v[40:55], a[212:215], v[28:31], v[40:55]
ds_read_b128 v[24:27], v5 offset:61440
s_waitcnt vmcnt(0)
s_barrier
s_waitcnt lgkmcnt(6)
v_mfma_f32_32x32x16_bf16 v[40:55], a[216:219], v[32:35], v[40:55]
ds_read_b128 v[28:31], v5 offset:62464
s_cmp_lg_u32 s42, 0
s_cbranch_scc1 Lgup_w_194
s_mov_b64 exec, 1
buffer_store_dword v4, v3, s[4:7], s59 offen sc1
s_mov_b64 exec, -1
Lgup_w_194:
s_waitcnt lgkmcnt(6)
v_mfma_f32_32x32x16_bf16 v[40:55], a[220:223], v[36:39], v[40:55]
ds_read_b128 v[32:35], v5 offset:63488
s_waitcnt lgkmcnt(6)
v_mfma_f32_32x32x16_bf16 v[40:55], a[224:227], v[8:11], v[40:55]
ds_read_b128 v[36:39], v5 offset:64512
s_waitcnt lgkmcnt(6)
v_mfma_f32_32x32x16_bf16 v[40:55], a[228:231], v[12:15], v[40:55]
s_waitcnt lgkmcnt(5)
v_mfma_f32_32x32x16_bf16 v[40:55], a[232:235], v[16:19], v[40:55]
s_waitcnt lgkmcnt(4)
v_mfma_f32_32x32x16_bf16 v[40:55], a[236:239], v[20:23], v[40:55]
s_waitcnt lgkmcnt(3)
v_mfma_f32_32x32x16_bf16 v[40:55], a[240:243], v[24:27], v[40:55]
s_waitcnt lgkmcnt(2)
v_mfma_f32_32x32x16_bf16 v[40:55], a[244:247], v[28:31], v[40:55]
s_waitcnt lgkmcnt(1)
v_mfma_f32_32x32x16_bf16 v[40:55], a[248:251], v[32:35], v[40:55]
s_waitcnt lgkmcnt(0)
v_mfma_f32_32x32x16_bf16 v[40:55], a[252:255], v[36:39], v[40:55]
s_mov_b32 s64, s57
s_add_u32 s50, s46, 1
s_add_u32 s57, s57, s58
v_mov_b32 v4, s50
s_add_u32 s46, s46, s48
s_sub_u32 s47, s47, 1
s_waitcnt vmcnt(8)
s_branch Lgup_top1
Lgup_nop0:
s_waitcnt lgkmcnt(6)
v_mfma_f32_32x32x16_bf16 v[40:55], a[8:11], v[16:19], v[40:55]
ds_read_b128 v[12:15], v5 offset:9216
v_mul_f32 v56, v72, v72
v_mul_f32 v57, v73, v73
v_mul_f32 v58, v74, v74
v_mul_f32 v59, v75, v75
s_waitcnt lgkmcnt(6)
v_mfma_f32_32x32x16_bf16 v[40:55], a[12:15], v[20:23], v[40:55]
ds_read_b128 v[16:19], v5 offset:10240
v_mul_f32 v60, v76, v76
v_mul_f32 v61, v77, v77
v_mul_f32 v62, v78, v78
v_mul_f32 v63, v79, v79
s_waitcnt lgkmcnt(6)
v_mfma_f32_32x32x16_bf16 v[40:55], a[16:19], v[24:27], v[40:55]
ds_read_b128 v[20:23], v5 offset:11264
v_fma_f32 v56, v56, s72, v6
v_fma_f32 v57, v57, s72, v6
v_fma_f32 v58, v58, s72, v6
v_fma_f32 v59, v59, s72, v6
s_waitcnt lgkmcnt(6)
v_mfma_f32_32x32x16_bf16 v[40:55], a[20:23], v[28:31], v[40:55]
ds_read_b128 v[24:27], v5 offset:12288
v_fma_f32 v60, v60, s72, v6
v_fma_f32 v61, v61, s72, v6
v_fma_f32 v62, v62, s72, v6
v_fma_f32 v63, v63, s72, v6
s_waitcnt lgkmcnt(6)
v_mfma_f32_32x32x16_bf16 v[40:55], a[24:27], v[32:35], v[40:55]
ds_read_b128 v[28:31], v5 offset:13312
v_mul_f32 v56, v56, v72
v_mul_f32 v57, v57, v73
v_mul_f32 v58, v58, v74
v_mul_f32 v59, v59, v75
s_waitcnt lgkmcnt(6)
v_mfma_f32_32x32x16_bf16 v[40:55], a[28:31], v[36:39], v[40:55]
ds_read_b128 v[32:35], v5 offset:14336
v_mul_f32 v60, v60, v76
v_mul_f32 v61, v61, v77
v_mul_f32 v62, v62, v78
v_mul_f32 v63, v63, v79
s_waitcnt lgkmcnt(6)
v_mfma_f32_32x32x16_bf16 v[40:55], a[32:35], v[8:11], v[40:55]
ds_read_b128 v[36:39], v5 offset:15360
v_exp_f32 v56, v56
v_mul_f32 v72, v72, v80
v_exp_f32 v57, v57
s_waitcnt lgkmcnt(6)
v_mfma_f32_32x32x16_bf16 v[40:55], a[36:39], v[12:15], v[40:55]
ds_read_b128 v[8:11], v5 offset:16384
v_mul_f32 v73, v73, v81
v_exp_f32 v58, v58
v_mul_f32 v74, v74, v82
s_waitcnt lgkmcnt(6)
v_mfma_f32_32x32x16_bf16 v[40:55], a[40:43], v[16:19], v[40:55]
ds_read_b128 v[12:15], v5 offset:17408
v_exp_f32 v59, v59
v_mul_f32 v75, v75, v83
v_exp_f32 v60, v60
s_waitcnt lgkmcnt(6)
v_mfma_f32_32x32x16_bf16 v[40:55], a[44:47], v[20:23], v[40:55]
ds_read_b128 v[16:19], v5 offset:18432
v_mul_f32 v76, v76, v84
v_exp_f32 v61, v61
v_mul_f32 v77, v77, v85
s_waitcnt lgkmcnt(6)
v_mfma_f32_32x32x16_bf16 v[40:55], a[48:51], v[24:27], v[40:55]
ds_read_b128 v[20:23], v5 offset:19456
v_exp_f32 v62, v62
v_mul_f32 v78, v78, v86
v_exp_f32 v63, v63
s_waitcnt lgkmcnt(6)
v_mfma_f32_32x32x16_bf16 v[40:55], a[52:55], v[28:31], v[40:55]
ds_read_b128 v[24:27], v5 offset:20480
v_mul_f32 v79, v79, v87
v_add_f32 v56, 1.0, v56
v_add_f32 v57, 1.0, v57
v_add_f32 v58, 1.0, v58
s_waitcnt lgkmcnt(6)
v_mfma_f32_32x32x16_bf16 v[40:55], a[56:59], v[32:35], v[40:55]
ds_read_b128 v[28:31], v5 offset:21504
v_add_f32 v59, 1.0, v59
v_add_f32 v60, 1.0, v60
v_add_f32 v61, 1.0, v61
v_add_f32 v62, 1.0, v62
s_waitcnt lgkmcnt(6)
v_mfma_f32_32x32x16_bf16 v[40:55], a[60:63], v[36:39], v[40:55]
ds_read_b128 v[32:35], v5 offset:22528
v_add_f32 v63, 1.0, v63
v_rcp_f32 v56, v56
v_rcp_f32 v57, v57
s_waitcnt lgkmcnt(6)
v_mfma_f32_32x32x16_bf16 v[40:55], a[64:67], v[8:11], v[40:55]
ds_read_b128 v[36:39], v5 offset:23552
v_rcp_f32 v58, v58
v_rcp_f32 v59, v59
s_waitcnt lgkmcnt(6)
v_mfma_f32_32x32x16_bf16 v[40:55], a[68:71], v[12:15], v[40:55]
ds_read_b128 v[8:11], v5 offset:24576
v_rcp_f32 v60, v60
v_rcp_f32 v61, v61
s_waitcnt lgkmcnt(6)
v_mfma_f32_32x32x16_bf16 v[40:55], a[72:75], v[16:19], v[40:55]
ds_read_b128 v[12:15], v5 offset:25600
v_rcp_f32 v62, v62
v_rcp_f32 v63, v63
s_waitcnt lgkmcnt(6)
v_mfma_f32_32x32x16_bf16 v[40:55], a[76:79], v[20:23], v[40:55]
ds_read_b128 v[16:19], v5 offset:26624
v_mul_f32 v72, v72, v56
v_mul_f32 v73, v73, v57
v_mul_f32 v74, v74, v58
v_mul_f32 v75, v75, v59
s_waitcnt lgkmcnt(6)
v_mfma_f32_32x32x16_bf16 v[40:55], a[80:83], v[24:27], v[40:55]
ds_read_b128 v[20:23], v5 offset:27648
v_mul_f32 v76, v76, v60
v_mul_f32 v77, v77, v61
v_mul_f32 v78, v78, v62
v_mul_f32 v79, v79, v63
s_waitcnt lgkmcnt(6)
v_mfma_f32_32x32x16_bf16 v[40:55], a[84:87], v[28:31], v[40:55]
ds_read_b128 v[24:27], v5 offset:28672
v_cvt_pk_bf16_f32 v64, v72, v73
v_cvt_pk_bf16_f32 v65, v74, v75
v_cvt_pk_bf16_f32 v66, v76, v77
v_cvt_pk_bf16_f32 v67, v78, v79
s_cmp_lg_u32 s42, 0
s_cbranch_scc1 Lgup_w_195
s_waitcnt vmcnt(0)
v_cmp_gt_i32 vcc, v69, v2
s_nop 1
v_mov_b32 v70, vcc_hi
v_mov_b32 v2, vcc_lo
ds_write2_b32 v71, v70, v2 offset0:4 offset1:1
Lgup_w_195:
s_waitcnt lgkmcnt(6)
v_mfma_f32_32x32x16_bf16 v[40:55], a[88:91], v[32:35], v[40:55]
ds_read_b128 v[28:31], v5 offset:29696
buffer_store_dwordx4 v[64:67], v0, s[4:7], s64 offen sc1
s_waitcnt lgkmcnt(6)
v_mfma_f32_32x32x16_bf16 v[40:55], a[92:95], v[36:39], v[40:55]
ds_read_b128 v[32:35], v5 offset:30720
s_waitcnt vmcnt(1) lgkmcnt(2)
s_barrier
ds_read_b32 v70, v71 offset:4
s_waitcnt lgkmcnt(6)
v_mfma_f32_32x32x16_bf16 v[40:55], a[96:99], v[8:11], v[40:55]
ds_read_b128 v[36:39], v5 offset:31744
s_waitcnt lgkmcnt(6)
v_mfma_f32_32x32x16_bf16 v[40:55], a[100:103], v[12:15], v[40:55]
ds_read_b128 v[8:11], v5 offset:32768
s_waitcnt lgkmcnt(2)
v_readfirstlane_b32 s50, v70
s_nop 0
s_cmp_eq_u32 s50, 0
s_cbranch_scc1 Lgup_late0
s_waitcnt lgkmcnt(6)
v_mfma_f32_32x32x16_bf16 v[40:55], a[104:107], v[16:19], v[40:55]
ds_read_b128 v[12:15], v5 offset:33792
s_cmp_lg_u32 s42, 0
s_cbranch_scc1 Lgup_w_196
buffer_load_dword v2, v68, s[4:7], s60 offen sc1
Lgup_w_196:
s_waitcnt lgkmcnt(6)
v_mfma_f32_32x32x16_bf16 v[40:55], a[108:111], v[20:23], v[40:55]
ds_read_b128 v[16:19], v5 offset:34816
s_waitcnt lgkmcnt(6)
v_mfma_f32_32x32x16_bf16 v[40:55], a[112:115], v[24:27], v[40:55]
ds_read_b128 v[20:23], v5 offset:35840
s_waitcnt lgkmcnt(6)
v_mfma_f32_32x32x16_bf16 v[40:55], a[116:119], v[28:31], v[40:55]
ds_read_b128 v[24:27], v5 offset:36864
s_waitcnt lgkmcnt(6)
v_mfma_f32_32x32x16_bf16 v[40:55], a[120:123], v[32:35], v[40:55]
ds_read_b128 v[28:31], v5 offset:37888
s_waitcnt lgkmcnt(6)
v_mfma_f32_32x32x16_bf16 v[40:55], a[124:127], v[36:39], v[40:55]
ds_read_b128 v[32:35], v5 offset:38912
s_waitcnt lgkmcnt(6)
v_mfma_f32_32x32x16_bf16 v[40:55], a[128:131], v[8:11], v[40:55]
ds_read_b128 v[36:39], v5 offset:39936
s_waitcnt lgkmcnt(6)
v_mfma_f32_32x32x16_bf16 v[40:55], a[132:135], v[12:15], v[40:55]
ds_read_b128 v[8:11], v5 offset:40960
s_waitcnt lgkmcnt(6)
v_mfma_f32_32x32x16_bf16 v[40:55], a[136:139], v[16:19], v[40:55]
ds_read_b128 v[12:15], v5 offset:41984
s_waitcnt lgkmcnt(6)
v_mfma_f32_32x32x16_bf16 v[40:55], a[140:143], v[20:23], v[40:55]
ds_read_b128 v[16:19], v5 offset:43008
s_waitcnt lgkmcnt(6)
v_mfma_f32_32x32x16_bf16 v[40:55], a[144:147], v[24:27], v[40:55]
ds_read_b128 v[20:23], v5 offset:44032
s_waitcnt lgkmcnt(6)
v_mfma_f32_32x32x16_bf16 v[40:55], a[148:151], v[28:31], v[40:55]
ds_read_b128 v[24:27], v5 offset:45056
s_waitcnt lgkmcnt(6)
v_mfma_f32_32x32x16_bf16 v[40:55], a[152:155], v[32:35], v[40:55]
ds_read_b128 v[28:31], v5 offset:46080
s_waitcnt lgkmcnt(6)
v_mfma_f32_32x32x16_bf16 v[40:55], a[156:159], v[36:39], v[40:55]
ds_read_b128 v[32:35], v5 offset:47104
s_waitcnt lgkmcnt(6)
v_mfma_f32_32x32x16_bf16 v[40:55], a[160:163], v[8:11], v[40:55]
ds_read_b128 v[36:39], v5 offset:48128
s_waitcnt lgkmcnt(6)
v_mfma_f32_32x32x16_bf16 v[40:55], a[164:167], v[12:15], v[40:55]
ds_read_b128 v[8:11], v5 offset:49152
s_waitcnt lgkmcnt(6)
v_mfma_f32_32x32x16_bf16 v[40:55], a[168:171], v[16:19], v[40:55]
ds_read_b128 v[12:15], v5 offset:50176
s_waitcnt lgkmcnt(6)
v_mfma_f32_32x32x16_bf16 v[40:55], a[172:175], v[20:23], v[40:55]
ds_read_b128 v[16:19], v5 offset:51200
s_waitcnt lgkmcnt(6)
v_mfma_f32_32x32x16_bf16 v[40:55], a[176:179], v[24:27], v[40:55]
ds_read_b128 v[20:23], v5 offset:52224
s_waitcnt lgkmcnt(6)
v_mfma_f32_32x32x16_bf16 v[40:55], a[180:183], v[28:31], v[40:55]
ds_read_b128 v[24:27], v5 offset:53248
s_waitcnt lgkmcnt(6)
v_mfma_f32_32x32x16_bf16 v[40:55], a[184:187], v[32:35], v[40:55]
ds_read_b128 v[28:31], v5 offset:54272
s_waitcnt lgkmcnt(6)
v_mfma_f32_32x32x16_bf16 v[40:55], a[188:191], v[36:39], v[40:55]
ds_read_b128 v[32:35], v5 offset:55296
s_waitcnt lgkmcnt(6)
v_mfma_f32_32x32x16_bf16 v[40:55], a[192:195], v[8:11], v[40:55]
ds_read_b128 v[36:39], v5 offset:56320
s_waitcnt lgkmcnt(6)
v_mfma_f32_32x32x16_bf16 v[40:55], a[196:199], v[12:15], v[40:55]
ds_read_b128 v[8:11], v5 offset:57344
s_waitcnt lgkmcnt(6)
v_mfma_f32_32x32x16_bf16 v[40:55], a[200:203], v[16:19], v[40:55]
ds_read_b128 v[12:15], v5 offset:58368
s_waitcnt lgkmcnt(6)
v_mfma_f32_32x32x16_bf16 v[40:55], a[204:207], v[20:23], v[40:55]
ds_read_b128 v[16:19], v5 offset:59392
s_waitcnt lgkmcnt(6)
v_mfma_f32_32x32x16_bf16 v[40:55], a[208:211], v[24:27], v[40:55]
ds_read_b128 v[20:23], v5 offset:60416
s_waitcnt lgkmcnt(6)
v_mfma_f32_32x32x16_bf16 v[40:55], a[212:215], v[28:31], v[40:55]
ds_read_b128 v[24:27], v5 offset:61440
s_cmp_eq_u32 s42, 0
s_cbranch_scc1 Lgup_z_197
s_waitcnt vmcnt(0)
Lgup_z_197:
s_waitcnt vmcnt(1)
s_barrier
s_waitcnt lgkmcnt(6)
v_mfma_f32_32x32x16_bf16 v[40:55], a[216:219], v[32:35], v[40:55]
ds_read_b128 v[28:31], v5 offset:62464
s_cmp_lg_u32 s42, 0
s_cbranch_scc1 Lgup_w_198
s_mov_b64 exec, 1
buffer_store_dword v4, v3, s[4:7], s59 offen sc1
s_mov_b64 exec, -1
Lgup_w_198:
s_waitcnt lgkmcnt(6)
v_mfma_f32_32x32x16_bf16 v[40:55], a[220:223], v[36:39], v[40:55]
ds_read_b128 v[32:35], v5 offset:63488
s_cmp_lg_u32 s42, 0
s_cbranch_scc1 Lgup_w_199
s_waitcnt vmcnt(1)
v_cmp_gt_i32 vcc, v69, v2
s_nop 1
v_mov_b32 v70, vcc_hi
v_mov_b32 v2, vcc_lo
ds_write2_b32 v71, v70, v2 offset0:4 offset1:2
Lgup_w_199:
s_waitcnt lgkmcnt(6)
v_mfma_f32_32x32x16_bf16 v[40:55], a[224:227], v[8:11], v[40:55]
ds_read_b128 v[36:39], v5 offset:64512
s_waitcnt lgkmcnt(6)
v_mfma_f32_32x32x16_bf16 v[40:55], a[228:231], v[12:15], v[40:55]
s_waitcnt lgkmcnt(0)
s_barrier
ds_read_b32 v70, v71 offset:8
s_waitcnt lgkmcnt(5)
v_mfma_f32_32x32x16_bf16 v[40:55], a[232:235], v[16:19], v[40:55]
s_waitcnt lgkmcnt(4)
v_mfma_f32_32x32x16_bf16 v[40:55], a[236:239], v[20:23], v[40:55]
s_waitcnt lgkmcnt(0)
v_readfirstlane_b32 s50, v70
s_nop 0
s_cmp_eq_u32 s50, 0
s_cbranch_scc1 Lgup_late20
s_waitcnt lgkmcnt(3)
v_mfma_f32_32x32x16_bf16 v[40:55], a[240:243], v[24:27], v[40:55]
s_waitcnt lgkmcnt(2)
v_mfma_f32_32x32x16_bf16 v[40:55], a[244:247], v[28:31], v[40:55]
s_waitcnt lgkmcnt(1)
v_mfma_f32_32x32x16_bf16 v[40:55], a[248:251], v[32:35], v[40:55]
s_waitcnt lgkmcnt(0)
v_mfma_f32_32x32x16_bf16 v[40:55], a[252:255], v[36:39], v[40:55]
s_mov_b32 s64, s57
s_add_u32 s50, s46, 1
s_add_u32 s57, s57, s58
v_mov_b32 v4, s50
s_nop 7
v_pk_mul_f32 v[56:57], v[40:41], v[40:41]
v_pk_mul_f32 v[58:59], v[42:43], v[42:43]
v_pk_mul_f32 v[60:61], v[44:45], v[44:45]
v_pk_mul_f32 v[62:63], v[46:47], v[46:47]
v_pk_fma_f32 v[56:57], v[56:57], s[72:73], v[6:7]
v_pk_fma_f32 v[58:59], v[58:59], s[72:73], v[6:7]
v_pk_fma_f32 v[60:61], v[60:61], s[72:73], v[6:7]
v_pk_fma_f32 v[62:63], v[62:63], s[72:73], v[6:7]
v_pk_mul_f32 v[56:57], v[56:57], v[40:41]
v_pk_mul_f32 v[58:59], v[58:59], v[42:43]
v_pk_mul_f32 v[60:61], v[60:61], v[44:45]
v_pk_mul_f32 v[62:63], v[62:63], v[46:47]
v_exp_f32 v56, v56
v_exp_f32 v57, v57
v_exp_f32 v58, v58
v_exp_f32 v59, v59
v_exp_f32 v60, v60
v_exp_f32 v61, v61
v_exp_f32 v62, v62
v_exp_f32 v63, v63
v_pk_mul_f32 v[40:41], v[40:41], v[48:49]
v_pk_mul_f32 v[42:43], v[42:43], v[50:51]
v_pk_mul_f32 v[44:45], v[44:45], v[52:53]
v_pk_mul_f32 v[46:47], v[46:47], v[54:55]
v_pk_add_f32 v[56:57], v[56:57], 1.0 op_sel_hi:[1,0]
v_pk_add_f32 v[58:59], v[58:59], 1.0 op_sel_hi:[1,0]
v_pk_add_f32 v[60:61], v[60:61], 1.0 op_sel_hi:[1,0]
v_pk_add_f32 v[62:63], v[62:63], 1.0 op_sel_hi:[1,0]
v_rcp_f32 v56, v56
v_rcp_f32 v57, v57
v_rcp_f32 v58, v58
v_rcp_f32 v59, v59
v_rcp_f32 v60, v60
v_rcp_f32 v61, v61
v_rcp_f32 v62, v62
v_rcp_f32 v63, v63
v_pk_mul_f32 v[40:41], v[40:41], v[56:57]
v_pk_mul_f32 v[42:43], v[42:43], v[58:59]
v_pk_mul_f32 v[44:45], v[44:45], v[60:61]
v_pk_mul_f32 v[46:47], v[46:47], v[62:63]
v_cvt_pk_bf16_f32 v64, v40, v41
v_cvt_pk_bf16_f32 v65, v42, v43
v_cvt_pk_bf16_f32 v66, v44, v45
v_cvt_pk_bf16_f32 v67, v46, v47
buffer_store_dwordx4 v[64:67], v0, s[4:7], s64 offen sc1
s_cmp_lg_u32 s42, 0
s_cbranch_scc1 Lgup_w_200
buffer_load_dword v2, v68, s[4:7], s60 offen sc1
s_waitcnt vmcnt(0)
v_cmp_gt_i32 vcc, v69, v2
s_nop 1
v_mov_b32 v70, vcc_hi
v_mov_b32 v2, vcc_lo
ds_write2_b32 v71, v70, v2 offset1:1
s_waitcnt lgkmcnt(0)
Lgup_w_200:
s_add_u32 s46, s46, s48
s_sub_u32 s47, s47, 1
s_waitcnt vmcnt(0)
s_barrier
ds_read_b32 v70, v71 offset:4
s_cmp_lg_u32 s42, 0
s_cbranch_scc1 Lgup_w_201
s_mov_b64 exec, 1
buffer_store_dword v4, v3, s[4:7], s59 offen sc1
s_mov_b64 exec, -1
Lgup_w_201:
s_waitcnt lgkmcnt(0)
v_readfirstlane_b32 s50, v70
s_nop 0
s_cmp_eq_u32 s50, 0
s_cbranch_scc1 Lgup_fetch
s_branch Lgup_cold
Lgup_late0:
s_waitcnt lgkmcnt(6)
v_mfma_f32_32x32x16_bf16 v[40:55], a[104:107], v[16:19], v[40:55]
ds_read_b128 v[12:15], v5 offset:33792
s_add_u32 m0, s54, 0
s_add_u32 s55, s53, 0
buffer_load_dwordx4 v0, s[4:7], s55 offen sc1 lds
s_waitcnt lgkmcnt(6)
v_mfma_f32_32x32x16_bf16 v[40:55], a[108:111], v[20:23], v[40:55]
ds_read_b128 v[16:19], v5 offset:34816
s_add_u32 m0, s54, 4096
s_add_u32 s55, s53, 4096
buffer_load_dwordx4 v0, s[4:7], s55 offen sc1 lds
s_waitcnt lgkmcnt(6)
v_mfma_f32_32x32x16_bf16 v[40:55], a[112:115], v[24:27], v[40:55]
ds_read_b128 v[20:23], v5 offset:35840
s_add_u32 m0, s54, 8192
s_add_u32 s55, s53, 8192
buffer_load_dwordx4 v0, s[4:7], s55 offen sc1 lds
s_waitcnt lgkmcnt(6)
v_mfma_f32_32x32x16_bf16 v[40:55], a[116:119], v[28:31], v[40:55]
ds_read_b128 v[24:27], v5 offset:36864
s_add_u32 m0, s54, 12288
s_add_u32 s55, s53, 12288
buffer_load_dwordx4 v0, s[4:7], s55 offen sc1 lds
s_waitcnt lgkmcnt(6)
v_mfma_f32_32x32x16_bf16 v[40:55], a[120:123], v[32:35], v[40:55]
ds_read_b128 v[28:31], v5 offset:37888
s_add_u32 m0, s54, 16384
s_add_u32 s55, s53, 16384
buffer_load_dwordx4 v0, s[4:7], s55 offen sc1 lds
s_waitcnt lgkmcnt(6)
v_mfma_f32_32x32x16_bf16 v[40:55], a[124:127], v[36:39], v[40:55]
ds_read_b128 v[32:35], v5 offset:38912
s_add_u32 m0, s54, 20480
s_add_u32 s55, s53, 20480
buffer_load_dwordx4 v0, s[4:7], s55 offen sc1 lds
s_waitcnt lgkmcnt(6)
v_mfma_f32_32x32x16_bf16 v[40:55], a[128:131], v[8:11], v[40:55]
ds_read_b128 v[36:39], v5 offset:39936
s_add_u32 m0, s54, 24576
s_add_u32 s55, s53, 24576
buffer_load_dwordx4 v0, s[4:7], s55 offen sc1 lds
s_waitcnt lgkmcnt(6)
v_mfma_f32_32x32x16_bf16 v[40:55], a[132:135], v[12:15], v[40:55]
ds_read_b128 v[8:11], v5 offset:40960
s_add_u32 m0, s54, 28672
s_add_u32 s55, s53, 28672
buffer_load_dwordx4 v0, s[4:7], s55 offen sc1 lds
s_waitcnt lgkmcnt(6)
v_mfma_f32_32x32x16_bf16 v[40:55], a[136:139], v[16:19], v[40:55]
ds_read_b128 v[12:15], v5 offset:41984
s_add_u32 m0, s54, 32768
s_add_u32 s55, s53, 32768
buffer_load_dwordx4 v0, s[4:7], s55 offen sc1 lds
s_waitcnt lgkmcnt(6)
v_mfma_f32_32x32x16_bf16 v[40:55], a[140:143], v[20:23], v[40:55]
ds_read_b128 v[16:19], v5 offset:43008
s_waitcnt lgkmcnt(6)
v_mfma_f32_32x32x16_bf16 v[40:55], a[144:147], v[24:27], v[40:55]
ds_read_b128 v[20:23], v5 offset:44032
s_add_u32 m0, s54, 36864
s_add_u32 s55, s53, 36864
buffer_load_dwordx4 v0, s[4:7], s55 offen sc1 lds
s_waitcnt lgkmcnt(6)
v_mfma_f32_32x32x16_bf16 v[40:55], a[148:151], v[28:31], v[40:55]
ds_read_b128 v[24:27], v5 offset:45056
s_waitcnt lgkmcnt(6)
v_mfma_f32_32x32x16_bf16 v[40:55], a[152:155], v[32:35], v[40:55]
ds_read_b128 v[28:31], v5 offset:46080
s_add_u32 m0, s54, 40960
s_add_u32 s55, s53, 40960
buffer_load_dwordx4 v0, s[4:7], s55 offen sc1 lds
s_waitcnt lgkmcnt(6)
v_mfma_f32_32x32x16_bf16 v[40:55], a[156:159], v[36:39], v[40:55]
ds_read_b128 v[32:35], v5 offset:47104
s_waitcnt lgkmcnt(6)
v_mfma_f32_32x32x16_bf16 v[40:55], a[160:163], v[8:11], v[40:55]
ds_read_b128 v[36:39], v5 offset:48128
s_add_u32 m0, s54, 45056
s_add_u32 s55, s53, 45056
buffer_load_dwordx4 v0, s[4:7], s55 offen sc1 lds
s_waitcnt lgkmcnt(6)
v_mfma_f32_32x32x16_bf16 v[40:55], a[164:167], v[12:15], v[40:55]
ds_read_b128 v[8:11], v5 offset:49152
s_waitcnt lgkmcnt(6)
v_mfma_f32_32x32x16_bf16 v[40:55], a[168:171], v[16:19], v[40:55]
ds_read_b128 v[12:15], v5 offset:50176
s_add_u32 m0, s54, 49152
s_add_u32 s55, s53, 49152
buffer_load_dwordx4 v0, s[4:7], s55 offen sc1 lds
s_waitcnt lgkmcnt(6)
v_mfma_f32_32x32x16_bf16 v[40:55], a[172:175], v[20:23], v[40:55]
ds_read_b128 v[16:19], v5 offset:51200
s_waitcnt lgkmcnt(6)
v_mfma_f32_32x32x16_bf16 v[40:55], a[176:179], v[24:27], v[40:55]
ds_read_b128 v[20:23], v5 offset:52224
s_add_u32 m0, s54, 53248
s_add_u32 s55, s53, 53248
buffer_load_dwordx4 v0, s[4:7], s55 offen sc1 lds
s_waitcnt lgkmcnt(6)
v_mfma_f32_32x32x16_bf16 v[40:55], a[180:183], v[28:31], v[40:55]
ds_read_b128 v[24:27], v5 offset:53248
s_waitcnt lgkmcnt(6)
v_mfma_f32_32x32x16_bf16 v[40:55], a[184:187], v[32:35], v[40:55]
ds_read_b128 v[28:31], v5 offset:54272
s_add_u32 m0, s54, 57344
s_add_u32 s55, s53, 57344
buffer_load_dwordx4 v0, s[4:7], s55 offen sc1 lds
s_waitcnt lgkmcnt(6)
v_mfma_f32_32x32x16_bf16 v[40:55], a[188:191], v[36:39], v[40:55]
ds_read_b128 v[32:35], v5 offset:55296
s_waitcnt lgkmcnt(6)
v_mfma_f32_32x32x16_bf16 v[40:55], a[192:195], v[8:11], v[40:55]
ds_read_b128 v[36:39], v5 offset:56320
s_add_u32 m0, s54, 61440
s_add_u32 s55, s53, 61440
buffer_load_dwordx4 v0, s[4:7], s55 offen sc1 lds
s_waitcnt lgkmcnt(6)
v_mfma_f32_32x32x16_bf16 v[40:55], a[196:199], v[12:15], v[40:55]
ds_read_b128 v[8:11], v5 offset:57344
s_waitcnt lgkmcnt(6)
v_mfma_f32_32x32x16_bf16 v[40:55], a[200:203], v[16:19], v[40:55]
ds_read_b128 v[12:15], v5 offset:58368
s_waitcnt lgkmcnt(6)
v_mfma_f32_32x32x16_bf16 v[40:55], a[204:207], v[20:23], v[40:55]
ds_read_b128 v[16:19], v5 offset:59392
s_waitcnt lgkmcnt(6)
v_mfma_f32_32x32x16_bf16 v[40:55], a[208:211], v[24:27], v[40:55]
ds_read_b128 v[20:23], v5 offset:60416
s_waitcnt lgkmcnt(6)
v_mfma_f32_32x32x16_bf16 v[40:55], a[212:215], v[28:31], v[40:55]
ds_read_b128 v[24:27], v5 offset:61440
s_waitcnt vmcnt(16)
s_barrier
s_waitcnt lgkmcnt(6)
v_mfma_f32_32x32x16_bf16 v[40:55], a[216:219], v[32:35], v[40:55]
ds_read_b128 v[28:31], v5 offset:62464
s_cmp_lg_u32 s42, 0
s_cbranch_scc1 Lgup_w_202
s_mov_b64 exec, 1
buffer_store_dword v4, v3, s[4:7], s59 offen sc1
s_mov_b64 exec, -1
Lgup_w_202:
s_waitcnt lgkmcnt(6)
v_mfma_f32_32x32x16_bf16 v[40:55], a[220:223], v[36:39], v[40:55]
ds_read_b128 v[32:35], v5 offset:63488
s_waitcnt lgkmcnt(6)
v_mfma_f32_32x32x16_bf16 v[40:55], a[224:227], v[8:11], v[40:55]
ds_read_b128 v[36:39], v5 offset:64512
s_waitcnt lgkmcnt(6)
v_mfma_f32_32x32x16_bf16 v[40:55], a[228:231], v[12:15], v[40:55]
s_waitcnt lgkmcnt(5)
v_mfma_f32_32x32x16_bf16 v[40:55], a[232:235], v[16:19], v[40:55]
s_waitcnt lgkmcnt(4)
v_mfma_f32_32x32x16_bf16 v[40:55], a[236:239], v[20:23], v[40:55]
s_waitcnt lgkmcnt(3)
v_mfma_f32_32x32x16_bf16 v[40:55], a[240:243], v[24:27], v[40:55]
s_waitcnt lgkmcnt(2)
v_mfma_f32_32x32x16_bf16 v[40:55], a[244:247], v[28:31], v[40:55]
s_waitcnt lgkmcnt(1)
v_mfma_f32_32x32x16_bf16 v[40:55], a[248:251], v[32:35], v[40:55]
s_waitcnt lgkmcnt(0)
v_mfma_f32_32x32x16_bf16 v[40:55], a[252:255], v[36:39], v[40:55]
s_mov_b32 s64, s57
s_add_u32 s50, s46, 1
s_add_u32 s57, s57, s58
v_mov_b32 v4, s50
s_add_u32 s46, s46, s48
s_sub_u32 s47, s47, 1
s_waitcnt vmcnt(8)
s_branch Lgup_top1
Lgup_late20:
s_waitcnt lgkmcnt(3)
v_mfma_f32_32x32x16_bf16 v[40:55], a[240:243], v[24:27], v[40:55]
s_waitcnt lgkmcnt(2)
v_mfma_f32_32x32x16_bf16 v[40:55], a[244:247], v[28:31], v[40:55]
s_waitcnt lgkmcnt(1)
v_mfma_f32_32x32x16_bf16 v[40:55], a[248:251], v[32:35], v[40:55]
s_waitcnt lgkmcnt(0)
v_mfma_f32_32x32x16_bf16 v[40:55], a[252:255], v[36:39], v[40:55]
s_mov_b32 s64, s57
s_add_u32 s50, s46, 1
s_add_u32 s57, s57, s58
v_mov_b32 v4, s50
s_nop 7
v_pk_mul_f32 v[56:57], v[40:41], v[40:41]
v_pk_mul_f32 v[58:59], v[42:43], v[42:43]
v_pk_mul_f32 v[60:61], v[44:45], v[44:45]
v_pk_mul_f32 v[62:63], v[46:47], v[46:47]
v_pk_fma_f32 v[56:57], v[56:57], s[72:73], v[6:7]
v_pk_fma_f32 v[58:59], v[58:59], s[72:73], v[6:7]
v_pk_fma_f32 v[60:61], v[60:61], s[72:73], v[6:7]
v_pk_fma_f32 v[62:63], v[62:63], s[72:73], v[6:7]
v_pk_mul_f32 v[56:57], v[56:57], v[40:41]
v_pk_mul_f32 v[58:59], v[58:59], v[42:43]
v_pk_mul_f32 v[60:61], v[60:61], v[44:45]
v_pk_mul_f32 v[62:63], v[62:63], v[46:47]
v_exp_f32 v56, v56
v_exp_f32 v57, v57
v_exp_f32 v58, v58
v_exp_f32 v59, v59
v_exp_f32 v60, v60
v_exp_f32 v61, v61
v_exp_f32 v62, v62
v_exp_f32 v63, v63
v_pk_mul_f32 v[40:41], v[40:41], v[48:49]
v_pk_mul_f32 v[42:43], v[42:43], v[50:51]
v_pk_mul_f32 v[44:45], v[44:45], v[52:53]
v_pk_mul_f32 v[46:47], v[46:47], v[54:55]
v_pk_add_f32 v[56:57], v[56:57], 1.0 op_sel_hi:[1,0]
v_pk_add_f32 v[58:59], v[58:59], 1.0 op_sel_hi:[1,0]
v_pk_add_f32 v[60:61], v[60:61], 1.0 op_sel_hi:[1,0]
v_pk_add_f32 v[62:63], v[62:63], 1.0 op_sel_hi:[1,0]
v_rcp_f32 v56, v56
v_rcp_f32 v57, v57
v_rcp_f32 v58, v58
v_rcp_f32 v59, v59
v_rcp_f32 v60, v60
v_rcp_f32 v61, v61
v_rcp_f32 v62, v62
v_rcp_f32 v63, v63
v_pk_mul_f32 v[40:41], v[40:41], v[56:57]
v_pk_mul_f32 v[42:43], v[42:43], v[58:59]
v_pk_mul_f32 v[44:45], v[44:45], v[60:61]
v_pk_mul_f32 v[46:47], v[46:47], v[62:63]
v_cvt_pk_bf16_f32 v64, v40, v41
v_cvt_pk_bf16_f32 v65, v42, v43
v_cvt_pk_bf16_f32 v66, v44, v45
v_cvt_pk_bf16_f32 v67, v46, v47
buffer_store_dwordx4 v[64:67], v0, s[4:7], s64 offen sc1
s_add_u32 s46, s46, s48
s_sub_u32 s47, s47, 1
s_add_u32 m0, s54, 0
s_add_u32 s55, s53, 0
buffer_load_dwordx4 v0, s[4:7], s55 offen sc1 lds
s_add_u32 m0, s54, 4096
s_add_u32 s55, s53, 4096
buffer_load_dwordx4 v0, s[4:7], s55 offen sc1 lds
s_add_u32 m0, s54, 8192
s_add_u32 s55, s53, 8192
buffer_load_dwordx4 v0, s[4:7], s55 offen sc1 lds
s_add_u32 m0, s54, 12288
s_add_u32 s55, s53, 12288
buffer_load_dwordx4 v0, s[4:7], s55 offen sc1 lds
s_add_u32 m0, s54, 16384
s_add_u32 s55, s53, 16384
buffer_load_dwordx4 v0, s[4:7], s55 offen sc1 lds
s_add_u32 m0, s54, 20480
s_add_u32 s55, s53, 20480
buffer_load_dwordx4 v0, s[4:7], s55 offen sc1 lds
s_add_u32 m0, s54, 24576
s_add_u32 s55, s53, 24576
buffer_load_dwordx4 v0, s[4:7], s55 offen sc1 lds
s_add_u32 m0, s54, 28672
s_add_u32 s55, s53, 28672
buffer_load_dwordx4 v0, s[4:7], s55 offen sc1 lds
s_add_u32 m0, s54, 32768
s_add_u32 s55, s53, 32768
buffer_load_dwordx4 v0, s[4:7], s55 offen sc1 lds
s_add_u32 m0, s54, 36864
s_add_u32 s55, s53, 36864
buffer_load_dwordx4 v0, s[4:7], s55 offen sc1 lds
s_add_u32 m0, s54, 40960
s_add_u32 s55, s53, 40960
buffer_load_dwordx4 v0, s[4:7], s55 offen sc1 lds
s_add_u32 m0, s54, 45056
s_add_u32 s55, s53, 45056
buffer_load_dwordx4 v0, s[4:7], s55 offen sc1 lds
s_add_u32 m0, s54, 49152
s_add_u32 s55, s53, 49152
buffer_load_dwordx4 v0, s[4:7], s55 offen sc1 lds
s_add_u32 m0, s54, 53248
s_add_u32 s55, s53, 53248
buffer_load_dwordx4 v0, s[4:7], s55 offen sc1 lds
s_add_u32 m0, s54, 57344
s_add_u32 s55, s53, 57344
buffer_load_dwordx4 v0, s[4:7], s55 offen sc1 lds
s_add_u32 m0, s54, 61440
s_add_u32 s55, s53, 61440
buffer_load_dwordx4 v0, s[4:7], s55 offen sc1 lds
s_lshl_b32 s64, s40, 14
s_lshl_b32 s50, s42, 11
s_add_u32 s64, s64, s50
s_add_u32 s64, s64, 155189248
s_waitcnt vmcnt(16)
s_barrier
s_cmp_lg_u32 s42, 0
s_cbranch_scc1 Lgup_w_203
s_mov_b64 exec, 1
buffer_store_dword v4, v3, s[4:7], s59 offen sc1
s_mov_b64 exec, -1
Lgup_w_203:
s_waitcnt vmcnt(8)
s_branch Lgup_top1
Lgup_last0:
s_waitcnt lgkmcnt(6)
v_mfma_f32_32x32x16_bf16 v[40:55], a[8:11], v[16:19], v[40:55]
ds_read_b128 v[12:15], v5 offset:9216
v_mul_f32 v56, v72, v72
v_mul_f32 v57, v73, v73
v_mul_f32 v58, v74, v74
v_mul_f32 v59, v75, v75
s_waitcnt lgkmcnt(6)
v_mfma_f32_32x32x16_bf16 v[40:55], a[12:15], v[20:23], v[40:55]
ds_read_b128 v[16:19], v5 offset:10240
v_mul_f32 v60, v76, v76
v_mul_f32 v61, v77, v77
v_mul_f32 v62, v78, v78
v_mul_f32 v63, v79, v79
s_waitcnt lgkmcnt(6)
v_mfma_f32_32x32x16_bf16 v[40:55], a[16:19], v[24:27], v[40:55]
ds_read_b128 v[20:23], v5 offset:11264
v_fma_f32 v56, v56, s72, v6
v_fma_f32 v57, v57, s72, v6
v_fma_f32 v58, v58, s72, v6
v_fma_f32 v59, v59, s72, v6
s_waitcnt lgkmcnt(6)
v_mfma_f32_32x32x16_bf16 v[40:55], a[20:23], v[28:31], v[40:55]
ds_read_b128 v[24:27], v5 offset:12288
v_fma_f32 v60, v60, s72, v6
v_fma_f32 v61, v61, s72, v6
v_fma_f32 v62, v62, s72, v6
v_fma_f32 v63, v63, s72, v6
s_waitcnt lgkmcnt(6)
v_mfma_f32_32x32x16_bf16 v[40:55], a[24:27], v[32:35], v[40:55]
ds_read_b128 v[28:31], v5 offset:13312
v_mul_f32 v56, v56, v72
v_mul_f32 v57, v57, v73
v_mul_f32 v58, v58, v74
v_mul_f32 v59, v59, v75
s_waitcnt lgkmcnt(6)
v_mfma_f32_32x32x16_bf16 v[40:55], a[28:31], v[36:39], v[40:55]
ds_read_b128 v[32:35], v5 offset:14336
v_mul_f32 v60, v60, v76
v_mul_f32 v61, v61, v77
v_mul_f32 v62, v62, v78
v_mul_f32 v63, v63, v79
s_waitcnt lgkmcnt(6)
v_mfma_f32_32x32x16_bf16 v[40:55], a[32:35], v[8:11], v[40:55]
ds_read_b128 v[36:39], v5 offset:15360
v_exp_f32 v56, v56
v_mul_f32 v72, v72, v80
v_exp_f32 v57, v57
s_waitcnt lgkmcnt(6)
v_mfma_f32_32x32x16_bf16 v[40:55], a[36:39], v[12:15], v[40:55]
ds_read_b128 v[8:11], v5 offset:16384
v_mul_f32 v73, v73, v81
v_exp_f32 v58, v58
v_mul_f32 v74, v74, v82
s_waitcnt lgkmcnt(6)
v_mfma_f32_32x32x16_bf16 v[40:55], a[40:43], v[16:19], v[40:55]
ds_read_b128 v[12:15], v5 offset:17408
v_exp_f32 v59, v59
v_mul_f32 v75, v75, v83
v_exp_f32 v60, v60
s_waitcnt lgkmcnt(6)
v_mfma_f32_32x32x16_bf16 v[40:55], a[44:47], v[20:23], v[40:55]
ds_read_b128 v[16:19], v5 offset:18432
v_mul_f32 v76, v76, v84
v_exp_f32 v61, v61
v_mul_f32 v77, v77, v85
s_waitcnt lgkmcnt(6)
v_mfma_f32_32x32x16_bf16 v[40:55], a[48:51], v[24:27], v[40:55]
ds_read_b128 v[20:23], v5 offset:19456
v_exp_f32 v62, v62
v_mul_f32 v78, v78, v86
v_exp_f32 v63, v63
s_waitcnt lgkmcnt(6)
v_mfma_f32_32x32x16_bf16 v[40:55], a[52:55], v[28:31], v[40:55]
ds_read_b128 v[24:27], v5 offset:20480
v_mul_f32 v79, v79, v87
v_add_f32 v56, 1.0, v56
v_add_f32 v57, 1.0, v57
v_add_f32 v58, 1.0, v58
s_waitcnt lgkmcnt(6)
v_mfma_f32_32x32x16_bf16 v[40:55], a[56:59], v[32:35], v[40:55]
ds_read_b128 v[28:31], v5 offset:21504
v_add_f32 v59, 1.0, v59
v_add_f32 v60, 1.0, v60
v_add_f32 v61, 1.0, v61
v_add_f32 v62, 1.0, v62
s_waitcnt lgkmcnt(6)
v_mfma_f32_32x32x16_bf16 v[40:55], a[60:63], v[36:39], v[40:55]
ds_read_b128 v[32:35], v5 offset:22528
v_add_f32 v63, 1.0, v63
v_rcp_f32 v56, v56
v_rcp_f32 v57, v57
s_waitcnt lgkmcnt(6)
v_mfma_f32_32x32x16_bf16 v[40:55], a[64:67], v[8:11], v[40:55]
ds_read_b128 v[36:39], v5 offset:23552
v_rcp_f32 v58, v58
v_rcp_f32 v59, v59
s_waitcnt lgkmcnt(6)
v_mfma_f32_32x32x16_bf16 v[40:55], a[68:71], v[12:15], v[40:55]
ds_read_b128 v[8:11], v5 offset:24576
v_rcp_f32 v60, v60
v_rcp_f32 v61, v61
s_waitcnt lgkmcnt(6)
v_mfma_f32_32x32x16_bf16 v[40:55], a[72:75], v[16:19], v[40:55]
ds_read_b128 v[12:15], v5 offset:25600
v_rcp_f32 v62, v62
v_rcp_f32 v63, v63
s_waitcnt lgkmcnt(6)
v_mfma_f32_32x32x16_bf16 v[40:55], a[76:79], v[20:23], v[40:55]
ds_read_b128 v[16:19], v5 offset:26624
v_mul_f32 v72, v72, v56
v_mul_f32 v73, v73, v57
v_mul_f32 v74, v74, v58
v_mul_f32 v75, v75, v59
s_waitcnt lgkmcnt(6)
v_mfma_f32_32x32x16_bf16 v[40:55], a[80:83], v[24:27], v[40:55]
ds_read_b128 v[20:23], v5 offset:27648
v_mul_f32 v76, v76, v60
v_mul_f32 v77, v77, v61
v_mul_f32 v78, v78, v62
v_mul_f32 v79, v79, v63
s_waitcnt lgkmcnt(6)
v_mfma_f32_32x32x16_bf16 v[40:55], a[84:87], v[28:31], v[40:55]
ds_read_b128 v[24:27], v5 offset:28672
v_cvt_pk_bf16_f32 v64, v72, v73
v_cvt_pk_bf16_f32 v65, v74, v75
v_cvt_pk_bf16_f32 v66, v76, v77
v_cvt_pk_bf16_f32 v67, v78, v79
s_waitcnt lgkmcnt(6)
v_mfma_f32_32x32x16_bf16 v[40:55], a[88:91], v[32:35], v[40:55]
ds_read_b128 v[28:31], v5 offset:29696
buffer_store_dwordx4 v[64:67], v0, s[4:7], s64 offen sc1
s_waitcnt lgkmcnt(6)
v_mfma_f32_32x32x16_bf16 v[40:55], a[92:95], v[36:39], v[40:55]
ds_read_b128 v[32:35], v5 offset:30720
s_waitcnt vmcnt(1) lgkmcnt(2)
s_barrier
s_waitcnt lgkmcnt(6)
v_mfma_f32_32x32x16_bf16 v[40:55], a[96:99], v[8:11], v[40:55]
ds_read_b128 v[36:39], v5 offset:31744
s_waitcnt lgkmcnt(6)
v_mfma_f32_32x32x16_bf16 v[40:55], a[100:103], v[12:15], v[40:55]
ds_read_b128 v[8:11], v5 offset:32768
s_waitcnt lgkmcnt(6)
v_mfma_f32_32x32x16_bf16 v[40:55], a[104:107], v[16:19], v[40:55]
ds_read_b128 v[12:15], v5 offset:33792
s_waitcnt lgkmcnt(6)
v_mfma_f32_32x32x16_bf16 v[40:55], a[108:111], v[20:23], v[40:55]
ds_read_b128 v[16:19], v5 offset:34816
s_waitcnt lgkmcnt(6)
v_mfma_f32_32x32x16_bf16 v[40:55], a[112:115], v[24:27], v[40:55]
ds_read_b128 v[20:23], v5 offset:35840
s_waitcnt lgkmcnt(6)
v_mfma_f32_32x32x16_bf16 v[40:55], a[116:119], v[28:31], v[40:55]
ds_read_b128 v[24:27], v5 offset:36864
s_waitcnt lgkmcnt(6)
v_mfma_f32_32x32x16_bf16 v[40:55], a[120:123], v[32:35], v[40:55]
ds_read_b128 v[28:31], v5 offset:37888
s_waitcnt lgkmcnt(6)
v_mfma_f32_32x32x16_bf16 v[40:55], a[124:127], v[36:39], v[40:55]
ds_read_b128 v[32:35], v5 offset:38912
s_waitcnt lgkmcnt(6)
v_mfma_f32_32x32x16_bf16 v[40:55], a[128:131], v[8:11], v[40:55]
ds_read_b128 v[36:39], v5 offset:39936
s_waitcnt lgkmcnt(6)
v_mfma_f32_32x32x16_bf16 v[40:55], a[132:135], v[12:15], v[40:55]
ds_read_b128 v[8:11], v5 offset:40960
s_waitcnt lgkmcnt(6)
v_mfma_f32_32x32x16_bf16 v[40:55], a[136:139], v[16:19], v[40:55]
ds_read_b128 v[12:15], v5 offset:41984
s_waitcnt lgkmcnt(6)
v_mfma_f32_32x32x16_bf16 v[40:55], a[140:143], v[20:23], v[40:55]
ds_read_b128 v[16:19], v5 offset:43008
s_waitcnt lgkmcnt(6)
v_mfma_f32_32x32x16_bf16 v[40:55], a[144:147], v[24:27], v[40:55]
ds_read_b128 v[20:23], v5 offset:44032
s_waitcnt lgkmcnt(6)
v_mfma_f32_32x32x16_bf16 v[40:55], a[148:151], v[28:31], v[40:55]
ds_read_b128 v[24:27], v5 offset:45056
s_waitcnt lgkmcnt(6)
v_mfma_f32_32x32x16_bf16 v[40:55], a[152:155], v[32:35], v[40:55]
ds_read_b128 v[28:31], v5 offset:46080
s_waitcnt lgkmcnt(6)
v_mfma_f32_32x32x16_bf16 v[40:55], a[156:159], v[36:39], v[40:55]
ds_read_b128 v[32:35], v5 offset:47104
s_waitcnt lgkmcnt(6)
v_mfma_f32_32x32x16_bf16 v[40:55], a[160:163], v[8:11], v[40:55]
ds_read_b128 v[36:39], v5 offset:48128
s_waitcnt lgkmcnt(6)
v_mfma_f32_32x32x16_bf16 v[40:55], a[164:167], v[12:15], v[40:55]
ds_read_b128 v[8:11], v5 offset:49152
s_waitcnt lgkmcnt(6)
v_mfma_f32_32x32x16_bf16 v[40:55], a[168:171], v[16:19], v[40:55]
ds_read_b128 v[12:15], v5 offset:50176
s_waitcnt lgkmcnt(6)
v_mfma_f32_32x32x16_bf16 v[40:55], a[172:175], v[20:23], v[40:55]
ds_read_b128 v[16:19], v5 offset:51200
s_waitcnt lgkmcnt(6)
v_mfma_f32_32x32x16_bf16 v[40:55], a[176:179], v[24:27], v[40:55]
ds_read_b128 v[20:23], v5 offset:52224
s_waitcnt lgkmcnt(6)
v_mfma_f32_32x32x16_bf16 v[40:55], a[180:183], v[28:31], v[40:55]
ds_read_b128 v[24:27], v5 offset:53248
s_waitcnt lgkmcnt(6)
v_mfma_f32_32x32x16_bf16 v[40:55], a[184:187], v[32:35], v[40:55]
ds_read_b128 v[28:31], v5 offset:54272
s_waitcnt lgkmcnt(6)
v_mfma_f32_32x32x16_bf16 v[40:55], a[188:191], v[36:39], v[40:55]
ds_read_b128 v[32:35], v5 offset:55296
s_waitcnt lgkmcnt(6)
v_mfma_f32_32x32x16_bf16 v[40:55], a[192:195], v[8:11], v[40:55]
ds_read_b128 v[36:39], v5 offset:56320
s_waitcnt lgkmcnt(6)
v_mfma_f32_32x32x16_bf16 v[40:55], a[196:199], v[12:15], v[40:55]
ds_read_b128 v[8:11], v5 offset:57344
s_waitcnt lgkmcnt(6)
v_mfma_f32_32x32x16_bf16 v[40:55], a[200:203], v[16:19], v[40:55]
ds_read_b128 v[12:15], v5 offset:58368
s_waitcnt lgkmcnt(6)
v_mfma_f32_32x32x16_bf16 v[40:55], a[204:207], v[20:23], v[40:55]
ds_read_b128 v[16:19], v5 offset:59392
s_waitcnt lgkmcnt(6)
v_mfma_f32_32x32x16_bf16 v[40:55], a[208:211], v[24:27], v[40:55]
ds_read_b128 v[20:23], v5 offset:60416
s_waitcnt lgkmcnt(6)
v_mfma_f32_32x32x16_bf16 v[40:55], a[212:215], v[28:31], v[40:55]
ds_read_b128 v[24:27], v5 offset:61440
s_waitcnt vmcnt(0)
s_barrier
s_waitcnt lgkmcnt(6)
v_mfma_f32_32x32x16_bf16 v[40:55], a[216:219], v[32:35], v[40:55]
ds_read_b128 v[28:31], v5 offset:62464
s_cmp_lg_u32 s42, 0
s_cbranch_scc1 Lgup_w_204
s_mov_b64 exec, 1
buffer_store_dword v4, v3, s[4:7], s59 offen sc1
s_mov_b64 exec, -1
Lgup_w_204:
s_waitcnt lgkmcnt(6)
v_mfma_f32_32x32x16_bf16 v[40:55], a[220:223], v[36:39], v[40:55]
ds_read_b128 v[32:35], v5 offset:63488
s_waitcnt lgkmcnt(6)
v_mfma_f32_32x32x16_bf16 v[40:55], a[224:227], v[8:11], v[40:55]
ds_read_b128 v[36:39], v5 offset:64512
s_waitcnt lgkmcnt(6)
v_mfma_f32_32x32x16_bf16 v[40:55], a[228:231], v[12:15], v[40:55]
s_waitcnt lgkmcnt(5)
v_mfma_f32_32x32x16_bf16 v[40:55], a[232:235], v[16:19], v[40:55]
s_waitcnt lgkmcnt(4)
v_mfma_f32_32x32x16_bf16 v[40:55], a[236:239], v[20:23], v[40:55]
s_waitcnt lgkmcnt(3)
v_mfma_f32_32x32x16_bf16 v[40:55], a[240:243], v[24:27], v[40:55]
s_waitcnt lgkmcnt(2)
v_mfma_f32_32x32x16_bf16 v[40:55], a[244:247], v[28:31], v[40:55]
s_waitcnt lgkmcnt(1)
v_mfma_f32_32x32x16_bf16 v[40:55], a[248:251], v[32:35], v[40:55]
s_waitcnt lgkmcnt(0)
v_mfma_f32_32x32x16_bf16 v[40:55], a[252:255], v[36:39], v[40:55]
s_mov_b32 s64, s57
s_add_u32 s50, s46, 1
s_add_u32 s57, s57, s58
v_mov_b32 v4, s50
s_nop 7
v_pk_mul_f32 v[56:57], v[40:41], v[40:41]
v_pk_mul_f32 v[58:59], v[42:43], v[42:43]
v_pk_mul_f32 v[60:61], v[44:45], v[44:45]
v_pk_mul_f32 v[62:63], v[46:47], v[46:47]
v_pk_fma_f32 v[56:57], v[56:57], s[72:73], v[6:7]
v_pk_fma_f32 v[58:59], v[58:59], s[72:73], v[6:7]
v_pk_fma_f32 v[60:61], v[60:61], s[72:73], v[6:7]
v_pk_fma_f32 v[62:63], v[62:63], s[72:73], v[6:7]
v_pk_mul_f32 v[56:57], v[56:57], v[40:41]
v_pk_mul_f32 v[58:59], v[58:59], v[42:43]
v_pk_mul_f32 v[60:61], v[60:61], v[44:45]
v_pk_mul_f32 v[62:63], v[62:63], v[46:47]
v_exp_f32 v56, v56
v_exp_f32 v57, v57
v_exp_f32 v58, v58
v_exp_f32 v59, v59
v_exp_f32 v60, v60
v_exp_f32 v61, v61
v_exp_f32 v62, v62
v_exp_f32 v63, v63
v_pk_mul_f32 v[40:41], v[40:41], v[48:49]
v_pk_mul_f32 v[42:43], v[42:43], v[50:51]
v_pk_mul_f32 v[44:45], v[44:45], v[52:53]
v_pk_mul_f32 v[46:47], v[46:47], v[54:55]
v_pk_add_f32 v[56:57], v[56:57], 1.0 op_sel_hi:[1,0]
v_pk_add_f32 v[58:59], v[58:59], 1.0 op_sel_hi:[1,0]
v_pk_add_f32 v[60:61], v[60:61], 1.0 op_sel_hi:[1,0]
v_pk_add_f32 v[62:63], v[62:63], 1.0 op_sel_hi:[1,0]
v_rcp_f32 v56, v56
v_rcp_f32 v57, v57
v_rcp_f32 v58, v58
v_rcp_f32 v59, v59
v_rcp_f32 v60, v60
v_rcp_f32 v61, v61
v_rcp_f32 v62, v62
v_rcp_f32 v63, v63
v_pk_mul_f32 v[40:41], v[40:41], v[56:57]
v_pk_mul_f32 v[42:43], v[42:43], v[58:59]
v_pk_mul_f32 v[44:45], v[44:45], v[60:61]
v_pk_mul_f32 v[46:47], v[46:47], v[62:63]
v_cvt_pk_bf16_f32 v64, v40, v41
v_cvt_pk_bf16_f32 v65, v42, v43
v_cvt_pk_bf16_f32 v66, v44, v45
v_cvt_pk_bf16_f32 v67, v46, v47
buffer_store_dwordx4 v[64:67], v0, s[4:7], s64 offen sc1
s_waitcnt vmcnt(0)
s_barrier
s_cmp_lg_u32 s42, 0
s_cbranch_scc1 Lgup_w_205
s_mov_b64 exec, 1
buffer_store_dword v4, v3, s[4:7], s59 offen sc1
s_mov_b64 exec, -1
Lgup_w_205:
s_branch Lend
Lgup_top1:
s_cmp_lg_u32 s42, 0
s_cbranch_scc1 Lgup_w_206
s_mul_i32 s50, s62, s61
s_add_u32 s62, s62, 1
s_cmp_eq_u32 s62, s78
s_cselect_b32 s62, 0, s62
s_mul_i32 s51, s62, s61
s_sub_u32 s51, s51, s50
s_add_u32 s63, s46, 2
v_mad_i32_i24 v68, v88, s51, v1
v_add_u32 v68, s50, v68
v_add_u32 v69, s63, v88
buffer_load_dword v2, v68, s[4:7], s60 offen sc1
Lgup_w_206:
s_xor_b32 s65, s65, 0x10000
s_add_u32 s49, s49, s56
v_add_u32 v5, s65, v0
s_barrier
ds_read_b128 v[8:11], v5 offset:0
ds_read_b128 v[12:15], v5 offset:1024
ds_read_b32 v70, v71 offset:16
ds_read_b128 v[16:19], v5 offset:2048
s_lshl_b32 s53, s42, 10
s_xor_b32 s54, s65, 0x10000
s_add_u32 s54, s54, s53
s_add_u32 s53, s53, s49
s_waitcnt lgkmcnt(3)
v_mfma_f32_32x32x16_bf16 v[72:87], a[0:3], v[8:11], 0
ds_read_b128 v[20:23], v5 offset:3072
ds_read_b128 v[24:27], v5 offset:4096
ds_read_b128 v[28:31], v5 offset:5120
ds_read_b128 v[32:35], v5 offset:6144
s_waitcnt lgkmcnt(5)
v_mfma_f32_32x32x16_bf16 v[72:87], a[4:7], v[12:15], v[72:87]
ds_read_b128 v[36:39], v5 offset:7168
ds_read_b128 v[8:11], v5 offset:8192
v_readfirstlane_b32 s50, v70
s_cmp_le_u32 s47, 1
s_cbranch_scc1 Lgup_last1
s_cmp_lg_u32 s50, 0
s_cbranch_scc1 Lgup_nop1
s_waitcnt lgkmcnt(6)
v_mfma_f32_32x32x16_bf16 v[72:87], a[8:11], v[16:19], v[72:87]
ds_read_b128 v[12:15], v5 offset:9216
s_add_u32 m0, s54, 0
s_add_u32 s55, s53, 0
buffer_load_dwordx4 v0, s[4:7], s55 offen sc1 lds
v_mul_f32 v56, v40, v40
s_waitcnt lgkmcnt(6)
v_mfma_f32_32x32x16_bf16 v[72:87], a[12:15], v[20:23], v[72:87]
ds_read_b128 v[16:19], v5 offset:10240
v_mul_f32 v57, v41, v41
v_mul_f32 v58, v42, v42
v_mul_f32 v59, v43, v43
v_mul_f32 v60, v44, v44
s_waitcnt lgkmcnt(6)
v_mfma_f32_32x32x16_bf16 v[72:87], a[16:19], v[24:27], v[72:87]
ds_read_b128 v[20:23], v5 offset:11264
s_add_u32 m0, s54, 4096
s_add_u32 s55, s53, 4096
buffer_load_dwordx4 v0, s[4:7], s55 offen sc1 lds
v_mul_f32 v61, v45, v45
s_waitcnt lgkmcnt(6)
v_mfma_f32_32x32x16_bf16 v[72:87], a[20:23], v[28:31], v[72:87]
ds_read_b128 v[24:27], v5 offset:12288
v_mul_f32 v62, v46, v46
v_mul_f32 v63, v47, v47
v_fma_f32 v56, v56, s72, v6
v_fma_f32 v57, v57, s72, v6
s_waitcnt lgkmcnt(6)
v_mfma_f32_32x32x16_bf16 v[72:87], a[24:27], v[32:35], v[72:87]
ds_read_b128 v[28:31], v5 offset:13312
s_add_u32 m0, s54, 8192
s_add_u32 s55, s53, 8192
buffer_load_dwordx4 v0, s[4:7], s55 offen sc1 lds
v_fma_f32 v58, v58, s72, v6
s_waitcnt lgkmcnt(6)
v_mfma_f32_32x32x16_bf16 v[72:87], a[28:31], v[36:39], v[72:87]
ds_read_b128 v[32:35], v5 offset:14336
v_fma_f32 v59, v59, s72, v6
v_fma_f32 v60, v60, s72, v6
v_fma_f32 v61, v61, s72, v6
v_fma_f32 v62, v62, s72, v6
s_waitcnt lgkmcnt(6)
v_mfma_f32_32x32x16_bf16 v[72:87], a[32:35], v[8:11], v[72:87]
ds_read_b128 v[36:39], v5 offset:15360
s_add_u32 m0, s54, 12288
s_add_u32 s55, s53, 12288
buffer_load_dwordx4 v0, s[4:7], s55 offen sc1 lds
v_fma_f32 v63, v63, s72, v6
s_waitcnt lgkmcnt(6)
v_mfma_f32_32x32x16_bf16 v[72:87], a[36:39], v[12:15], v[72:87]
ds_read_b128 v[8:11], v5 offset:16384
v_mul_f32 v56, v56, v40
v_mul_f32 v57, v57, v41
v_mul_f32 v58, v58, v42
v_mul_f32 v59, v59, v43
s_waitcnt lgkmcnt(6)
v_mfma_f32_32x32x16_bf16 v[72:87], a[40:43], v[16:19], v[72:87]
ds_read_b128 v[12:15], v5 offset:17408
s_add_u32 m0, s54, 16384
s_add_u32 s55, s53, 16384
buffer_load_dwordx4 v0, s[4:7], s55 offen sc1 lds
v_mul_f32 v60, v60, v44
s_waitcnt lgkmcnt(6)
v_mfma_f32_32x32x16_bf16 v[72:87], a[44:47], v[20:23], v[72:87]
ds_read_b128 v[16:19], v5 offset:18432
v_mul_f32 v61, v61, v45
v_mul_f32 v62, v62, v46
v_mul_f32 v63, v63, v47
v_exp_f32 v56, v56
s_waitcnt lgkmcnt(6)
v_mfma_f32_32x32x16_bf16 v[72:87], a[48:51], v[24:27], v[72:87]
ds_read_b128 v[20:23], v5 offset:19456
s_add_u32 m0, s54, 20480
s_add_u32 s55, s53, 20480
buffer_load_dwordx4 v0, s[4:7], s55 offen sc1 lds
v_mul_f32 v40, v40, v48
s_waitcnt lgkmcnt(6)
v_mfma_f32_32x32x16_bf16 v[72:87], a[52:55], v[28:31], v[72:87]
ds_read_b128 v[24:27], v5 offset:20480
v_exp_f32 v57, v57
v_mul_f32 v41, v41, v49
v_exp_f32 v58, v58
s_waitcnt lgkmcnt(6)
v_mfma_f32_32x32x16_bf16 v[72:87], a[56:59], v[32:35], v[72:87]
ds_read_b128 v[28:31], v5 offset:21504
s_add_u32 m0, s54, 24576
s_add_u32 s55, s53, 24576
buffer_load_dwordx4 v0, s[4:7], s55 offen sc1 lds
v_mul_f32 v42, v42, v50
s_waitcnt lgkmcnt(6)
v_mfma_f32_32x32x16_bf16 v[72:87], a[60:63], v[36:39], v[72:87]
ds_read_b128 v[32:35], v5 offset:22528
v_exp_f32 v59, v59
v_mul_f32 v43, v43, v51
v_exp_f32 v60, v60
s_waitcnt lgkmcnt(6)
v_mfma_f32_32x32x16_bf16 v[72:87], a[64:67], v[8:11], v[72:87]
ds_read_b128 v[36:39], v5 offset:23552
s_add_u32 m0, s54, 28672
s_add_u32 s55, s53, 28672
buffer_load_dwordx4 v0, s[4:7], s55 offen sc1 lds
v_mul_f32 v44, v44, v52
s_waitcnt lgkmcnt(6)
v_mfma_f32_32x32x16_bf16 v[72:87], a[68:71], v[12:15], v[72:87]
ds_read_b128 v[8:11], v5 offset:24576
v_exp_f32 v61, v61
v_mul_f32 v45, v45, v53
v_exp_f32 v62, v62
s_waitcnt lgkmcnt(6)
v_mfma_f32_32x32x16_bf16 v[72:87], a[72:75], v[16:19], v[72:87]
ds_read_b128 v[12:15], v5 offset:25600
s_add_u32 m0, s54, 32768
s_add_u32 s55, s53, 32768
buffer_load_dwordx4 v0, s[4:7], s55 offen sc1 lds
v_mul_f32 v46, v46, v54
s_waitcnt lgkmcnt(6)
v_mfma_f32_32x32x16_bf16 v[72:87], a[76:79], v[20:23], v[72:87]
ds_read_b128 v[16:19], v5 offset:26624
v_exp_f32 v63, v63
v_mul_f32 v47, v47, v55
v_add_f32 v56, 1.0, v56
s_waitcnt lgkmcnt(6)
v_mfma_f32_32x32x16_bf16 v[72:87], a[80:83], v[24:27], v[72:87]
ds_read_b128 v[20:23], v5 offset:27648
s_add_u32 m0, s54, 36864
s_add_u32 s55, s53, 36864
buffer_load_dwordx4 v0, s[4:7], s55 offen sc1 lds
v_add_f32 v57, 1.0, v57
s_waitcnt lgkmcnt(6)
v_mfma_f32_32x32x16_bf16 v[72:87], a[84:87], v[28:31], v[72:87]
ds_read_b128 v[24:27], v5 offset:28672
v_add_f32 v58, 1.0, v58
v_add_f32 v59, 1.0, v59
v_add_f32 v60, 1.0, v60
v_add_f32 v61, 1.0, v61
s_cmp_lg_u32 s42, 0
s_cbranch_scc1 Lgup_w_207
s_waitcnt vmcnt(10)
v_cmp_gt_i32 vcc, v69, v2
s_nop 1
v_mov_b32 v70, vcc_hi
v_mov_b32 v2, vcc_lo
ds_write2_b32 v71, v70, v2 offset0:0 offset1:1
Lgup_w_207:
s_waitcnt lgkmcnt(6)
v_mfma_f32_32x32x16_bf16 v[72:87], a[88:91], v[32:35], v[72:87]
ds_read_b128 v[28:31], v5 offset:29696
s_add_u32 m0, s54, 40960
s_add_u32 s55, s53, 40960
buffer_load_dwordx4 v0, s[4:7], s55 offen sc1 lds
v_add_f32 v62, 1.0, v62
s_waitcnt lgkmcnt(6)
v_mfma_f32_32x32x16_bf16 v[72:87], a[92:95], v[36:39], v[72:87]
ds_read_b128 v[32:35], v5 offset:30720
v_add_f32 v63, 1.0, v63
v_rcp_f32 v56, v56
v_rcp_f32 v57, v57
s_waitcnt vmcnt(11) lgkmcnt(2)
s_barrier
s_waitcnt lgkmcnt(6)
v_mfma_f32_32x32x16_bf16 v[72:87], a[96:99], v[8:11], v[72:87]
ds_read_b128 v[36:39], v5 offset:31744
s_add_u32 m0, s54, 45056
s_add_u32 s55, s53, 45056
buffer_load_dwordx4 v0, s[4:7], s55 offen sc1 lds
v_rcp_f32 v58, v58
s_waitcnt lgkmcnt(6)
v_mfma_f32_32x32x16_bf16 v[72:87], a[100:103], v[12:15], v[72:87]
ds_read_b128 v[8:11], v5 offset:32768
v_rcp_f32 v59, v59
v_rcp_f32 v60, v60
s_waitcnt lgkmcnt(6)
v_mfma_f32_32x32x16_bf16 v[72:87], a[104:107], v[16:19], v[72:87]
ds_read_b128 v[12:15], v5 offset:33792
s_add_u32 m0, s54, 49152
s_add_u32 s55, s53, 49152
buffer_load_dwordx4 v0, s[4:7], s55 offen sc1 lds
v_rcp_f32 v61, v61
s_waitcnt lgkmcnt(6)
v_mfma_f32_32x32x16_bf16 v[72:87], a[108:111], v[20:23], v[72:87]
ds_read_b128 v[16:19], v5 offset:34816
v_rcp_f32 v62, v62
v_rcp_f32 v63, v63
s_waitcnt lgkmcnt(6)
v_mfma_f32_32x32x16_bf16 v[72:87], a[112:115], v[24:27], v[72:87]
ds_read_b128 v[20:23], v5 offset:35840
s_add_u32 m0, s54, 53248
s_add_u32 s55, s53, 53248
buffer_load_dwordx4 v0, s[4:7], s55 offen sc1 lds
v_mul_f32 v40, v40, v56
s_waitcnt lgkmcnt(6)
v_mfma_f32_32x32x16_bf16 v[72:87], a[116:119], v[28:31], v[72:87]
ds_read_b128 v[24:27], v5 offset:36864
v_mul_f32 v41, v41, v57
v_mul_f32 v42, v42, v58
v_mul_f32 v43, v43, v59
v_mul_f32 v44, v44, v60
s_waitcnt lgkmcnt(6)
v_mfma_f32_32x32x16_bf16 v[72:87], a[120:123], v[32:35], v[72:87]
ds_read_b128 v[28:31], v5 offset:37888
s_add_u32 m0, s54, 57344
s_add_u32 s55, s53, 57344
buffer_load_dwordx4 v0, s[4:7], s55 offen sc1 lds
v_mul_f32 v45, v45, v61
s_waitcnt lgkmcnt(6)
v_mfma_f32_32x32x16_bf16 v[72:87], a[124:127], v[36:39], v[72:87]
ds_read_b128 v[32:35], v5 offset:38912
v_mul_f32 v46, v46, v62
v_mul_f32 v47, v47, v63
v_cvt_pk_bf16_f32 v64, v40, v41
v_cvt_pk_bf16_f32 v65, v42, v43
s_waitcnt lgkmcnt(6)
v_mfma_f32_32x32x16_bf16 v[72:87], a[128:131], v[8:11], v[72:87]
ds_read_b128 v[36:39], v5 offset:39936
s_add_u32 m0, s54, 61440
s_add_u32 s55, s53, 61440
buffer_load_dwordx4 v0, s[4:7], s55 offen sc1 lds
v_cvt_pk_bf16_f32 v66, v44, v45
s_waitcnt lgkmcnt(6)
v_mfma_f32_32x32x16_bf16 v[72:87], a[132:135], v[12:15], v[72:87]
ds_read_b128 v[8:11], v5 offset:40960
v_cvt_pk_bf16_f32 v67, v46, v47
buffer_store_dwordx4 v[64:67], v0, s[4:7], s64 offen sc1
s_waitcnt lgkmcnt(6)
v_mfma_f32_32x32x16_bf16 v[72:87], a[136:139], v[16:19], v[72:87]
ds_read_b128 v[12:15], v5 offset:41984
s_waitcnt lgkmcnt(6)
v_mfma_f32_32x32x16_bf16 v[72:87], a[140:143], v[20:23], v[72:87]
ds_read_b128 v[16:19], v5 offset:43008
s_waitcnt lgkmcnt(6)
v_mfma_f32_32x32x16_bf16 v[72:87], a[144:147], v[24:27], v[72:87]
ds_read_b128 v[20:23], v5 offset:44032
s_waitcnt lgkmcnt(6)
v_mfma_f32_32x32x16_bf16 v[72:87], a[148:151], v[28:31], v[72:87]
ds_read_b128 v[24:27], v5 offset:45056
s_waitcnt lgkmcnt(6)
v_mfma_f32_32x32x16_bf16 v[72:87], a[152:155], v[32:35], v[72:87]
ds_read_b128 v[28:31], v5 offset:46080
s_waitcnt lgkmcnt(6)
v_mfma_f32_32x32x16_bf16 v[72:87], a[156:159], v[36:39], v[72:87]
ds_read_b128 v[32:35], v5 offset:47104
s_waitcnt lgkmcnt(6)
v_mfma_f32_32x32x16_bf16 v[72:87], a[160:163], v[8:11], v[72:87]
ds_read_b128 v[36:39], v5 offset:48128
s_waitcnt lgkmcnt(6)
v_mfma_f32_32x32x16_bf16 v[72:87], a[164:167], v[12:15], v[72:87]
ds_read_b128 v[8:11], v5 offset:49152
s_waitcnt lgkmcnt(6)
v_mfma_f32_32x32x16_bf16 v[72:87], a[168:171], v[16:19], v[72:87]
ds_read_b128 v[12:15], v5 offset:50176
s_waitcnt lgkmcnt(6)
v_mfma_f32_32x32x16_bf16 v[72:87], a[172:175], v[20:23], v[72:87]
ds_read_b128 v[16:19], v5 offset:51200
s_waitcnt lgkmcnt(6)
v_mfma_f32_32x32x16_bf16 v[72:87], a[176:179], v[24:27], v[72:87]
ds_read_b128 v[20:23], v5 offset:52224
s_waitcnt lgkmcnt(6)
v_mfma_f32_32x32x16_bf16 v[72:87], a[180:183], v[28:31], v[72:87]
ds_read_b128 v[24:27], v5 offset:53248
s_waitcnt lgkmcnt(6)
v_mfma_f32_32x32x16_bf16 v[72:87], a[184:187], v[32:35], v[72:87]
ds_read_b128 v[28:31], v5 offset:54272
s_waitcnt lgkmcnt(6)
v_mfma_f32_32x32x16_bf16 v[72:87], a[188:191], v[36:39], v[72:87]
ds_read_b128 v[32:35], v5 offset:55296
s_waitcnt lgkmcnt(6)
v_mfma_f32_32x32x16_bf16 v[72:87], a[192:195], v[8:11], v[72:87]
ds_read_b128 v[36:39], v5 offset:56320
s_waitcnt lgkmcnt(6)
v_mfma_f32_32x32x16_bf16 v[72:87], a[196:199], v[12:15], v[72:87]
ds_read_b128 v[8:11], v5 offset:57344
s_waitcnt lgkmcnt(6)
v_mfma_f32_32x32x16_bf16 v[72:87], a[200:203], v[16:19], v[72:87]
ds_read_b128 v[12:15], v5 offset:58368
s_waitcnt lgkmcnt(6)
v_mfma_f32_32x32x16_bf16 v[72:87], a[204:207], v[20:23], v[72:87]
ds_read_b128 v[16:19], v5 offset:59392
s_waitcnt lgkmcnt(6)
v_mfma_f32_32x32x16_bf16 v[72:87], a[208:211], v[24:27], v[72:87]
ds_read_b128 v[20:23], v5 offset:60416
s_waitcnt lgkmcnt(6)
v_mfma_f32_32x32x16_bf16 v[72:87], a[212:215], v[28:31], v[72:87]
ds_read_b128 v[24:27], v5 offset:61440
s_waitcnt vmcnt(0)
s_barrier
s_waitcnt lgkmcnt(6)
v_mfma_f32_32x32x16_bf16 v[72:87], a[216:219], v[32:35], v[72:87]
ds_read_b128 v[28:31], v5 offset:62464
s_cmp_lg_u32 s42, 0
s_cbranch_scc1 Lgup_w_208
s_mov_b64 exec, 1
buffer_store_dword v4, v3, s[4:7], s59 offen sc1
s_mov_b64 exec, -1
Lgup_w_208:
s_waitcnt lgkmcnt(6)
v_mfma_f32_32x32x16_bf16 v[72:87], a[220:223], v[36:39], v[72:87]
ds_read_b128 v[32:35], v5 offset:63488
s_waitcnt lgkmcnt(6)
v_mfma_f32_32x32x16_bf16 v[72:87], a[224:227], v[8:11], v[72:87]
ds_read_b128 v[36:39], v5 offset:64512
s_waitcnt lgkmcnt(6)
v_mfma_f32_32x32x16_bf16 v[72:87], a[228:231], v[12:15], v[72:87]
s_waitcnt lgkmcnt(5)
v_mfma_f32_32x32x16_bf16 v[72:87], a[232:235], v[16:19], v[72:87]
s_waitcnt lgkmcnt(4)
v_mfma_f32_32x32x16_bf16 v[72:87], a[236:239], v[20:23], v[72:87]
s_waitcnt lgkmcnt(3)
v_mfma_f32_32x32x16_bf16 v[72:87], a[240:243], v[24:27], v[72:87]
s_waitcnt lgkmcnt(2)
v_mfma_f32_32x32x16_bf16 v[72:87], a[244:247], v[28:31], v[72:87]
s_waitcnt lgkmcnt(1)
v_mfma_f32_32x32x16_bf16 v[72:87], a[248:251], v[32:35], v[72:87]
s_waitcnt lgkmcnt(0)
v_mfma_f32_32x32x16_bf16 v[72:87], a[252:255], v[36:39], v[72:87]
s_mov_b32 s64, s57
s_add_u32 s50, s46, 1
s_add_u32 s57, s57, s58
v_mov_b32 v4, s50
s_add_u32 s46, s46, s48
s_sub_u32 s47, s47, 1
s_waitcnt vmcnt(8)
s_branch Lgup_top0
Lgup_nop1:
s_waitcnt lgkmcnt(6)
v_mfma_f32_32x32x16_bf16 v[72:87], a[8:11], v[16:19], v[72:87]
ds_read_b128 v[12:15], v5 offset:9216
v_mul_f32 v56, v40, v40
v_mul_f32 v57, v41, v41
v_mul_f32 v58, v42, v42
v_mul_f32 v59, v43, v43
s_waitcnt lgkmcnt(6)
v_mfma_f32_32x32x16_bf16 v[72:87], a[12:15], v[20:23], v[72:87]
ds_read_b128 v[16:19], v5 offset:10240
v_mul_f32 v60, v44, v44
v_mul_f32 v61, v45, v45
v_mul_f32 v62, v46, v46
v_mul_f32 v63, v47, v47
s_waitcnt lgkmcnt(6)
v_mfma_f32_32x32x16_bf16 v[72:87], a[16:19], v[24:27], v[72:87]
ds_read_b128 v[20:23], v5 offset:11264
v_fma_f32 v56, v56, s72, v6
v_fma_f32 v57, v57, s72, v6
v_fma_f32 v58, v58, s72, v6
v_fma_f32 v59, v59, s72, v6
s_waitcnt lgkmcnt(6)
v_mfma_f32_32x32x16_bf16 v[72:87], a[20:23], v[28:31], v[72:87]
ds_read_b128 v[24:27], v5 offset:12288
v_fma_f32 v60, v60, s72, v6
v_fma_f32 v61, v61, s72, v6
v_fma_f32 v62, v62, s72, v6
v_fma_f32 v63, v63, s72, v6
s_waitcnt lgkmcnt(6)
v_mfma_f32_32x32x16_bf16 v[72:87], a[24:27], v[32:35], v[72:87]
ds_read_b128 v[28:31], v5 offset:13312
v_mul_f32 v56, v56, v40
v_mul_f32 v57, v57, v41
v_mul_f32 v58, v58, v42
v_mul_f32 v59, v59, v43
s_waitcnt lgkmcnt(6)
v_mfma_f32_32x32x16_bf16 v[72:87], a[28:31], v[36:39], v[72:87]
ds_read_b128 v[32:35], v5 offset:14336
v_mul_f32 v60, v60, v44
v_mul_f32 v61, v61, v45
v_mul_f32 v62, v62, v46
v_mul_f32 v63, v63, v47
s_waitcnt lgkmcnt(6)
v_mfma_f32_32x32x16_bf16 v[72:87], a[32:35], v[8:11], v[72:87]
ds_read_b128 v[36:39], v5 offset:15360
v_exp_f32 v56, v56
v_mul_f32 v40, v40, v48
v_exp_f32 v57, v57
s_waitcnt lgkmcnt(6)
v_mfma_f32_32x32x16_bf16 v[72:87], a[36:39], v[12:15], v[72:87]
ds_read_b128 v[8:11], v5 offset:16384
v_mul_f32 v41, v41, v49
v_exp_f32 v58, v58
v_mul_f32 v42, v42, v50
s_waitcnt lgkmcnt(6)
v_mfma_f32_32x32x16_bf16 v[72:87], a[40:43], v[16:19], v[72:87]
ds_read_b128 v[12:15], v5 offset:17408
v_exp_f32 v59, v59
v_mul_f32 v43, v43, v51
v_exp_f32 v60, v60
s_waitcnt lgkmcnt(6)
v_mfma_f32_32x32x16_bf16 v[72:87], a[44:47], v[20:23], v[72:87]
ds_read_b128 v[16:19], v5 offset:18432
v_mul_f32 v44, v44, v52
v_exp_f32 v61, v61
v_mul_f32 v45, v45, v53
s_waitcnt lgkmcnt(6)
v_mfma_f32_32x32x16_bf16 v[72:87], a[48:51], v[24:27], v[72:87]
ds_read_b128 v[20:23], v5 offset:19456
v_exp_f32 v62, v62
v_mul_f32 v46, v46, v54
v_exp_f32 v63, v63
s_waitcnt lgkmcnt(6)
v_mfma_f32_32x32x16_bf16 v[72:87], a[52:55], v[28:31], v[72:87]
ds_read_b128 v[24:27], v5 offset:20480
v_mul_f32 v47, v47, v55
v_add_f32 v56, 1.0, v56
v_add_f32 v57, 1.0, v57
v_add_f32 v58, 1.0, v58
s_waitcnt lgkmcnt(6)
v_mfma_f32_32x32x16_bf16 v[72:87], a[56:59], v[32:35], v[72:87]
ds_read_b128 v[28:31], v5 offset:21504
v_add_f32 v59, 1.0, v59
v_add_f32 v60, 1.0, v60
v_add_f32 v61, 1.0, v61
v_add_f32 v62, 1.0, v62
s_waitcnt lgkmcnt(6)
v_mfma_f32_32x32x16_bf16 v[72:87], a[60:63], v[36:39], v[72:87]
ds_read_b128 v[32:35], v5 offset:22528
v_add_f32 v63, 1.0, v63
v_rcp_f32 v56, v56
v_rcp_f32 v57, v57
s_waitcnt lgkmcnt(6)
v_mfma_f32_32x32x16_bf16 v[72:87], a[64:67], v[8:11], v[72:87]
ds_read_b128 v[36:39], v5 offset:23552
v_rcp_f32 v58, v58
v_rcp_f32 v59, v59
s_waitcnt lgkmcnt(6)
v_mfma_f32_32x32x16_bf16 v[72:87], a[68:71], v[12:15], v[72:87]
ds_read_b128 v[8:11], v5 offset:24576
v_rcp_f32 v60, v60
v_rcp_f32 v61, v61
s_waitcnt lgkmcnt(6)
v_mfma_f32_32x32x16_bf16 v[72:87], a[72:75], v[16:19], v[72:87]
ds_read_b128 v[12:15], v5 offset:25600
v_rcp_f32 v62, v62
v_rcp_f32 v63, v63
s_waitcnt lgkmcnt(6)
v_mfma_f32_32x32x16_bf16 v[72:87], a[76:79], v[20:23], v[72:87]
ds_read_b128 v[16:19], v5 offset:26624
v_mul_f32 v40, v40, v56
v_mul_f32 v41, v41, v57
v_mul_f32 v42, v42, v58
v_mul_f32 v43, v43, v59
s_waitcnt lgkmcnt(6)
v_mfma_f32_32x32x16_bf16 v[72:87], a[80:83], v[24:27], v[72:87]
ds_read_b128 v[20:23], v5 offset:27648
v_mul_f32 v44, v44, v60
v_mul_f32 v45, v45, v61
v_mul_f32 v46, v46, v62
v_mul_f32 v47, v47, v63
s_waitcnt lgkmcnt(6)
v_mfma_f32_32x32x16_bf16 v[72:87], a[84:87], v[28:31], v[72:87]
ds_read_b128 v[24:27], v5 offset:28672
v_cvt_pk_bf16_f32 v64, v40, v41
v_cvt_pk_bf16_f32 v65, v42, v43
v_cvt_pk_bf16_f32 v66, v44, v45
v_cvt_pk_bf16_f32 v67, v46, v47
s_cmp_lg_u32 s42, 0
s_cbranch_scc1 Lgup_w_209
s_waitcnt vmcnt(0)
v_cmp_gt_i32 vcc, v69, v2
s_nop 1
v_mov_b32 v70, vcc_hi
v_mov_b32 v2, vcc_lo
ds_write2_b32 v71, v70, v2 offset0:0 offset1:1
Lgup_w_209:
s_waitcnt lgkmcnt(6)
v_mfma_f32_32x32x16_bf16 v[72:87], a[88:91], v[32:35], v[72:87]
ds_read_b128 v[28:31], v5 offset:29696
buffer_store_dwordx4 v[64:67], v0, s[4:7], s64 offen sc1
s_waitcnt lgkmcnt(6)
v_mfma_f32_32x32x16_bf16 v[72:87], a[92:95], v[36:39], v[72:87]
ds_read_b128 v[32:35], v5 offset:30720
s_waitcnt vmcnt(1) lgkmcnt(2)
s_barrier
ds_read_b32 v70, v71 offset:4
s_waitcnt lgkmcnt(6)
v_mfma_f32_32x32x16_bf16 v[72:87], a[96:99], v[8:11], v[72:87]
ds_read_b128 v[36:39], v5 offset:31744
s_waitcnt lgkmcnt(6)
v_mfma_f32_32x32x16_bf16 v[72:87], a[100:103], v[12:15], v[72:87]
ds_read_b128 v[8:11], v5 offset:32768
s_waitcnt lgkmcnt(2)
v_readfirstlane_b32 s50, v70
s_nop 0
s_cmp_eq_u32 s50, 0
s_cbranch_scc1 Lgup_late1
s_waitcnt lgkmcnt(6)
v_mfma_f32_32x32x16_bf16 v[72:87], a[104:107], v[16:19], v[72:87]
ds_read_b128 v[12:15], v5 offset:33792
s_cmp_lg_u32 s42, 0
s_cbranch_scc1 Lgup_w_210
buffer_load_dword v2, v68, s[4:7], s60 offen sc1
Lgup_w_210:
s_waitcnt lgkmcnt(6)
v_mfma_f32_32x32x16_bf16 v[72:87], a[108:111], v[20:23], v[72:87]
ds_read_b128 v[16:19], v5 offset:34816
s_waitcnt lgkmcnt(6)
v_mfma_f32_32x32x16_bf16 v[72:87], a[112:115], v[24:27], v[72:87]
ds_read_b128 v[20:23], v5 offset:35840
s_waitcnt lgkmcnt(6)
v_mfma_f32_32x32x16_bf16 v[72:87], a[116:119], v[28:31], v[72:87]
ds_read_b128 v[24:27], v5 offset:36864
s_waitcnt lgkmcnt(6)
v_mfma_f32_32x32x16_bf16 v[72:87], a[120:123], v[32:35], v[72:87]
ds_read_b128 v[28:31], v5 offset:37888
s_waitcnt lgkmcnt(6)
v_mfma_f32_32x32x16_bf16 v[72:87], a[124:127], v[36:39], v[72:87]
ds_read_b128 v[32:35], v5 offset:38912
s_waitcnt lgkmcnt(6)
v_mfma_f32_32x32x16_bf16 v[72:87], a[128:131], v[8:11], v[72:87]
ds_read_b128 v[36:39], v5 offset:39936
s_waitcnt lgkmcnt(6)
v_mfma_f32_32x32x16_bf16 v[72:87], a[132:135], v[12:15], v[72:87]
ds_read_b128 v[8:11], v5 offset:40960
s_waitcnt lgkmcnt(6)
v_mfma_f32_32x32x16_bf16 v[72:87], a[136:139], v[16:19], v[72:87]
ds_read_b128 v[12:15], v5 offset:41984
s_waitcnt lgkmcnt(6)
v_mfma_f32_32x32x16_bf16 v[72:87], a[140:143], v[20:23], v[72:87]
ds_read_b128 v[16:19], v5 offset:43008
s_waitcnt lgkmcnt(6)
v_mfma_f32_32x32x16_bf16 v[72:87], a[144:147], v[24:27], v[72:87]
ds_read_b128 v[20:23], v5 offset:44032
s_waitcnt lgkmcnt(6)
v_mfma_f32_32x32x16_bf16 v[72:87], a[148:151], v[28:31], v[72:87]
ds_read_b128 v[24:27], v5 offset:45056
s_waitcnt lgkmcnt(6)
v_mfma_f32_32x32x16_bf16 v[72:87], a[152:155], v[32:35], v[72:87]
ds_read_b128 v[28:31], v5 offset:46080
s_waitcnt lgkmcnt(6)
v_mfma_f32_32x32x16_bf16 v[72:87], a[156:159], v[36:39], v[72:87]
ds_read_b128 v[32:35], v5 offset:47104
s_waitcnt lgkmcnt(6)
v_mfma_f32_32x32x16_bf16 v[72:87], a[160:163], v[8:11], v[72:87]
ds_read_b128 v[36:39], v5 offset:48128
s_waitcnt lgkmcnt(6)
v_mfma_f32_32x32x16_bf16 v[72:87], a[164:167], v[12:15], v[72:87]
ds_read_b128 v[8:11], v5 offset:49152
s_waitcnt lgkmcnt(6)
v_mfma_f32_32x32x16_bf16 v[72:87], a[168:171], v[16:19], v[72:87]
ds_read_b128 v[12:15], v5 offset:50176
s_waitcnt lgkmcnt(6)
v_mfma_f32_32x32x16_bf16 v[72:87], a[172:175], v[20:23], v[72:87]
ds_read_b128 v[16:19], v5 offset:51200
s_waitcnt lgkmcnt(6)
v_mfma_f32_32x32x16_bf16 v[72:87], a[176:179], v[24:27], v[72:87]
ds_read_b128 v[20:23], v5 offset:52224
s_waitcnt lgkmcnt(6)
v_mfma_f32_32x32x16_bf16 v[72:87], a[180:183], v[28:31], v[72:87]
ds_read_b128 v[24:27], v5 offset:53248
s_waitcnt lgkmcnt(6)
v_mfma_f32_32x32x16_bf16 v[72:87], a[184:187], v[32:35], v[72:87]
ds_read_b128 v[28:31], v5 offset:54272
s_waitcnt lgkmcnt(6)
v_mfma_f32_32x32x16_bf16 v[72:87], a[188:191], v[36:39], v[72:87]
ds_read_b128 v[32:35], v5 offset:55296
s_waitcnt lgkmcnt(6)
v_mfma_f32_32x32x16_bf16 v[72:87], a[192:195], v[8:11], v[72:87]
ds_read_b128 v[36:39], v5 offset:56320
s_waitcnt lgkmcnt(6)
v_mfma_f32_32x32x16_bf16 v[72:87], a[196:199], v[12:15], v[72:87]
ds_read_b128 v[8:11], v5 offset:57344
s_waitcnt lgkmcnt(6)
v_mfma_f32_32x32x16_bf16 v[72:87], a[200:203], v[16:19], v[72:87]
ds_read_b128 v[12:15], v5 offset:58368
s_waitcnt lgkmcnt(6)
v_mfma_f32_32x32x16_bf16 v[72:87], a[204:207], v[20:23], v[72:87]
ds_read_b128 v[16:19], v5 offset:59392
s_waitcnt lgkmcnt(6)
v_mfma_f32_32x32x16_bf16 v[72:87], a[208:211], v[24:27], v[72:87]
ds_read_b128 v[20:23], v5 offset:60416
s_waitcnt lgkmcnt(6)
v_mfma_f32_32x32x16_bf16 v[72:87], a[212:215], v[28:31], v[72:87]
ds_read_b128 v[24:27], v5 offset:61440
s_cmp_eq_u32 s42, 0
s_cbranch_scc1 Lgup_z_211
s_waitcnt vmcnt(0)
Lgup_z_211:
s_waitcnt vmcnt(1)
s_barrier
s_waitcnt lgkmcnt(6)
v_mfma_f32_32x32x16_bf16 v[72:87], a[216:219], v[32:35], v[72:87]
ds_read_b128 v[28:31], v5 offset:62464
s_cmp_lg_u32 s42, 0
s_cbranch_scc1 Lgup_w_212
s_mov_b64 exec, 1
buffer_store_dword v4, v3, s[4:7], s59 offen sc1
s_mov_b64 exec, -1
Lgup_w_212:
s_waitcnt lgkmcnt(6)
v_mfma_f32_32x32x16_bf16 v[72:87], a[220:223], v[36:39], v[72:87]
ds_read_b128 v[32:35], v5 offset:63488
s_cmp_lg_u32 s42, 0
s_cbranch_scc1 Lgup_w_213
s_waitcnt vmcnt(1)
v_cmp_gt_i32 vcc, v69, v2
s_nop 1
v_mov_b32 v70, vcc_hi
v_mov_b32 v2, vcc_lo
ds_write2_b32 v71, v70, v2 offset0:0 offset1:2
Lgup_w_213:
s_waitcnt lgkmcnt(6)
v_mfma_f32_32x32x16_bf16 v[72:87], a[224:227], v[8:11], v[72:87]
ds_read_b128 v[36:39], v5 offset:64512
s_waitcnt lgkmcnt(6)
v_mfma_f32_32x32x16_bf16 v[72:87], a[228:231], v[12:15], v[72:87]
s_waitcnt lgkmcnt(0)
s_barrier
ds_read_b32 v70, v71 offset:8
s_waitcnt lgkmcnt(5)
v_mfma_f32_32x32x16_bf16 v[72:87], a[232:235], v[16:19], v[72:87]
s_waitcnt lgkmcnt(4)
v_mfma_f32_32x32x16_bf16 v[72:87], a[236:239], v[20:23], v[72:87]
s_waitcnt lgkmcnt(0)
v_readfirstlane_b32 s50, v70
s_nop 0
s_cmp_eq_u32 s50, 0
s_cbranch_scc1 Lgup_late21
s_waitcnt lgkmcnt(3)
v_mfma_f32_32x32x16_bf16 v[72:87], a[240:243], v[24:27], v[72:87]
s_waitcnt lgkmcnt(2)
v_mfma_f32_32x32x16_bf16 v[72:87], a[244:247], v[28:31], v[72:87]
s_waitcnt lgkmcnt(1)
v_mfma_f32_32x32x16_bf16 v[72:87], a[248:251], v[32:35], v[72:87]
s_waitcnt lgkmcnt(0)
v_mfma_f32_32x32x16_bf16 v[72:87], a[252:255], v[36:39], v[72:87]
s_mov_b32 s64, s57
s_add_u32 s50, s46, 1
s_add_u32 s57, s57, s58
v_mov_b32 v4, s50
s_nop 7
v_pk_mul_f32 v[56:57], v[72:73], v[72:73]
v_pk_mul_f32 v[58:59], v[74:75], v[74:75]
v_pk_mul_f32 v[60:61], v[76:77], v[76:77]
v_pk_mul_f32 v[62:63], v[78:79], v[78:79]
v_pk_fma_f32 v[56:57], v[56:57], s[72:73], v[6:7]
v_pk_fma_f32 v[58:59], v[58:59], s[72:73], v[6:7]
v_pk_fma_f32 v[60:61], v[60:61], s[72:73], v[6:7]
v_pk_fma_f32 v[62:63], v[62:63], s[72:73], v[6:7]
v_pk_mul_f32 v[56:57], v[56:57], v[72:73]
v_pk_mul_f32 v[58:59], v[58:59], v[74:75]
v_pk_mul_f32 v[60:61], v[60:61], v[76:77]
v_pk_mul_f32 v[62:63], v[62:63], v[78:79]
v_exp_f32 v56, v56
v_exp_f32 v57, v57
v_exp_f32 v58, v58
v_exp_f32 v59, v59
v_exp_f32 v60, v60
v_exp_f32 v61, v61
v_exp_f32 v62, v62
v_exp_f32 v63, v63
v_pk_mul_f32 v[72:73], v[72:73], v[80:81]
v_pk_mul_f32 v[74:75], v[74:75], v[82:83]
v_pk_mul_f32 v[76:77], v[76:77], v[84:85]
v_pk_mul_f32 v[78:79], v[78:79], v[86:87]
v_pk_add_f32 v[56:57], v[56:57], 1.0 op_sel_hi:[1,0]
v_pk_add_f32 v[58:59], v[58:59], 1.0 op_sel_hi:[1,0]
v_pk_add_f32 v[60:61], v[60:61], 1.0 op_sel_hi:[1,0]
v_pk_add_f32 v[62:63], v[62:63], 1.0 op_sel_hi:[1,0]
v_rcp_f32 v56, v56
v_rcp_f32 v57, v57
v_rcp_f32 v58, v58
v_rcp_f32 v59, v59
v_rcp_f32 v60, v60
v_rcp_f32 v61, v61
v_rcp_f32 v62, v62
v_rcp_f32 v63, v63
v_pk_mul_f32 v[72:73], v[72:73], v[56:57]
v_pk_mul_f32 v[74:75], v[74:75], v[58:59]
v_pk_mul_f32 v[76:77], v[76:77], v[60:61]
v_pk_mul_f32 v[78:79], v[78:79], v[62:63]
v_cvt_pk_bf16_f32 v64, v72, v73
v_cvt_pk_bf16_f32 v65, v74, v75
v_cvt_pk_bf16_f32 v66, v76, v77
v_cvt_pk_bf16_f32 v67, v78, v79
buffer_store_dwordx4 v[64:67], v0, s[4:7], s64 offen sc1
s_cmp_lg_u32 s42, 0
s_cbranch_scc1 Lgup_w_214
buffer_load_dword v2, v68, s[4:7], s60 offen sc1
s_waitcnt vmcnt(0)
v_cmp_gt_i32 vcc, v69, v2
s_nop 1
v_mov_b32 v70, vcc_hi
v_mov_b32 v2, vcc_lo
ds_write2_b32 v71, v70, v2 offset1:1
s_waitcnt lgkmcnt(0)
Lgup_w_214:
s_add_u32 s46, s46, s48
s_sub_u32 s47, s47, 1
s_waitcnt vmcnt(0)
s_barrier
ds_read_b32 v70, v71 offset:4
s_cmp_lg_u32 s42, 0
s_cbranch_scc1 Lgup_w_215
s_mov_b64 exec, 1
buffer_store_dword v4, v3, s[4:7], s59 offen sc1
s_mov_b64 exec, -1
Lgup_w_215:
s_waitcnt lgkmcnt(0)
v_readfirstlane_b32 s50, v70
s_nop 0
s_cmp_eq_u32 s50, 0
s_cbranch_scc1 Lgup_fetch
s_branch Lgup_cold
Lgup_late1:
s_waitcnt lgkmcnt(6)
v_mfma_f32_32x32x16_bf16 v[72:87], a[104:107], v[16:19], v[72:87]
ds_read_b128 v[12:15], v5 offset:33792
s_add_u32 m0, s54, 0
s_add_u32 s55, s53, 0
buffer_load_dwordx4 v0, s[4:7], s55 offen sc1 lds
s_waitcnt lgkmcnt(6)
v_mfma_f32_32x32x16_bf16 v[72:87], a[108:111], v[20:23], v[72:87]
ds_read_b128 v[16:19], v5 offset:34816
s_add_u32 m0, s54, 4096
s_add_u32 s55, s53, 4096
buffer_load_dwordx4 v0, s[4:7], s55 offen sc1 lds
s_waitcnt lgkmcnt(6)
v_mfma_f32_32x32x16_bf16 v[72:87], a[112:115], v[24:27], v[72:87]
ds_read_b128 v[20:23], v5 offset:35840
s_add_u32 m0, s54, 8192
s_add_u32 s55, s53, 8192
buffer_load_dwordx4 v0, s[4:7], s55 offen sc1 lds
s_waitcnt lgkmcnt(6)
v_mfma_f32_32x32x16_bf16 v[72:87], a[116:119], v[28:31], v[72:87]
ds_read_b128 v[24:27], v5 offset:36864
s_add_u32 m0, s54, 12288
s_add_u32 s55, s53, 12288
buffer_load_dwordx4 v0, s[4:7], s55 offen sc1 lds
s_waitcnt lgkmcnt(6)
v_mfma_f32_32x32x16_bf16 v[72:87], a[120:123], v[32:35], v[72:87]
ds_read_b128 v[28:31], v5 offset:37888
s_add_u32 m0, s54, 16384
s_add_u32 s55, s53, 16384
buffer_load_dwordx4 v0, s[4:7], s55 offen sc1 lds
s_waitcnt lgkmcnt(6)
v_mfma_f32_32x32x16_bf16 v[72:87], a[124:127], v[36:39], v[72:87]
ds_read_b128 v[32:35], v5 offset:38912
s_add_u32 m0, s54, 20480
s_add_u32 s55, s53, 20480
buffer_load_dwordx4 v0, s[4:7], s55 offen sc1 lds
s_waitcnt lgkmcnt(6)
v_mfma_f32_32x32x16_bf16 v[72:87], a[128:131], v[8:11], v[72:87]
ds_read_b128 v[36:39], v5 offset:39936
s_add_u32 m0, s54, 24576
s_add_u32 s55, s53, 24576
buffer_load_dwordx4 v0, s[4:7], s55 offen sc1 lds
s_waitcnt lgkmcnt(6)
v_mfma_f32_32x32x16_bf16 v[72:87], a[132:135], v[12:15], v[72:87]
ds_read_b128 v[8:11], v5 offset:40960
s_add_u32 m0, s54, 28672
s_add_u32 s55, s53, 28672
buffer_load_dwordx4 v0, s[4:7], s55 offen sc1 lds
s_waitcnt lgkmcnt(6)
v_mfma_f32_32x32x16_bf16 v[72:87], a[136:139], v[16:19], v[72:87]
ds_read_b128 v[12:15], v5 offset:41984
s_add_u32 m0, s54, 32768
s_add_u32 s55, s53, 32768
buffer_load_dwordx4 v0, s[4:7], s55 offen sc1 lds
s_waitcnt lgkmcnt(6)
v_mfma_f32_32x32x16_bf16 v[72:87], a[140:143], v[20:23], v[72:87]
ds_read_b128 v[16:19], v5 offset:43008
s_waitcnt lgkmcnt(6)
v_mfma_f32_32x32x16_bf16 v[72:87], a[144:147], v[24:27], v[72:87]
ds_read_b128 v[20:23], v5 offset:44032
s_add_u32 m0, s54, 36864
s_add_u32 s55, s53, 36864
buffer_load_dwordx4 v0, s[4:7], s55 offen sc1 lds
s_waitcnt lgkmcnt(6)
v_mfma_f32_32x32x16_bf16 v[72:87], a[148:151], v[28:31], v[72:87]
ds_read_b128 v[24:27], v5 offset:45056
s_waitcnt lgkmcnt(6)
v_mfma_f32_32x32x16_bf16 v[72:87], a[152:155], v[32:35], v[72:87]
ds_read_b128 v[28:31], v5 offset:46080
s_add_u32 m0, s54, 40960
s_add_u32 s55, s53, 40960
buffer_load_dwordx4 v0, s[4:7], s55 offen sc1 lds
s_waitcnt lgkmcnt(6)
v_mfma_f32_32x32x16_bf16 v[72:87], a[156:159], v[36:39], v[72:87]
ds_read_b128 v[32:35], v5 offset:47104
s_waitcnt lgkmcnt(6)
v_mfma_f32_32x32x16_bf16 v[72:87], a[160:163], v[8:11], v[72:87]
ds_read_b128 v[36:39], v5 offset:48128
s_add_u32 m0, s54, 45056
s_add_u32 s55, s53, 45056
buffer_load_dwordx4 v0, s[4:7], s55 offen sc1 lds
s_waitcnt lgkmcnt(6)
v_mfma_f32_32x32x16_bf16 v[72:87], a[164:167], v[12:15], v[72:87]
ds_read_b128 v[8:11], v5 offset:49152
s_waitcnt lgkmcnt(6)
v_mfma_f32_32x32x16_bf16 v[72:87], a[168:171], v[16:19], v[72:87]
ds_read_b128 v[12:15], v5 offset:50176
s_add_u32 m0, s54, 49152
s_add_u32 s55, s53, 49152
buffer_load_dwordx4 v0, s[4:7], s55 offen sc1 lds
s_waitcnt lgkmcnt(6)
v_mfma_f32_32x32x16_bf16 v[72:87], a[172:175], v[20:23], v[72:87]
ds_read_b128 v[16:19], v5 offset:51200
s_waitcnt lgkmcnt(6)
v_mfma_f32_32x32x16_bf16 v[72:87], a[176:179], v[24:27], v[72:87]
ds_read_b128 v[20:23], v5 offset:52224
s_add_u32 m0, s54, 53248
s_add_u32 s55, s53, 53248
buffer_load_dwordx4 v0, s[4:7], s55 offen sc1 lds
s_waitcnt lgkmcnt(6)
v_mfma_f32_32x32x16_bf16 v[72:87], a[180:183], v[28:31], v[72:87]
ds_read_b128 v[24:27], v5 offset:53248
s_waitcnt lgkmcnt(6)
v_mfma_f32_32x32x16_bf16 v[72:87], a[184:187], v[32:35], v[72:87]
ds_read_b128 v[28:31], v5 offset:54272
s_add_u32 m0, s54, 57344
s_add_u32 s55, s53, 57344
buffer_load_dwordx4 v0, s[4:7], s55 offen sc1 lds
s_waitcnt lgkmcnt(6)
v_mfma_f32_32x32x16_bf16 v[72:87], a[188:191], v[36:39], v[72:87]
ds_read_b128 v[32:35], v5 offset:55296
s_waitcnt lgkmcnt(6)
v_mfma_f32_32x32x16_bf16 v[72:87], a[192:195], v[8:11], v[72:87]
ds_read_b128 v[36:39], v5 offset:56320
s_add_u32 m0, s54, 61440
s_add_u32 s55, s53, 61440
buffer_load_dwordx4 v0, s[4:7], s55 offen sc1 lds
s_waitcnt lgkmcnt(6)
v_mfma_f32_32x32x16_bf16 v[72:87], a[196:199], v[12:15], v[72:87]
ds_read_b128 v[8:11], v5 offset:57344
s_waitcnt lgkmcnt(6)
v_mfma_f32_32x32x16_bf16 v[72:87], a[200:203], v[16:19], v[72:87]
ds_read_b128 v[12:15], v5 offset:58368
s_waitcnt lgkmcnt(6)
v_mfma_f32_32x32x16_bf16 v[72:87], a[204:207], v[20:23], v[72:87]
ds_read_b128 v[16:19], v5 offset:59392
s_waitcnt lgkmcnt(6)
v_mfma_f32_32x32x16_bf16 v[72:87], a[208:211], v[24:27], v[72:87]
ds_read_b128 v[20:23], v5 offset:60416
s_waitcnt lgkmcnt(6)
v_mfma_f32_32x32x16_bf16 v[72:87], a[212:215], v[28:31], v[72:87]
ds_read_b128 v[24:27], v5 offset:61440
s_waitcnt vmcnt(16)
s_barrier
s_waitcnt lgkmcnt(6)
v_mfma_f32_32x32x16_bf16 v[72:87], a[216:219], v[32:35], v[72:87]
ds_read_b128 v[28:31], v5 offset:62464
s_cmp_lg_u32 s42, 0
s_cbranch_scc1 Lgup_w_216
s_mov_b64 exec, 1
buffer_store_dword v4, v3, s[4:7], s59 offen sc1
s_mov_b64 exec, -1
Lgup_w_216:
s_waitcnt lgkmcnt(6)
v_mfma_f32_32x32x16_bf16 v[72:87], a[220:223], v[36:39], v[72:87]
ds_read_b128 v[32:35], v5 offset:63488
s_waitcnt lgkmcnt(6)
v_mfma_f32_32x32x16_bf16 v[72:87], a[224:227], v[8:11], v[72:87]
ds_read_b128 v[36:39], v5 offset:64512
s_waitcnt lgkmcnt(6)
v_mfma_f32_32x32x16_bf16 v[72:87], a[228:231], v[12:15], v[72:87]
s_waitcnt lgkmcnt(5)
v_mfma_f32_32x32x16_bf16 v[72:87], a[232:235], v[16:19], v[72:87]
s_waitcnt lgkmcnt(4)
v_mfma_f32_32x32x16_bf16 v[72:87], a[236:239], v[20:23], v[72:87]
s_waitcnt lgkmcnt(3)
v_mfma_f32_32x32x16_bf16 v[72:87], a[240:243], v[24:27], v[72:87]
s_waitcnt lgkmcnt(2)
v_mfma_f32_32x32x16_bf16 v[72:87], a[244:247], v[28:31], v[72:87]
s_waitcnt lgkmcnt(1)
v_mfma_f32_32x32x16_bf16 v[72:87], a[248:251], v[32:35], v[72:87]
s_waitcnt lgkmcnt(0)
v_mfma_f32_32x32x16_bf16 v[72:87], a[252:255], v[36:39], v[72:87]
s_mov_b32 s64, s57
s_add_u32 s50, s46, 1
s_add_u32 s57, s57, s58
v_mov_b32 v4, s50
s_add_u32 s46, s46, s48
s_sub_u32 s47, s47, 1
s_waitcnt vmcnt(8)
s_branch Lgup_top0
Lgup_late21:
s_waitcnt lgkmcnt(3)
v_mfma_f32_32x32x16_bf16 v[72:87], a[240:243], v[24:27], v[72:87]
s_waitcnt lgkmcnt(2)
v_mfma_f32_32x32x16_bf16 v[72:87], a[244:247], v[28:31], v[72:87]
s_waitcnt lgkmcnt(1)
v_mfma_f32_32x32x16_bf16 v[72:87], a[248:251], v[32:35], v[72:87]
s_waitcnt lgkmcnt(0)
v_mfma_f32_32x32x16_bf16 v[72:87], a[252:255], v[36:39], v[72:87]
s_mov_b32 s64, s57
s_add_u32 s50, s46, 1
s_add_u32 s57, s57, s58
v_mov_b32 v4, s50
s_nop 7
v_pk_mul_f32 v[56:57], v[72:73], v[72:73]
v_pk_mul_f32 v[58:59], v[74:75], v[74:75]
v_pk_mul_f32 v[60:61], v[76:77], v[76:77]
v_pk_mul_f32 v[62:63], v[78:79], v[78:79]
v_pk_fma_f32 v[56:57], v[56:57], s[72:73], v[6:7]
v_pk_fma_f32 v[58:59], v[58:59], s[72:73], v[6:7]
v_pk_fma_f32 v[60:61], v[60:61], s[72:73], v[6:7]
v_pk_fma_f32 v[62:63], v[62:63], s[72:73], v[6:7]
v_pk_mul_f32 v[56:57], v[56:57], v[72:73]
v_pk_mul_f32 v[58:59], v[58:59], v[74:75]
v_pk_mul_f32 v[60:61], v[60:61], v[76:77]
v_pk_mul_f32 v[62:63], v[62:63], v[78:79]
v_exp_f32 v56, v56
v_exp_f32 v57, v57
v_exp_f32 v58, v58
v_exp_f32 v59, v59
v_exp_f32 v60, v60
v_exp_f32 v61, v61
v_exp_f32 v62, v62
v_exp_f32 v63, v63
v_pk_mul_f32 v[72:73], v[72:73], v[80:81]
v_pk_mul_f32 v[74:75], v[74:75], v[82:83]
v_pk_mul_f32 v[76:77], v[76:77], v[84:85]
v_pk_mul_f32 v[78:79], v[78:79], v[86:87]
v_pk_add_f32 v[56:57], v[56:57], 1.0 op_sel_hi:[1,0]
v_pk_add_f32 v[58:59], v[58:59], 1.0 op_sel_hi:[1,0]
v_pk_add_f32 v[60:61], v[60:61], 1.0 op_sel_hi:[1,0]
v_pk_add_f32 v[62:63], v[62:63], 1.0 op_sel_hi:[1,0]
v_rcp_f32 v56, v56
v_rcp_f32 v57, v57
v_rcp_f32 v58, v58
v_rcp_f32 v59, v59
v_rcp_f32 v60, v60
v_rcp_f32 v61, v61
v_rcp_f32 v62, v62
v_rcp_f32 v63, v63
v_pk_mul_f32 v[72:73], v[72:73], v[56:57]
v_pk_mul_f32 v[74:75], v[74:75], v[58:59]
v_pk_mul_f32 v[76:77], v[76:77], v[60:61]
v_pk_mul_f32 v[78:79], v[78:79], v[62:63]
v_cvt_pk_bf16_f32 v64, v72, v73
v_cvt_pk_bf16_f32 v65, v74, v75
v_cvt_pk_bf16_f32 v66, v76, v77
v_cvt_pk_bf16_f32 v67, v78, v79
buffer_store_dwordx4 v[64:67], v0, s[4:7], s64 offen sc1
s_add_u32 s46, s46, s48
s_sub_u32 s47, s47, 1
s_add_u32 m0, s54, 0
s_add_u32 s55, s53, 0
buffer_load_dwordx4 v0, s[4:7], s55 offen sc1 lds
s_add_u32 m0, s54, 4096
s_add_u32 s55, s53, 4096
buffer_load_dwordx4 v0, s[4:7], s55 offen sc1 lds
s_add_u32 m0, s54, 8192
s_add_u32 s55, s53, 8192
buffer_load_dwordx4 v0, s[4:7], s55 offen sc1 lds
s_add_u32 m0, s54, 12288
s_add_u32 s55, s53, 12288
buffer_load_dwordx4 v0, s[4:7], s55 offen sc1 lds
s_add_u32 m0, s54, 16384
s_add_u32 s55, s53, 16384
buffer_load_dwordx4 v0, s[4:7], s55 offen sc1 lds
s_add_u32 m0, s54, 20480
s_add_u32 s55, s53, 20480
buffer_load_dwordx4 v0, s[4:7], s55 offen sc1 lds
s_add_u32 m0, s54, 24576
s_add_u32 s55, s53, 24576
buffer_load_dwordx4 v0, s[4:7], s55 offen sc1 lds
s_add_u32 m0, s54, 28672
s_add_u32 s55, s53, 28672
buffer_load_dwordx4 v0, s[4:7], s55 offen sc1 lds
s_add_u32 m0, s54, 32768
s_add_u32 s55, s53, 32768
buffer_load_dwordx4 v0, s[4:7], s55 offen sc1 lds
s_add_u32 m0, s54, 36864
s_add_u32 s55, s53, 36864
buffer_load_dwordx4 v0, s[4:7], s55 offen sc1 lds
s_add_u32 m0, s54, 40960
s_add_u32 s55, s53, 40960
buffer_load_dwordx4 v0, s[4:7], s55 offen sc1 lds
s_add_u32 m0, s54, 45056
s_add_u32 s55, s53, 45056
buffer_load_dwordx4 v0, s[4:7], s55 offen sc1 lds
s_add_u32 m0, s54, 49152
s_add_u32 s55, s53, 49152
buffer_load_dwordx4 v0, s[4:7], s55 offen sc1 lds
s_add_u32 m0, s54, 53248
s_add_u32 s55, s53, 53248
buffer_load_dwordx4 v0, s[4:7], s55 offen sc1 lds
s_add_u32 m0, s54, 57344
s_add_u32 s55, s53, 57344
buffer_load_dwordx4 v0, s[4:7], s55 offen sc1 lds
s_add_u32 m0, s54, 61440
s_add_u32 s55, s53, 61440
buffer_load_dwordx4 v0, s[4:7], s55 offen sc1 lds
s_lshl_b32 s64, s40, 14
s_lshl_b32 s50, s42, 11
s_add_u32 s64, s64, s50
s_add_u32 s64, s64, 155189248
s_waitcnt vmcnt(16)
s_barrier
s_cmp_lg_u32 s42, 0
s_cbranch_scc1 Lgup_w_217
s_mov_b64 exec, 1
buffer_store_dword v4, v3, s[4:7], s59 offen sc1
s_mov_b64 exec, -1
Lgup_w_217:
s_waitcnt vmcnt(8)
s_branch Lgup_top0
Lgup_last1:
s_waitcnt lgkmcnt(6)
v_mfma_f32_32x32x16_bf16 v[72:87], a[8:11], v[16:19], v[72:87]
ds_read_b128 v[12:15], v5 offset:9216
v_mul_f32 v56, v40, v40
v_mul_f32 v57, v41, v41
v_mul_f32 v58, v42, v42
v_mul_f32 v59, v43, v43
s_waitcnt lgkmcnt(6)
v_mfma_f32_32x32x16_bf16 v[72:87], a[12:15], v[20:23], v[72:87]
ds_read_b128 v[16:19], v5 offset:10240
v_mul_f32 v60, v44, v44
v_mul_f32 v61, v45, v45
v_mul_f32 v62, v46, v46
v_mul_f32 v63, v47, v47
s_waitcnt lgkmcnt(6)
v_mfma_f32_32x32x16_bf16 v[72:87], a[16:19], v[24:27], v[72:87]
ds_read_b128 v[20:23], v5 offset:11264
v_fma_f32 v56, v56, s72, v6
v_fma_f32 v57, v57, s72, v6
v_fma_f32 v58, v58, s72, v6
v_fma_f32 v59, v59, s72, v6
s_waitcnt lgkmcnt(6)
v_mfma_f32_32x32x16_bf16 v[72:87], a[20:23], v[28:31], v[72:87]
ds_read_b128 v[24:27], v5 offset:12288
v_fma_f32 v60, v60, s72, v6
v_fma_f32 v61, v61, s72, v6
v_fma_f32 v62, v62, s72, v6
v_fma_f32 v63, v63, s72, v6
s_waitcnt lgkmcnt(6)
v_mfma_f32_32x32x16_bf16 v[72:87], a[24:27], v[32:35], v[72:87]
ds_read_b128 v[28:31], v5 offset:13312
v_mul_f32 v56, v56, v40
v_mul_f32 v57, v57, v41
v_mul_f32 v58, v58, v42
v_mul_f32 v59, v59, v43
s_waitcnt lgkmcnt(6)
v_mfma_f32_32x32x16_bf16 v[72:87], a[28:31], v[36:39], v[72:87]
ds_read_b128 v[32:35], v5 offset:14336
v_mul_f32 v60, v60, v44
v_mul_f32 v61, v61, v45
v_mul_f32 v62, v62, v46
v_mul_f32 v63, v63, v47
s_waitcnt lgkmcnt(6)
v_mfma_f32_32x32x16_bf16 v[72:87], a[32:35], v[8:11], v[72:87]
ds_read_b128 v[36:39], v5 offset:15360
v_exp_f32 v56, v56
v_mul_f32 v40, v40, v48
v_exp_f32 v57, v57
s_waitcnt lgkmcnt(6)
v_mfma_f32_32x32x16_bf16 v[72:87], a[36:39], v[12:15], v[72:87]
ds_read_b128 v[8:11], v5 offset:16384
v_mul_f32 v41, v41, v49
v_exp_f32 v58, v58
v_mul_f32 v42, v42, v50
s_waitcnt lgkmcnt(6)
v_mfma_f32_32x32x16_bf16 v[72:87], a[40:43], v[16:19], v[72:87]
ds_read_b128 v[12:15], v5 offset:17408
v_exp_f32 v59, v59
v_mul_f32 v43, v43, v51
v_exp_f32 v60, v60
s_waitcnt lgkmcnt(6)
v_mfma_f32_32x32x16_bf16 v[72:87], a[44:47], v[20:23], v[72:87]
ds_read_b128 v[16:19], v5 offset:18432
v_mul_f32 v44, v44, v52
v_exp_f32 v61, v61
v_mul_f32 v45, v45, v53
s_waitcnt lgkmcnt(6)
v_mfma_f32_32x32x16_bf16 v[72:87], a[48:51], v[24:27], v[72:87]
ds_read_b128 v[20:23], v5 offset:19456
v_exp_f32 v62, v62
v_mul_f32 v46, v46, v54
v_exp_f32 v63, v63
s_waitcnt lgkmcnt(6)
v_mfma_f32_32x32x16_bf16 v[72:87], a[52:55], v[28:31], v[72:87]
ds_read_b128 v[24:27], v5 offset:20480
v_mul_f32 v47, v47, v55
v_add_f32 v56, 1.0, v56
v_add_f32 v57, 1.0, v57
v_add_f32 v58, 1.0, v58
s_waitcnt lgkmcnt(6)
v_mfma_f32_32x32x16_bf16 v[72:87], a[56:59], v[32:35], v[72:87]
ds_read_b128 v[28:31], v5 offset:21504
v_add_f32 v59, 1.0, v59
v_add_f32 v60, 1.0, v60
v_add_f32 v61, 1.0, v61
v_add_f32 v62, 1.0, v62
s_waitcnt lgkmcnt(6)
v_mfma_f32_32x32x16_bf16 v[72:87], a[60:63], v[36:39], v[72:87]
ds_read_b128 v[32:35], v5 offset:22528
v_add_f32 v63, 1.0, v63
v_rcp_f32 v56, v56
v_rcp_f32 v57, v57
s_waitcnt lgkmcnt(6)
v_mfma_f32_32x32x16_bf16 v[72:87], a[64:67], v[8:11], v[72:87]
ds_read_b128 v[36:39], v5 offset:23552
v_rcp_f32 v58, v58
v_rcp_f32 v59, v59
s_waitcnt lgkmcnt(6)
v_mfma_f32_32x32x16_bf16 v[72:87], a[68:71], v[12:15], v[72:87]
ds_read_b128 v[8:11], v5 offset:24576
v_rcp_f32 v60, v60
v_rcp_f32 v61, v61
s_waitcnt lgkmcnt(6)
v_mfma_f32_32x32x16_bf16 v[72:87], a[72:75], v[16:19], v[72:87]
ds_read_b128 v[12:15], v5 offset:25600
v_rcp_f32 v62, v62
v_rcp_f32 v63, v63
s_waitcnt lgkmcnt(6)
v_mfma_f32_32x32x16_bf16 v[72:87], a[76:79], v[20:23], v[72:87]
ds_read_b128 v[16:19], v5 offset:26624
v_mul_f32 v40, v40, v56
v_mul_f32 v41, v41, v57
v_mul_f32 v42, v42, v58
v_mul_f32 v43, v43, v59
s_waitcnt lgkmcnt(6)
v_mfma_f32_32x32x16_bf16 v[72:87], a[80:83], v[24:27], v[72:87]
ds_read_b128 v[20:23], v5 offset:27648
v_mul_f32 v44, v44, v60
v_mul_f32 v45, v45, v61
v_mul_f32 v46, v46, v62
v_mul_f32 v47, v47, v63
s_waitcnt lgkmcnt(6)
v_mfma_f32_32x32x16_bf16 v[72:87], a[84:87], v[28:31], v[72:87]
ds_read_b128 v[24:27], v5 offset:28672
v_cvt_pk_bf16_f32 v64, v40, v41
v_cvt_pk_bf16_f32 v65, v42, v43
v_cvt_pk_bf16_f32 v66, v44, v45
v_cvt_pk_bf16_f32 v67, v46, v47
s_waitcnt lgkmcnt(6)
v_mfma_f32_32x32x16_bf16 v[72:87], a[88:91], v[32:35], v[72:87]
ds_read_b128 v[28:31], v5 offset:29696
buffer_store_dwordx4 v[64:67], v0, s[4:7], s64 offen sc1
s_waitcnt lgkmcnt(6)
v_mfma_f32_32x32x16_bf16 v[72:87], a[92:95], v[36:39], v[72:87]
ds_read_b128 v[32:35], v5 offset:30720
s_waitcnt vmcnt(1) lgkmcnt(2)
s_barrier
s_waitcnt lgkmcnt(6)
v_mfma_f32_32x32x16_bf16 v[72:87], a[96:99], v[8:11], v[72:87]
ds_read_b128 v[36:39], v5 offset:31744
s_waitcnt lgkmcnt(6)
v_mfma_f32_32x32x16_bf16 v[72:87], a[100:103], v[12:15], v[72:87]
ds_read_b128 v[8:11], v5 offset:32768
s_waitcnt lgkmcnt(6)
v_mfma_f32_32x32x16_bf16 v[72:87], a[104:107], v[16:19], v[72:87]
ds_read_b128 v[12:15], v5 offset:33792
s_waitcnt lgkmcnt(6)
v_mfma_f32_32x32x16_bf16 v[72:87], a[108:111], v[20:23], v[72:87]
ds_read_b128 v[16:19], v5 offset:34816
s_waitcnt lgkmcnt(6)
v_mfma_f32_32x32x16_bf16 v[72:87], a[112:115], v[24:27], v[72:87]
ds_read_b128 v[20:23], v5 offset:35840
s_waitcnt lgkmcnt(6)
v_mfma_f32_32x32x16_bf16 v[72:87], a[116:119], v[28:31], v[72:87]
ds_read_b128 v[24:27], v5 offset:36864
s_waitcnt lgkmcnt(6)
v_mfma_f32_32x32x16_bf16 v[72:87], a[120:123], v[32:35], v[72:87]
ds_read_b128 v[28:31], v5 offset:37888
s_waitcnt lgkmcnt(6)
v_mfma_f32_32x32x16_bf16 v[72:87], a[124:127], v[36:39], v[72:87]
ds_read_b128 v[32:35], v5 offset:38912
s_waitcnt lgkmcnt(6)
v_mfma_f32_32x32x16_bf16 v[72:87], a[128:131], v[8:11], v[72:87]
ds_read_b128 v[36:39], v5 offset:39936
s_waitcnt lgkmcnt(6)
v_mfma_f32_32x32x16_bf16 v[72:87], a[132:135], v[12:15], v[72:87]
ds_read_b128 v[8:11], v5 offset:40960
s_waitcnt lgkmcnt(6)
v_mfma_f32_32x32x16_bf16 v[72:87], a[136:139], v[16:19], v[72:87]
ds_read_b128 v[12:15], v5 offset:41984
s_waitcnt lgkmcnt(6)
v_mfma_f32_32x32x16_bf16 v[72:87], a[140:143], v[20:23], v[72:87]
ds_read_b128 v[16:19], v5 offset:43008
s_waitcnt lgkmcnt(6)
v_mfma_f32_32x32x16_bf16 v[72:87], a[144:147], v[24:27], v[72:87]
ds_read_b128 v[20:23], v5 offset:44032
s_waitcnt lgkmcnt(6)
v_mfma_f32_32x32x16_bf16 v[72:87], a[148:151], v[28:31], v[72:87]
ds_read_b128 v[24:27], v5 offset:45056
s_waitcnt lgkmcnt(6)
v_mfma_f32_32x32x16_bf16 v[72:87], a[152:155], v[32:35], v[72:87]
ds_read_b128 v[28:31], v5 offset:46080
s_waitcnt lgkmcnt(6)
v_mfma_f32_32x32x16_bf16 v[72:87], a[156:159], v[36:39], v[72:87]
ds_read_b128 v[32:35], v5 offset:47104
s_waitcnt lgkmcnt(6)
v_mfma_f32_32x32x16_bf16 v[72:87], a[160:163], v[8:11], v[72:87]
ds_read_b128 v[36:39], v5 offset:48128
s_waitcnt lgkmcnt(6)
v_mfma_f32_32x32x16_bf16 v[72:87], a[164:167], v[12:15], v[72:87]
ds_read_b128 v[8:11], v5 offset:49152
s_waitcnt lgkmcnt(6)
v_mfma_f32_32x32x16_bf16 v[72:87], a[168:171], v[16:19], v[72:87]
ds_read_b128 v[12:15], v5 offset:50176
s_waitcnt lgkmcnt(6)
v_mfma_f32_32x32x16_bf16 v[72:87], a[172:175], v[20:23], v[72:87]
ds_read_b128 v[16:19], v5 offset:51200
s_waitcnt lgkmcnt(6)
v_mfma_f32_32x32x16_bf16 v[72:87], a[176:179], v[24:27], v[72:87]
ds_read_b128 v[20:23], v5 offset:52224
s_waitcnt lgkmcnt(6)
v_mfma_f32_32x32x16_bf16 v[72:87], a[180:183], v[28:31], v[72:87]
ds_read_b128 v[24:27], v5 offset:53248
s_waitcnt lgkmcnt(6)
v_mfma_f32_32x32x16_bf16 v[72:87], a[184:187], v[32:35], v[72:87]
ds_read_b128 v[28:31], v5 offset:54272
s_waitcnt lgkmcnt(6)
v_mfma_f32_32x32x16_bf16 v[72:87], a[188:191], v[36:39], v[72:87]
ds_read_b128 v[32:35], v5 offset:55296
s_waitcnt lgkmcnt(6)
v_mfma_f32_32x32x16_bf16 v[72:87], a[192:195], v[8:11], v[72:87]
ds_read_b128 v[36:39], v5 offset:56320
s_waitcnt lgkmcnt(6)
v_mfma_f32_32x32x16_bf16 v[72:87], a[196:199], v[12:15], v[72:87]
ds_read_b128 v[8:11], v5 offset:57344
s_waitcnt lgkmcnt(6)
v_mfma_f32_32x32x16_bf16 v[72:87], a[200:203], v[16:19], v[72:87]
ds_read_b128 v[12:15], v5 offset:58368
s_waitcnt lgkmcnt(6)
v_mfma_f32_32x32x16_bf16 v[72:87], a[204:207], v[20:23], v[72:87]
ds_read_b128 v[16:19], v5 offset:59392
s_waitcnt lgkmcnt(6)
v_mfma_f32_32x32x16_bf16 v[72:87], a[208:211], v[24:27], v[72:87]
ds_read_b128 v[20:23], v5 offset:60416
s_waitcnt lgkmcnt(6)
v_mfma_f32_32x32x16_bf16 v[72:87], a[212:215], v[28:31], v[72:87]
ds_read_b128 v[24:27], v5 offset:61440
s_waitcnt vmcnt(0)
s_barrier
s_waitcnt lgkmcnt(6)
v_mfma_f32_32x32x16_bf16 v[72:87], a[216:219], v[32:35], v[72:87]
ds_read_b128 v[28:31], v5 offset:62464
s_cmp_lg_u32 s42, 0
s_cbranch_scc1 Lgup_w_218
s_mov_b64 exec, 1
buffer_store_dword v4, v3, s[4:7], s59 offen sc1
s_mov_b64 exec, -1
Lgup_w_218:
s_waitcnt lgkmcnt(6)
v_mfma_f32_32x32x16_bf16 v[72:87], a[220:223], v[36:39], v[72:87]
ds_read_b128 v[32:35], v5 offset:63488
s_waitcnt lgkmcnt(6)
v_mfma_f32_32x32x16_bf16 v[72:87], a[224:227], v[8:11], v[72:87]
ds_read_b128 v[36:39], v5 offset:64512
s_waitcnt lgkmcnt(6)
v_mfma_f32_32x32x16_bf16 v[72:87], a[228:231], v[12:15], v[72:87]
s_waitcnt lgkmcnt(5)
v_mfma_f32_32x32x16_bf16 v[72:87], a[232:235], v[16:19], v[72:87]
s_waitcnt lgkmcnt(4)
v_mfma_f32_32x32x16_bf16 v[72:87], a[236:239], v[20:23], v[72:87]
s_waitcnt lgkmcnt(3)
v_mfma_f32_32x32x16_bf16 v[72:87], a[240:243], v[24:27], v[72:87]
s_waitcnt lgkmcnt(2)
v_mfma_f32_32x32x16_bf16 v[72:87], a[244:247], v[28:31], v[72:87]
s_waitcnt lgkmcnt(1)
v_mfma_f32_32x32x16_bf16 v[72:87], a[248:251], v[32:35], v[72:87]
s_waitcnt lgkmcnt(0)
v_mfma_f32_32x32x16_bf16 v[72:87], a[252:255], v[36:39], v[72:87]
s_mov_b32 s64, s57
s_add_u32 s50, s46, 1
s_add_u32 s57, s57, s58
v_mov_b32 v4, s50
s_nop 7
v_pk_mul_f32 v[56:57], v[72:73], v[72:73]
v_pk_mul_f32 v[58:59], v[74:75], v[74:75]
v_pk_mul_f32 v[60:61], v[76:77], v[76:77]
v_pk_mul_f32 v[62:63], v[78:79], v[78:79]
v_pk_fma_f32 v[56:57], v[56:57], s[72:73], v[6:7]
v_pk_fma_f32 v[58:59], v[58:59], s[72:73], v[6:7]
v_pk_fma_f32 v[60:61], v[60:61], s[72:73], v[6:7]
v_pk_fma_f32 v[62:63], v[62:63], s[72:73], v[6:7]
v_pk_mul_f32 v[56:57], v[56:57], v[72:73]
v_pk_mul_f32 v[58:59], v[58:59], v[74:75]
v_pk_mul_f32 v[60:61], v[60:61], v[76:77]
v_pk_mul_f32 v[62:63], v[62:63], v[78:79]
v_exp_f32 v56, v56
v_exp_f32 v57, v57
v_exp_f32 v58, v58
v_exp_f32 v59, v59
v_exp_f32 v60, v60
v_exp_f32 v61, v61
v_exp_f32 v62, v62
v_exp_f32 v63, v63
v_pk_mul_f32 v[72:73], v[72:73], v[80:81]
v_pk_mul_f32 v[74:75], v[74:75], v[82:83]
v_pk_mul_f32 v[76:77], v[76:77], v[84:85]
v_pk_mul_f32 v[78:79], v[78:79], v[86:87]
v_pk_add_f32 v[56:57], v[56:57], 1.0 op_sel_hi:[1,0]
v_pk_add_f32 v[58:59], v[58:59], 1.0 op_sel_hi:[1,0]
v_pk_add_f32 v[60:61], v[60:61], 1.0 op_sel_hi:[1,0]
v_pk_add_f32 v[62:63], v[62:63], 1.0 op_sel_hi:[1,0]
v_rcp_f32 v56, v56
v_rcp_f32 v57, v57
v_rcp_f32 v58, v58
v_rcp_f32 v59, v59
v_rcp_f32 v60, v60
v_rcp_f32 v61, v61
v_rcp_f32 v62, v62
v_rcp_f32 v63, v63
v_pk_mul_f32 v[72:73], v[72:73], v[56:57]
v_pk_mul_f32 v[74:75], v[74:75], v[58:59]
v_pk_mul_f32 v[76:77], v[76:77], v[60:61]
v_pk_mul_f32 v[78:79], v[78:79], v[62:63]
v_cvt_pk_bf16_f32 v64, v72, v73
v_cvt_pk_bf16_f32 v65, v74, v75
v_cvt_pk_bf16_f32 v66, v76, v77
v_cvt_pk_bf16_f32 v67, v78, v79
buffer_store_dwordx4 v[64:67], v0, s[4:7], s64 offen sc1
s_waitcnt vmcnt(0)
s_barrier
s_cmp_lg_u32 s42, 0
s_cbranch_scc1 Lgup_w_219
s_mov_b64 exec, 1
buffer_store_dword v4, v3, s[4:7], s59 offen sc1
s_mov_b64 exec, -1
Lgup_w_219:
s_branch Lend
Lgdown:
s_mov_b32 s65, 0x10000
v_mov_b32 v71, 131072
v_mov_b32 v4, s46
s_mov_b32 s62, 0
s_mul_i32 s50, s62, s61
s_add_u32 s62, s62, 1
s_cmp_eq_u32 s62, s78
s_cselect_b32 s62, 0, s62
s_mul_i32 s51, s62, s61
s_sub_u32 s51, s51, s50
s_add_u32 s63, s46, 1
v_mad_i32_i24 v68, v88, s51, v1
v_add_u32 v68, s50, v68
v_add_u32 v69, s63, v88
Lgdown_cold:
s_cmp_lg_u32 s42, 0
s_cbranch_scc1 Lgdown_w_220
Lgdown_sp:
buffer_load_dword v2, v68, s[4:7], s60 offen sc1
s_waitcnt vmcnt(0)
v_cmp_gt_i32 vcc, v69, v2
s_nop 0
s_cmp_eq_u32 vcc_lo, 0
s_cbranch_scc1 Lgdown_spd
s_sleep 2
s_sub_u32 s43, s43, 1
s_cbranch_scc0 Lgdown_sp
s_mov_b32 s43, 0
Lgdown_spd:
v_mov_b32 v70, vcc_hi
ds_write_b32 v71, v70
s_waitcnt lgkmcnt(0)
Lgdown_w_220:
s_barrier
Lgdown_fetch:
s_lshl_b32 s53, s42, 10
s_xor_b32 s54, s65, 0x10000
s_add_u32 s54, s54, s53
s_add_u32 s53, s53, s49
s_add_u32 m0, s54, 0
s_add_u32 s55, s53, 0
buffer_load_dwordx4 v0, s[4:7], s55 offen sc1 lds
s_add_u32 m0, s54, 4096
s_add_u32 s55, s53, 4096
buffer_load_dwordx4 v0, s[4:7], s55 offen sc1 lds
s_add_u32 m0, s54, 8192
s_add_u32 s55, s53, 8192
buffer_load_dwordx4 v0, s[4:7], s55 offen sc1 lds
s_add_u32 m0, s54, 12288
s_add_u32 s55, s53, 12288
buffer_load_dwordx4 v0, s[4:7], s55 offen sc1 lds
s_add_u32 m0, s54, 16384
s_add_u32 s55, s53, 16384
buffer_load_dwordx4 v0, s[4:7], s55 offen sc1 lds
s_add_u32 m0, s54, 20480
s_add_u32 s55, s53, 20480
buffer_load_dwordx4 v0, s[4:7], s55 offen sc1 lds
s_add_u32 m0, s54, 24576
s_add_u32 s55, s53, 24576
buffer_load_dwordx4 v0, s[4:7], s55 offen sc1 lds
s_add_u32 m0, s54, 28672
s_add_u32 s55, s53, 28672
buffer_load_dwordx4 v0, s[4:7], s55 offen sc1 lds
s_add_u32 m0, s54, 32768
s_add_u32 s55, s53, 32768
buffer_load_dwordx4 v0, s[4:7], s55 offen sc1 lds
s_add_u32 m0, s54, 36864
s_add_u32 s55, s53, 36864
buffer_load_dwordx4 v0, s[4:7], s55 offen sc1 lds
s_add_u32 m0, s54, 40960
s_add_u32 s55, s53, 40960
buffer_load_dwordx4 v0, s[4:7], s55 offen sc1 lds
s_add_u32 m0, s54, 45056
s_add_u32 s55, s53, 45056
buffer_load_dwordx4 v0, s[4:7], s55 offen sc1 lds
s_add_u32 m0, s54, 49152
s_add_u32 s55, s53, 49152
buffer_load_dwordx4 v0, s[4:7], s55 offen sc1 lds
s_add_u32 m0, s54, 53248
s_add_u32 s55, s53, 53248
buffer_load_dwordx4 v0, s[4:7], s55 offen sc1 lds
s_lshl_b32 s64, s40, 14
s_lshl_b32 s50, s42, 11
s_add_u32 s64, s64, s50
s_add_u32 s64, s64, 155189248
s_waitcnt vmcnt(6)
Lgdown_top0:
s_cmp_lg_u32 s42, 0
s_cbranch_scc1 Lgdown_w_221
s_mul_i32 s50, s62, s61
s_add_u32 s62, s62, 1
s_cmp_eq_u32 s62, s78
s_cselect_b32 s62, 0, s62
s_mul_i32 s51, s62, s61
s_sub_u32 s51, s51, s50
s_add_u32 s63, s46, 2
v_mad_i32_i24 v68, v88, s51, v1
v_add_u32 v68, s50, v68
v_add_u32 v69, s63, v88
buffer_load_dword v2, v68, s[4:7], s60 offen sc1
Lgdown_w_221:
s_xor_b32 s65, s65, 0x10000
s_add_u32 s49, s49, s56
v_add_u32 v5, s65, v0
s_barrier
ds_read_b128 v[8:11], v5 offset:0
ds_read_b128 v[12:15], v5 offset:1024
ds_read_b32 v70, v71 offset:0
ds_read_b128 v[16:19], v5 offset:2048
s_lshl_b32 s53, s42, 10
s_xor_b32 s54, s65, 0x10000
s_add_u32 s54, s54, s53
s_add_u32 s53, s53, s49
s_waitcnt lgkmcnt(3)
v_mfma_f32_32x32x16_bf16 v[40:55], a[0:3], v[8:11], 0
ds_read_b128 v[20:23], v5 offset:3072
ds_read_b128 v[24:27], v5 offset:4096
ds_read_b128 v[28:31], v5 offset:5120
ds_read_b128 v[32:35], v5 offset:6144
s_waitcnt lgkmcnt(5)
v_mfma_f32_32x32x16_bf16 v[40:55], a[4:7], v[12:15], v[40:55]
ds_read_b128 v[36:39], v5 offset:7168
ds_read_b128 v[8:11], v5 offset:8192
v_readfirstlane_b32 s50, v70
s_cmp_le_u32 s47, 1
s_cbranch_scc1 Lgdown_last0
s_cmp_lg_u32 s50, 0
s_cbranch_scc1 Lgdown_nop0
s_waitcnt lgkmcnt(6)
v_mfma_f32_32x32x16_bf16 v[40:55], a[8:11], v[16:19], v[40:55]
ds_read_b128 v[12:15], v5 offset:9216
s_add_u32 m0, s54, 0
s_add_u32 s55, s53, 0
buffer_load_dwordx4 v0, s[4:7], s55 offen sc1 lds
v_cvt_pk_bf16_f32 v56, v72, v73
s_waitcnt lgkmcnt(6)
v_mfma_f32_32x32x16_bf16 v[40:55], a[12:15], v[20:23], v[40:55]
ds_read_b128 v[16:19], v5 offset:10240
v_cvt_pk_bf16_f32 v57, v74, v75
v_cvt_pk_bf16_f32 v58, v76, v77
v_cvt_pk_bf16_f32 v59, v78, v79
buffer_store_dwordx4 v[56:59], v0, s[4:7], s64 offen sc1
s_waitcnt lgkmcnt(6)
v_mfma_f32_32x32x16_bf16 v[40:55], a[16:19], v[24:27], v[40:55]
ds_read_b128 v[20:23], v5 offset:11264
s_add_u32 m0, s54, 4096
s_add_u32 s55, s53, 4096
buffer_load_dwordx4 v0, s[4:7], s55 offen sc1 lds
s_add_u32 s64, s64, 4096
s_waitcnt lgkmcnt(6)
v_mfma_f32_32x32x16_bf16 v[40:55], a[20:23], v[28:31], v[40:55]
ds_read_b128 v[24:27], v5 offset:12288
v_cvt_pk_bf16_f32 v60, v80, v81
v_cvt_pk_bf16_f32 v61, v82, v83
v_cvt_pk_bf16_f32 v62, v84, v85
v_cvt_pk_bf16_f32 v63, v86, v87
s_waitcnt lgkmcnt(6)
v_mfma_f32_32x32x16_bf16 v[40:55], a[24:27], v[32:35], v[40:55]
ds_read_b128 v[28:31], v5 offset:13312
s_add_u32 m0, s54, 8192
s_add_u32 s55, s53, 8192
buffer_load_dwordx4 v0, s[4:7], s55 offen sc1 lds
buffer_store_dwordx4 v[60:63], v0, s[4:7], s64 offen sc1
s_waitcnt lgkmcnt(6)
v_mfma_f32_32x32x16_bf16 v[40:55], a[28:31], v[36:39], v[40:55]
ds_read_b128 v[32:35], v5 offset:14336
s_waitcnt lgkmcnt(6)
v_mfma_f32_32x32x16_bf16 v[40:55], a[32:35], v[8:11], v[40:55]
ds_read_b128 v[36:39], v5 offset:15360
s_add_u32 m0, s54, 12288
s_add_u32 s55, s53, 12288
buffer_load_dwordx4 v0, s[4:7], s55 offen sc1 lds
s_waitcnt lgkmcnt(6)
v_mfma_f32_32x32x16_bf16 v[40:55], a[36:39], v[12:15], v[40:55]
ds_read_b128 v[8:11], v5 offset:16384
s_waitcnt lgkmcnt(6)
v_mfma_f32_32x32x16_bf16 v[40:55], a[40:43], v[16:19], v[40:55]
ds_read_b128 v[12:15], v5 offset:17408
s_add_u32 m0, s54, 16384
s_add_u32 s55, s53, 16384
buffer_load_dwordx4 v0, s[4:7], s55 offen sc1 lds
s_waitcnt lgkmcnt(6)
v_mfma_f32_32x32x16_bf16 v[40:55], a[44:47], v[20:23], v[40:55]
ds_read_b128 v[16:19], v5 offset:18432
s_waitcnt lgkmcnt(6)
v_mfma_f32_32x32x16_bf16 v[40:55], a[48:51], v[24:27], v[40:55]
ds_read_b128 v[20:23], v5 offset:19456
s_add_u32 m0, s54, 20480
s_add_u32 s55, s53, 20480
buffer_load_dwordx4 v0, s[4:7], s55 offen sc1 lds
s_waitcnt lgkmcnt(6)
v_mfma_f32_32x32x16_bf16 v[40:55], a[52:55], v[28:31], v[40:55]
ds_read_b128 v[24:27], v5 offset:20480
s_waitcnt lgkmcnt(6)
v_mfma_f32_32x32x16_bf16 v[40:55], a[56:59], v[32:35], v[40:55]
ds_read_b128 v[28:31], v5 offset:21504
s_add_u32 m0, s54, 24576
s_add_u32 s55, s53, 24576
buffer_load_dwordx4 v0, s[4:7], s55 offen sc1 lds
s_waitcnt lgkmcnt(6)
v_mfma_f32_32x32x16_bf16 v[40:55], a[60:63], v[36:39], v[40:55]
ds_read_b128 v[32:35], v5 offset:22528
s_waitcnt lgkmcnt(6)
v_mfma_f32_32x32x16_bf16 v[40:55], a[64:67], v[8:11], v[40:55]
ds_read_b128 v[36:39], v5 offset:23552
s_add_u32 m0, s54, 28672
s_add_u32 s55, s53, 28672
buffer_load_dwordx4 v0, s[4:7], s55 offen sc1 lds
s_waitcnt lgkmcnt(6)
v_mfma_f32_32x32x16_bf16 v[40:55], a[68:71], v[12:15], v[40:55]
ds_read_b128 v[8:11], v5 offset:24576
s_waitcnt lgkmcnt(6)
v_mfma_f32_32x32x16_bf16 v[40:55], a[72:75], v[16:19], v[40:55]
ds_read_b128 v[12:15], v5 offset:25600
s_add_u32 m0, s54, 32768
s_add_u32 s55, s53, 32768
buffer_load_dwordx4 v0, s[4:7], s55 offen sc1 lds
s_waitcnt lgkmcnt(6)
v_mfma_f32_32x32x16_bf16 v[40:55], a[76:79], v[20:23], v[40:55]
ds_read_b128 v[16:19], v5 offset:26624
s_waitcnt lgkmcnt(6)
v_mfma_f32_32x32x16_bf16 v[40:55], a[80:83], v[24:27], v[40:55]
ds_read_b128 v[20:23], v5 offset:27648
s_add_u32 m0, s54, 36864
s_add_u32 s55, s53, 36864
buffer_load_dwordx4 v0, s[4:7], s55 offen sc1 lds
s_waitcnt lgkmcnt(6)
v_mfma_f32_32x32x16_bf16 v[40:55], a[84:87], v[28:31], v[40:55]
ds_read_b128 v[24:27], v5 offset:28672
s_cmp_lg_u32 s42, 0
s_cbranch_scc1 Lgdown_w_222
s_waitcnt vmcnt(12)
v_cmp_gt_i32 vcc, v69, v2
s_nop 1
v_mov_b32 v70, vcc_hi
v_mov_b32 v2, vcc_lo
ds_write2_b32 v71, v70, v2 offset0:4 offset1:1
Lgdown_w_222:
s_waitcnt lgkmcnt(6)
v_mfma_f32_32x32x16_bf16 v[40:55], a[88:91], v[32:35], v[40:55]
ds_read_b128 v[28:31], v5 offset:29696
s_add_u32 m0, s54, 40960
s_add_u32 s55, s53, 40960
buffer_load_dwordx4 v0, s[4:7], s55 offen sc1 lds
s_waitcnt lgkmcnt(6)
v_mfma_f32_32x32x16_bf16 v[40:55], a[92:95], v[36:39], v[40:55]
ds_read_b128 v[32:35], v5 offset:30720
s_waitcnt vmcnt(13) lgkmcnt(2)
s_barrier
s_waitcnt lgkmcnt(6)
v_mfma_f32_32x32x16_bf16 v[40:55], a[96:99], v[8:11], v[40:55]
ds_read_b128 v[36:39], v5 offset:31744
s_add_u32 m0, s54, 45056
s_add_u32 s55, s53, 45056
buffer_load_dwordx4 v0, s[4:7], s55 offen sc1 lds
s_waitcnt lgkmcnt(6)
v_mfma_f32_32x32x16_bf16 v[40:55], a[100:103], v[12:15], v[40:55]
ds_read_b128 v[8:11], v5 offset:32768
s_waitcnt lgkmcnt(6)
v_mfma_f32_32x32x16_bf16 v[40:55], a[104:107], v[16:19], v[40:55]
ds_read_b128 v[12:15], v5 offset:33792
s_add_u32 m0, s54, 49152
s_add_u32 s55, s53, 49152
buffer_load_dwordx4 v0, s[4:7], s55 offen sc1 lds
s_waitcnt lgkmcnt(6)
v_mfma_f32_32x32x16_bf16 v[40:55], a[108:111], v[20:23], v[40:55]
ds_read_b128 v[16:19], v5 offset:34816
s_waitcnt lgkmcnt(6)
v_mfma_f32_32x32x16_bf16 v[40:55], a[112:115], v[24:27], v[40:55]
ds_read_b128 v[20:23], v5 offset:35840
s_add_u32 m0, s54, 53248
s_add_u32 s55, s53, 53248
buffer_load_dwordx4 v0, s[4:7], s55 offen sc1 lds
s_waitcnt lgkmcnt(6)
v_mfma_f32_32x32x16_bf16 v[40:55], a[116:119], v[28:31], v[40:55]
ds_read_b128 v[24:27], v5 offset:36864
s_waitcnt lgkmcnt(6)
v_mfma_f32_32x32x16_bf16 v[40:55], a[120:123], v[32:35], v[40:55]
ds_read_b128 v[28:31], v5 offset:37888
s_waitcnt lgkmcnt(6)
v_mfma_f32_32x32x16_bf16 v[40:55], a[124:127], v[36:39], v[40:55]
ds_read_b128 v[32:35], v5 offset:38912
s_waitcnt lgkmcnt(6)
v_mfma_f32_32x32x16_bf16 v[40:55], a[128:131], v[8:11], v[40:55]
ds_read_b128 v[36:39], v5 offset:39936
s_waitcnt lgkmcnt(6)
v_mfma_f32_32x32x16_bf16 v[40:55], a[132:135], v[12:15], v[40:55]
ds_read_b128 v[8:11], v5 offset:40960
s_waitcnt vmcnt(11)
s_barrier
s_waitcnt lgkmcnt(6)
v_mfma_f32_32x32x16_bf16 v[40:55], a[136:139], v[16:19], v[40:55]
ds_read_b128 v[12:15], v5 offset:41984
s_cmp_lg_u32 s42, 0
s_cbranch_scc1 Lgdown_w_223
s_mov_b64 exec, 1
buffer_store_dword v4, v3, s[4:7], s59 offen sc1
s_mov_b64 exec, -1
Lgdown_w_223:
s_waitcnt lgkmcnt(6)
v_mfma_f32_32x32x16_bf16 v[40:55], a[140:143], v[20:23], v[40:55]
ds_read_b128 v[16:19], v5 offset:43008
s_waitcnt lgkmcnt(6)
v_mfma_f32_32x32x16_bf16 v[40:55], a[144:147], v[24:27], v[40:55]
ds_read_b128 v[20:23], v5 offset:44032
s_waitcnt lgkmcnt(6)
v_mfma_f32_32x32x16_bf16 v[40:55], a[148:151], v[28:31], v[40:55]
ds_read_b128 v[24:27], v5 offset:45056
s_waitcnt lgkmcnt(6)
v_mfma_f32_32x32x16_bf16 v[40:55], a[152:155], v[32:35], v[40:55]
ds_read_b128 v[28:31], v5 offset:46080
s_waitcnt lgkmcnt(6)
v_mfma_f32_32x32x16_bf16 v[40:55], a[156:159], v[36:39], v[40:55]
ds_read_b128 v[32:35], v5 offset:47104
s_waitcnt lgkmcnt(6)
v_mfma_f32_32x32x16_bf16 v[40:55], a[160:163], v[8:11], v[40:55]
ds_read_b128 v[36:39], v5 offset:48128
s_waitcnt lgkmcnt(6)
v_mfma_f32_32x32x16_bf16 v[40:55], a[164:167], v[12:15], v[40:55]
ds_read_b128 v[8:11], v5 offset:49152
s_waitcnt lgkmcnt(6)
v_mfma_f32_32x32x16_bf16 v[40:55], a[168:171], v[16:19], v[40:55]
ds_read_b128 v[12:15], v5 offset:50176
s_waitcnt lgkmcnt(6)
v_mfma_f32_32x32x16_bf16 v[40:55], a[172:175], v[20:23], v[40:55]
ds_read_b128 v[16:19], v5 offset:51200
s_waitcnt lgkmcnt(6)
v_mfma_f32_32x32x16_bf16 v[40:55], a[176:179], v[24:27], v[40:55]
ds_read_b128 v[20:23], v5 offset:52224
s_waitcnt lgkmcnt(6)
v_mfma_f32_32x32x16_bf16 v[40:55], a[180:183], v[28:31], v[40:55]
ds_read_b128 v[24:27], v5 offset:53248
s_waitcnt lgkmcnt(6)
v_mfma_f32_32x32x16_bf16 v[40:55], a[184:187], v[32:35], v[40:55]
ds_read_b128 v[28:31], v5 offset:54272
s_waitcnt lgkmcnt(6)
v_mfma_f32_32x32x16_bf16 v[40:55], a[188:191], v[36:39], v[40:55]
ds_read_b128 v[32:35], v5 offset:55296
s_waitcnt lgkmcnt(6)
v_mfma_f32_32x32x16_bf16 v[40:55], a[192:195], v[8:11], v[40:55]
ds_read_b128 v[36:39], v5 offset:56320
s_waitcnt lgkmcnt(6)
v_mfma_f32_32x32x16_bf16 v[40:55], a[196:199], v[12:15], v[40:55]
s_waitcnt lgkmcnt(5)
v_mfma_f32_32x32x16_bf16 v[40:55], a[200:203], v[16:19], v[40:55]
s_waitcnt lgkmcnt(4)
v_mfma_f32_32x32x16_bf16 v[40:55], a[204:207], v[20:23], v[40:55]
s_waitcnt lgkmcnt(3)
v_mfma_f32_32x32x16_bf16 v[40:55], a[208:211], v[24:27], v[40:55]
s_waitcnt lgkmcnt(2)
v_mfma_f32_32x32x16_bf16 v[40:55], a[212:215], v[28:31], v[40:55]
s_waitcnt lgkmcnt(1)
v_mfma_f32_32x32x16_bf16 v[40:55], a[216:219], v[32:35], v[40:55]
s_waitcnt lgkmcnt(0)
v_mfma_f32_32x32x16_bf16 v[40:55], a[220:223], v[36:39], v[40:55]
s_mov_b32 s64, s57
s_add_u32 s50, s46, 1
s_add_u32 s57, s57, s58
v_mov_b32 v4, s50
s_add_u32 s46, s46, s48
s_sub_u32 s47, s47, 1
s_waitcnt vmcnt(6)
s_branch Lgdown_top1
Lgdown_nop0:
s_waitcnt lgkmcnt(6)
v_mfma_f32_32x32x16_bf16 v[40:55], a[8:11], v[16:19], v[40:55]
ds_read_b128 v[12:15], v5 offset:9216
v_cvt_pk_bf16_f32 v56, v72, v73
v_cvt_pk_bf16_f32 v57, v74, v75
v_cvt_pk_bf16_f32 v58, v76, v77
v_cvt_pk_bf16_f32 v59, v78, v79
s_waitcnt lgkmcnt(6)
v_mfma_f32_32x32x16_bf16 v[40:55], a[12:15], v[20:23], v[40:55]
ds_read_b128 v[16:19], v5 offset:10240
buffer_store_dwordx4 v[56:59], v0, s[4:7], s64 offen sc1
s_add_u32 s64, s64, 4096
v_cvt_pk_bf16_f32 v60, v80, v81
v_cvt_pk_bf16_f32 v61, v82, v83
s_waitcnt lgkmcnt(6)
v_mfma_f32_32x32x16_bf16 v[40:55], a[16:19], v[24:27], v[40:55]
ds_read_b128 v[20:23], v5 offset:11264
v_cvt_pk_bf16_f32 v62, v84, v85
v_cvt_pk_bf16_f32 v63, v86, v87
buffer_store_dwordx4 v[60:63], v0, s[4:7], s64 offen sc1
s_waitcnt lgkmcnt(6)
v_mfma_f32_32x32x16_bf16 v[40:55], a[20:23], v[28:31], v[40:55]
ds_read_b128 v[24:27], v5 offset:12288
s_waitcnt lgkmcnt(6)
v_mfma_f32_32x32x16_bf16 v[40:55], a[24:27], v[32:35], v[40:55]
ds_read_b128 v[28:31], v5 offset:13312
s_waitcnt lgkmcnt(6)
v_mfma_f32_32x32x16_bf16 v[40:55], a[28:31], v[36:39], v[40:55]
ds_read_b128 v[32:35], v5 offset:14336
s_waitcnt lgkmcnt(6)
v_mfma_f32_32x32x16_bf16 v[40:55], a[32:35], v[8:11], v[40:55]
ds_read_b128 v[36:39], v5 offset:15360
s_waitcnt lgkmcnt(6)
v_mfma_f32_32x32x16_bf16 v[40:55], a[36:39], v[12:15], v[40:55]
ds_read_b128 v[8:11], v5 offset:16384
s_waitcnt lgkmcnt(6)
v_mfma_f32_32x32x16_bf16 v[40:55], a[40:43], v[16:19], v[40:55]
ds_read_b128 v[12:15], v5 offset:17408
s_waitcnt lgkmcnt(6)
v_mfma_f32_32x32x16_bf16 v[40:55], a[44:47], v[20:23], v[40:55]
ds_read_b128 v[16:19], v5 offset:18432
s_waitcnt lgkmcnt(6)
v_mfma_f32_32x32x16_bf16 v[40:55], a[48:51], v[24:27], v[40:55]
ds_read_b128 v[20:23], v5 offset:19456
s_waitcnt lgkmcnt(6)
v_mfma_f32_32x32x16_bf16 v[40:55], a[52:55], v[28:31], v[40:55]
ds_read_b128 v[24:27], v5 offset:20480
s_waitcnt lgkmcnt(6)
v_mfma_f32_32x32x16_bf16 v[40:55], a[56:59], v[32:35], v[40:55]
ds_read_b128 v[28:31], v5 offset:21504
s_waitcnt lgkmcnt(6)
v_mfma_f32_32x32x16_bf16 v[40:55], a[60:63], v[36:39], v[40:55]
ds_read_b128 v[32:35], v5 offset:22528
s_waitcnt lgkmcnt(6)
v_mfma_f32_32x32x16_bf16 v[40:55], a[64:67], v[8:11], v[40:55]
ds_read_b128 v[36:39], v5 offset:23552
s_waitcnt lgkmcnt(6)
v_mfma_f32_32x32x16_bf16 v[40:55], a[68:71], v[12:15], v[40:55]
ds_read_b128 v[8:11], v5 offset:24576
s_waitcnt lgkmcnt(6)
v_mfma_f32_32x32x16_bf16 v[40:55], a[72:75], v[16:19], v[40:55]
ds_read_b128 v[12:15], v5 offset:25600
s_waitcnt lgkmcnt(6)
v_mfma_f32_32x32x16_bf16 v[40:55], a[76:79], v[20:23], v[40:55]
ds_read_b128 v[16:19], v5 offset:26624
s_waitcnt lgkmcnt(6)
v_mfma_f32_32x32x16_bf16 v[40:55], a[80:83], v[24:27], v[40:55]
ds_read_b128 v[20:23], v5 offset:27648
s_waitcnt lgkmcnt(6)
v_mfma_f32_32x32x16_bf16 v[40:55], a[84:87], v[28:31], v[40:55]
ds_read_b128 v[24:27], v5 offset:28672
s_cmp_lg_u32 s42, 0
s_cbranch_scc1 Lgdown_w_224
s_waitcnt vmcnt(2)
v_cmp_gt_i32 vcc, v69, v2
s_nop 1
v_mov_b32 v70, vcc_hi
v_mov_b32 v2, vcc_lo
ds_write2_b32 v71, v70, v2 offset0:4 offset1:1
Lgdown_w_224:
s_waitcnt lgkmcnt(6)
v_mfma_f32_32x32x16_bf16 v[40:55], a[88:91], v[32:35], v[40:55]
ds_read_b128 v[28:31], v5 offset:29696
s_waitcnt lgkmcnt(6)
v_mfma_f32_32x32x16_bf16 v[40:55], a[92:95], v[36:39], v[40:55]
ds_read_b128 v[32:35], v5 offset:30720
s_waitcnt vmcnt(2) lgkmcnt(2)
s_barrier
ds_read_b32 v70, v71 offset:4
s_waitcnt lgkmcnt(6)
v_mfma_f32_32x32x16_bf16 v[40:55], a[96:99], v[8:11], v[40:55]
ds_read_b128 v[36:39], v5 offset:31744
s_waitcnt lgkmcnt(6)
v_mfma_f32_32x32x16_bf16 v[40:55], a[100:103], v[12:15], v[40:55]
ds_read_b128 v[8:11], v5 offset:32768
s_waitcnt lgkmcnt(2)
v_readfirstlane_b32 s50, v70
s_nop 0
s_cmp_eq_u32 s50, 0
s_cbranch_scc1 Lgdown_late0
s_waitcnt lgkmcnt(6)
v_mfma_f32_32x32x16_bf16 v[40:55], a[104:107], v[16:19], v[40:55]
ds_read_b128 v[12:15], v5 offset:33792
s_cmp_lg_u32 s42, 0
s_cbranch_scc1 Lgdown_w_225
buffer_load_dword v2, v68, s[4:7], s60 offen sc1
Lgdown_w_225:
s_waitcnt lgkmcnt(6)
v_mfma_f32_32x32x16_bf16 v[40:55], a[108:111], v[20:23], v[40:55]
ds_read_b128 v[16:19], v5 offset:34816
s_waitcnt lgkmcnt(6)
v_mfma_f32_32x32x16_bf16 v[40:55], a[112:115], v[24:27], v[40:55]
ds_read_b128 v[20:23], v5 offset:35840
s_waitcnt lgkmcnt(6)
v_mfma_f32_32x32x16_bf16 v[40:55], a[116:119], v[28:31], v[40:55]
ds_read_b128 v[24:27], v5 offset:36864
s_waitcnt lgkmcnt(6)
v_mfma_f32_32x32x16_bf16 v[40:55], a[120:123], v[32:35], v[40:55]
ds_read_b128 v[28:31], v5 offset:37888
s_waitcnt lgkmcnt(6)
v_mfma_f32_32x32x16_bf16 v[40:55], a[124:127], v[36:39], v[40:55]
ds_read_b128 v[32:35], v5 offset:38912
s_waitcnt lgkmcnt(6)
v_mfma_f32_32x32x16_bf16 v[40:55], a[128:131], v[8:11], v[40:55]
ds_read_b128 v[36:39], v5 offset:39936
s_waitcnt lgkmcnt(6)
v_mfma_f32_32x32x16_bf16 v[40:55], a[132:135], v[12:15], v[40:55]
ds_read_b128 v[8:11], v5 offset:40960
s_cmp_eq_u32 s42, 0
s_cbranch_scc1 Lgdown_z_226
s_waitcnt vmcnt(0)
Lgdown_z_226:
s_waitcnt vmcnt(1)
s_barrier
s_waitcnt lgkmcnt(6)
v_mfma_f32_32x32x16_bf16 v[40:55], a[136:139], v[16:19], v[40:55]
ds_read_b128 v[12:15], v5 offset:41984
s_cmp_lg_u32 s42, 0
s_cbranch_scc1 Lgdown_w_227
s_mov_b64 exec, 1
buffer_store_dword v4, v3, s[4:7], s59 offen sc1
s_mov_b64 exec, -1
Lgdown_w_227:
s_waitcnt lgkmcnt(6)
v_mfma_f32_32x32x16_bf16 v[40:55], a[140:143], v[20:23], v[40:55]
ds_read_b128 v[16:19], v5 offset:43008
s_waitcnt lgkmcnt(6)
v_mfma_f32_32x32x16_bf16 v[40:55], a[144:147], v[24:27], v[40:55]
ds_read_b128 v[20:23], v5 offset:44032
s_waitcnt lgkmcnt(6)
v_mfma_f32_32x32x16_bf16 v[40:55], a[148:151], v[28:31], v[40:55]
ds_read_b128 v[24:27], v5 offset:45056
s_waitcnt lgkmcnt(6)
v_mfma_f32_32x32x16_bf16 v[40:55], a[152:155], v[32:35], v[40:55]
ds_read_b128 v[28:31], v5 offset:46080
s_waitcnt lgkmcnt(6)
v_mfma_f32_32x32x16_bf16 v[40:55], a[156:159], v[36:39], v[40:55]
ds_read_b128 v[32:35], v5 offset:47104
s_waitcnt lgkmcnt(6)
v_mfma_f32_32x32x16_bf16 v[40:55], a[160:163], v[8:11], v[40:55]
ds_read_b128 v[36:39], v5 offset:48128
s_waitcnt lgkmcnt(6)
v_mfma_f32_32x32x16_bf16 v[40:55], a[164:167], v[12:15], v[40:55]
ds_read_b128 v[8:11], v5 offset:49152
s_waitcnt lgkmcnt(6)
v_mfma_f32_32x32x16_bf16 v[40:55], a[168:171], v[16:19], v[40:55]
ds_read_b128 v[12:15], v5 offset:50176
s_waitcnt lgkmcnt(6)
v_mfma_f32_32x32x16_bf16 v[40:55], a[172:175], v[20:23], v[40:55]
ds_read_b128 v[16:19], v5 offset:51200
s_waitcnt lgkmcnt(6)
v_mfma_f32_32x32x16_bf16 v[40:55], a[176:179], v[24:27], v[40:55]
ds_read_b128 v[20:23], v5 offset:52224
s_waitcnt lgkmcnt(6)
v_mfma_f32_32x32x16_bf16 v[40:55], a[180:183], v[28:31], v[40:55]
ds_read_b128 v[24:27], v5 offset:53248
s_waitcnt lgkmcnt(6)
v_mfma_f32_32x32x16_bf16 v[40:55], a[184:187], v[32:35], v[40:55]
ds_read_b128 v[28:31], v5 offset:54272
s_waitcnt lgkmcnt(6)
v_mfma_f32_32x32x16_bf16 v[40:55], a[188:191], v[36:39], v[40:55]
ds_read_b128 v[32:35], v5 offset:55296
s_cmp_lg_u32 s42, 0
s_cbranch_scc1 Lgdown_w_228
s_waitcnt vmcnt(1)
v_cmp_gt_i32 vcc, v69, v2
s_nop 1
v_mov_b32 v70, vcc_hi
v_mov_b32 v2, vcc_lo
ds_write2_b32 v71, v70, v2 offset0:4 offset1:2
Lgdown_w_228:
s_waitcnt lgkmcnt(6)
v_mfma_f32_32x32x16_bf16 v[40:55], a[192:195], v[8:11], v[40:55]
ds_read_b128 v[36:39], v5 offset:56320
s_waitcnt lgkmcnt(6)
v_mfma_f32_32x32x16_bf16 v[40:55], a[196:199], v[12:15], v[40:55]
s_waitcnt lgkmcnt(0)
s_barrier
ds_read_b32 v70, v71 offset:8
s_waitcnt lgkmcnt(5)
v_mfma_f32_32x32x16_bf16 v[40:55], a[200:203], v[16:19], v[40:55]
s_waitcnt lgkmcnt(4)
v_mfma_f32_32x32x16_bf16 v[40:55], a[204:207], v[20:23], v[40:55]
s_waitcnt lgkmcnt(0)
v_readfirstlane_b32 s50, v70
s_nop 0
s_cmp_eq_u32 s50, 0
s_cbranch_scc1 Lgdown_late20
s_waitcnt lgkmcnt(3)
v_mfma_f32_32x32x16_bf16 v[40:55], a[208:211], v[24:27], v[40:55]
s_waitcnt lgkmcnt(2)
v_mfma_f32_32x32x16_bf16 v[40:55], a[212:215], v[28:31], v[40:55]
s_waitcnt lgkmcnt(1)
v_mfma_f32_32x32x16_bf16 v[40:55], a[216:219], v[32:35], v[40:55]
s_waitcnt lgkmcnt(0)
v_mfma_f32_32x32x16_bf16 v[40:55], a[220:223], v[36:39], v[40:55]
s_mov_b32 s64, s57
s_add_u32 s50, s46, 1
s_add_u32 s57, s57, s58
v_mov_b32 v4, s50
s_nop 7
v_cvt_pk_bf16_f32 v56, v40, v41
v_cvt_pk_bf16_f32 v57, v42, v43
v_cvt_pk_bf16_f32 v58, v44, v45
v_cvt_pk_bf16_f32 v59, v46, v47
buffer_store_dwordx4 v[56:59], v0, s[4:7], s64 offen sc1
s_add_u32 s64, s64, 4096
v_cvt_pk_bf16_f32 v60, v48, v49
v_cvt_pk_bf16_f32 v61, v50, v51
v_cvt_pk_bf16_f32 v62, v52, v53
v_cvt_pk_bf16_f32 v63, v54, v55
buffer_store_dwordx4 v[60:63], v0, s[4:7], s64 offen sc1
s_cmp_lg_u32 s42, 0
s_cbranch_scc1 Lgdown_w_229
buffer_load_dword v2, v68, s[4:7], s60 offen sc1
s_waitcnt vmcnt(0)
v_cmp_gt_i32 vcc, v69, v2
s_nop 1
v_mov_b32 v70, vcc_hi
v_mov_b32 v2, vcc_lo
ds_write2_b32 v71, v70, v2 offset1:1
s_waitcnt lgkmcnt(0)
Lgdown_w_229:
s_add_u32 s46, s46, s48
s_sub_u32 s47, s47, 1
s_waitcnt vmcnt(0)
s_barrier
ds_read_b32 v70, v71 offset:4
s_cmp_lg_u32 s42, 0
s_cbranch_scc1 Lgdown_w_230
s_mov_b64 exec, 1
buffer_store_dword v4, v3, s[4:7], s59 offen sc1
s_mov_b64 exec, -1
Lgdown_w_230:
s_waitcnt lgkmcnt(0)
v_readfirstlane_b32 s50, v70
s_nop 0
s_cmp_eq_u32 s50, 0
s_cbranch_scc1 Lgdown_fetch
s_branch Lgdown_cold
Lgdown_late0:
s_waitcnt lgkmcnt(6)
v_mfma_f32_32x32x16_bf16 v[40:55], a[104:107], v[16:19], v[40:55]
ds_read_b128 v[12:15], v5 offset:33792
s_add_u32 m0, s54, 0
s_add_u32 s55, s53, 0
buffer_load_dwordx4 v0, s[4:7], s55 offen sc1 lds
s_waitcnt lgkmcnt(6)
v_mfma_f32_32x32x16_bf16 v[40:55], a[108:111], v[20:23], v[40:55]
ds_read_b128 v[16:19], v5 offset:34816
s_add_u32 m0, s54, 4096
s_add_u32 s55, s53, 4096
buffer_load_dwordx4 v0, s[4:7], s55 offen sc1 lds
s_waitcnt lgkmcnt(6)
v_mfma_f32_32x32x16_bf16 v[40:55], a[112:115], v[24:27], v[40:55]
ds_read_b128 v[20:23], v5 offset:35840
s_add_u32 m0, s54, 8192
s_add_u32 s55, s53, 8192
buffer_load_dwordx4 v0, s[4:7], s55 offen sc1 lds
s_waitcnt lgkmcnt(6)
v_mfma_f32_32x32x16_bf16 v[40:55], a[116:119], v[28:31], v[40:55]
ds_read_b128 v[24:27], v5 offset:36864
s_add_u32 m0, s54, 12288
s_add_u32 s55, s53, 12288
buffer_load_dwordx4 v0, s[4:7], s55 offen sc1 lds
s_waitcnt lgkmcnt(6)
v_mfma_f32_32x32x16_bf16 v[40:55], a[120:123], v[32:35], v[40:55]
ds_read_b128 v[28:31], v5 offset:37888
s_add_u32 m0, s54, 16384
s_add_u32 s55, s53, 16384
buffer_load_dwordx4 v0, s[4:7], s55 offen sc1 lds
s_waitcnt lgkmcnt(6)
v_mfma_f32_32x32x16_bf16 v[40:55], a[124:127], v[36:39], v[40:55]
ds_read_b128 v[32:35], v5 offset:38912
s_add_u32 m0, s54, 20480
s_add_u32 s55, s53, 20480
buffer_load_dwordx4 v0, s[4:7], s55 offen sc1 lds
s_waitcnt lgkmcnt(6)
v_mfma_f32_32x32x16_bf16 v[40:55], a[128:131], v[8:11], v[40:55]
ds_read_b128 v[36:39], v5 offset:39936
s_add_u32 m0, s54, 24576
s_add_u32 s55, s53, 24576
buffer_load_dwordx4 v0, s[4:7], s55 offen sc1 lds
s_waitcnt lgkmcnt(6)
v_mfma_f32_32x32x16_bf16 v[40:55], a[132:135], v[12:15], v[40:55]
ds_read_b128 v[8:11], v5 offset:40960
s_add_u32 m0, s54, 28672
s_add_u32 s55, s53, 28672
buffer_load_dwordx4 v0, s[4:7], s55 offen sc1 lds
s_waitcnt vmcnt(8)
s_barrier
s_waitcnt lgkmcnt(6)
v_mfma_f32_32x32x16_bf16 v[40:55], a[136:139], v[16:19], v[40:55]
ds_read_b128 v[12:15], v5 offset:41984
s_cmp_lg_u32 s42, 0
s_cbranch_scc1 Lgdown_w_231
s_mov_b64 exec, 1
buffer_store_dword v4, v3, s[4:7], s59 offen sc1
s_mov_b64 exec, -1
Lgdown_w_231:
s_waitcnt lgkmcnt(6)
v_mfma_f32_32x32x16_bf16 v[40:55], a[140:143], v[20:23], v[40:55]
ds_read_b128 v[16:19], v5 offset:43008
s_waitcnt lgkmcnt(6)
v_mfma_f32_32x32x16_bf16 v[40:55], a[144:147], v[24:27], v[40:55]
ds_read_b128 v[20:23], v5 offset:44032
s_add_u32 m0, s54, 32768
s_add_u32 s55, s53, 32768
buffer_load_dwordx4 v0, s[4:7], s55 offen sc1 lds
s_waitcnt lgkmcnt(6)
v_mfma_f32_32x32x16_bf16 v[40:55], a[148:151], v[28:31], v[40:55]
ds_read_b128 v[24:27], v5 offset:45056
s_waitcnt lgkmcnt(6)
v_mfma_f32_32x32x16_bf16 v[40:55], a[152:155], v[32:35], v[40:55]
ds_read_b128 v[28:31], v5 offset:46080
s_add_u32 m0, s54, 36864
s_add_u32 s55, s53, 36864
buffer_load_dwordx4 v0, s[4:7], s55 offen sc1 lds
s_waitcnt lgkmcnt(6)
v_mfma_f32_32x32x16_bf16 v[40:55], a[156:159], v[36:39], v[40:55]
ds_read_b128 v[32:35], v5 offset:47104
s_waitcnt lgkmcnt(6)
v_mfma_f32_32x32x16_bf16 v[40:55], a[160:163], v[8:11], v[40:55]
ds_read_b128 v[36:39], v5 offset:48128
s_add_u32 m0, s54, 40960
s_add_u32 s55, s53, 40960
buffer_load_dwordx4 v0, s[4:7], s55 offen sc1 lds
s_waitcnt lgkmcnt(6)
v_mfma_f32_32x32x16_bf16 v[40:55], a[164:167], v[12:15], v[40:55]
ds_read_b128 v[8:11], v5 offset:49152
s_waitcnt lgkmcnt(6)
v_mfma_f32_32x32x16_bf16 v[40:55], a[168:171], v[16:19], v[40:55]
ds_read_b128 v[12:15], v5 offset:50176
s_add_u32 m0, s54, 45056
s_add_u32 s55, s53, 45056
buffer_load_dwordx4 v0, s[4:7], s55 offen sc1 lds
s_waitcnt lgkmcnt(6)
v_mfma_f32_32x32x16_bf16 v[40:55], a[172:175], v[20:23], v[40:55]
ds_read_b128 v[16:19], v5 offset:51200
s_waitcnt lgkmcnt(6)
v_mfma_f32_32x32x16_bf16 v[40:55], a[176:179], v[24:27], v[40:55]
ds_read_b128 v[20:23], v5 offset:52224
s_add_u32 m0, s54, 49152
s_add_u32 s55, s53, 49152
buffer_load_dwordx4 v0, s[4:7], s55 offen sc1 lds
s_waitcnt lgkmcnt(6)
v_mfma_f32_32x32x16_bf16 v[40:55], a[180:183], v[28:31], v[40:55]
ds_read_b128 v[24:27], v5 offset:53248
s_waitcnt lgkmcnt(6)
v_mfma_f32_32x32x16_bf16 v[40:55], a[184:187], v[32:35], v[40:55]
ds_read_b128 v[28:31], v5 offset:54272
s_add_u32 m0, s54, 53248
s_add_u32 s55, s53, 53248
buffer_load_dwordx4 v0, s[4:7], s55 offen sc1 lds
s_waitcnt lgkmcnt(6)
v_mfma_f32_32x32x16_bf16 v[40:55], a[188:191], v[36:39], v[40:55]
ds_read_b128 v[32:35], v5 offset:55296
s_waitcnt lgkmcnt(6)
v_mfma_f32_32x32x16_bf16 v[40:55], a[192:195], v[8:11], v[40:55]
ds_read_b128 v[36:39], v5 offset:56320
s_waitcnt lgkmcnt(6)
v_mfma_f32_32x32x16_bf16 v[40:55], a[196:199], v[12:15], v[40:55]
s_waitcnt lgkmcnt(5)
v_mfma_f32_32x32x16_bf16 v[40:55], a[200:203], v[16:19], v[40:55]
s_waitcnt lgkmcnt(4)
v_mfma_f32_32x32x16_bf16 v[40:55], a[204:207], v[20:23], v[40:55]
s_waitcnt lgkmcnt(3)
v_mfma_f32_32x32x16_bf16 v[40:55], a[208:211], v[24:27], v[40:55]
s_waitcnt lgkmcnt(2)
v_mfma_f32_32x32x16_bf16 v[40:55], a[212:215], v[28:31], v[40:55]
s_waitcnt lgkmcnt(1)
v_mfma_f32_32x32x16_bf16 v[40:55], a[216:219], v[32:35], v[40:55]
s_waitcnt lgkmcnt(0)
v_mfma_f32_32x32x16_bf16 v[40:55], a[220:223], v[36:39], v[40:55]
s_mov_b32 s64, s57
s_add_u32 s50, s46, 1
s_add_u32 s57, s57, s58
v_mov_b32 v4, s50
s_add_u32 s46, s46, s48
s_sub_u32 s47, s47, 1
s_waitcnt vmcnt(6)
s_branch Lgdown_top1
Lgdown_late20:
s_waitcnt lgkmcnt(3)
v_mfma_f32_32x32x16_bf16 v[40:55], a[208:211], v[24:27], v[40:55]
s_waitcnt lgkmcnt(2)
v_mfma_f32_32x32x16_bf16 v[40:55], a[212:215], v[28:31], v[40:55]
s_waitcnt lgkmcnt(1)
v_mfma_f32_32x32x16_bf16 v[40:55], a[216:219], v[32:35], v[40:55]
s_waitcnt lgkmcnt(0)
v_mfma_f32_32x32x16_bf16 v[40:55], a[220:223], v[36:39], v[40:55]
s_mov_b32 s64, s57
s_add_u32 s50, s46, 1
s_add_u32 s57, s57, s58
v_mov_b32 v4, s50
s_nop 7
v_cvt_pk_bf16_f32 v56, v40, v41
v_cvt_pk_bf16_f32 v57, v42, v43
v_cvt_pk_bf16_f32 v58, v44, v45
v_cvt_pk_bf16_f32 v59, v46, v47
buffer_store_dwordx4 v[56:59], v0, s[4:7], s64 offen sc1
s_add_u32 s64, s64, 4096
v_cvt_pk_bf16_f32 v60, v48, v49
v_cvt_pk_bf16_f32 v61, v50, v51
v_cvt_pk_bf16_f32 v62, v52, v53
v_cvt_pk_bf16_f32 v63, v54, v55
buffer_store_dwordx4 v[60:63], v0, s[4:7], s64 offen sc1
s_add_u32 s46, s46, s48
s_sub_u32 s47, s47, 1
s_add_u32 m0, s54, 0
s_add_u32 s55, s53, 0
buffer_load_dwordx4 v0, s[4:7], s55 offen sc1 lds
s_add_u32 m0, s54, 4096
s_add_u32 s55, s53, 4096
buffer_load_dwordx4 v0, s[4:7], s55 offen sc1 lds
s_add_u32 m0, s54, 8192
s_add_u32 s55, s53, 8192
buffer_load_dwordx4 v0, s[4:7], s55 offen sc1 lds
s_add_u32 m0, s54, 12288
s_add_u32 s55, s53, 12288
buffer_load_dwordx4 v0, s[4:7], s55 offen sc1 lds
s_add_u32 m0, s54, 16384
s_add_u32 s55, s53, 16384
buffer_load_dwordx4 v0, s[4:7], s55 offen sc1 lds
s_add_u32 m0, s54, 20480
s_add_u32 s55, s53, 20480
buffer_load_dwordx4 v0, s[4:7], s55 offen sc1 lds
s_add_u32 m0, s54, 24576
s_add_u32 s55, s53, 24576
buffer_load_dwordx4 v0, s[4:7], s55 offen sc1 lds
s_add_u32 m0, s54, 28672
s_add_u32 s55, s53, 28672
buffer_load_dwordx4 v0, s[4:7], s55 offen sc1 lds
s_add_u32 m0, s54, 32768
s_add_u32 s55, s53, 32768
buffer_load_dwordx4 v0, s[4:7], s55 offen sc1 lds
s_add_u32 m0, s54, 36864
s_add_u32 s55, s53, 36864
buffer_load_dwordx4 v0, s[4:7], s55 offen sc1 lds
s_add_u32 m0, s54, 40960
s_add_u32 s55, s53, 40960
buffer_load_dwordx4 v0, s[4:7], s55 offen sc1 lds
s_add_u32 m0, s54, 45056
s_add_u32 s55, s53, 45056
buffer_load_dwordx4 v0, s[4:7], s55 offen sc1 lds
s_add_u32 m0, s54, 49152
s_add_u32 s55, s53, 49152
buffer_load_dwordx4 v0, s[4:7], s55 offen sc1 lds
s_add_u32 m0, s54, 53248
s_add_u32 s55, s53, 53248
buffer_load_dwordx4 v0, s[4:7], s55 offen sc1 lds
s_lshl_b32 s64, s40, 14
s_lshl_b32 s50, s42, 11
s_add_u32 s64, s64, s50
s_add_u32 s64, s64, 155189248
s_waitcnt vmcnt(14)
s_barrier
s_cmp_lg_u32 s42, 0
s_cbranch_scc1 Lgdown_w_232
s_mov_b64 exec, 1
buffer_store_dword v4, v3, s[4:7], s59 offen sc1
s_mov_b64 exec, -1
Lgdown_w_232:
s_waitcnt vmcnt(6)
s_branch Lgdown_top1
Lgdown_last0:
s_waitcnt lgkmcnt(6)
v_mfma_f32_32x32x16_bf16 v[40:55], a[8:11], v[16:19], v[40:55]
ds_read_b128 v[12:15], v5 offset:9216
v_cvt_pk_bf16_f32 v56, v72, v73
v_cvt_pk_bf16_f32 v57, v74, v75
v_cvt_pk_bf16_f32 v58, v76, v77
v_cvt_pk_bf16_f32 v59, v78, v79
s_waitcnt lgkmcnt(6)
v_mfma_f32_32x32x16_bf16 v[40:55], a[12:15], v[20:23], v[40:55]
ds_read_b128 v[16:19], v5 offset:10240
buffer_store_dwordx4 v[56:59], v0, s[4:7], s64 offen sc1
s_add_u32 s64, s64, 4096
v_cvt_pk_bf16_f32 v60, v80, v81
v_cvt_pk_bf16_f32 v61, v82, v83
s_waitcnt lgkmcnt(6)
v_mfma_f32_32x32x16_bf16 v[40:55], a[16:19], v[24:27], v[40:55]
ds_read_b128 v[20:23], v5 offset:11264
v_cvt_pk_bf16_f32 v62, v84, v85
v_cvt_pk_bf16_f32 v63, v86, v87
buffer_store_dwordx4 v[60:63], v0, s[4:7], s64 offen sc1
s_waitcnt lgkmcnt(6)
v_mfma_f32_32x32x16_bf16 v[40:55], a[20:23], v[28:31], v[40:55]
ds_read_b128 v[24:27], v5 offset:12288
s_waitcnt lgkmcnt(6)
v_mfma_f32_32x32x16_bf16 v[40:55], a[24:27], v[32:35], v[40:55]
ds_read_b128 v[28:31], v5 offset:13312
s_waitcnt lgkmcnt(6)
v_mfma_f32_32x32x16_bf16 v[40:55], a[28:31], v[36:39], v[40:55]
ds_read_b128 v[32:35], v5 offset:14336
s_waitcnt lgkmcnt(6)
v_mfma_f32_32x32x16_bf16 v[40:55], a[32:35], v[8:11], v[40:55]
ds_read_b128 v[36:39], v5 offset:15360
s_waitcnt lgkmcnt(6)
v_mfma_f32_32x32x16_bf16 v[40:55], a[36:39], v[12:15], v[40:55]
ds_read_b128 v[8:11], v5 offset:16384
s_waitcnt lgkmcnt(6)
v_mfma_f32_32x32x16_bf16 v[40:55], a[40:43], v[16:19], v[40:55]
ds_read_b128 v[12:15], v5 offset:17408
s_waitcnt lgkmcnt(6)
v_mfma_f32_32x32x16_bf16 v[40:55], a[44:47], v[20:23], v[40:55]
ds_read_b128 v[16:19], v5 offset:18432
s_waitcnt lgkmcnt(6)
v_mfma_f32_32x32x16_bf16 v[40:55], a[48:51], v[24:27], v[40:55]
ds_read_b128 v[20:23], v5 offset:19456
s_waitcnt lgkmcnt(6)
v_mfma_f32_32x32x16_bf16 v[40:55], a[52:55], v[28:31], v[40:55]
ds_read_b128 v[24:27], v5 offset:20480
s_waitcnt lgkmcnt(6)
v_mfma_f32_32x32x16_bf16 v[40:55], a[56:59], v[32:35], v[40:55]
ds_read_b128 v[28:31], v5 offset:21504
s_waitcnt lgkmcnt(6)
v_mfma_f32_32x32x16_bf16 v[40:55], a[60:63], v[36:39], v[40:55]
ds_read_b128 v[32:35], v5 offset:22528
s_waitcnt lgkmcnt(6)
v_mfma_f32_32x32x16_bf16 v[40:55], a[64:67], v[8:11], v[40:55]
ds_read_b128 v[36:39], v5 offset:23552
s_waitcnt lgkmcnt(6)
v_mfma_f32_32x32x16_bf16 v[40:55], a[68:71], v[12:15], v[40:55]
ds_read_b128 v[8:11], v5 offset:24576
s_waitcnt lgkmcnt(6)
v_mfma_f32_32x32x16_bf16 v[40:55], a[72:75], v[16:19], v[40:55]
ds_read_b128 v[12:15], v5 offset:25600
s_waitcnt lgkmcnt(6)
v_mfma_f32_32x32x16_bf16 v[40:55], a[76:79], v[20:23], v[40:55]
ds_read_b128 v[16:19], v5 offset:26624
s_waitcnt lgkmcnt(6)
v_mfma_f32_32x32x16_bf16 v[40:55], a[80:83], v[24:27], v[40:55]
ds_read_b128 v[20:23], v5 offset:27648
s_waitcnt lgkmcnt(6)
v_mfma_f32_32x32x16_bf16 v[40:55], a[84:87], v[28:31], v[40:55]
ds_read_b128 v[24:27], v5 offset:28672
s_waitcnt lgkmcnt(6)
v_mfma_f32_32x32x16_bf16 v[40:55], a[88:91], v[32:35], v[40:55]
ds_read_b128 v[28:31], v5 offset:29696
s_waitcnt lgkmcnt(6)
v_mfma_f32_32x32x16_bf16 v[40:55], a[92:95], v[36:39], v[40:55]
ds_read_b128 v[32:35], v5 offset:30720
s_waitcnt vmcnt(2) lgkmcnt(2)
s_barrier
s_waitcnt lgkmcnt(6)
v_mfma_f32_32x32x16_bf16 v[40:55], a[96:99], v[8:11], v[40:55]
ds_read_b128 v[36:39], v5 offset:31744
s_waitcnt lgkmcnt(6)
v_mfma_f32_32x32x16_bf16 v[40:55], a[100:103], v[12:15], v[40:55]
ds_read_b128 v[8:11], v5 offset:32768
s_waitcnt lgkmcnt(6)
v_mfma_f32_32x32x16_bf16 v[40:55], a[104:107], v[16:19], v[40:55]
ds_read_b128 v[12:15], v5 offset:33792
s_waitcnt lgkmcnt(6)
v_mfma_f32_32x32x16_bf16 v[40:55], a[108:111], v[20:23], v[40:55]
ds_read_b128 v[16:19], v5 offset:34816
s_waitcnt lgkmcnt(6)
v_mfma_f32_32x32x16_bf16 v[40:55], a[112:115], v[24:27], v[40:55]
ds_read_b128 v[20:23], v5 offset:35840
s_waitcnt lgkmcnt(6)
v_mfma_f32_32x32x16_bf16 v[40:55], a[116:119], v[28:31], v[40:55]
ds_read_b128 v[24:27], v5 offset:36864
s_waitcnt lgkmcnt(6)
v_mfma_f32_32x32x16_bf16 v[40:55], a[120:123], v[32:35], v[40:55]
ds_read_b128 v[28:31], v5 offset:37888
s_waitcnt lgkmcnt(6)
v_mfma_f32_32x32x16_bf16 v[40:55], a[124:127], v[36:39], v[40:55]
ds_read_b128 v[32:35], v5 offset:38912
s_waitcnt lgkmcnt(6)
v_mfma_f32_32x32x16_bf16 v[40:55], a[128:131], v[8:11], v[40:55]
ds_read_b128 v[36:39], v5 offset:39936
s_waitcnt lgkmcnt(6)
v_mfma_f32_32x32x16_bf16 v[40:55], a[132:135], v[12:15], v[40:55]
ds_read_b128 v[8:11], v5 offset:40960
s_waitcnt vmcnt(0)
s_barrier
s_waitcnt lgkmcnt(6)
v_mfma_f32_32x32x16_bf16 v[40:55], a[136:139], v[16:19], v[40:55]
ds_read_b128 v[12:15], v5 offset:41984
s_cmp_lg_u32 s42, 0
s_cbranch_scc1 Lgdown_w_233
s_mov_b64 exec, 1
buffer_store_dword v4, v3, s[4:7], s59 offen sc1
s_mov_b64 exec, -1
Lgdown_w_233:
s_waitcnt lgkmcnt(6)
v_mfma_f32_32x32x16_bf16 v[40:55], a[140:143], v[20:23], v[40:55]
ds_read_b128 v[16:19], v5 offset:43008
s_waitcnt lgkmcnt(6)
v_mfma_f32_32x32x16_bf16 v[40:55], a[144:147], v[24:27], v[40:55]
ds_read_b128 v[20:23], v5 offset:44032
s_waitcnt lgkmcnt(6)
v_mfma_f32_32x32x16_bf16 v[40:55], a[148:151], v[28:31], v[40:55]
ds_read_b128 v[24:27], v5 offset:45056
s_waitcnt lgkmcnt(6)
v_mfma_f32_32x32x16_bf16 v[40:55], a[152:155], v[32:35], v[40:55]
ds_read_b128 v[28:31], v5 offset:46080
s_waitcnt lgkmcnt(6)
v_mfma_f32_32x32x16_bf16 v[40:55], a[156:159], v[36:39], v[40:55]
ds_read_b128 v[32:35], v5 offset:47104
s_waitcnt lgkmcnt(6)
v_mfma_f32_32x32x16_bf16 v[40:55], a[160:163], v[8:11], v[40:55]
ds_read_b128 v[36:39], v5 offset:48128
s_waitcnt lgkmcnt(6)
v_mfma_f32_32x32x16_bf16 v[40:55], a[164:167], v[12:15], v[40:55]
ds_read_b128 v[8:11], v5 offset:49152
s_waitcnt lgkmcnt(6)
v_mfma_f32_32x32x16_bf16 v[40:55], a[168:171], v[16:19], v[40:55]
ds_read_b128 v[12:15], v5 offset:50176
s_waitcnt lgkmcnt(6)
v_mfma_f32_32x32x16_bf16 v[40:55], a[172:175], v[20:23], v[40:55]
ds_read_b128 v[16:19], v5 offset:51200
s_waitcnt lgkmcnt(6)
v_mfma_f32_32x32x16_bf16 v[40:55], a[176:179], v[24:27], v[40:55]
ds_read_b128 v[20:23], v5 offset:52224
s_waitcnt lgkmcnt(6)
v_mfma_f32_32x32x16_bf16 v[40:55], a[180:183], v[28:31], v[40:55]
ds_read_b128 v[24:27], v5 offset:53248
s_waitcnt lgkmcnt(6)
v_mfma_f32_32x32x16_bf16 v[40:55], a[184:187], v[32:35], v[40:55]
ds_read_b128 v[28:31], v5 offset:54272
s_waitcnt lgkmcnt(6)
v_mfma_f32_32x32x16_bf16 v[40:55], a[188:191], v[36:39], v[40:55]
ds_read_b128 v[32:35], v5 offset:55296
s_waitcnt lgkmcnt(6)
v_mfma_f32_32x32x16_bf16 v[40:55], a[192:195], v[8:11], v[40:55]
ds_read_b128 v[36:39], v5 offset:56320
s_waitcnt lgkmcnt(6)
v_mfma_f32_32x32x16_bf16 v[40:55], a[196:199], v[12:15], v[40:55]
s_waitcnt lgkmcnt(5)
v_mfma_f32_32x32x16_bf16 v[40:55], a[200:203], v[16:19], v[40:55]
s_waitcnt lgkmcnt(4)
v_mfma_f32_32x32x16_bf16 v[40:55], a[204:207], v[20:23], v[40:55]
s_waitcnt lgkmcnt(3)
v_mfma_f32_32x32x16_bf16 v[40:55], a[208:211], v[24:27], v[40:55]
s_waitcnt lgkmcnt(2)
v_mfma_f32_32x32x16_bf16 v[40:55], a[212:215], v[28:31], v[40:55]
s_waitcnt lgkmcnt(1)
v_mfma_f32_32x32x16_bf16 v[40:55], a[216:219], v[32:35], v[40:55]
s_waitcnt lgkmcnt(0)
v_mfma_f32_32x32x16_bf16 v[40:55], a[220:223], v[36:39], v[40:55]
s_mov_b32 s64, s57
s_add_u32 s50, s46, 1
s_add_u32 s57, s57, s58
v_mov_b32 v4, s50
s_nop 7
v_cvt_pk_bf16_f32 v56, v40, v41
v_cvt_pk_bf16_f32 v57, v42, v43
v_cvt_pk_bf16_f32 v58, v44, v45
v_cvt_pk_bf16_f32 v59, v46, v47
buffer_store_dwordx4 v[56:59], v0, s[4:7], s64 offen sc1
s_add_u32 s64, s64, 4096
v_cvt_pk_bf16_f32 v60, v48, v49
v_cvt_pk_bf16_f32 v61, v50, v51
v_cvt_pk_bf16_f32 v62, v52, v53
v_cvt_pk_bf16_f32 v63, v54, v55
buffer_store_dwordx4 v[60:63], v0, s[4:7], s64 offen sc1
s_waitcnt vmcnt(0)
s_barrier
s_cmp_lg_u32 s42, 0
s_cbranch_scc1 Lgdown_w_234
s_mov_b64 exec, 1
buffer_store_dword v4, v3, s[4:7], s59 offen sc1
s_mov_b64 exec, -1
Lgdown_w_234:
s_branch Lend
Lgdown_top1:
s_cmp_lg_u32 s42, 0
s_cbranch_scc1 Lgdown_w_235
s_mul_i32 s50, s62, s61
s_add_u32 s62, s62, 1
s_cmp_eq_u32 s62, s78
s_cselect_b32 s62, 0, s62
s_mul_i32 s51, s62, s61
s_sub_u32 s51, s51, s50
s_add_u32 s63, s46, 2
v_mad_i32_i24 v68, v88, s51, v1
v_add_u32 v68, s50, v68
v_add_u32 v69, s63, v88
buffer_load_dword v2, v68, s[4:7], s60 offen sc1
Lgdown_w_235:
s_xor_b32 s65, s65, 0x10000
s_add_u32 s49, s49, s56
v_add_u32 v5, s65, v0
s_barrier
ds_read_b128 v[8:11], v5 offset:0
ds_read_b128 v[12:15], v5 offset:1024
ds_read_b32 v70, v71 offset:16
ds_read_b128 v[16:19], v5 offset:2048
s_lshl_b32 s53, s42, 10
s_xor_b32 s54, s65, 0x10000
s_add_u32 s54, s54, s53
s_add_u32 s53, s53, s49
s_waitcnt lgkmcnt(3)
v_mfma_f32_32x32x16_bf16 v[72:87], a[0:3], v[8:11], 0
ds_read_b128 v[20:23], v5 offset:3072
ds_read_b128 v[24:27], v5 offset:4096
ds_read_b128 v[28:31], v5 offset:5120
ds_read_b128 v[32:35], v5 offset:6144
s_waitcnt lgkmcnt(5)
v_mfma_f32_32x32x16_bf16 v[72:87], a[4:7], v[12:15], v[72:87]
ds_read_b128 v[36:39], v5 offset:7168
ds_read_b128 v[8:11], v5 offset:8192
v_readfirstlane_b32 s50, v70
s_cmp_le_u32 s47, 1
s_cbranch_scc1 Lgdown_last1
s_cmp_lg_u32 s50, 0
s_cbranch_scc1 Lgdown_nop1
s_waitcnt lgkmcnt(6)
v_mfma_f32_32x32x16_bf16 v[72:87], a[8:11], v[16:19], v[72:87]
ds_read_b128 v[12:15], v5 offset:9216
s_add_u32 m0, s54, 0
s_add_u32 s55, s53, 0
buffer_load_dwordx4 v0, s[4:7], s55 offen sc1 lds
v_cvt_pk_bf16_f32 v56, v40, v41
s_waitcnt lgkmcnt(6)
v_mfma_f32_32x32x16_bf16 v[72:87], a[12:15], v[20:23], v[72:87]
ds_read_b128 v[16:19], v5 offset:10240
v_cvt_pk_bf16_f32 v57, v42, v43
v_cvt_pk_bf16_f32 v58, v44, v45
v_cvt_pk_bf16_f32 v59, v46, v47
buffer_store_dwordx4 v[56:59], v0, s[4:7], s64 offen sc1
s_waitcnt lgkmcnt(6)
v_mfma_f32_32x32x16_bf16 v[72:87], a[16:19], v[24:27], v[72:87]
ds_read_b128 v[20:23], v5 offset:11264
s_add_u32 m0, s54, 4096
s_add_u32 s55, s53, 4096
buffer_load_dwordx4 v0, s[4:7], s55 offen sc1 lds
s_add_u32 s64, s64, 4096
s_waitcnt lgkmcnt(6)
v_mfma_f32_32x32x16_bf16 v[72:87], a[20:23], v[28:31], v[72:87]
ds_read_b128 v[24:27], v5 offset:12288
v_cvt_pk_bf16_f32 v60, v48, v49
v_cvt_pk_bf16_f32 v61, v50, v51
v_cvt_pk_bf16_f32 v62, v52, v53
v_cvt_pk_bf16_f32 v63, v54, v55
s_waitcnt lgkmcnt(6)
v_mfma_f32_32x32x16_bf16 v[72:87], a[24:27], v[32:35], v[72:87]
ds_read_b128 v[28:31], v5 offset:13312
s_add_u32 m0, s54, 8192
s_add_u32 s55, s53, 8192
buffer_load_dwordx4 v0, s[4:7], s55 offen sc1 lds
buffer_store_dwordx4 v[60:63], v0, s[4:7], s64 offen sc1
s_waitcnt lgkmcnt(6)
v_mfma_f32_32x32x16_bf16 v[72:87], a[28:31], v[36:39], v[72:87]
ds_read_b128 v[32:35], v5 offset:14336
s_waitcnt lgkmcnt(6)
v_mfma_f32_32x32x16_bf16 v[72:87], a[32:35], v[8:11], v[72:87]
ds_read_b128 v[36:39], v5 offset:15360
s_add_u32 m0, s54, 12288
s_add_u32 s55, s53, 12288
buffer_load_dwordx4 v0, s[4:7], s55 offen sc1 lds
s_waitcnt lgkmcnt(6)
v_mfma_f32_32x32x16_bf16 v[72:87], a[36:39], v[12:15], v[72:87]
ds_read_b128 v[8:11], v5 offset:16384
s_waitcnt lgkmcnt(6)
v_mfma_f32_32x32x16_bf16 v[72:87], a[40:43], v[16:19], v[72:87]
ds_read_b128 v[12:15], v5 offset:17408
s_add_u32 m0, s54, 16384
s_add_u32 s55, s53, 16384
buffer_load_dwordx4 v0, s[4:7], s55 offen sc1 lds
s_waitcnt lgkmcnt(6)
v_mfma_f32_32x32x16_bf16 v[72:87], a[44:47], v[20:23], v[72:87]
ds_read_b128 v[16:19], v5 offset:18432
s_waitcnt lgkmcnt(6)
v_mfma_f32_32x32x16_bf16 v[72:87], a[48:51], v[24:27], v[72:87]
ds_read_b128 v[20:23], v5 offset:19456
s_add_u32 m0, s54, 20480
s_add_u32 s55, s53, 20480
buffer_load_dwordx4 v0, s[4:7], s55 offen sc1 lds
s_waitcnt lgkmcnt(6)
v_mfma_f32_32x32x16_bf16 v[72:87], a[52:55], v[28:31], v[72:87]
ds_read_b128 v[24:27], v5 offset:20480
s_waitcnt lgkmcnt(6)
v_mfma_f32_32x32x16_bf16 v[72:87], a[56:59], v[32:35], v[72:87]
ds_read_b128 v[28:31], v5 offset:21504
s_add_u32 m0, s54, 24576
s_add_u32 s55, s53, 24576
buffer_load_dwordx4 v0, s[4:7], s55 offen sc1 lds
s_waitcnt lgkmcnt(6)
v_mfma_f32_32x32x16_bf16 v[72:87], a[60:63], v[36:39], v[72:87]
ds_read_b128 v[32:35], v5 offset:22528
s_waitcnt lgkmcnt(6)
v_mfma_f32_32x32x16_bf16 v[72:87], a[64:67], v[8:11], v[72:87]
ds_read_b128 v[36:39], v5 offset:23552
s_add_u32 m0, s54, 28672
s_add_u32 s55, s53, 28672
buffer_load_dwordx4 v0, s[4:7], s55 offen sc1 lds
s_waitcnt lgkmcnt(6)
v_mfma_f32_32x32x16_bf16 v[72:87], a[68:71], v[12:15], v[72:87]
ds_read_b128 v[8:11], v5 offset:24576
s_waitcnt lgkmcnt(6)
v_mfma_f32_32x32x16_bf16 v[72:87], a[72:75], v[16:19], v[72:87]
ds_read_b128 v[12:15], v5 offset:25600
s_add_u32 m0, s54, 32768
s_add_u32 s55, s53, 32768
buffer_load_dwordx4 v0, s[4:7], s55 offen sc1 lds
s_waitcnt lgkmcnt(6)
v_mfma_f32_32x32x16_bf16 v[72:87], a[76:79], v[20:23], v[72:87]
ds_read_b128 v[16:19], v5 offset:26624
s_waitcnt lgkmcnt(6)
v_mfma_f32_32x32x16_bf16 v[72:87], a[80:83], v[24:27], v[72:87]
ds_read_b128 v[20:23], v5 offset:27648
s_add_u32 m0, s54, 36864
s_add_u32 s55, s53, 36864
buffer_load_dwordx4 v0, s[4:7], s55 offen sc1 lds
s_waitcnt lgkmcnt(6)
v_mfma_f32_32x32x16_bf16 v[72:87], a[84:87], v[28:31], v[72:87]
ds_read_b128 v[24:27], v5 offset:28672
s_cmp_lg_u32 s42, 0
s_cbranch_scc1 Lgdown_w_236
s_waitcnt vmcnt(12)
v_cmp_gt_i32 vcc, v69, v2
s_nop 1
v_mov_b32 v70, vcc_hi
v_mov_b32 v2, vcc_lo
ds_write2_b32 v71, v70, v2 offset0:0 offset1:1
Lgdown_w_236:
s_waitcnt lgkmcnt(6)
v_mfma_f32_32x32x16_bf16 v[72:87], a[88:91], v[32:35], v[72:87]
ds_read_b128 v[28:31], v5 offset:29696
s_add_u32 m0, s54, 40960
s_add_u32 s55, s53, 40960
buffer_load_dwordx4 v0, s[4:7], s55 offen sc1 lds
s_waitcnt lgkmcnt(6)
v_mfma_f32_32x32x16_bf16 v[72:87], a[92:95], v[36:39], v[72:87]
ds_read_b128 v[32:35], v5 offset:30720
s_waitcnt vmcnt(13) lgkmcnt(2)
s_barrier
s_waitcnt lgkmcnt(6)
v_mfma_f32_32x32x16_bf16 v[72:87], a[96:99], v[8:11], v[72:87]
ds_read_b128 v[36:39], v5 offset:31744
s_add_u32 m0, s54, 45056
s_add_u32 s55, s53, 45056
buffer_load_dwordx4 v0, s[4:7], s55 offen sc1 lds
s_waitcnt lgkmcnt(6)
v_mfma_f32_32x32x16_bf16 v[72:87], a[100:103], v[12:15], v[72:87]
ds_read_b128 v[8:11], v5 offset:32768
s_waitcnt lgkmcnt(6)
v_mfma_f32_32x32x16_bf16 v[72:87], a[104:107], v[16:19], v[72:87]
ds_read_b128 v[12:15], v5 offset:33792
s_add_u32 m0, s54, 49152
s_add_u32 s55, s53, 49152
buffer_load_dwordx4 v0, s[4:7], s55 offen sc1 lds
s_waitcnt lgkmcnt(6)
v_mfma_f32_32x32x16_bf16 v[72:87], a[108:111], v[20:23], v[72:87]
ds_read_b128 v[16:19], v5 offset:34816
s_waitcnt lgkmcnt(6)
v_mfma_f32_32x32x16_bf16 v[72:87], a[112:115], v[24:27], v[72:87]
ds_read_b128 v[20:23], v5 offset:35840
s_add_u32 m0, s54, 53248
s_add_u32 s55, s53, 53248
buffer_load_dwordx4 v0, s[4:7], s55 offen sc1 lds
s_waitcnt lgkmcnt(6)
v_mfma_f32_32x32x16_bf16 v[72:87], a[116:119], v[28:31], v[72:87]
ds_read_b128 v[24:27], v5 offset:36864
s_waitcnt lgkmcnt(6)
v_mfma_f32_32x32x16_bf16 v[72:87], a[120:123], v[32:35], v[72:87]
ds_read_b128 v[28:31], v5 offset:37888
s_waitcnt lgkmcnt(6)
v_mfma_f32_32x32x16_bf16 v[72:87], a[124:127], v[36:39], v[72:87]
ds_read_b128 v[32:35], v5 offset:38912
s_waitcnt lgkmcnt(6)
v_mfma_f32_32x32x16_bf16 v[72:87], a[128:131], v[8:11], v[72:87]
ds_read_b128 v[36:39], v5 offset:39936
s_waitcnt lgkmcnt(6)
v_mfma_f32_32x32x16_bf16 v[72:87], a[132:135], v[12:15], v[72:87]
ds_read_b128 v[8:11], v5 offset:40960
s_waitcnt vmcnt(11)
s_barrier
s_waitcnt lgkmcnt(6)
v_mfma_f32_32x32x16_bf16 v[72:87], a[136:139], v[16:19], v[72:87]
ds_read_b128 v[12:15], v5 offset:41984
s_cmp_lg_u32 s42, 0
s_cbranch_scc1 Lgdown_w_237
s_mov_b64 exec, 1
buffer_store_dword v4, v3, s[4:7], s59 offen sc1
s_mov_b64 exec, -1
Lgdown_w_237:
s_waitcnt lgkmcnt(6)
v_mfma_f32_32x32x16_bf16 v[72:87], a[140:143], v[20:23], v[72:87]
ds_read_b128 v[16:19], v5 offset:43008
s_waitcnt lgkmcnt(6)
v_mfma_f32_32x32x16_bf16 v[72:87], a[144:147], v[24:27], v[72:87]
ds_read_b128 v[20:23], v5 offset:44032
s_waitcnt lgkmcnt(6)
v_mfma_f32_32x32x16_bf16 v[72:87], a[148:151], v[28:31], v[72:87]
ds_read_b128 v[24:27], v5 offset:45056
s_waitcnt lgkmcnt(6)
v_mfma_f32_32x32x16_bf16 v[72:87], a[152:155], v[32:35], v[72:87]
ds_read_b128 v[28:31], v5 offset:46080
s_waitcnt lgkmcnt(6)
v_mfma_f32_32x32x16_bf16 v[72:87], a[156:159], v[36:39], v[72:87]
ds_read_b128 v[32:35], v5 offset:47104
s_waitcnt lgkmcnt(6)
v_mfma_f32_32x32x16_bf16 v[72:87], a[160:163], v[8:11], v[72:87]
ds_read_b128 v[36:39], v5 offset:48128
s_waitcnt lgkmcnt(6)
v_mfma_f32_32x32x16_bf16 v[72:87], a[164:167], v[12:15], v[72:87]
ds_read_b128 v[8:11], v5 offset:49152
s_waitcnt lgkmcnt(6)
v_mfma_f32_32x32x16_bf16 v[72:87], a[168:171], v[16:19], v[72:87]
ds_read_b128 v[12:15], v5 offset:50176
s_waitcnt lgkmcnt(6)
v_mfma_f32_32x32x16_bf16 v[72:87], a[172:175], v[20:23], v[72:87]
ds_read_b128 v[16:19], v5 offset:51200
s_waitcnt lgkmcnt(6)
v_mfma_f32_32x32x16_bf16 v[72:87], a[176:179], v[24:27], v[72:87]
ds_read_b128 v[20:23], v5 offset:52224
s_waitcnt lgkmcnt(6)
v_mfma_f32_32x32x16_bf16 v[72:87], a[180:183], v[28:31], v[72:87]
ds_read_b128 v[24:27], v5 offset:53248
s_waitcnt lgkmcnt(6)
v_mfma_f32_32x32x16_bf16 v[72:87], a[184:187], v[32:35], v[72:87]
ds_read_b128 v[28:31], v5 offset:54272
s_waitcnt lgkmcnt(6)
v_mfma_f32_32x32x16_bf16 v[72:87], a[188:191], v[36:39], v[72:87]
ds_read_b128 v[32:35], v5 offset:55296
s_waitcnt lgkmcnt(6)
v_mfma_f32_32x32x16_bf16 v[72:87], a[192:195], v[8:11], v[72:87]
ds_read_b128 v[36:39], v5 offset:56320
s_waitcnt lgkmcnt(6)
v_mfma_f32_32x32x16_bf16 v[72:87], a[196:199], v[12:15], v[72:87]
s_waitcnt lgkmcnt(5)
v_mfma_f32_32x32x16_bf16 v[72:87], a[200:203], v[16:19], v[72:87]
s_waitcnt lgkmcnt(4)
v_mfma_f32_32x32x16_bf16 v[72:87], a[204:207], v[20:23], v[72:87]
s_waitcnt lgkmcnt(3)
v_mfma_f32_32x32x16_bf16 v[72:87], a[208:211], v[24:27], v[72:87]
s_waitcnt lgkmcnt(2)
v_mfma_f32_32x32x16_bf16 v[72:87], a[212:215], v[28:31], v[72:87]
s_waitcnt lgkmcnt(1)
v_mfma_f32_32x32x16_bf16 v[72:87], a[216:219], v[32:35], v[72:87]
s_waitcnt lgkmcnt(0)
v_mfma_f32_32x32x16_bf16 v[72:87], a[220:223], v[36:39], v[72:87]
s_mov_b32 s64, s57
s_add_u32 s50, s46, 1
s_add_u32 s57, s57, s58
v_mov_b32 v4, s50
s_add_u32 s46, s46, s48
s_sub_u32 s47, s47, 1
s_waitcnt vmcnt(6)
s_branch Lgdown_top0
Lgdown_nop1:
s_waitcnt lgkmcnt(6)
v_mfma_f32_32x32x16_bf16 v[72:87], a[8:11], v[16:19], v[72:87]
ds_read_b128 v[12:15], v5 offset:9216
v_cvt_pk_bf16_f32 v56, v40, v41
v_cvt_pk_bf16_f32 v57, v42, v43
v_cvt_pk_bf16_f32 v58, v44, v45
v_cvt_pk_bf16_f32 v59, v46, v47
s_waitcnt lgkmcnt(6)
v_mfma_f32_32x32x16_bf16 v[72:87], a[12:15], v[20:23], v[72:87]
ds_read_b128 v[16:19], v5 offset:10240
buffer_store_dwordx4 v[56:59], v0, s[4:7], s64 offen sc1
s_add_u32 s64, s64, 4096
v_cvt_pk_bf16_f32 v60, v48, v49
v_cvt_pk_bf16_f32 v61, v50, v51
s_waitcnt lgkmcnt(6)
v_mfma_f32_32x32x16_bf16 v[72:87], a[16:19], v[24:27], v[72:87]
ds_read_b128 v[20:23], v5 offset:11264
v_cvt_pk_bf16_f32 v62, v52, v53
v_cvt_pk_bf16_f32 v63, v54, v55
buffer_store_dwordx4 v[60:63], v0, s[4:7], s64 offen sc1
s_waitcnt lgkmcnt(6)
v_mfma_f32_32x32x16_bf16 v[72:87], a[20:23], v[28:31], v[72:87]
ds_read_b128 v[24:27], v5 offset:12288
s_waitcnt lgkmcnt(6)
v_mfma_f32_32x32x16_bf16 v[72:87], a[24:27], v[32:35], v[72:87]
ds_read_b128 v[28:31], v5 offset:13312
s_waitcnt lgkmcnt(6)
v_mfma_f32_32x32x16_bf16 v[72:87], a[28:31], v[36:39], v[72:87]
ds_read_b128 v[32:35], v5 offset:14336
s_waitcnt lgkmcnt(6)
v_mfma_f32_32x32x16_bf16 v[72:87], a[32:35], v[8:11], v[72:87]
ds_read_b128 v[36:39], v5 offset:15360
s_waitcnt lgkmcnt(6)
v_mfma_f32_32x32x16_bf16 v[72:87], a[36:39], v[12:15], v[72:87]
ds_read_b128 v[8:11], v5 offset:16384
s_waitcnt lgkmcnt(6)
v_mfma_f32_32x32x16_bf16 v[72:87], a[40:43], v[16:19], v[72:87]
ds_read_b128 v[12:15], v5 offset:17408
s_waitcnt lgkmcnt(6)
v_mfma_f32_32x32x16_bf16 v[72:87], a[44:47], v[20:23], v[72:87]
ds_read_b128 v[16:19], v5 offset:18432
s_waitcnt lgkmcnt(6)
v_mfma_f32_32x32x16_bf16 v[72:87], a[48:51], v[24:27], v[72:87]
ds_read_b128 v[20:23], v5 offset:19456
s_waitcnt lgkmcnt(6)
v_mfma_f32_32x32x16_bf16 v[72:87], a[52:55], v[28:31], v[72:87]
ds_read_b128 v[24:27], v5 offset:20480
s_waitcnt lgkmcnt(6)
v_mfma_f32_32x32x16_bf16 v[72:87], a[56:59], v[32:35], v[72:87]
ds_read_b128 v[28:31], v5 offset:21504
s_waitcnt lgkmcnt(6)
v_mfma_f32_32x32x16_bf16 v[72:87], a[60:63], v[36:39], v[72:87]
ds_read_b128 v[32:35], v5 offset:22528
s_waitcnt lgkmcnt(6)
v_mfma_f32_32x32x16_bf16 v[72:87], a[64:67], v[8:11], v[72:87]
ds_read_b128 v[36:39], v5 offset:23552
s_waitcnt lgkmcnt(6)
v_mfma_f32_32x32x16_bf16 v[72:87], a[68:71], v[12:15], v[72:87]
ds_read_b128 v[8:11], v5 offset:24576
s_waitcnt lgkmcnt(6)
v_mfma_f32_32x32x16_bf16 v[72:87], a[72:75], v[16:19], v[72:87]
ds_read_b128 v[12:15], v5 offset:25600
s_waitcnt lgkmcnt(6)
v_mfma_f32_32x32x16_bf16 v[72:87], a[76:79], v[20:23], v[72:87]
ds_read_b128 v[16:19], v5 offset:26624
s_waitcnt lgkmcnt(6)
v_mfma_f32_32x32x16_bf16 v[72:87], a[80:83], v[24:27], v[72:87]
ds_read_b128 v[20:23], v5 offset:27648
s_waitcnt lgkmcnt(6)
v_mfma_f32_32x32x16_bf16 v[72:87], a[84:87], v[28:31], v[72:87]
ds_read_b128 v[24:27], v5 offset:28672
s_cmp_lg_u32 s42, 0
s_cbranch_scc1 Lgdown_w_238
s_waitcnt vmcnt(2)
v_cmp_gt_i32 vcc, v69, v2
s_nop 1
v_mov_b32 v70, vcc_hi
v_mov_b32 v2, vcc_lo
ds_write2_b32 v71, v70, v2 offset0:0 offset1:1
Lgdown_w_238:
s_waitcnt lgkmcnt(6)
v_mfma_f32_32x32x16_bf16 v[72:87], a[88:91], v[32:35], v[72:87]
ds_read_b128 v[28:31], v5 offset:29696
s_waitcnt lgkmcnt(6)
v_mfma_f32_32x32x16_bf16 v[72:87], a[92:95], v[36:39], v[72:87]
ds_read_b128 v[32:35], v5 offset:30720
s_waitcnt vmcnt(2) lgkmcnt(2)
s_barrier
ds_read_b32 v70, v71 offset:4
s_waitcnt lgkmcnt(6)
v_mfma_f32_32x32x16_bf16 v[72:87], a[96:99], v[8:11], v[72:87]
ds_read_b128 v[36:39], v5 offset:31744
s_waitcnt lgkmcnt(6)
v_mfma_f32_32x32x16_bf16 v[72:87], a[100:103], v[12:15], v[72:87]
ds_read_b128 v[8:11], v5 offset:32768
s_waitcnt lgkmcnt(2)
v_readfirstlane_b32 s50, v70
s_nop 0
s_cmp_eq_u32 s50, 0
s_cbranch_scc1 Lgdown_late1
s_waitcnt lgkmcnt(6)
v_mfma_f32_32x32x16_bf16 v[72:87], a[104:107], v[16:19], v[72:87]
ds_read_b128 v[12:15], v5 offset:33792
s_cmp_lg_u32 s42, 0
s_cbranch_scc1 Lgdown_w_239
buffer_load_dword v2, v68, s[4:7], s60 offen sc1
Lgdown_w_239:
s_waitcnt lgkmcnt(6)
v_mfma_f32_32x32x16_bf16 v[72:87], a[108:111], v[20:23], v[72:87]
ds_read_b128 v[16:19], v5 offset:34816
s_waitcnt lgkmcnt(6)
v_mfma_f32_32x32x16_bf16 v[72:87], a[112:115], v[24:27], v[72:87]
ds_read_b128 v[20:23], v5 offset:35840
s_waitcnt lgkmcnt(6)
v_mfma_f32_32x32x16_bf16 v[72:87], a[116:119], v[28:31], v[72:87]
ds_read_b128 v[24:27], v5 offset:36864
s_waitcnt lgkmcnt(6)
v_mfma_f32_32x32x16_bf16 v[72:87], a[120:123], v[32:35], v[72:87]
ds_read_b128 v[28:31], v5 offset:37888
s_waitcnt lgkmcnt(6)
v_mfma_f32_32x32x16_bf16 v[72:87], a[124:127], v[36:39], v[72:87]
ds_read_b128 v[32:35], v5 offset:38912
s_waitcnt lgkmcnt(6)
v_mfma_f32_32x32x16_bf16 v[72:87], a[128:131], v[8:11], v[72:87]
ds_read_b128 v[36:39], v5 offset:39936
s_waitcnt lgkmcnt(6)
v_mfma_f32_32x32x16_bf16 v[72:87], a[132:135], v[12:15], v[72:87]
ds_read_b128 v[8:11], v5 offset:40960
s_cmp_eq_u32 s42, 0
s_cbranch_scc1 Lgdown_z_240
s_waitcnt vmcnt(0)
Lgdown_z_240:
s_waitcnt vmcnt(1)
s_barrier
s_waitcnt lgkmcnt(6)
v_mfma_f32_32x32x16_bf16 v[72:87], a[136:139], v[16:19], v[72:87]
ds_read_b128 v[12:15], v5 offset:41984
s_cmp_lg_u32 s42, 0
s_cbranch_scc1 Lgdown_w_241
s_mov_b64 exec, 1
buffer_store_dword v4, v3, s[4:7], s59 offen sc1
s_mov_b64 exec, -1
Lgdown_w_241:
s_waitcnt lgkmcnt(6)
v_mfma_f32_32x32x16_bf16 v[72:87], a[140:143], v[20:23], v[72:87]
ds_read_b128 v[16:19], v5 offset:43008
s_waitcnt lgkmcnt(6)
v_mfma_f32_32x32x16_bf16 v[72:87], a[144:147], v[24:27], v[72:87]
ds_read_b128 v[20:23], v5 offset:44032
s_waitcnt lgkmcnt(6)
v_mfma_f32_32x32x16_bf16 v[72:87], a[148:151], v[28:31], v[72:87]
ds_read_b128 v[24:27], v5 offset:45056
s_waitcnt lgkmcnt(6)
v_mfma_f32_32x32x16_bf16 v[72:87], a[152:155], v[32:35], v[72:87]
ds_read_b128 v[28:31], v5 offset:46080
s_waitcnt lgkmcnt(6)
v_mfma_f32_32x32x16_bf16 v[72:87], a[156:159], v[36:39], v[72:87]
ds_read_b128 v[32:35], v5 offset:47104
s_waitcnt lgkmcnt(6)
v_mfma_f32_32x32x16_bf16 v[72:87], a[160:163], v[8:11], v[72:87]
ds_read_b128 v[36:39], v5 offset:48128
s_waitcnt lgkmcnt(6)
v_mfma_f32_32x32x16_bf16 v[72:87], a[164:167], v[12:15], v[72:87]
ds_read_b128 v[8:11], v5 offset:49152
s_waitcnt lgkmcnt(6)
v_mfma_f32_32x32x16_bf16 v[72:87], a[168:171], v[16:19], v[72:87]
ds_read_b128 v[12:15], v5 offset:50176
s_waitcnt lgkmcnt(6)
v_mfma_f32_32x32x16_bf16 v[72:87], a[172:175], v[20:23], v[72:87]
ds_read_b128 v[16:19], v5 offset:51200
s_waitcnt lgkmcnt(6)
v_mfma_f32_32x32x16_bf16 v[72:87], a[176:179], v[24:27], v[72:87]
ds_read_b128 v[20:23], v5 offset:52224
s_waitcnt lgkmcnt(6)
v_mfma_f32_32x32x16_bf16 v[72:87], a[180:183], v[28:31], v[72:87]
ds_read_b128 v[24:27], v5 offset:53248
s_waitcnt lgkmcnt(6)
v_mfma_f32_32x32x16_bf16 v[72:87], a[184:187], v[32:35], v[72:87]
ds_read_b128 v[28:31], v5 offset:54272
s_waitcnt lgkmcnt(6)
v_mfma_f32_32x32x16_bf16 v[72:87], a[188:191], v[36:39], v[72:87]
ds_read_b128 v[32:35], v5 offset:55296
s_cmp_lg_u32 s42, 0
s_cbranch_scc1 Lgdown_w_242
s_waitcnt vmcnt(1)
v_cmp_gt_i32 vcc, v69, v2
s_nop 1
v_mov_b32 v70, vcc_hi
v_mov_b32 v2, vcc_lo
ds_write2_b32 v71, v70, v2 offset0:0 offset1:2
Lgdown_w_242:
s_waitcnt lgkmcnt(6)
v_mfma_f32_32x32x16_bf16 v[72:87], a[192:195], v[8:11], v[72:87]
ds_read_b128 v[36:39], v5 offset:56320
s_waitcnt lgkmcnt(6)
v_mfma_f32_32x32x16_bf16 v[72:87], a[196:199], v[12:15], v[72:87]
s_waitcnt lgkmcnt(0)
s_barrier
ds_read_b32 v70, v71 offset:8
s_waitcnt lgkmcnt(5)
v_mfma_f32_32x32x16_bf16 v[72:87], a[200:203], v[16:19], v[72:87]
s_waitcnt lgkmcnt(4)
v_mfma_f32_32x32x16_bf16 v[72:87], a[204:207], v[20:23], v[72:87]
s_waitcnt lgkmcnt(0)
v_readfirstlane_b32 s50, v70
s_nop 0
s_cmp_eq_u32 s50, 0
s_cbranch_scc1 Lgdown_late21
s_waitcnt lgkmcnt(3)
v_mfma_f32_32x32x16_bf16 v[72:87], a[208:211], v[24:27], v[72:87]
s_waitcnt lgkmcnt(2)
v_mfma_f32_32x32x16_bf16 v[72:87], a[212:215], v[28:31], v[72:87]
s_waitcnt lgkmcnt(1)
v_mfma_f32_32x32x16_bf16 v[72:87], a[216:219], v[32:35], v[72:87]
s_waitcnt lgkmcnt(0)
v_mfma_f32_32x32x16_bf16 v[72:87], a[220:223], v[36:39], v[72:87]
s_mov_b32 s64, s57
s_add_u32 s50, s46, 1
s_add_u32 s57, s57, s58
v_mov_b32 v4, s50
s_nop 7
v_cvt_pk_bf16_f32 v56, v72, v73
v_cvt_pk_bf16_f32 v57, v74, v75
v_cvt_pk_bf16_f32 v58, v76, v77
v_cvt_pk_bf16_f32 v59, v78, v79
buffer_store_dwordx4 v[56:59], v0, s[4:7], s64 offen sc1
s_add_u32 s64, s64, 4096
v_cvt_pk_bf16_f32 v60, v80, v81
v_cvt_pk_bf16_f32 v61, v82, v83
v_cvt_pk_bf16_f32 v62, v84, v85
v_cvt_pk_bf16_f32 v63, v86, v87
buffer_store_dwordx4 v[60:63], v0, s[4:7], s64 offen sc1
s_cmp_lg_u32 s42, 0
s_cbranch_scc1 Lgdown_w_243
buffer_load_dword v2, v68, s[4:7], s60 offen sc1
s_waitcnt vmcnt(0)
v_cmp_gt_i32 vcc, v69, v2
s_nop 1
v_mov_b32 v70, vcc_hi
v_mov_b32 v2, vcc_lo
ds_write2_b32 v71, v70, v2 offset1:1
s_waitcnt lgkmcnt(0)
Lgdown_w_243:
s_add_u32 s46, s46, s48
s_sub_u32 s47, s47, 1
s_waitcnt vmcnt(0)
s_barrier
ds_read_b32 v70, v71 offset:4
s_cmp_lg_u32 s42, 0
s_cbranch_scc1 Lgdown_w_244
s_mov_b64 exec, 1
buffer_store_dword v4, v3, s[4:7], s59 offen sc1
s_mov_b64 exec, -1
Lgdown_w_244:
s_waitcnt lgkmcnt(0)
v_readfirstlane_b32 s50, v70
s_nop 0
s_cmp_eq_u32 s50, 0
s_cbranch_scc1 Lgdown_fetch
s_branch Lgdown_cold
Lgdown_late1:
s_waitcnt lgkmcnt(6)
v_mfma_f32_32x32x16_bf16 v[72:87], a[104:107], v[16:19], v[72:87]
ds_read_b128 v[12:15], v5 offset:33792
s_add_u32 m0, s54, 0
s_add_u32 s55, s53, 0
buffer_load_dwordx4 v0, s[4:7], s55 offen sc1 lds
s_waitcnt lgkmcnt(6)
v_mfma_f32_32x32x16_bf16 v[72:87], a[108:111], v[20:23], v[72:87]
ds_read_b128 v[16:19], v5 offset:34816
s_add_u32 m0, s54, 4096
s_add_u32 s55, s53, 4096
buffer_load_dwordx4 v0, s[4:7], s55 offen sc1 lds
s_waitcnt lgkmcnt(6)
v_mfma_f32_32x32x16_bf16 v[72:87], a[112:115], v[24:27], v[72:87]
ds_read_b128 v[20:23], v5 offset:35840
s_add_u32 m0, s54, 8192
s_add_u32 s55, s53, 8192
buffer_load_dwordx4 v0, s[4:7], s55 offen sc1 lds
s_waitcnt lgkmcnt(6)
v_mfma_f32_32x32x16_bf16 v[72:87], a[116:119], v[28:31], v[72:87]
ds_read_b128 v[24:27], v5 offset:36864
s_add_u32 m0, s54, 12288
s_add_u32 s55, s53, 12288
buffer_load_dwordx4 v0, s[4:7], s55 offen sc1 lds
s_waitcnt lgkmcnt(6)
v_mfma_f32_32x32x16_bf16 v[72:87], a[120:123], v[32:35], v[72:87]
ds_read_b128 v[28:31], v5 offset:37888
s_add_u32 m0, s54, 16384
s_add_u32 s55, s53, 16384
buffer_load_dwordx4 v0, s[4:7], s55 offen sc1 lds
s_waitcnt lgkmcnt(6)
v_mfma_f32_32x32x16_bf16 v[72:87], a[124:127], v[36:39], v[72:87]
ds_read_b128 v[32:35], v5 offset:38912
s_add_u32 m0, s54, 20480
s_add_u32 s55, s53, 20480
buffer_load_dwordx4 v0, s[4:7], s55 offen sc1 lds
s_waitcnt lgkmcnt(6)
v_mfma_f32_32x32x16_bf16 v[72:87], a[128:131], v[8:11], v[72:87]
ds_read_b128 v[36:39], v5 offset:39936
s_add_u32 m0, s54, 24576
s_add_u32 s55, s53, 24576
buffer_load_dwordx4 v0, s[4:7], s55 offen sc1 lds
s_waitcnt lgkmcnt(6)
v_mfma_f32_32x32x16_bf16 v[72:87], a[132:135], v[12:15], v[72:87]
ds_read_b128 v[8:11], v5 offset:40960
s_add_u32 m0, s54, 28672
s_add_u32 s55, s53, 28672
buffer_load_dwordx4 v0, s[4:7], s55 offen sc1 lds
s_waitcnt vmcnt(8)
s_barrier
s_waitcnt lgkmcnt(6)
v_mfma_f32_32x32x16_bf16 v[72:87], a[136:139], v[16:19], v[72:87]
ds_read_b128 v[12:15], v5 offset:41984
s_cmp_lg_u32 s42, 0
s_cbranch_scc1 Lgdown_w_245
s_mov_b64 exec, 1
buffer_store_dword v4, v3, s[4:7], s59 offen sc1
s_mov_b64 exec, -1
Lgdown_w_245:
s_waitcnt lgkmcnt(6)
v_mfma_f32_32x32x16_bf16 v[72:87], a[140:143], v[20:23], v[72:87]
ds_read_b128 v[16:19], v5 offset:43008
s_waitcnt lgkmcnt(6)
v_mfma_f32_32x32x16_bf16 v[72:87], a[144:147], v[24:27], v[72:87]
ds_read_b128 v[20:23], v5 offset:44032
s_add_u32 m0, s54, 32768
s_add_u32 s55, s53, 32768
buffer_load_dwordx4 v0, s[4:7], s55 offen sc1 lds
s_waitcnt lgkmcnt(6)
v_mfma_f32_32x32x16_bf16 v[72:87], a[148:151], v[28:31], v[72:87]
ds_read_b128 v[24:27], v5 offset:45056
s_waitcnt lgkmcnt(6)
v_mfma_f32_32x32x16_bf16 v[72:87], a[152:155], v[32:35], v[72:87]
ds_read_b128 v[28:31], v5 offset:46080
s_add_u32 m0, s54, 36864
s_add_u32 s55, s53, 36864
buffer_load_dwordx4 v0, s[4:7], s55 offen sc1 lds
s_waitcnt lgkmcnt(6)
v_mfma_f32_32x32x16_bf16 v[72:87], a[156:159], v[36:39], v[72:87]
ds_read_b128 v[32:35], v5 offset:47104
s_waitcnt lgkmcnt(6)
v_mfma_f32_32x32x16_bf16 v[72:87], a[160:163], v[8:11], v[72:87]
ds_read_b128 v[36:39], v5 offset:48128
s_add_u32 m0, s54, 40960
s_add_u32 s55, s53, 40960
buffer_load_dwordx4 v0, s[4:7], s55 offen sc1 lds
s_waitcnt lgkmcnt(6)
v_mfma_f32_32x32x16_bf16 v[72:87], a[164:167], v[12:15], v[72:87]
ds_read_b128 v[8:11], v5 offset:49152
s_waitcnt lgkmcnt(6)
v_mfma_f32_32x32x16_bf16 v[72:87], a[168:171], v[16:19], v[72:87]
ds_read_b128 v[12:15], v5 offset:50176
s_add_u32 m0, s54, 45056
s_add_u32 s55, s53, 45056
buffer_load_dwordx4 v0, s[4:7], s55 offen sc1 lds
s_waitcnt lgkmcnt(6)
v_mfma_f32_32x32x16_bf16 v[72:87], a[172:175], v[20:23], v[72:87]
ds_read_b128 v[16:19], v5 offset:51200
s_waitcnt lgkmcnt(6)
v_mfma_f32_32x32x16_bf16 v[72:87], a[176:179], v[24:27], v[72:87]
ds_read_b128 v[20:23], v5 offset:52224
s_add_u32 m0, s54, 49152
s_add_u32 s55, s53, 49152
buffer_load_dwordx4 v0, s[4:7], s55 offen sc1 lds
s_waitcnt lgkmcnt(6)
v_mfma_f32_32x32x16_bf16 v[72:87], a[180:183], v[28:31], v[72:87]
ds_read_b128 v[24:27], v5 offset:53248
s_waitcnt lgkmcnt(6)
v_mfma_f32_32x32x16_bf16 v[72:87], a[184:187], v[32:35], v[72:87]
ds_read_b128 v[28:31], v5 offset:54272
s_add_u32 m0, s54, 53248
s_add_u32 s55, s53, 53248
buffer_load_dwordx4 v0, s[4:7], s55 offen sc1 lds
s_waitcnt lgkmcnt(6)
v_mfma_f32_32x32x16_bf16 v[72:87], a[188:191], v[36:39], v[72:87]
ds_read_b128 v[32:35], v5 offset:55296
s_waitcnt lgkmcnt(6)
v_mfma_f32_32x32x16_bf16 v[72:87], a[192:195], v[8:11], v[72:87]
ds_read_b128 v[36:39], v5 offset:56320
s_waitcnt lgkmcnt(6)
v_mfma_f32_32x32x16_bf16 v[72:87], a[196:199], v[12:15], v[72:87]
s_waitcnt lgkmcnt(5)
v_mfma_f32_32x32x16_bf16 v[72:87], a[200:203], v[16:19], v[72:87]
s_waitcnt lgkmcnt(4)
v_mfma_f32_32x32x16_bf16 v[72:87], a[204:207], v[20:23], v[72:87]
s_waitcnt lgkmcnt(3)
v_mfma_f32_32x32x16_bf16 v[72:87], a[208:211], v[24:27], v[72:87]
s_waitcnt lgkmcnt(2)
v_mfma_f32_32x32x16_bf16 v[72:87], a[212:215], v[28:31], v[72:87]
s_waitcnt lgkmcnt(1)
v_mfma_f32_32x32x16_bf16 v[72:87], a[216:219], v[32:35], v[72:87]
s_waitcnt lgkmcnt(0)
v_mfma_f32_32x32x16_bf16 v[72:87], a[220:223], v[36:39], v[72:87]
s_mov_b32 s64, s57
s_add_u32 s50, s46, 1
s_add_u32 s57, s57, s58
v_mov_b32 v4, s50
s_add_u32 s46, s46, s48
s_sub_u32 s47, s47, 1
s_waitcnt vmcnt(6)
s_branch Lgdown_top0
Lgdown_late21:
s_waitcnt lgkmcnt(3)
v_mfma_f32_32x32x16_bf16 v[72:87], a[208:211], v[24:27], v[72:87]
s_waitcnt lgkmcnt(2)
v_mfma_f32_32x32x16_bf16 v[72:87], a[212:215], v[28:31], v[72:87]
s_waitcnt lgkmcnt(1)
v_mfma_f32_32x32x16_bf16 v[72:87], a[216:219], v[32:35], v[72:87]
s_waitcnt lgkmcnt(0)
v_mfma_f32_32x32x16_bf16 v[72:87], a[220:223], v[36:39], v[72:87]
s_mov_b32 s64, s57
s_add_u32 s50, s46, 1
s_add_u32 s57, s57, s58
v_mov_b32 v4, s50
s_nop 7
v_cvt_pk_bf16_f32 v56, v72, v73
v_cvt_pk_bf16_f32 v57, v74, v75
v_cvt_pk_bf16_f32 v58, v76, v77
v_cvt_pk_bf16_f32 v59, v78, v79
buffer_store_dwordx4 v[56:59], v0, s[4:7], s64 offen sc1
s_add_u32 s64, s64, 4096
v_cvt_pk_bf16_f32 v60, v80, v81
v_cvt_pk_bf16_f32 v61, v82, v83
v_cvt_pk_bf16_f32 v62, v84, v85
v_cvt_pk_bf16_f32 v63, v86, v87
buffer_store_dwordx4 v[60:63], v0, s[4:7], s64 offen sc1
s_add_u32 s46, s46, s48
s_sub_u32 s47, s47, 1
s_add_u32 m0, s54, 0
s_add_u32 s55, s53, 0
buffer_load_dwordx4 v0, s[4:7], s55 offen sc1 lds
s_add_u32 m0, s54, 4096
s_add_u32 s55, s53, 4096
buffer_load_dwordx4 v0, s[4:7], s55 offen sc1 lds
s_add_u32 m0, s54, 8192
s_add_u32 s55, s53, 8192
buffer_load_dwordx4 v0, s[4:7], s55 offen sc1 lds
s_add_u32 m0, s54, 12288
s_add_u32 s55, s53, 12288
buffer_load_dwordx4 v0, s[4:7], s55 offen sc1 lds
s_add_u32 m0, s54, 16384
s_add_u32 s55, s53, 16384
buffer_load_dwordx4 v0, s[4:7], s55 offen sc1 lds
s_add_u32 m0, s54, 20480
s_add_u32 s55, s53, 20480
buffer_load_dwordx4 v0, s[4:7], s55 offen sc1 lds
s_add_u32 m0, s54, 24576
s_add_u32 s55, s53, 24576
buffer_load_dwordx4 v0, s[4:7], s55 offen sc1 lds
s_add_u32 m0, s54, 28672
s_add_u32 s55, s53, 28672
buffer_load_dwordx4 v0, s[4:7], s55 offen sc1 lds
s_add_u32 m0, s54, 32768
s_add_u32 s55, s53, 32768
buffer_load_dwordx4 v0, s[4:7], s55 offen sc1 lds
s_add_u32 m0, s54, 36864
s_add_u32 s55, s53, 36864
buffer_load_dwordx4 v0, s[4:7], s55 offen sc1 lds
s_add_u32 m0, s54, 40960
s_add_u32 s55, s53, 40960
buffer_load_dwordx4 v0, s[4:7], s55 offen sc1 lds
s_add_u32 m0, s54, 45056
s_add_u32 s55, s53, 45056
buffer_load_dwordx4 v0, s[4:7], s55 offen sc1 lds
s_add_u32 m0, s54, 49152
s_add_u32 s55, s53, 49152
buffer_load_dwordx4 v0, s[4:7], s55 offen sc1 lds
s_add_u32 m0, s54, 53248
s_add_u32 s55, s53, 53248
buffer_load_dwordx4 v0, s[4:7], s55 offen sc1 lds
s_lshl_b32 s64, s40, 14
s_lshl_b32 s50, s42, 11
s_add_u32 s64, s64, s50
s_add_u32 s64, s64, 155189248
s_waitcnt vmcnt(14)
s_barrier
s_cmp_lg_u32 s42, 0
s_cbranch_scc1 Lgdown_w_246
s_mov_b64 exec, 1
buffer_store_dword v4, v3, s[4:7], s59 offen sc1
s_mov_b64 exec, -1
Lgdown_w_246:
s_waitcnt vmcnt(6)
s_branch Lgdown_top0
Lgdown_last1:
s_waitcnt lgkmcnt(6)
v_mfma_f32_32x32x16_bf16 v[72:87], a[8:11], v[16:19], v[72:87]
ds_read_b128 v[12:15], v5 offset:9216
v_cvt_pk_bf16_f32 v56, v40, v41
v_cvt_pk_bf16_f32 v57, v42, v43
v_cvt_pk_bf16_f32 v58, v44, v45
v_cvt_pk_bf16_f32 v59, v46, v47
s_waitcnt lgkmcnt(6)
v_mfma_f32_32x32x16_bf16 v[72:87], a[12:15], v[20:23], v[72:87]
ds_read_b128 v[16:19], v5 offset:10240
buffer_store_dwordx4 v[56:59], v0, s[4:7], s64 offen sc1
s_add_u32 s64, s64, 4096
v_cvt_pk_bf16_f32 v60, v48, v49
v_cvt_pk_bf16_f32 v61, v50, v51
s_waitcnt lgkmcnt(6)
v_mfma_f32_32x32x16_bf16 v[72:87], a[16:19], v[24:27], v[72:87]
ds_read_b128 v[20:23], v5 offset:11264
v_cvt_pk_bf16_f32 v62, v52, v53
v_cvt_pk_bf16_f32 v63, v54, v55
buffer_store_dwordx4 v[60:63], v0, s[4:7], s64 offen sc1
s_waitcnt lgkmcnt(6)
v_mfma_f32_32x32x16_bf16 v[72:87], a[20:23], v[28:31], v[72:87]
ds_read_b128 v[24:27], v5 offset:12288
s_waitcnt lgkmcnt(6)
v_mfma_f32_32x32x16_bf16 v[72:87], a[24:27], v[32:35], v[72:87]
ds_read_b128 v[28:31], v5 offset:13312
s_waitcnt lgkmcnt(6)
v_mfma_f32_32x32x16_bf16 v[72:87], a[28:31], v[36:39], v[72:87]
ds_read_b128 v[32:35], v5 offset:14336
s_waitcnt lgkmcnt(6)
v_mfma_f32_32x32x16_bf16 v[72:87], a[32:35], v[8:11], v[72:87]
ds_read_b128 v[36:39], v5 offset:15360
s_waitcnt lgkmcnt(6)
v_mfma_f32_32x32x16_bf16 v[72:87], a[36:39], v[12:15], v[72:87]
ds_read_b128 v[8:11], v5 offset:16384
s_waitcnt lgkmcnt(6)
v_mfma_f32_32x32x16_bf16 v[72:87], a[40:43], v[16:19], v[72:87]
ds_read_b128 v[12:15], v5 offset:17408
s_waitcnt lgkmcnt(6)
v_mfma_f32_32x32x16_bf16 v[72:87], a[44:47], v[20:23], v[72:87]
ds_read_b128 v[16:19], v5 offset:18432
s_waitcnt lgkmcnt(6)
v_mfma_f32_32x32x16_bf16 v[72:87], a[48:51], v[24:27], v[72:87]
ds_read_b128 v[20:23], v5 offset:19456
s_waitcnt lgkmcnt(6)
v_mfma_f32_32x32x16_bf16 v[72:87], a[52:55], v[28:31], v[72:87]
ds_read_b128 v[24:27], v5 offset:20480
s_waitcnt lgkmcnt(6)
v_mfma_f32_32x32x16_bf16 v[72:87], a[56:59], v[32:35], v[72:87]
ds_read_b128 v[28:31], v5 offset:21504
s_waitcnt lgkmcnt(6)
v_mfma_f32_32x32x16_bf16 v[72:87], a[60:63], v[36:39], v[72:87]
ds_read_b128 v[32:35], v5 offset:22528
s_waitcnt lgkmcnt(6)
v_mfma_f32_32x32x16_bf16 v[72:87], a[64:67], v[8:11], v[72:87]
ds_read_b128 v[36:39], v5 offset:23552
s_waitcnt lgkmcnt(6)
v_mfma_f32_32x32x16_bf16 v[72:87], a[68:71], v[12:15], v[72:87]
ds_read_b128 v[8:11], v5 offset:24576
s_waitcnt lgkmcnt(6)
v_mfma_f32_32x32x16_bf16 v[72:87], a[72:75], v[16:19], v[72:87]
ds_read_b128 v[12:15], v5 offset:25600
s_waitcnt lgkmcnt(6)
v_mfma_f32_32x32x16_bf16 v[72:87], a[76:79], v[20:23], v[72:87]
ds_read_b128 v[16:19], v5 offset:26624
s_waitcnt lgkmcnt(6)
v_mfma_f32_32x32x16_bf16 v[72:87], a[80:83], v[24:27], v[72:87]
ds_read_b128 v[20:23], v5 offset:27648
s_waitcnt lgkmcnt(6)
v_mfma_f32_32x32x16_bf16 v[72:87], a[84:87], v[28:31], v[72:87]
ds_read_b128 v[24:27], v5 offset:28672
s_waitcnt lgkmcnt(6)
v_mfma_f32_32x32x16_bf16 v[72:87], a[88:91], v[32:35], v[72:87]
ds_read_b128 v[28:31], v5 offset:29696
s_waitcnt lgkmcnt(6)
v_mfma_f32_32x32x16_bf16 v[72:87], a[92:95], v[36:39], v[72:87]
ds_read_b128 v[32:35], v5 offset:30720
s_waitcnt vmcnt(2) lgkmcnt(2)
s_barrier
s_waitcnt lgkmcnt(6)
v_mfma_f32_32x32x16_bf16 v[72:87], a[96:99], v[8:11], v[72:87]
ds_read_b128 v[36:39], v5 offset:31744
s_waitcnt lgkmcnt(6)
v_mfma_f32_32x32x16_bf16 v[72:87], a[100:103], v[12:15], v[72:87]
ds_read_b128 v[8:11], v5 offset:32768
s_waitcnt lgkmcnt(6)
v_mfma_f32_32x32x16_bf16 v[72:87], a[104:107], v[16:19], v[72:87]
ds_read_b128 v[12:15], v5 offset:33792
s_waitcnt lgkmcnt(6)
v_mfma_f32_32x32x16_bf16 v[72:87], a[108:111], v[20:23], v[72:87]
ds_read_b128 v[16:19], v5 offset:34816
s_waitcnt lgkmcnt(6)
v_mfma_f32_32x32x16_bf16 v[72:87], a[112:115], v[24:27], v[72:87]
ds_read_b128 v[20:23], v5 offset:35840
s_waitcnt lgkmcnt(6)
v_mfma_f32_32x32x16_bf16 v[72:87], a[116:119], v[28:31], v[72:87]
ds_read_b128 v[24:27], v5 offset:36864
s_waitcnt lgkmcnt(6)
v_mfma_f32_32x32x16_bf16 v[72:87], a[120:123], v[32:35], v[72:87]
ds_read_b128 v[28:31], v5 offset:37888
s_waitcnt lgkmcnt(6)
v_mfma_f32_32x32x16_bf16 v[72:87], a[124:127], v[36:39], v[72:87]
ds_read_b128 v[32:35], v5 offset:38912
s_waitcnt lgkmcnt(6)
v_mfma_f32_32x32x16_bf16 v[72:87], a[128:131], v[8:11], v[72:87]
ds_read_b128 v[36:39], v5 offset:39936
s_waitcnt lgkmcnt(6)
v_mfma_f32_32x32x16_bf16 v[72:87], a[132:135], v[12:15], v[72:87]
ds_read_b128 v[8:11], v5 offset:40960
s_waitcnt vmcnt(0)
s_barrier
s_waitcnt lgkmcnt(6)
v_mfma_f32_32x32x16_bf16 v[72:87], a[136:139], v[16:19], v[72:87]
ds_read_b128 v[12:15], v5 offset:41984
s_cmp_lg_u32 s42, 0
s_cbranch_scc1 Lgdown_w_247
s_mov_b64 exec, 1
buffer_store_dword v4, v3, s[4:7], s59 offen sc1
s_mov_b64 exec, -1
Lgdown_w_247:
s_waitcnt lgkmcnt(6)
v_mfma_f32_32x32x16_bf16 v[72:87], a[140:143], v[20:23], v[72:87]
ds_read_b128 v[16:19], v5 offset:43008
s_waitcnt lgkmcnt(6)
v_mfma_f32_32x32x16_bf16 v[72:87], a[144:147], v[24:27], v[72:87]
ds_read_b128 v[20:23], v5 offset:44032
s_waitcnt lgkmcnt(6)
v_mfma_f32_32x32x16_bf16 v[72:87], a[148:151], v[28:31], v[72:87]
ds_read_b128 v[24:27], v5 offset:45056
s_waitcnt lgkmcnt(6)
v_mfma_f32_32x32x16_bf16 v[72:87], a[152:155], v[32:35], v[72:87]
ds_read_b128 v[28:31], v5 offset:46080
s_waitcnt lgkmcnt(6)
v_mfma_f32_32x32x16_bf16 v[72:87], a[156:159], v[36:39], v[72:87]
ds_read_b128 v[32:35], v5 offset:47104
s_waitcnt lgkmcnt(6)
v_mfma_f32_32x32x16_bf16 v[72:87], a[160:163], v[8:11], v[72:87]
ds_read_b128 v[36:39], v5 offset:48128
s_waitcnt lgkmcnt(6)
v_mfma_f32_32x32x16_bf16 v[72:87], a[164:167], v[12:15], v[72:87]
ds_read_b128 v[8:11], v5 offset:49152
s_waitcnt lgkmcnt(6)
v_mfma_f32_32x32x16_bf16 v[72:87], a[168:171], v[16:19], v[72:87]
ds_read_b128 v[12:15], v5 offset:50176
s_waitcnt lgkmcnt(6)
v_mfma_f32_32x32x16_bf16 v[72:87], a[172:175], v[20:23], v[72:87]
ds_read_b128 v[16:19], v5 offset:51200
s_waitcnt lgkmcnt(6)
v_mfma_f32_32x32x16_bf16 v[72:87], a[176:179], v[24:27], v[72:87]
ds_read_b128 v[20:23], v5 offset:52224
s_waitcnt lgkmcnt(6)
v_mfma_f32_32x32x16_bf16 v[72:87], a[180:183], v[28:31], v[72:87]
ds_read_b128 v[24:27], v5 offset:53248
s_waitcnt lgkmcnt(6)
v_mfma_f32_32x32x16_bf16 v[72:87], a[184:187], v[32:35], v[72:87]
ds_read_b128 v[28:31], v5 offset:54272
s_waitcnt lgkmcnt(6)
v_mfma_f32_32x32x16_bf16 v[72:87], a[188:191], v[36:39], v[72:87]
ds_read_b128 v[32:35], v5 offset:55296
s_waitcnt lgkmcnt(6)
v_mfma_f32_32x32x16_bf16 v[72:87], a[192:195], v[8:11], v[72:87]
ds_read_b128 v[36:39], v5 offset:56320
s_waitcnt lgkmcnt(6)
v_mfma_f32_32x32x16_bf16 v[72:87], a[196:199], v[12:15], v[72:87]
s_waitcnt lgkmcnt(5)
v_mfma_f32_32x32x16_bf16 v[72:87], a[200:203], v[16:19], v[72:87]
s_waitcnt lgkmcnt(4)
v_mfma_f32_32x32x16_bf16 v[72:87], a[204:207], v[20:23], v[72:87]
s_waitcnt lgkmcnt(3)
v_mfma_f32_32x32x16_bf16 v[72:87], a[208:211], v[24:27], v[72:87]
s_waitcnt lgkmcnt(2)
v_mfma_f32_32x32x16_bf16 v[72:87], a[212:215], v[28:31], v[72:87]
s_waitcnt lgkmcnt(1)
v_mfma_f32_32x32x16_bf16 v[72:87], a[216:219], v[32:35], v[72:87]
s_waitcnt lgkmcnt(0)
v_mfma_f32_32x32x16_bf16 v[72:87], a[220:223], v[36:39], v[72:87]
s_mov_b32 s64, s57
s_add_u32 s50, s46, 1
s_add_u32 s57, s57, s58
v_mov_b32 v4, s50
s_nop 7
v_cvt_pk_bf16_f32 v56, v72, v73
v_cvt_pk_bf16_f32 v57, v74, v75
v_cvt_pk_bf16_f32 v58, v76, v77
v_cvt_pk_bf16_f32 v59, v78, v79
buffer_store_dwordx4 v[56:59], v0, s[4:7], s64 offen sc1
s_add_u32 s64, s64, 4096
v_cvt_pk_bf16_f32 v60, v80, v81
v_cvt_pk_bf16_f32 v61, v82, v83
v_cvt_pk_bf16_f32 v62, v84, v85
v_cvt_pk_bf16_f32 v63, v86, v87
buffer_store_dwordx4 v[60:63], v0, s[4:7], s64 offen sc1
s_waitcnt vmcnt(0)
s_barrier
s_cmp_lg_u32 s42, 0
s_cbranch_scc1 Lgdown_w_248
s_mov_b64 exec, 1
buffer_store_dword v4, v3, s[4:7], s59 offen sc1
s_mov_b64 exec, -1
Lgdown_w_248:
s_branch Lend
Latt:
s_lshl_b32 s50, s45, 2
s_add_u32 s50, s50, s42
s_and_b32 s48, s50, 31
s_lshr_b32 s46, s50, 5
s_lshl_b32 s59, s46, 14
s_lshl_b32 s51, s48, 7
s_add_u32 s59, s59, s51
s_add_u32 s59, s59, s99
s_add_u32 s59, s59, 16384
s_lshl_b32 s60, s48, 8
s_add_u32 s60, s60, s99
s_mov_b32 s61, 133169152
s_sub_u32 s53, s8, s38
s_lshr_b32 s56, s48, 3
s_lshl_b32 s56, s56, 1
s_add_u32 s56, s56, 0
s_lshr_b32 s56, s98, s56
s_xor_b32 s56, s56, s48
s_and_b32 s56, s56, 2
s_lshl_b32 s56, s56, 12
s_lshl_b32 s51, s48, 20
s_add_u32 s56, s56, s51
s_add_u32 s56, s56, s53
s_add_u32 s56, s56, 33554432
s_lshr_b32 s62, s48, 3
s_lshl_b32 s62, s62, 1
s_add_u32 s62, s62, 8
s_lshr_b32 s62, s98, s62
s_xor_b32 s62, s62, s48
s_and_b32 s62, s62, 2
s_lshl_b32 s62, s62, 12
s_lshl_b32 s51, s48, 20
s_add_u32 s62, s62, s51
s_add_u32 s62, s62, s53
s_add_u32 s62, s62, 67108864
s_lshr_b32 s65, s48, 2
s_lshl_b32 s65, s65, 16
s_xor_b32 s65, s65, s98
s_lshr_b32 s65, s65, 16
s_and_b32 s65, s65, 2
s_lshl_b32 s65, s65, 12
s_lshl_b32 s51, s48, 18
s_add_u32 s65, s65, s51
s_add_u32 s65, s65, s53
s_add_u32 s65, s65, 100663296
s_lshr_b32 s64, s48, 2
s_lshl_b32 s64, s64, 18
s_xor_b32 s64, s64, s98
s_lshr_b32 s64, s64, 18
s_and_b32 s64, s64, 2
s_lshl_b32 s64, s64, 12
s_lshl_b32 s51, s48, 18
s_add_u32 s64, s64, s51
s_add_u32 s64, s64, s53
s_add_u32 s64, s64, 109051904
s_mov_b32 s98, 0x3fb8aa3b
s_mov_b32 s99, s98
s_mov_b32 s100, 0x3db504f3
s_mov_b32 s101, s100
v_lshrrev_b32 v10, 4, v0
v_lshrrev_b32 v11, 5, v10
v_and_b32 v12, 7, v10
v_lshlrev_b32 v5, 4, v12
v_lshl_add_u32 v5, v11, 7, v5
v_and_b32 v12, 15, v10
v_lshlrev_b32 v6, 2, v12
v_bfe_u32 v12, v10, 4, 1
v_lshl_add_u32 v6, v12, 10, v6
v_lshl_add_u32 v6, v11, 6, v6
v_and_b32 v12, 31, v10
v_lshlrev_b32 v11, 2, v11
v_sub_u32 v12, v12, v11
v_and_b32 v13, 1, v10
v_lshlrev_b32 v7, 7, v13
s_lshl_b32 s51, s50, 8
s_lshl_b32 s52, s48, 7
s_add_u32 s52, s52, 24576
v_add_u32 v14, s51, v7
v_mov_b32 v13, s52
v_cmp_gt_u32 vcc, 16, v10
s_nop 1
v_cndmask_b32 v14, v14, v13, vcc
v_mov_b32 v15, 0xf149f2ca
v_cmp_le_i32 s[66:67], 0, v12
v_cmp_le_i32 s[68:69], 1, v12
v_cmp_le_i32 s[70:71], 2, v12
v_cmp_le_i32 s[72:73], 3, v12
v_cmp_le_i32 s[74:75], 8, v12
v_cmp_le_i32 s[76:77], 9, v12
v_cmp_le_i32 s[78:79], 10, v12
v_cmp_le_i32 s[80:81], 11, v12
v_cmp_le_i32 s[82:83], 16, v12
v_cmp_le_i32 s[84:85], 17, v12
v_cmp_le_i32 s[86:87], 18, v12
v_cmp_le_i32 s[88:89], 19, v12
v_cmp_le_i32 s[90:91], 24, v12
v_cmp_le_i32 s[92:93], 25, v12
v_cmp_le_i32 s[94:95], 26, v12
v_cmp_le_i32 s[96:97], 27, v12
v_mov_b32 v146, 0
v_mov_b32 v147, 0
v_mov_b32 v150, 0
v_mov_b32 v151, 0
v_mov_b32 v154, 0
v_mov_b32 v155, 0
v_mov_b32 v158, 0
v_mov_b32 v159, 0
v_mov_b32 v202, 0
v_mov_b32 v203, 0
Latt_top:
s_add_u32 s63, s46, 1
v_mov_b32 v1, v14
s_sub_u32 s50, s63, 1
Latt_s1:
buffer_load_dword v2, v1, s[4:7], s61 offen sc1
s_waitcnt vmcnt(0)
v_cmp_gt_i32 vcc, s63, v2
s_cbranch_vccz Latt_s1d
v_cmp_gt_i32 vcc, s50, v2
s_sleep 1
s_cbranch_vccz Latt_s1n
s_sleep 12
Latt_s1n:
s_sub_u32 s43, s43, 1
s_cbranch_scc0 Latt_s1
s_mov_b32 s43, 0
Latt_s1d:
s_lshl_b32 s50, s48, 6
s_add_u32 s50, s50, s46
s_lshl_b32 s51, s50, 13
s_lshl_b32 s54, s46, 14
s_add_u32 s53, s54, s56
s_add_u32 s54, s54, s62
s_lshr_b32 s49, s46, 2
s_lshl_b32 s49, s49, 14
s_and_b32 s50, s46, 3
s_lshl_b32 s50, s50, 11
s_add_u32 s49, s49, s50
s_add_u32 s52, s51, 4194304
buffer_load_dwordx4 v[16:19], v0, s[4:7], s52 offen offset:0 sc1
buffer_load_dwordx4 v[20:23], v0, s[4:7], s52 offen offset:1024 sc1
buffer_load_dwordx4 v[24:27], v0, s[4:7], s52 offen offset:2048 sc1
buffer_load_dwordx4 v[28:31], v0, s[4:7], s52 offen offset:3072 sc1
s_add_u32 s52, s51, 4198400
buffer_load_dwordx4 v[32:35], v0, s[4:7], s52 offen offset:0 sc1
buffer_load_dwordx4 v[36:39], v0, s[4:7], s52 offen offset:1024 sc1
buffer_load_dwordx4 v[40:43], v0, s[4:7], s52 offen offset:2048 sc1
buffer_load_dwordx4 v[44:47], v0, s[4:7], s52 offen offset:3072 sc1
s_add_u32 s52, s53, 0
buffer_load_dwordx4 v[48:51], v0, s[4:7], s52 offen offset:0 sc1
buffer_load_dwordx4 v[52:55], v0, s[4:7], s52 offen offset:1024 sc1
buffer_load_dwordx4 v[56:59], v0, s[4:7], s52 offen offset:2048 sc1
buffer_load_dwordx4 v[60:63], v0, s[4:7], s52 offen offset:3072 sc1
s_add_u32 s52, s53, 4096
buffer_load_dwordx4 v[64:67], v0, s[4:7], s52 offen offset:0 sc1
buffer_load_dwordx4 v[68:71], v0, s[4:7], s52 offen offset:1024 sc1
buffer_load_dwordx4 v[72:75], v0, s[4:7], s52 offen offset:2048 sc1
buffer_load_dwordx4 v[76:79], v0, s[4:7], s52 offen offset:3072 sc1
s_add_u32 s52, s54, 0
buffer_load_dwordx4 v[80:83], v0, s[4:7], s52 offen offset:0 sc1
buffer_load_dwordx4 v[84:87], v0, s[4:7], s52 offen offset:1024 sc1
buffer_load_dwordx4 v[88:91], v0, s[4:7], s52 offen offset:2048 sc1
buffer_load_dwordx4 v[92:95], v0, s[4:7], s52 offen offset:3072 sc1
s_add_u32 s52, s54, 4096
buffer_load_dwordx4 v[96:99], v0, s[4:7], s52 offen offset:0 sc1
buffer_load_dwordx4 v[100:103], v0, s[4:7], s52 offen offset:1024 sc1
buffer_load_dwordx4 v[104:107], v0, s[4:7], s52 offen offset:2048 sc1
buffer_load_dwordx4 v[108:111], v0, s[4:7], s52 offen offset:3072 sc1
s_waitcnt vmcnt(15)
v_mfma_f32_32x32x16_bf16 v[160:175], v[48:51], v[16:19], 0
s_waitcnt vmcnt(14)
v_mfma_f32_32x32x16_bf16 v[160:175], v[52:55], v[20:23], v[160:175]
s_waitcnt vmcnt(13)
v_mfma_f32_32x32x16_bf16 v[160:175], v[56:59], v[24:27], v[160:175]
s_waitcnt vmcnt(12)
v_mfma_f32_32x32x16_bf16 v[160:175], v[60:63], v[28:31], v[160:175]
s_waitcnt vmcnt(11)
v_mfma_f32_32x32x16_bf16 v[160:175], v[64:67], v[32:35], v[160:175]
s_waitcnt vmcnt(10)
v_mfma_f32_32x32x16_bf16 v[160:175], v[68:71], v[36:39], v[160:175]
s_waitcnt vmcnt(9)
v_mfma_f32_32x32x16_bf16 v[160:175], v[72:75], v[40:43], v[160:175]
s_waitcnt vmcnt(8)
v_mfma_f32_32x32x16_bf16 v[160:175], v[76:79], v[44:47], v[160:175]
s_nop 11
v_cvt_pk_bf16_f32 v160, v160, v161
v_cvt_pk_bf16_f32 v162, v162, v163
v_cvt_pk_bf16_f32 v164, v164, v165
v_cvt_pk_bf16_f32 v166, v166, v167
v_cvt_pk_bf16_f32 v168, v168, v169
v_cvt_pk_bf16_f32 v170, v170, v171
v_cvt_pk_bf16_f32 v172, v172, v173
v_cvt_pk_bf16_f32 v174, v174, v175
v_and_b32 v161, 0xffff0000, v160
v_lshlrev_b32 v160, 16, v160
v_and_b32 v163, 0xffff0000, v162
v_lshlrev_b32 v162, 16, v162
v_and_b32 v165, 0xffff0000, v164
v_lshlrev_b32 v164, 16, v164
v_and_b32 v167, 0xffff0000, v166
v_lshlrev_b32 v166, 16, v166
v_and_b32 v169, 0xffff0000, v168
v_lshlrev_b32 v168, 16, v168
v_and_b32 v171, 0xffff0000, v170
v_lshlrev_b32 v170, 16, v170
v_and_b32 v173, 0xffff0000, v172
v_lshlrev_b32 v172, 16, v172
v_and_b32 v175, 0xffff0000, v174
v_lshlrev_b32 v174, 16, v174
v_pk_mul_f32 v[160:161], v[160:161], s[100:101]
v_pk_mul_f32 v[162:163], v[162:163], s[100:101]
v_pk_mul_f32 v[164:165], v[164:165], s[100:101]
v_pk_mul_f32 v[166:167], v[166:167], s[100:101]
v_pk_mul_f32 v[168:169], v[168:169], s[100:101]
v_pk_mul_f32 v[170:171], v[170:171], s[100:101]
v_pk_mul_f32 v[172:173], v[172:173], s[100:101]
v_pk_mul_f32 v[174:175], v[174:175], s[100:101]
v_cvt_pk_bf16_f32 v160, v160, v161
v_cvt_pk_bf16_f32 v162, v162, v163
v_cvt_pk_bf16_f32 v164, v164, v165
v_cvt_pk_bf16_f32 v166, v166, v167
v_cvt_pk_bf16_f32 v168, v168, v169
v_cvt_pk_bf16_f32 v170, v170, v171
v_cvt_pk_bf16_f32 v172, v172, v173
v_cvt_pk_bf16_f32 v174, v174, v175
v_and_b32 v161, 0xffff0000, v160
v_lshlrev_b32 v160, 16, v160
v_and_b32 v163, 0xffff0000, v162
v_lshlrev_b32 v162, 16, v162
v_and_b32 v165, 0xffff0000, v164
v_lshlrev_b32 v164, 16, v164
v_and_b32 v167, 0xffff0000, v166
v_lshlrev_b32 v166, 16, v166
v_and_b32 v169, 0xffff0000, v168
v_lshlrev_b32 v168, 16, v168
v_and_b32 v171, 0xffff0000, v170
v_lshlrev_b32 v170, 16, v170
v_and_b32 v173, 0xffff0000, v172
v_lshlrev_b32 v172, 16, v172
v_and_b32 v175, 0xffff0000, v174
v_lshlrev_b32 v174, 16, v174
v_cndmask_b32 v160, v15, v160, s[66:67]
v_cndmask_b32 v161, v15, v161, s[68:69]
v_cndmask_b32 v162, v15, v162, s[70:71]
v_cndmask_b32 v163, v15, v163, s[72:73]
v_cndmask_b32 v164, v15, v164, s[74:75]
v_cndmask_b32 v165, v15, v165, s[76:77]
v_cndmask_b32 v166, v15, v166, s[78:79]
v_cndmask_b32 v167, v15, v167, s[80:81]
v_cndmask_b32 v168, v15, v168, s[82:83]
v_cndmask_b32 v169, v15, v169, s[84:85]
v_cndmask_b32 v170, v15, v170, s[86:87]
v_cndmask_b32 v171, v15, v171, s[88:89]
v_cndmask_b32 v172, v15, v172, s[90:91]
v_cndmask_b32 v173, v15, v173, s[92:93]
v_cndmask_b32 v174, v15, v174, s[94:95]
v_cndmask_b32 v175, v15, v175, s[96:97]
v_max3_f32 v204, v160, v161, v162
v_max3_f32 v204, v163, v164, v204
v_max3_f32 v204, v165, v166, v204
v_max3_f32 v204, v167, v168, v204
v_max3_f32 v204, v169, v170, v204
v_max3_f32 v204, v171, v172, v204
v_max3_f32 v204, v173, v174, v204
v_max_f32 v204, v175, v204
v_mov_b32 v9, v204
s_nop 1
v_permlane32_swap_b32 v204, v9
v_max_f32 v204, v204, v9
v_mul_f32 v204, s98, v204
v_pk_fma_f32 v[160:161], v[160:161], s[98:99], v[204:205] op_sel_hi:[1,1,0] neg_lo:[0,0,1] neg_hi:[0,0,1]
v_pk_fma_f32 v[162:163], v[162:163], s[98:99], v[204:205] op_sel_hi:[1,1,0] neg_lo:[0,0,1] neg_hi:[0,0,1]
v_pk_fma_f32 v[168:169], v[168:169], s[98:99], v[204:205] op_sel_hi:[1,1,0] neg_lo:[0,0,1] neg_hi:[0,0,1]
v_pk_fma_f32 v[170:171], v[170:171], s[98:99], v[204:205] op_sel_hi:[1,1,0] neg_lo:[0,0,1] neg_hi:[0,0,1]
v_pk_fma_f32 v[164:165], v[164:165], s[98:99], v[204:205] op_sel_hi:[1,1,0] neg_lo:[0,0,1] neg_hi:[0,0,1]
v_pk_fma_f32 v[166:167], v[166:167], s[98:99], v[204:205] op_sel_hi:[1,1,0] neg_lo:[0,0,1] neg_hi:[0,0,1]
v_pk_fma_f32 v[172:173], v[172:173], s[98:99], v[204:205] op_sel_hi:[1,1,0] neg_lo:[0,0,1] neg_hi:[0,0,1]
v_pk_fma_f32 v[174:175], v[174:175], s[98:99], v[204:205] op_sel_hi:[1,1,0] neg_lo:[0,0,1] neg_hi:[0,0,1]
v_exp_f32 v160, v160
v_exp_f32 v161, v161
v_exp_f32 v162, v162
v_exp_f32 v163, v163
v_exp_f32 v168, v168
v_exp_f32 v169, v169
v_exp_f32 v170, v170
v_exp_f32 v171, v171
v_exp_f32 v164, v164
v_exp_f32 v165, v165
v_exp_f32 v166, v166
v_exp_f32 v167, v167
v_exp_f32 v172, v172
v_exp_f32 v173, v173
v_exp_f32 v174, v174
v_exp_f32 v175, v175
v_cvt_pk_bf16_f32 v192, v160, v161
v_cvt_pk_bf16_f32 v193, v162, v163
v_cvt_pk_bf16_f32 v194, v168, v169
v_cvt_pk_bf16_f32 v195, v170, v171
v_cvt_pk_bf16_f32 v196, v164, v165
v_cvt_pk_bf16_f32 v197, v166, v167
v_cvt_pk_bf16_f32 v198, v172, v173
v_cvt_pk_bf16_f32 v199, v174, v175
s_waitcnt vmcnt(0)
v_mfma_f32_32x32x16_bf16 v[208:223], v[80:83], v[192:195], 0
v_mfma_f32_32x32x16_bf16 v[208:223], v[84:87], v[196:199], v[208:223]
v_mfma_f32_32x32x16_bf16 v[224:239], v[88:91], v[192:195], 0
v_mfma_f32_32x32x16_bf16 v[224:239], v[92:95], v[196:199], v[224:239]
v_mfma_f32_32x32x16_bf16 v[240:255], v[96:99], v[192:195], 0
v_mfma_f32_32x32x16_bf16 v[240:255], v[100:103], v[196:199], v[240:255]
v_mfma_f32_32x32x16_bf16 v[48:63], v[104:107], v[192:195], 0
v_mfma_f32_32x32x16_bf16 v[48:63], v[108:111], v[196:199], v[48:63]
v_pk_add_f32 v[160:161], v[160:161], v[162:163]
v_pk_add_f32 v[160:161], v[160:161], v[168:169]
v_pk_add_f32 v[160:161], v[160:161], v[170:171]
v_pk_add_f32 v[160:161], v[160:161], v[164:165]
v_pk_add_f32 v[160:161], v[160:161], v[166:167]
v_pk_add_f32 v[160:161], v[160:161], v[172:173]
v_pk_add_f32 v[160:161], v[160:161], v[174:175]
v_add_f32 v206, v160, v161
s_lshl_b32 s57, s46, 18
s_lshl_b32 s51, s48, 13
s_add_u32 s57, s57, s51
s_add_u32 s57, s57, 62914560
s_add_u32 s58, s57, 4096
v_mov_b32 v4, s63
v_mov_b32 v1, v7
s_sub_u32 s50, s63, 1
Latt_s2:
buffer_load_dword v2, v1, s[4:7], s60 offen sc1
s_waitcnt vmcnt(0)
v_cmp_gt_i32 vcc, s63, v2
s_cbranch_vccz Latt_s2d
v_cmp_gt_i32 vcc, s50, v2
s_sleep 1
s_cbranch_vccz Latt_s2n
s_sleep 12
Latt_s2n:
s_sub_u32 s43, s43, 1
s_cbranch_scc0 Latt_s2
s_mov_b32 s43, 0
Latt_s2d:
s_add_u32 s52, s49, s65
s_add_u32 s53, s49, s64
buffer_load_dwordx4 v[112:115], v5, s[4:7], s52 offen offset:0 sc1
buffer_load_dwordx4 v[116:119], v5, s[4:7], s52 offen offset:256 sc1
buffer_load_dwordx4 v[120:123], v5, s[4:7], s52 offen offset:512 sc1
buffer_load_dwordx4 v[124:127], v5, s[4:7], s52 offen offset:768 sc1
buffer_load_dwordx4 v[128:131], v5, s[4:7], s52 offen offset:1024 sc1
buffer_load_dwordx4 v[132:135], v5, s[4:7], s52 offen offset:1280 sc1
buffer_load_dwordx4 v[136:139], v5, s[4:7], s52 offen offset:1536 sc1
buffer_load_dwordx4 v[140:143], v5, s[4:7], s52 offen offset:1792 sc1
buffer_load_dword v144, v6, s[4:7], s53 offen offset:0 sc1
buffer_load_dword v145, v6, s[4:7], s53 offen offset:128 sc1
buffer_load_dword v148, v6, s[4:7], s53 offen offset:256 sc1
buffer_load_dword v149, v6, s[4:7], s53 offen offset:384 sc1
buffer_load_dword v152, v6, s[4:7], s53 offen offset:512 sc1
buffer_load_dword v153, v6, s[4:7], s53 offen offset:640 sc1
buffer_load_dword v156, v6, s[4:7], s53 offen offset:768 sc1
buffer_load_dword v157, v6, s[4:7], s53 offen offset:896 sc1
s_waitcnt vmcnt(15)
v_mfma_f32_32x32x16_bf16 v[176:191], v[112:115], v[16:19], 0
s_waitcnt vmcnt(14)
v_mfma_f32_32x32x16_bf16 v[176:191], v[116:119], v[20:23], v[176:191]
s_waitcnt vmcnt(13)
v_mfma_f32_32x32x16_bf16 v[176:191], v[120:123], v[24:27], v[176:191]
s_waitcnt vmcnt(12)
v_mfma_f32_32x32x16_bf16 v[176:191], v[124:127], v[28:31], v[176:191]
s_waitcnt vmcnt(11)
v_mfma_f32_32x32x16_bf16 v[176:191], v[128:131], v[32:35], v[176:191]
s_waitcnt vmcnt(10)
v_mfma_f32_32x32x16_bf16 v[176:191], v[132:135], v[36:39], v[176:191]
s_waitcnt vmcnt(9)
v_mfma_f32_32x32x16_bf16 v[176:191], v[136:139], v[40:43], v[176:191]
s_waitcnt vmcnt(8)
v_mfma_f32_32x32x16_bf16 v[176:191], v[140:143], v[44:47], v[176:191]
s_nop 11
v_cvt_pk_bf16_f32 v176, v176, v177
v_cvt_pk_bf16_f32 v178, v178, v179
v_and_b32 v177, 0xffff0000, v176
v_lshlrev_b32 v176, 16, v176
v_and_b32 v179, 0xffff0000, v178
v_lshlrev_b32 v178, 16, v178
v_pk_mul_f32 v[176:177], v[176:177], s[100:101]
v_pk_mul_f32 v[178:179], v[178:179], s[100:101]
v_cvt_pk_bf16_f32 v176, v176, v177
v_cvt_pk_bf16_f32 v178, v178, v179
v_and_b32 v177, 0xffff0000, v176
v_lshlrev_b32 v176, 16, v176
v_and_b32 v179, 0xffff0000, v178
v_lshlrev_b32 v178, 16, v178
v_max3_f32 v8, v176, v177, v178
v_max_f32 v8, v179, v8
v_mov_b32 v9, v8
s_nop 1
v_permlane32_swap_b32 v8, v9
v_max_f32 v8, v8, v9
v_mul_f32 v8, s98, v8
v_max_f32 v8, v8, v204
v_sub_f32 v12, v204, v8
v_pk_fma_f32 v[176:177], v[176:177], s[98:99], v[8:9] op_sel_hi:[1,1,0] neg_lo:[0,0,1] neg_hi:[0,0,1]
v_pk_fma_f32 v[178:179], v[178:179], s[98:99], v[8:9] op_sel_hi:[1,1,0] neg_lo:[0,0,1] neg_hi:[0,0,1]
v_exp_f32 v12, v12
v_exp_f32 v176, v176
v_exp_f32 v177, v177
v_exp_f32 v178, v178
v_exp_f32 v179, v179
v_mul_f32 v206, v206, v12
v_pk_add_f32 v[180:181], v[176:177], v[178:179]
v_add_f32 v206, v206, v180
v_add_f32 v8, v206, v181
v_mov_b32 v9, v8
s_nop 1
v_permlane32_swap_b32 v8, v9
v_add_f32 v8, v8, v9
v_rcp_f32 v8, v8
s_waitcnt vmcnt(0)
v_mul_f32 v12, v12, v8
v_pk_mul_f32 v[176:177], v[176:177], v[8:9] op_sel_hi:[1,0]
v_pk_mul_f32 v[178:179], v[178:179], v[8:9] op_sel_hi:[1,0]
v_cvt_pk_bf16_f32 v200, v176, v177
v_cvt_pk_bf16_f32 v201, v178, v179
v_pk_mul_f32 v[208:209], v[208:209], v[12:13] op_sel_hi:[1,0]
v_pk_mul_f32 v[210:211], v[210:211], v[12:13] op_sel_hi:[1,0]
v_pk_mul_f32 v[212:213], v[212:213], v[12:13] op_sel_hi:[1,0]
v_pk_mul_f32 v[214:215], v[214:215], v[12:13] op_sel_hi:[1,0]
v_pk_mul_f32 v[216:217], v[216:217], v[12:13] op_sel_hi:[1,0]
v_pk_mul_f32 v[218:219], v[218:219], v[12:13] op_sel_hi:[1,0]
v_pk_mul_f32 v[220:221], v[220:221], v[12:13] op_sel_hi:[1,0]
v_pk_mul_f32 v[222:223], v[222:223], v[12:13] op_sel_hi:[1,0]
s_nop 1
v_mfma_f32_32x32x16_bf16 v[208:223], v[144:147], v[200:203], v[208:223]
v_pk_mul_f32 v[224:225], v[224:225], v[12:13] op_sel_hi:[1,0]
v_pk_mul_f32 v[226:227], v[226:227], v[12:13] op_sel_hi:[1,0]
v_pk_mul_f32 v[228:229], v[228:229], v[12:13] op_sel_hi:[1,0]
v_pk_mul_f32 v[230:231], v[230:231], v[12:13] op_sel_hi:[1,0]
v_pk_mul_f32 v[232:233], v[232:233], v[12:13] op_sel_hi:[1,0]
v_pk_mul_f32 v[234:235], v[234:235], v[12:13] op_sel_hi:[1,0]
v_pk_mul_f32 v[236:237], v[236:237], v[12:13] op_sel_hi:[1,0]
v_pk_mul_f32 v[238:239], v[238:239], v[12:13] op_sel_hi:[1,0]
s_nop 1
v_mfma_f32_32x32x16_bf16 v[224:239], v[148:151], v[200:203], v[224:239]
v_pk_mul_f32 v[240:241], v[240:241], v[12:13] op_sel_hi:[1,0]
v_pk_mul_f32 v[242:243], v[242:243], v[12:13] op_sel_hi:[1,0]
v_pk_mul_f32 v[244:245], v[244:245], v[12:13] op_sel_hi:[1,0]
v_pk_mul_f32 v[246:247], v[246:247], v[12:13] op_sel_hi:[1,0]
v_pk_mul_f32 v[248:249], v[248:249], v[12:13] op_sel_hi:[1,0]
v_pk_mul_f32 v[250:251], v[250:251], v[12:13] op_sel_hi:[1,0]
v_pk_mul_f32 v[252:253], v[252:253], v[12:13] op_sel_hi:[1,0]
v_pk_mul_f32 v[254:255], v[254:255], v[12:13] op_sel_hi:[1,0]
v_cvt_pk_bf16_f32 v16, v208, v209
v_cvt_pk_bf16_f32 v17, v210, v211
v_cvt_pk_bf16_f32 v18, v212, v213
v_cvt_pk_bf16_f32 v19, v214, v215
v_cvt_pk_bf16_f32 v20, v216, v217
v_cvt_pk_bf16_f32 v21, v218, v219
v_cvt_pk_bf16_f32 v22, v220, v221
v_cvt_pk_bf16_f32 v23, v222, v223
buffer_store_dwordx4 v[16:19], v0, s[4:7], s57 offen offset:0 sc1
buffer_store_dwordx4 v[20:23], v0, s[4:7], s58 offen offset:0 sc1
v_mfma_f32_32x32x16_bf16 v[240:255], v[152:155], v[200:203], v[240:255]
v_pk_mul_f32 v[48:49], v[48:49], v[12:13] op_sel_hi:[1,0]
v_pk_mul_f32 v[50:51], v[50:51], v[12:13] op_sel_hi:[1,0]
v_pk_mul_f32 v[52:53], v[52:53], v[12:13] op_sel_hi:[1,0]
v_pk_mul_f32 v[54:55], v[54:55], v[12:13] op_sel_hi:[1,0]
v_pk_mul_f32 v[56:57], v[56:57], v[12:13] op_sel_hi:[1,0]
v_pk_mul_f32 v[58:59], v[58:59], v[12:13] op_sel_hi:[1,0]
v_pk_mul_f32 v[60:61], v[60:61], v[12:13] op_sel_hi:[1,0]
v_pk_mul_f32 v[62:63], v[62:63], v[12:13] op_sel_hi:[1,0]
v_cvt_pk_bf16_f32 v24, v224, v225
v_cvt_pk_bf16_f32 v25, v226, v227
v_cvt_pk_bf16_f32 v26, v228, v229
v_cvt_pk_bf16_f32 v27, v230, v231
v_cvt_pk_bf16_f32 v28, v232, v233
v_cvt_pk_bf16_f32 v29, v234, v235
v_cvt_pk_bf16_f32 v30, v236, v237
v_cvt_pk_bf16_f32 v31, v238, v239
buffer_store_dwordx4 v[24:27], v0, s[4:7], s57 offen offset:1024 sc1
buffer_store_dwordx4 v[28:31], v0, s[4:7], s58 offen offset:1024 sc1
v_mfma_f32_32x32x16_bf16 v[48:63], v[156:159], v[200:203], v[48:63]
v_cvt_pk_bf16_f32 v32, v240, v241
v_cvt_pk_bf16_f32 v33, v242, v243
v_cvt_pk_bf16_f32 v34, v244, v245
v_cvt_pk_bf16_f32 v35, v246, v247
v_cvt_pk_bf16_f32 v36, v248, v249
v_cvt_pk_bf16_f32 v37, v250, v251
v_cvt_pk_bf16_f32 v38, v252, v253
v_cvt_pk_bf16_f32 v39, v254, v255
buffer_store_dwordx4 v[32:35], v0, s[4:7], s57 offen offset:2048 sc1
buffer_store_dwordx4 v[36:39], v0, s[4:7], s58 offen offset:2048 sc1
s_nop 1
v_cvt_pk_bf16_f32 v40, v48, v49
v_cvt_pk_bf16_f32 v41, v50, v51
v_cvt_pk_bf16_f32 v42, v52, v53
v_cvt_pk_bf16_f32 v43, v54, v55
v_cvt_pk_bf16_f32 v44, v56, v57
v_cvt_pk_bf16_f32 v45, v58, v59
v_cvt_pk_bf16_f32 v46, v60, v61
v_cvt_pk_bf16_f32 v47, v62, v63
buffer_store_dwordx4 v[40:43], v0, s[4:7], s57 offen offset:3072 sc1
buffer_store_dwordx4 v[44:47], v0, s[4:7], s58 offen offset:3072 sc1
s_add_u32 s46, s46, 3
s_waitcnt vmcnt(0)
s_mov_b64 exec, 1
buffer_store_dword v4, v3, s[4:7], s59 offen sc1
s_mov_b64 exec, -1
s_cmp_lt_u32 s46, 64
s_cbranch_scc1 Latt_top
s_branch Lend
Lred1:
s_and_b32 s48, s45, 3
s_lshr_b32 s46, s45, 2
s_lshl_b32 s59, s45, 7
s_add_u32 s59, s59, s99
s_add_u32 s59, s59, 69632
s_add_u32 s69, s99, 65536
s_add_u32 s61, s99, 102400
s_mov_b32 s70, 0x3f80
s_mov_b32 s71, 0x3f800000
v_lshrrev_b32 v10, 4, v0
v_and_b32 v1, 31, v10
v_lshlrev_b32 v1, 7, v1
v_lshrrev_b32 v11, 4, v10
v_lshlrev_b32 v5, 10, v11
v_bfe_u32 v12, v10, 3, 1
v_lshl_add_u32 v5, v12, 9, v5
v_and_b32 v13, 7, v10
v_lshl_add_u32 v5, v13, 4, v5
s_lshl_b32 s50, s42, 14
s_lshl_b32 s51, s48, 7
s_add_u32 s50, s50, s51
v_add_u32 v5, s50, v5
v_lshlrev_b32 v6, 11, v13
v_lshrrev_b32 v11, 3, v10
v_lshl_add_u32 v6, v11, 4, v6
s_lshl_b32 s50, s42, 9
s_lshl_b32 s51, s48, 14
s_add_u32 s50, s50, s51
v_add_u32 v6, s50, v6
v_and_b32 v15, 7, v10
v_lshlrev_b32 v15, 4, v15
s_lshl_b32 s50, s42, 2
v_add_u32 v14, s50, v15
s_cmp_eq_u32 s79, 4
s_cselect_b32 s46, 63, s46
s_cselect_b32 s50, 512, 0
s_add_u32 s59, s59, s50
s_mov_b32 s12, s16
s_mov_b32 s13, s17
s_mov_b32 s14, 4194304
s_mov_b32 s15, 0x20000
Lred1_top:
s_add_u32 s63, s46, 1
s_lshl_b32 s49, s46, 16
buffer_load_dwordx4 v[80:83], v6, s[12:15], s49 offen offset:0
buffer_load_dwordx4 v[84:87], v6, s[12:15], s49 offen offset:128
buffer_load_dwordx4 v[88:91], v6, s[12:15], s49 offen offset:256
buffer_load_dwordx4 v[92:95], v6, s[12:15], s49 offen offset:384
s_cmp_lg_u32 s42, 0
s_cbranch_scc1 Lred1_spb
s_sub_u32 s50, s63, 1
Lred1_sp:
buffer_load_dword v2, v1, s[4:7], s69 offen sc1
s_waitcnt vmcnt(0)
v_cmp_gt_i32 vcc, s63, v2
s_cbranch_vccz Lred1_spd
v_cmp_gt_i32 vcc, s50, v2
s_sleep 1
s_cbranch_vccz Lred1_spn
s_sleep 12
Lred1_spn:
s_sub_u32 s43, s43, 1
s_cbranch_scc0 Lred1_sp
s_mov_b32 s43, 0
Lred1_spd:
Lred1_spb:
s_barrier
s_lshl_b32 s50, s46, 18
s_add_u32 s50, s50, 79691776
s_add_u32 s51, s50, 0
buffer_load_dwordx4 v[16:19], v5, s[4:7], s51 offen sc1
s_add_u32 s51, s50, 65536
buffer_load_dwordx4 v[20:23], v5, s[4:7], s51 offen sc1
s_add_u32 s51, s50, 131072
buffer_load_dwordx4 v[24:27], v5, s[4:7], s51 offen sc1
s_add_u32 s51, s50, 196608
buffer_load_dwordx4 v[28:31], v5, s[4:7], s51 offen sc1
s_add_u32 s51, s50, 4096
buffer_load_dwordx4 v[32:35], v5, s[4:7], s51 offen sc1
s_add_u32 s51, s50, 69632
buffer_load_dwordx4 v[36:39], v5, s[4:7], s51 offen sc1
s_add_u32 s51, s50, 135168
buffer_load_dwordx4 v[40:43], v5, s[4:7], s51 offen sc1
s_add_u32 s51, s50, 200704
buffer_load_dwordx4 v[44:47], v5, s[4:7], s51 offen sc1
s_add_u32 s51, s50, 8192
buffer_load_dwordx4 v[48:51], v5, s[4:7], s51 offen sc1
s_add_u32 s51, s50, 73728
buffer_load_dwordx4 v[52:55], v5, s[4:7], s51 offen sc1
s_add_u32 s51, s50, 139264
buffer_load_dwordx4 v[56:59], v5, s[4:7], s51 offen sc1
s_add_u32 s51, s50, 204800
buffer_load_dwordx4 v[60:63], v5, s[4:7], s51 offen sc1
s_add_u32 s51, s50, 12288
buffer_load_dwordx4 v[64:67], v5, s[4:7], s51 offen sc1
s_add_u32 s51, s50, 77824
buffer_load_dwordx4 v[68:71], v5, s[4:7], s51 offen sc1
s_add_u32 s51, s50, 143360
buffer_load_dwordx4 v[72:75], v5, s[4:7], s51 offen sc1
s_add_u32 s51, s50, 208896
buffer_load_dwordx4 v[76:79], v5, s[4:7], s51 offen sc1
s_waitcnt vmcnt(16)
v_mov_b32 v10, v82
v_mov_b32 v11, v83
v_mov_b32_dpp v82, v80 row_ror:8 row_mask:0xf bank_mask:0x3
v_mov_b32_dpp v83, v81 row_ror:8 row_mask:0xf bank_mask:0x3
v_mov_b32_dpp v80, v10 row_ror:8 row_mask:0xf bank_mask:0xc
v_mov_b32_dpp v81, v11 row_ror:8 row_mask:0xf bank_mask:0xc
v_lshlrev_b32 v96, 16, v80
v_and_b32 v97, 0xffff0000, v80
v_lshlrev_b32 v98, 16, v81
v_and_b32 v99, 0xffff0000, v81
v_lshlrev_b32 v100, 16, v82
v_and_b32 v101, 0xffff0000, v82
v_lshlrev_b32 v102, 16, v83
v_and_b32 v103, 0xffff0000, v83
v_mov_b32 v10, v86
v_mov_b32 v11, v87
v_mov_b32_dpp v86, v84 row_ror:8 row_mask:0xf bank_mask:0x3
v_mov_b32_dpp v87, v85 row_ror:8 row_mask:0xf bank_mask:0x3
v_mov_b32_dpp v84, v10 row_ror:8 row_mask:0xf bank_mask:0xc
v_mov_b32_dpp v85, v11 row_ror:8 row_mask:0xf bank_mask:0xc
v_lshlrev_b32 v104, 16, v84
v_and_b32 v105, 0xffff0000, v84
v_lshlrev_b32 v106, 16, v85
v_and_b32 v107, 0xffff0000, v85
v_lshlrev_b32 v108, 16, v86
v_and_b32 v109, 0xffff0000, v86
v_lshlrev_b32 v110, 16, v87
v_and_b32 v111, 0xffff0000, v87
v_mov_b32 v10, v90
v_mov_b32 v11, v91
v_mov_b32_dpp v90, v88 row_ror:8 row_mask:0xf bank_mask:0x3
v_mov_b32_dpp v91, v89 row_ror:8 row_mask:0xf bank_mask:0x3
v_mov_b32_dpp v88, v10 row_ror:8 row_mask:0xf bank_mask:0xc
v_mov_b32_dpp v89, v11 row_ror:8 row_mask:0xf bank_mask:0xc
v_lshlrev_b32 v112, 16, v88
v_and_b32 v113, 0xffff0000, v88
v_lshlrev_b32 v114, 16, v89
v_and_b32 v115, 0xffff0000, v89
v_lshlrev_b32 v116, 16, v90
v_and_b32 v117, 0xffff0000, v90
v_lshlrev_b32 v118, 16, v91
v_and_b32 v119, 0xffff0000, v91
v_mov_b32 v10, v94
v_mov_b32 v11, v95
v_mov_b32_dpp v94, v92 row_ror:8 row_mask:0xf bank_mask:0x3
v_mov_b32_dpp v95, v93 row_ror:8 row_mask:0xf bank_mask:0x3
v_mov_b32_dpp v92, v10 row_ror:8 row_mask:0xf bank_mask:0xc
v_mov_b32_dpp v93, v11 row_ror:8 row_mask:0xf bank_mask:0xc
v_lshlrev_b32 v120, 16, v92
v_and_b32 v121, 0xffff0000, v92
v_lshlrev_b32 v122, 16, v93
v_and_b32 v123, 0xffff0000, v93
v_lshlrev_b32 v124, 16, v94
v_and_b32 v125, 0xffff0000, v94
v_lshlrev_b32 v126, 16, v95
v_and_b32 v127, 0xffff0000, v95
s_waitcnt vmcnt(15)
v_dot2_f32_bf16 v96, v16, s70, v96
v_dot2_f32_bf16 v97, v16, s71, v97
v_dot2_f32_bf16 v98, v17, s70, v98
v_dot2_f32_bf16 v99, v17, s71, v99
v_dot2_f32_bf16 v100, v18, s70, v100
v_dot2_f32_bf16 v101, v18, s71, v101
v_dot2_f32_bf16 v102, v19, s70, v102
v_dot2_f32_bf16 v103, v19, s71, v103
s_waitcnt vmcnt(14)
v_dot2_f32_bf16 v96, v20, s70, v96
v_dot2_f32_bf16 v97, v20, s71, v97
v_dot2_f32_bf16 v98, v21, s70, v98
v_dot2_f32_bf16 v99, v21, s71, v99
v_dot2_f32_bf16 v100, v22, s70, v100
v_dot2_f32_bf16 v101, v22, s71, v101
v_dot2_f32_bf16 v102, v23, s70, v102
v_dot2_f32_bf16 v103, v23, s71, v103
s_waitcnt vmcnt(13)
v_dot2_f32_bf16 v96, v24, s70, v96
v_dot2_f32_bf16 v97, v24, s71, v97
v_dot2_f32_bf16 v98, v25, s70, v98
v_dot2_f32_bf16 v99, v25, s71, v99
v_dot2_f32_bf16 v100, v26, s70, v100
v_dot2_f32_bf16 v101, v26, s71, v101
v_dot2_f32_bf16 v102, v27, s70, v102
v_dot2_f32_bf16 v103, v27, s71, v103
s_waitcnt vmcnt(12)
v_dot2_f32_bf16 v96, v28, s70, v96
v_dot2_f32_bf16 v97, v28, s71, v97
v_dot2_f32_bf16 v98, v29, s70, v98
v_dot2_f32_bf16 v99, v29, s71, v99
v_dot2_f32_bf16 v100, v30, s70, v100
v_dot2_f32_bf16 v101, v30, s71, v101
v_dot2_f32_bf16 v102, v31, s70, v102
v_dot2_f32_bf16 v103, v31, s71, v103
s_waitcnt vmcnt(11)
v_dot2_f32_bf16 v104, v32, s70, v104
v_dot2_f32_bf16 v105, v32, s71, v105
v_dot2_f32_bf16 v106, v33, s70, v106
v_dot2_f32_bf16 v107, v33, s71, v107
v_dot2_f32_bf16 v108, v34, s70, v108
v_dot2_f32_bf16 v109, v34, s71, v109
v_dot2_f32_bf16 v110, v35, s70, v110
v_dot2_f32_bf16 v111, v35, s71, v111
s_waitcnt vmcnt(10)
v_dot2_f32_bf16 v104, v36, s70, v104
v_dot2_f32_bf16 v105, v36, s71, v105
v_dot2_f32_bf16 v106, v37, s70, v106
v_dot2_f32_bf16 v107, v37, s71, v107
v_dot2_f32_bf16 v108, v38, s70, v108
v_dot2_f32_bf16 v109, v38, s71, v109
v_dot2_f32_bf16 v110, v39, s70, v110
v_dot2_f32_bf16 v111, v39, s71, v111
s_waitcnt vmcnt(9)
v_dot2_f32_bf16 v104, v40, s70, v104
v_dot2_f32_bf16 v105, v40, s71, v105
v_dot2_f32_bf16 v106, v41, s70, v106
v_dot2_f32_bf16 v107, v41, s71, v107
v_dot2_f32_bf16 v108, v42, s70, v108
v_dot2_f32_bf16 v109, v42, s71, v109
v_dot2_f32_bf16 v110, v43, s70, v110
v_dot2_f32_bf16 v111, v43, s71, v111
s_waitcnt vmcnt(8)
v_dot2_f32_bf16 v104, v44, s70, v104
v_dot2_f32_bf16 v105, v44, s71, v105
v_dot2_f32_bf16 v106, v45, s70, v106
v_dot2_f32_bf16 v107, v45, s71, v107
v_dot2_f32_bf16 v108, v46, s70, v108
v_dot2_f32_bf16 v109, v46, s71, v109
v_dot2_f32_bf16 v110, v47, s70, v110
v_dot2_f32_bf16 v111, v47, s71, v111
s_waitcnt vmcnt(7)
v_dot2_f32_bf16 v112, v48, s70, v112
v_dot2_f32_bf16 v113, v48, s71, v113
v_dot2_f32_bf16 v114, v49, s70, v114
v_dot2_f32_bf16 v115, v49, s71, v115
v_dot2_f32_bf16 v116, v50, s70, v116
v_dot2_f32_bf16 v117, v50, s71, v117
v_dot2_f32_bf16 v118, v51, s70, v118
v_dot2_f32_bf16 v119, v51, s71, v119
s_waitcnt vmcnt(6)
v_dot2_f32_bf16 v112, v52, s70, v112
v_dot2_f32_bf16 v113, v52, s71, v113
v_dot2_f32_bf16 v114, v53, s70, v114
v_dot2_f32_bf16 v115, v53, s71, v115
v_dot2_f32_bf16 v116, v54, s70, v116
v_dot2_f32_bf16 v117, v54, s71, v117
v_dot2_f32_bf16 v118, v55, s70, v118
v_dot2_f32_bf16 v119, v55, s71, v119
s_waitcnt vmcnt(5)
v_dot2_f32_bf16 v112, v56, s70, v112
v_dot2_f32_bf16 v113, v56, s71, v113
v_dot2_f32_bf16 v114, v57, s70, v114
v_dot2_f32_bf16 v115, v57, s71, v115
v_dot2_f32_bf16 v116, v58, s70, v116
v_dot2_f32_bf16 v117, v58, s71, v117
v_dot2_f32_bf16 v118, v59, s70, v118
v_dot2_f32_bf16 v119, v59, s71, v119
s_waitcnt vmcnt(4)
v_dot2_f32_bf16 v112, v60, s70, v112
v_dot2_f32_bf16 v113, v60, s71, v113
v_dot2_f32_bf16 v114, v61, s70, v114
v_dot2_f32_bf16 v115, v61, s71, v115
v_dot2_f32_bf16 v116, v62, s70, v116
v_dot2_f32_bf16 v117, v62, s71, v117
v_dot2_f32_bf16 v118, v63, s70, v118
v_dot2_f32_bf16 v119, v63, s71, v119
s_waitcnt vmcnt(3)
v_dot2_f32_bf16 v120, v64, s70, v120
v_dot2_f32_bf16 v121, v64, s71, v121
v_dot2_f32_bf16 v122, v65, s70, v122
v_dot2_f32_bf16 v123, v65, s71, v123
v_dot2_f32_bf16 v124, v66, s70, v124
v_dot2_f32_bf16 v125, v66, s71, v125
v_dot2_f32_bf16 v126, v67, s70, v126
v_dot2_f32_bf16 v127, v67, s71, v127
s_waitcnt vmcnt(2)
v_dot2_f32_bf16 v120, v68, s70, v120
v_dot2_f32_bf16 v121, v68, s71, v121
v_dot2_f32_bf16 v122, v69, s70, v122
v_dot2_f32_bf16 v123, v69, s71, v123
v_dot2_f32_bf16 v124, v70, s70, v124
v_dot2_f32_bf16 v125, v70, s71, v125
v_dot2_f32_bf16 v126, v71, s70, v126
v_dot2_f32_bf16 v127, v71, s71, v127
s_waitcnt vmcnt(1)
v_dot2_f32_bf16 v120, v72, s70, v120
v_dot2_f32_bf16 v121, v72, s71, v121
v_dot2_f32_bf16 v122, v73, s70, v122
v_dot2_f32_bf16 v123, v73, s71, v123
v_dot2_f32_bf16 v124, v74, s70, v124
v_dot2_f32_bf16 v125, v74, s71, v125
v_dot2_f32_bf16 v126, v75, s70, v126
v_dot2_f32_bf16 v127, v75, s71, v127
s_waitcnt vmcnt(0)
v_dot2_f32_bf16 v120, v76, s70, v120
v_dot2_f32_bf16 v121, v76, s71, v121
v_dot2_f32_bf16 v122, v77, s70, v122
v_dot2_f32_bf16 v123, v77, s71, v123
v_dot2_f32_bf16 v124, v78, s70, v124
v_dot2_f32_bf16 v125, v78, s71, v125
v_dot2_f32_bf16 v126, v79, s70, v126
v_dot2_f32_bf16 v127, v79, s71, v127
v_cvt_pk_bf16_f32 v80, v96, v97
v_cvt_pk_bf16_f32 v81, v98, v99
v_cvt_pk_bf16_f32 v82, v100, v101
v_cvt_pk_bf16_f32 v83, v102, v103
v_cvt_pk_bf16_f32 v84, v104, v105
v_cvt_pk_bf16_f32 v85, v106, v107
v_cvt_pk_bf16_f32 v86, v108, v109
v_cvt_pk_bf16_f32 v87, v110, v111
v_cvt_pk_bf16_f32 v88, v112, v113
v_cvt_pk_bf16_f32 v89, v114, v115
v_cvt_pk_bf16_f32 v90, v116, v117
v_cvt_pk_bf16_f32 v91, v118, v119
v_cvt_pk_bf16_f32 v92, v120, v121
v_cvt_pk_bf16_f32 v93, v122, v123
v_cvt_pk_bf16_f32 v94, v124, v125
v_cvt_pk_bf16_f32 v95, v126, v127
s_add_u32 s51, s49, 96468992
buffer_store_dwordx4 v[80:83], v5, s[4:7], s51 offen sc1
s_add_u32 s51, s51, 4096
buffer_store_dwordx4 v[84:87], v5, s[4:7], s51 offen sc1
s_add_u32 s51, s51, 4096
buffer_store_dwordx4 v[88:91], v5, s[4:7], s51 offen sc1
s_add_u32 s51, s51, 4096
buffer_store_dwordx4 v[92:95], v5, s[4:7], s51 offen sc1
v_pk_add_f32 v[10:11], v[96:97], v[98:99]
v_pk_add_f32 v[10:11], v[10:11], v[100:101]
v_pk_add_f32 v[10:11], v[10:11], v[102:103]
v_pk_add_f32 v[10:11], v[10:11], v[104:105]
v_pk_add_f32 v[10:11], v[10:11], v[106:107]
v_pk_add_f32 v[10:11], v[10:11], v[108:109]
v_pk_add_f32 v[10:11], v[10:11], v[110:111]
v_pk_add_f32 v[10:11], v[10:11], v[112:113]
v_pk_add_f32 v[10:11], v[10:11], v[114:115]
v_pk_add_f32 v[10:11], v[10:11], v[116:117]
v_pk_add_f32 v[10:11], v[10:11], v[118:119]
v_pk_add_f32 v[10:11], v[10:11], v[120:121]
v_pk_add_f32 v[10:11], v[10:11], v[122:123]
v_pk_add_f32 v[10:11], v[10:11], v[124:125]
v_pk_add_f32 v[10:11], v[10:11], v[126:127]
v_add_f32 v8, v10, v11
s_nop 1
v_add_f32_dpp v8, v8, v8 row_ror:8 row_mask:0xf bank_mask:0xf
v_mov_b32 v9, v8
s_nop 1
v_permlane16_swap_b32 v8, v9
v_add_f32 v8, v8, v9
v_mov_b32 v9, v8
s_nop 1
v_permlane32_swap_b32 v8, v9
v_add_f32 v8, v8, v9
ds_write_b32 v14, v8 offset:0
s_waitcnt lgkmcnt(0)
s_barrier
ds_read_b128 v[10:13], v15 offset:0
s_waitcnt lgkmcnt(0)
v_pk_add_f32 v[10:11], v[10:11], v[12:13]
v_add_f32 v8, v10, v11
v_mul_f32 v8, 0xba800000, v8
v_pk_add_f32 v[96:97], v[96:97], v[8:9] op_sel_hi:[1,0]
v_pk_add_f32 v[98:99], v[98:99], v[8:9] op_sel_hi:[1,0]
v_pk_add_f32 v[100:101], v[100:101], v[8:9] op_sel_hi:[1,0]
v_pk_add_f32 v[102:103], v[102:103], v[8:9] op_sel_hi:[1,0]
v_pk_add_f32 v[104:105], v[104:105], v[8:9] op_sel_hi:[1,0]
v_pk_add_f32 v[106:107], v[106:107], v[8:9] op_sel_hi:[1,0]
v_pk_add_f32 v[108:109], v[108:109], v[8:9] op_sel_hi:[1,0]
v_pk_add_f32 v[110:111], v[110:111], v[8:9] op_sel_hi:[1,0]
v_pk_add_f32 v[112:113], v[112:113], v[8:9] op_sel_hi:[1,0]
v_pk_add_f32 v[114:115], v[114:115], v[8:9] op_sel_hi:[1,0]
v_pk_add_f32 v[116:117], v[116:117], v[8:9] op_sel_hi:[1,0]
v_pk_add_f32 v[118:119], v[118:119], v[8:9] op_sel_hi:[1,0]
v_pk_add_f32 v[120:121], v[120:121], v[8:9] op_sel_hi:[1,0]
v_pk_add_f32 v[122:123], v[122:123], v[8:9] op_sel_hi:[1,0]
v_pk_add_f32 v[124:125], v[124:125], v[8:9] op_sel_hi:[1,0]
v_pk_add_f32 v[126:127], v[126:127], v[8:9] op_sel_hi:[1,0]
v_pk_mul_f32 v[10:11], v[96:97], v[96:97]
v_pk_fma_f32 v[10:11], v[98:99], v[98:99], v[10:11]
v_pk_fma_f32 v[10:11], v[100:101], v[100:101], v[10:11]
v_pk_fma_f32 v[10:11], v[102:103], v[102:103], v[10:11]
v_pk_fma_f32 v[10:11], v[104:105], v[104:105], v[10:11]
v_pk_fma_f32 v[10:11], v[106:107], v[106:107], v[10:11]
v_pk_fma_f32 v[10:11], v[108:109], v[108:109], v[10:11]
v_pk_fma_f32 v[10:11], v[110:111], v[110:111], v[10:11]
v_pk_fma_f32 v[10:11], v[112:113], v[112:113], v[10:11]
v_pk_fma_f32 v[10:11], v[114:115], v[114:115], v[10:11]
v_pk_fma_f32 v[10:11], v[116:117], v[116:117], v[10:11]
v_pk_fma_f32 v[10:11], v[118:119], v[118:119], v[10:11]
v_pk_fma_f32 v[10:11], v[120:121], v[120:121], v[10:11]
v_pk_fma_f32 v[10:11], v[122:123], v[122:123], v[10:11]
v_pk_fma_f32 v[10:11], v[124:125], v[124:125], v[10:11]
v_pk_fma_f32 v[10:11], v[126:127], v[126:127], v[10:11]
v_add_f32 v8, v10, v11
s_nop 1
v_add_f32_dpp v8, v8, v8 row_ror:8 row_mask:0xf bank_mask:0xf
v_mov_b32 v9, v8
s_nop 1
v_permlane16_swap_b32 v8, v9
v_add_f32 v8, v8, v9
v_mov_b32 v9, v8
s_nop 1
v_permlane32_swap_b32 v8, v9
v_add_f32 v8, v8, v9
ds_write_b32 v14, v8 offset:128
s_waitcnt lgkmcnt(0)
s_barrier
ds_read_b128 v[10:13], v15 offset:128
s_waitcnt lgkmcnt(0)
v_pk_add_f32 v[10:11], v[10:11], v[12:13]
v_add_f32 v8, v10, v11
v_mov_b32 v9, 0x3727c5ac
v_fmac_f32 v9, 0x3a800000, v8
v_rsq_f32 v8, v9
s_nop 0
v_pk_mul_f32 v[96:97], v[96:97], v[8:9] op_sel_hi:[1,0]
v_pk_mul_f32 v[98:99], v[98:99], v[8:9] op_sel_hi:[1,0]
v_pk_mul_f32 v[100:101], v[100:101], v[8:9] op_sel_hi:[1,0]
v_pk_mul_f32 v[102:103], v[102:103], v[8:9] op_sel_hi:[1,0]
v_pk_mul_f32 v[104:105], v[104:105], v[8:9] op_sel_hi:[1,0]
v_pk_mul_f32 v[106:107], v[106:107], v[8:9] op_sel_hi:[1,0]
v_pk_mul_f32 v[108:109], v[108:109], v[8:9] op_sel_hi:[1,0]
v_pk_mul_f32 v[110:111], v[110:111], v[8:9] op_sel_hi:[1,0]
v_pk_mul_f32 v[112:113], v[112:113], v[8:9] op_sel_hi:[1,0]
v_pk_mul_f32 v[114:115], v[114:115], v[8:9] op_sel_hi:[1,0]
v_pk_mul_f32 v[116:117], v[116:117], v[8:9] op_sel_hi:[1,0]
v_pk_mul_f32 v[118:119], v[118:119], v[8:9] op_sel_hi:[1,0]
v_pk_mul_f32 v[120:121], v[120:121], v[8:9] op_sel_hi:[1,0]
v_pk_mul_f32 v[122:123], v[122:123], v[8:9] op_sel_hi:[1,0]
v_pk_mul_f32 v[124:125], v[124:125], v[8:9] op_sel_hi:[1,0]
v_pk_mul_f32 v[126:127], v[126:127], v[8:9] op_sel_hi:[1,0]
v_cvt_pk_bf16_f32 v128, v96, v97
v_cvt_pk_bf16_f32 v129, v98, v99
v_cvt_pk_bf16_f32 v130, v100, v101
v_cvt_pk_bf16_f32 v131, v102, v103
v_cvt_pk_bf16_f32 v132, v104, v105
v_cvt_pk_bf16_f32 v133, v106, v107
v_cvt_pk_bf16_f32 v134, v108, v109
v_cvt_pk_bf16_f32 v135, v110, v111
v_cvt_pk_bf16_f32 v136, v112, v113
v_cvt_pk_bf16_f32 v137, v114, v115
v_cvt_pk_bf16_f32 v138, v116, v117
v_cvt_pk_bf16_f32 v139, v118, v119
v_cvt_pk_bf16_f32 v140, v120, v121
v_cvt_pk_bf16_f32 v141, v122, v123
v_cvt_pk_bf16_f32 v142, v124, v125
v_cvt_pk_bf16_f32 v143, v126, v127
s_add_u32 s51, s49, 100663296
buffer_store_dwordx4 v[128:131], v5, s[4:7], s51 offen sc1
s_add_u32 s51, s51, 4096
buffer_store_dwordx4 v[132:135], v5, s[4:7], s51 offen sc1
s_add_u32 s51, s51, 4096
buffer_store_dwordx4 v[136:139], v5, s[4:7], s51 offen sc1
s_add_u32 s51, s51, 4096
buffer_store_dwordx4 v[140:143], v5, s[4:7], s51 offen sc1
v_mov_b32 v4, s63
s_waitcnt vmcnt(0)
s_barrier
s_cmp_lg_u32 s42, 0
s_cbranch_scc1 Lred1_np
s_mov_b64 exec, 1
buffer_store_dword v4, v3, s[4:7], s59 offen sc1
s_mov_b64 exec, -1
Lred1_np:
s_add_u32 s46, s46, 2
s_cmp_lt_u32 s46, 63
s_cbranch_scc1 Lred1_top
s_branch Lend
Lred2:
s_and_b32 s48, s45, 3
s_lshr_b32 s46, s45, 2
s_lshl_b32 s59, s45, 7
s_add_u32 s59, s59, s99
s_add_u32 s59, s59, 69632
s_add_u32 s69, s99, 98304
s_add_u32 s61, s99, 102400
s_mov_b32 s70, 0x3f80
s_mov_b32 s71, 0x3f800000
v_lshrrev_b32 v10, 4, v0
v_and_b32 v1, 31, v10
v_lshlrev_b32 v1, 7, v1
v_lshrrev_b32 v11, 4, v10
v_lshlrev_b32 v5, 10, v11
v_bfe_u32 v12, v10, 3, 1
v_lshl_add_u32 v5, v12, 9, v5
v_and_b32 v13, 7, v10
v_lshl_add_u32 v5, v13, 4, v5
s_lshl_b32 s50, s42, 14
s_lshl_b32 s51, s48, 7
s_add_u32 s50, s50, s51
v_add_u32 v5, s50, v5
v_lshlrev_b32 v6, 11, v13
v_lshrrev_b32 v11, 3, v10
v_lshl_add_u32 v6, v11, 4, v6
s_lshl_b32 s50, s42, 9
s_lshl_b32 s51, s48, 14
s_add_u32 s50, s50, s51
v_add_u32 v6, s50, v6
v_and_b32 v15, 7, v10
v_lshlrev_b32 v15, 4, v15
s_lshl_b32 s50, s42, 2
v_add_u32 v14, s50, v15
s_cmp_eq_u32 s79, 4
s_cselect_b32 s46, 63, s46
s_cselect_b32 s50, 512, 0
s_add_u32 s59, s59, s50
s_mov_b32 s12, s34
s_mov_b32 s13, s35
s_mov_b32 s14, 4194304
s_mov_b32 s15, 0x20000
Lred2_top:
s_add_u32 s63, s46, 1
s_lshl_b32 s49, s46, 16
s_cmp_eq_u32 s46, 63
s_cselect_b32 s69, s61, s69
s_cmp_lg_u32 s42, 0
s_cbranch_scc1 Lred2_spb
s_sub_u32 s50, s63, 1
Lred2_sp:
buffer_load_dword v2, v1, s[4:7], s69 offen sc1
s_waitcnt vmcnt(0)
v_cmp_gt_i32 vcc, s63, v2
s_cbranch_vccz Lred2_spd
v_cmp_gt_i32 vcc, s50, v2
s_sleep 1
s_cbranch_vccz Lred2_spn
s_sleep 12
Lred2_spn:
s_sub_u32 s43, s43, 1
s_cbranch_scc0 Lred2_sp
s_mov_b32 s43, 0
Lred2_spd:
Lred2_spb:
s_barrier
s_lshl_b32 s50, s46, 18
s_add_u32 s50, s50, 138412032
s_add_u32 s51, s49, 96468992
buffer_load_dwordx4 v[80:83], v5, s[4:7], s51 offen sc1
s_add_u32 s51, s51, 4096
buffer_load_dwordx4 v[84:87], v5, s[4:7], s51 offen sc1
s_add_u32 s51, s51, 4096
buffer_load_dwordx4 v[88:91], v5, s[4:7], s51 offen sc1
s_add_u32 s51, s51, 4096
buffer_load_dwordx4 v[92:95], v5, s[4:7], s51 offen sc1
s_add_u32 s51, s50, 0
buffer_load_dwordx4 v[16:19], v5, s[4:7], s51 offen sc1
s_add_u32 s51, s50, 65536
buffer_load_dwordx4 v[20:23], v5, s[4:7], s51 offen sc1
s_add_u32 s51, s50, 131072
buffer_load_dwordx4 v[24:27], v5, s[4:7], s51 offen sc1
s_add_u32 s51, s50, 196608
buffer_load_dwordx4 v[28:31], v5, s[4:7], s51 offen sc1
s_add_u32 s51, s50, 4096
buffer_load_dwordx4 v[32:35], v5, s[4:7], s51 offen sc1
s_add_u32 s51, s50, 69632
buffer_load_dwordx4 v[36:39], v5, s[4:7], s51 offen sc1
s_add_u32 s51, s50, 135168
buffer_load_dwordx4 v[40:43], v5, s[4:7], s51 offen sc1
s_add_u32 s51, s50, 200704
buffer_load_dwordx4 v[44:47], v5, s[4:7], s51 offen sc1
s_add_u32 s51, s50, 8192
buffer_load_dwordx4 v[48:51], v5, s[4:7], s51 offen sc1
s_add_u32 s51, s50, 73728
buffer_load_dwordx4 v[52:55], v5, s[4:7], s51 offen sc1
s_add_u32 s51, s50, 139264
buffer_load_dwordx4 v[56:59], v5, s[4:7], s51 offen sc1
s_add_u32 s51, s50, 204800
buffer_load_dwordx4 v[60:63], v5, s[4:7], s51 offen sc1
s_add_u32 s51, s50, 12288
buffer_load_dwordx4 v[64:67], v5, s[4:7], s51 offen sc1
s_add_u32 s51, s50, 77824
buffer_load_dwordx4 v[68:71], v5, s[4:7], s51 offen sc1
s_add_u32 s51, s50, 143360
buffer_load_dwordx4 v[72:75], v5, s[4:7], s51 offen sc1
s_add_u32 s51, s50, 208896
buffer_load_dwordx4 v[76:79], v5, s[4:7], s51 offen sc1
s_waitcnt vmcnt(16)
v_lshlrev_b32 v96, 16, v80
v_and_b32 v97, 0xffff0000, v80
v_lshlrev_b32 v98, 16, v81
v_and_b32 v99, 0xffff0000, v81
v_lshlrev_b32 v100, 16, v82
v_and_b32 v101, 0xffff0000, v82
v_lshlrev_b32 v102, 16, v83
v_and_b32 v103, 0xffff0000, v83
v_lshlrev_b32 v104, 16, v84
v_and_b32 v105, 0xffff0000, v84
v_lshlrev_b32 v106, 16, v85
v_and_b32 v107, 0xffff0000, v85
v_lshlrev_b32 v108, 16, v86
v_and_b32 v109, 0xffff0000, v86
v_lshlrev_b32 v110, 16, v87
v_and_b32 v111, 0xffff0000, v87
v_lshlrev_b32 v112, 16, v88
v_and_b32 v113, 0xffff0000, v88
v_lshlrev_b32 v114, 16, v89
v_and_b32 v115, 0xffff0000, v89
v_lshlrev_b32 v116, 16, v90
v_and_b32 v117, 0xffff0000, v90
v_lshlrev_b32 v118, 16, v91
v_and_b32 v119, 0xffff0000, v91
v_lshlrev_b32 v120, 16, v92
v_and_b32 v121, 0xffff0000, v92
v_lshlrev_b32 v122, 16, v93
v_and_b32 v123, 0xffff0000, v93
v_lshlrev_b32 v124, 16, v94
v_and_b32 v125, 0xffff0000, v94
v_lshlrev_b32 v126, 16, v95
v_and_b32 v127, 0xffff0000, v95
s_waitcnt vmcnt(15)
v_dot2_f32_bf16 v96, v16, s70, v96
v_dot2_f32_bf16 v97, v16, s71, v97
v_dot2_f32_bf16 v98, v17, s70, v98
v_dot2_f32_bf16 v99, v17, s71, v99
v_dot2_f32_bf16 v100, v18, s70, v100
v_dot2_f32_bf16 v101, v18, s71, v101
v_dot2_f32_bf16 v102, v19, s70, v102
v_dot2_f32_bf16 v103, v19, s71, v103
s_waitcnt vmcnt(14)
v_dot2_f32_bf16 v96, v20, s70, v96
v_dot2_f32_bf16 v97, v20, s71, v97
v_dot2_f32_bf16 v98, v21, s70, v98
v_dot2_f32_bf16 v99, v21, s71, v99
v_dot2_f32_bf16 v100, v22, s70, v100
v_dot2_f32_bf16 v101, v22, s71, v101
v_dot2_f32_bf16 v102, v23, s70, v102
v_dot2_f32_bf16 v103, v23, s71, v103
s_waitcnt vmcnt(13)
v_dot2_f32_bf16 v96, v24, s70, v96
v_dot2_f32_bf16 v97, v24, s71, v97
v_dot2_f32_bf16 v98, v25, s70, v98
v_dot2_f32_bf16 v99, v25, s71, v99
v_dot2_f32_bf16 v100, v26, s70, v100
v_dot2_f32_bf16 v101, v26, s71, v101
v_dot2_f32_bf16 v102, v27, s70, v102
v_dot2_f32_bf16 v103, v27, s71, v103
s_waitcnt vmcnt(12)
v_dot2_f32_bf16 v96, v28, s70, v96
v_dot2_f32_bf16 v97, v28, s71, v97
v_dot2_f32_bf16 v98, v29, s70, v98
v_dot2_f32_bf16 v99, v29, s71, v99
v_dot2_f32_bf16 v100, v30, s70, v100
v_dot2_f32_bf16 v101, v30, s71, v101
v_dot2_f32_bf16 v102, v31, s70, v102
v_dot2_f32_bf16 v103, v31, s71, v103
s_waitcnt vmcnt(11)
v_dot2_f32_bf16 v104, v32, s70, v104
v_dot2_f32_bf16 v105, v32, s71, v105
v_dot2_f32_bf16 v106, v33, s70, v106
v_dot2_f32_bf16 v107, v33, s71, v107
v_dot2_f32_bf16 v108, v34, s70, v108
v_dot2_f32_bf16 v109, v34, s71, v109
v_dot2_f32_bf16 v110, v35, s70, v110
v_dot2_f32_bf16 v111, v35, s71, v111
s_waitcnt vmcnt(10)
v_dot2_f32_bf16 v104, v36, s70, v104
v_dot2_f32_bf16 v105, v36, s71, v105
v_dot2_f32_bf16 v106, v37, s70, v106
v_dot2_f32_bf16 v107, v37, s71, v107
v_dot2_f32_bf16 v108, v38, s70, v108
v_dot2_f32_bf16 v109, v38, s71, v109
v_dot2_f32_bf16 v110, v39, s70, v110
v_dot2_f32_bf16 v111, v39, s71, v111
s_waitcnt vmcnt(9)
v_dot2_f32_bf16 v104, v40, s70, v104
v_dot2_f32_bf16 v105, v40, s71, v105
v_dot2_f32_bf16 v106, v41, s70, v106
v_dot2_f32_bf16 v107, v41, s71, v107
v_dot2_f32_bf16 v108, v42, s70, v108
v_dot2_f32_bf16 v109, v42, s71, v109
v_dot2_f32_bf16 v110, v43, s70, v110
v_dot2_f32_bf16 v111, v43, s71, v111
s_waitcnt vmcnt(8)
v_dot2_f32_bf16 v104, v44, s70, v104
v_dot2_f32_bf16 v105, v44, s71, v105
v_dot2_f32_bf16 v106, v45, s70, v106
v_dot2_f32_bf16 v107, v45, s71, v107
v_dot2_f32_bf16 v108, v46, s70, v108
v_dot2_f32_bf16 v109, v46, s71, v109
v_dot2_f32_bf16 v110, v47, s70, v110
v_dot2_f32_bf16 v111, v47, s71, v111
s_waitcnt vmcnt(7)
v_dot2_f32_bf16 v112, v48, s70, v112
v_dot2_f32_bf16 v113, v48, s71, v113
v_dot2_f32_bf16 v114, v49, s70, v114
v_dot2_f32_bf16 v115, v49, s71, v115
v_dot2_f32_bf16 v116, v50, s70, v116
v_dot2_f32_bf16 v117, v50, s71, v117
v_dot2_f32_bf16 v118, v51, s70, v118
v_dot2_f32_bf16 v119, v51, s71, v119
s_waitcnt vmcnt(6)
v_dot2_f32_bf16 v112, v52, s70, v112
v_dot2_f32_bf16 v113, v52, s71, v113
v_dot2_f32_bf16 v114, v53, s70, v114
v_dot2_f32_bf16 v115, v53, s71, v115
v_dot2_f32_bf16 v116, v54, s70, v116
v_dot2_f32_bf16 v117, v54, s71, v117
v_dot2_f32_bf16 v118, v55, s70, v118
v_dot2_f32_bf16 v119, v55, s71, v119
s_waitcnt vmcnt(5)
v_dot2_f32_bf16 v112, v56, s70, v112
v_dot2_f32_bf16 v113, v56, s71, v113
v_dot2_f32_bf16 v114, v57, s70, v114
v_dot2_f32_bf16 v115, v57, s71, v115
v_dot2_f32_bf16 v116, v58, s70, v116
v_dot2_f32_bf16 v117, v58, s71, v117
v_dot2_f32_bf16 v118, v59, s70, v118
v_dot2_f32_bf16 v119, v59, s71, v119
s_waitcnt vmcnt(4)
v_dot2_f32_bf16 v112, v60, s70, v112
v_dot2_f32_bf16 v113, v60, s71, v113
v_dot2_f32_bf16 v114, v61, s70, v114
v_dot2_f32_bf16 v115, v61, s71, v115
v_dot2_f32_bf16 v116, v62, s70, v116
v_dot2_f32_bf16 v117, v62, s71, v117
v_dot2_f32_bf16 v118, v63, s70, v118
v_dot2_f32_bf16 v119, v63, s71, v119
s_waitcnt vmcnt(3)
v_dot2_f32_bf16 v120, v64, s70, v120
v_dot2_f32_bf16 v121, v64, s71, v121
v_dot2_f32_bf16 v122, v65, s70, v122
v_dot2_f32_bf16 v123, v65, s71, v123
v_dot2_f32_bf16 v124, v66, s70, v124
v_dot2_f32_bf16 v125, v66, s71, v125
v_dot2_f32_bf16 v126, v67, s70, v126
v_dot2_f32_bf16 v127, v67, s71, v127
s_waitcnt vmcnt(2)
v_dot2_f32_bf16 v120, v68, s70, v120
v_dot2_f32_bf16 v121, v68, s71, v121
v_dot2_f32_bf16 v122, v69, s70, v122
v_dot2_f32_bf16 v123, v69, s71, v123
v_dot2_f32_bf16 v124, v70, s70, v124
v_dot2_f32_bf16 v125, v70, s71, v125
v_dot2_f32_bf16 v126, v71, s70, v126
v_dot2_f32_bf16 v127, v71, s71, v127
s_waitcnt vmcnt(1)
v_dot2_f32_bf16 v120, v72, s70, v120
v_dot2_f32_bf16 v121, v72, s71, v121
v_dot2_f32_bf16 v122, v73, s70, v122
v_dot2_f32_bf16 v123, v73, s71, v123
v_dot2_f32_bf16 v124, v74, s70, v124
v_dot2_f32_bf16 v125, v74, s71, v125
v_dot2_f32_bf16 v126, v75, s70, v126
v_dot2_f32_bf16 v127, v75, s71, v127
s_waitcnt vmcnt(0)
v_dot2_f32_bf16 v120, v76, s70, v120
v_dot2_f32_bf16 v121, v76, s71, v121
v_dot2_f32_bf16 v122, v77, s70, v122
v_dot2_f32_bf16 v123, v77, s71, v123
v_dot2_f32_bf16 v124, v78, s70, v124
v_dot2_f32_bf16 v125, v78, s71, v125
v_dot2_f32_bf16 v126, v79, s70, v126
v_dot2_f32_bf16 v127, v79, s71, v127
v_cvt_pk_bf16_f32 v80, v96, v97
v_cvt_pk_bf16_f32 v81, v98, v99
v_cvt_pk_bf16_f32 v82, v100, v101
v_cvt_pk_bf16_f32 v83, v102, v103
v_cvt_pk_bf16_f32 v84, v104, v105
v_cvt_pk_bf16_f32 v85, v106, v107
v_cvt_pk_bf16_f32 v86, v108, v109
v_cvt_pk_bf16_f32 v87, v110, v111
v_cvt_pk_bf16_f32 v88, v112, v113
v_cvt_pk_bf16_f32 v89, v114, v115
v_cvt_pk_bf16_f32 v90, v116, v117
v_cvt_pk_bf16_f32 v91, v118, v119
v_cvt_pk_bf16_f32 v92, v120, v121
v_cvt_pk_bf16_f32 v93, v122, v123
v_cvt_pk_bf16_f32 v94, v124, v125
v_cvt_pk_bf16_f32 v95, v126, v127
v_mov_b32 v10, v82
v_mov_b32 v11, v83
v_mov_b32_dpp v82, v80 row_ror:8 row_mask:0xf bank_mask:0x3
v_mov_b32_dpp v83, v81 row_ror:8 row_mask:0xf bank_mask:0x3
v_mov_b32_dpp v80, v10 row_ror:8 row_mask:0xf bank_mask:0xc
v_mov_b32_dpp v81, v11 row_ror:8 row_mask:0xf bank_mask:0xc
buffer_store_dwordx4 v[80:83], v6, s[12:15], s49 offen offset:0
v_mov_b32 v10, v86
v_mov_b32 v11, v87
v_mov_b32_dpp v86, v84 row_ror:8 row_mask:0xf bank_mask:0x3
v_mov_b32_dpp v87, v85 row_ror:8 row_mask:0xf bank_mask:0x3
v_mov_b32_dpp v84, v10 row_ror:8 row_mask:0xf bank_mask:0xc
v_mov_b32_dpp v85, v11 row_ror:8 row_mask:0xf bank_mask:0xc
buffer_store_dwordx4 v[84:87], v6, s[12:15], s49 offen offset:128
v_mov_b32 v10, v90
v_mov_b32 v11, v91
v_mov_b32_dpp v90, v88 row_ror:8 row_mask:0xf bank_mask:0x3
v_mov_b32_dpp v91, v89 row_ror:8 row_mask:0xf bank_mask:0x3
v_mov_b32_dpp v88, v10 row_ror:8 row_mask:0xf bank_mask:0xc
v_mov_b32_dpp v89, v11 row_ror:8 row_mask:0xf bank_mask:0xc
buffer_store_dwordx4 v[88:91], v6, s[12:15], s49 offen offset:256
v_mov_b32 v10, v94
v_mov_b32 v11, v95
v_mov_b32_dpp v94, v92 row_ror:8 row_mask:0xf bank_mask:0x3
v_mov_b32_dpp v95, v93 row_ror:8 row_mask:0xf bank_mask:0x3
v_mov_b32_dpp v92, v10 row_ror:8 row_mask:0xf bank_mask:0xc
v_mov_b32_dpp v93, v11 row_ror:8 row_mask:0xf bank_mask:0xc
buffer_store_dwordx4 v[92:95], v6, s[12:15], s49 offen offset:384
s_add_u32 s46, s46, 2
s_cmp_lt_u32 s46, 63
s_cbranch_scc1 Lred2_top
s_branch Lend
Lend:
Lend0:
s_endpgm
.section .rodata,"a"
.p2align 6
.amdhsa_kernel sequential_preLN__memory_aug_recurrent_mem_tr__geglu_ffn__prompt_kernel
  .amdhsa_next_free_vgpr 512
  .amdhsa_next_free_sgpr 102
  .amdhsa_accum_offset 256
  .amdhsa_group_segment_fixed_size 0
  .amdhsa_kernarg_size 112
  .amdhsa_user_sgpr_count 2
  .amdhsa_user_sgpr_kernarg_segment_ptr 1
  .amdhsa_system_sgpr_workgroup_id_x 1
  .amdhsa_float_denorm_mode_32 3
.end_amdhsa_kernel
```
